```python
import torch

def _softmax(x, axis=-1):
    return torch.softmax(x, dim=axis)
def _gelu(x):
    return torch.nn.functional.gelu(x, approximate="tanh")
def _silu(x):
    return torch.nn.functional.silu(x)
def _sigmoid(x):
    return torch.sigmoid(x)
def _layernorm(x, axis=-1, eps=1e-5):
    m = x.mean(dim=axis, keepdim=True)
    v = x.var(dim=axis, keepdim=True, unbiased=False)
    return (x - m) / torch.sqrt(v + eps)
def _scatter_add(tgt, idx, src, axis=0):
    return tgt.clone().index_add_(axis, idx, src)
def _segment_sum(src, seg, n):
    out = torch.zeros((n,) + src.shape[1:], dtype=src.dtype)
    return out.index_add_(0, seg, src)
def _pad(x, pw):
    flat = tuple(v for pair in reversed(pw) for v in pair)
    return torch.nn.functional.pad(x, flat)

kernel_name = 'standalone__mha_block_cached__near_ridge'

def setup_inputs():

    _w = (lambda a: (lambda t: t.to(torch.bfloat16) if t.is_floating_point() else t)(torch.as_tensor(a)))
    B, Sq, D = 32, 192, 448
    H, Sk, Dh = 16, 512, 256
    return {
        "x": _w((lambda *s: torch.randn(*s, dtype=torch.bfloat16) * 0.8)(B, Sq, D)),
        "k_cache": _w((lambda *s: torch.randn(*s, dtype=torch.bfloat16) * 0.8)(B, H, Sk, Dh)),
        "v_cache": _w((lambda *s: torch.randn(*s, dtype=torch.bfloat16) * 0.05)(B, H, Sk, Dh)),
        "wq": _w((lambda *s: torch.randn(*s, dtype=torch.bfloat16) * 0.8)(D, H * Dh) * (D ** -0.5)),
        "wo": _w((lambda *s: torch.randn(*s, dtype=torch.bfloat16) * 0.05)(H * Dh, D) * ((H * Dh) ** -0.5)),
    }

def reference(x, k_cache, v_cache, wq, wo):
    B, Sq, D = x.shape
    H, Dh = 16, 256
    q = (lambda x, *d: x.permute(*d))((x @ wq).reshape(B, Sq, H, Dh), 0, 2, 1, 3)
    scores = torch.einsum("bhqd,bhkd->bhqk", q, k_cache) * (Dh ** -0.5)
    p = _softmax(scores, axis=-1)
    o = torch.einsum("bhqk,bhkd->bhqd", p, v_cache)
    return (lambda x, *d: x.permute(*d))(o, 0, 2, 1, 3).reshape(B, Sq, H * Dh) @ wo
```

```asm
; @launch grid=(256,1,1) block=(256,1,1) lds=163840
.amdgcn_target "amdgcn-amd-amdhsa--gfx950"
.text
.globl standalone__mha_block_cached__near_ridge_kernel
.p2align 8
.type standalone__mha_block_cached__near_ridge_kernel,@function
standalone__mha_block_cached__near_ridge_kernel:
s_cmp_ge_u32 s2, 256
s_cbranch_scc1 L_done
s_load_dwordx4 s[4:7], s[0:1], 0
s_load_dwordx4 s[8:11], s[0:1], 16
s_load_dwordx2 s[12:13], s[0:1], 32
s_load_dwordx4 s[88:91], s[0:1], 40
s_load_dwordx2 s[14:15], s[0:1], 56
v_lshrrev_b32 v20, 6, v0
v_and_b32 v21, 63, v0
v_readfirstlane_b32 s16, v20
s_and_b32 s92, s2, 1
s_lshl_b32 s92, s92, 2
s_lshr_b32 s51, s2, 3
s_and_b32 s51, s51, 3
s_add_u32 s92, s92, s51
s_lshr_b32 s93, s2, 1
s_and_b32 s93, s93, 3
s_lshl_b32 s93, s93, 3
s_lshr_b32 s56, s2, 5
s_add_u32 s93, s93, s56
s_lshl_b32 s94, s93, 3
s_add_u32 s94, s94, s92
v_lshlrev_b32 v252, 4, v21
v_lshrrev_b32 v22, 5, v21
v_and_b32 v23, 0x1f0, v252
s_lshl_b32 s55, s16, 16
v_lshl_add_u32 v24, v22, 15, v23
v_add_u32 v4, s55, v24
v_add_u32 v5, 7136, v4
v_add_u32 v6, 14272, v4
v_add_u32 v7, 21408, v4
s_mul_i32 s55, s16, 43008
v_lshrrev_b32 v24, 3, v21
v_and_b32 v25, 7, v21
v_lshrrev_b32 v26, 1, v24
v_xor_b32 v25, v25, v26
v_mul_u32_u24 v24, 896, v24
v_add_u32 v24, s55, v24
v_lshl_add_u32 v14, v25, 4, v24
v_xor_b32 v25, 4, v25
v_lshl_add_u32 v253, v25, 4, v24
v_add_u32 v253, 6144, v253
s_mul_i32 s17, s16, 4224
s_mul_i32 s52, s16, 6144
s_lshl_b32 s51, s51, 1
s_add_u32 s51, s51, s56
s_mul_i32 s55, s51, 37
s_lshr_b32 s55, s55, 8
s_mul_i32 s55, s55, 7
s_sub_u32 s51, s51, s55
s_lshl_b32 s95, s92, 10
s_mul_i32 s55, s93, 172032
s_waitcnt lgkmcnt(0)
s_add_u32 s36, s4, s55
s_addc_u32 s37, s5, 0
s_mov_b32 s38, 172032
s_mov_b32 s39, 0x20000
s_mov_b32 s28, s10
s_mov_b32 s29, s11
s_mov_b32 s30, 3670016
s_mov_b32 s31, 0x20000
s_lshl_b32 s18, s51, 7
s_lshl_b32 s99, s51, 19
s_add_u32 s99, s99, s95
s_add_u32 m0, s52, 0
s_add_u32 s50, s18, 0
buffer_load_dwordx4 v14, s[36:39], s50 offen lds
buffer_load_dwordx4 v253, s[36:39], s50 offen offset:1024 lds
s_add_u32 m0, s52, 2048
s_add_u32 s50, s18, 14336
buffer_load_dwordx4 v14, s[36:39], s50 offen lds
buffer_load_dwordx4 v253, s[36:39], s50 offen offset:1024 lds
s_add_u32 m0, s52, 4096
s_add_u32 s50, s18, 28672
buffer_load_dwordx4 v14, s[36:39], s50 offen lds
buffer_load_dwordx4 v253, s[36:39], s50 offen offset:1024 lds
s_add_u32 m0, s17, 67584
s_add_u32 s50, s99, 0
buffer_load_dwordx4 v4, s[28:31], s50 offen offset:0 lds
buffer_load_dwordx4 v5, s[28:31], s50 offen offset:1056 lds
buffer_load_dwordx4 v6, s[28:31], s50 offen offset:2112 lds
buffer_load_dwordx4 v7, s[28:31], s50 offen offset:3168 lds
v_and_b32 v24, 15, v21
v_lshrrev_b32 v25, 4, v21
v_mul_u32_u24 v26, 1056, v24
v_lshl_add_u32 v8, v25, 4, v26
v_lshrrev_b32 v26, 1, v24
v_xor_b32 v26, v26, v25
v_lshlrev_b32 v26, 4, v26
v_lshl_add_u32 v254, v24, 7, v26
v_lshrrev_b32 v24, 2, v21
v_and_b32 v25, 3, v21
v_mul_u32_u24 v24, 1056, v24
v_lshl_add_u32 v9, v25, 3, v24
v_lshl_add_u32 v15, v25, 4, v24
s_add_u32 s53, s52, 24576
s_add_u32 s54, s52, 49152
s_cmp_eq_u32 s16, 3
s_cselect_b32 s54, 152064, s54
s_add_u32 s51, s51, 1
s_cmp_eq_u32 s51, 7
s_cselect_b32 s51, 0, s51
s_lshl_b32 s19, s51, 7
s_lshl_b32 s100, s51, 19
s_add_u32 s100, s100, s95
s_add_u32 s51, s51, 1
s_cmp_eq_u32 s51, 7
s_cselect_b32 s51, 0, s51
s_lshl_b32 s84, s51, 7
s_lshl_b32 s101, s51, 19
s_add_u32 s101, s101, s95
s_add_u32 s51, s51, 1
s_cmp_eq_u32 s51, 7
s_cselect_b32 s51, 0, s51
s_lshl_b32 s85, s51, 7
s_lshl_b32 s45, s51, 19
s_add_u32 s45, s45, s95
s_getpc_b64 s[66:67]
L_pc:
s_add_u32 m0, s17, 84480
s_add_u32 s50, s99, 262144
buffer_load_dwordx4 v4, s[28:31], s50 offen offset:0 lds
buffer_load_dwordx4 v5, s[28:31], s50 offen offset:1056 lds
buffer_load_dwordx4 v6, s[28:31], s50 offen offset:2112 lds
buffer_load_dwordx4 v7, s[28:31], s50 offen offset:3168 lds
s_add_u32 m0, s53, 0
s_add_u32 s50, s19, 0
buffer_load_dwordx4 v14, s[36:39], s50 offen lds
buffer_load_dwordx4 v253, s[36:39], s50 offen offset:1024 lds
s_add_u32 m0, s53, 2048
s_add_u32 s50, s19, 14336
buffer_load_dwordx4 v14, s[36:39], s50 offen lds
buffer_load_dwordx4 v253, s[36:39], s50 offen offset:1024 lds
s_add_u32 m0, s53, 4096
s_add_u32 s50, s19, 28672
buffer_load_dwordx4 v14, s[36:39], s50 offen lds
buffer_load_dwordx4 v253, s[36:39], s50 offen offset:1024 lds
s_waitcnt vmcnt(14)
v_add_u32 v74, s52, v254
v_xor_b32 v75, 64, v74
ds_read_b128 a[120:123], v74 offset:0
ds_read_b128 a[124:127], v74 offset:2048
ds_read_b128 a[128:131], v74 offset:4096
ds_read_b128 a[132:135], v75 offset:0
ds_read_b128 a[136:139], v75 offset:2048
ds_read_b128 a[140:143], v75 offset:4096
s_waitcnt vmcnt(10)
s_barrier
v_add_u32 v15, 67584, v15
ds_read_b64_tr_b16 a[16:17], v15 offset:0
ds_read_b64_tr_b16 a[18:19], v15 offset:512
ds_read_b64_tr_b16 a[20:21], v15 offset:8
ds_read_b64_tr_b16 a[22:23], v15 offset:520
ds_read_b64_tr_b16 a[24:25], v15 offset:64
ds_read_b64_tr_b16 a[26:27], v15 offset:576
ds_read_b64_tr_b16 a[28:29], v15 offset:72
ds_read_b64_tr_b16 a[30:31], v15 offset:584
ds_read_b64_tr_b16 a[32:33], v15 offset:128
ds_read_b64_tr_b16 a[34:35], v15 offset:640
s_waitcnt lgkmcnt(6)
LS_0:
v_mfma_f32_16x16x32_bf16 v[76:79], a[16:19], a[120:123], 0
ds_read_b64_tr_b16 a[36:37], v15 offset:136
v_mfma_f32_16x16x32_bf16 v[80:83], a[16:19], a[124:127], 0
ds_read_b64_tr_b16 a[38:39], v15 offset:648
v_mfma_f32_16x16x32_bf16 v[84:87], a[16:19], a[128:131], 0
s_add_u32 m0, s17, 101376
s_add_u32 s50, s100, 0
v_mfma_f32_16x16x32_bf16 v[96:99], a[20:23], a[128:131], 0
ds_read_b64_tr_b16 a[40:41], v15 offset:192
v_mfma_f32_16x16x32_bf16 v[92:95], a[20:23], a[124:127], 0
ds_read_b64_tr_b16 a[42:43], v15 offset:704
buffer_load_dwordx4 v4, s[28:31], s50 offen offset:0 lds
v_mfma_f32_16x16x32_bf16 v[88:91], a[20:23], a[120:123], 0
s_waitcnt lgkmcnt(6)
buffer_load_dwordx4 v5, s[28:31], s50 offen offset:1056 lds
v_mfma_f32_16x16x32_bf16 v[100:103], a[24:27], a[120:123], 0
ds_read_b64_tr_b16 a[44:45], v15 offset:200
v_mfma_f32_16x16x32_bf16 v[104:107], a[24:27], a[124:127], 0
ds_read_b64_tr_b16 a[46:47], v15 offset:712
buffer_load_dwordx4 v6, s[28:31], s50 offen offset:2112 lds
v_mfma_f32_16x16x32_bf16 v[108:111], a[24:27], a[128:131], 0
buffer_load_dwordx4 v7, s[28:31], s50 offen offset:3168 lds
v_mfma_f32_16x16x32_bf16 v[120:123], a[28:31], a[128:131], 0
ds_read_b64_tr_b16 a[16:17], v15 offset:256
s_add_u32 m0, s17, 118272
s_add_u32 s50, s100, 262144
v_mfma_f32_16x16x32_bf16 v[116:119], a[28:31], a[124:127], 0
ds_read_b64_tr_b16 a[18:19], v15 offset:768
buffer_load_dwordx4 v4, s[28:31], s50 offen offset:0 lds
v_mfma_f32_16x16x32_bf16 v[112:115], a[28:31], a[120:123], 0
s_waitcnt lgkmcnt(6)
v_mfma_f32_16x16x32_bf16 v[124:127], a[32:35], a[120:123], 0
ds_read_b64_tr_b16 a[20:21], v15 offset:264
buffer_load_dwordx4 v5, s[28:31], s50 offen offset:1056 lds
v_mfma_f32_16x16x32_bf16 v[128:131], a[32:35], a[124:127], 0
ds_read_b64_tr_b16 a[22:23], v15 offset:776
s_add_u32 s51, s51, 1
s_cmp_eq_u32 s51, 7
s_cselect_b32 s51, 0, s51
v_mfma_f32_16x16x32_bf16 v[132:135], a[32:35], a[128:131], 0
buffer_load_dwordx4 v6, s[28:31], s50 offen offset:2112 lds
v_mfma_f32_16x16x32_bf16 v[144:147], a[36:39], a[128:131], 0
ds_read_b64_tr_b16 a[24:25], v15 offset:320
v_mfma_f32_16x16x32_bf16 v[140:143], a[36:39], a[124:127], 0
ds_read_b64_tr_b16 a[26:27], v15 offset:832
s_lshl_b32 s96, s51, 7
s_lshl_b32 s46, s51, 19
s_add_u32 s46, s46, s95
v_mfma_f32_16x16x32_bf16 v[136:139], a[36:39], a[120:123], 0
s_waitcnt lgkmcnt(6)
buffer_load_dwordx4 v7, s[28:31], s50 offen offset:3168 lds
v_mfma_f32_16x16x32_bf16 v[148:151], a[40:43], a[120:123], 0
ds_read_b64_tr_b16 a[28:29], v15 offset:328
v_mfma_f32_16x16x32_bf16 v[152:155], a[40:43], a[124:127], 0
ds_read_b64_tr_b16 a[30:31], v15 offset:840
s_add_u32 s51, s51, 1
s_cmp_eq_u32 s51, 7
s_cselect_b32 s51, 0, s51
v_mfma_f32_16x16x32_bf16 v[156:159], a[40:43], a[128:131], 0
s_waitcnt vmcnt(14)
s_barrier
v_mfma_f32_16x16x32_bf16 v[168:171], a[44:47], a[128:131], 0
ds_read_b64_tr_b16 a[32:33], v15 offset:384
s_add_u32 m0, s54, 0
s_add_u32 s50, s84, 0
v_mfma_f32_16x16x32_bf16 v[164:167], a[44:47], a[124:127], 0
ds_read_b64_tr_b16 a[34:35], v15 offset:896
s_lshl_b32 s97, s51, 7
s_lshl_b32 s57, s51, 19
s_add_u32 s57, s57, s95
v_mfma_f32_16x16x32_bf16 v[160:163], a[44:47], a[120:123], 0
s_waitcnt lgkmcnt(6)
buffer_load_dwordx4 v14, s[36:39], s50 offen lds
v_mfma_f32_16x16x32_bf16 v[172:175], a[16:19], a[120:123], 0
ds_read_b64_tr_b16 a[36:37], v15 offset:392
buffer_load_dwordx4 v253, s[36:39], s50 offen offset:1024 lds
v_mfma_f32_16x16x32_bf16 v[176:179], a[16:19], a[124:127], 0
ds_read_b64_tr_b16 a[38:39], v15 offset:904
s_add_u32 s51, s51, 1
s_cmp_eq_u32 s51, 7
s_cselect_b32 s51, 0, s51
v_mfma_f32_16x16x32_bf16 v[180:183], a[16:19], a[128:131], 0
s_lshl_b32 s98, s51, 7
s_lshl_b32 s58, s51, 19
s_add_u32 s58, s58, s95
v_mfma_f32_16x16x32_bf16 v[192:195], a[20:23], a[128:131], 0
ds_read_b64_tr_b16 a[40:41], v15 offset:448
v_mfma_f32_16x16x32_bf16 v[188:191], a[20:23], a[124:127], 0
ds_read_b64_tr_b16 a[42:43], v15 offset:960
s_add_u32 m0, s54, 2048
s_add_u32 s50, s84, 14336
v_mfma_f32_16x16x32_bf16 v[184:187], a[20:23], a[120:123], 0
s_waitcnt lgkmcnt(6)
s_lshr_b32 s55, s2, 3
s_lshl_b32 s55, s55, 2
v_mfma_f32_16x16x32_bf16 v[196:199], a[24:27], a[120:123], 0
ds_read_b64_tr_b16 a[44:45], v15 offset:456
buffer_load_dwordx4 v14, s[36:39], s50 offen lds
v_mfma_f32_16x16x32_bf16 v[200:203], a[24:27], a[124:127], 0
ds_read_b64_tr_b16 a[46:47], v15 offset:968
s_add_u32 s55, s55, s16
s_lshl_b32 s55, s55, 7
v_mfma_f32_16x16x32_bf16 v[204:207], a[24:27], a[128:131], 0
buffer_load_dwordx4 v253, s[36:39], s50 offen offset:1024 lds
v_lshlrev_b32 v68, 10, v252
v_mfma_f32_16x16x32_bf16 v[216:219], a[28:31], a[128:131], 0
ds_read_b64_tr_b16 a[16:17], v15 offset:16896
v_add_u32 v68, s55, v68
v_mfma_f32_16x16x32_bf16 v[212:215], a[28:31], a[124:127], 0
ds_read_b64_tr_b16 a[18:19], v15 offset:17408
s_add_u32 m0, s54, 4096
s_add_u32 s50, s84, 28672
v_mfma_f32_16x16x32_bf16 v[208:211], a[28:31], a[120:123], 0
s_waitcnt lgkmcnt(6)
buffer_load_dwordx4 v14, s[36:39], s50 offen lds
v_mfma_f32_16x16x32_bf16 v[220:223], a[32:35], a[120:123], 0
ds_read_b64_tr_b16 a[20:21], v15 offset:16904
s_mov_b32 s55, L_code_end-L_pc-4
v_mfma_f32_16x16x32_bf16 v[224:227], a[32:35], a[124:127], 0
ds_read_b64_tr_b16 a[22:23], v15 offset:17416
buffer_load_dwordx4 v253, s[36:39], s50 offen offset:1024 lds
v_min_u32 v68, s55, v68
v_mfma_f32_16x16x32_bf16 v[228:231], a[32:35], a[128:131], 0
s_add_u32 m0, s52, 0
s_add_u32 s50, s85, 0
v_mfma_f32_16x16x32_bf16 v[240:243], a[36:39], a[128:131], 0
ds_read_b64_tr_b16 a[24:25], v15 offset:16960
global_load_dword a255, v68, s[66:67]
v_mfma_f32_16x16x32_bf16 v[236:239], a[36:39], a[124:127], 0
ds_read_b64_tr_b16 a[26:27], v15 offset:17472
buffer_load_dwordx4 v14, s[36:39], s50 offen lds
s_lshl_b32 s55, s94, 19
v_mfma_f32_16x16x32_bf16 v[232:235], a[36:39], a[120:123], 0
s_waitcnt lgkmcnt(6)
buffer_load_dwordx4 v253, s[36:39], s50 offen offset:1024 lds
v_mfma_f32_16x16x32_bf16 v[244:247], a[40:43], a[120:123], 0
ds_read_b64_tr_b16 a[28:29], v15 offset:16968
s_add_u32 m0, s52, 2048
s_add_u32 s50, s85, 14336
v_mfma_f32_16x16x32_bf16 v[248:251], a[40:43], a[124:127], 0
ds_read_b64_tr_b16 a[30:31], v15 offset:17480
buffer_load_dwordx4 v14, s[36:39], s50 offen lds
v_mfma_f32_16x16x32_bf16 a[0:3], a[40:43], a[128:131], 0
buffer_load_dwordx4 v253, s[36:39], s50 offen offset:1024 lds
v_mfma_f32_16x16x32_bf16 a[12:15], a[44:47], a[128:131], 0
ds_read_b64_tr_b16 a[32:33], v15 offset:17024
s_add_u32 m0, s52, 4096
s_add_u32 s50, s85, 28672
v_mfma_f32_16x16x32_bf16 a[8:11], a[44:47], a[124:127], 0
ds_read_b64_tr_b16 a[34:35], v15 offset:17536
buffer_load_dwordx4 v14, s[36:39], s50 offen lds
v_mfma_f32_16x16x32_bf16 a[4:7], a[44:47], a[120:123], 0
s_waitcnt lgkmcnt(6)
buffer_load_dwordx4 v253, s[36:39], s50 offen offset:1024 lds
LS_1:
v_mfma_f32_16x16x32_bf16 v[76:79], a[16:19], a[132:135], v[76:79]
ds_read_b64_tr_b16 a[36:37], v15 offset:17032
s_waitcnt vmcnt(21)
v_mfma_f32_16x16x32_bf16 v[80:83], a[16:19], a[136:139], v[80:83]
ds_read_b64_tr_b16 a[38:39], v15 offset:17544
v_add_u32 v74, s53, v254
v_mfma_f32_16x16x32_bf16 v[84:87], a[16:19], a[140:143], v[84:87]
s_add_u32 m0, s17, 135168
s_add_u32 s50, s101, 262144
v_mfma_f32_16x16x32_bf16 v[96:99], a[20:23], a[140:143], v[96:99]
ds_read_b64_tr_b16 a[40:41], v15 offset:17088
v_xor_b32 v75, 64, v74
v_mfma_f32_16x16x32_bf16 v[92:95], a[20:23], a[136:139], v[92:95]
ds_read_b64_tr_b16 a[42:43], v15 offset:17600
ds_read_b128 a[48:51], v74 offset:0
v_mfma_f32_16x16x32_bf16 v[88:91], a[20:23], a[132:135], v[88:91]
s_waitcnt lgkmcnt(7)
ds_read_b128 a[52:55], v74 offset:2048
v_mfma_f32_16x16x32_bf16 v[100:103], a[24:27], a[132:135], v[100:103]
ds_read_b64_tr_b16 a[44:45], v15 offset:17096
ds_read_b128 a[56:59], v74 offset:4096
v_mfma_f32_16x16x32_bf16 v[104:107], a[24:27], a[136:139], v[104:107]
ds_read_b64_tr_b16 a[46:47], v15 offset:17608
ds_read_b128 a[60:63], v75 offset:0
v_mfma_f32_16x16x32_bf16 v[108:111], a[24:27], a[140:143], v[108:111]
buffer_load_dwordx4 v4, s[28:31], s50 offen offset:0 lds
v_mfma_f32_16x16x32_bf16 v[120:123], a[28:31], a[140:143], v[120:123]
ds_read_b64_tr_b16 a[16:17], v15 offset:17152
ds_read_b128 a[64:67], v75 offset:2048
v_mfma_f32_16x16x32_bf16 v[116:119], a[28:31], a[136:139], v[116:119]
ds_read_b64_tr_b16 a[18:19], v15 offset:17664
ds_read_b128 a[68:71], v75 offset:4096
v_mfma_f32_16x16x32_bf16 v[112:115], a[28:31], a[132:135], v[112:115]
s_waitcnt lgkmcnt(12)
s_waitcnt vmcnt(8)
v_mfma_f32_16x16x32_bf16 v[124:127], a[32:35], a[132:135], v[124:127]
ds_read_b64_tr_b16 a[20:21], v15 offset:17160
v_add_u32 v74, s54, v254
v_mfma_f32_16x16x32_bf16 v[128:131], a[32:35], a[136:139], v[128:131]
ds_read_b64_tr_b16 a[22:23], v15 offset:17672
v_xor_b32 v75, 64, v74
v_mfma_f32_16x16x32_bf16 v[132:135], a[32:35], a[140:143], v[132:135]
buffer_load_dwordx4 v5, s[28:31], s50 offen offset:1056 lds
v_mfma_f32_16x16x32_bf16 v[144:147], a[36:39], a[140:143], v[144:147]
ds_read_b64_tr_b16 a[24:25], v15 offset:17216
s_waitcnt lgkmcnt(3)
v_mfma_f32_16x16x32_bf16 v[140:143], a[36:39], a[136:139], v[140:143]
ds_read_b64_tr_b16 a[26:27], v15 offset:17728
ds_read_b128 a[72:75], v74 offset:0
v_mfma_f32_16x16x32_bf16 v[136:139], a[36:39], a[132:135], v[136:139]
s_waitcnt lgkmcnt(10)
ds_read_b128 a[76:79], v74 offset:2048
v_mfma_f32_16x16x32_bf16 v[148:151], a[40:43], a[132:135], v[148:151]
ds_read_b64_tr_b16 a[28:29], v15 offset:17224
buffer_load_dwordx4 v6, s[28:31], s50 offen offset:2112 lds
v_mfma_f32_16x16x32_bf16 v[152:155], a[40:43], a[136:139], v[152:155]
ds_read_b64_tr_b16 a[30:31], v15 offset:17736
ds_read_b128 a[80:83], v74 offset:4096
v_mfma_f32_16x16x32_bf16 v[156:159], a[40:43], a[140:143], v[156:159]
s_waitcnt vmcnt(20)
s_barrier
v_mfma_f32_16x16x32_bf16 v[168:171], a[44:47], a[140:143], v[168:171]
ds_read_b64_tr_b16 a[32:33], v15 offset:17280
buffer_load_dwordx4 v7, s[28:31], s50 offen offset:3168 lds
v_mfma_f32_16x16x32_bf16 v[164:167], a[44:47], a[136:139], v[164:167]
ds_read_b64_tr_b16 a[34:35], v15 offset:17792
ds_read_b128 a[84:87], v75 offset:0
v_mfma_f32_16x16x32_bf16 v[160:163], a[44:47], a[132:135], v[160:163]
s_waitcnt lgkmcnt(10)
ds_read_b128 a[88:91], v75 offset:2048
v_mfma_f32_16x16x32_bf16 v[172:175], a[16:19], a[132:135], v[172:175]
ds_read_b64_tr_b16 a[36:37], v15 offset:17288
s_add_u32 m0, s53, 0
s_add_u32 s50, s96, 0
v_mfma_f32_16x16x32_bf16 v[176:179], a[16:19], a[136:139], v[176:179]
ds_read_b64_tr_b16 a[38:39], v15 offset:17800
buffer_load_dwordx4 v14, s[36:39], s50 offen lds
v_mfma_f32_16x16x32_bf16 v[180:183], a[16:19], a[140:143], v[180:183]
buffer_load_dwordx4 v253, s[36:39], s50 offen offset:1024 lds
ds_read_b128 a[92:95], v75 offset:4096
v_mfma_f32_16x16x32_bf16 v[192:195], a[20:23], a[140:143], v[192:195]
ds_read_b64_tr_b16 a[40:41], v15 offset:17344
s_add_u32 m0, s53, 2048
s_add_u32 s50, s96, 14336
v_mfma_f32_16x16x32_bf16 v[188:191], a[20:23], a[136:139], v[188:191]
ds_read_b64_tr_b16 a[42:43], v15 offset:17856
buffer_load_dwordx4 v14, s[36:39], s50 offen lds
v_mfma_f32_16x16x32_bf16 v[184:187], a[20:23], a[132:135], v[184:187]
s_waitcnt lgkmcnt(10)
buffer_load_dwordx4 v253, s[36:39], s50 offen offset:1024 lds
v_mfma_f32_16x16x32_bf16 v[196:199], a[24:27], a[132:135], v[196:199]
ds_read_b64_tr_b16 a[44:45], v15 offset:17352
s_add_u32 m0, s53, 4096
s_add_u32 s50, s96, 28672
v_mfma_f32_16x16x32_bf16 v[200:203], a[24:27], a[136:139], v[200:203]
ds_read_b64_tr_b16 a[46:47], v15 offset:17864
buffer_load_dwordx4 v14, s[36:39], s50 offen lds
v_mfma_f32_16x16x32_bf16 v[204:207], a[24:27], a[140:143], v[204:207]
buffer_load_dwordx4 v253, s[36:39], s50 offen offset:1024 lds
s_waitcnt lgkmcnt(4)
v_mfma_f32_16x16x32_bf16 v[216:219], a[28:31], a[140:143], v[216:219]
ds_read_b64_tr_b16 a[16:17], v15 offset:33792
s_add_u32 m0, s54, 0
s_add_u32 s50, s97, 0
v_mfma_f32_16x16x32_bf16 v[212:215], a[28:31], a[136:139], v[212:215]
ds_read_b64_tr_b16 a[18:19], v15 offset:34304
buffer_load_dwordx4 v14, s[36:39], s50 offen lds
v_mfma_f32_16x16x32_bf16 v[208:211], a[28:31], a[132:135], v[208:211]
s_waitcnt lgkmcnt(7)
buffer_load_dwordx4 v253, s[36:39], s50 offen offset:1024 lds
v_mfma_f32_16x16x32_bf16 v[220:223], a[32:35], a[132:135], v[220:223]
ds_read_b64_tr_b16 a[20:21], v15 offset:33800
s_add_u32 m0, s54, 2048
s_add_u32 s50, s97, 14336
v_mfma_f32_16x16x32_bf16 v[224:227], a[32:35], a[136:139], v[224:227]
ds_read_b64_tr_b16 a[22:23], v15 offset:34312
buffer_load_dwordx4 v14, s[36:39], s50 offen lds
v_mfma_f32_16x16x32_bf16 v[228:231], a[32:35], a[140:143], v[228:231]
buffer_load_dwordx4 v253, s[36:39], s50 offen offset:1024 lds
v_mfma_f32_16x16x32_bf16 v[240:243], a[36:39], a[140:143], v[240:243]
ds_read_b64_tr_b16 a[24:25], v15 offset:33856
s_add_u32 m0, s54, 4096
s_add_u32 s50, s97, 28672
v_mfma_f32_16x16x32_bf16 v[236:239], a[36:39], a[136:139], v[236:239]
ds_read_b64_tr_b16 a[26:27], v15 offset:34368
buffer_load_dwordx4 v14, s[36:39], s50 offen lds
v_mfma_f32_16x16x32_bf16 v[232:235], a[36:39], a[132:135], v[232:235]
s_waitcnt lgkmcnt(6)
buffer_load_dwordx4 v253, s[36:39], s50 offen offset:1024 lds
v_mfma_f32_16x16x32_bf16 v[244:247], a[40:43], a[132:135], v[244:247]
ds_read_b64_tr_b16 a[28:29], v15 offset:33864
s_add_u32 m0, s17, 67584
s_add_u32 s50, s101, 0
v_mfma_f32_16x16x32_bf16 v[248:251], a[40:43], a[136:139], v[248:251]
ds_read_b64_tr_b16 a[30:31], v15 offset:34376
buffer_load_dwordx4 v4, s[28:31], s50 offen offset:0 lds
v_mfma_f32_16x16x32_bf16 a[0:3], a[40:43], a[140:143], a[0:3]
buffer_load_dwordx4 v5, s[28:31], s50 offen offset:1056 lds
v_mfma_f32_16x16x32_bf16 a[12:15], a[44:47], a[140:143], a[12:15]
ds_read_b64_tr_b16 a[32:33], v15 offset:33920
buffer_load_dwordx4 v6, s[28:31], s50 offen offset:2112 lds
v_mfma_f32_16x16x32_bf16 a[8:11], a[44:47], a[136:139], a[8:11]
ds_read_b64_tr_b16 a[34:35], v15 offset:34432
v_mfma_f32_16x16x32_bf16 a[4:7], a[44:47], a[132:135], a[4:7]
s_waitcnt lgkmcnt(6)
buffer_load_dwordx4 v7, s[28:31], s50 offen offset:3168 lds
LS_2:
v_mfma_f32_16x16x32_bf16 v[76:79], a[16:19], a[48:51], v[76:79]
ds_read_b64_tr_b16 a[36:37], v15 offset:33928
s_waitcnt vmcnt(20)
v_mfma_f32_16x16x32_bf16 v[80:83], a[16:19], a[52:55], v[80:83]
ds_read_b64_tr_b16 a[38:39], v15 offset:34440
v_add_u32 v74, s52, v254
v_mfma_f32_16x16x32_bf16 v[84:87], a[16:19], a[56:59], v[84:87]
s_add_u32 s20, s6, s55
s_addc_u32 s21, s7, 0
v_mfma_f32_16x16x32_bf16 v[96:99], a[20:23], a[56:59], v[96:99]
ds_read_b64_tr_b16 a[40:41], v15 offset:33984
v_xor_b32 v75, 64, v74
v_mfma_f32_16x16x32_bf16 v[92:95], a[20:23], a[52:55], v[92:95]
ds_read_b64_tr_b16 a[42:43], v15 offset:34496
ds_read_b128 a[96:99], v74 offset:0
v_mfma_f32_16x16x32_bf16 v[88:91], a[20:23], a[48:51], v[88:91]
s_waitcnt lgkmcnt(7)
ds_read_b128 a[100:103], v74 offset:2048
v_mfma_f32_16x16x32_bf16 v[100:103], a[24:27], a[48:51], v[100:103]
ds_read_b64_tr_b16 a[44:45], v15 offset:33992
ds_read_b128 a[104:107], v74 offset:4096
v_mfma_f32_16x16x32_bf16 v[104:107], a[24:27], a[52:55], v[104:107]
ds_read_b64_tr_b16 a[46:47], v15 offset:34504
ds_read_b128 a[108:111], v75 offset:0
v_mfma_f32_16x16x32_bf16 v[108:111], a[24:27], a[56:59], v[108:111]
s_sub_u32 s20, s20, 2048
s_subb_u32 s21, s21, 0
v_mfma_f32_16x16x32_bf16 v[120:123], a[28:31], a[56:59], v[120:123]
ds_read_b64_tr_b16 a[16:17], v15 offset:34048
ds_read_b128 a[112:115], v75 offset:2048
v_mfma_f32_16x16x32_bf16 v[116:119], a[28:31], a[52:55], v[116:119]
ds_read_b64_tr_b16 a[18:19], v15 offset:34560
ds_read_b128 a[116:119], v75 offset:4096
v_mfma_f32_16x16x32_bf16 v[112:115], a[28:31], a[48:51], v[112:115]
s_waitcnt lgkmcnt(12)
v_mfma_f32_16x16x32_bf16 v[124:127], a[32:35], a[48:51], v[124:127]
ds_read_b64_tr_b16 a[20:21], v15 offset:34056
v_mfma_f32_16x16x32_bf16 v[128:131], a[32:35], a[52:55], v[128:131]
ds_read_b64_tr_b16 a[22:23], v15 offset:34568
v_mfma_f32_16x16x32_bf16 v[132:135], a[32:35], a[56:59], v[132:135]
s_mov_b32 s22, 526336
s_mov_b32 s23, 0x20000
v_mfma_f32_16x16x32_bf16 v[144:147], a[36:39], a[56:59], v[144:147]
ds_read_b64_tr_b16 a[24:25], v15 offset:34112
s_waitcnt lgkmcnt(3)
v_mfma_f32_16x16x32_bf16 v[140:143], a[36:39], a[52:55], v[140:143]
ds_read_b64_tr_b16 a[26:27], v15 offset:34624
v_mfma_f32_16x16x32_bf16 v[136:139], a[36:39], a[48:51], v[136:139]
s_waitcnt lgkmcnt(9)
v_mfma_f32_16x16x32_bf16 v[148:151], a[40:43], a[48:51], v[148:151]
ds_read_b64_tr_b16 a[28:29], v15 offset:34120
v_mfma_f32_16x16x32_bf16 v[152:155], a[40:43], a[52:55], v[152:155]
ds_read_b64_tr_b16 a[30:31], v15 offset:34632
v_mfma_f32_16x16x32_bf16 v[156:159], a[40:43], a[56:59], v[156:159]
s_waitcnt vmcnt(33)
s_barrier
v_mfma_f32_16x16x32_bf16 v[168:171], a[44:47], a[56:59], v[168:171]
ds_read_b64_tr_b16 a[32:33], v15 offset:34176
v_mfma_f32_16x16x32_bf16 v[164:167], a[44:47], a[52:55], v[164:167]
ds_read_b64_tr_b16 a[34:35], v15 offset:34688
v_mfma_f32_16x16x32_bf16 v[160:163], a[44:47], a[48:51], v[160:163]
s_waitcnt lgkmcnt(6)
v_mfma_f32_16x16x32_bf16 v[172:175], a[16:19], a[48:51], v[172:175]
ds_read_b64_tr_b16 a[36:37], v15 offset:34184
v_mfma_f32_16x16x32_bf16 v[176:179], a[16:19], a[52:55], v[176:179]
ds_read_b64_tr_b16 a[38:39], v15 offset:34696
v_mfma_f32_16x16x32_bf16 v[180:183], a[16:19], a[56:59], v[180:183]
s_add_u32 m0, s52, 0
s_add_u32 s50, s98, 0
v_mfma_f32_16x16x32_bf16 v[192:195], a[20:23], a[56:59], v[192:195]
ds_read_b64_tr_b16 a[40:41], v15 offset:34240
buffer_load_dwordx4 v14, s[36:39], s50 offen lds
v_mfma_f32_16x16x32_bf16 v[188:191], a[20:23], a[52:55], v[188:191]
ds_read_b64_tr_b16 a[42:43], v15 offset:34752
v_mfma_f32_16x16x32_bf16 v[184:187], a[20:23], a[48:51], v[184:187]
s_waitcnt lgkmcnt(6)
buffer_load_dwordx4 v253, s[36:39], s50 offen offset:1024 lds
v_mfma_f32_16x16x32_bf16 v[196:199], a[24:27], a[48:51], v[196:199]
ds_read_b64_tr_b16 a[44:45], v15 offset:34248
v_mfma_f32_16x16x32_bf16 v[200:203], a[24:27], a[52:55], v[200:203]
ds_read_b64_tr_b16 a[46:47], v15 offset:34760
v_mfma_f32_16x16x32_bf16 v[204:207], a[24:27], a[56:59], v[204:207]
s_add_u32 m0, s52, 2048
s_add_u32 s50, s98, 14336
v_mfma_f32_16x16x32_bf16 v[216:219], a[28:31], a[56:59], v[216:219]
ds_read_b64_tr_b16 a[16:17], v15 offset:50688
buffer_load_dwordx4 v14, s[36:39], s50 offen lds
v_mfma_f32_16x16x32_bf16 v[212:215], a[28:31], a[52:55], v[212:215]
ds_read_b64_tr_b16 a[18:19], v15 offset:51200
v_mfma_f32_16x16x32_bf16 v[208:211], a[28:31], a[48:51], v[208:211]
s_waitcnt lgkmcnt(6)
buffer_load_dwordx4 v253, s[36:39], s50 offen offset:1024 lds
v_mfma_f32_16x16x32_bf16 v[220:223], a[32:35], a[48:51], v[220:223]
ds_read_b64_tr_b16 a[20:21], v15 offset:50696
s_add_u32 m0, s52, 4096
s_add_u32 s50, s98, 28672
v_mfma_f32_16x16x32_bf16 v[224:227], a[32:35], a[52:55], v[224:227]
ds_read_b64_tr_b16 a[22:23], v15 offset:51208
buffer_load_dwordx4 v14, s[36:39], s50 offen lds
v_mfma_f32_16x16x32_bf16 v[228:231], a[32:35], a[56:59], v[228:231]
s_add_u32 s24, s8, s55
s_addc_u32 s25, s9, 0
v_mfma_f32_16x16x32_bf16 v[240:243], a[36:39], a[56:59], v[240:243]
ds_read_b64_tr_b16 a[24:25], v15 offset:50752
buffer_load_dwordx4 v253, s[36:39], s50 offen offset:1024 lds
v_mfma_f32_16x16x32_bf16 v[236:239], a[36:39], a[52:55], v[236:239]
ds_read_b64_tr_b16 a[26:27], v15 offset:51264
s_add_u32 m0, s17, 84480
s_add_u32 s50, s45, 0
v_mfma_f32_16x16x32_bf16 v[232:235], a[36:39], a[48:51], v[232:235]
s_waitcnt lgkmcnt(6)
buffer_load_dwordx4 v4, s[28:31], s50 offen offset:0 lds
v_mfma_f32_16x16x32_bf16 v[244:247], a[40:43], a[48:51], v[244:247]
ds_read_b64_tr_b16 a[28:29], v15 offset:50760
v_mfma_f32_16x16x32_bf16 v[248:251], a[40:43], a[52:55], v[248:251]
ds_read_b64_tr_b16 a[30:31], v15 offset:51272
buffer_load_dwordx4 v5, s[28:31], s50 offen offset:1056 lds
v_mfma_f32_16x16x32_bf16 a[0:3], a[40:43], a[56:59], a[0:3]
s_sub_u32 s24, s24, 2048
s_subb_u32 s25, s25, 0
v_mfma_f32_16x16x32_bf16 a[12:15], a[44:47], a[56:59], a[12:15]
ds_read_b64_tr_b16 a[32:33], v15 offset:50816
buffer_load_dwordx4 v6, s[28:31], s50 offen offset:2112 lds
v_mfma_f32_16x16x32_bf16 a[8:11], a[44:47], a[52:55], a[8:11]
ds_read_b64_tr_b16 a[34:35], v15 offset:51328
v_mfma_f32_16x16x32_bf16 a[4:7], a[44:47], a[48:51], a[4:7]
s_waitcnt lgkmcnt(6)
buffer_load_dwordx4 v7, s[28:31], s50 offen offset:3168 lds
LS_3:
v_mfma_f32_16x16x32_bf16 v[76:79], a[16:19], a[60:63], v[76:79]
ds_read_b64_tr_b16 a[36:37], v15 offset:50824
s_waitcnt vmcnt(20)
v_mfma_f32_16x16x32_bf16 v[80:83], a[16:19], a[64:67], v[80:83]
ds_read_b64_tr_b16 a[38:39], v15 offset:51336
v_add_u32 v74, s53, v254
v_mfma_f32_16x16x32_bf16 v[84:87], a[16:19], a[68:71], v[84:87]
s_mov_b32 s26, 526336
s_mov_b32 s27, 0x20000
v_mfma_f32_16x16x32_bf16 v[96:99], a[20:23], a[68:71], v[96:99]
ds_read_b64_tr_b16 a[40:41], v15 offset:50880
v_xor_b32 v75, 64, v74
v_mfma_f32_16x16x32_bf16 v[92:95], a[20:23], a[64:67], v[92:95]
ds_read_b64_tr_b16 a[42:43], v15 offset:51392
ds_read_b128 v[16:19], v74 offset:0
v_mfma_f32_16x16x32_bf16 v[88:91], a[20:23], a[60:63], v[88:91]
s_waitcnt lgkmcnt(7)
ds_read_b128 v[20:23], v74 offset:2048
v_mfma_f32_16x16x32_bf16 v[100:103], a[24:27], a[60:63], v[100:103]
ds_read_b64_tr_b16 a[44:45], v15 offset:50888
ds_read_b128 v[24:27], v74 offset:4096
v_mfma_f32_16x16x32_bf16 v[104:107], a[24:27], a[64:67], v[104:107]
ds_read_b64_tr_b16 a[46:47], v15 offset:51400
ds_read_b128 v[28:31], v75 offset:0
v_mfma_f32_16x16x32_bf16 v[108:111], a[24:27], a[68:71], v[108:111]
s_lshr_b32 s55, s16, 1
s_lshl_b32 s55, s55, 12
v_mfma_f32_16x16x32_bf16 v[120:123], a[28:31], a[68:71], v[120:123]
ds_read_b64_tr_b16 a[16:17], v15 offset:50944
ds_read_b128 v[32:35], v75 offset:2048
v_mfma_f32_16x16x32_bf16 v[116:119], a[28:31], a[64:67], v[116:119]
ds_read_b64_tr_b16 a[18:19], v15 offset:51456
ds_read_b128 v[36:39], v75 offset:4096
v_mfma_f32_16x16x32_bf16 v[112:115], a[28:31], a[60:63], v[112:115]
s_waitcnt lgkmcnt(12)
s_waitcnt vmcnt(14)
v_mfma_f32_16x16x32_bf16 v[124:127], a[32:35], a[60:63], v[124:127]
ds_read_b64_tr_b16 a[20:21], v15 offset:50952
v_add_u32 v74, s54, v254
v_mfma_f32_16x16x32_bf16 v[128:131], a[32:35], a[64:67], v[128:131]
ds_read_b64_tr_b16 a[22:23], v15 offset:51464
v_xor_b32 v75, 64, v74
v_mfma_f32_16x16x32_bf16 v[132:135], a[32:35], a[68:71], v[132:135]
s_and_b32 s87, s16, 1
s_lshl_b32 s87, s87, 11
v_mfma_f32_16x16x32_bf16 v[144:147], a[36:39], a[68:71], v[144:147]
ds_read_b64_tr_b16 a[24:25], v15 offset:51008
ds_read_b128 v[40:43], v74 offset:0
v_mfma_f32_16x16x32_bf16 v[140:143], a[36:39], a[64:67], v[140:143]
ds_read_b64_tr_b16 a[26:27], v15 offset:51520
ds_read_b128 v[44:47], v74 offset:2048
v_mfma_f32_16x16x32_bf16 v[136:139], a[36:39], a[60:63], v[136:139]
s_waitcnt lgkmcnt(11)
ds_read_b128 v[48:51], v74 offset:4096
v_mfma_f32_16x16x32_bf16 v[148:151], a[40:43], a[60:63], v[148:151]
ds_read_b64_tr_b16 a[28:29], v15 offset:51016
ds_read_b128 v[52:55], v75 offset:0
v_mfma_f32_16x16x32_bf16 v[152:155], a[40:43], a[64:67], v[152:155]
ds_read_b64_tr_b16 a[30:31], v15 offset:51528
ds_read_b128 v[56:59], v75 offset:2048
v_mfma_f32_16x16x32_bf16 v[156:159], a[40:43], a[68:71], v[156:159]
s_waitcnt vmcnt(10)
s_barrier
v_mfma_f32_16x16x32_bf16 v[168:171], a[44:47], a[68:71], v[168:171]
ds_read_b64_tr_b16 a[32:33], v15 offset:51072
ds_read_b128 v[60:63], v75 offset:4096
v_mfma_f32_16x16x32_bf16 v[164:167], a[44:47], a[64:67], v[164:167]
ds_read_b64_tr_b16 a[34:35], v15 offset:51584
v_mfma_f32_16x16x32_bf16 v[160:163], a[44:47], a[60:63], v[160:163]
s_waitcnt lgkmcnt(12)
v_mfma_f32_16x16x32_bf16 v[172:175], a[16:19], a[60:63], v[172:175]
ds_read_b64_tr_b16 a[36:37], v15 offset:51080
v_mfma_f32_16x16x32_bf16 v[176:179], a[16:19], a[64:67], v[176:179]
ds_read_b64_tr_b16 a[38:39], v15 offset:51592
v_mfma_f32_16x16x32_bf16 v[180:183], a[16:19], a[68:71], v[180:183]
s_add_u32 m0, s17, 101376
s_add_u32 s50, s45, 262144
v_mfma_f32_16x16x32_bf16 v[192:195], a[20:23], a[68:71], v[192:195]
ds_read_b64_tr_b16 a[40:41], v15 offset:51136
v_mfma_f32_16x16x32_bf16 v[188:191], a[20:23], a[64:67], v[188:191]
ds_read_b64_tr_b16 a[42:43], v15 offset:51648
v_mfma_f32_16x16x32_bf16 v[184:187], a[20:23], a[60:63], v[184:187]
s_waitcnt lgkmcnt(8)
v_mfma_f32_16x16x32_bf16 v[196:199], a[24:27], a[60:63], v[196:199]
ds_read_b64_tr_b16 a[44:45], v15 offset:51144
v_mfma_f32_16x16x32_bf16 v[200:203], a[24:27], a[64:67], v[200:203]
ds_read_b64_tr_b16 a[46:47], v15 offset:51656
v_mfma_f32_16x16x32_bf16 v[204:207], a[24:27], a[68:71], v[204:207]
buffer_load_dwordx4 v4, s[28:31], s50 offen offset:0 lds
v_mfma_f32_16x16x32_bf16 v[216:219], a[28:31], a[68:71], v[216:219]
ds_read_b64_tr_b16 a[16:17], v15 offset:0
v_mfma_f32_16x16x32_bf16 v[212:215], a[28:31], a[64:67], v[212:215]
ds_read_b64_tr_b16 a[18:19], v15 offset:512
v_mfma_f32_16x16x32_bf16 v[208:211], a[28:31], a[60:63], v[208:211]
s_waitcnt lgkmcnt(6)
v_mfma_f32_16x16x32_bf16 v[220:223], a[32:35], a[60:63], v[220:223]
v_mov_b32 v72, v15
v_add_u32 v72, 16896, v72
ds_read_b64_tr_b16 a[20:21], v72 offset:50688
v_mfma_f32_16x16x32_bf16 v[224:227], a[32:35], a[64:67], v[224:227]
ds_read_b64_tr_b16 a[22:23], v72 offset:51200
v_mfma_f32_16x16x32_bf16 v[228:231], a[32:35], a[68:71], v[228:231]
buffer_load_dwordx4 v5, s[28:31], s50 offen offset:1056 lds
v_mfma_f32_16x16x32_bf16 v[240:243], a[36:39], a[68:71], v[240:243]
ds_read_b64_tr_b16 a[24:25], v15 offset:8
v_mfma_f32_16x16x32_bf16 v[236:239], a[36:39], a[64:67], v[236:239]
ds_read_b64_tr_b16 a[26:27], v15 offset:520
v_mfma_f32_16x16x32_bf16 v[232:235], a[36:39], a[60:63], v[232:235]
s_waitcnt lgkmcnt(6)
v_mfma_f32_16x16x32_bf16 v[244:247], a[40:43], a[60:63], v[244:247]
ds_read_b64_tr_b16 a[28:29], v72 offset:50696
buffer_load_dwordx4 v6, s[28:31], s50 offen offset:2112 lds
v_mfma_f32_16x16x32_bf16 v[248:251], a[40:43], a[64:67], v[248:251]
ds_read_b64_tr_b16 a[30:31], v72 offset:51208
s_add_u32 s55, s55, s87
s_add_u32 s55, s55, 2048
v_mfma_f32_16x16x32_bf16 a[0:3], a[40:43], a[68:71], a[0:3]
v_lshrrev_b32 v68, 9, v252
v_mfma_f32_16x16x32_bf16 a[12:15], a[44:47], a[68:71], a[12:15]
ds_read_b64_tr_b16 a[32:33], v15 offset:64
buffer_load_dwordx4 v7, s[28:31], s50 offen offset:3168 lds
v_mfma_f32_16x16x32_bf16 a[8:11], a[44:47], a[64:67], a[8:11]
ds_read_b64_tr_b16 a[34:35], v15 offset:576
v_and_b32 v69, 0x1f0, v252
v_mfma_f32_16x16x32_bf16 a[4:7], a[44:47], a[60:63], a[4:7]
s_waitcnt lgkmcnt(6)
v_lshl_add_u32 v68, v68, 13, v69
LS_4:
v_mfma_f32_16x16x32_bf16 v[76:79], a[16:19], a[72:75], v[76:79]
ds_read_b64_tr_b16 a[36:37], v72 offset:50752
v_add_u32 v0, s55, v68
s_waitcnt vmcnt(8)
v_mfma_f32_16x16x32_bf16 v[76:79], a[20:23], a[84:87], v[76:79]
ds_read_b64_tr_b16 a[38:39], v72 offset:51264
v_subrev_u32 v1, 544, v0
v_add_u32 v74, s52, v254
v_mfma_f32_16x16x32_bf16 v[80:83], a[20:23], a[88:91], v[80:83]
v_subrev_u32 v2, 1088, v0
v_xor_b32 v75, 64, v74
v_mfma_f32_16x16x32_bf16 v[80:83], a[16:19], a[76:79], v[80:83]
ds_read_b64_tr_b16 a[40:41], v15 offset:72
v_subrev_u32 v3, 1632, v0
ds_read_b128 a[120:123], v74 offset:0
v_mfma_f32_16x16x32_bf16 v[84:87], a[16:19], a[80:83], v[84:87]
ds_read_b64_tr_b16 a[42:43], v15 offset:584
ds_read_b128 a[124:127], v74 offset:2048
v_mfma_f32_16x16x32_bf16 v[84:87], a[20:23], a[92:95], v[84:87]
s_waitcnt lgkmcnt(8)
ds_read_b128 a[128:131], v74 offset:4096
v_mfma_f32_16x16x32_bf16 v[96:99], a[28:31], a[92:95], v[96:99]
ds_read_b64_tr_b16 a[44:45], v72 offset:50760
s_sub_u32 s32, s12, 2048
s_subb_u32 s33, s13, 0
v_mfma_f32_16x16x32_bf16 v[96:99], a[24:27], a[80:83], v[96:99]
ds_read_b64_tr_b16 a[46:47], v72 offset:51272
ds_read_b128 a[132:135], v75 offset:0
v_mfma_f32_16x16x32_bf16 v[92:95], a[24:27], a[76:79], v[92:95]
s_mov_b32 s34, 3672064
s_mov_b32 s35, 0x20000
v_mfma_f32_16x16x32_bf16 v[92:95], a[28:31], a[88:91], v[92:95]
ds_read_b64_tr_b16 a[16:17], v15 offset:128
s_mul_i32 s44, s92, 458752
s_mov_b32 s47, 0x41800000
v_mfma_f32_16x16x32_bf16 v[88:91], a[28:31], a[84:87], v[88:91]
ds_read_b64_tr_b16 a[18:19], v15 offset:640
ds_read_b128 a[136:139], v75 offset:2048
v_mfma_f32_16x16x32_bf16 v[88:91], a[24:27], a[72:75], v[88:91]
s_waitcnt lgkmcnt(11)
ds_read_b128 a[140:143], v75 offset:4096
v_mfma_f32_16x16x32_bf16 v[100:103], a[32:35], a[72:75], v[100:103]
ds_read_b64_tr_b16 a[20:21], v72 offset:50816
s_mov_b32 s48, 0x3db8aa3b
s_lshl_b32 s55, s56, 2
v_mfma_f32_16x16x32_bf16 v[100:103], a[36:39], a[84:87], v[100:103]
ds_read_b64_tr_b16 a[22:23], v72 offset:51328
v_mfma_f32_16x16x32_bf16 v[104:107], a[36:39], a[88:91], v[104:107]
s_add_u32 s55, s55, s16
s_mul_i32 s59, s55, 14336
v_mfma_f32_16x16x32_bf16 v[104:107], a[32:35], a[76:79], v[104:107]
ds_read_b64_tr_b16 a[24:25], v15 offset:136
s_add_u32 s59, s59, s44
s_add_u32 s59, s59, 2048
v_mfma_f32_16x16x32_bf16 v[108:111], a[32:35], a[80:83], v[108:111]
ds_read_b64_tr_b16 a[26:27], v15 offset:648
s_mul_i32 s86, s16, 28672
s_add_u32 s86, s86, 2048
v_mfma_f32_16x16x32_bf16 v[108:111], a[36:39], a[92:95], v[108:111]
s_waitcnt lgkmcnt(9)
v_mfma_f32_16x16x32_bf16 v[120:123], a[44:47], a[92:95], v[120:123]
ds_read_b64_tr_b16 a[28:29], v72 offset:50824
s_mul_i32 s56, s16, 43008
s_mul_i32 s55, s94, 172032
v_mfma_f32_16x16x32_bf16 v[120:123], a[40:43], a[80:83], v[120:123]
ds_read_b64_tr_b16 a[30:31], v72 offset:51336
s_add_u32 s55, s55, s56
v_mfma_f32_16x16x32_bf16 v[116:119], a[40:43], a[76:79], v[116:119]
s_barrier
s_add_u32 s40, s14, s55
s_addc_u32 s41, s15, 0
v_mfma_f32_16x16x32_bf16 v[116:119], a[44:47], a[88:91], v[116:119]
ds_read_b64_tr_b16 a[32:33], v15 offset:192
s_mov_b32 s42, 43008
s_mov_b32 s43, 0x20000
v_mfma_f32_16x16x32_bf16 v[112:115], a[44:47], a[84:87], v[112:115]
ds_read_b64_tr_b16 a[34:35], v15 offset:704
v_mfma_f32_16x16x32_bf16 v[112:115], a[40:43], a[72:75], v[112:115]
s_waitcnt lgkmcnt(6)
s_mul_i32 s55, s93, 1376256
s_add_u32 s55, s55, s56
v_mfma_f32_16x16x32_bf16 v[124:127], a[16:19], a[72:75], v[124:127]
ds_read_b64_tr_b16 a[36:37], v72 offset:50880
s_add_u32 s76, s14, s55
s_addc_u32 s77, s15, 0
v_mfma_f32_16x16x32_bf16 v[124:127], a[20:23], a[84:87], v[124:127]
ds_read_b64_tr_b16 a[38:39], v72 offset:51392
v_mfma_f32_16x16x32_bf16 v[128:131], a[20:23], a[88:91], v[128:131]
s_mov_b32 s78, 1247232
s_mov_b32 s79, 0x20000
v_mfma_f32_16x16x32_bf16 v[128:131], a[16:19], a[76:79], v[128:131]
ds_read_b64_tr_b16 a[40:41], v15 offset:200
s_mul_i32 s55, s93, 172032
s_add_u32 s55, s55, s56
v_mfma_f32_16x16x32_bf16 v[132:135], a[16:19], a[80:83], v[132:135]
ds_read_b64_tr_b16 a[42:43], v15 offset:712
s_add_u32 s68, s88, s55
s_addc_u32 s69, s89, 0
v_mfma_f32_16x16x32_bf16 v[132:135], a[20:23], a[92:95], v[132:135]
s_waitcnt lgkmcnt(6)
v_mfma_f32_16x16x32_bf16 v[144:147], a[28:31], a[92:95], v[144:147]
ds_read_b64_tr_b16 a[44:45], v72 offset:50888
s_add_u32 m0, s17, 118272
s_add_u32 s50, s46, 0
v_mfma_f32_16x16x32_bf16 v[144:147], a[24:27], a[80:83], v[144:147]
ds_read_b64_tr_b16 a[46:47], v72 offset:51400
s_mov_b32 s70, 43008
s_mov_b32 s71, 0x20000
v_mfma_f32_16x16x32_bf16 v[140:143], a[24:27], a[76:79], v[140:143]
buffer_load_dwordx4 v4, s[28:31], s50 offen offset:0 lds
v_mfma_f32_16x16x32_bf16 v[140:143], a[28:31], a[88:91], v[140:143]
ds_read_b64_tr_b16 a[16:17], v15 offset:256
s_lshl_b32 s55, s93, 3
v_mfma_f32_16x16x32_bf16 v[136:139], a[28:31], a[84:87], v[136:139]
ds_read_b64_tr_b16 a[18:19], v15 offset:768
s_add_u32 s72, s90, s55
s_addc_u32 s73, s91, 0
v_mfma_f32_16x16x32_bf16 v[136:139], a[24:27], a[72:75], v[136:139]
s_waitcnt lgkmcnt(6)
v_mfma_f32_16x16x32_bf16 v[148:151], a[32:35], a[72:75], v[148:151]
ds_read_b64_tr_b16 a[20:21], v72 offset:50944
s_mov_b32 s74, 8
s_mov_b32 s75, 0x20000
v_mfma_f32_16x16x32_bf16 v[148:151], a[36:39], a[84:87], v[148:151]
ds_read_b64_tr_b16 a[22:23], v72 offset:51456
buffer_load_dwordx4 v5, s[28:31], s50 offen offset:1056 lds
v_mfma_f32_16x16x32_bf16 v[152:155], a[36:39], a[88:91], v[152:155]
s_lshl_b32 s55, s93, 9
s_add_u32 s55, s55, 44302336
v_mfma_f32_16x16x32_bf16 v[152:155], a[32:35], a[76:79], v[152:155]
ds_read_b64_tr_b16 a[24:25], v15 offset:264
s_add_u32 s80, s14, s55
s_addc_u32 s81, s15, 0
v_mfma_f32_16x16x32_bf16 v[156:159], a[32:35], a[80:83], v[156:159]
ds_read_b64_tr_b16 a[26:27], v15 offset:776
v_mfma_f32_16x16x32_bf16 v[156:159], a[36:39], a[92:95], v[156:159]
s_waitcnt lgkmcnt(6)
s_mov_b32 s82, 512
s_mov_b32 s83, 0x20000
v_mfma_f32_16x16x32_bf16 v[168:171], a[44:47], a[92:95], v[168:171]
ds_read_b64_tr_b16 a[28:29], v72 offset:50952
buffer_load_dwordx4 v6, s[28:31], s50 offen offset:2112 lds
v_mfma_f32_16x16x32_bf16 v[168:171], a[40:43], a[80:83], v[168:171]
ds_read_b64_tr_b16 a[30:31], v72 offset:51464
v_mfma_f32_16x16x32_bf16 v[164:167], a[40:43], a[76:79], v[164:167]
s_mov_b32 s49, s92
s_and_b32 s13, s93, 7
v_mfma_f32_16x16x32_bf16 v[164:167], a[44:47], a[88:91], v[164:167]
ds_read_b64_tr_b16 a[32:33], v15 offset:320
s_cmp_eq_u32 s13, 7
s_cselect_b32 s13, 0, s13
v_mfma_f32_16x16x32_bf16 v[160:163], a[44:47], a[84:87], v[160:163]
ds_read_b64_tr_b16 a[34:35], v15 offset:832
buffer_load_dwordx4 v7, s[28:31], s50 offen offset:3168 lds
v_mfma_f32_16x16x32_bf16 v[160:163], a[40:43], a[72:75], v[160:163]
s_waitcnt lgkmcnt(6)
s_lshl_b32 s13, s13, 7
LS_5:
v_mfma_f32_16x16x32_bf16 v[172:175], a[16:19], a[72:75], v[172:175]
ds_read_b64_tr_b16 a[36:37], v72 offset:51008
v_mfma_f32_16x16x32_bf16 v[172:175], a[20:23], a[84:87], v[172:175]
ds_read_b64_tr_b16 a[38:39], v72 offset:51520
v_mfma_f32_16x16x32_bf16 v[176:179], a[20:23], a[88:91], v[176:179]
v_mfma_f32_16x16x32_bf16 v[176:179], a[16:19], a[76:79], v[176:179]
ds_read_b64_tr_b16 a[40:41], v15 offset:328
v_mfma_f32_16x16x32_bf16 v[180:183], a[16:19], a[80:83], v[180:183]
ds_read_b64_tr_b16 a[42:43], v15 offset:840
v_mfma_f32_16x16x32_bf16 v[180:183], a[20:23], a[92:95], v[180:183]
s_waitcnt lgkmcnt(6)
v_mfma_f32_16x16x32_bf16 v[192:195], a[28:31], a[92:95], v[192:195]
ds_read_b64_tr_b16 a[44:45], v72 offset:51016
s_waitcnt vmcnt(4)
s_barrier
v_mfma_f32_16x16x32_bf16 v[192:195], a[24:27], a[80:83], v[192:195]
ds_read_b64_tr_b16 a[46:47], v72 offset:51528
v_mfma_f32_16x16x32_bf16 v[188:191], a[24:27], a[76:79], v[188:191]
s_add_u32 m0, s17, 0
s_add_u32 s50, s46, 262144
v_mfma_f32_16x16x32_bf16 v[188:191], a[28:31], a[88:91], v[188:191]
ds_read_b64_tr_b16 a[16:17], v15 offset:384
v_mfma_f32_16x16x32_bf16 v[184:187], a[28:31], a[84:87], v[184:187]
ds_read_b64_tr_b16 a[18:19], v15 offset:896
v_mfma_f32_16x16x32_bf16 v[184:187], a[24:27], a[72:75], v[184:187]
s_waitcnt lgkmcnt(6)
v_mfma_f32_16x16x32_bf16 v[196:199], a[32:35], a[72:75], v[196:199]
ds_read_b64_tr_b16 a[20:21], v72 offset:51072
v_mfma_f32_16x16x32_bf16 v[196:199], a[36:39], a[84:87], v[196:199]
ds_read_b64_tr_b16 a[22:23], v72 offset:51584
v_mfma_f32_16x16x32_bf16 v[200:203], a[36:39], a[88:91], v[200:203]
buffer_load_dwordx4 v4, s[28:31], s50 offen offset:0 lds
v_mfma_f32_16x16x32_bf16 v[200:203], a[32:35], a[76:79], v[200:203]
ds_read_b64_tr_b16 a[24:25], v15 offset:392
v_mfma_f32_16x16x32_bf16 v[204:207], a[32:35], a[80:83], v[204:207]
ds_read_b64_tr_b16 a[26:27], v15 offset:904
v_mfma_f32_16x16x32_bf16 v[204:207], a[36:39], a[92:95], v[204:207]
s_waitcnt lgkmcnt(6)
v_mfma_f32_16x16x32_bf16 v[216:219], a[44:47], a[92:95], v[216:219]
ds_read_b64_tr_b16 a[28:29], v72 offset:51080
v_mfma_f32_16x16x32_bf16 v[216:219], a[40:43], a[80:83], v[216:219]
ds_read_b64_tr_b16 a[30:31], v72 offset:51592
v_mfma_f32_16x16x32_bf16 v[212:215], a[40:43], a[76:79], v[212:215]
buffer_load_dwordx4 v5, s[28:31], s50 offen offset:1056 lds
v_mfma_f32_16x16x32_bf16 v[212:215], a[44:47], a[88:91], v[212:215]
ds_read_b64_tr_b16 a[32:33], v15 offset:448
v_mfma_f32_16x16x32_bf16 v[208:211], a[44:47], a[84:87], v[208:211]
ds_read_b64_tr_b16 a[34:35], v15 offset:960
v_mfma_f32_16x16x32_bf16 v[208:211], a[40:43], a[72:75], v[208:211]
s_waitcnt lgkmcnt(6)
v_mfma_f32_16x16x32_bf16 v[220:223], a[16:19], a[72:75], v[220:223]
ds_read_b64_tr_b16 a[36:37], v72 offset:51136
v_mfma_f32_16x16x32_bf16 v[220:223], a[20:23], a[84:87], v[220:223]
ds_read_b64_tr_b16 a[38:39], v72 offset:51648
v_mfma_f32_16x16x32_bf16 v[224:227], a[20:23], a[88:91], v[224:227]
buffer_load_dwordx4 v6, s[28:31], s50 offen offset:2112 lds
v_mfma_f32_16x16x32_bf16 v[224:227], a[16:19], a[76:79], v[224:227]
ds_read_b64_tr_b16 a[40:41], v15 offset:456
v_mfma_f32_16x16x32_bf16 v[228:231], a[16:19], a[80:83], v[228:231]
ds_read_b64_tr_b16 a[42:43], v15 offset:968
v_mfma_f32_16x16x32_bf16 v[228:231], a[20:23], a[92:95], v[228:231]
s_waitcnt lgkmcnt(6)
v_mfma_f32_16x16x32_bf16 v[240:243], a[28:31], a[92:95], v[240:243]
ds_read_b64_tr_b16 a[44:45], v72 offset:51144
v_mfma_f32_16x16x32_bf16 v[240:243], a[24:27], a[80:83], v[240:243]
ds_read_b64_tr_b16 a[46:47], v72 offset:51656
v_mfma_f32_16x16x32_bf16 v[236:239], a[24:27], a[76:79], v[236:239]
buffer_load_dwordx4 v7, s[28:31], s50 offen offset:3168 lds
v_mfma_f32_16x16x32_bf16 v[236:239], a[28:31], a[88:91], v[236:239]
ds_read_b64_tr_b16 a[16:17], v15 offset:16896
v_mfma_f32_16x16x32_bf16 v[232:235], a[28:31], a[84:87], v[232:235]
ds_read_b64_tr_b16 a[18:19], v15 offset:17408
v_mfma_f32_16x16x32_bf16 v[232:235], a[24:27], a[72:75], v[232:235]
s_waitcnt lgkmcnt(6)
v_mfma_f32_16x16x32_bf16 v[244:247], a[32:35], a[72:75], v[244:247]
ds_read_b64_tr_b16 a[20:21], v72 offset:16896
v_mfma_f32_16x16x32_bf16 v[244:247], a[36:39], a[84:87], v[244:247]
ds_read_b64_tr_b16 a[22:23], v72 offset:17408
s_add_u32 m0, s17, 16896
s_mov_b32 s50, 0
v_mfma_f32_16x16x32_bf16 v[248:251], a[36:39], a[88:91], v[248:251]
buffer_load_dwordx4 v0, s[20:23], s50 offen offset:0 nt lds
v_mfma_f32_16x16x32_bf16 v[248:251], a[32:35], a[76:79], v[248:251]
ds_read_b64_tr_b16 a[24:25], v15 offset:16904
v_mfma_f32_16x16x32_bf16 a[0:3], a[32:35], a[80:83], a[0:3]
ds_read_b64_tr_b16 a[26:27], v15 offset:17416
v_mfma_f32_16x16x32_bf16 a[0:3], a[36:39], a[92:95], a[0:3]
s_waitcnt lgkmcnt(6)
buffer_load_dwordx4 v1, s[20:23], s50 offen offset:1056 nt lds
v_mfma_f32_16x16x32_bf16 a[12:15], a[44:47], a[92:95], a[12:15]
ds_read_b64_tr_b16 a[28:29], v72 offset:16904
v_mfma_f32_16x16x32_bf16 a[12:15], a[40:43], a[80:83], a[12:15]
ds_read_b64_tr_b16 a[30:31], v72 offset:17416
v_mfma_f32_16x16x32_bf16 a[8:11], a[40:43], a[76:79], a[8:11]
buffer_load_dwordx4 v2, s[20:23], s50 offen offset:2112 nt lds
v_mfma_f32_16x16x32_bf16 a[8:11], a[44:47], a[88:91], a[8:11]
ds_read_b64_tr_b16 a[32:33], v15 offset:16960
v_mfma_f32_16x16x32_bf16 a[4:7], a[44:47], a[84:87], a[4:7]
ds_read_b64_tr_b16 a[34:35], v15 offset:17472
v_mfma_f32_16x16x32_bf16 a[4:7], a[40:43], a[72:75], a[4:7]
s_waitcnt lgkmcnt(6)
buffer_load_dwordx4 v3, s[20:23], s50 offen offset:3168 nt lds
LS_6:
v_mfma_f32_16x16x32_bf16 v[76:79], a[16:19], a[96:99], v[76:79]
ds_read_b64_tr_b16 a[36:37], v72 offset:16960
v_mfma_f32_16x16x32_bf16 v[76:79], a[20:23], a[108:111], v[76:79]
ds_read_b64_tr_b16 a[38:39], v72 offset:17472
v_mfma_f32_16x16x32_bf16 v[80:83], a[20:23], a[112:115], v[80:83]
s_lshl_b32 s56, s49, 2
s_cmp_eq_u32 s16, 0
s_cselect_b32 s56, s56, 268435456
v_mfma_f32_16x16x32_bf16 v[80:83], a[16:19], a[100:103], v[80:83]
ds_read_b64_tr_b16 a[40:41], v15 offset:16968
v_lshlrev_b32 v64, 3, v252
v_mfma_f32_16x16x32_bf16 v[84:87], a[16:19], a[104:107], v[84:87]
ds_read_b64_tr_b16 a[42:43], v15 offset:17480
v_add_u32 v64, s56, v64
v_mfma_f32_16x16x32_bf16 v[84:87], a[20:23], a[116:119], v[84:87]
s_waitcnt lgkmcnt(6)
v_mov_b32 v65, 0
v_mfma_f32_16x16x32_bf16 v[96:99], a[28:31], a[116:119], v[96:99]
ds_read_b64_tr_b16 a[44:45], v72 offset:16968
v_lshlrev_b32 v66, 8, v252
v_mfma_f32_16x16x32_bf16 v[96:99], a[24:27], a[104:107], v[96:99]
ds_read_b64_tr_b16 a[46:47], v72 offset:17480
v_and_b32 v67, 268435456, v64
v_mfma_f32_16x16x32_bf16 v[92:95], a[24:27], a[100:103], v[92:95]
s_add_u32 m0, s17, 33792
s_add_u32 s50, s57, 0
v_mfma_f32_16x16x32_bf16 v[92:95], a[28:31], a[112:115], v[92:95]
ds_read_b64_tr_b16 a[16:17], v15 offset:17024
v_add_u32 v66, v66, v67
v_mfma_f32_16x16x32_bf16 v[88:91], a[28:31], a[108:111], v[88:91]
ds_read_b64_tr_b16 a[18:19], v15 offset:17536
v_mov_b32 v67, 1
v_mfma_f32_16x16x32_bf16 v[88:91], a[24:27], a[96:99], v[88:91]
s_waitcnt lgkmcnt(6)
buffer_atomic_swap v65, v64, s[80:83], 0 offen sc0 sc1
v_mfma_f32_16x16x32_bf16 v[100:103], a[32:35], a[96:99], v[100:103]
ds_read_b64_tr_b16 a[20:21], v72 offset:17024
v_mfma_f32_16x16x32_bf16 v[100:103], a[36:39], a[108:111], v[100:103]
ds_read_b64_tr_b16 a[22:23], v72 offset:17536
v_mfma_f32_16x16x32_bf16 v[104:107], a[36:39], a[112:115], v[104:107]
buffer_load_dwordx4 v4, s[28:31], s50 offen offset:0 lds
v_mfma_f32_16x16x32_bf16 v[104:107], a[32:35], a[100:103], v[104:107]
ds_read_b64_tr_b16 a[24:25], v15 offset:17032
v_mfma_f32_16x16x32_bf16 v[108:111], a[32:35], a[104:107], v[108:111]
ds_read_b64_tr_b16 a[26:27], v15 offset:17544
v_mfma_f32_16x16x32_bf16 v[108:111], a[36:39], a[116:119], v[108:111]
s_waitcnt lgkmcnt(6)
v_mfma_f32_16x16x32_bf16 v[120:123], a[44:47], a[116:119], v[120:123]
ds_read_b64_tr_b16 a[28:29], v72 offset:17032
v_mfma_f32_16x16x32_bf16 v[120:123], a[40:43], a[104:107], v[120:123]
ds_read_b64_tr_b16 a[30:31], v72 offset:17544
v_mfma_f32_16x16x32_bf16 v[116:119], a[40:43], a[100:103], v[116:119]
s_barrier
v_mfma_f32_16x16x32_bf16 v[116:119], a[44:47], a[112:115], v[116:119]
ds_read_b64_tr_b16 a[32:33], v15 offset:17088
v_mfma_f32_16x16x32_bf16 v[112:115], a[44:47], a[108:111], v[112:115]
ds_read_b64_tr_b16 a[34:35], v15 offset:17600
v_mfma_f32_16x16x32_bf16 v[112:115], a[40:43], a[96:99], v[112:115]
s_waitcnt lgkmcnt(6)
v_mfma_f32_16x16x32_bf16 v[124:127], a[16:19], a[96:99], v[124:127]
ds_read_b64_tr_b16 a[36:37], v72 offset:17088
v_mfma_f32_16x16x32_bf16 v[124:127], a[20:23], a[108:111], v[124:127]
ds_read_b64_tr_b16 a[38:39], v72 offset:17600
v_mfma_f32_16x16x32_bf16 v[128:131], a[20:23], a[112:115], v[128:131]
buffer_load_dwordx4 v5, s[28:31], s50 offen offset:1056 lds
v_mfma_f32_16x16x32_bf16 v[128:131], a[16:19], a[100:103], v[128:131]
ds_read_b64_tr_b16 a[40:41], v15 offset:17096
v_mfma_f32_16x16x32_bf16 v[132:135], a[16:19], a[104:107], v[132:135]
ds_read_b64_tr_b16 a[42:43], v15 offset:17608
v_mfma_f32_16x16x32_bf16 v[132:135], a[20:23], a[116:119], v[132:135]
s_waitcnt lgkmcnt(6)
v_mfma_f32_16x16x32_bf16 v[144:147], a[28:31], a[116:119], v[144:147]
ds_read_b64_tr_b16 a[44:45], v72 offset:17096
v_mfma_f32_16x16x32_bf16 v[144:147], a[24:27], a[104:107], v[144:147]
ds_read_b64_tr_b16 a[46:47], v72 offset:17608
v_mfma_f32_16x16x32_bf16 v[140:143], a[24:27], a[100:103], v[140:143]
buffer_load_dwordx4 v6, s[28:31], s50 offen offset:2112 lds
v_mfma_f32_16x16x32_bf16 v[140:143], a[28:31], a[112:115], v[140:143]
ds_read_b64_tr_b16 a[16:17], v15 offset:17152
v_mfma_f32_16x16x32_bf16 v[136:139], a[28:31], a[108:111], v[136:139]
ds_read_b64_tr_b16 a[18:19], v15 offset:17664
v_mfma_f32_16x16x32_bf16 v[136:139], a[24:27], a[96:99], v[136:139]
s_waitcnt lgkmcnt(6)
buffer_load_dwordx4 v7, s[28:31], s50 offen offset:3168 lds
v_mfma_f32_16x16x32_bf16 v[148:151], a[32:35], a[96:99], v[148:151]
ds_read_b64_tr_b16 a[20:21], v72 offset:17152
v_mfma_f32_16x16x32_bf16 v[148:151], a[36:39], a[108:111], v[148:151]
ds_read_b64_tr_b16 a[22:23], v72 offset:17664
s_add_u32 m0, s17, 50688
s_mov_b32 s50, 16384
v_mfma_f32_16x16x32_bf16 v[152:155], a[36:39], a[112:115], v[152:155]
buffer_load_dwordx4 v0, s[20:23], s50 offen offset:0 nt lds
v_mfma_f32_16x16x32_bf16 v[152:155], a[32:35], a[100:103], v[152:155]
ds_read_b64_tr_b16 a[24:25], v15 offset:17160
v_mfma_f32_16x16x32_bf16 v[156:159], a[32:35], a[104:107], v[156:159]
ds_read_b64_tr_b16 a[26:27], v15 offset:17672
v_mfma_f32_16x16x32_bf16 v[156:159], a[36:39], a[116:119], v[156:159]
s_waitcnt lgkmcnt(6)
buffer_load_dwordx4 v1, s[20:23], s50 offen offset:1056 nt lds
v_mfma_f32_16x16x32_bf16 v[168:171], a[44:47], a[116:119], v[168:171]
ds_read_b64_tr_b16 a[28:29], v72 offset:17160
v_mfma_f32_16x16x32_bf16 v[168:171], a[40:43], a[104:107], v[168:171]
ds_read_b64_tr_b16 a[30:31], v72 offset:17672
v_mfma_f32_16x16x32_bf16 v[164:167], a[40:43], a[100:103], v[164:167]
buffer_load_dwordx4 v2, s[20:23], s50 offen offset:2112 nt lds
v_mfma_f32_16x16x32_bf16 v[164:167], a[44:47], a[112:115], v[164:167]
ds_read_b64_tr_b16 a[32:33], v15 offset:17216
v_mfma_f32_16x16x32_bf16 v[160:163], a[44:47], a[108:111], v[160:163]
ds_read_b64_tr_b16 a[34:35], v15 offset:17728
v_mfma_f32_16x16x32_bf16 v[160:163], a[40:43], a[96:99], v[160:163]
s_waitcnt lgkmcnt(6)
buffer_load_dwordx4 v3, s[20:23], s50 offen offset:3168 nt lds
LS_7:
v_mfma_f32_16x16x32_bf16 v[172:175], a[16:19], a[96:99], v[172:175]
ds_read_b64_tr_b16 a[36:37], v72 offset:17216
v_mfma_f32_16x16x32_bf16 v[172:175], a[20:23], a[108:111], v[172:175]
ds_read_b64_tr_b16 a[38:39], v72 offset:17728
v_mfma_f32_16x16x32_bf16 v[176:179], a[20:23], a[112:115], v[176:179]
s_add_u32 m0, s17, 67584
s_add_u32 s50, s57, 262144
v_mfma_f32_16x16x32_bf16 v[176:179], a[16:19], a[100:103], v[176:179]
ds_read_b64_tr_b16 a[40:41], v15 offset:17224
v_mfma_f32_16x16x32_bf16 v[180:183], a[16:19], a[104:107], v[180:183]
ds_read_b64_tr_b16 a[42:43], v15 offset:17736
v_mfma_f32_16x16x32_bf16 v[180:183], a[20:23], a[116:119], v[180:183]
s_waitcnt lgkmcnt(6)
v_mfma_f32_16x16x32_bf16 v[192:195], a[28:31], a[116:119], v[192:195]
ds_read_b64_tr_b16 a[44:45], v72 offset:17224
v_mfma_f32_16x16x32_bf16 v[192:195], a[24:27], a[104:107], v[192:195]
ds_read_b64_tr_b16 a[46:47], v72 offset:17736
v_mfma_f32_16x16x32_bf16 v[188:191], a[24:27], a[100:103], v[188:191]
buffer_load_dwordx4 v4, s[28:31], s50 offen offset:0 lds
v_mfma_f32_16x16x32_bf16 v[188:191], a[28:31], a[112:115], v[188:191]
ds_read_b64_tr_b16 a[16:17], v15 offset:17280
v_mfma_f32_16x16x32_bf16 v[184:187], a[28:31], a[108:111], v[184:187]
ds_read_b64_tr_b16 a[18:19], v15 offset:17792
v_mfma_f32_16x16x32_bf16 v[184:187], a[24:27], a[96:99], v[184:187]
s_waitcnt lgkmcnt(6)
v_mfma_f32_16x16x32_bf16 v[196:199], a[32:35], a[96:99], v[196:199]
ds_read_b64_tr_b16 a[20:21], v72 offset:17280
v_mfma_f32_16x16x32_bf16 v[196:199], a[36:39], a[108:111], v[196:199]
ds_read_b64_tr_b16 a[22:23], v72 offset:17792
v_mfma_f32_16x16x32_bf16 v[200:203], a[36:39], a[112:115], v[200:203]
buffer_load_dwordx4 v5, s[28:31], s50 offen offset:1056 lds
v_mfma_f32_16x16x32_bf16 v[200:203], a[32:35], a[100:103], v[200:203]
ds_read_b64_tr_b16 a[24:25], v15 offset:17288
v_mfma_f32_16x16x32_bf16 v[204:207], a[32:35], a[104:107], v[204:207]
ds_read_b64_tr_b16 a[26:27], v15 offset:17800
v_mfma_f32_16x16x32_bf16 v[204:207], a[36:39], a[116:119], v[204:207]
s_waitcnt lgkmcnt(6)
v_mfma_f32_16x16x32_bf16 v[216:219], a[44:47], a[116:119], v[216:219]
ds_read_b64_tr_b16 a[28:29], v72 offset:17288
v_mfma_f32_16x16x32_bf16 v[216:219], a[40:43], a[104:107], v[216:219]
ds_read_b64_tr_b16 a[30:31], v72 offset:17800
v_mfma_f32_16x16x32_bf16 v[212:215], a[40:43], a[100:103], v[212:215]
s_waitcnt vmcnt(15)
s_barrier
v_mfma_f32_16x16x32_bf16 v[212:215], a[44:47], a[112:115], v[212:215]
ds_read_b64_tr_b16 a[32:33], v15 offset:17344
v_mfma_f32_16x16x32_bf16 v[208:211], a[44:47], a[108:111], v[208:211]
ds_read_b64_tr_b16 a[34:35], v15 offset:17856
v_mfma_f32_16x16x32_bf16 v[208:211], a[40:43], a[96:99], v[208:211]
s_waitcnt lgkmcnt(6)
v_mfma_f32_16x16x32_bf16 v[220:223], a[16:19], a[96:99], v[220:223]
ds_read_b64_tr_b16 a[36:37], v72 offset:17344
v_mfma_f32_16x16x32_bf16 v[220:223], a[20:23], a[108:111], v[220:223]
ds_read_b64_tr_b16 a[38:39], v72 offset:17856
v_mfma_f32_16x16x32_bf16 v[224:227], a[20:23], a[112:115], v[224:227]
buffer_load_dwordx4 v6, s[28:31], s50 offen offset:2112 lds
v_mfma_f32_16x16x32_bf16 v[224:227], a[16:19], a[100:103], v[224:227]
ds_read_b64_tr_b16 a[40:41], v15 offset:17352
v_mfma_f32_16x16x32_bf16 v[228:231], a[16:19], a[104:107], v[228:231]
ds_read_b64_tr_b16 a[42:43], v15 offset:17864
v_mfma_f32_16x16x32_bf16 v[228:231], a[20:23], a[116:119], v[228:231]
s_waitcnt lgkmcnt(6)
v_mfma_f32_16x16x32_bf16 v[240:243], a[28:31], a[116:119], v[240:243]
ds_read_b64_tr_b16 a[44:45], v72 offset:17352
v_mfma_f32_16x16x32_bf16 v[240:243], a[24:27], a[104:107], v[240:243]
ds_read_b64_tr_b16 a[46:47], v72 offset:17864
v_mfma_f32_16x16x32_bf16 v[236:239], a[24:27], a[100:103], v[236:239]
buffer_load_dwordx4 v7, s[28:31], s50 offen offset:3168 lds
v_mfma_f32_16x16x32_bf16 v[236:239], a[28:31], a[112:115], v[236:239]
ds_read_b64_tr_b16 a[16:17], v15 offset:50688
v_mfma_f32_16x16x32_bf16 v[232:235], a[28:31], a[108:111], v[232:235]
ds_read_b64_tr_b16 a[18:19], v15 offset:51200
v_mfma_f32_16x16x32_bf16 v[232:235], a[24:27], a[96:99], v[232:235]
s_waitcnt lgkmcnt(6)
v_mfma_f32_16x16x32_bf16 v[244:247], a[32:35], a[96:99], v[244:247]
v_subrev_u32 v72, 84480, v72
ds_read_b64_tr_b16 a[20:21], v72 offset:0
v_mfma_f32_16x16x32_bf16 v[244:247], a[36:39], a[108:111], v[244:247]
ds_read_b64_tr_b16 a[22:23], v72 offset:512
s_add_u32 m0, s17, 135168
s_mov_b32 s50, 0
v_mfma_f32_16x16x32_bf16 v[248:251], a[36:39], a[112:115], v[248:251]
buffer_load_dwordx4 v0, s[24:27], s50 offen offset:0 nt lds
v_mfma_f32_16x16x32_bf16 v[248:251], a[32:35], a[100:103], v[248:251]
ds_read_b64_tr_b16 a[24:25], v15 offset:50696
v_mfma_f32_16x16x32_bf16 a[0:3], a[32:35], a[104:107], a[0:3]
ds_read_b64_tr_b16 a[26:27], v15 offset:51208
v_mfma_f32_16x16x32_bf16 a[0:3], a[36:39], a[116:119], a[0:3]
s_waitcnt lgkmcnt(6)
buffer_load_dwordx4 v1, s[24:27], s50 offen offset:1056 nt lds
v_mfma_f32_16x16x32_bf16 a[12:15], a[44:47], a[116:119], a[12:15]
ds_read_b64_tr_b16 a[28:29], v72 offset:8
v_mfma_f32_16x16x32_bf16 a[12:15], a[40:43], a[104:107], a[12:15]
ds_read_b64_tr_b16 a[30:31], v72 offset:520
v_mfma_f32_16x16x32_bf16 a[8:11], a[40:43], a[100:103], a[8:11]
buffer_load_dwordx4 v2, s[24:27], s50 offen offset:2112 nt lds
v_mfma_f32_16x16x32_bf16 a[8:11], a[44:47], a[112:115], a[8:11]
ds_read_b64_tr_b16 a[32:33], v15 offset:50752
v_mfma_f32_16x16x32_bf16 a[4:7], a[44:47], a[108:111], a[4:7]
ds_read_b64_tr_b16 a[34:35], v15 offset:51264
v_mfma_f32_16x16x32_bf16 a[4:7], a[40:43], a[96:99], a[4:7]
s_waitcnt lgkmcnt(6)
buffer_load_dwordx4 v3, s[24:27], s50 offen offset:3168 nt lds
LS_8:
v_mfma_f32_16x16x32_bf16 v[76:79], a[16:19], v[16:19], v[76:79]
ds_read_b64_tr_b16 a[36:37], v72 offset:64
v_mfma_f32_16x16x32_bf16 v[76:79], a[20:23], v[28:31], v[76:79]
ds_read_b64_tr_b16 a[38:39], v72 offset:576
v_mfma_f32_16x16x32_bf16 v[80:83], a[20:23], v[32:35], v[80:83]
v_mfma_f32_16x16x32_bf16 v[80:83], a[16:19], v[20:23], v[80:83]
ds_read_b64_tr_b16 a[40:41], v15 offset:50760
v_mfma_f32_16x16x32_bf16 v[84:87], a[16:19], v[24:27], v[84:87]
ds_read_b64_tr_b16 a[42:43], v15 offset:51272
v_mfma_f32_16x16x32_bf16 v[84:87], a[20:23], v[36:39], v[84:87]
s_waitcnt lgkmcnt(6)
v_mfma_f32_16x16x32_bf16 v[96:99], a[28:31], v[36:39], v[96:99]
ds_read_b64_tr_b16 a[44:45], v72 offset:72
v_mfma_f32_16x16x32_bf16 v[96:99], a[24:27], v[24:27], v[96:99]
ds_read_b64_tr_b16 a[46:47], v72 offset:584
v_mfma_f32_16x16x32_bf16 v[92:95], a[24:27], v[20:23], v[92:95]
v_mfma_f32_16x16x32_bf16 v[92:95], a[28:31], v[32:35], v[92:95]
ds_read_b64_tr_b16 a[16:17], v15 offset:50816
v_mfma_f32_16x16x32_bf16 v[88:91], a[28:31], v[28:31], v[88:91]
ds_read_b64_tr_b16 a[18:19], v15 offset:51328
v_mfma_f32_16x16x32_bf16 v[88:91], a[24:27], v[16:19], v[88:91]
s_waitcnt lgkmcnt(6)
v_mfma_f32_16x16x32_bf16 v[100:103], a[32:35], v[16:19], v[100:103]
ds_read_b64_tr_b16 a[20:21], v72 offset:128
v_mfma_f32_16x16x32_bf16 v[100:103], a[36:39], v[28:31], v[100:103]
ds_read_b64_tr_b16 a[22:23], v72 offset:640
v_mfma_f32_16x16x32_bf16 v[104:107], a[36:39], v[32:35], v[104:107]
v_mfma_f32_16x16x32_bf16 v[104:107], a[32:35], v[20:23], v[104:107]
ds_read_b64_tr_b16 a[24:25], v15 offset:50824
v_mfma_f32_16x16x32_bf16 v[108:111], a[32:35], v[24:27], v[108:111]
ds_read_b64_tr_b16 a[26:27], v15 offset:51336
v_mfma_f32_16x16x32_bf16 v[108:111], a[36:39], v[36:39], v[108:111]
s_waitcnt lgkmcnt(6)
v_mfma_f32_16x16x32_bf16 v[120:123], a[44:47], v[36:39], v[120:123]
ds_read_b64_tr_b16 a[28:29], v72 offset:136
v_mfma_f32_16x16x32_bf16 v[120:123], a[40:43], v[24:27], v[120:123]
ds_read_b64_tr_b16 a[30:31], v72 offset:648
v_mfma_f32_16x16x32_bf16 v[116:119], a[40:43], v[20:23], v[116:119]
s_barrier
v_mfma_f32_16x16x32_bf16 v[116:119], a[44:47], v[32:35], v[116:119]
ds_read_b64_tr_b16 a[32:33], v15 offset:50880
v_mfma_f32_16x16x32_bf16 v[112:115], a[44:47], v[28:31], v[112:115]
ds_read_b64_tr_b16 a[34:35], v15 offset:51392
v_mfma_f32_16x16x32_bf16 v[112:115], a[40:43], v[16:19], v[112:115]
s_waitcnt lgkmcnt(6)
v_mfma_f32_16x16x32_bf16 v[124:127], a[16:19], v[16:19], v[124:127]
ds_read_b64_tr_b16 a[36:37], v72 offset:192
v_mfma_f32_16x16x32_bf16 v[124:127], a[20:23], v[28:31], v[124:127]
ds_read_b64_tr_b16 a[38:39], v72 offset:704
v_mfma_f32_16x16x32_bf16 v[128:131], a[20:23], v[32:35], v[128:131]
s_add_u32 m0, s17, 84480
s_add_u32 s50, s58, 0
v_mfma_f32_16x16x32_bf16 v[128:131], a[16:19], v[20:23], v[128:131]
ds_read_b64_tr_b16 a[40:41], v15 offset:50888
v_mfma_f32_16x16x32_bf16 v[132:135], a[16:19], v[24:27], v[132:135]
ds_read_b64_tr_b16 a[42:43], v15 offset:51400
v_mfma_f32_16x16x32_bf16 v[132:135], a[20:23], v[36:39], v[132:135]
s_waitcnt lgkmcnt(6)
v_mfma_f32_16x16x32_bf16 v[144:147], a[28:31], v[36:39], v[144:147]
ds_read_b64_tr_b16 a[44:45], v72 offset:200
v_mfma_f32_16x16x32_bf16 v[144:147], a[24:27], v[24:27], v[144:147]
ds_read_b64_tr_b16 a[46:47], v72 offset:712
v_mfma_f32_16x16x32_bf16 v[140:143], a[24:27], v[20:23], v[140:143]
buffer_load_dwordx4 v4, s[28:31], s50 offen offset:0 lds
v_mfma_f32_16x16x32_bf16 v[140:143], a[28:31], v[32:35], v[140:143]
ds_read_b64_tr_b16 a[16:17], v15 offset:50944
v_mfma_f32_16x16x32_bf16 v[136:139], a[28:31], v[28:31], v[136:139]
ds_read_b64_tr_b16 a[18:19], v15 offset:51456
v_mfma_f32_16x16x32_bf16 v[136:139], a[24:27], v[16:19], v[136:139]
s_waitcnt lgkmcnt(6)
v_mfma_f32_16x16x32_bf16 v[148:151], a[32:35], v[16:19], v[148:151]
ds_read_b64_tr_b16 a[20:21], v72 offset:256
v_mfma_f32_16x16x32_bf16 v[148:151], a[36:39], v[28:31], v[148:151]
ds_read_b64_tr_b16 a[22:23], v72 offset:768
v_mfma_f32_16x16x32_bf16 v[152:155], a[36:39], v[32:35], v[152:155]
buffer_load_dwordx4 v5, s[28:31], s50 offen offset:1056 lds
v_mfma_f32_16x16x32_bf16 v[152:155], a[32:35], v[20:23], v[152:155]
ds_read_b64_tr_b16 a[24:25], v15 offset:50952
v_mfma_f32_16x16x32_bf16 v[156:159], a[32:35], v[24:27], v[156:159]
ds_read_b64_tr_b16 a[26:27], v15 offset:51464
v_mfma_f32_16x16x32_bf16 v[156:159], a[36:39], v[36:39], v[156:159]
s_waitcnt lgkmcnt(6)
v_mfma_f32_16x16x32_bf16 v[168:171], a[44:47], v[36:39], v[168:171]
ds_read_b64_tr_b16 a[28:29], v72 offset:264
v_mfma_f32_16x16x32_bf16 v[168:171], a[40:43], v[24:27], v[168:171]
ds_read_b64_tr_b16 a[30:31], v72 offset:776
v_mfma_f32_16x16x32_bf16 v[164:167], a[40:43], v[20:23], v[164:167]
buffer_load_dwordx4 v6, s[28:31], s50 offen offset:2112 lds
v_mfma_f32_16x16x32_bf16 v[164:167], a[44:47], v[32:35], v[164:167]
ds_read_b64_tr_b16 a[32:33], v15 offset:51008
v_mfma_f32_16x16x32_bf16 v[160:163], a[44:47], v[28:31], v[160:163]
ds_read_b64_tr_b16 a[34:35], v15 offset:51520
v_mfma_f32_16x16x32_bf16 v[160:163], a[40:43], v[16:19], v[160:163]
s_waitcnt lgkmcnt(6)
buffer_load_dwordx4 v7, s[28:31], s50 offen offset:3168 lds
LS_9:
v_mfma_f32_16x16x32_bf16 v[172:175], a[16:19], v[16:19], v[172:175]
ds_read_b64_tr_b16 a[36:37], v72 offset:320
v_mfma_f32_16x16x32_bf16 v[172:175], a[20:23], v[28:31], v[172:175]
ds_read_b64_tr_b16 a[38:39], v72 offset:832
v_mfma_f32_16x16x32_bf16 v[176:179], a[20:23], v[32:35], v[176:179]
s_add_u32 m0, s17, 101376
s_add_u32 s50, s58, 262144
v_mfma_f32_16x16x32_bf16 v[176:179], a[16:19], v[20:23], v[176:179]
ds_read_b64_tr_b16 a[40:41], v15 offset:51016
v_mfma_f32_16x16x32_bf16 v[180:183], a[16:19], v[24:27], v[180:183]
ds_read_b64_tr_b16 a[42:43], v15 offset:51528
v_mfma_f32_16x16x32_bf16 v[180:183], a[20:23], v[36:39], v[180:183]
s_waitcnt lgkmcnt(6)
v_mfma_f32_16x16x32_bf16 v[192:195], a[28:31], v[36:39], v[192:195]
ds_read_b64_tr_b16 a[44:45], v72 offset:328
v_mfma_f32_16x16x32_bf16 v[192:195], a[24:27], v[24:27], v[192:195]
ds_read_b64_tr_b16 a[46:47], v72 offset:840
v_mfma_f32_16x16x32_bf16 v[188:191], a[24:27], v[20:23], v[188:191]
buffer_load_dwordx4 v4, s[28:31], s50 offen offset:0 lds
v_mfma_f32_16x16x32_bf16 v[188:191], a[28:31], v[32:35], v[188:191]
ds_read_b64_tr_b16 a[16:17], v15 offset:51072
v_mfma_f32_16x16x32_bf16 v[184:187], a[28:31], v[28:31], v[184:187]
ds_read_b64_tr_b16 a[18:19], v15 offset:51584
v_mfma_f32_16x16x32_bf16 v[184:187], a[24:27], v[16:19], v[184:187]
s_waitcnt lgkmcnt(6)
v_mfma_f32_16x16x32_bf16 v[196:199], a[32:35], v[16:19], v[196:199]
ds_read_b64_tr_b16 a[20:21], v72 offset:384
v_mfma_f32_16x16x32_bf16 v[196:199], a[36:39], v[28:31], v[196:199]
ds_read_b64_tr_b16 a[22:23], v72 offset:896
v_mfma_f32_16x16x32_bf16 v[200:203], a[36:39], v[32:35], v[200:203]
buffer_load_dwordx4 v5, s[28:31], s50 offen offset:1056 lds
v_mfma_f32_16x16x32_bf16 v[200:203], a[32:35], v[20:23], v[200:203]
ds_read_b64_tr_b16 a[24:25], v15 offset:51080
v_mfma_f32_16x16x32_bf16 v[204:207], a[32:35], v[24:27], v[204:207]
ds_read_b64_tr_b16 a[26:27], v15 offset:51592
v_mfma_f32_16x16x32_bf16 v[204:207], a[36:39], v[36:39], v[204:207]
s_waitcnt lgkmcnt(6)
v_mfma_f32_16x16x32_bf16 v[216:219], a[44:47], v[36:39], v[216:219]
ds_read_b64_tr_b16 a[28:29], v72 offset:392
v_mfma_f32_16x16x32_bf16 v[216:219], a[40:43], v[24:27], v[216:219]
ds_read_b64_tr_b16 a[30:31], v72 offset:904
v_mfma_f32_16x16x32_bf16 v[212:215], a[40:43], v[20:23], v[212:215]
s_waitcnt vmcnt(10)
s_barrier
v_mfma_f32_16x16x32_bf16 v[212:215], a[44:47], v[32:35], v[212:215]
ds_read_b64_tr_b16 a[32:33], v15 offset:51136
v_mfma_f32_16x16x32_bf16 v[208:211], a[44:47], v[28:31], v[208:211]
ds_read_b64_tr_b16 a[34:35], v15 offset:51648
v_mfma_f32_16x16x32_bf16 v[208:211], a[40:43], v[16:19], v[208:211]
s_waitcnt lgkmcnt(6)
v_mfma_f32_16x16x32_bf16 v[220:223], a[16:19], v[16:19], v[220:223]
ds_read_b64_tr_b16 a[36:37], v72 offset:448
v_mfma_f32_16x16x32_bf16 v[220:223], a[20:23], v[28:31], v[220:223]
ds_read_b64_tr_b16 a[38:39], v72 offset:960
v_mfma_f32_16x16x32_bf16 v[224:227], a[20:23], v[32:35], v[224:227]
buffer_load_dwordx4 v6, s[28:31], s50 offen offset:2112 lds
v_mfma_f32_16x16x32_bf16 v[224:227], a[16:19], v[20:23], v[224:227]
ds_read_b64_tr_b16 a[40:41], v15 offset:51144
v_mfma_f32_16x16x32_bf16 v[228:231], a[16:19], v[24:27], v[228:231]
ds_read_b64_tr_b16 a[42:43], v15 offset:51656
v_mfma_f32_16x16x32_bf16 v[228:231], a[20:23], v[36:39], v[228:231]
s_waitcnt lgkmcnt(6)
v_mfma_f32_16x16x32_bf16 v[240:243], a[28:31], v[36:39], v[240:243]
ds_read_b64_tr_b16 a[44:45], v72 offset:456
v_mfma_f32_16x16x32_bf16 v[240:243], a[24:27], v[24:27], v[240:243]
ds_read_b64_tr_b16 a[46:47], v72 offset:968
v_mfma_f32_16x16x32_bf16 v[236:239], a[24:27], v[20:23], v[236:239]
buffer_load_dwordx4 v7, s[28:31], s50 offen offset:3168 lds
v_mfma_f32_16x16x32_bf16 v[236:239], a[28:31], v[32:35], v[236:239]
v_subrev_u32 v15, 67584, v15
ds_read_b64_tr_b16 a[16:17], v15 offset:33792
v_mfma_f32_16x16x32_bf16 v[232:235], a[28:31], v[28:31], v[232:235]
ds_read_b64_tr_b16 a[18:19], v15 offset:34304
v_mfma_f32_16x16x32_bf16 v[232:235], a[24:27], v[16:19], v[232:235]
s_waitcnt lgkmcnt(6)
v_mfma_f32_16x16x32_bf16 v[244:247], a[32:35], v[16:19], v[244:247]
v_add_u32 v72, 67584, v72
ds_read_b64_tr_b16 a[20:21], v72 offset:0
v_mfma_f32_16x16x32_bf16 v[244:247], a[36:39], v[28:31], v[244:247]
ds_read_b64_tr_b16 a[22:23], v72 offset:512
v_mfma_f32_16x16x32_bf16 v[248:251], a[36:39], v[32:35], v[248:251]
v_mfma_f32_16x16x32_bf16 v[248:251], a[32:35], v[20:23], v[248:251]
ds_read_b64_tr_b16 a[24:25], v15 offset:33800
v_mfma_f32_16x16x32_bf16 a[0:3], a[32:35], v[24:27], a[0:3]
ds_read_b64_tr_b16 a[26:27], v15 offset:34312
v_mfma_f32_16x16x32_bf16 a[0:3], a[36:39], v[36:39], a[0:3]
s_waitcnt lgkmcnt(6)
v_mfma_f32_16x16x32_bf16 a[12:15], a[44:47], v[36:39], a[12:15]
ds_read_b64_tr_b16 a[28:29], v72 offset:8
v_mfma_f32_16x16x32_bf16 a[12:15], a[40:43], v[24:27], a[12:15]
ds_read_b64_tr_b16 a[30:31], v72 offset:520
v_mfma_f32_16x16x32_bf16 a[8:11], a[40:43], v[20:23], a[8:11]
v_mfma_f32_16x16x32_bf16 a[8:11], a[44:47], v[32:35], a[8:11]
ds_read_b64_tr_b16 a[32:33], v15 offset:33856
v_mfma_f32_16x16x32_bf16 a[4:7], a[44:47], v[28:31], a[4:7]
ds_read_b64_tr_b16 a[34:35], v15 offset:34368
v_mfma_f32_16x16x32_bf16 a[4:7], a[40:43], v[16:19], a[4:7]
s_waitcnt lgkmcnt(6)
LS_10:
v_mfma_f32_16x16x32_bf16 v[76:79], a[16:19], v[40:43], v[76:79]
ds_read_b64_tr_b16 a[36:37], v72 offset:64
v_mfma_f32_16x16x32_bf16 v[76:79], a[20:23], v[52:55], v[76:79]
ds_read_b64_tr_b16 a[38:39], v72 offset:576
v_mfma_f32_16x16x32_bf16 v[80:83], a[20:23], v[56:59], v[80:83]
v_mfma_f32_16x16x32_bf16 v[80:83], a[16:19], v[44:47], v[80:83]
ds_read_b64_tr_b16 a[40:41], v15 offset:33864
v_mfma_f32_16x16x32_bf16 v[84:87], a[16:19], v[48:51], v[84:87]
ds_read_b64_tr_b16 a[42:43], v15 offset:34376
v_mfma_f32_16x16x32_bf16 v[84:87], a[20:23], v[60:63], v[84:87]
s_waitcnt lgkmcnt(6)
v_mfma_f32_16x16x32_bf16 v[96:99], a[28:31], v[60:63], v[96:99]
ds_read_b64_tr_b16 a[44:45], v72 offset:72
v_mfma_f32_16x16x32_bf16 v[96:99], a[24:27], v[48:51], v[96:99]
ds_read_b64_tr_b16 a[46:47], v72 offset:584
v_mfma_f32_16x16x32_bf16 v[92:95], a[24:27], v[44:47], v[92:95]
v_mfma_f32_16x16x32_bf16 v[92:95], a[28:31], v[56:59], v[92:95]
ds_read_b64_tr_b16 a[16:17], v15 offset:33920
v_mfma_f32_16x16x32_bf16 v[88:91], a[28:31], v[52:55], v[88:91]
ds_read_b64_tr_b16 a[18:19], v15 offset:34432
v_mfma_f32_16x16x32_bf16 v[88:91], a[24:27], v[40:43], v[88:91]
s_waitcnt lgkmcnt(6)
v_mfma_f32_16x16x32_bf16 v[100:103], a[32:35], v[40:43], v[100:103]
ds_read_b64_tr_b16 a[20:21], v72 offset:128
v_mfma_f32_16x16x32_bf16 v[100:103], a[36:39], v[52:55], v[100:103]
ds_read_b64_tr_b16 a[22:23], v72 offset:640
v_mfma_f32_16x16x32_bf16 v[104:107], a[36:39], v[56:59], v[104:107]
v_mfma_f32_16x16x32_bf16 v[104:107], a[32:35], v[44:47], v[104:107]
ds_read_b64_tr_b16 a[24:25], v15 offset:33928
v_mfma_f32_16x16x32_bf16 v[108:111], a[32:35], v[48:51], v[108:111]
ds_read_b64_tr_b16 a[26:27], v15 offset:34440
v_mfma_f32_16x16x32_bf16 v[108:111], a[36:39], v[60:63], v[108:111]
s_waitcnt lgkmcnt(6)
v_mfma_f32_16x16x32_bf16 v[120:123], a[44:47], v[60:63], v[120:123]
ds_read_b64_tr_b16 a[28:29], v72 offset:136
v_mfma_f32_16x16x32_bf16 v[120:123], a[40:43], v[48:51], v[120:123]
ds_read_b64_tr_b16 a[30:31], v72 offset:648
v_mfma_f32_16x16x32_bf16 v[116:119], a[40:43], v[44:47], v[116:119]
s_barrier
v_mfma_f32_16x16x32_bf16 v[116:119], a[44:47], v[56:59], v[116:119]
ds_read_b64_tr_b16 a[32:33], v15 offset:33984
v_mfma_f32_16x16x32_bf16 v[112:115], a[44:47], v[52:55], v[112:115]
ds_read_b64_tr_b16 a[34:35], v15 offset:34496
v_mfma_f32_16x16x32_bf16 v[112:115], a[40:43], v[40:43], v[112:115]
s_waitcnt lgkmcnt(6)
v_mfma_f32_16x16x32_bf16 v[124:127], a[16:19], v[40:43], v[124:127]
ds_read_b64_tr_b16 a[36:37], v72 offset:192
v_mfma_f32_16x16x32_bf16 v[124:127], a[20:23], v[52:55], v[124:127]
ds_read_b64_tr_b16 a[38:39], v72 offset:704
v_mfma_f32_16x16x32_bf16 v[128:131], a[20:23], v[56:59], v[128:131]
s_add_u32 m0, s17, 0
s_mov_b32 s50, 32768
v_mfma_f32_16x16x32_bf16 v[128:131], a[16:19], v[44:47], v[128:131]
ds_read_b64_tr_b16 a[40:41], v15 offset:33992
v_mfma_f32_16x16x32_bf16 v[132:135], a[16:19], v[48:51], v[132:135]
ds_read_b64_tr_b16 a[42:43], v15 offset:34504
v_mfma_f32_16x16x32_bf16 v[132:135], a[20:23], v[60:63], v[132:135]
s_waitcnt lgkmcnt(6)
v_mfma_f32_16x16x32_bf16 v[144:147], a[28:31], v[60:63], v[144:147]
ds_read_b64_tr_b16 a[44:45], v72 offset:200
v_mfma_f32_16x16x32_bf16 v[144:147], a[24:27], v[48:51], v[144:147]
ds_read_b64_tr_b16 a[46:47], v72 offset:712
v_mfma_f32_16x16x32_bf16 v[140:143], a[24:27], v[44:47], v[140:143]
buffer_load_dwordx4 v0, s[20:23], s50 offen offset:0 nt lds
v_mfma_f32_16x16x32_bf16 v[140:143], a[28:31], v[56:59], v[140:143]
ds_read_b64_tr_b16 a[16:17], v15 offset:34048
v_mfma_f32_16x16x32_bf16 v[136:139], a[28:31], v[52:55], v[136:139]
ds_read_b64_tr_b16 a[18:19], v15 offset:34560
v_mfma_f32_16x16x32_bf16 v[136:139], a[24:27], v[40:43], v[136:139]
s_waitcnt lgkmcnt(6)
v_mfma_f32_16x16x32_bf16 v[148:151], a[32:35], v[40:43], v[148:151]
ds_read_b64_tr_b16 a[20:21], v72 offset:256
v_mfma_f32_16x16x32_bf16 v[148:151], a[36:39], v[52:55], v[148:151]
ds_read_b64_tr_b16 a[22:23], v72 offset:768
v_mfma_f32_16x16x32_bf16 v[152:155], a[36:39], v[56:59], v[152:155]
buffer_load_dwordx4 v1, s[20:23], s50 offen offset:1056 nt lds
v_mfma_f32_16x16x32_bf16 v[152:155], a[32:35], v[44:47], v[152:155]
ds_read_b64_tr_b16 a[24:25], v15 offset:34056
v_mfma_f32_16x16x32_bf16 v[156:159], a[32:35], v[48:51], v[156:159]
ds_read_b64_tr_b16 a[26:27], v15 offset:34568
v_mfma_f32_16x16x32_bf16 v[156:159], a[36:39], v[60:63], v[156:159]
s_waitcnt lgkmcnt(6)
v_mfma_f32_16x16x32_bf16 v[168:171], a[44:47], v[60:63], v[168:171]
ds_read_b64_tr_b16 a[28:29], v72 offset:264
v_mfma_f32_16x16x32_bf16 v[168:171], a[40:43], v[48:51], v[168:171]
ds_read_b64_tr_b16 a[30:31], v72 offset:776
v_mfma_f32_16x16x32_bf16 v[164:167], a[40:43], v[44:47], v[164:167]
buffer_load_dwordx4 v2, s[20:23], s50 offen offset:2112 nt lds
v_mfma_f32_16x16x32_bf16 v[164:167], a[44:47], v[56:59], v[164:167]
ds_read_b64_tr_b16 a[32:33], v15 offset:34112
v_mfma_f32_16x16x32_bf16 v[160:163], a[44:47], v[52:55], v[160:163]
ds_read_b64_tr_b16 a[34:35], v15 offset:34624
v_mfma_f32_16x16x32_bf16 v[160:163], a[40:43], v[40:43], v[160:163]
s_waitcnt lgkmcnt(6)
buffer_load_dwordx4 v3, s[20:23], s50 offen offset:3168 nt lds
LS_11:
v_mfma_f32_16x16x32_bf16 v[172:175], a[16:19], v[40:43], v[172:175]
ds_read_b64_tr_b16 a[36:37], v72 offset:320
v_mfma_f32_16x16x32_bf16 v[172:175], a[20:23], v[52:55], v[172:175]
ds_read_b64_tr_b16 a[38:39], v72 offset:832
v_mfma_f32_16x16x32_bf16 v[176:179], a[20:23], v[56:59], v[176:179]
s_waitcnt vmcnt(28)
buffer_atomic_add v67, v66, s[72:75], 0 offen sc1
v_mfma_f32_16x16x32_bf16 v[176:179], a[16:19], v[44:47], v[176:179]
ds_read_b64_tr_b16 a[40:41], v15 offset:34120
v_mfma_f32_16x16x32_bf16 v[180:183], a[16:19], v[48:51], v[180:183]
ds_read_b64_tr_b16 a[42:43], v15 offset:34632
v_mfma_f32_16x16x32_bf16 v[180:183], a[20:23], v[60:63], v[180:183]
s_waitcnt lgkmcnt(6)
v_mfma_f32_16x16x32_bf16 v[192:195], a[28:31], v[60:63], v[192:195]
ds_read_b64_tr_b16 a[44:45], v72 offset:328
v_mfma_f32_16x16x32_bf16 v[192:195], a[24:27], v[48:51], v[192:195]
ds_read_b64_tr_b16 a[46:47], v72 offset:840
v_mfma_f32_16x16x32_bf16 v[188:191], a[24:27], v[44:47], v[188:191]
s_add_u32 m0, s17, 118272
s_mov_b32 s50, 16384
v_mfma_f32_16x16x32_bf16 v[188:191], a[28:31], v[56:59], v[188:191]
ds_read_b64_tr_b16 a[16:17], v15 offset:34176
v_mfma_f32_16x16x32_bf16 v[184:187], a[28:31], v[52:55], v[184:187]
ds_read_b64_tr_b16 a[18:19], v15 offset:34688
v_mfma_f32_16x16x32_bf16 v[184:187], a[24:27], v[40:43], v[184:187]
s_waitcnt lgkmcnt(6)
v_mfma_f32_16x16x32_bf16 v[196:199], a[32:35], v[40:43], v[196:199]
ds_read_b64_tr_b16 a[20:21], v72 offset:384
v_mfma_f32_16x16x32_bf16 v[196:199], a[36:39], v[52:55], v[196:199]
ds_read_b64_tr_b16 a[22:23], v72 offset:896
v_mfma_f32_16x16x32_bf16 v[200:203], a[36:39], v[56:59], v[200:203]
buffer_load_dwordx4 v0, s[24:27], s50 offen offset:0 nt lds
v_mfma_f32_16x16x32_bf16 v[200:203], a[32:35], v[44:47], v[200:203]
ds_read_b64_tr_b16 a[24:25], v15 offset:34184
v_mfma_f32_16x16x32_bf16 v[204:207], a[32:35], v[48:51], v[204:207]
ds_read_b64_tr_b16 a[26:27], v15 offset:34696
v_mfma_f32_16x16x32_bf16 v[204:207], a[36:39], v[60:63], v[204:207]
s_waitcnt lgkmcnt(6)
v_mfma_f32_16x16x32_bf16 v[216:219], a[44:47], v[60:63], v[216:219]
ds_read_b64_tr_b16 a[28:29], v72 offset:392
v_mfma_f32_16x16x32_bf16 v[216:219], a[40:43], v[48:51], v[216:219]
ds_read_b64_tr_b16 a[30:31], v72 offset:904
v_mfma_f32_16x16x32_bf16 v[212:215], a[40:43], v[44:47], v[212:215]
s_waitcnt vmcnt(6)
s_barrier
v_mfma_f32_16x16x32_bf16 v[212:215], a[44:47], v[56:59], v[212:215]
ds_read_b64_tr_b16 a[32:33], v15 offset:34240
v_mfma_f32_16x16x32_bf16 v[208:211], a[44:47], v[52:55], v[208:211]
ds_read_b64_tr_b16 a[34:35], v15 offset:34752
v_mfma_f32_16x16x32_bf16 v[208:211], a[40:43], v[40:43], v[208:211]
s_waitcnt lgkmcnt(6)
v_mfma_f32_16x16x32_bf16 v[220:223], a[16:19], v[40:43], v[220:223]
ds_read_b64_tr_b16 a[36:37], v72 offset:448
v_mfma_f32_16x16x32_bf16 v[220:223], a[20:23], v[52:55], v[220:223]
ds_read_b64_tr_b16 a[38:39], v72 offset:960
v_mfma_f32_16x16x32_bf16 v[224:227], a[20:23], v[56:59], v[224:227]
buffer_load_dwordx4 v1, s[24:27], s50 offen offset:1056 nt lds
v_mfma_f32_16x16x32_bf16 v[224:227], a[16:19], v[44:47], v[224:227]
ds_read_b64_tr_b16 a[40:41], v15 offset:34248
v_mfma_f32_16x16x32_bf16 v[228:231], a[16:19], v[48:51], v[228:231]
ds_read_b64_tr_b16 a[42:43], v15 offset:34760
v_mfma_f32_16x16x32_bf16 v[228:231], a[20:23], v[60:63], v[228:231]
s_waitcnt lgkmcnt(6)
v_mfma_f32_16x16x32_bf16 v[240:243], a[28:31], v[60:63], v[240:243]
ds_read_b64_tr_b16 a[44:45], v72 offset:456
v_mfma_f32_16x16x32_bf16 v[240:243], a[24:27], v[48:51], v[240:243]
ds_read_b64_tr_b16 a[46:47], v72 offset:968
v_mfma_f32_16x16x32_bf16 v[236:239], a[24:27], v[44:47], v[236:239]
buffer_load_dwordx4 v2, s[24:27], s50 offen offset:2112 nt lds
v_mfma_f32_16x16x32_bf16 v[236:239], a[28:31], v[56:59], v[236:239]
v_add_u32 v15, 84480, v15
ds_read_b64_tr_b16 a[16:17], v15 offset:0
v_mfma_f32_16x16x32_bf16 v[232:235], a[28:31], v[52:55], v[232:235]
ds_read_b64_tr_b16 a[18:19], v15 offset:512
v_mfma_f32_16x16x32_bf16 v[232:235], a[24:27], v[40:43], v[232:235]
s_waitcnt lgkmcnt(6)
v_mfma_f32_16x16x32_bf16 v[244:247], a[32:35], v[40:43], v[244:247]
ds_read_b64_tr_b16 a[20:21], v72 offset:33792
v_mfma_f32_16x16x32_bf16 v[244:247], a[36:39], v[52:55], v[244:247]
ds_read_b64_tr_b16 a[22:23], v72 offset:34304
v_mfma_f32_16x16x32_bf16 v[248:251], a[36:39], v[56:59], v[248:251]
buffer_load_dwordx4 v3, s[24:27], s50 offen offset:3168 nt lds
v_mfma_f32_16x16x32_bf16 v[248:251], a[32:35], v[44:47], v[248:251]
ds_read_b64_tr_b16 a[24:25], v15 offset:8
v_mfma_f32_16x16x32_bf16 a[0:3], a[32:35], v[48:51], a[0:3]
ds_read_b64_tr_b16 a[26:27], v15 offset:520
v_mfma_f32_16x16x32_bf16 a[0:3], a[36:39], v[60:63], a[0:3]
s_waitcnt lgkmcnt(6)
v_mfma_f32_16x16x32_bf16 a[12:15], a[44:47], v[60:63], a[12:15]
ds_read_b64_tr_b16 a[28:29], v72 offset:33800
v_mfma_f32_16x16x32_bf16 a[12:15], a[40:43], v[48:51], a[12:15]
ds_read_b64_tr_b16 a[30:31], v72 offset:34312
v_mfma_f32_16x16x32_bf16 a[8:11], a[40:43], v[44:47], a[8:11]
v_mfma_f32_16x16x32_bf16 a[8:11], a[44:47], v[56:59], a[8:11]
ds_read_b64_tr_b16 a[32:33], v15 offset:64
v_mfma_f32_16x16x32_bf16 a[4:7], a[44:47], v[52:55], a[4:7]
ds_read_b64_tr_b16 a[34:35], v15 offset:576
v_mfma_f32_16x16x32_bf16 a[4:7], a[40:43], v[40:43], a[4:7]
s_waitcnt lgkmcnt(6)
LS_12:
v_mfma_f32_16x16x32_bf16 v[76:79], a[16:19], a[120:123], v[76:79]
ds_read_b64_tr_b16 a[36:37], v72 offset:33856
v_mfma_f32_16x16x32_bf16 v[76:79], a[20:23], a[132:135], v[76:79]
ds_read_b64_tr_b16 a[38:39], v72 offset:34368
v_mfma_f32_16x16x32_bf16 v[80:83], a[20:23], a[136:139], v[80:83]
v_mfma_f32_16x16x32_bf16 v[80:83], a[16:19], a[124:127], v[80:83]
ds_read_b64_tr_b16 a[40:41], v15 offset:72
v_mfma_f32_16x16x32_bf16 v[84:87], a[16:19], a[128:131], v[84:87]
ds_read_b64_tr_b16 a[42:43], v15 offset:584
s_nop 1
v_mul_f32 v76, s48, v76
v_mfma_f32_16x16x32_bf16 v[84:87], a[20:23], a[140:143], v[84:87]
s_waitcnt lgkmcnt(6)
v_mul_f32 v77, s48, v77
v_mfma_f32_16x16x32_bf16 v[96:99], a[28:31], a[140:143], v[96:99]
ds_read_b64_tr_b16 a[44:45], v72 offset:33864
v_mul_f32 v78, s48, v78
v_mfma_f32_16x16x32_bf16 v[96:99], a[24:27], a[128:131], v[96:99]
ds_read_b64_tr_b16 a[46:47], v72 offset:34376
v_mul_f32 v79, s48, v79
v_mfma_f32_16x16x32_bf16 v[92:95], a[24:27], a[124:127], v[92:95]
v_cvt_pk_bf16_f32 v16, v76, v77
v_cvt_pk_bf16_f32 v17, v78, v79
v_mfma_f32_16x16x32_bf16 v[92:95], a[28:31], a[136:139], v[92:95]
ds_read_b64_tr_b16 a[16:17], v15 offset:128
v_mul_f32 v80, s48, v80
v_mfma_f32_16x16x32_bf16 v[88:91], a[28:31], a[132:135], v[88:91]
ds_read_b64_tr_b16 a[18:19], v15 offset:640
v_mul_f32 v81, s48, v81
v_mfma_f32_16x16x32_bf16 v[88:91], a[24:27], a[120:123], v[88:91]
s_waitcnt lgkmcnt(6)
v_mul_f32 v82, s48, v82
v_mfma_f32_16x16x32_bf16 v[100:103], a[32:35], a[120:123], v[100:103]
ds_read_b64_tr_b16 a[20:21], v72 offset:33920
v_mul_f32 v83, s48, v83
v_mfma_f32_16x16x32_bf16 v[100:103], a[36:39], a[132:135], v[100:103]
ds_read_b64_tr_b16 a[22:23], v72 offset:34432
v_mul_f32 v92, s48, v92
v_mfma_f32_16x16x32_bf16 v[104:107], a[36:39], a[136:139], v[104:107]
v_mul_f32 v88, s48, v88
v_mul_f32 v89, s48, v89
v_mfma_f32_16x16x32_bf16 v[104:107], a[32:35], a[124:127], v[104:107]
ds_read_b64_tr_b16 a[24:25], v15 offset:136
v_mul_f32 v90, s48, v90
v_mfma_f32_16x16x32_bf16 v[108:111], a[32:35], a[128:131], v[108:111]
ds_read_b64_tr_b16 a[26:27], v15 offset:648
v_mul_f32 v91, s48, v91
v_mfma_f32_16x16x32_bf16 v[108:111], a[36:39], a[140:143], v[108:111]
s_waitcnt lgkmcnt(6)
v_mul_f32 v93, s48, v93
v_mfma_f32_16x16x32_bf16 v[120:123], a[44:47], a[140:143], v[120:123]
ds_read_b64_tr_b16 a[28:29], v72 offset:33928
v_mul_f32 v94, s48, v94
v_mfma_f32_16x16x32_bf16 v[120:123], a[40:43], a[128:131], v[120:123]
ds_read_b64_tr_b16 a[30:31], v72 offset:34440
v_mul_f32 v95, s48, v95
v_mfma_f32_16x16x32_bf16 v[116:119], a[40:43], a[124:127], v[116:119]
s_barrier
v_cvt_pk_bf16_f32 v18, v88, v89
v_mfma_f32_16x16x32_bf16 v[116:119], a[44:47], a[136:139], v[116:119]
ds_read_b64_tr_b16 a[32:33], v15 offset:192
v_cvt_pk_bf16_f32 v19, v90, v91
v_mfma_f32_16x16x32_bf16 v[112:115], a[44:47], a[132:135], v[112:115]
ds_read_b64_tr_b16 a[34:35], v15 offset:704
v_accvgpr_write_b32 a48, v16
v_mfma_f32_16x16x32_bf16 v[112:115], a[40:43], a[120:123], v[112:115]
s_waitcnt lgkmcnt(6)
v_accvgpr_write_b32 a49, v17
v_mfma_f32_16x16x32_bf16 v[124:127], a[16:19], a[120:123], v[124:127]
ds_read_b64_tr_b16 a[36:37], v72 offset:33984
v_cvt_pk_bf16_f32 v20, v80, v81
v_mfma_f32_16x16x32_bf16 v[124:127], a[20:23], a[132:135], v[124:127]
ds_read_b64_tr_b16 a[38:39], v72 offset:34496
v_cvt_pk_bf16_f32 v21, v82, v83
v_mfma_f32_16x16x32_bf16 v[128:131], a[20:23], a[136:139], v[128:131]
s_add_u32 m0, s17, 33792
s_mov_b32 s50, 49152
v_mfma_f32_16x16x32_bf16 v[128:131], a[16:19], a[124:127], v[128:131]
ds_read_b64_tr_b16 a[40:41], v15 offset:200
v_mul_f32 v84, s48, v84
v_mfma_f32_16x16x32_bf16 v[132:135], a[16:19], a[128:131], v[132:135]
ds_read_b64_tr_b16 a[42:43], v15 offset:712
v_mul_f32 v85, s48, v85
v_mfma_f32_16x16x32_bf16 v[132:135], a[20:23], a[140:143], v[132:135]
s_waitcnt lgkmcnt(6)
v_mul_f32 v86, s48, v86
v_mfma_f32_16x16x32_bf16 v[144:147], a[28:31], a[140:143], v[144:147]
ds_read_b64_tr_b16 a[44:45], v72 offset:33992
v_mul_f32 v87, s48, v87
v_mfma_f32_16x16x32_bf16 v[144:147], a[24:27], a[128:131], v[144:147]
ds_read_b64_tr_b16 a[46:47], v72 offset:34504
v_mul_f32 v96, s48, v96
v_mfma_f32_16x16x32_bf16 v[140:143], a[24:27], a[124:127], v[140:143]
buffer_load_dwordx4 v0, s[20:23], s50 offen offset:0 nt lds
v_mfma_f32_16x16x32_bf16 v[140:143], a[28:31], a[136:139], v[140:143]
ds_read_b64_tr_b16 a[16:17], v15 offset:256
v_mul_f32 v97, s48, v97
v_mfma_f32_16x16x32_bf16 v[136:139], a[28:31], a[132:135], v[136:139]
ds_read_b64_tr_b16 a[18:19], v15 offset:768
v_mul_f32 v98, s48, v98
v_mfma_f32_16x16x32_bf16 v[136:139], a[24:27], a[120:123], v[136:139]
s_waitcnt lgkmcnt(6)
v_mul_f32 v99, s48, v99
v_mfma_f32_16x16x32_bf16 v[148:151], a[32:35], a[120:123], v[148:151]
ds_read_b64_tr_b16 a[20:21], v72 offset:34048
v_cvt_pk_bf16_f32 v22, v92, v93
v_mfma_f32_16x16x32_bf16 v[148:151], a[36:39], a[132:135], v[148:151]
ds_read_b64_tr_b16 a[22:23], v72 offset:34560
v_cvt_pk_bf16_f32 v23, v94, v95
v_mfma_f32_16x16x32_bf16 v[152:155], a[36:39], a[136:139], v[152:155]
buffer_load_dwordx4 v1, s[20:23], s50 offen offset:1056 nt lds
v_mfma_f32_16x16x32_bf16 v[152:155], a[32:35], a[124:127], v[152:155]
ds_read_b64_tr_b16 a[24:25], v15 offset:264
v_accvgpr_write_b32 a50, v18
v_mfma_f32_16x16x32_bf16 v[156:159], a[32:35], a[128:131], v[156:159]
ds_read_b64_tr_b16 a[26:27], v15 offset:776
v_accvgpr_write_b32 a51, v19
v_mfma_f32_16x16x32_bf16 v[156:159], a[36:39], a[140:143], v[156:159]
s_waitcnt lgkmcnt(6)
v_accvgpr_write_b32 a52, v20
v_mfma_f32_16x16x32_bf16 v[168:171], a[44:47], a[140:143], v[168:171]
ds_read_b64_tr_b16 a[28:29], v72 offset:34056
buffer_load_dwordx4 v2, s[20:23], s50 offen offset:2112 nt lds
v_mfma_f32_16x16x32_bf16 v[168:171], a[40:43], a[128:131], v[168:171]
ds_read_b64_tr_b16 a[30:31], v72 offset:34568
v_accvgpr_write_b32 a53, v21
v_cvt_pk_bf16_f32 v24, v84, v85
v_mfma_f32_16x16x32_bf16 v[164:167], a[40:43], a[124:127], v[164:167]
v_cvt_pk_bf16_f32 v25, v86, v87
v_cvt_pk_bf16_f32 v26, v96, v97
v_cvt_pk_bf16_f32 v27, v98, v99
v_mfma_f32_16x16x32_bf16 v[164:167], a[44:47], a[136:139], v[164:167]
ds_read_b64_tr_b16 a[32:33], v15 offset:320
buffer_load_dwordx4 v3, s[20:23], s50 offen offset:3168 nt lds
v_mfma_f32_16x16x32_bf16 v[160:163], a[44:47], a[132:135], v[160:163]
ds_read_b64_tr_b16 a[34:35], v15 offset:832
v_accvgpr_write_b32 a54, v22
v_accvgpr_write_b32 a55, v23
v_mfma_f32_16x16x32_bf16 v[160:163], a[40:43], a[120:123], v[160:163]
s_waitcnt lgkmcnt(6)
v_accvgpr_write_b32 a56, v24
v_accvgpr_write_b32 a57, v25
LS_13:
v_mfma_f32_16x16x32_bf16 v[172:175], a[16:19], a[120:123], v[172:175]
ds_read_b64_tr_b16 a[36:37], v72 offset:34112
s_add_u32 m0, s17, 67584
s_mov_b32 s50, 32768
v_mfma_f32_16x16x32_bf16 v[172:175], a[20:23], a[132:135], v[172:175]
ds_read_b64_tr_b16 a[38:39], v72 offset:34624
buffer_load_dwordx4 v0, s[24:27], s50 offen offset:0 nt lds
v_mfma_f32_16x16x32_bf16 v[176:179], a[20:23], a[136:139], v[176:179]
v_accvgpr_write_b32 a58, v26
v_accvgpr_write_b32 a59, v27
v_mul_f32 v100, s48, v100
v_mfma_f32_16x16x32_bf16 v[176:179], a[16:19], a[124:127], v[176:179]
ds_read_b64_tr_b16 a[40:41], v15 offset:328
v_mul_f32 v101, s48, v101
v_mul_f32 v102, s48, v102
v_mfma_f32_16x16x32_bf16 v[180:183], a[16:19], a[128:131], v[180:183]
ds_read_b64_tr_b16 a[42:43], v15 offset:840
buffer_load_dwordx4 v1, s[24:27], s50 offen offset:1056 nt lds
v_mfma_f32_16x16x32_bf16 v[180:183], a[20:23], a[140:143], v[180:183]
s_waitcnt lgkmcnt(6)
v_mul_f32 v103, s48, v103
v_mul_f32 v112, s48, v112
v_mfma_f32_16x16x32_bf16 v[192:195], a[28:31], a[140:143], v[192:195]
ds_read_b64_tr_b16 a[44:45], v72 offset:34120
v_mul_f32 v113, s48, v113
v_mul_f32 v114, s48, v114
v_mul_f32 v115, s48, v115
v_mfma_f32_16x16x32_bf16 v[192:195], a[24:27], a[128:131], v[192:195]
ds_read_b64_tr_b16 a[46:47], v72 offset:34632
buffer_load_dwordx4 v2, s[24:27], s50 offen offset:2112 nt lds
v_cvt_pk_bf16_f32 v32, v100, v101
v_mfma_f32_16x16x32_bf16 v[188:191], a[24:27], a[124:127], v[188:191]
v_cvt_pk_bf16_f32 v33, v102, v103
v_mul_f32 v104, s48, v104
v_mul_f32 v105, s48, v105
v_mul_f32 v106, s48, v106
v_mfma_f32_16x16x32_bf16 v[188:191], a[28:31], a[136:139], v[188:191]
ds_read_b64_tr_b16 a[16:17], v15 offset:384
v_mul_f32 v107, s48, v107
v_mul_f32 v116, s48, v116
v_mul_f32 v117, s48, v117
v_mfma_f32_16x16x32_bf16 v[184:187], a[28:31], a[132:135], v[184:187]
ds_read_b64_tr_b16 a[18:19], v15 offset:896
buffer_load_dwordx4 v3, s[24:27], s50 offen offset:3168 nt lds
v_mul_f32 v118, s48, v118
v_mfma_f32_16x16x32_bf16 v[184:187], a[24:27], a[120:123], v[184:187]
s_waitcnt lgkmcnt(6)
v_mul_f32 v119, s48, v119
v_cvt_pk_bf16_f32 v34, v112, v113
v_cvt_pk_bf16_f32 v35, v114, v115
v_mfma_f32_16x16x32_bf16 v[196:199], a[32:35], a[120:123], v[196:199]
ds_read_b64_tr_b16 a[20:21], v72 offset:34176
v_accvgpr_write_b32 a60, v32
v_accvgpr_write_b32 a61, v33
v_cvt_pk_bf16_f32 v36, v104, v105
v_mfma_f32_16x16x32_bf16 v[196:199], a[36:39], a[132:135], v[196:199]
ds_read_b64_tr_b16 a[22:23], v72 offset:34688
v_cvt_pk_bf16_f32 v37, v106, v107
v_mul_f32 v108, s48, v108
v_mul_f32 v109, s48, v109
v_mfma_f32_16x16x32_bf16 v[200:203], a[36:39], a[136:139], v[200:203]
v_mul_f32 v110, s48, v110
v_mul_f32 v111, s48, v111
v_mul_f32 v120, s48, v120
v_mul_f32 v121, s48, v121
v_mfma_f32_16x16x32_bf16 v[200:203], a[32:35], a[124:127], v[200:203]
ds_read_b64_tr_b16 a[24:25], v15 offset:392
v_mul_f32 v122, s48, v122
v_mul_f32 v123, s48, v123
v_cvt_pk_bf16_f32 v38, v116, v117
v_mfma_f32_16x16x32_bf16 v[204:207], a[32:35], a[128:131], v[204:207]
ds_read_b64_tr_b16 a[26:27], v15 offset:904
v_cvt_pk_bf16_f32 v39, v118, v119
v_accvgpr_write_b32 a62, v34
v_accvgpr_write_b32 a63, v35
v_mfma_f32_16x16x32_bf16 v[204:207], a[36:39], a[140:143], v[204:207]
s_waitcnt lgkmcnt(6)
v_accvgpr_write_b32 a64, v36
v_accvgpr_write_b32 a65, v37
v_cvt_pk_bf16_f32 v64, v108, v109
v_mfma_f32_16x16x32_bf16 v[216:219], a[44:47], a[140:143], v[216:219]
ds_read_b64_tr_b16 a[28:29], v72 offset:34184
v_cvt_pk_bf16_f32 v65, v110, v111
v_cvt_pk_bf16_f32 v66, v120, v121
v_cvt_pk_bf16_f32 v67, v122, v123
v_accvgpr_write_b32 a66, v38
v_mfma_f32_16x16x32_bf16 v[216:219], a[40:43], a[128:131], v[216:219]
ds_read_b64_tr_b16 a[30:31], v72 offset:34696
v_accvgpr_write_b32 a67, v39
v_accvgpr_write_b32 a68, v64
v_accvgpr_write_b32 a69, v65
v_accvgpr_write_b32 a70, v66
v_mfma_f32_16x16x32_bf16 v[212:215], a[40:43], a[124:127], v[212:215]
s_waitcnt vmcnt(42)
s_barrier
v_accvgpr_write_b32 a71, v67
v_mul_f32 v124, s48, v124
v_mul_f32 v125, s48, v125
v_mfma_f32_16x16x32_bf16 v[212:215], a[44:47], a[136:139], v[212:215]
ds_read_b64_tr_b16 a[32:33], v15 offset:448
v_mul_f32 v126, s48, v126
v_mul_f32 v127, s48, v127
v_mul_f32 v136, s48, v136
v_mul_f32 v137, s48, v137
v_mfma_f32_16x16x32_bf16 v[208:211], a[44:47], a[132:135], v[208:211]
ds_read_b64_tr_b16 a[34:35], v15 offset:960
v_mul_f32 v138, s48, v138
v_mul_f32 v139, s48, v139
v_cvt_pk_bf16_f32 v68, v124, v125
v_cvt_pk_bf16_f32 v69, v126, v127
v_mfma_f32_16x16x32_bf16 v[208:211], a[40:43], a[120:123], v[208:211]
s_waitcnt lgkmcnt(6)
v_mul_f32 v128, s48, v128
v_mul_f32 v129, s48, v129
v_mul_f32 v130, s48, v130
v_mul_f32 v131, s48, v131
v_mfma_f32_16x16x32_bf16 v[220:223], a[16:19], a[120:123], v[220:223]
ds_read_b64_tr_b16 a[36:37], v72 offset:34240
v_mul_f32 v140, s48, v140
v_mul_f32 v141, s48, v141
v_mul_f32 v142, s48, v142
v_mul_f32 v143, s48, v143
v_mfma_f32_16x16x32_bf16 v[220:223], a[20:23], a[132:135], v[220:223]
ds_read_b64_tr_b16 a[38:39], v72 offset:34752
v_cvt_pk_bf16_f32 v70, v136, v137
v_cvt_pk_bf16_f32 v71, v138, v139
v_accvgpr_write_b32 a72, v68
v_accvgpr_write_b32 a73, v69
v_mfma_f32_16x16x32_bf16 v[224:227], a[20:23], a[136:139], v[224:227]
v_cvt_pk_bf16_f32 v16, v128, v129
v_cvt_pk_bf16_f32 v17, v130, v131
v_mul_f32 v132, s48, v132
v_mul_f32 v133, s48, v133
v_mul_f32 v134, s48, v134
v_mfma_f32_16x16x32_bf16 v[224:227], a[16:19], a[124:127], v[224:227]
ds_read_b64_tr_b16 a[40:41], v15 offset:456
v_mul_f32 v135, s48, v135
v_mul_f32 v144, s48, v144
v_mul_f32 v145, s48, v145
v_mul_f32 v146, s48, v146
v_mfma_f32_16x16x32_bf16 v[228:231], a[16:19], a[128:131], v[228:231]
ds_read_b64_tr_b16 a[42:43], v15 offset:968
v_mul_f32 v147, s48, v147
v_cvt_pk_bf16_f32 v18, v140, v141
v_cvt_pk_bf16_f32 v19, v142, v143
v_accvgpr_write_b32 a74, v70
v_mfma_f32_16x16x32_bf16 v[228:231], a[20:23], a[140:143], v[228:231]
s_waitcnt lgkmcnt(6)
v_accvgpr_write_b32 a75, v71
v_accvgpr_write_b32 a76, v16
v_accvgpr_write_b32 a77, v17
v_cvt_pk_bf16_f32 v20, v132, v133
v_mfma_f32_16x16x32_bf16 v[240:243], a[28:31], a[140:143], v[240:243]
ds_read_b64_tr_b16 a[44:45], v72 offset:34248
v_cvt_pk_bf16_f32 v21, v134, v135
v_cvt_pk_bf16_f32 v22, v144, v145
v_cvt_pk_bf16_f32 v23, v146, v147
v_accvgpr_write_b32 a78, v18
v_mfma_f32_16x16x32_bf16 v[240:243], a[24:27], a[128:131], v[240:243]
ds_read_b64_tr_b16 a[46:47], v72 offset:34760
v_accvgpr_write_b32 a79, v19
v_accvgpr_write_b32 a80, v20
v_accvgpr_write_b32 a81, v21
v_accvgpr_write_b32 a82, v22
v_mfma_f32_16x16x32_bf16 v[236:239], a[24:27], a[124:127], v[236:239]
v_accvgpr_write_b32 a83, v23
v_mul_f32 v148, s48, v148
v_mul_f32 v149, s48, v149
v_mul_f32 v150, s48, v150
v_mul_f32 v151, s48, v151
v_mfma_f32_16x16x32_bf16 v[236:239], a[28:31], a[136:139], v[236:239]
ds_read_b128 a[16:19], v8 offset:17408
v_mul_f32 v160, s48, v160
v_mul_f32 v161, s48, v161
v_mul_f32 v162, s48, v162
v_mul_f32 v163, s48, v163
v_mfma_f32_16x16x32_bf16 v[232:235], a[28:31], a[132:135], v[232:235]
v_cvt_pk_bf16_f32 v24, v148, v149
v_cvt_pk_bf16_f32 v25, v150, v151
v_mul_f32 v152, s48, v152
v_mul_f32 v153, s48, v153
v_mul_f32 v154, s48, v154
v_mfma_f32_16x16x32_bf16 v[232:235], a[24:27], a[120:123], v[232:235]
s_waitcnt lgkmcnt(5)
v_mul_f32 v155, s48, v155
v_mul_f32 v164, s48, v164
v_mul_f32 v165, s48, v165
v_mul_f32 v166, s48, v166
v_mfma_f32_16x16x32_bf16 v[244:247], a[32:35], a[120:123], v[244:247]
ds_read_b128 a[20:23], v8 offset:16896
v_mul_f32 v167, s48, v167
v_cvt_pk_bf16_f32 v26, v160, v161
v_cvt_pk_bf16_f32 v27, v162, v163
v_accvgpr_write_b32 a84, v24
v_mfma_f32_16x16x32_bf16 v[244:247], a[36:39], a[132:135], v[244:247]
v_accvgpr_write_b32 a85, v25
v_cvt_pk_bf16_f32 v32, v152, v153
v_cvt_pk_bf16_f32 v33, v154, v155
v_mul_f32 v156, s48, v156
v_mul_f32 v157, s48, v157
v_mfma_f32_16x16x32_bf16 v[248:251], a[36:39], a[136:139], v[248:251]
v_mul_f32 v158, s48, v158
v_mul_f32 v159, s48, v159
v_mul_f32 v168, s48, v168
v_mul_f32 v169, s48, v169
v_mul_f32 v170, s48, v170
v_mfma_f32_16x16x32_bf16 v[248:251], a[32:35], a[124:127], v[248:251]
ds_read_b128 a[24:27], v8 offset:17472
v_mul_f32 v171, s48, v171
v_cvt_pk_bf16_f32 v34, v164, v165
v_cvt_pk_bf16_f32 v35, v166, v167
v_accvgpr_write_b32 a86, v26
v_mfma_f32_16x16x32_bf16 a[0:3], a[32:35], a[128:131], a[0:3]
v_accvgpr_write_b32 a87, v27
v_accvgpr_write_b32 a88, v32
v_accvgpr_write_b32 a89, v33
v_cvt_pk_bf16_f32 v36, v156, v157
v_cvt_pk_bf16_f32 v37, v158, v159
v_mfma_f32_16x16x32_bf16 a[0:3], a[36:39], a[140:143], a[0:3]
s_waitcnt lgkmcnt(3)
v_cvt_pk_bf16_f32 v38, v168, v169
v_cvt_pk_bf16_f32 v39, v170, v171
v_accvgpr_write_b32 a90, v34
v_accvgpr_write_b32 a91, v35
v_mfma_f32_16x16x32_bf16 a[12:15], a[44:47], a[140:143], a[12:15]
ds_read_b128 a[28:31], v8 offset:16960
v_accvgpr_write_b32 a92, v36
v_accvgpr_write_b32 a93, v37
v_accvgpr_write_b32 a94, v38
v_accvgpr_write_b32 a95, v39
v_mfma_f32_16x16x32_bf16 a[12:15], a[40:43], a[128:131], a[12:15]
v_mul_f32 v172, s48, v172
v_mul_f32 v173, s48, v173
v_mul_f32 v174, s48, v174
v_mul_f32 v175, s48, v175
v_mul_f32 v184, s48, v184
v_mfma_f32_16x16x32_bf16 a[8:11], a[40:43], a[124:127], a[8:11]
v_mul_f32 v185, s48, v185
v_mul_f32 v186, s48, v186
v_mul_f32 v187, s48, v187
v_cvt_pk_bf16_f32 v64, v172, v173
v_cvt_pk_bf16_f32 v65, v174, v175
v_mfma_f32_16x16x32_bf16 a[8:11], a[44:47], a[136:139], a[8:11]
ds_read_b128 a[32:35], v8 offset:17536
v_mul_f32 v176, s48, v176
v_mul_f32 v177, s48, v177
v_mul_f32 v178, s48, v178
v_mul_f32 v179, s48, v179
v_mfma_f32_16x16x32_bf16 a[4:7], a[44:47], a[132:135], a[4:7]
v_mul_f32 v188, s48, v188
v_mul_f32 v189, s48, v189
v_mul_f32 v190, s48, v190
v_mul_f32 v191, s48, v191
v_cvt_pk_bf16_f32 v66, v184, v185
v_mfma_f32_16x16x32_bf16 a[4:7], a[40:43], a[120:123], a[4:7]
s_waitcnt lgkmcnt(3)
v_cvt_pk_bf16_f32 v67, v186, v187
v_accvgpr_write_b32 a96, v64
v_accvgpr_write_b32 a97, v65
v_cvt_pk_bf16_f32 v68, v176, v177
LS_14:
v_mfma_f32_16x16x32_bf16 v[52:55], a[16:19], a[48:51], 0
ds_read_b128 a[36:39], v8 offset:17024
v_cvt_pk_bf16_f32 v69, v178, v179
v_mul_f32 v180, s48, v180
v_mul_f32 v181, s48, v181
v_mul_f32 v182, s48, v182
v_mfma_f32_16x16x32_bf16 v[56:59], a[16:19], a[52:55], 0
v_mul_f32 v183, s48, v183
v_mul_f32 v192, s48, v192
v_mul_f32 v193, s48, v193
v_mul_f32 v194, s48, v194
v_mul_f32 v195, s48, v195
v_mfma_f32_16x16x32_bf16 v[60:63], a[16:19], a[56:59], 0
v_cvt_pk_bf16_f32 v70, v188, v189
v_cvt_pk_bf16_f32 v71, v190, v191
v_accvgpr_write_b32 a98, v66
v_accvgpr_write_b32 a99, v67
v_accvgpr_write_b32 a100, v68
v_mfma_f32_16x16x32_bf16 v[48:51], a[20:23], a[56:59], 0
ds_read_b128 a[40:43], v8 offset:17600
v_accvgpr_write_b32 a101, v69
v_cvt_pk_bf16_f32 v16, v180, v181
v_cvt_pk_bf16_f32 v17, v182, v183
v_cvt_pk_bf16_f32 v18, v192, v193
v_mfma_f32_16x16x32_bf16 v[44:47], a[20:23], a[52:55], 0
s_waitcnt vmcnt(33)
s_barrier
v_cvt_pk_bf16_f32 v19, v194, v195
v_accvgpr_write_b32 a102, v70
v_accvgpr_write_b32 a103, v71
v_mfma_f32_16x16x32_bf16 v[40:43], a[20:23], a[48:51], 0
s_waitcnt lgkmcnt(3)
s_add_u32 m0, s17, 84480
s_mov_b32 s50, 65536
v_accvgpr_write_b32 a104, v16
v_accvgpr_write_b32 a105, v17
v_mfma_f32_16x16x32_bf16 v[52:55], a[24:27], a[60:63], v[52:55]
ds_read_b128 a[44:47], v8 offset:17088
buffer_load_dwordx4 v0, s[20:23], s50 offen offset:0 nt lds
v_accvgpr_write_b32 a106, v18
v_accvgpr_write_b32 a107, v19
v_mfma_f32_16x16x32_bf16 v[56:59], a[24:27], a[64:67], v[56:59]
v_mul_f32 v196, s48, v196
v_mul_f32 v197, s48, v197
v_mul_f32 v198, s48, v198
v_mul_f32 v199, s48, v199
v_mul_f32 v208, s48, v208
v_mfma_f32_16x16x32_bf16 v[60:63], a[24:27], a[68:71], v[60:63]
v_mul_f32 v209, s48, v209
v_mul_f32 v210, s48, v210
v_mul_f32 v211, s48, v211
v_cvt_pk_bf16_f32 v20, v196, v197
v_cvt_pk_bf16_f32 v21, v198, v199
v_mfma_f32_16x16x32_bf16 v[48:51], a[28:31], a[68:71], v[48:51]
ds_read_b128 a[16:19], v8 offset:17664
buffer_load_dwordx4 v1, s[20:23], s50 offen offset:1056 nt lds
v_mul_f32 v200, s48, v200
v_mul_f32 v201, s48, v201
v_mfma_f32_16x16x32_bf16 v[44:47], a[28:31], a[64:67], v[44:47]
v_mul_f32 v202, s48, v202
v_mul_f32 v203, s48, v203
v_mul_f32 v212, s48, v212
v_mul_f32 v213, s48, v213
v_mul_f32 v214, s48, v214
v_mfma_f32_16x16x32_bf16 v[40:43], a[28:31], a[60:63], v[40:43]
s_waitcnt lgkmcnt(3)
v_mul_f32 v215, s48, v215
v_cvt_pk_bf16_f32 v22, v208, v209
v_cvt_pk_bf16_f32 v23, v210, v211
v_accvgpr_write_b32 a108, v20
v_mfma_f32_16x16x32_bf16 v[52:55], a[32:35], a[72:75], v[52:55]
ds_read_b128 a[20:23], v8 offset:17152
buffer_load_dwordx4 v2, s[20:23], s50 offen offset:2112 nt lds
v_accvgpr_write_b32 a109, v21
v_cvt_pk_bf16_f32 v24, v200, v201
v_cvt_pk_bf16_f32 v25, v202, v203
v_mfma_f32_16x16x32_bf16 v[56:59], a[32:35], a[76:79], v[56:59]
v_mul_f32 v204, s48, v204
v_mul_f32 v205, s48, v205
v_mul_f32 v206, s48, v206
v_mul_f32 v207, s48, v207
v_mul_f32 v216, s48, v216
v_mfma_f32_16x16x32_bf16 v[60:63], a[32:35], a[80:83], v[60:63]
v_mul_f32 v217, s48, v217
v_mul_f32 v218, s48, v218
v_mul_f32 v219, s48, v219
v_cvt_pk_bf16_f32 v26, v212, v213
v_cvt_pk_bf16_f32 v27, v214, v215
v_mfma_f32_16x16x32_bf16 v[48:51], a[36:39], a[80:83], v[48:51]
ds_read_b128 a[24:27], v8 offset:17728
buffer_load_dwordx4 v3, s[20:23], s50 offen offset:3168 nt lds
v_accvgpr_write_b32 a110, v22
v_accvgpr_write_b32 a111, v23
v_accvgpr_write_b32 a112, v24
v_mfma_f32_16x16x32_bf16 v[44:47], a[36:39], a[76:79], v[44:47]
s_add_u32 m0, s17, 101376
s_mov_b32 s50, 49152
v_accvgpr_write_b32 a113, v25
v_cvt_pk_bf16_f32 v32, v204, v205
v_cvt_pk_bf16_f32 v33, v206, v207
v_mfma_f32_16x16x32_bf16 v[40:43], a[36:39], a[72:75], v[40:43]
s_waitcnt lgkmcnt(3)
buffer_load_dwordx4 v0, s[24:27], s50 offen offset:0 nt lds
v_cvt_pk_bf16_f32 v34, v216, v217
v_cvt_pk_bf16_f32 v35, v218, v219
v_mfma_f32_16x16x32_bf16 v[52:55], a[40:43], a[84:87], v[52:55]
ds_read_b128 a[28:31], v8 offset:17216
v_accvgpr_write_b32 a114, v26
v_accvgpr_write_b32 a115, v27
v_accvgpr_write_b32 a116, v32
v_accvgpr_write_b32 a117, v33
v_accvgpr_write_b32 a118, v34
v_mfma_f32_16x16x32_bf16 v[56:59], a[40:43], a[88:91], v[56:59]
v_accvgpr_write_b32 a119, v35
v_mul_f32 v220, s48, v220
v_mul_f32 v221, s48, v221
v_mul_f32 v222, s48, v222
v_mul_f32 v223, s48, v223
v_mfma_f32_16x16x32_bf16 v[60:63], a[40:43], a[92:95], v[60:63]
buffer_load_dwordx4 v1, s[24:27], s50 offen offset:1056 nt lds
v_mul_f32 v232, s48, v232
v_mul_f32 v233, s48, v233
v_mul_f32 v234, s48, v234
v_mfma_f32_16x16x32_bf16 v[48:51], a[44:47], a[92:95], v[48:51]
ds_read_b128 a[32:35], v8 offset:17792
v_mul_f32 v235, s48, v235
v_cvt_pk_bf16_f32 v36, v220, v221
v_cvt_pk_bf16_f32 v37, v222, v223
v_mul_f32 v224, s48, v224
v_mul_f32 v225, s48, v225
v_mfma_f32_16x16x32_bf16 v[44:47], a[44:47], a[88:91], v[44:47]
v_mul_f32 v226, s48, v226
v_mul_f32 v227, s48, v227
v_mul_f32 v236, s48, v236
v_mul_f32 v237, s48, v237
v_mul_f32 v238, s48, v238
v_mfma_f32_16x16x32_bf16 v[40:43], a[44:47], a[84:87], v[40:43]
s_waitcnt lgkmcnt(3)
buffer_load_dwordx4 v2, s[24:27], s50 offen offset:2112 nt lds
v_mul_f32 v239, s48, v239
v_cvt_pk_bf16_f32 v38, v232, v233
v_mfma_f32_16x16x32_bf16 v[52:55], a[16:19], a[96:99], v[52:55]
ds_read_b128 a[36:39], v8 offset:17280
v_cvt_pk_bf16_f32 v39, v234, v235
v_cvt_pk_bf16_f32 v64, v224, v225
v_cvt_pk_bf16_f32 v65, v226, v227
v_mul_f32 v228, s48, v228
v_mul_f32 v229, s48, v229
v_mfma_f32_16x16x32_bf16 v[56:59], a[16:19], a[100:103], v[56:59]
v_mul_f32 v230, s48, v230
v_mul_f32 v231, s48, v231
v_mul_f32 v240, s48, v240
v_mul_f32 v241, s48, v241
v_mul_f32 v242, s48, v242
v_mul_f32 v243, s48, v243
v_mfma_f32_16x16x32_bf16 v[60:63], a[16:19], a[104:107], v[60:63]
buffer_load_dwordx4 v3, s[24:27], s50 offen offset:3168 nt lds
v_cvt_pk_bf16_f32 v66, v236, v237
v_cvt_pk_bf16_f32 v67, v238, v239
v_accvgpr_write_b32 a120, v36
v_accvgpr_write_b32 a121, v37
v_mfma_f32_16x16x32_bf16 v[48:51], a[20:23], a[104:107], v[48:51]
ds_read_b128 a[40:43], v8 offset:17856
v_accvgpr_write_b32 a122, v38
v_accvgpr_write_b32 a123, v39
v_cvt_pk_bf16_f32 v68, v228, v229
v_cvt_pk_bf16_f32 v69, v230, v231
v_cvt_pk_bf16_f32 v70, v240, v241
v_mfma_f32_16x16x32_bf16 v[44:47], a[20:23], a[100:103], v[44:47]
v_cvt_pk_bf16_f32 v71, v242, v243
v_accvgpr_write_b32 a124, v64
v_accvgpr_write_b32 a125, v65
v_accvgpr_write_b32 a126, v66
v_accvgpr_write_b32 a127, v67
v_accvgpr_write_b32 a128, v68
v_mfma_f32_16x16x32_bf16 v[40:43], a[20:23], a[96:99], v[40:43]
s_waitcnt lgkmcnt(3)
v_accvgpr_write_b32 a129, v69
v_accvgpr_write_b32 a130, v70
v_accvgpr_write_b32 a131, v71
v_accvgpr_read_b32 v208, a4
v_accvgpr_read_b32 v209, a5
v_mfma_f32_16x16x32_bf16 v[52:55], a[24:27], a[108:111], v[52:55]
ds_read_b128 a[44:47], v8 offset:17344
v_accvgpr_read_b32 v210, a6
v_accvgpr_read_b32 v211, a7
v_mul_f32 v244, s48, v244
v_mul_f32 v245, s48, v245
v_mul_f32 v246, s48, v246
v_mfma_f32_16x16x32_bf16 v[56:59], a[24:27], a[112:115], v[56:59]
v_mul_f32 v247, s48, v247
v_accvgpr_read_b32 v212, a8
v_accvgpr_read_b32 v213, a9
v_accvgpr_read_b32 v214, a10
v_accvgpr_read_b32 v215, a11
v_mfma_f32_16x16x32_bf16 v[60:63], a[24:27], a[116:119], v[60:63]
v_mul_f32 v208, s48, v208
v_mul_f32 v209, s48, v209
v_mul_f32 v210, s48, v210
v_mul_f32 v211, s48, v211
v_cvt_pk_bf16_f32 v16, v244, v245
v_mfma_f32_16x16x32_bf16 v[48:51], a[28:31], a[116:119], v[48:51]
ds_read_b128 a[16:19], v8 offset:50688
v_cvt_pk_bf16_f32 v17, v246, v247
v_mul_f32 v248, s48, v248
v_mul_f32 v249, s48, v249
v_mul_f32 v250, s48, v250
v_mul_f32 v251, s48, v251
v_mfma_f32_16x16x32_bf16 v[44:47], a[28:31], a[112:115], v[44:47]
v_accvgpr_read_b32 v204, a0
v_accvgpr_read_b32 v205, a1
v_accvgpr_read_b32 v206, a2
v_accvgpr_read_b32 v207, a3
v_accvgpr_read_b32 v216, a12
v_mfma_f32_16x16x32_bf16 v[40:43], a[28:31], a[108:111], v[40:43]
s_waitcnt lgkmcnt(3)
v_accvgpr_read_b32 v217, a13
v_accvgpr_read_b32 v218, a14
v_accvgpr_read_b32 v219, a15
v_mul_f32 v212, s48, v212
v_mfma_f32_16x16x32_bf16 v[52:55], a[32:35], a[120:123], v[52:55]
ds_read_b128 a[20:23], v8 offset:50752
v_mul_f32 v213, s48, v213
v_mul_f32 v214, s48, v214
v_mul_f32 v215, s48, v215
v_cvt_pk_bf16_f32 v18, v208, v209
v_cvt_pk_bf16_f32 v19, v210, v211
v_mfma_f32_16x16x32_bf16 v[56:59], a[32:35], a[124:127], v[56:59]
v_cvt_pk_bf16_f32 v20, v248, v249
v_cvt_pk_bf16_f32 v21, v250, v251
v_mul_f32 v204, s48, v204
v_mul_f32 v205, s48, v205
v_mul_f32 v206, s48, v206
v_mfma_f32_16x16x32_bf16 v[60:63], a[32:35], a[128:131], v[60:63]
v_mul_f32 v207, s48, v207
v_mul_f32 v216, s48, v216
v_mul_f32 v217, s48, v217
v_mul_f32 v218, s48, v218
v_mul_f32 v219, s48, v219
v_mfma_f32_16x16x32_bf16 v[48:51], a[36:39], a[128:131], v[48:51]
ds_read_b128 a[24:27], v8 offset:50816
v_accvgpr_write_b32 a132, v16
v_accvgpr_write_b32 a133, v17
v_cvt_pk_bf16_f32 v22, v212, v213
v_cvt_pk_bf16_f32 v23, v214, v215
v_accvgpr_write_b32 a134, v18
v_mfma_f32_16x16x32_bf16 v[44:47], a[36:39], a[124:127], v[44:47]
v_accvgpr_write_b32 a135, v19
v_cvt_pk_bf16_f32 v24, v204, v205
v_cvt_pk_bf16_f32 v25, v206, v207
v_accvgpr_write_b32 a136, v20
v_accvgpr_write_b32 a137, v21
v_mfma_f32_16x16x32_bf16 v[40:43], a[36:39], a[120:123], v[40:43]
s_waitcnt lgkmcnt(3)
v_cvt_pk_bf16_f32 v26, v216, v217
v_cvt_pk_bf16_f32 v27, v218, v219
v_accvgpr_write_b32 a138, v22
v_accvgpr_write_b32 a139, v23
v_mfma_f32_16x16x32_bf16 v[52:55], a[40:43], a[132:135], v[52:55]
ds_read_b128 a[28:31], v8 offset:50880
v_accvgpr_write_b32 a140, v24
v_accvgpr_write_b32 a141, v25
v_accvgpr_write_b32 a142, v26
v_accvgpr_write_b32 a143, v27
v_mfma_f32_16x16x32_bf16 v[56:59], a[40:43], a[136:139], v[56:59]
s_nop 0
v_mfma_f32_16x16x32_bf16 v[60:63], a[40:43], a[140:143], v[60:63]
v_mfma_f32_16x16x32_bf16 v[48:51], a[44:47], a[140:143], v[48:51]
ds_read_b128 a[32:35], v8 offset:50944
v_mfma_f32_16x16x32_bf16 v[44:47], a[44:47], a[136:139], v[44:47]
v_mfma_f32_16x16x32_bf16 v[40:43], a[44:47], a[132:135], v[40:43]
s_waitcnt lgkmcnt(3)
v_max3_f32 v10, v52, v53, v54
v_max3_f32 v11, v56, v57, v58
s_nop 0
v_max3_f32 v12, v60, v61, v62
LS_15:
v_mfma_f32_16x16x32_bf16 v[64:67], a[16:19], a[48:51], 0
ds_read_b128 a[36:39], v8 offset:51008
v_max_f32 v10, v10, v55
v_max_f32 v11, v11, v59
v_max_f32 v12, v12, v63
v_mfma_f32_16x16x32_bf16 v[64:67], a[20:23], a[60:63], v[64:67]
v_max3_f32 v10, v10, v40, v41
v_max3_f32 v11, v11, v44, v45
v_mfma_f32_16x16x32_bf16 v[68:71], a[20:23], a[64:67], 0
v_max3_f32 v12, v12, v48, v49
v_max3_f32 v10, v10, v42, v43
v_max3_f32 v11, v11, v46, v47
v_mfma_f32_16x16x32_bf16 v[68:71], a[16:19], a[52:55], v[68:71]
ds_read_b128 a[40:43], v8 offset:51072
v_max3_f32 v12, v12, v50, v51
v_mov_b32 v30, v10
v_mov_b32 v34, v11
v_mfma_f32_16x16x32_bf16 v[72:75], a[16:19], a[56:59], 0
v_mov_b32 v38, v12
v_mfma_f32_16x16x32_bf16 v[72:75], a[20:23], a[68:71], v[72:75]
s_waitcnt lgkmcnt(3)
v_permlane32_swap_b32 v10, v30
v_permlane32_swap_b32 v11, v34
v_mfma_f32_16x16x32_bf16 v[72:75], a[24:27], a[80:83], v[72:75]
ds_read_b128 a[44:47], v8 offset:51136
v_permlane32_swap_b32 v12, v38
v_max_f32 v10, v10, v30
v_max_f32 v11, v11, v34
v_mfma_f32_16x16x32_bf16 v[72:75], a[28:31], a[92:95], v[72:75]
v_max_f32 v12, v12, v38
v_mov_b32 v30, v10
v_mov_b32 v34, v11
v_mfma_f32_16x16x32_bf16 v[68:71], a[28:31], a[88:91], v[68:71]
v_mov_b32 v38, v12
v_mfma_f32_16x16x32_bf16 v[68:71], a[24:27], a[76:79], v[68:71]
ds_read_b128 a[16:19], v8 offset:51200
v_permlane16_swap_b32 v10, v30
v_permlane16_swap_b32 v11, v34
v_mfma_f32_16x16x32_bf16 v[64:67], a[24:27], a[72:75], v[64:67]
v_permlane16_swap_b32 v12, v38
v_max_f32 v10, v10, v30
v_max_f32 v11, v11, v34
v_mfma_f32_16x16x32_bf16 v[64:67], a[28:31], a[84:87], v[64:67]
s_waitcnt lgkmcnt(3)
v_max_f32 v12, v12, v38
v_ceil_f32 v10, v10
v_ceil_f32 v11, v11
v_mfma_f32_16x16x32_bf16 v[64:67], a[32:35], a[96:99], v[64:67]
ds_read_b128 a[20:23], v8 offset:51264
v_ceil_f32 v12, v12
v_sub_f32 v16, 0, v10
v_sub_f32 v20, 0, v11
v_mfma_f32_16x16x32_bf16 v[64:67], a[36:39], a[108:111], v[64:67]
v_sub_f32 v24, 0, v12
v_mov_b32 v10, 0
v_mov_b32 v11, 0
v_mov_b32 v17, v16
v_mov_b32 v18, v16
v_mov_b32 v19, v16
v_mov_b32 v21, v20
v_mfma_f32_16x16x32_bf16 v[68:71], a[36:39], a[112:115], v[68:71]
v_mov_b32 v12, 0
v_add_f32 v40, v40, v16
v_add_f32 v41, v41, v16
v_add_f32 v42, v42, v16
v_add_f32 v43, v43, v16
v_add_f32 v44, v44, v20
v_add_f32 v45, v45, v20
v_add_f32 v46, v46, v20
v_mfma_f32_16x16x32_bf16 v[68:71], a[32:35], a[100:103], v[68:71]
ds_read_b128 a[24:27], v8 offset:51328
v_exp_f32 v40, v40
v_exp_f32 v41, v41
v_exp_f32 v42, v42
v_mfma_f32_16x16x32_bf16 v[72:75], a[32:35], a[104:107], v[72:75]
v_add_f32 v47, v47, v20
v_add_f32 v48, v48, v24
v_add_f32 v49, v49, v24
v_add_f32 v50, v50, v24
v_add_f32 v51, v51, v24
v_exp_f32 v43, v43
v_mfma_f32_16x16x32_bf16 v[72:75], a[36:39], a[116:119], v[72:75]
s_waitcnt lgkmcnt(3)
v_exp_f32 v44, v44
v_exp_f32 v45, v45
v_exp_f32 v46, v46
v_mov_b32 v22, v20
v_mfma_f32_16x16x32_bf16 v[72:75], a[40:43], a[128:131], v[72:75]
ds_read_b128 a[28:31], v8 offset:51392
v_exp_f32 v47, v47
v_exp_f32 v48, v48
v_exp_f32 v49, v49
v_mfma_f32_16x16x32_bf16 v[72:75], a[44:47], a[140:143], v[72:75]
v_exp_f32 v50, v50
v_exp_f32 v51, v51
v_mov_b32 v23, v20
v_mov_b32 v25, v24
v_mov_b32 v26, v24
v_mfma_f32_16x16x32_bf16 v[68:71], a[44:47], a[136:139], v[68:71]
s_waitcnt vmcnt(33)
s_barrier
v_mov_b32 v27, v24
v_add_f32 v10, v10, v40
v_add_f32 v10, v10, v41
v_add_f32 v10, v10, v42
v_add_f32 v10, v10, v43
v_add_f32 v11, v11, v44
v_mfma_f32_16x16x32_bf16 v[68:71], a[40:43], a[124:127], v[68:71]
ds_read_b128 a[32:35], v8 offset:51456
v_add_f32 v11, v11, v45
v_add_f32 v11, v11, v46
v_add_f32 v11, v11, v47
v_cvt_pk_bf16_f32 v28, v40, v41
v_cvt_pk_bf16_f32 v29, v42, v43
v_cvt_pk_bf16_f32 v32, v44, v45
v_mfma_f32_16x16x32_bf16 v[64:67], a[40:43], a[120:123], v[64:67]
v_cvt_pk_bf16_f32 v33, v46, v47
v_add_f32 v12, v12, v48
v_add_f32 v12, v12, v49
v_add_f32 v12, v12, v50
v_add_f32 v12, v12, v51
v_cvt_pk_bf16_f32 v36, v48, v49
v_cvt_pk_bf16_f32 v37, v50, v51
v_mfma_f32_16x16x32_bf16 v[64:67], a[44:47], a[132:135], v[64:67]
s_waitcnt lgkmcnt(3)
s_add_u32 m0, s17, 16896
s_mov_b32 s50, 81920
v_add_f32 v52, v52, v16
v_mfma_f32_16x16x32_bf16 v[40:43], a[16:19], a[48:51], v[16:19]
ds_read_b128 a[36:39], v8 offset:51520
buffer_load_dwordx4 v0, s[20:23], s50 offen offset:0 nt lds
v_add_f32 v53, v53, v16
v_mfma_f32_16x16x32_bf16 v[40:43], a[20:23], a[60:63], v[40:43]
v_exp_f32 v52, v52
v_exp_f32 v53, v53
v_mfma_f32_16x16x32_bf16 v[44:47], a[20:23], a[64:67], v[20:23]
v_add_f32 v54, v54, v16
v_add_f32 v55, v55, v16
v_add_f32 v56, v56, v20
v_add_f32 v57, v57, v20
v_mfma_f32_16x16x32_bf16 v[44:47], a[16:19], a[52:55], v[44:47]
ds_read_b128 a[40:43], v8 offset:51584
buffer_load_dwordx4 v1, s[20:23], s50 offen offset:1056 nt lds
v_add_f32 v58, v58, v20
v_mfma_f32_16x16x32_bf16 v[48:51], a[16:19], a[56:59], v[24:27]
v_exp_f32 v54, v54
v_exp_f32 v55, v55
v_mfma_f32_16x16x32_bf16 v[48:51], a[20:23], a[68:71], v[48:51]
s_waitcnt lgkmcnt(3)
v_exp_f32 v56, v56
v_add_f32 v59, v59, v20
v_mfma_f32_16x16x32_bf16 v[48:51], a[24:27], a[80:83], v[48:51]
ds_read_b128 a[44:47], v8 offset:51648
v_exp_f32 v57, v57
v_add_f32 v60, v60, v24
v_mfma_f32_16x16x32_bf16 v[48:51], a[28:31], a[92:95], v[48:51]
v_exp_f32 v58, v58
v_exp_f32 v59, v59
v_mfma_f32_16x16x32_bf16 v[44:47], a[28:31], a[88:91], v[44:47]
v_exp_f32 v60, v60
buffer_load_dwordx4 v2, s[20:23], s50 offen offset:2112 nt lds
v_mfma_f32_16x16x32_bf16 v[44:47], a[24:27], a[76:79], v[44:47]
v_add_u32 v9, 84480, v9
ds_read_b64_tr_b16 a[16:17], v9 offset:50688
v_add_f32 v61, v61, v24
v_add_f32 v62, v62, v24
v_mfma_f32_16x16x32_bf16 v[40:43], a[24:27], a[72:75], v[40:43]
ds_read_b64_tr_b16 a[18:19], v9 offset:51200
v_exp_f32 v61, v61
v_add_f32 v63, v63, v24
v_mfma_f32_16x16x32_bf16 v[40:43], a[28:31], a[84:87], v[40:43]
s_waitcnt lgkmcnt(4)
v_exp_f32 v62, v62
v_add_f32 v64, v64, v16
v_mfma_f32_16x16x32_bf16 v[40:43], a[32:35], a[96:99], v[40:43]
ds_read_b64_tr_b16 a[20:21], v9 offset:50720
v_exp_f32 v63, v63
v_add_f32 v65, v65, v16
v_mfma_f32_16x16x32_bf16 v[40:43], a[36:39], a[108:111], v[40:43]
ds_read_b64_tr_b16 a[22:23], v9 offset:51232
v_add_f32 v66, v66, v16
v_add_f32 v67, v67, v16
v_add_f32 v68, v68, v20
v_mfma_f32_16x16x32_bf16 v[44:47], a[36:39], a[112:115], v[44:47]
v_add_f32 v69, v69, v20
v_add_f32 v70, v70, v20
v_add_f32 v71, v71, v20
v_add_f32 v72, v72, v24
v_mfma_f32_16x16x32_bf16 v[44:47], a[32:35], a[100:103], v[44:47]
ds_read_b64_tr_b16 a[24:25], v9 offset:50752
v_add_f32 v73, v73, v24
v_add_f32 v74, v74, v24
v_add_f32 v75, v75, v24
v_mfma_f32_16x16x32_bf16 v[48:51], a[32:35], a[104:107], v[48:51]
ds_read_b64_tr_b16 a[26:27], v9 offset:51264
v_max3_f32 v13, v64, v65, v66
buffer_load_dwordx4 v3, s[20:23], s50 offen offset:3168 nt lds
v_mfma_f32_16x16x32_bf16 v[48:51], a[36:39], a[116:119], v[48:51]
s_waitcnt lgkmcnt(6)
v_max3_f32 v13, v13, v67, v68
v_cvt_pk_bf16_f32 v30, v52, v53
v_cvt_pk_bf16_f32 v31, v54, v55
v_mfma_f32_16x16x32_bf16 v[48:51], a[40:43], a[128:131], v[48:51]
ds_read_b64_tr_b16 a[28:29], v9 offset:50784
v_max3_f32 v13, v13, v69, v70
v_cvt_pk_bf16_f32 v34, v56, v57
v_cvt_pk_bf16_f32 v35, v58, v59
v_mfma_f32_16x16x32_bf16 v[48:51], a[44:47], a[140:143], v[48:51]
ds_read_b64_tr_b16 a[30:31], v9 offset:51296
v_cvt_pk_bf16_f32 v38, v60, v61
v_cvt_pk_bf16_f32 v39, v62, v63
v_max3_f32 v13, v13, v71, v72
v_mfma_f32_16x16x32_bf16 v[44:47], a[44:47], a[136:139], v[44:47]
v_max3_f32 v13, v13, v73, v74
v_add_f32 v10, v10, v52
v_add_f32 v10, v10, v53
v_add_f32 v10, v10, v54
v_mfma_f32_16x16x32_bf16 v[44:47], a[40:43], a[124:127], v[44:47]
ds_read_b64_tr_b16 a[32:33], v9 offset:50816
v_add_f32 v10, v10, v55
v_add_f32 v11, v11, v56
v_add_f32 v11, v11, v57
v_add_f32 v11, v11, v58
v_mfma_f32_16x16x32_bf16 v[40:43], a[40:43], a[120:123], v[40:43]
ds_read_b64_tr_b16 a[34:35], v9 offset:51328
v_add_f32 v11, v11, v59
v_add_f32 v12, v12, v60
v_add_f32 v12, v12, v61
v_mfma_f32_16x16x32_bf16 v[40:43], a[44:47], a[132:135], v[40:43]
s_waitcnt lgkmcnt(6)
v_add_f32 v12, v12, v62
v_add_f32 v12, v12, v63
v_max_f32 v13, v13, v75
LS_16:
v_mfma_f32_16x16x32_bf16 v[76:79], a[16:19], v[28:31], 0
ds_read_b64_tr_b16 a[36:37], v9 offset:50848
v_mfma_f32_16x16x32_bf16 v[80:83], a[16:19], v[32:35], 0
ds_read_b64_tr_b16 a[38:39], v9 offset:51360
v_mfma_f32_16x16x32_bf16 v[84:87], a[16:19], v[36:39], 0
v_mfma_f32_16x16x32_bf16 v[96:99], a[20:23], v[36:39], 0
ds_read_b64_tr_b16 a[40:41], v9 offset:50880
v_max3_f32 v13, v13, v40, v41
v_mfma_f32_16x16x32_bf16 v[92:95], a[20:23], v[32:35], 0
ds_read_b64_tr_b16 a[42:43], v9 offset:51392
v_max3_f32 v13, v13, v42, v43
v_mfma_f32_16x16x32_bf16 v[88:91], a[20:23], v[28:31], 0
s_waitcnt lgkmcnt(6)
v_max3_f32 v13, v13, v44, v45
v_mfma_f32_16x16x32_bf16 v[100:103], a[24:27], v[28:31], 0
ds_read_b64_tr_b16 a[44:45], v9 offset:50912
v_max3_f32 v13, v13, v46, v47
v_mfma_f32_16x16x32_bf16 v[104:107], a[24:27], v[32:35], 0
ds_read_b64_tr_b16 a[46:47], v9 offset:51424
v_max3_f32 v13, v13, v48, v49
v_mfma_f32_16x16x32_bf16 v[108:111], a[24:27], v[36:39], 0
v_max3_f32 v13, v13, v50, v51
v_mfma_f32_16x16x32_bf16 v[120:123], a[28:31], v[36:39], 0
ds_read_b64_tr_b16 a[16:17], v9 offset:50944
v_cmp_lt_f32 vcc, s47, v13
v_mfma_f32_16x16x32_bf16 v[116:119], a[28:31], v[32:35], 0
ds_read_b64_tr_b16 a[18:19], v9 offset:51456
v_mfma_f32_16x16x32_bf16 v[112:115], a[28:31], v[28:31], 0
s_waitcnt lgkmcnt(6)
s_cbranch_vccnz RARE_h0j0
RET_h0j0:
v_mfma_f32_16x16x32_bf16 v[124:127], a[32:35], v[28:31], 0
ds_read_b64_tr_b16 a[20:21], v9 offset:50976
ds_read_b64_tr_b16 a[22:23], v9 offset:51488
v_mfma_f32_16x16x32_bf16 v[128:131], a[32:35], v[32:35], 0
v_exp_f32 v40, v40
v_mfma_f32_16x16x32_bf16 v[132:135], a[32:35], v[36:39], 0
v_exp_f32 v41, v41
v_mfma_f32_16x16x32_bf16 v[144:147], a[36:39], v[36:39], 0
ds_read_b64_tr_b16 a[24:25], v9 offset:51008
ds_read_b64_tr_b16 a[26:27], v9 offset:51520
v_mfma_f32_16x16x32_bf16 v[140:143], a[36:39], v[32:35], 0
v_exp_f32 v42, v42
v_mfma_f32_16x16x32_bf16 v[136:139], a[36:39], v[28:31], 0
s_waitcnt lgkmcnt(6)
v_add_f32 v10, v10, v40
v_mfma_f32_16x16x32_bf16 v[148:151], a[40:43], v[28:31], 0
ds_read_b64_tr_b16 a[28:29], v9 offset:51040
ds_read_b64_tr_b16 a[30:31], v9 offset:51552
v_mfma_f32_16x16x32_bf16 v[152:155], a[40:43], v[32:35], 0
v_exp_f32 v43, v43
v_mfma_f32_16x16x32_bf16 v[156:159], a[40:43], v[36:39], 0
s_waitcnt vmcnt(25)
s_barrier
v_mfma_f32_16x16x32_bf16 v[168:171], a[44:47], v[36:39], 0
ds_read_b64_tr_b16 a[32:33], v9 offset:51072
ds_read_b64_tr_b16 a[34:35], v9 offset:51584
v_mfma_f32_16x16x32_bf16 v[164:167], a[44:47], v[32:35], 0
s_add_u32 m0, s17, 50688
s_mov_b32 s50, 65536
v_mfma_f32_16x16x32_bf16 v[160:163], a[44:47], v[28:31], 0
s_waitcnt lgkmcnt(6)
v_add_f32 v10, v10, v41
v_mfma_f32_16x16x32_bf16 v[172:175], a[16:19], v[28:31], 0
ds_read_b64_tr_b16 a[36:37], v9 offset:51104
ds_read_b64_tr_b16 a[38:39], v9 offset:51616
v_mfma_f32_16x16x32_bf16 v[176:179], a[16:19], v[32:35], 0
buffer_load_dwordx4 v0, s[24:27], s50 offen offset:0 nt lds
v_mfma_f32_16x16x32_bf16 v[180:183], a[16:19], v[36:39], 0
v_exp_f32 v44, v44
v_mfma_f32_16x16x32_bf16 v[192:195], a[20:23], v[36:39], 0
ds_read_b64_tr_b16 a[40:41], v9 offset:51136
ds_read_b64_tr_b16 a[42:43], v9 offset:51648
v_mfma_f32_16x16x32_bf16 v[188:191], a[20:23], v[32:35], 0
buffer_load_dwordx4 v1, s[24:27], s50 offen offset:1056 nt lds
v_mfma_f32_16x16x32_bf16 v[184:187], a[20:23], v[28:31], 0
s_waitcnt lgkmcnt(6)
v_add_f32 v10, v10, v42
v_mfma_f32_16x16x32_bf16 v[196:199], a[24:27], v[28:31], 0
ds_read_b64_tr_b16 a[44:45], v9 offset:51168
ds_read_b64_tr_b16 a[46:47], v9 offset:51680
v_mfma_f32_16x16x32_bf16 v[200:203], a[24:27], v[32:35], 0
buffer_load_dwordx4 v2, s[24:27], s50 offen offset:2112 nt lds
v_mfma_f32_16x16x32_bf16 v[204:207], a[24:27], v[36:39], 0
v_exp_f32 v45, v45
v_mfma_f32_16x16x32_bf16 v[216:219], a[28:31], v[36:39], 0
ds_read_b128 a[16:19], v8 offset:512
v_add_f32 v10, v10, v43
v_mfma_f32_16x16x32_bf16 v[212:215], a[28:31], v[32:35], 0
v_exp_f32 v46, v46
v_mfma_f32_16x16x32_bf16 v[208:211], a[28:31], v[28:31], 0
s_waitcnt lgkmcnt(5)
v_add_f32 v11, v11, v44
v_mfma_f32_16x16x32_bf16 v[220:223], a[32:35], v[28:31], 0
ds_read_b128 a[20:23], v8 offset:576
v_add_f32 v11, v11, v45
v_mfma_f32_16x16x32_bf16 v[224:227], a[32:35], v[32:35], 0
v_exp_f32 v47, v47
v_mfma_f32_16x16x32_bf16 v[228:231], a[32:35], v[36:39], 0
v_exp_f32 v48, v48
v_mfma_f32_16x16x32_bf16 v[240:243], a[36:39], v[36:39], 0
ds_read_b128 a[24:27], v8 offset:640
v_add_f32 v11, v11, v46
v_mfma_f32_16x16x32_bf16 v[236:239], a[36:39], v[32:35], 0
v_exp_f32 v49, v49
v_mfma_f32_16x16x32_bf16 v[232:235], a[36:39], v[28:31], 0
s_waitcnt lgkmcnt(3)
v_add_f32 v11, v11, v47
v_mfma_f32_16x16x32_bf16 v[244:247], a[40:43], v[28:31], 0
ds_read_b128 a[28:31], v8 offset:704
v_add_f32 v12, v12, v48
v_mfma_f32_16x16x32_bf16 v[248:251], a[40:43], v[32:35], 0
v_exp_f32 v50, v50
v_mfma_f32_16x16x32_bf16 a[0:3], a[40:43], v[36:39], 0
v_exp_f32 v51, v51
v_mfma_f32_16x16x32_bf16 a[12:15], a[44:47], v[36:39], 0
ds_read_b128 a[32:35], v8 offset:768
buffer_load_dwordx4 v3, s[24:27], s50 offen offset:3168 nt lds
v_mfma_f32_16x16x32_bf16 a[8:11], a[44:47], v[32:35], 0
v_add_f32 v12, v12, v49
v_add_f32 v12, v12, v50
v_mfma_f32_16x16x32_bf16 a[4:7], a[44:47], v[28:31], 0
s_waitcnt lgkmcnt(3)
v_add_f32 v12, v12, v51
LS_17:
v_mfma_f32_16x16x32_bf16 v[52:55], a[16:19], a[48:51], v[16:19]
ds_read_b128 a[36:39], v8 offset:832
v_cvt_pk_bf16_f32 v30, v40, v41
v_mfma_f32_16x16x32_bf16 v[52:55], a[20:23], a[60:63], v[52:55]
v_exp_f32 v64, v64
v_mfma_f32_16x16x32_bf16 v[56:59], a[20:23], a[64:67], v[20:23]
v_exp_f32 v65, v65
v_mfma_f32_16x16x32_bf16 v[56:59], a[16:19], a[52:55], v[56:59]
ds_read_b128 a[40:43], v8 offset:896
v_cvt_pk_bf16_f32 v31, v42, v43
v_mfma_f32_16x16x32_bf16 v[60:63], a[16:19], a[56:59], v[24:27]
v_exp_f32 v66, v66
v_mfma_f32_16x16x32_bf16 v[60:63], a[20:23], a[68:71], v[60:63]
s_waitcnt lgkmcnt(3)
v_cvt_pk_bf16_f32 v34, v44, v45
v_mfma_f32_16x16x32_bf16 v[60:63], a[24:27], a[80:83], v[60:63]
ds_read_b128 a[44:47], v8 offset:960
v_cvt_pk_bf16_f32 v35, v46, v47
v_mfma_f32_16x16x32_bf16 v[60:63], a[28:31], a[92:95], v[60:63]
v_exp_f32 v67, v67
v_mfma_f32_16x16x32_bf16 v[56:59], a[28:31], a[88:91], v[56:59]
v_exp_f32 v68, v68
v_mfma_f32_16x16x32_bf16 v[56:59], a[24:27], a[76:79], v[56:59]
ds_read_b128 a[16:19], v8 offset:0
v_cvt_pk_bf16_f32 v38, v48, v49
v_mfma_f32_16x16x32_bf16 v[52:55], a[24:27], a[72:75], v[52:55]
v_exp_f32 v69, v69
v_mfma_f32_16x16x32_bf16 v[52:55], a[28:31], a[84:87], v[52:55]
s_waitcnt lgkmcnt(3)
v_cvt_pk_bf16_f32 v39, v50, v51
v_mfma_f32_16x16x32_bf16 v[52:55], a[32:35], a[96:99], v[52:55]
ds_read_b128 a[20:23], v8 offset:64
v_cvt_pk_bf16_f32 v28, v64, v65
v_mfma_f32_16x16x32_bf16 v[52:55], a[36:39], a[108:111], v[52:55]
v_exp_f32 v70, v70
v_mfma_f32_16x16x32_bf16 v[56:59], a[36:39], a[112:115], v[56:59]
v_exp_f32 v71, v71
v_mfma_f32_16x16x32_bf16 v[56:59], a[32:35], a[100:103], v[56:59]
ds_read_b128 a[24:27], v8 offset:128
v_cvt_pk_bf16_f32 v29, v66, v67
v_mfma_f32_16x16x32_bf16 v[60:63], a[32:35], a[104:107], v[60:63]
v_exp_f32 v72, v72
v_mfma_f32_16x16x32_bf16 v[60:63], a[36:39], a[116:119], v[60:63]
s_waitcnt lgkmcnt(3)
v_cvt_pk_bf16_f32 v32, v68, v69
v_mfma_f32_16x16x32_bf16 v[60:63], a[40:43], a[128:131], v[60:63]
ds_read_b128 a[28:31], v8 offset:192
v_cvt_pk_bf16_f32 v33, v70, v71
v_mfma_f32_16x16x32_bf16 v[60:63], a[44:47], a[140:143], v[60:63]
v_exp_f32 v73, v73
v_mfma_f32_16x16x32_bf16 v[56:59], a[44:47], a[136:139], v[56:59]
s_waitcnt vmcnt(24)
s_barrier
v_mfma_f32_16x16x32_bf16 v[56:59], a[40:43], a[124:127], v[56:59]
ds_read_b128 a[32:35], v8 offset:256
v_cvt_pk_bf16_f32 v36, v72, v73
v_mfma_f32_16x16x32_bf16 v[52:55], a[40:43], a[120:123], v[52:55]
s_add_u32 m0, s17, 135168
s_mov_b32 s50, 98304
v_mfma_f32_16x16x32_bf16 v[52:55], a[44:47], a[132:135], v[52:55]
s_waitcnt lgkmcnt(3)
v_add_f32 v10, v10, v64
v_mfma_f32_16x16x32_bf16 v[40:43], a[16:19], a[48:51], v[16:19]
ds_read_b128 a[36:39], v8 offset:320
v_add_f32 v10, v10, v65
v_mfma_f32_16x16x32_bf16 v[40:43], a[20:23], a[60:63], v[40:43]
buffer_load_dwordx4 v0, s[20:23], s50 offen offset:0 nt lds
v_mfma_f32_16x16x32_bf16 v[44:47], a[20:23], a[64:67], v[20:23]
v_exp_f32 v74, v74
v_mfma_f32_16x16x32_bf16 v[44:47], a[16:19], a[52:55], v[44:47]
ds_read_b128 a[40:43], v8 offset:384
v_max3_f32 v13, v52, v53, v54
v_mfma_f32_16x16x32_bf16 v[48:51], a[16:19], a[56:59], v[24:27]
buffer_load_dwordx4 v1, s[20:23], s50 offen offset:1056 nt lds
v_mfma_f32_16x16x32_bf16 v[48:51], a[20:23], a[68:71], v[48:51]
s_waitcnt lgkmcnt(3)
v_max3_f32 v13, v13, v55, v56
v_mfma_f32_16x16x32_bf16 v[48:51], a[24:27], a[80:83], v[48:51]
ds_read_b128 a[44:47], v8 offset:448
v_max3_f32 v13, v13, v57, v58
v_mfma_f32_16x16x32_bf16 v[48:51], a[28:31], a[92:95], v[48:51]
v_exp_f32 v75, v75
v_mfma_f32_16x16x32_bf16 v[44:47], a[28:31], a[88:91], v[44:47]
buffer_load_dwordx4 v2, s[20:23], s50 offen offset:2112 nt lds
v_mfma_f32_16x16x32_bf16 v[44:47], a[24:27], a[76:79], v[44:47]
ds_read_b64_tr_b16 a[16:17], v9 offset:33792
v_cvt_pk_bf16_f32 v37, v74, v75
v_mfma_f32_16x16x32_bf16 v[40:43], a[24:27], a[72:75], v[40:43]
ds_read_b64_tr_b16 a[18:19], v9 offset:34304
v_max3_f32 v13, v13, v59, v60
v_mfma_f32_16x16x32_bf16 v[40:43], a[28:31], a[84:87], v[40:43]
s_waitcnt lgkmcnt(4)
v_max3_f32 v13, v13, v61, v62
v_mfma_f32_16x16x32_bf16 v[40:43], a[32:35], a[96:99], v[40:43]
ds_read_b64_tr_b16 a[20:21], v9 offset:33824
v_add_f32 v10, v10, v66
v_mfma_f32_16x16x32_bf16 v[40:43], a[36:39], a[108:111], v[40:43]
ds_read_b64_tr_b16 a[22:23], v9 offset:34336
v_add_f32 v10, v10, v67
v_mfma_f32_16x16x32_bf16 v[44:47], a[36:39], a[112:115], v[44:47]
buffer_load_dwordx4 v3, s[20:23], s50 offen offset:3168 nt lds
v_mfma_f32_16x16x32_bf16 v[44:47], a[32:35], a[100:103], v[44:47]
ds_read_b64_tr_b16 a[24:25], v9 offset:33856
v_add_f32 v11, v11, v68
v_mfma_f32_16x16x32_bf16 v[48:51], a[32:35], a[104:107], v[48:51]
ds_read_b64_tr_b16 a[26:27], v9 offset:34368
v_add_f32 v11, v11, v69
v_mfma_f32_16x16x32_bf16 v[48:51], a[36:39], a[116:119], v[48:51]
s_waitcnt lgkmcnt(6)
v_add_f32 v11, v11, v70
v_mfma_f32_16x16x32_bf16 v[48:51], a[40:43], a[128:131], v[48:51]
ds_read_b64_tr_b16 a[28:29], v9 offset:33888
v_add_f32 v11, v11, v71
v_mfma_f32_16x16x32_bf16 v[48:51], a[44:47], a[140:143], v[48:51]
ds_read_b64_tr_b16 a[30:31], v9 offset:34400
v_add_f32 v12, v12, v72
v_mfma_f32_16x16x32_bf16 v[44:47], a[44:47], a[136:139], v[44:47]
v_add_f32 v12, v12, v73
v_add_f32 v12, v12, v74
v_mfma_f32_16x16x32_bf16 v[44:47], a[40:43], a[124:127], v[44:47]
ds_read_b64_tr_b16 a[32:33], v9 offset:33920
v_add_f32 v12, v12, v75
v_mfma_f32_16x16x32_bf16 v[40:43], a[40:43], a[120:123], v[40:43]
ds_read_b64_tr_b16 a[34:35], v9 offset:34432
v_max_f32 v13, v13, v63
v_mfma_f32_16x16x32_bf16 v[40:43], a[44:47], a[132:135], v[40:43]
s_waitcnt lgkmcnt(6)
LS_18:
v_mfma_f32_16x16x32_bf16 v[76:79], a[16:19], v[28:31], v[76:79]
ds_read_b64_tr_b16 a[36:37], v9 offset:33952
v_mfma_f32_16x16x32_bf16 v[80:83], a[16:19], v[32:35], v[80:83]
ds_read_b64_tr_b16 a[38:39], v9 offset:34464
v_mfma_f32_16x16x32_bf16 v[84:87], a[16:19], v[36:39], v[84:87]
v_mfma_f32_16x16x32_bf16 v[96:99], a[20:23], v[36:39], v[96:99]
ds_read_b64_tr_b16 a[40:41], v9 offset:33984
v_max3_f32 v13, v13, v40, v41
v_mfma_f32_16x16x32_bf16 v[92:95], a[20:23], v[32:35], v[92:95]
ds_read_b64_tr_b16 a[42:43], v9 offset:34496
v_max3_f32 v13, v13, v42, v43
v_mfma_f32_16x16x32_bf16 v[88:91], a[20:23], v[28:31], v[88:91]
s_waitcnt lgkmcnt(6)
v_max3_f32 v13, v13, v44, v45
v_mfma_f32_16x16x32_bf16 v[100:103], a[24:27], v[28:31], v[100:103]
ds_read_b64_tr_b16 a[44:45], v9 offset:34016
v_max3_f32 v13, v13, v46, v47
v_mfma_f32_16x16x32_bf16 v[104:107], a[24:27], v[32:35], v[104:107]
ds_read_b64_tr_b16 a[46:47], v9 offset:34528
v_max3_f32 v13, v13, v48, v49
v_mfma_f32_16x16x32_bf16 v[108:111], a[24:27], v[36:39], v[108:111]
v_max3_f32 v13, v13, v50, v51
v_mfma_f32_16x16x32_bf16 v[120:123], a[28:31], v[36:39], v[120:123]
ds_read_b64_tr_b16 a[16:17], v9 offset:34048
v_cmp_lt_f32 vcc, s47, v13
v_mfma_f32_16x16x32_bf16 v[116:119], a[28:31], v[32:35], v[116:119]
ds_read_b64_tr_b16 a[18:19], v9 offset:34560
v_mfma_f32_16x16x32_bf16 v[112:115], a[28:31], v[28:31], v[112:115]
s_waitcnt lgkmcnt(6)
s_cbranch_vccnz RARE_h0j1
RET_h0j1:
v_mfma_f32_16x16x32_bf16 v[124:127], a[32:35], v[28:31], v[124:127]
ds_read_b64_tr_b16 a[20:21], v9 offset:34080
ds_read_b64_tr_b16 a[22:23], v9 offset:34592
v_mfma_f32_16x16x32_bf16 v[128:131], a[32:35], v[32:35], v[128:131]
v_exp_f32 v40, v40
v_mfma_f32_16x16x32_bf16 v[132:135], a[32:35], v[36:39], v[132:135]
v_exp_f32 v41, v41
v_mfma_f32_16x16x32_bf16 v[144:147], a[36:39], v[36:39], v[144:147]
ds_read_b64_tr_b16 a[24:25], v9 offset:34112
ds_read_b64_tr_b16 a[26:27], v9 offset:34624
v_mfma_f32_16x16x32_bf16 v[140:143], a[36:39], v[32:35], v[140:143]
v_exp_f32 v42, v42
v_mfma_f32_16x16x32_bf16 v[136:139], a[36:39], v[28:31], v[136:139]
s_waitcnt lgkmcnt(6)
v_add_f32 v10, v10, v40
v_mfma_f32_16x16x32_bf16 v[148:151], a[40:43], v[28:31], v[148:151]
ds_read_b64_tr_b16 a[28:29], v9 offset:34144
ds_read_b64_tr_b16 a[30:31], v9 offset:34656
v_mfma_f32_16x16x32_bf16 v[152:155], a[40:43], v[32:35], v[152:155]
v_exp_f32 v43, v43
v_mfma_f32_16x16x32_bf16 v[156:159], a[40:43], v[36:39], v[156:159]
s_waitcnt vmcnt(24)
s_barrier
v_mfma_f32_16x16x32_bf16 v[168:171], a[44:47], v[36:39], v[168:171]
ds_read_b64_tr_b16 a[32:33], v9 offset:34176
ds_read_b64_tr_b16 a[34:35], v9 offset:34688
v_mfma_f32_16x16x32_bf16 v[164:167], a[44:47], v[32:35], v[164:167]
s_add_u32 m0, s17, 0
s_mov_b32 s50, 81920
v_mfma_f32_16x16x32_bf16 v[160:163], a[44:47], v[28:31], v[160:163]
s_waitcnt lgkmcnt(6)
v_add_f32 v10, v10, v41
v_mfma_f32_16x16x32_bf16 v[172:175], a[16:19], v[28:31], v[172:175]
ds_read_b64_tr_b16 a[36:37], v9 offset:34208
ds_read_b64_tr_b16 a[38:39], v9 offset:34720
v_mfma_f32_16x16x32_bf16 v[176:179], a[16:19], v[32:35], v[176:179]
buffer_load_dwordx4 v0, s[24:27], s50 offen offset:0 nt lds
v_mfma_f32_16x16x32_bf16 v[180:183], a[16:19], v[36:39], v[180:183]
v_exp_f32 v44, v44
v_mfma_f32_16x16x32_bf16 v[192:195], a[20:23], v[36:39], v[192:195]
ds_read_b64_tr_b16 a[40:41], v9 offset:34240
ds_read_b64_tr_b16 a[42:43], v9 offset:34752
v_mfma_f32_16x16x32_bf16 v[188:191], a[20:23], v[32:35], v[188:191]
buffer_load_dwordx4 v1, s[24:27], s50 offen offset:1056 nt lds
v_mfma_f32_16x16x32_bf16 v[184:187], a[20:23], v[28:31], v[184:187]
s_waitcnt lgkmcnt(6)
v_add_f32 v10, v10, v42
v_mfma_f32_16x16x32_bf16 v[196:199], a[24:27], v[28:31], v[196:199]
ds_read_b64_tr_b16 a[44:45], v9 offset:34272
ds_read_b64_tr_b16 a[46:47], v9 offset:34784
v_mfma_f32_16x16x32_bf16 v[200:203], a[24:27], v[32:35], v[200:203]
buffer_load_dwordx4 v2, s[24:27], s50 offen offset:2112 nt lds
v_mfma_f32_16x16x32_bf16 v[204:207], a[24:27], v[36:39], v[204:207]
v_exp_f32 v45, v45
v_mfma_f32_16x16x32_bf16 v[216:219], a[28:31], v[36:39], v[216:219]
ds_read_b128 a[16:19], v8 offset:33792
v_add_f32 v10, v10, v43
v_mfma_f32_16x16x32_bf16 v[212:215], a[28:31], v[32:35], v[212:215]
v_exp_f32 v46, v46
v_mfma_f32_16x16x32_bf16 v[208:211], a[28:31], v[28:31], v[208:211]
s_waitcnt lgkmcnt(5)
v_add_f32 v11, v11, v44
v_mfma_f32_16x16x32_bf16 v[220:223], a[32:35], v[28:31], v[220:223]
ds_read_b128 a[20:23], v8 offset:33856
v_add_f32 v11, v11, v45
v_mfma_f32_16x16x32_bf16 v[224:227], a[32:35], v[32:35], v[224:227]
v_exp_f32 v47, v47
v_mfma_f32_16x16x32_bf16 v[228:231], a[32:35], v[36:39], v[228:231]
v_exp_f32 v48, v48
v_mfma_f32_16x16x32_bf16 v[240:243], a[36:39], v[36:39], v[240:243]
ds_read_b128 a[24:27], v8 offset:33920
v_add_f32 v11, v11, v46
v_mfma_f32_16x16x32_bf16 v[236:239], a[36:39], v[32:35], v[236:239]
v_exp_f32 v49, v49
v_mfma_f32_16x16x32_bf16 v[232:235], a[36:39], v[28:31], v[232:235]
s_waitcnt lgkmcnt(3)
v_add_f32 v11, v11, v47
v_mfma_f32_16x16x32_bf16 v[244:247], a[40:43], v[28:31], v[244:247]
ds_read_b128 a[28:31], v8 offset:33984
v_add_f32 v12, v12, v48
v_mfma_f32_16x16x32_bf16 v[248:251], a[40:43], v[32:35], v[248:251]
v_exp_f32 v50, v50
v_mfma_f32_16x16x32_bf16 a[0:3], a[40:43], v[36:39], a[0:3]
v_exp_f32 v51, v51
v_mfma_f32_16x16x32_bf16 a[12:15], a[44:47], v[36:39], a[12:15]
ds_read_b128 a[32:35], v8 offset:34048
buffer_load_dwordx4 v3, s[24:27], s50 offen offset:3168 nt lds
v_mfma_f32_16x16x32_bf16 a[8:11], a[44:47], v[32:35], a[8:11]
v_add_f32 v12, v12, v49
v_add_f32 v12, v12, v50
v_mfma_f32_16x16x32_bf16 a[4:7], a[44:47], v[28:31], a[4:7]
s_waitcnt lgkmcnt(3)
v_add_f32 v12, v12, v51
LS_19:
v_mfma_f32_16x16x32_bf16 v[64:67], a[16:19], a[48:51], v[16:19]
ds_read_b128 a[36:39], v8 offset:34112
v_cvt_pk_bf16_f32 v28, v40, v41
v_mfma_f32_16x16x32_bf16 v[64:67], a[20:23], a[60:63], v[64:67]
v_exp_f32 v52, v52
v_mfma_f32_16x16x32_bf16 v[68:71], a[20:23], a[64:67], v[20:23]
v_exp_f32 v53, v53
v_mfma_f32_16x16x32_bf16 v[68:71], a[16:19], a[52:55], v[68:71]
ds_read_b128 a[40:43], v8 offset:34176
v_cvt_pk_bf16_f32 v29, v42, v43
v_mfma_f32_16x16x32_bf16 v[72:75], a[16:19], a[56:59], v[24:27]
v_exp_f32 v54, v54
v_mfma_f32_16x16x32_bf16 v[72:75], a[20:23], a[68:71], v[72:75]
s_waitcnt lgkmcnt(3)
v_cvt_pk_bf16_f32 v32, v44, v45
v_mfma_f32_16x16x32_bf16 v[72:75], a[24:27], a[80:83], v[72:75]
ds_read_b128 a[44:47], v8 offset:34240
v_cvt_pk_bf16_f32 v33, v46, v47
v_mfma_f32_16x16x32_bf16 v[72:75], a[28:31], a[92:95], v[72:75]
v_exp_f32 v55, v55
v_mfma_f32_16x16x32_bf16 v[68:71], a[28:31], a[88:91], v[68:71]
v_exp_f32 v56, v56
v_mfma_f32_16x16x32_bf16 v[68:71], a[24:27], a[76:79], v[68:71]
ds_read_b128 a[16:19], v8 offset:34304
v_cvt_pk_bf16_f32 v36, v48, v49
v_mfma_f32_16x16x32_bf16 v[64:67], a[24:27], a[72:75], v[64:67]
v_exp_f32 v57, v57
v_mfma_f32_16x16x32_bf16 v[64:67], a[28:31], a[84:87], v[64:67]
s_waitcnt lgkmcnt(3)
v_cvt_pk_bf16_f32 v37, v50, v51
v_mfma_f32_16x16x32_bf16 v[64:67], a[32:35], a[96:99], v[64:67]
ds_read_b128 a[20:23], v8 offset:34368
v_cvt_pk_bf16_f32 v30, v52, v53
v_mfma_f32_16x16x32_bf16 v[64:67], a[36:39], a[108:111], v[64:67]
v_exp_f32 v58, v58
v_mfma_f32_16x16x32_bf16 v[68:71], a[36:39], a[112:115], v[68:71]
v_exp_f32 v59, v59
v_mfma_f32_16x16x32_bf16 v[68:71], a[32:35], a[100:103], v[68:71]
ds_read_b128 a[24:27], v8 offset:34432
v_cvt_pk_bf16_f32 v31, v54, v55
v_mfma_f32_16x16x32_bf16 v[72:75], a[32:35], a[104:107], v[72:75]
v_exp_f32 v60, v60
v_mfma_f32_16x16x32_bf16 v[72:75], a[36:39], a[116:119], v[72:75]
s_waitcnt lgkmcnt(3)
v_cvt_pk_bf16_f32 v34, v56, v57
v_mfma_f32_16x16x32_bf16 v[72:75], a[40:43], a[128:131], v[72:75]
ds_read_b128 a[28:31], v8 offset:34496
v_cvt_pk_bf16_f32 v35, v58, v59
v_mfma_f32_16x16x32_bf16 v[72:75], a[44:47], a[140:143], v[72:75]
v_exp_f32 v61, v61
v_mfma_f32_16x16x32_bf16 v[68:71], a[44:47], a[136:139], v[68:71]
s_waitcnt vmcnt(24)
s_barrier
v_mfma_f32_16x16x32_bf16 v[68:71], a[40:43], a[124:127], v[68:71]
ds_read_b128 a[32:35], v8 offset:34560
v_cvt_pk_bf16_f32 v38, v60, v61
v_mfma_f32_16x16x32_bf16 v[64:67], a[40:43], a[120:123], v[64:67]
s_add_u32 m0, s17, 118272
s_mov_b32 s50, 114688
v_mfma_f32_16x16x32_bf16 v[64:67], a[44:47], a[132:135], v[64:67]
s_waitcnt lgkmcnt(3)
v_add_f32 v10, v10, v52
v_mfma_f32_16x16x32_bf16 v[40:43], a[16:19], a[48:51], v[16:19]
ds_read_b128 a[36:39], v8 offset:34624
v_add_f32 v10, v10, v53
v_mfma_f32_16x16x32_bf16 v[40:43], a[20:23], a[60:63], v[40:43]
buffer_load_dwordx4 v0, s[20:23], s50 offen offset:0 nt lds
v_mfma_f32_16x16x32_bf16 v[44:47], a[20:23], a[64:67], v[20:23]
v_exp_f32 v62, v62
v_mfma_f32_16x16x32_bf16 v[44:47], a[16:19], a[52:55], v[44:47]
ds_read_b128 a[40:43], v8 offset:34688
v_max3_f32 v13, v64, v65, v66
v_mfma_f32_16x16x32_bf16 v[48:51], a[16:19], a[56:59], v[24:27]
buffer_load_dwordx4 v1, s[20:23], s50 offen offset:1056 nt lds
v_mfma_f32_16x16x32_bf16 v[48:51], a[20:23], a[68:71], v[48:51]
s_waitcnt lgkmcnt(3)
v_max3_f32 v13, v13, v67, v68
v_mfma_f32_16x16x32_bf16 v[48:51], a[24:27], a[80:83], v[48:51]
ds_read_b128 a[44:47], v8 offset:34752
v_max3_f32 v13, v13, v69, v70
v_mfma_f32_16x16x32_bf16 v[48:51], a[28:31], a[92:95], v[48:51]
v_exp_f32 v63, v63
v_mfma_f32_16x16x32_bf16 v[44:47], a[28:31], a[88:91], v[44:47]
buffer_load_dwordx4 v2, s[20:23], s50 offen offset:2112 nt lds
v_mfma_f32_16x16x32_bf16 v[44:47], a[24:27], a[76:79], v[44:47]
v_subrev_u32 v9, 50688, v9
ds_read_b64_tr_b16 a[16:17], v9 offset:33792
v_mfma_f32_16x16x32_bf16 v[40:43], a[24:27], a[72:75], v[40:43]
ds_read_b64_tr_b16 a[18:19], v9 offset:34304
v_cvt_pk_bf16_f32 v39, v62, v63
v_mfma_f32_16x16x32_bf16 v[40:43], a[28:31], a[84:87], v[40:43]
s_waitcnt lgkmcnt(4)
v_max3_f32 v13, v13, v71, v72
v_mfma_f32_16x16x32_bf16 v[40:43], a[32:35], a[96:99], v[40:43]
ds_read_b64_tr_b16 a[20:21], v9 offset:33824
v_max3_f32 v13, v13, v73, v74
v_mfma_f32_16x16x32_bf16 v[40:43], a[36:39], a[108:111], v[40:43]
ds_read_b64_tr_b16 a[22:23], v9 offset:34336
v_add_f32 v10, v10, v54
v_mfma_f32_16x16x32_bf16 v[44:47], a[36:39], a[112:115], v[44:47]
buffer_load_dwordx4 v3, s[20:23], s50 offen offset:3168 nt lds
v_mfma_f32_16x16x32_bf16 v[44:47], a[32:35], a[100:103], v[44:47]
ds_read_b64_tr_b16 a[24:25], v9 offset:33856
v_add_f32 v10, v10, v55
v_mfma_f32_16x16x32_bf16 v[48:51], a[32:35], a[104:107], v[48:51]
ds_read_b64_tr_b16 a[26:27], v9 offset:34368
v_add_f32 v11, v11, v56
v_mfma_f32_16x16x32_bf16 v[48:51], a[36:39], a[116:119], v[48:51]
s_waitcnt lgkmcnt(6)
v_add_f32 v11, v11, v57
v_mfma_f32_16x16x32_bf16 v[48:51], a[40:43], a[128:131], v[48:51]
ds_read_b64_tr_b16 a[28:29], v9 offset:33888
v_add_f32 v11, v11, v58
v_mfma_f32_16x16x32_bf16 v[48:51], a[44:47], a[140:143], v[48:51]
ds_read_b64_tr_b16 a[30:31], v9 offset:34400
v_add_f32 v11, v11, v59
v_mfma_f32_16x16x32_bf16 v[44:47], a[44:47], a[136:139], v[44:47]
v_add_f32 v12, v12, v60
v_add_f32 v12, v12, v61
v_mfma_f32_16x16x32_bf16 v[44:47], a[40:43], a[124:127], v[44:47]
ds_read_b64_tr_b16 a[32:33], v9 offset:33920
v_add_f32 v12, v12, v62
v_mfma_f32_16x16x32_bf16 v[40:43], a[40:43], a[120:123], v[40:43]
ds_read_b64_tr_b16 a[34:35], v9 offset:34432
v_add_f32 v12, v12, v63
v_mfma_f32_16x16x32_bf16 v[40:43], a[44:47], a[132:135], v[40:43]
s_waitcnt lgkmcnt(6)
v_max_f32 v13, v13, v75
LS_20:
v_mfma_f32_16x16x32_bf16 v[76:79], a[16:19], v[28:31], v[76:79]
ds_read_b64_tr_b16 a[36:37], v9 offset:33952
v_mfma_f32_16x16x32_bf16 v[80:83], a[16:19], v[32:35], v[80:83]
ds_read_b64_tr_b16 a[38:39], v9 offset:34464
v_mfma_f32_16x16x32_bf16 v[84:87], a[16:19], v[36:39], v[84:87]
v_mfma_f32_16x16x32_bf16 v[96:99], a[20:23], v[36:39], v[96:99]
ds_read_b64_tr_b16 a[40:41], v9 offset:33984
v_max3_f32 v13, v13, v40, v41
v_mfma_f32_16x16x32_bf16 v[92:95], a[20:23], v[32:35], v[92:95]
ds_read_b64_tr_b16 a[42:43], v9 offset:34496
v_max3_f32 v13, v13, v42, v43
v_mfma_f32_16x16x32_bf16 v[88:91], a[20:23], v[28:31], v[88:91]
s_waitcnt lgkmcnt(6)
v_max3_f32 v13, v13, v44, v45
v_mfma_f32_16x16x32_bf16 v[100:103], a[24:27], v[28:31], v[100:103]
ds_read_b64_tr_b16 a[44:45], v9 offset:34016
v_max3_f32 v13, v13, v46, v47
v_mfma_f32_16x16x32_bf16 v[104:107], a[24:27], v[32:35], v[104:107]
ds_read_b64_tr_b16 a[46:47], v9 offset:34528
v_max3_f32 v13, v13, v48, v49
v_mfma_f32_16x16x32_bf16 v[108:111], a[24:27], v[36:39], v[108:111]
v_max3_f32 v13, v13, v50, v51
v_mfma_f32_16x16x32_bf16 v[120:123], a[28:31], v[36:39], v[120:123]
ds_read_b64_tr_b16 a[16:17], v9 offset:34048
v_cmp_lt_f32 vcc, s47, v13
v_mfma_f32_16x16x32_bf16 v[116:119], a[28:31], v[32:35], v[116:119]
ds_read_b64_tr_b16 a[18:19], v9 offset:34560
v_mfma_f32_16x16x32_bf16 v[112:115], a[28:31], v[28:31], v[112:115]
s_waitcnt lgkmcnt(6)
s_cbranch_vccnz RARE_h0j2
RET_h0j2:
v_mfma_f32_16x16x32_bf16 v[124:127], a[32:35], v[28:31], v[124:127]
ds_read_b64_tr_b16 a[20:21], v9 offset:34080
ds_read_b64_tr_b16 a[22:23], v9 offset:34592
v_mfma_f32_16x16x32_bf16 v[128:131], a[32:35], v[32:35], v[128:131]
v_exp_f32 v40, v40
v_mfma_f32_16x16x32_bf16 v[132:135], a[32:35], v[36:39], v[132:135]
v_exp_f32 v41, v41
v_mfma_f32_16x16x32_bf16 v[144:147], a[36:39], v[36:39], v[144:147]
ds_read_b64_tr_b16 a[24:25], v9 offset:34112
ds_read_b64_tr_b16 a[26:27], v9 offset:34624
v_mfma_f32_16x16x32_bf16 v[140:143], a[36:39], v[32:35], v[140:143]
v_exp_f32 v42, v42
v_mfma_f32_16x16x32_bf16 v[136:139], a[36:39], v[28:31], v[136:139]
s_waitcnt lgkmcnt(6)
v_add_f32 v10, v10, v40
v_mfma_f32_16x16x32_bf16 v[148:151], a[40:43], v[28:31], v[148:151]
ds_read_b64_tr_b16 a[28:29], v9 offset:34144
ds_read_b64_tr_b16 a[30:31], v9 offset:34656
v_mfma_f32_16x16x32_bf16 v[152:155], a[40:43], v[32:35], v[152:155]
v_exp_f32 v43, v43
v_mfma_f32_16x16x32_bf16 v[156:159], a[40:43], v[36:39], v[156:159]
s_waitcnt vmcnt(24)
s_barrier
v_mfma_f32_16x16x32_bf16 v[168:171], a[44:47], v[36:39], v[168:171]
ds_read_b64_tr_b16 a[32:33], v9 offset:34176
ds_read_b64_tr_b16 a[34:35], v9 offset:34688
v_mfma_f32_16x16x32_bf16 v[164:167], a[44:47], v[32:35], v[164:167]
s_add_u32 m0, s17, 33792
s_mov_b32 s50, 98304
v_mfma_f32_16x16x32_bf16 v[160:163], a[44:47], v[28:31], v[160:163]
s_waitcnt lgkmcnt(6)
v_add_f32 v10, v10, v41
v_mfma_f32_16x16x32_bf16 v[172:175], a[16:19], v[28:31], v[172:175]
ds_read_b64_tr_b16 a[36:37], v9 offset:34208
ds_read_b64_tr_b16 a[38:39], v9 offset:34720
v_mfma_f32_16x16x32_bf16 v[176:179], a[16:19], v[32:35], v[176:179]
buffer_load_dwordx4 v0, s[24:27], s50 offen offset:0 nt lds
v_mfma_f32_16x16x32_bf16 v[180:183], a[16:19], v[36:39], v[180:183]
v_exp_f32 v44, v44
v_mfma_f32_16x16x32_bf16 v[192:195], a[20:23], v[36:39], v[192:195]
ds_read_b64_tr_b16 a[40:41], v9 offset:34240
ds_read_b64_tr_b16 a[42:43], v9 offset:34752
v_mfma_f32_16x16x32_bf16 v[188:191], a[20:23], v[32:35], v[188:191]
buffer_load_dwordx4 v1, s[24:27], s50 offen offset:1056 nt lds
v_mfma_f32_16x16x32_bf16 v[184:187], a[20:23], v[28:31], v[184:187]
s_waitcnt lgkmcnt(6)
v_add_f32 v10, v10, v42
v_mfma_f32_16x16x32_bf16 v[196:199], a[24:27], v[28:31], v[196:199]
ds_read_b64_tr_b16 a[44:45], v9 offset:34272
ds_read_b64_tr_b16 a[46:47], v9 offset:34784
v_mfma_f32_16x16x32_bf16 v[200:203], a[24:27], v[32:35], v[200:203]
buffer_load_dwordx4 v2, s[24:27], s50 offen offset:2112 nt lds
v_mfma_f32_16x16x32_bf16 v[204:207], a[24:27], v[36:39], v[204:207]
v_exp_f32 v45, v45
v_mfma_f32_16x16x32_bf16 v[216:219], a[28:31], v[36:39], v[216:219]
v_add_u32 v8, 84480, v8
ds_read_b128 a[16:19], v8 offset:512
v_mfma_f32_16x16x32_bf16 v[212:215], a[28:31], v[32:35], v[212:215]
v_exp_f32 v46, v46
v_mfma_f32_16x16x32_bf16 v[208:211], a[28:31], v[28:31], v[208:211]
s_waitcnt lgkmcnt(5)
v_add_f32 v10, v10, v43
v_mfma_f32_16x16x32_bf16 v[220:223], a[32:35], v[28:31], v[220:223]
ds_read_b128 a[20:23], v8 offset:576
v_add_f32 v11, v11, v44
v_mfma_f32_16x16x32_bf16 v[224:227], a[32:35], v[32:35], v[224:227]
v_exp_f32 v47, v47
v_mfma_f32_16x16x32_bf16 v[228:231], a[32:35], v[36:39], v[228:231]
v_exp_f32 v48, v48
v_mfma_f32_16x16x32_bf16 v[240:243], a[36:39], v[36:39], v[240:243]
ds_read_b128 a[24:27], v8 offset:640
v_add_f32 v11, v11, v45
v_mfma_f32_16x16x32_bf16 v[236:239], a[36:39], v[32:35], v[236:239]
v_exp_f32 v49, v49
v_mfma_f32_16x16x32_bf16 v[232:235], a[36:39], v[28:31], v[232:235]
s_waitcnt lgkmcnt(3)
v_add_f32 v11, v11, v46
v_mfma_f32_16x16x32_bf16 v[244:247], a[40:43], v[28:31], v[244:247]
ds_read_b128 a[28:31], v8 offset:704
v_exp_f32 v50, v50
v_mfma_f32_16x16x32_bf16 v[248:251], a[40:43], v[32:35], v[248:251]
v_exp_f32 v51, v51
v_mfma_f32_16x16x32_bf16 a[0:3], a[40:43], v[36:39], a[0:3]
buffer_load_dwordx4 v3, s[24:27], s50 offen offset:3168 nt lds
v_mfma_f32_16x16x32_bf16 a[12:15], a[44:47], v[36:39], a[12:15]
ds_read_b128 a[32:35], v8 offset:768
v_add_f32 v11, v11, v47
v_add_f32 v12, v12, v48
v_mfma_f32_16x16x32_bf16 a[8:11], a[44:47], v[32:35], a[8:11]
v_add_f32 v12, v12, v49
v_add_f32 v12, v12, v50
v_mfma_f32_16x16x32_bf16 a[4:7], a[44:47], v[28:31], a[4:7]
s_waitcnt lgkmcnt(3)
v_add_f32 v12, v12, v51
LS_21:
v_mfma_f32_16x16x32_bf16 v[52:55], a[16:19], a[48:51], v[16:19]
ds_read_b128 a[36:39], v8 offset:832
v_cvt_pk_bf16_f32 v30, v40, v41
v_mfma_f32_16x16x32_bf16 v[52:55], a[20:23], a[60:63], v[52:55]
v_exp_f32 v64, v64
v_mfma_f32_16x16x32_bf16 v[56:59], a[20:23], a[64:67], v[20:23]
v_exp_f32 v65, v65
v_mfma_f32_16x16x32_bf16 v[56:59], a[16:19], a[52:55], v[56:59]
ds_read_b128 a[40:43], v8 offset:896
v_cvt_pk_bf16_f32 v31, v42, v43
v_mfma_f32_16x16x32_bf16 v[60:63], a[16:19], a[56:59], v[24:27]
v_exp_f32 v66, v66
v_mfma_f32_16x16x32_bf16 v[60:63], a[20:23], a[68:71], v[60:63]
s_waitcnt lgkmcnt(3)
v_cvt_pk_bf16_f32 v34, v44, v45
v_mfma_f32_16x16x32_bf16 v[60:63], a[24:27], a[80:83], v[60:63]
ds_read_b128 a[44:47], v8 offset:960
v_cvt_pk_bf16_f32 v35, v46, v47
v_mfma_f32_16x16x32_bf16 v[60:63], a[28:31], a[92:95], v[60:63]
v_exp_f32 v67, v67
v_mfma_f32_16x16x32_bf16 v[56:59], a[28:31], a[88:91], v[56:59]
v_exp_f32 v68, v68
v_mfma_f32_16x16x32_bf16 v[56:59], a[24:27], a[76:79], v[56:59]
ds_read_b128 a[16:19], v8 offset:0
v_cvt_pk_bf16_f32 v38, v48, v49
v_mfma_f32_16x16x32_bf16 v[52:55], a[24:27], a[72:75], v[52:55]
v_exp_f32 v69, v69
v_mfma_f32_16x16x32_bf16 v[52:55], a[28:31], a[84:87], v[52:55]
s_waitcnt lgkmcnt(3)
v_cvt_pk_bf16_f32 v39, v50, v51
v_mfma_f32_16x16x32_bf16 v[52:55], a[32:35], a[96:99], v[52:55]
ds_read_b128 a[20:23], v8 offset:64
v_cvt_pk_bf16_f32 v28, v64, v65
v_mfma_f32_16x16x32_bf16 v[52:55], a[36:39], a[108:111], v[52:55]
v_exp_f32 v70, v70
v_mfma_f32_16x16x32_bf16 v[56:59], a[36:39], a[112:115], v[56:59]
v_exp_f32 v71, v71
v_mfma_f32_16x16x32_bf16 v[56:59], a[32:35], a[100:103], v[56:59]
ds_read_b128 a[24:27], v8 offset:128
v_cvt_pk_bf16_f32 v29, v66, v67
v_mfma_f32_16x16x32_bf16 v[60:63], a[32:35], a[104:107], v[60:63]
v_exp_f32 v72, v72
v_mfma_f32_16x16x32_bf16 v[60:63], a[36:39], a[116:119], v[60:63]
s_waitcnt lgkmcnt(3)
v_cvt_pk_bf16_f32 v32, v68, v69
v_mfma_f32_16x16x32_bf16 v[60:63], a[40:43], a[128:131], v[60:63]
ds_read_b128 a[28:31], v8 offset:192
v_cvt_pk_bf16_f32 v33, v70, v71
v_mfma_f32_16x16x32_bf16 v[60:63], a[44:47], a[140:143], v[60:63]
v_exp_f32 v73, v73
v_mfma_f32_16x16x32_bf16 v[56:59], a[44:47], a[136:139], v[56:59]
s_waitcnt vmcnt(24)
s_barrier
v_mfma_f32_16x16x32_bf16 v[56:59], a[40:43], a[124:127], v[56:59]
ds_read_b128 a[32:35], v8 offset:256
v_cvt_pk_bf16_f32 v36, v72, v73
v_mfma_f32_16x16x32_bf16 v[52:55], a[40:43], a[120:123], v[52:55]
s_add_u32 m0, s17, 67584
s_mov_b32 s50, 131072
v_mfma_f32_16x16x32_bf16 v[52:55], a[44:47], a[132:135], v[52:55]
s_waitcnt lgkmcnt(3)
v_add_f32 v10, v10, v64
v_mfma_f32_16x16x32_bf16 v[40:43], a[16:19], a[48:51], v[16:19]
ds_read_b128 a[36:39], v8 offset:320
v_add_f32 v10, v10, v65
v_mfma_f32_16x16x32_bf16 v[40:43], a[20:23], a[60:63], v[40:43]
buffer_load_dwordx4 v0, s[20:23], s50 offen offset:0 nt lds
v_mfma_f32_16x16x32_bf16 v[44:47], a[20:23], a[64:67], v[20:23]
v_exp_f32 v74, v74
v_mfma_f32_16x16x32_bf16 v[44:47], a[16:19], a[52:55], v[44:47]
ds_read_b128 a[40:43], v8 offset:384
v_max3_f32 v13, v52, v53, v54
v_mfma_f32_16x16x32_bf16 v[48:51], a[16:19], a[56:59], v[24:27]
buffer_load_dwordx4 v1, s[20:23], s50 offen offset:1056 nt lds
v_mfma_f32_16x16x32_bf16 v[48:51], a[20:23], a[68:71], v[48:51]
s_waitcnt lgkmcnt(3)
v_max3_f32 v13, v13, v55, v56
v_mfma_f32_16x16x32_bf16 v[48:51], a[24:27], a[80:83], v[48:51]
ds_read_b128 a[44:47], v8 offset:448
v_max3_f32 v13, v13, v57, v58
v_mfma_f32_16x16x32_bf16 v[48:51], a[28:31], a[92:95], v[48:51]
v_exp_f32 v75, v75
v_mfma_f32_16x16x32_bf16 v[44:47], a[28:31], a[88:91], v[44:47]
buffer_load_dwordx4 v2, s[20:23], s50 offen offset:2112 nt lds
v_mfma_f32_16x16x32_bf16 v[44:47], a[24:27], a[76:79], v[44:47]
v_add_u32 v9, 50688, v9
ds_read_b64_tr_b16 a[16:17], v9 offset:16896
v_mfma_f32_16x16x32_bf16 v[40:43], a[24:27], a[72:75], v[40:43]
ds_read_b64_tr_b16 a[18:19], v9 offset:17408
v_cvt_pk_bf16_f32 v37, v74, v75
v_mfma_f32_16x16x32_bf16 v[40:43], a[28:31], a[84:87], v[40:43]
s_waitcnt lgkmcnt(4)
v_max3_f32 v13, v13, v59, v60
v_mfma_f32_16x16x32_bf16 v[40:43], a[32:35], a[96:99], v[40:43]
ds_read_b64_tr_b16 a[20:21], v9 offset:16928
v_max3_f32 v13, v13, v61, v62
v_mfma_f32_16x16x32_bf16 v[40:43], a[36:39], a[108:111], v[40:43]
ds_read_b64_tr_b16 a[22:23], v9 offset:17440
v_add_f32 v10, v10, v66
v_mfma_f32_16x16x32_bf16 v[44:47], a[36:39], a[112:115], v[44:47]
buffer_load_dwordx4 v3, s[20:23], s50 offen offset:3168 nt lds
v_mfma_f32_16x16x32_bf16 v[44:47], a[32:35], a[100:103], v[44:47]
ds_read_b64_tr_b16 a[24:25], v9 offset:16960
v_add_f32 v10, v10, v67
v_mfma_f32_16x16x32_bf16 v[48:51], a[32:35], a[104:107], v[48:51]
ds_read_b64_tr_b16 a[26:27], v9 offset:17472
v_add_f32 v11, v11, v68
v_mfma_f32_16x16x32_bf16 v[48:51], a[36:39], a[116:119], v[48:51]
s_waitcnt lgkmcnt(6)
v_add_f32 v11, v11, v69
v_mfma_f32_16x16x32_bf16 v[48:51], a[40:43], a[128:131], v[48:51]
ds_read_b64_tr_b16 a[28:29], v9 offset:16992
v_add_f32 v11, v11, v70
v_mfma_f32_16x16x32_bf16 v[48:51], a[44:47], a[140:143], v[48:51]
ds_read_b64_tr_b16 a[30:31], v9 offset:17504
v_add_f32 v11, v11, v71
v_mfma_f32_16x16x32_bf16 v[44:47], a[44:47], a[136:139], v[44:47]
v_add_f32 v12, v12, v72
v_add_f32 v12, v12, v73
v_mfma_f32_16x16x32_bf16 v[44:47], a[40:43], a[124:127], v[44:47]
ds_read_b64_tr_b16 a[32:33], v9 offset:17024
v_add_f32 v12, v12, v74
v_mfma_f32_16x16x32_bf16 v[40:43], a[40:43], a[120:123], v[40:43]
ds_read_b64_tr_b16 a[34:35], v9 offset:17536
v_add_f32 v12, v12, v75
v_mfma_f32_16x16x32_bf16 v[40:43], a[44:47], a[132:135], v[40:43]
s_waitcnt lgkmcnt(6)
v_max_f32 v13, v13, v63
LS_22:
v_mfma_f32_16x16x32_bf16 v[76:79], a[16:19], v[28:31], v[76:79]
ds_read_b64_tr_b16 a[36:37], v9 offset:17056
v_mfma_f32_16x16x32_bf16 v[80:83], a[16:19], v[32:35], v[80:83]
ds_read_b64_tr_b16 a[38:39], v9 offset:17568
v_mfma_f32_16x16x32_bf16 v[84:87], a[16:19], v[36:39], v[84:87]
v_mfma_f32_16x16x32_bf16 v[96:99], a[20:23], v[36:39], v[96:99]
ds_read_b64_tr_b16 a[40:41], v9 offset:17088
v_max3_f32 v13, v13, v40, v41
v_mfma_f32_16x16x32_bf16 v[92:95], a[20:23], v[32:35], v[92:95]
ds_read_b64_tr_b16 a[42:43], v9 offset:17600
v_max3_f32 v13, v13, v42, v43
v_mfma_f32_16x16x32_bf16 v[88:91], a[20:23], v[28:31], v[88:91]
s_waitcnt lgkmcnt(6)
v_max3_f32 v13, v13, v44, v45
v_mfma_f32_16x16x32_bf16 v[100:103], a[24:27], v[28:31], v[100:103]
ds_read_b64_tr_b16 a[44:45], v9 offset:17120
v_max3_f32 v13, v13, v46, v47
v_mfma_f32_16x16x32_bf16 v[104:107], a[24:27], v[32:35], v[104:107]
ds_read_b64_tr_b16 a[46:47], v9 offset:17632
v_max3_f32 v13, v13, v48, v49
v_mfma_f32_16x16x32_bf16 v[108:111], a[24:27], v[36:39], v[108:111]
v_max3_f32 v13, v13, v50, v51
v_mfma_f32_16x16x32_bf16 v[120:123], a[28:31], v[36:39], v[120:123]
ds_read_b64_tr_b16 a[16:17], v9 offset:17152
v_cmp_lt_f32 vcc, s47, v13
v_mfma_f32_16x16x32_bf16 v[116:119], a[28:31], v[32:35], v[116:119]
ds_read_b64_tr_b16 a[18:19], v9 offset:17664
v_mfma_f32_16x16x32_bf16 v[112:115], a[28:31], v[28:31], v[112:115]
s_waitcnt lgkmcnt(6)
s_cbranch_vccnz RARE_h0j3
RET_h0j3:
v_mfma_f32_16x16x32_bf16 v[124:127], a[32:35], v[28:31], v[124:127]
ds_read_b64_tr_b16 a[20:21], v9 offset:17184
ds_read_b64_tr_b16 a[22:23], v9 offset:17696
v_mfma_f32_16x16x32_bf16 v[128:131], a[32:35], v[32:35], v[128:131]
v_exp_f32 v40, v40
v_mfma_f32_16x16x32_bf16 v[132:135], a[32:35], v[36:39], v[132:135]
v_exp_f32 v41, v41
v_mfma_f32_16x16x32_bf16 v[144:147], a[36:39], v[36:39], v[144:147]
ds_read_b64_tr_b16 a[24:25], v9 offset:17216
ds_read_b64_tr_b16 a[26:27], v9 offset:17728
v_mfma_f32_16x16x32_bf16 v[140:143], a[36:39], v[32:35], v[140:143]
v_exp_f32 v42, v42
v_mfma_f32_16x16x32_bf16 v[136:139], a[36:39], v[28:31], v[136:139]
s_waitcnt lgkmcnt(6)
v_add_f32 v10, v10, v40
v_mfma_f32_16x16x32_bf16 v[148:151], a[40:43], v[28:31], v[148:151]
ds_read_b64_tr_b16 a[28:29], v9 offset:17248
ds_read_b64_tr_b16 a[30:31], v9 offset:17760
v_mfma_f32_16x16x32_bf16 v[152:155], a[40:43], v[32:35], v[152:155]
v_exp_f32 v43, v43
v_mfma_f32_16x16x32_bf16 v[156:159], a[40:43], v[36:39], v[156:159]
s_waitcnt vmcnt(24)
s_barrier
v_mfma_f32_16x16x32_bf16 v[168:171], a[44:47], v[36:39], v[168:171]
ds_read_b64_tr_b16 a[32:33], v9 offset:17280
ds_read_b64_tr_b16 a[34:35], v9 offset:17792
v_mfma_f32_16x16x32_bf16 v[164:167], a[44:47], v[32:35], v[164:167]
s_add_u32 m0, s17, 84480
s_mov_b32 s50, 114688
v_mfma_f32_16x16x32_bf16 v[160:163], a[44:47], v[28:31], v[160:163]
s_waitcnt lgkmcnt(6)
v_add_f32 v10, v10, v41
v_mfma_f32_16x16x32_bf16 v[172:175], a[16:19], v[28:31], v[172:175]
ds_read_b64_tr_b16 a[36:37], v9 offset:17312
ds_read_b64_tr_b16 a[38:39], v9 offset:17824
v_mfma_f32_16x16x32_bf16 v[176:179], a[16:19], v[32:35], v[176:179]
buffer_load_dwordx4 v0, s[24:27], s50 offen offset:0 nt lds
v_mfma_f32_16x16x32_bf16 v[180:183], a[16:19], v[36:39], v[180:183]
v_exp_f32 v44, v44
v_mfma_f32_16x16x32_bf16 v[192:195], a[20:23], v[36:39], v[192:195]
ds_read_b64_tr_b16 a[40:41], v9 offset:17344
ds_read_b64_tr_b16 a[42:43], v9 offset:17856
v_mfma_f32_16x16x32_bf16 v[188:191], a[20:23], v[32:35], v[188:191]
buffer_load_dwordx4 v1, s[24:27], s50 offen offset:1056 nt lds
v_mfma_f32_16x16x32_bf16 v[184:187], a[20:23], v[28:31], v[184:187]
s_waitcnt lgkmcnt(6)
v_add_f32 v10, v10, v42
v_mfma_f32_16x16x32_bf16 v[196:199], a[24:27], v[28:31], v[196:199]
ds_read_b64_tr_b16 a[44:45], v9 offset:17376
ds_read_b64_tr_b16 a[46:47], v9 offset:17888
v_mfma_f32_16x16x32_bf16 v[200:203], a[24:27], v[32:35], v[200:203]
buffer_load_dwordx4 v2, s[24:27], s50 offen offset:2112 nt lds
v_mfma_f32_16x16x32_bf16 v[204:207], a[24:27], v[36:39], v[204:207]
v_exp_f32 v45, v45
v_mfma_f32_16x16x32_bf16 v[216:219], a[28:31], v[36:39], v[216:219]
v_subrev_u32 v8, 84480, v8
ds_read_b128 a[16:19], v8 offset:16896
v_mfma_f32_16x16x32_bf16 v[212:215], a[28:31], v[32:35], v[212:215]
v_exp_f32 v46, v46
v_mfma_f32_16x16x32_bf16 v[208:211], a[28:31], v[28:31], v[208:211]
s_waitcnt lgkmcnt(5)
v_add_f32 v10, v10, v43
v_mfma_f32_16x16x32_bf16 v[220:223], a[32:35], v[28:31], v[220:223]
ds_read_b128 a[20:23], v8 offset:16960
v_add_f32 v11, v11, v44
v_mfma_f32_16x16x32_bf16 v[224:227], a[32:35], v[32:35], v[224:227]
v_exp_f32 v47, v47
v_mfma_f32_16x16x32_bf16 v[228:231], a[32:35], v[36:39], v[228:231]
v_exp_f32 v48, v48
v_mfma_f32_16x16x32_bf16 v[240:243], a[36:39], v[36:39], v[240:243]
ds_read_b128 a[24:27], v8 offset:17024
v_add_f32 v11, v11, v45
v_mfma_f32_16x16x32_bf16 v[236:239], a[36:39], v[32:35], v[236:239]
v_exp_f32 v49, v49
v_mfma_f32_16x16x32_bf16 v[232:235], a[36:39], v[28:31], v[232:235]
s_waitcnt lgkmcnt(3)
v_add_f32 v11, v11, v46
v_mfma_f32_16x16x32_bf16 v[244:247], a[40:43], v[28:31], v[244:247]
ds_read_b128 a[28:31], v8 offset:17088
v_exp_f32 v50, v50
v_mfma_f32_16x16x32_bf16 v[248:251], a[40:43], v[32:35], v[248:251]
v_exp_f32 v51, v51
v_mfma_f32_16x16x32_bf16 a[0:3], a[40:43], v[36:39], a[0:3]
buffer_load_dwordx4 v3, s[24:27], s50 offen offset:3168 nt lds
v_mfma_f32_16x16x32_bf16 a[12:15], a[44:47], v[36:39], a[12:15]
ds_read_b128 a[32:35], v8 offset:17152
v_add_f32 v11, v11, v47
v_add_f32 v12, v12, v48
v_mfma_f32_16x16x32_bf16 a[8:11], a[44:47], v[32:35], a[8:11]
v_add_f32 v12, v12, v49
v_add_f32 v12, v12, v50
v_mfma_f32_16x16x32_bf16 a[4:7], a[44:47], v[28:31], a[4:7]
s_waitcnt lgkmcnt(3)
v_add_f32 v12, v12, v51
LS_23:
v_mfma_f32_16x16x32_bf16 v[64:67], a[16:19], a[48:51], v[16:19]
ds_read_b128 a[36:39], v8 offset:17216
v_cvt_pk_bf16_f32 v28, v40, v41
v_mfma_f32_16x16x32_bf16 v[64:67], a[20:23], a[60:63], v[64:67]
v_exp_f32 v52, v52
v_mfma_f32_16x16x32_bf16 v[68:71], a[20:23], a[64:67], v[20:23]
v_exp_f32 v53, v53
v_mfma_f32_16x16x32_bf16 v[68:71], a[16:19], a[52:55], v[68:71]
ds_read_b128 a[40:43], v8 offset:17280
v_cvt_pk_bf16_f32 v29, v42, v43
v_mfma_f32_16x16x32_bf16 v[72:75], a[16:19], a[56:59], v[24:27]
v_exp_f32 v54, v54
v_mfma_f32_16x16x32_bf16 v[72:75], a[20:23], a[68:71], v[72:75]
s_waitcnt lgkmcnt(3)
v_cvt_pk_bf16_f32 v32, v44, v45
v_mfma_f32_16x16x32_bf16 v[72:75], a[24:27], a[80:83], v[72:75]
ds_read_b128 a[44:47], v8 offset:17344
v_cvt_pk_bf16_f32 v33, v46, v47
v_mfma_f32_16x16x32_bf16 v[72:75], a[28:31], a[92:95], v[72:75]
v_exp_f32 v55, v55
v_mfma_f32_16x16x32_bf16 v[68:71], a[28:31], a[88:91], v[68:71]
v_exp_f32 v56, v56
v_mfma_f32_16x16x32_bf16 v[68:71], a[24:27], a[76:79], v[68:71]
ds_read_b128 a[16:19], v8 offset:17408
v_cvt_pk_bf16_f32 v36, v48, v49
v_mfma_f32_16x16x32_bf16 v[64:67], a[24:27], a[72:75], v[64:67]
v_exp_f32 v57, v57
v_mfma_f32_16x16x32_bf16 v[64:67], a[28:31], a[84:87], v[64:67]
s_waitcnt lgkmcnt(3)
v_cvt_pk_bf16_f32 v37, v50, v51
v_mfma_f32_16x16x32_bf16 v[64:67], a[32:35], a[96:99], v[64:67]
ds_read_b128 a[20:23], v8 offset:17472
v_cvt_pk_bf16_f32 v30, v52, v53
v_mfma_f32_16x16x32_bf16 v[64:67], a[36:39], a[108:111], v[64:67]
v_exp_f32 v58, v58
v_mfma_f32_16x16x32_bf16 v[68:71], a[36:39], a[112:115], v[68:71]
v_exp_f32 v59, v59
v_mfma_f32_16x16x32_bf16 v[68:71], a[32:35], a[100:103], v[68:71]
ds_read_b128 a[24:27], v8 offset:17536
v_cvt_pk_bf16_f32 v31, v54, v55
v_mfma_f32_16x16x32_bf16 v[72:75], a[32:35], a[104:107], v[72:75]
v_exp_f32 v60, v60
v_mfma_f32_16x16x32_bf16 v[72:75], a[36:39], a[116:119], v[72:75]
s_waitcnt lgkmcnt(3)
v_cvt_pk_bf16_f32 v34, v56, v57
v_mfma_f32_16x16x32_bf16 v[72:75], a[40:43], a[128:131], v[72:75]
ds_read_b128 a[28:31], v8 offset:17600
v_cvt_pk_bf16_f32 v35, v58, v59
v_mfma_f32_16x16x32_bf16 v[72:75], a[44:47], a[140:143], v[72:75]
v_exp_f32 v61, v61
v_mfma_f32_16x16x32_bf16 v[68:71], a[44:47], a[136:139], v[68:71]
s_waitcnt vmcnt(24)
s_barrier
v_mfma_f32_16x16x32_bf16 v[68:71], a[40:43], a[124:127], v[68:71]
ds_read_b128 a[32:35], v8 offset:17664
v_cvt_pk_bf16_f32 v38, v60, v61
v_mfma_f32_16x16x32_bf16 v[64:67], a[40:43], a[120:123], v[64:67]
s_add_u32 m0, s17, 101376
s_mov_b32 s50, 147456
v_mfma_f32_16x16x32_bf16 v[64:67], a[44:47], a[132:135], v[64:67]
s_waitcnt lgkmcnt(3)
v_add_f32 v10, v10, v52
v_mfma_f32_16x16x32_bf16 v[40:43], a[16:19], a[48:51], v[16:19]
ds_read_b128 a[36:39], v8 offset:17728
v_add_f32 v10, v10, v53
v_mfma_f32_16x16x32_bf16 v[40:43], a[20:23], a[60:63], v[40:43]
buffer_load_dwordx4 v0, s[20:23], s50 offen offset:0 nt lds
v_mfma_f32_16x16x32_bf16 v[44:47], a[20:23], a[64:67], v[20:23]
v_exp_f32 v62, v62
v_mfma_f32_16x16x32_bf16 v[44:47], a[16:19], a[52:55], v[44:47]
ds_read_b128 a[40:43], v8 offset:17792
v_max3_f32 v13, v64, v65, v66
v_mfma_f32_16x16x32_bf16 v[48:51], a[16:19], a[56:59], v[24:27]
buffer_load_dwordx4 v1, s[20:23], s50 offen offset:1056 nt lds
v_mfma_f32_16x16x32_bf16 v[48:51], a[20:23], a[68:71], v[48:51]
s_waitcnt lgkmcnt(3)
v_max3_f32 v13, v13, v67, v68
v_mfma_f32_16x16x32_bf16 v[48:51], a[24:27], a[80:83], v[48:51]
ds_read_b128 a[44:47], v8 offset:17856
v_max3_f32 v13, v13, v69, v70
v_mfma_f32_16x16x32_bf16 v[48:51], a[28:31], a[92:95], v[48:51]
v_exp_f32 v63, v63
v_mfma_f32_16x16x32_bf16 v[44:47], a[28:31], a[88:91], v[44:47]
buffer_load_dwordx4 v2, s[20:23], s50 offen offset:2112 nt lds
v_mfma_f32_16x16x32_bf16 v[44:47], a[24:27], a[76:79], v[44:47]
v_subrev_u32 v9, 67584, v9
ds_read_b64_tr_b16 a[16:17], v9 offset:33792
v_mfma_f32_16x16x32_bf16 v[40:43], a[24:27], a[72:75], v[40:43]
ds_read_b64_tr_b16 a[18:19], v9 offset:34304
v_cvt_pk_bf16_f32 v39, v62, v63
v_mfma_f32_16x16x32_bf16 v[40:43], a[28:31], a[84:87], v[40:43]
s_waitcnt lgkmcnt(4)
v_max3_f32 v13, v13, v71, v72
v_mfma_f32_16x16x32_bf16 v[40:43], a[32:35], a[96:99], v[40:43]
ds_read_b64_tr_b16 a[20:21], v9 offset:33824
v_max3_f32 v13, v13, v73, v74
v_mfma_f32_16x16x32_bf16 v[40:43], a[36:39], a[108:111], v[40:43]
ds_read_b64_tr_b16 a[22:23], v9 offset:34336
v_add_f32 v10, v10, v54
v_mfma_f32_16x16x32_bf16 v[44:47], a[36:39], a[112:115], v[44:47]
buffer_load_dwordx4 v3, s[20:23], s50 offen offset:3168 nt lds
v_mfma_f32_16x16x32_bf16 v[44:47], a[32:35], a[100:103], v[44:47]
ds_read_b64_tr_b16 a[24:25], v9 offset:33856
v_add_f32 v10, v10, v55
v_mfma_f32_16x16x32_bf16 v[48:51], a[32:35], a[104:107], v[48:51]
ds_read_b64_tr_b16 a[26:27], v9 offset:34368
v_add_f32 v11, v11, v56
v_mfma_f32_16x16x32_bf16 v[48:51], a[36:39], a[116:119], v[48:51]
s_waitcnt lgkmcnt(6)
v_add_f32 v11, v11, v57
v_mfma_f32_16x16x32_bf16 v[48:51], a[40:43], a[128:131], v[48:51]
ds_read_b64_tr_b16 a[28:29], v9 offset:33888
v_add_f32 v11, v11, v58
v_mfma_f32_16x16x32_bf16 v[48:51], a[44:47], a[140:143], v[48:51]
ds_read_b64_tr_b16 a[30:31], v9 offset:34400
v_add_f32 v11, v11, v59
v_mfma_f32_16x16x32_bf16 v[44:47], a[44:47], a[136:139], v[44:47]
v_add_f32 v12, v12, v60
v_add_f32 v12, v12, v61
v_mfma_f32_16x16x32_bf16 v[44:47], a[40:43], a[124:127], v[44:47]
ds_read_b64_tr_b16 a[32:33], v9 offset:33920
v_add_f32 v12, v12, v62
v_mfma_f32_16x16x32_bf16 v[40:43], a[40:43], a[120:123], v[40:43]
ds_read_b64_tr_b16 a[34:35], v9 offset:34432
v_add_f32 v12, v12, v63
v_mfma_f32_16x16x32_bf16 v[40:43], a[44:47], a[132:135], v[40:43]
s_waitcnt lgkmcnt(6)
v_max_f32 v13, v13, v75
LS_24:
v_mfma_f32_16x16x32_bf16 v[76:79], a[16:19], v[28:31], v[76:79]
ds_read_b64_tr_b16 a[36:37], v9 offset:33952
v_mfma_f32_16x16x32_bf16 v[80:83], a[16:19], v[32:35], v[80:83]
ds_read_b64_tr_b16 a[38:39], v9 offset:34464
v_mfma_f32_16x16x32_bf16 v[84:87], a[16:19], v[36:39], v[84:87]
v_mfma_f32_16x16x32_bf16 v[96:99], a[20:23], v[36:39], v[96:99]
ds_read_b64_tr_b16 a[40:41], v9 offset:33984
v_max3_f32 v13, v13, v40, v41
v_mfma_f32_16x16x32_bf16 v[92:95], a[20:23], v[32:35], v[92:95]
ds_read_b64_tr_b16 a[42:43], v9 offset:34496
v_max3_f32 v13, v13, v42, v43
v_mfma_f32_16x16x32_bf16 v[88:91], a[20:23], v[28:31], v[88:91]
s_waitcnt lgkmcnt(6)
v_max3_f32 v13, v13, v44, v45
v_mfma_f32_16x16x32_bf16 v[100:103], a[24:27], v[28:31], v[100:103]
ds_read_b64_tr_b16 a[44:45], v9 offset:34016
v_max3_f32 v13, v13, v46, v47
v_mfma_f32_16x16x32_bf16 v[104:107], a[24:27], v[32:35], v[104:107]
ds_read_b64_tr_b16 a[46:47], v9 offset:34528
v_max3_f32 v13, v13, v48, v49
v_mfma_f32_16x16x32_bf16 v[108:111], a[24:27], v[36:39], v[108:111]
v_max3_f32 v13, v13, v50, v51
v_mfma_f32_16x16x32_bf16 v[120:123], a[28:31], v[36:39], v[120:123]
ds_read_b64_tr_b16 a[16:17], v9 offset:34048
v_cmp_lt_f32 vcc, s47, v13
v_mfma_f32_16x16x32_bf16 v[116:119], a[28:31], v[32:35], v[116:119]
ds_read_b64_tr_b16 a[18:19], v9 offset:34560
v_mfma_f32_16x16x32_bf16 v[112:115], a[28:31], v[28:31], v[112:115]
s_waitcnt lgkmcnt(6)
s_cbranch_vccnz RARE_h0j4
RET_h0j4:
v_mfma_f32_16x16x32_bf16 v[124:127], a[32:35], v[28:31], v[124:127]
ds_read_b64_tr_b16 a[20:21], v9 offset:34080
ds_read_b64_tr_b16 a[22:23], v9 offset:34592
v_mfma_f32_16x16x32_bf16 v[128:131], a[32:35], v[32:35], v[128:131]
v_exp_f32 v40, v40
v_mfma_f32_16x16x32_bf16 v[132:135], a[32:35], v[36:39], v[132:135]
v_exp_f32 v41, v41
v_mfma_f32_16x16x32_bf16 v[144:147], a[36:39], v[36:39], v[144:147]
ds_read_b64_tr_b16 a[24:25], v9 offset:34112
ds_read_b64_tr_b16 a[26:27], v9 offset:34624
v_mfma_f32_16x16x32_bf16 v[140:143], a[36:39], v[32:35], v[140:143]
v_exp_f32 v42, v42
v_mfma_f32_16x16x32_bf16 v[136:139], a[36:39], v[28:31], v[136:139]
s_waitcnt lgkmcnt(6)
v_add_f32 v10, v10, v40
v_mfma_f32_16x16x32_bf16 v[148:151], a[40:43], v[28:31], v[148:151]
ds_read_b64_tr_b16 a[28:29], v9 offset:34144
ds_read_b64_tr_b16 a[30:31], v9 offset:34656
v_mfma_f32_16x16x32_bf16 v[152:155], a[40:43], v[32:35], v[152:155]
v_exp_f32 v43, v43
v_mfma_f32_16x16x32_bf16 v[156:159], a[40:43], v[36:39], v[156:159]
s_waitcnt vmcnt(24)
s_barrier
v_mfma_f32_16x16x32_bf16 v[168:171], a[44:47], v[36:39], v[168:171]
ds_read_b64_tr_b16 a[32:33], v9 offset:34176
ds_read_b64_tr_b16 a[34:35], v9 offset:34688
v_mfma_f32_16x16x32_bf16 v[164:167], a[44:47], v[32:35], v[164:167]
s_add_u32 m0, s17, 16896
s_mov_b32 s50, 131072
v_mfma_f32_16x16x32_bf16 v[160:163], a[44:47], v[28:31], v[160:163]
s_waitcnt lgkmcnt(6)
v_add_f32 v10, v10, v41
v_mfma_f32_16x16x32_bf16 v[172:175], a[16:19], v[28:31], v[172:175]
ds_read_b64_tr_b16 a[36:37], v9 offset:34208
ds_read_b64_tr_b16 a[38:39], v9 offset:34720
v_mfma_f32_16x16x32_bf16 v[176:179], a[16:19], v[32:35], v[176:179]
buffer_load_dwordx4 v0, s[24:27], s50 offen offset:0 nt lds
v_mfma_f32_16x16x32_bf16 v[180:183], a[16:19], v[36:39], v[180:183]
v_exp_f32 v44, v44
v_mfma_f32_16x16x32_bf16 v[192:195], a[20:23], v[36:39], v[192:195]
ds_read_b64_tr_b16 a[40:41], v9 offset:34240
ds_read_b64_tr_b16 a[42:43], v9 offset:34752
v_mfma_f32_16x16x32_bf16 v[188:191], a[20:23], v[32:35], v[188:191]
buffer_load_dwordx4 v1, s[24:27], s50 offen offset:1056 nt lds
v_mfma_f32_16x16x32_bf16 v[184:187], a[20:23], v[28:31], v[184:187]
s_waitcnt lgkmcnt(6)
v_add_f32 v10, v10, v42
v_mfma_f32_16x16x32_bf16 v[196:199], a[24:27], v[28:31], v[196:199]
ds_read_b64_tr_b16 a[44:45], v9 offset:34272
ds_read_b64_tr_b16 a[46:47], v9 offset:34784
v_mfma_f32_16x16x32_bf16 v[200:203], a[24:27], v[32:35], v[200:203]
buffer_load_dwordx4 v2, s[24:27], s50 offen offset:2112 nt lds
v_mfma_f32_16x16x32_bf16 v[204:207], a[24:27], v[36:39], v[204:207]
v_exp_f32 v45, v45
v_mfma_f32_16x16x32_bf16 v[216:219], a[28:31], v[36:39], v[216:219]
v_add_u32 v8, 84480, v8
ds_read_b128 a[16:19], v8 offset:51200
v_mfma_f32_16x16x32_bf16 v[212:215], a[28:31], v[32:35], v[212:215]
v_exp_f32 v46, v46
v_mfma_f32_16x16x32_bf16 v[208:211], a[28:31], v[28:31], v[208:211]
s_waitcnt lgkmcnt(5)
v_add_f32 v10, v10, v43
v_mfma_f32_16x16x32_bf16 v[220:223], a[32:35], v[28:31], v[220:223]
ds_read_b128 a[20:23], v8 offset:51264
v_add_f32 v11, v11, v44
v_mfma_f32_16x16x32_bf16 v[224:227], a[32:35], v[32:35], v[224:227]
v_exp_f32 v47, v47
v_mfma_f32_16x16x32_bf16 v[228:231], a[32:35], v[36:39], v[228:231]
v_exp_f32 v48, v48
v_mfma_f32_16x16x32_bf16 v[240:243], a[36:39], v[36:39], v[240:243]
ds_read_b128 a[24:27], v8 offset:51328
v_add_f32 v11, v11, v45
v_mfma_f32_16x16x32_bf16 v[236:239], a[36:39], v[32:35], v[236:239]
v_exp_f32 v49, v49
v_mfma_f32_16x16x32_bf16 v[232:235], a[36:39], v[28:31], v[232:235]
s_waitcnt lgkmcnt(3)
v_add_f32 v11, v11, v46
v_mfma_f32_16x16x32_bf16 v[244:247], a[40:43], v[28:31], v[244:247]
ds_read_b128 a[28:31], v8 offset:51392
v_exp_f32 v50, v50
v_mfma_f32_16x16x32_bf16 v[248:251], a[40:43], v[32:35], v[248:251]
v_exp_f32 v51, v51
v_mfma_f32_16x16x32_bf16 a[0:3], a[40:43], v[36:39], a[0:3]
buffer_load_dwordx4 v3, s[24:27], s50 offen offset:3168 nt lds
v_mfma_f32_16x16x32_bf16 a[12:15], a[44:47], v[36:39], a[12:15]
ds_read_b128 a[32:35], v8 offset:51456
v_add_f32 v11, v11, v47
v_add_f32 v12, v12, v48
v_mfma_f32_16x16x32_bf16 a[8:11], a[44:47], v[32:35], a[8:11]
v_add_f32 v12, v12, v49
v_add_f32 v12, v12, v50
v_mfma_f32_16x16x32_bf16 a[4:7], a[44:47], v[28:31], a[4:7]
s_waitcnt lgkmcnt(3)
v_add_f32 v12, v12, v51
LS_25:
v_mfma_f32_16x16x32_bf16 v[52:55], a[16:19], a[48:51], v[16:19]
ds_read_b128 a[36:39], v8 offset:51520
v_cvt_pk_bf16_f32 v30, v40, v41
v_mfma_f32_16x16x32_bf16 v[52:55], a[20:23], a[60:63], v[52:55]
v_exp_f32 v64, v64
v_mfma_f32_16x16x32_bf16 v[56:59], a[20:23], a[64:67], v[20:23]
v_exp_f32 v65, v65
v_mfma_f32_16x16x32_bf16 v[56:59], a[16:19], a[52:55], v[56:59]
ds_read_b128 a[40:43], v8 offset:51584
v_cvt_pk_bf16_f32 v31, v42, v43
v_mfma_f32_16x16x32_bf16 v[60:63], a[16:19], a[56:59], v[24:27]
v_exp_f32 v66, v66
v_mfma_f32_16x16x32_bf16 v[60:63], a[20:23], a[68:71], v[60:63]
s_waitcnt lgkmcnt(3)
v_cvt_pk_bf16_f32 v34, v44, v45
v_mfma_f32_16x16x32_bf16 v[60:63], a[24:27], a[80:83], v[60:63]
ds_read_b128 a[44:47], v8 offset:51648
v_cvt_pk_bf16_f32 v35, v46, v47
v_mfma_f32_16x16x32_bf16 v[60:63], a[28:31], a[92:95], v[60:63]
v_exp_f32 v67, v67
v_mfma_f32_16x16x32_bf16 v[56:59], a[28:31], a[88:91], v[56:59]
v_exp_f32 v68, v68
v_mfma_f32_16x16x32_bf16 v[56:59], a[24:27], a[76:79], v[56:59]
ds_read_b128 a[16:19], v8 offset:50688
v_cvt_pk_bf16_f32 v38, v48, v49
v_mfma_f32_16x16x32_bf16 v[52:55], a[24:27], a[72:75], v[52:55]
v_exp_f32 v69, v69
v_mfma_f32_16x16x32_bf16 v[52:55], a[28:31], a[84:87], v[52:55]
s_waitcnt lgkmcnt(3)
v_cvt_pk_bf16_f32 v39, v50, v51
v_mfma_f32_16x16x32_bf16 v[52:55], a[32:35], a[96:99], v[52:55]
ds_read_b128 a[20:23], v8 offset:50752
v_cvt_pk_bf16_f32 v28, v64, v65
v_mfma_f32_16x16x32_bf16 v[52:55], a[36:39], a[108:111], v[52:55]
v_exp_f32 v70, v70
v_mfma_f32_16x16x32_bf16 v[56:59], a[36:39], a[112:115], v[56:59]
v_exp_f32 v71, v71
v_mfma_f32_16x16x32_bf16 v[56:59], a[32:35], a[100:103], v[56:59]
ds_read_b128 a[24:27], v8 offset:50816
v_cvt_pk_bf16_f32 v29, v66, v67
v_mfma_f32_16x16x32_bf16 v[60:63], a[32:35], a[104:107], v[60:63]
v_exp_f32 v72, v72
v_mfma_f32_16x16x32_bf16 v[60:63], a[36:39], a[116:119], v[60:63]
s_waitcnt lgkmcnt(3)
v_cvt_pk_bf16_f32 v32, v68, v69
v_mfma_f32_16x16x32_bf16 v[60:63], a[40:43], a[128:131], v[60:63]
ds_read_b128 a[28:31], v8 offset:50880
v_cvt_pk_bf16_f32 v33, v70, v71
v_mfma_f32_16x16x32_bf16 v[60:63], a[44:47], a[140:143], v[60:63]
v_exp_f32 v73, v73
v_mfma_f32_16x16x32_bf16 v[56:59], a[44:47], a[136:139], v[56:59]
s_waitcnt vmcnt(24)
s_barrier
v_mfma_f32_16x16x32_bf16 v[56:59], a[40:43], a[124:127], v[56:59]
ds_read_b128 a[32:35], v8 offset:50944
v_cvt_pk_bf16_f32 v36, v72, v73
v_mfma_f32_16x16x32_bf16 v[52:55], a[40:43], a[120:123], v[52:55]
v_exp_f32 v74, v74
v_mfma_f32_16x16x32_bf16 v[52:55], a[44:47], a[132:135], v[52:55]
s_waitcnt lgkmcnt(3)
v_add_f32 v10, v10, v64
v_mfma_f32_16x16x32_bf16 v[40:43], a[16:19], a[48:51], v[16:19]
ds_read_b128 a[36:39], v8 offset:51008
v_add_f32 v10, v10, v65
v_mfma_f32_16x16x32_bf16 v[40:43], a[20:23], a[60:63], v[40:43]
v_exp_f32 v75, v75
v_mfma_f32_16x16x32_bf16 v[44:47], a[20:23], a[64:67], v[20:23]
v_cvt_pk_bf16_f32 v37, v74, v75
v_add_f32 v10, v10, v66
v_mfma_f32_16x16x32_bf16 v[44:47], a[16:19], a[52:55], v[44:47]
ds_read_b128 a[40:43], v8 offset:51072
v_max3_f32 v13, v52, v53, v54
v_mfma_f32_16x16x32_bf16 v[48:51], a[16:19], a[56:59], v[24:27]
v_max3_f32 v13, v13, v55, v56
v_add_f32 v10, v10, v67
v_mfma_f32_16x16x32_bf16 v[48:51], a[20:23], a[68:71], v[48:51]
s_waitcnt lgkmcnt(3)
v_max3_f32 v13, v13, v57, v58
v_mfma_f32_16x16x32_bf16 v[48:51], a[24:27], a[80:83], v[48:51]
ds_read_b128 a[44:47], v8 offset:51136
v_max3_f32 v13, v13, v59, v60
v_mfma_f32_16x16x32_bf16 v[48:51], a[28:31], a[92:95], v[48:51]
v_max3_f32 v13, v13, v61, v62
v_add_f32 v11, v11, v68
v_mfma_f32_16x16x32_bf16 v[44:47], a[28:31], a[88:91], v[44:47]
v_add_f32 v11, v11, v69
v_add_f32 v11, v11, v70
v_mfma_f32_16x16x32_bf16 v[44:47], a[24:27], a[76:79], v[44:47]
v_subrev_u32 v9, 16896, v9
ds_read_b64_tr_b16 a[16:17], v9 offset:0
v_mfma_f32_16x16x32_bf16 v[40:43], a[24:27], a[72:75], v[40:43]
ds_read_b64_tr_b16 a[18:19], v9 offset:512
v_add_f32 v11, v11, v71
v_mfma_f32_16x16x32_bf16 v[40:43], a[28:31], a[84:87], v[40:43]
s_waitcnt lgkmcnt(4)
v_add_f32 v12, v12, v72
v_mfma_f32_16x16x32_bf16 v[40:43], a[32:35], a[96:99], v[40:43]
ds_read_b64_tr_b16 a[20:21], v9 offset:32
v_add_f32 v12, v12, v73
v_mfma_f32_16x16x32_bf16 v[40:43], a[36:39], a[108:111], v[40:43]
ds_read_b64_tr_b16 a[22:23], v9 offset:544
v_add_f32 v12, v12, v74
v_mfma_f32_16x16x32_bf16 v[44:47], a[36:39], a[112:115], v[44:47]
v_add_f32 v12, v12, v75
v_max_f32 v13, v13, v63
v_mfma_f32_16x16x32_bf16 v[44:47], a[32:35], a[100:103], v[44:47]
ds_read_b64_tr_b16 a[24:25], v9 offset:64
v_mfma_f32_16x16x32_bf16 v[48:51], a[32:35], a[104:107], v[48:51]
ds_read_b64_tr_b16 a[26:27], v9 offset:576
v_mfma_f32_16x16x32_bf16 v[48:51], a[36:39], a[116:119], v[48:51]
s_waitcnt lgkmcnt(6)
v_mfma_f32_16x16x32_bf16 v[48:51], a[40:43], a[128:131], v[48:51]
ds_read_b64_tr_b16 a[28:29], v9 offset:96
v_mfma_f32_16x16x32_bf16 v[48:51], a[44:47], a[140:143], v[48:51]
ds_read_b64_tr_b16 a[30:31], v9 offset:608
v_mfma_f32_16x16x32_bf16 v[44:47], a[44:47], a[136:139], v[44:47]
v_mfma_f32_16x16x32_bf16 v[44:47], a[40:43], a[124:127], v[44:47]
ds_read_b64_tr_b16 a[32:33], v9 offset:128
v_mfma_f32_16x16x32_bf16 v[40:43], a[40:43], a[120:123], v[40:43]
ds_read_b64_tr_b16 a[34:35], v9 offset:640
v_mfma_f32_16x16x32_bf16 v[40:43], a[44:47], a[132:135], v[40:43]
s_waitcnt lgkmcnt(6)
LS_26:
v_mfma_f32_16x16x32_bf16 v[76:79], a[16:19], v[28:31], v[76:79]
ds_read_b64_tr_b16 a[36:37], v9 offset:160
v_mfma_f32_16x16x32_bf16 v[80:83], a[16:19], v[32:35], v[80:83]
ds_read_b64_tr_b16 a[38:39], v9 offset:672
v_mfma_f32_16x16x32_bf16 v[84:87], a[16:19], v[36:39], v[84:87]
s_add_u32 m0, s17, 50688
s_mov_b32 s50, 163840
v_mfma_f32_16x16x32_bf16 v[96:99], a[20:23], v[36:39], v[96:99]
ds_read_b64_tr_b16 a[40:41], v9 offset:192
v_max3_f32 v13, v13, v40, v41
v_mfma_f32_16x16x32_bf16 v[92:95], a[20:23], v[32:35], v[92:95]
ds_read_b64_tr_b16 a[42:43], v9 offset:704
v_max3_f32 v13, v13, v42, v43
v_mfma_f32_16x16x32_bf16 v[88:91], a[20:23], v[28:31], v[88:91]
s_waitcnt lgkmcnt(6)
v_max3_f32 v13, v13, v44, v45
v_mfma_f32_16x16x32_bf16 v[100:103], a[24:27], v[28:31], v[100:103]
ds_read_b64_tr_b16 a[44:45], v9 offset:224
v_max3_f32 v13, v13, v46, v47
v_mfma_f32_16x16x32_bf16 v[104:107], a[24:27], v[32:35], v[104:107]
ds_read_b64_tr_b16 a[46:47], v9 offset:736
v_max3_f32 v13, v13, v48, v49
v_mfma_f32_16x16x32_bf16 v[108:111], a[24:27], v[36:39], v[108:111]
buffer_load_dwordx4 v0, s[20:23], s50 offen offset:0 nt lds
v_mfma_f32_16x16x32_bf16 v[120:123], a[28:31], v[36:39], v[120:123]
ds_read_b64_tr_b16 a[16:17], v9 offset:256
v_max3_f32 v13, v13, v50, v51
v_mfma_f32_16x16x32_bf16 v[116:119], a[28:31], v[32:35], v[116:119]
ds_read_b64_tr_b16 a[18:19], v9 offset:768
v_cmp_lt_f32 vcc, s47, v13
v_mfma_f32_16x16x32_bf16 v[112:115], a[28:31], v[28:31], v[112:115]
s_waitcnt lgkmcnt(6)
v_mfma_f32_16x16x32_bf16 v[124:127], a[32:35], v[28:31], v[124:127]
ds_read_b64_tr_b16 a[20:21], v9 offset:288
ds_read_b64_tr_b16 a[22:23], v9 offset:800
v_mfma_f32_16x16x32_bf16 v[128:131], a[32:35], v[32:35], v[128:131]
s_cbranch_vccnz RARE_h0j5
RET_h0j5:
v_mfma_f32_16x16x32_bf16 v[132:135], a[32:35], v[36:39], v[132:135]
buffer_load_dwordx4 v1, s[20:23], s50 offen offset:1056 nt lds
v_mfma_f32_16x16x32_bf16 v[144:147], a[36:39], v[36:39], v[144:147]
ds_read_b64_tr_b16 a[24:25], v9 offset:320
ds_read_b64_tr_b16 a[26:27], v9 offset:832
v_mfma_f32_16x16x32_bf16 v[140:143], a[36:39], v[32:35], v[140:143]
v_exp_f32 v40, v40
v_mfma_f32_16x16x32_bf16 v[136:139], a[36:39], v[28:31], v[136:139]
s_waitcnt lgkmcnt(6)
v_add_f32 v10, v10, v40
v_mfma_f32_16x16x32_bf16 v[148:151], a[40:43], v[28:31], v[148:151]
ds_read_b64_tr_b16 a[28:29], v9 offset:352
ds_read_b64_tr_b16 a[30:31], v9 offset:864
v_mfma_f32_16x16x32_bf16 v[152:155], a[40:43], v[32:35], v[152:155]
buffer_load_dwordx4 v2, s[20:23], s50 offen offset:2112 nt lds
v_mfma_f32_16x16x32_bf16 v[156:159], a[40:43], v[36:39], v[156:159]
s_waitcnt vmcnt(23)
s_barrier
v_mfma_f32_16x16x32_bf16 v[168:171], a[44:47], v[36:39], v[168:171]
ds_read_b64_tr_b16 a[32:33], v9 offset:384
ds_read_b64_tr_b16 a[34:35], v9 offset:896
v_mfma_f32_16x16x32_bf16 v[164:167], a[44:47], v[32:35], v[164:167]
v_exp_f32 v41, v41
v_mfma_f32_16x16x32_bf16 v[160:163], a[44:47], v[28:31], v[160:163]
s_waitcnt lgkmcnt(6)
v_add_f32 v10, v10, v41
v_mfma_f32_16x16x32_bf16 v[172:175], a[16:19], v[28:31], v[172:175]
ds_read_b64_tr_b16 a[36:37], v9 offset:416
ds_read_b64_tr_b16 a[38:39], v9 offset:928
v_mfma_f32_16x16x32_bf16 v[176:179], a[16:19], v[32:35], v[176:179]
v_exp_f32 v42, v42
v_mfma_f32_16x16x32_bf16 v[180:183], a[16:19], v[36:39], v[180:183]
v_exp_f32 v43, v43
v_mfma_f32_16x16x32_bf16 v[192:195], a[20:23], v[36:39], v[192:195]
ds_read_b64_tr_b16 a[40:41], v9 offset:448
ds_read_b64_tr_b16 a[42:43], v9 offset:960
v_mfma_f32_16x16x32_bf16 v[188:191], a[20:23], v[32:35], v[188:191]
v_exp_f32 v44, v44
v_mfma_f32_16x16x32_bf16 v[184:187], a[20:23], v[28:31], v[184:187]
s_waitcnt lgkmcnt(6)
v_add_f32 v10, v10, v42
v_mfma_f32_16x16x32_bf16 v[196:199], a[24:27], v[28:31], v[196:199]
ds_read_b64_tr_b16 a[44:45], v9 offset:480
ds_read_b64_tr_b16 a[46:47], v9 offset:992
v_mfma_f32_16x16x32_bf16 v[200:203], a[24:27], v[32:35], v[200:203]
v_exp_f32 v45, v45
v_mfma_f32_16x16x32_bf16 v[204:207], a[24:27], v[36:39], v[204:207]
v_exp_f32 v46, v46
v_mfma_f32_16x16x32_bf16 v[216:219], a[28:31], v[36:39], v[216:219]
ds_read_b128 a[16:19], v8 offset:33792
v_add_f32 v10, v10, v43
v_mfma_f32_16x16x32_bf16 v[212:215], a[28:31], v[32:35], v[212:215]
v_exp_f32 v47, v47
v_mfma_f32_16x16x32_bf16 v[208:211], a[28:31], v[28:31], v[208:211]
s_waitcnt lgkmcnt(5)
v_add_f32 v11, v11, v44
v_mfma_f32_16x16x32_bf16 v[220:223], a[32:35], v[28:31], v[220:223]
ds_read_b128 a[20:23], v8 offset:33856
v_add_f32 v11, v11, v45
v_mfma_f32_16x16x32_bf16 v[224:227], a[32:35], v[32:35], v[224:227]
v_exp_f32 v48, v48
v_mfma_f32_16x16x32_bf16 v[228:231], a[32:35], v[36:39], v[228:231]
v_exp_f32 v49, v49
v_mfma_f32_16x16x32_bf16 v[240:243], a[36:39], v[36:39], v[240:243]
ds_read_b128 a[24:27], v8 offset:33920
v_add_f32 v11, v11, v46
v_mfma_f32_16x16x32_bf16 v[236:239], a[36:39], v[32:35], v[236:239]
v_exp_f32 v50, v50
v_mfma_f32_16x16x32_bf16 v[232:235], a[36:39], v[28:31], v[232:235]
s_waitcnt lgkmcnt(3)
v_add_f32 v11, v11, v47
v_mfma_f32_16x16x32_bf16 v[244:247], a[40:43], v[28:31], v[244:247]
ds_read_b128 a[28:31], v8 offset:33984
v_add_f32 v12, v12, v48
v_mfma_f32_16x16x32_bf16 v[248:251], a[40:43], v[32:35], v[248:251]
v_exp_f32 v51, v51
v_mfma_f32_16x16x32_bf16 a[0:3], a[40:43], v[36:39], a[0:3]
buffer_load_dwordx4 v3, s[20:23], s50 offen offset:3168 nt lds
v_mfma_f32_16x16x32_bf16 a[12:15], a[44:47], v[36:39], a[12:15]
ds_read_b128 a[32:35], v8 offset:34048
v_add_f32 v12, v12, v49
v_mfma_f32_16x16x32_bf16 a[8:11], a[44:47], v[32:35], a[8:11]
v_add_f32 v12, v12, v50
v_add_f32 v12, v12, v51
v_mfma_f32_16x16x32_bf16 a[4:7], a[44:47], v[28:31], a[4:7]
s_waitcnt lgkmcnt(3)
LS_27:
v_mfma_f32_16x16x32_bf16 v[64:67], a[16:19], a[48:51], v[16:19]
ds_read_b128 a[36:39], v8 offset:34112
v_cvt_pk_bf16_f32 v28, v40, v41
v_mfma_f32_16x16x32_bf16 v[64:67], a[20:23], a[60:63], v[64:67]
s_add_u32 m0, s17, 135168
s_mov_b32 s50, 147456
v_mfma_f32_16x16x32_bf16 v[68:71], a[20:23], a[64:67], v[20:23]
buffer_load_dwordx4 v0, s[24:27], s50 offen offset:0 nt lds
v_mfma_f32_16x16x32_bf16 v[68:71], a[16:19], a[52:55], v[68:71]
ds_read_b128 a[40:43], v8 offset:34176
v_cvt_pk_bf16_f32 v29, v42, v43
v_mfma_f32_16x16x32_bf16 v[72:75], a[16:19], a[56:59], v[24:27]
v_exp_f32 v52, v52
v_mfma_f32_16x16x32_bf16 v[72:75], a[20:23], a[68:71], v[72:75]
s_waitcnt lgkmcnt(3)
v_cvt_pk_bf16_f32 v32, v44, v45
v_mfma_f32_16x16x32_bf16 v[72:75], a[24:27], a[80:83], v[72:75]
ds_read_b128 a[44:47], v8 offset:34240
v_cvt_pk_bf16_f32 v33, v46, v47
v_mfma_f32_16x16x32_bf16 v[72:75], a[28:31], a[92:95], v[72:75]
buffer_load_dwordx4 v1, s[24:27], s50 offen offset:1056 nt lds
v_mfma_f32_16x16x32_bf16 v[68:71], a[28:31], a[88:91], v[68:71]
v_exp_f32 v53, v53
v_mfma_f32_16x16x32_bf16 v[68:71], a[24:27], a[76:79], v[68:71]
ds_read_b128 a[16:19], v8 offset:34304
v_cvt_pk_bf16_f32 v36, v48, v49
v_mfma_f32_16x16x32_bf16 v[64:67], a[24:27], a[72:75], v[64:67]
v_exp_f32 v54, v54
v_mfma_f32_16x16x32_bf16 v[64:67], a[28:31], a[84:87], v[64:67]
s_waitcnt lgkmcnt(3)
v_cvt_pk_bf16_f32 v37, v50, v51
v_mfma_f32_16x16x32_bf16 v[64:67], a[32:35], a[96:99], v[64:67]
ds_read_b128 a[20:23], v8 offset:34368
v_cvt_pk_bf16_f32 v30, v52, v53
v_mfma_f32_16x16x32_bf16 v[64:67], a[36:39], a[108:111], v[64:67]
v_exp_f32 v55, v55
v_mfma_f32_16x16x32_bf16 v[68:71], a[36:39], a[112:115], v[68:71]
v_exp_f32 v56, v56
v_mfma_f32_16x16x32_bf16 v[68:71], a[32:35], a[100:103], v[68:71]
ds_read_b128 a[24:27], v8 offset:34432
v_cvt_pk_bf16_f32 v31, v54, v55
v_mfma_f32_16x16x32_bf16 v[72:75], a[32:35], a[104:107], v[72:75]
v_exp_f32 v57, v57
v_mfma_f32_16x16x32_bf16 v[72:75], a[36:39], a[116:119], v[72:75]
s_waitcnt lgkmcnt(3)
v_cvt_pk_bf16_f32 v34, v56, v57
v_mfma_f32_16x16x32_bf16 v[72:75], a[40:43], a[128:131], v[72:75]
ds_read_b128 a[28:31], v8 offset:34496
v_add_f32 v10, v10, v52
v_mfma_f32_16x16x32_bf16 v[72:75], a[44:47], a[140:143], v[72:75]
v_exp_f32 v58, v58
v_mfma_f32_16x16x32_bf16 v[68:71], a[44:47], a[136:139], v[68:71]
s_waitcnt vmcnt(22)
s_barrier
v_mfma_f32_16x16x32_bf16 v[68:71], a[40:43], a[124:127], v[68:71]
ds_read_b128 a[32:35], v8 offset:34560
v_add_f32 v10, v10, v53
v_mfma_f32_16x16x32_bf16 v[64:67], a[40:43], a[120:123], v[64:67]
v_exp_f32 v59, v59
v_mfma_f32_16x16x32_bf16 v[64:67], a[44:47], a[132:135], v[64:67]
s_waitcnt lgkmcnt(3)
v_cvt_pk_bf16_f32 v35, v58, v59
v_mfma_f32_16x16x32_bf16 v[40:43], a[16:19], a[48:51], v[16:19]
ds_read_b128 a[36:39], v8 offset:34624
v_add_f32 v10, v10, v54
v_mfma_f32_16x16x32_bf16 v[40:43], a[20:23], a[60:63], v[40:43]
v_exp_f32 v60, v60
v_mfma_f32_16x16x32_bf16 v[44:47], a[20:23], a[64:67], v[20:23]
v_exp_f32 v61, v61
v_mfma_f32_16x16x32_bf16 v[44:47], a[16:19], a[52:55], v[44:47]
ds_read_b128 a[40:43], v8 offset:34688
v_max3_f32 v13, v64, v65, v66
v_mfma_f32_16x16x32_bf16 v[48:51], a[16:19], a[56:59], v[24:27]
v_exp_f32 v62, v62
v_mfma_f32_16x16x32_bf16 v[48:51], a[20:23], a[68:71], v[48:51]
s_waitcnt lgkmcnt(3)
v_max3_f32 v13, v13, v67, v68
v_mfma_f32_16x16x32_bf16 v[48:51], a[24:27], a[80:83], v[48:51]
ds_read_b128 a[44:47], v8 offset:34752
v_max3_f32 v13, v13, v69, v70
v_mfma_f32_16x16x32_bf16 v[48:51], a[28:31], a[92:95], v[48:51]
v_exp_f32 v63, v63
v_mfma_f32_16x16x32_bf16 v[44:47], a[28:31], a[88:91], v[44:47]
buffer_load_dwordx4 v2, s[24:27], s50 offen offset:2112 nt lds
v_mfma_f32_16x16x32_bf16 v[44:47], a[24:27], a[76:79], v[44:47]
ds_read_b64_tr_b16 a[16:17], v9 offset:33792
v_cvt_pk_bf16_f32 v38, v60, v61
v_mfma_f32_16x16x32_bf16 v[40:43], a[24:27], a[72:75], v[40:43]
ds_read_b64_tr_b16 a[18:19], v9 offset:34304
v_cvt_pk_bf16_f32 v39, v62, v63
v_mfma_f32_16x16x32_bf16 v[40:43], a[28:31], a[84:87], v[40:43]
s_waitcnt lgkmcnt(4)
v_max3_f32 v13, v13, v71, v72
v_mfma_f32_16x16x32_bf16 v[40:43], a[32:35], a[96:99], v[40:43]
ds_read_b64_tr_b16 a[20:21], v9 offset:33824
v_max3_f32 v13, v13, v73, v74
v_mfma_f32_16x16x32_bf16 v[40:43], a[36:39], a[108:111], v[40:43]
ds_read_b64_tr_b16 a[22:23], v9 offset:34336
v_add_f32 v10, v10, v55
v_mfma_f32_16x16x32_bf16 v[44:47], a[36:39], a[112:115], v[44:47]
buffer_load_dwordx4 v3, s[24:27], s50 offen offset:3168 nt lds
v_mfma_f32_16x16x32_bf16 v[44:47], a[32:35], a[100:103], v[44:47]
ds_read_b64_tr_b16 a[24:25], v9 offset:33856
v_add_f32 v11, v11, v56
v_mfma_f32_16x16x32_bf16 v[48:51], a[32:35], a[104:107], v[48:51]
ds_read_b64_tr_b16 a[26:27], v9 offset:34368
v_add_f32 v11, v11, v57
v_mfma_f32_16x16x32_bf16 v[48:51], a[36:39], a[116:119], v[48:51]
s_waitcnt lgkmcnt(6)
v_add_f32 v11, v11, v58
v_mfma_f32_16x16x32_bf16 v[48:51], a[40:43], a[128:131], v[48:51]
ds_read_b64_tr_b16 a[28:29], v9 offset:33888
v_add_f32 v11, v11, v59
v_mfma_f32_16x16x32_bf16 v[48:51], a[44:47], a[140:143], v[48:51]
ds_read_b64_tr_b16 a[30:31], v9 offset:34400
v_add_f32 v12, v12, v60
v_mfma_f32_16x16x32_bf16 v[44:47], a[44:47], a[136:139], v[44:47]
v_add_f32 v12, v12, v61
v_add_f32 v12, v12, v62
v_mfma_f32_16x16x32_bf16 v[44:47], a[40:43], a[124:127], v[44:47]
ds_read_b64_tr_b16 a[32:33], v9 offset:33920
v_add_f32 v12, v12, v63
v_mfma_f32_16x16x32_bf16 v[40:43], a[40:43], a[120:123], v[40:43]
ds_read_b64_tr_b16 a[34:35], v9 offset:34432
v_max_f32 v13, v13, v75
v_mfma_f32_16x16x32_bf16 v[40:43], a[44:47], a[132:135], v[40:43]
s_waitcnt lgkmcnt(6)
LS_28:
v_mfma_f32_16x16x32_bf16 v[76:79], a[16:19], v[28:31], v[76:79]
ds_read_b64_tr_b16 a[36:37], v9 offset:33952
v_mfma_f32_16x16x32_bf16 v[80:83], a[16:19], v[32:35], v[80:83]
ds_read_b64_tr_b16 a[38:39], v9 offset:34464
v_mfma_f32_16x16x32_bf16 v[84:87], a[16:19], v[36:39], v[84:87]
s_add_u32 m0, s17, 0
s_mov_b32 s50, 180224
v_mfma_f32_16x16x32_bf16 v[96:99], a[20:23], v[36:39], v[96:99]
ds_read_b64_tr_b16 a[40:41], v9 offset:33984
v_max3_f32 v13, v13, v40, v41
v_mfma_f32_16x16x32_bf16 v[92:95], a[20:23], v[32:35], v[92:95]
ds_read_b64_tr_b16 a[42:43], v9 offset:34496
v_max3_f32 v13, v13, v42, v43
v_mfma_f32_16x16x32_bf16 v[88:91], a[20:23], v[28:31], v[88:91]
s_waitcnt lgkmcnt(6)
v_max3_f32 v13, v13, v44, v45
v_mfma_f32_16x16x32_bf16 v[100:103], a[24:27], v[28:31], v[100:103]
ds_read_b64_tr_b16 a[44:45], v9 offset:34016
v_max3_f32 v13, v13, v46, v47
v_mfma_f32_16x16x32_bf16 v[104:107], a[24:27], v[32:35], v[104:107]
ds_read_b64_tr_b16 a[46:47], v9 offset:34528
v_max3_f32 v13, v13, v48, v49
v_mfma_f32_16x16x32_bf16 v[108:111], a[24:27], v[36:39], v[108:111]
buffer_load_dwordx4 v0, s[20:23], s50 offen offset:0 nt lds
v_mfma_f32_16x16x32_bf16 v[120:123], a[28:31], v[36:39], v[120:123]
ds_read_b64_tr_b16 a[16:17], v9 offset:34048
v_max3_f32 v13, v13, v50, v51
v_mfma_f32_16x16x32_bf16 v[116:119], a[28:31], v[32:35], v[116:119]
ds_read_b64_tr_b16 a[18:19], v9 offset:34560
v_cmp_lt_f32 vcc, s47, v13
v_mfma_f32_16x16x32_bf16 v[112:115], a[28:31], v[28:31], v[112:115]
s_waitcnt lgkmcnt(6)
v_mfma_f32_16x16x32_bf16 v[124:127], a[32:35], v[28:31], v[124:127]
ds_read_b64_tr_b16 a[20:21], v9 offset:34080
ds_read_b64_tr_b16 a[22:23], v9 offset:34592
v_mfma_f32_16x16x32_bf16 v[128:131], a[32:35], v[32:35], v[128:131]
s_cbranch_vccnz RARE_h0j6
RET_h0j6:
v_mfma_f32_16x16x32_bf16 v[132:135], a[32:35], v[36:39], v[132:135]
buffer_load_dwordx4 v1, s[20:23], s50 offen offset:1056 nt lds
v_mfma_f32_16x16x32_bf16 v[144:147], a[36:39], v[36:39], v[144:147]
ds_read_b64_tr_b16 a[24:25], v9 offset:34112
ds_read_b64_tr_b16 a[26:27], v9 offset:34624
v_mfma_f32_16x16x32_bf16 v[140:143], a[36:39], v[32:35], v[140:143]
v_exp_f32 v40, v40
v_mfma_f32_16x16x32_bf16 v[136:139], a[36:39], v[28:31], v[136:139]
s_waitcnt lgkmcnt(6)
v_add_f32 v10, v10, v40
v_mfma_f32_16x16x32_bf16 v[148:151], a[40:43], v[28:31], v[148:151]
ds_read_b64_tr_b16 a[28:29], v9 offset:34144
ds_read_b64_tr_b16 a[30:31], v9 offset:34656
v_mfma_f32_16x16x32_bf16 v[152:155], a[40:43], v[32:35], v[152:155]
buffer_load_dwordx4 v2, s[20:23], s50 offen offset:2112 nt lds
v_mfma_f32_16x16x32_bf16 v[156:159], a[40:43], v[36:39], v[156:159]
s_waitcnt vmcnt(23)
s_barrier
v_mfma_f32_16x16x32_bf16 v[168:171], a[44:47], v[36:39], v[168:171]
ds_read_b64_tr_b16 a[32:33], v9 offset:34176
ds_read_b64_tr_b16 a[34:35], v9 offset:34688
v_mfma_f32_16x16x32_bf16 v[164:167], a[44:47], v[32:35], v[164:167]
v_exp_f32 v41, v41
v_mfma_f32_16x16x32_bf16 v[160:163], a[44:47], v[28:31], v[160:163]
s_waitcnt lgkmcnt(6)
v_add_f32 v10, v10, v41
v_mfma_f32_16x16x32_bf16 v[172:175], a[16:19], v[28:31], v[172:175]
ds_read_b64_tr_b16 a[36:37], v9 offset:34208
ds_read_b64_tr_b16 a[38:39], v9 offset:34720
v_mfma_f32_16x16x32_bf16 v[176:179], a[16:19], v[32:35], v[176:179]
v_exp_f32 v42, v42
v_mfma_f32_16x16x32_bf16 v[180:183], a[16:19], v[36:39], v[180:183]
v_exp_f32 v43, v43
v_mfma_f32_16x16x32_bf16 v[192:195], a[20:23], v[36:39], v[192:195]
ds_read_b64_tr_b16 a[40:41], v9 offset:34240
ds_read_b64_tr_b16 a[42:43], v9 offset:34752
v_mfma_f32_16x16x32_bf16 v[188:191], a[20:23], v[32:35], v[188:191]
v_exp_f32 v44, v44
v_mfma_f32_16x16x32_bf16 v[184:187], a[20:23], v[28:31], v[184:187]
s_waitcnt lgkmcnt(6)
v_add_f32 v10, v10, v42
v_mfma_f32_16x16x32_bf16 v[196:199], a[24:27], v[28:31], v[196:199]
ds_read_b64_tr_b16 a[44:45], v9 offset:34272
ds_read_b64_tr_b16 a[46:47], v9 offset:34784
v_mfma_f32_16x16x32_bf16 v[200:203], a[24:27], v[32:35], v[200:203]
v_exp_f32 v45, v45
v_mfma_f32_16x16x32_bf16 v[204:207], a[24:27], v[36:39], v[204:207]
v_exp_f32 v46, v46
v_mfma_f32_16x16x32_bf16 v[216:219], a[28:31], v[36:39], v[216:219]
v_subrev_u32 v8, 50688, v8
ds_read_b128 a[16:19], v8 offset:34304
v_mfma_f32_16x16x32_bf16 v[212:215], a[28:31], v[32:35], v[212:215]
v_exp_f32 v47, v47
v_mfma_f32_16x16x32_bf16 v[208:211], a[28:31], v[28:31], v[208:211]
s_waitcnt lgkmcnt(5)
v_add_f32 v10, v10, v43
v_mfma_f32_16x16x32_bf16 v[220:223], a[32:35], v[28:31], v[220:223]
ds_read_b128 a[20:23], v8 offset:34368
v_add_f32 v11, v11, v44
v_mfma_f32_16x16x32_bf16 v[224:227], a[32:35], v[32:35], v[224:227]
v_exp_f32 v48, v48
v_mfma_f32_16x16x32_bf16 v[228:231], a[32:35], v[36:39], v[228:231]
v_exp_f32 v49, v49
v_mfma_f32_16x16x32_bf16 v[240:243], a[36:39], v[36:39], v[240:243]
ds_read_b128 a[24:27], v8 offset:34432
v_add_f32 v11, v11, v45
v_mfma_f32_16x16x32_bf16 v[236:239], a[36:39], v[32:35], v[236:239]
v_exp_f32 v50, v50
v_mfma_f32_16x16x32_bf16 v[232:235], a[36:39], v[28:31], v[232:235]
s_waitcnt lgkmcnt(3)
v_add_f32 v11, v11, v46
v_mfma_f32_16x16x32_bf16 v[244:247], a[40:43], v[28:31], v[244:247]
ds_read_b128 a[28:31], v8 offset:34496
v_add_f32 v11, v11, v47
v_mfma_f32_16x16x32_bf16 v[248:251], a[40:43], v[32:35], v[248:251]
v_exp_f32 v51, v51
v_mfma_f32_16x16x32_bf16 a[0:3], a[40:43], v[36:39], a[0:3]
buffer_load_dwordx4 v3, s[20:23], s50 offen offset:3168 nt lds
v_mfma_f32_16x16x32_bf16 a[12:15], a[44:47], v[36:39], a[12:15]
ds_read_b128 a[32:35], v8 offset:34560
v_add_f32 v12, v12, v48
v_mfma_f32_16x16x32_bf16 a[8:11], a[44:47], v[32:35], a[8:11]
v_add_f32 v12, v12, v49
v_add_f32 v12, v12, v50
v_mfma_f32_16x16x32_bf16 a[4:7], a[44:47], v[28:31], a[4:7]
s_waitcnt lgkmcnt(3)
v_add_f32 v12, v12, v51
LS_29:
v_mfma_f32_16x16x32_bf16 v[52:55], a[16:19], a[48:51], v[16:19]
ds_read_b128 a[36:39], v8 offset:34624
v_cvt_pk_bf16_f32 v30, v40, v41
v_mfma_f32_16x16x32_bf16 v[52:55], a[20:23], a[60:63], v[52:55]
v_exp_f32 v64, v64
v_mfma_f32_16x16x32_bf16 v[56:59], a[20:23], a[64:67], v[20:23]
v_exp_f32 v65, v65
v_mfma_f32_16x16x32_bf16 v[56:59], a[16:19], a[52:55], v[56:59]
ds_read_b128 a[40:43], v8 offset:34688
v_cvt_pk_bf16_f32 v31, v42, v43
v_mfma_f32_16x16x32_bf16 v[60:63], a[16:19], a[56:59], v[24:27]
v_exp_f32 v66, v66
v_mfma_f32_16x16x32_bf16 v[60:63], a[20:23], a[68:71], v[60:63]
s_waitcnt lgkmcnt(3)
v_cvt_pk_bf16_f32 v34, v44, v45
v_mfma_f32_16x16x32_bf16 v[60:63], a[24:27], a[80:83], v[60:63]
ds_read_b128 a[44:47], v8 offset:34752
v_cvt_pk_bf16_f32 v35, v46, v47
v_mfma_f32_16x16x32_bf16 v[60:63], a[28:31], a[92:95], v[60:63]
v_exp_f32 v67, v67
v_mfma_f32_16x16x32_bf16 v[56:59], a[28:31], a[88:91], v[56:59]
v_exp_f32 v68, v68
v_mfma_f32_16x16x32_bf16 v[56:59], a[24:27], a[76:79], v[56:59]
ds_read_b128 a[16:19], v8 offset:33792
v_cvt_pk_bf16_f32 v38, v48, v49
v_mfma_f32_16x16x32_bf16 v[52:55], a[24:27], a[72:75], v[52:55]
v_exp_f32 v69, v69
v_mfma_f32_16x16x32_bf16 v[52:55], a[28:31], a[84:87], v[52:55]
s_waitcnt lgkmcnt(3)
v_cvt_pk_bf16_f32 v39, v50, v51
v_mfma_f32_16x16x32_bf16 v[52:55], a[32:35], a[96:99], v[52:55]
ds_read_b128 a[20:23], v8 offset:33856
v_cvt_pk_bf16_f32 v28, v64, v65
v_mfma_f32_16x16x32_bf16 v[52:55], a[36:39], a[108:111], v[52:55]
v_exp_f32 v70, v70
v_mfma_f32_16x16x32_bf16 v[56:59], a[36:39], a[112:115], v[56:59]
v_exp_f32 v71, v71
v_mfma_f32_16x16x32_bf16 v[56:59], a[32:35], a[100:103], v[56:59]
ds_read_b128 a[24:27], v8 offset:33920
v_cvt_pk_bf16_f32 v29, v66, v67
v_mfma_f32_16x16x32_bf16 v[60:63], a[32:35], a[104:107], v[60:63]
v_exp_f32 v72, v72
v_mfma_f32_16x16x32_bf16 v[60:63], a[36:39], a[116:119], v[60:63]
s_waitcnt lgkmcnt(3)
v_cvt_pk_bf16_f32 v32, v68, v69
v_mfma_f32_16x16x32_bf16 v[60:63], a[40:43], a[128:131], v[60:63]
ds_read_b128 a[28:31], v8 offset:33984
v_cvt_pk_bf16_f32 v33, v70, v71
v_mfma_f32_16x16x32_bf16 v[60:63], a[44:47], a[140:143], v[60:63]
v_exp_f32 v73, v73
v_mfma_f32_16x16x32_bf16 v[56:59], a[44:47], a[136:139], v[56:59]
s_waitcnt vmcnt(20)
s_barrier
v_mfma_f32_16x16x32_bf16 v[56:59], a[40:43], a[124:127], v[56:59]
ds_read_b128 a[32:35], v8 offset:34048
v_cvt_pk_bf16_f32 v36, v72, v73
v_mfma_f32_16x16x32_bf16 v[52:55], a[40:43], a[120:123], v[52:55]
v_exp_f32 v74, v74
v_mfma_f32_16x16x32_bf16 v[52:55], a[44:47], a[132:135], v[52:55]
s_waitcnt lgkmcnt(3)
v_add_f32 v10, v10, v64
v_mfma_f32_16x16x32_bf16 v[40:43], a[16:19], a[48:51], v[16:19]
ds_read_b128 a[36:39], v8 offset:34112
v_add_f32 v10, v10, v65
v_mfma_f32_16x16x32_bf16 v[40:43], a[20:23], a[60:63], v[40:43]
v_exp_f32 v75, v75
v_mfma_f32_16x16x32_bf16 v[44:47], a[20:23], a[64:67], v[20:23]
v_cvt_pk_bf16_f32 v37, v74, v75
v_add_f32 v10, v10, v66
v_mfma_f32_16x16x32_bf16 v[44:47], a[16:19], a[52:55], v[44:47]
ds_read_b128 a[40:43], v8 offset:34176
v_max3_f32 v13, v52, v53, v54
v_mfma_f32_16x16x32_bf16 v[48:51], a[16:19], a[56:59], v[24:27]
v_max3_f32 v13, v13, v55, v56
v_add_f32 v10, v10, v67
v_mfma_f32_16x16x32_bf16 v[48:51], a[20:23], a[68:71], v[48:51]
s_waitcnt lgkmcnt(3)
v_max3_f32 v13, v13, v57, v58
v_mfma_f32_16x16x32_bf16 v[48:51], a[24:27], a[80:83], v[48:51]
ds_read_b128 a[44:47], v8 offset:34240
v_max3_f32 v13, v13, v59, v60
v_mfma_f32_16x16x32_bf16 v[48:51], a[28:31], a[92:95], v[48:51]
v_max3_f32 v13, v13, v61, v62
v_add_f32 v11, v11, v68
v_mfma_f32_16x16x32_bf16 v[44:47], a[28:31], a[88:91], v[44:47]
v_add_f32 v11, v11, v69
v_add_f32 v11, v11, v70
v_mfma_f32_16x16x32_bf16 v[44:47], a[24:27], a[76:79], v[44:47]
v_add_u32 v9, 84480, v9
ds_read_b64_tr_b16 a[16:17], v9 offset:0
v_mfma_f32_16x16x32_bf16 v[40:43], a[24:27], a[72:75], v[40:43]
ds_read_b64_tr_b16 a[18:19], v9 offset:512
v_add_f32 v11, v11, v71
v_mfma_f32_16x16x32_bf16 v[40:43], a[28:31], a[84:87], v[40:43]
s_waitcnt lgkmcnt(4)
v_add_f32 v12, v12, v72
v_mfma_f32_16x16x32_bf16 v[40:43], a[32:35], a[96:99], v[40:43]
ds_read_b64_tr_b16 a[20:21], v9 offset:32
v_add_f32 v12, v12, v73
v_mfma_f32_16x16x32_bf16 v[40:43], a[36:39], a[108:111], v[40:43]
ds_read_b64_tr_b16 a[22:23], v9 offset:544
v_add_f32 v12, v12, v74
v_mfma_f32_16x16x32_bf16 v[44:47], a[36:39], a[112:115], v[44:47]
v_add_f32 v12, v12, v75
v_max_f32 v13, v13, v63
v_mfma_f32_16x16x32_bf16 v[44:47], a[32:35], a[100:103], v[44:47]
ds_read_b64_tr_b16 a[24:25], v9 offset:64
v_mfma_f32_16x16x32_bf16 v[48:51], a[32:35], a[104:107], v[48:51]
ds_read_b64_tr_b16 a[26:27], v9 offset:576
v_mfma_f32_16x16x32_bf16 v[48:51], a[36:39], a[116:119], v[48:51]
s_waitcnt lgkmcnt(6)
v_mfma_f32_16x16x32_bf16 v[48:51], a[40:43], a[128:131], v[48:51]
ds_read_b64_tr_b16 a[28:29], v9 offset:96
v_mfma_f32_16x16x32_bf16 v[48:51], a[44:47], a[140:143], v[48:51]
ds_read_b64_tr_b16 a[30:31], v9 offset:608
v_mfma_f32_16x16x32_bf16 v[44:47], a[44:47], a[136:139], v[44:47]
v_mfma_f32_16x16x32_bf16 v[44:47], a[40:43], a[124:127], v[44:47]
ds_read_b64_tr_b16 a[32:33], v9 offset:128
v_mfma_f32_16x16x32_bf16 v[40:43], a[40:43], a[120:123], v[40:43]
ds_read_b64_tr_b16 a[34:35], v9 offset:640
v_mfma_f32_16x16x32_bf16 v[40:43], a[44:47], a[132:135], v[40:43]
s_waitcnt lgkmcnt(6)
LS_30:
v_mfma_f32_16x16x32_bf16 v[76:79], a[16:19], v[28:31], v[76:79]
ds_read_b64_tr_b16 a[36:37], v9 offset:160
v_mfma_f32_16x16x32_bf16 v[80:83], a[16:19], v[32:35], v[80:83]
ds_read_b64_tr_b16 a[38:39], v9 offset:672
v_mfma_f32_16x16x32_bf16 v[84:87], a[16:19], v[36:39], v[84:87]
s_add_u32 m0, s17, 33792
s_mov_b32 s50, 163840
v_mfma_f32_16x16x32_bf16 v[96:99], a[20:23], v[36:39], v[96:99]
ds_read_b64_tr_b16 a[40:41], v9 offset:192
v_max3_f32 v13, v13, v40, v41
v_mfma_f32_16x16x32_bf16 v[92:95], a[20:23], v[32:35], v[92:95]
ds_read_b64_tr_b16 a[42:43], v9 offset:704
v_max3_f32 v13, v13, v42, v43
v_mfma_f32_16x16x32_bf16 v[88:91], a[20:23], v[28:31], v[88:91]
s_waitcnt lgkmcnt(6)
v_max3_f32 v13, v13, v44, v45
v_mfma_f32_16x16x32_bf16 v[100:103], a[24:27], v[28:31], v[100:103]
ds_read_b64_tr_b16 a[44:45], v9 offset:224
v_max3_f32 v13, v13, v46, v47
v_mfma_f32_16x16x32_bf16 v[104:107], a[24:27], v[32:35], v[104:107]
ds_read_b64_tr_b16 a[46:47], v9 offset:736
v_max3_f32 v13, v13, v48, v49
v_mfma_f32_16x16x32_bf16 v[108:111], a[24:27], v[36:39], v[108:111]
buffer_load_dwordx4 v0, s[24:27], s50 offen offset:0 nt lds
v_mfma_f32_16x16x32_bf16 v[120:123], a[28:31], v[36:39], v[120:123]
ds_read_b64_tr_b16 a[16:17], v9 offset:256
v_max3_f32 v13, v13, v50, v51
v_mfma_f32_16x16x32_bf16 v[116:119], a[28:31], v[32:35], v[116:119]
ds_read_b64_tr_b16 a[18:19], v9 offset:768
v_cmp_lt_f32 vcc, s47, v13
v_mfma_f32_16x16x32_bf16 v[112:115], a[28:31], v[28:31], v[112:115]
s_waitcnt lgkmcnt(6)
v_mfma_f32_16x16x32_bf16 v[124:127], a[32:35], v[28:31], v[124:127]
ds_read_b64_tr_b16 a[20:21], v9 offset:288
ds_read_b64_tr_b16 a[22:23], v9 offset:800
v_mfma_f32_16x16x32_bf16 v[128:131], a[32:35], v[32:35], v[128:131]
s_cbranch_vccnz RARE_h0j7
RET_h0j7:
v_mfma_f32_16x16x32_bf16 v[132:135], a[32:35], v[36:39], v[132:135]
buffer_load_dwordx4 v1, s[24:27], s50 offen offset:1056 nt lds
v_mfma_f32_16x16x32_bf16 v[144:147], a[36:39], v[36:39], v[144:147]
ds_read_b64_tr_b16 a[24:25], v9 offset:320
ds_read_b64_tr_b16 a[26:27], v9 offset:832
v_mfma_f32_16x16x32_bf16 v[140:143], a[36:39], v[32:35], v[140:143]
v_exp_f32 v40, v40
v_mfma_f32_16x16x32_bf16 v[136:139], a[36:39], v[28:31], v[136:139]
s_waitcnt lgkmcnt(6)
v_add_f32 v10, v10, v40
v_mfma_f32_16x16x32_bf16 v[148:151], a[40:43], v[28:31], v[148:151]
ds_read_b64_tr_b16 a[28:29], v9 offset:352
ds_read_b64_tr_b16 a[30:31], v9 offset:864
v_mfma_f32_16x16x32_bf16 v[152:155], a[40:43], v[32:35], v[152:155]
buffer_load_dwordx4 v2, s[24:27], s50 offen offset:2112 nt lds
v_mfma_f32_16x16x32_bf16 v[156:159], a[40:43], v[36:39], v[156:159]
s_waitcnt vmcnt(19)
s_barrier
v_mfma_f32_16x16x32_bf16 v[168:171], a[44:47], v[36:39], v[168:171]
ds_read_b64_tr_b16 a[32:33], v9 offset:384
ds_read_b64_tr_b16 a[34:35], v9 offset:896
v_mfma_f32_16x16x32_bf16 v[164:167], a[44:47], v[32:35], v[164:167]
v_exp_f32 v41, v41
v_mfma_f32_16x16x32_bf16 v[160:163], a[44:47], v[28:31], v[160:163]
s_waitcnt lgkmcnt(6)
v_add_f32 v10, v10, v41
v_mfma_f32_16x16x32_bf16 v[172:175], a[16:19], v[28:31], v[172:175]
ds_read_b64_tr_b16 a[36:37], v9 offset:416
ds_read_b64_tr_b16 a[38:39], v9 offset:928
v_mfma_f32_16x16x32_bf16 v[176:179], a[16:19], v[32:35], v[176:179]
v_exp_f32 v42, v42
v_mfma_f32_16x16x32_bf16 v[180:183], a[16:19], v[36:39], v[180:183]
v_exp_f32 v43, v43
v_mfma_f32_16x16x32_bf16 v[192:195], a[20:23], v[36:39], v[192:195]
ds_read_b64_tr_b16 a[40:41], v9 offset:448
ds_read_b64_tr_b16 a[42:43], v9 offset:960
v_mfma_f32_16x16x32_bf16 v[188:191], a[20:23], v[32:35], v[188:191]
v_exp_f32 v44, v44
v_mfma_f32_16x16x32_bf16 v[184:187], a[20:23], v[28:31], v[184:187]
s_waitcnt lgkmcnt(6)
v_add_f32 v10, v10, v42
v_mfma_f32_16x16x32_bf16 v[196:199], a[24:27], v[28:31], v[196:199]
ds_read_b64_tr_b16 a[44:45], v9 offset:480
ds_read_b64_tr_b16 a[46:47], v9 offset:992
v_mfma_f32_16x16x32_bf16 v[200:203], a[24:27], v[32:35], v[200:203]
v_exp_f32 v45, v45
v_mfma_f32_16x16x32_bf16 v[204:207], a[24:27], v[36:39], v[204:207]
v_exp_f32 v46, v46
v_mfma_f32_16x16x32_bf16 v[216:219], a[28:31], v[36:39], v[216:219]
v_add_u32 v8, 50688, v8
ds_read_b128 a[16:19], v8 offset:16896
v_mfma_f32_16x16x32_bf16 v[212:215], a[28:31], v[32:35], v[212:215]
v_exp_f32 v47, v47
v_mfma_f32_16x16x32_bf16 v[208:211], a[28:31], v[28:31], v[208:211]
s_waitcnt lgkmcnt(5)
v_add_f32 v10, v10, v43
v_mfma_f32_16x16x32_bf16 v[220:223], a[32:35], v[28:31], v[220:223]
ds_read_b128 a[20:23], v8 offset:16960
v_add_f32 v11, v11, v44
v_mfma_f32_16x16x32_bf16 v[224:227], a[32:35], v[32:35], v[224:227]
v_exp_f32 v48, v48
v_mfma_f32_16x16x32_bf16 v[228:231], a[32:35], v[36:39], v[228:231]
v_exp_f32 v49, v49
v_mfma_f32_16x16x32_bf16 v[240:243], a[36:39], v[36:39], v[240:243]
ds_read_b128 a[24:27], v8 offset:17024
v_add_f32 v11, v11, v45
v_mfma_f32_16x16x32_bf16 v[236:239], a[36:39], v[32:35], v[236:239]
v_exp_f32 v50, v50
v_mfma_f32_16x16x32_bf16 v[232:235], a[36:39], v[28:31], v[232:235]
s_waitcnt lgkmcnt(3)
v_add_f32 v11, v11, v46
v_mfma_f32_16x16x32_bf16 v[244:247], a[40:43], v[28:31], v[244:247]
ds_read_b128 a[28:31], v8 offset:17088
v_add_f32 v11, v11, v47
v_mfma_f32_16x16x32_bf16 v[248:251], a[40:43], v[32:35], v[248:251]
v_exp_f32 v51, v51
v_mfma_f32_16x16x32_bf16 a[0:3], a[40:43], v[36:39], a[0:3]
buffer_load_dwordx4 v3, s[24:27], s50 offen offset:3168 nt lds
v_mfma_f32_16x16x32_bf16 a[12:15], a[44:47], v[36:39], a[12:15]
ds_read_b128 a[32:35], v8 offset:17152
v_add_f32 v12, v12, v48
v_mfma_f32_16x16x32_bf16 a[8:11], a[44:47], v[32:35], a[8:11]
v_add_f32 v12, v12, v49
v_add_f32 v12, v12, v50
v_mfma_f32_16x16x32_bf16 a[4:7], a[44:47], v[28:31], a[4:7]
s_waitcnt lgkmcnt(3)
v_add_f32 v12, v12, v51
LS_31:
v_mfma_f32_16x16x32_bf16 v[64:67], a[16:19], a[48:51], v[16:19]
ds_read_b128 a[36:39], v8 offset:17216
v_cvt_pk_bf16_f32 v28, v40, v41
v_mfma_f32_16x16x32_bf16 v[64:67], a[20:23], a[60:63], v[64:67]
s_add_u32 m0, s17, 118272
s_mov_b32 s50, 196608
v_mfma_f32_16x16x32_bf16 v[68:71], a[20:23], a[64:67], v[20:23]
buffer_load_dwordx4 v0, s[20:23], s50 offen offset:0 nt lds
v_mfma_f32_16x16x32_bf16 v[68:71], a[16:19], a[52:55], v[68:71]
ds_read_b128 a[40:43], v8 offset:17280
v_cvt_pk_bf16_f32 v29, v42, v43
v_mfma_f32_16x16x32_bf16 v[72:75], a[16:19], a[56:59], v[24:27]
v_exp_f32 v52, v52
v_mfma_f32_16x16x32_bf16 v[72:75], a[20:23], a[68:71], v[72:75]
s_waitcnt lgkmcnt(3)
v_cvt_pk_bf16_f32 v32, v44, v45
v_mfma_f32_16x16x32_bf16 v[72:75], a[24:27], a[80:83], v[72:75]
ds_read_b128 a[44:47], v8 offset:17344
v_cvt_pk_bf16_f32 v33, v46, v47
v_mfma_f32_16x16x32_bf16 v[72:75], a[28:31], a[92:95], v[72:75]
buffer_load_dwordx4 v1, s[20:23], s50 offen offset:1056 nt lds
v_mfma_f32_16x16x32_bf16 v[68:71], a[28:31], a[88:91], v[68:71]
v_exp_f32 v53, v53
v_mfma_f32_16x16x32_bf16 v[68:71], a[24:27], a[76:79], v[68:71]
ds_read_b128 a[16:19], v8 offset:17408
v_cvt_pk_bf16_f32 v36, v48, v49
v_mfma_f32_16x16x32_bf16 v[64:67], a[24:27], a[72:75], v[64:67]
v_exp_f32 v54, v54
v_mfma_f32_16x16x32_bf16 v[64:67], a[28:31], a[84:87], v[64:67]
s_waitcnt lgkmcnt(3)
v_cvt_pk_bf16_f32 v37, v50, v51
v_mfma_f32_16x16x32_bf16 v[64:67], a[32:35], a[96:99], v[64:67]
ds_read_b128 a[20:23], v8 offset:17472
v_cvt_pk_bf16_f32 v30, v52, v53
v_mfma_f32_16x16x32_bf16 v[64:67], a[36:39], a[108:111], v[64:67]
v_exp_f32 v55, v55
v_mfma_f32_16x16x32_bf16 v[68:71], a[36:39], a[112:115], v[68:71]
v_exp_f32 v56, v56
v_mfma_f32_16x16x32_bf16 v[68:71], a[32:35], a[100:103], v[68:71]
ds_read_b128 a[24:27], v8 offset:17536
v_cvt_pk_bf16_f32 v31, v54, v55
v_mfma_f32_16x16x32_bf16 v[72:75], a[32:35], a[104:107], v[72:75]
v_exp_f32 v57, v57
v_mfma_f32_16x16x32_bf16 v[72:75], a[36:39], a[116:119], v[72:75]
s_waitcnt lgkmcnt(3)
v_cvt_pk_bf16_f32 v34, v56, v57
v_mfma_f32_16x16x32_bf16 v[72:75], a[40:43], a[128:131], v[72:75]
ds_read_b128 a[28:31], v8 offset:17600
v_add_f32 v10, v10, v52
v_mfma_f32_16x16x32_bf16 v[72:75], a[44:47], a[140:143], v[72:75]
v_exp_f32 v58, v58
v_mfma_f32_16x16x32_bf16 v[68:71], a[44:47], a[136:139], v[68:71]
s_waitcnt vmcnt(18)
s_barrier
v_mfma_f32_16x16x32_bf16 v[68:71], a[40:43], a[124:127], v[68:71]
ds_read_b128 a[32:35], v8 offset:17664
v_add_f32 v10, v10, v53
v_mfma_f32_16x16x32_bf16 v[64:67], a[40:43], a[120:123], v[64:67]
v_exp_f32 v59, v59
v_mfma_f32_16x16x32_bf16 v[64:67], a[44:47], a[132:135], v[64:67]
s_waitcnt lgkmcnt(3)
v_cvt_pk_bf16_f32 v35, v58, v59
v_mfma_f32_16x16x32_bf16 v[40:43], a[16:19], a[48:51], v[16:19]
ds_read_b128 a[36:39], v8 offset:17728
v_add_f32 v10, v10, v54
v_mfma_f32_16x16x32_bf16 v[40:43], a[20:23], a[60:63], v[40:43]
v_exp_f32 v60, v60
v_mfma_f32_16x16x32_bf16 v[44:47], a[20:23], a[64:67], v[20:23]
v_exp_f32 v61, v61
v_mfma_f32_16x16x32_bf16 v[44:47], a[16:19], a[52:55], v[44:47]
ds_read_b128 a[40:43], v8 offset:17792
v_max3_f32 v13, v64, v65, v66
v_mfma_f32_16x16x32_bf16 v[48:51], a[16:19], a[56:59], v[24:27]
v_exp_f32 v62, v62
v_mfma_f32_16x16x32_bf16 v[48:51], a[20:23], a[68:71], v[48:51]
s_waitcnt lgkmcnt(3)
v_max3_f32 v13, v13, v67, v68
v_mfma_f32_16x16x32_bf16 v[48:51], a[24:27], a[80:83], v[48:51]
ds_read_b128 a[44:47], v8 offset:17856
v_max3_f32 v13, v13, v69, v70
v_mfma_f32_16x16x32_bf16 v[48:51], a[28:31], a[92:95], v[48:51]
v_exp_f32 v63, v63
v_mfma_f32_16x16x32_bf16 v[44:47], a[28:31], a[88:91], v[44:47]
buffer_load_dwordx4 v2, s[20:23], s50 offen offset:2112 nt lds
v_mfma_f32_16x16x32_bf16 v[44:47], a[24:27], a[76:79], v[44:47]
v_subrev_u32 v9, 84480, v9
ds_read_b64_tr_b16 a[16:17], v9 offset:16896
v_mfma_f32_16x16x32_bf16 v[40:43], a[24:27], a[72:75], v[40:43]
ds_read_b64_tr_b16 a[18:19], v9 offset:17408
v_cvt_pk_bf16_f32 v38, v60, v61
v_mfma_f32_16x16x32_bf16 v[40:43], a[28:31], a[84:87], v[40:43]
s_waitcnt lgkmcnt(4)
v_cvt_pk_bf16_f32 v39, v62, v63
v_mfma_f32_16x16x32_bf16 v[40:43], a[32:35], a[96:99], v[40:43]
ds_read_b64_tr_b16 a[20:21], v9 offset:16928
v_max3_f32 v13, v13, v71, v72
v_mfma_f32_16x16x32_bf16 v[40:43], a[36:39], a[108:111], v[40:43]
ds_read_b64_tr_b16 a[22:23], v9 offset:17440
v_max3_f32 v13, v13, v73, v74
v_mfma_f32_16x16x32_bf16 v[44:47], a[36:39], a[112:115], v[44:47]
buffer_load_dwordx4 v3, s[20:23], s50 offen offset:3168 nt lds
v_mfma_f32_16x16x32_bf16 v[44:47], a[32:35], a[100:103], v[44:47]
ds_read_b64_tr_b16 a[24:25], v9 offset:16960
v_add_f32 v10, v10, v55
v_mfma_f32_16x16x32_bf16 v[48:51], a[32:35], a[104:107], v[48:51]
ds_read_b64_tr_b16 a[26:27], v9 offset:17472
v_add_f32 v11, v11, v56
v_mfma_f32_16x16x32_bf16 v[48:51], a[36:39], a[116:119], v[48:51]
s_waitcnt lgkmcnt(6)
v_add_f32 v11, v11, v57
v_mfma_f32_16x16x32_bf16 v[48:51], a[40:43], a[128:131], v[48:51]
ds_read_b64_tr_b16 a[28:29], v9 offset:16992
v_add_f32 v11, v11, v58
v_mfma_f32_16x16x32_bf16 v[48:51], a[44:47], a[140:143], v[48:51]
ds_read_b64_tr_b16 a[30:31], v9 offset:17504
v_add_f32 v11, v11, v59
v_mfma_f32_16x16x32_bf16 v[44:47], a[44:47], a[136:139], v[44:47]
v_add_f32 v12, v12, v60
v_add_f32 v12, v12, v61
v_mfma_f32_16x16x32_bf16 v[44:47], a[40:43], a[124:127], v[44:47]
ds_read_b64_tr_b16 a[32:33], v9 offset:17024
v_add_f32 v12, v12, v62
v_mfma_f32_16x16x32_bf16 v[40:43], a[40:43], a[120:123], v[40:43]
ds_read_b64_tr_b16 a[34:35], v9 offset:17536
v_add_f32 v12, v12, v63
v_mfma_f32_16x16x32_bf16 v[40:43], a[44:47], a[132:135], v[40:43]
s_waitcnt lgkmcnt(6)
v_max_f32 v13, v13, v75
LS_32:
v_mfma_f32_16x16x32_bf16 v[76:79], a[16:19], v[28:31], v[76:79]
ds_read_b64_tr_b16 a[36:37], v9 offset:17056
v_mfma_f32_16x16x32_bf16 v[80:83], a[16:19], v[32:35], v[80:83]
ds_read_b64_tr_b16 a[38:39], v9 offset:17568
v_mfma_f32_16x16x32_bf16 v[84:87], a[16:19], v[36:39], v[84:87]
v_mfma_f32_16x16x32_bf16 v[96:99], a[20:23], v[36:39], v[96:99]
ds_read_b64_tr_b16 a[40:41], v9 offset:17088
v_max3_f32 v13, v13, v40, v41
v_mfma_f32_16x16x32_bf16 v[92:95], a[20:23], v[32:35], v[92:95]
ds_read_b64_tr_b16 a[42:43], v9 offset:17600
v_max3_f32 v13, v13, v42, v43
v_mfma_f32_16x16x32_bf16 v[88:91], a[20:23], v[28:31], v[88:91]
s_waitcnt lgkmcnt(6)
v_max3_f32 v13, v13, v44, v45
v_mfma_f32_16x16x32_bf16 v[100:103], a[24:27], v[28:31], v[100:103]
ds_read_b64_tr_b16 a[44:45], v9 offset:17120
v_max3_f32 v13, v13, v46, v47
v_mfma_f32_16x16x32_bf16 v[104:107], a[24:27], v[32:35], v[104:107]
ds_read_b64_tr_b16 a[46:47], v9 offset:17632
v_max3_f32 v13, v13, v48, v49
v_mfma_f32_16x16x32_bf16 v[108:111], a[24:27], v[36:39], v[108:111]
v_max3_f32 v13, v13, v50, v51
v_mfma_f32_16x16x32_bf16 v[120:123], a[28:31], v[36:39], v[120:123]
ds_read_b64_tr_b16 a[16:17], v9 offset:17152
v_cmp_lt_f32 vcc, s47, v13
v_mfma_f32_16x16x32_bf16 v[116:119], a[28:31], v[32:35], v[116:119]
ds_read_b64_tr_b16 a[18:19], v9 offset:17664
v_mfma_f32_16x16x32_bf16 v[112:115], a[28:31], v[28:31], v[112:115]
s_waitcnt lgkmcnt(6)
s_cbranch_vccnz RARE_h0j8
RET_h0j8:
v_mfma_f32_16x16x32_bf16 v[124:127], a[32:35], v[28:31], v[124:127]
ds_read_b64_tr_b16 a[20:21], v9 offset:17184
ds_read_b64_tr_b16 a[22:23], v9 offset:17696
v_mfma_f32_16x16x32_bf16 v[128:131], a[32:35], v[32:35], v[128:131]
v_exp_f32 v40, v40
v_mfma_f32_16x16x32_bf16 v[132:135], a[32:35], v[36:39], v[132:135]
v_exp_f32 v41, v41
v_mfma_f32_16x16x32_bf16 v[144:147], a[36:39], v[36:39], v[144:147]
ds_read_b64_tr_b16 a[24:25], v9 offset:17216
ds_read_b64_tr_b16 a[26:27], v9 offset:17728
v_mfma_f32_16x16x32_bf16 v[140:143], a[36:39], v[32:35], v[140:143]
v_exp_f32 v42, v42
v_mfma_f32_16x16x32_bf16 v[136:139], a[36:39], v[28:31], v[136:139]
s_waitcnt lgkmcnt(6)
v_add_f32 v10, v10, v40
v_mfma_f32_16x16x32_bf16 v[148:151], a[40:43], v[28:31], v[148:151]
ds_read_b64_tr_b16 a[28:29], v9 offset:17248
ds_read_b64_tr_b16 a[30:31], v9 offset:17760
v_mfma_f32_16x16x32_bf16 v[152:155], a[40:43], v[32:35], v[152:155]
v_exp_f32 v43, v43
v_mfma_f32_16x16x32_bf16 v[156:159], a[40:43], v[36:39], v[156:159]
s_waitcnt vmcnt(16)
s_barrier
v_mfma_f32_16x16x32_bf16 v[168:171], a[44:47], v[36:39], v[168:171]
ds_read_b64_tr_b16 a[32:33], v9 offset:17280
ds_read_b64_tr_b16 a[34:35], v9 offset:17792
v_mfma_f32_16x16x32_bf16 v[164:167], a[44:47], v[32:35], v[164:167]
v_exp_f32 v44, v44
v_mfma_f32_16x16x32_bf16 v[160:163], a[44:47], v[28:31], v[160:163]
s_waitcnt lgkmcnt(6)
v_add_f32 v10, v10, v41
v_mfma_f32_16x16x32_bf16 v[172:175], a[16:19], v[28:31], v[172:175]
ds_read_b64_tr_b16 a[36:37], v9 offset:17312
ds_read_b64_tr_b16 a[38:39], v9 offset:17824
v_mfma_f32_16x16x32_bf16 v[176:179], a[16:19], v[32:35], v[176:179]
v_exp_f32 v45, v45
v_mfma_f32_16x16x32_bf16 v[180:183], a[16:19], v[36:39], v[180:183]
v_exp_f32 v46, v46
v_mfma_f32_16x16x32_bf16 v[192:195], a[20:23], v[36:39], v[192:195]
ds_read_b64_tr_b16 a[40:41], v9 offset:17344
ds_read_b64_tr_b16 a[42:43], v9 offset:17856
v_mfma_f32_16x16x32_bf16 v[188:191], a[20:23], v[32:35], v[188:191]
v_exp_f32 v47, v47
v_mfma_f32_16x16x32_bf16 v[184:187], a[20:23], v[28:31], v[184:187]
s_waitcnt lgkmcnt(6)
v_add_f32 v10, v10, v42
v_mfma_f32_16x16x32_bf16 v[196:199], a[24:27], v[28:31], v[196:199]
ds_read_b64_tr_b16 a[44:45], v9 offset:17376
ds_read_b64_tr_b16 a[46:47], v9 offset:17888
v_mfma_f32_16x16x32_bf16 v[200:203], a[24:27], v[32:35], v[200:203]
v_exp_f32 v48, v48
v_mfma_f32_16x16x32_bf16 v[204:207], a[24:27], v[36:39], v[204:207]
v_exp_f32 v49, v49
v_mfma_f32_16x16x32_bf16 v[216:219], a[28:31], v[36:39], v[216:219]
v_subrev_u32 v8, 67584, v8
ds_read_b128 a[16:19], v8 offset:34304
v_mfma_f32_16x16x32_bf16 v[212:215], a[28:31], v[32:35], v[212:215]
v_exp_f32 v50, v50
v_mfma_f32_16x16x32_bf16 v[208:211], a[28:31], v[28:31], v[208:211]
s_waitcnt lgkmcnt(5)
v_add_f32 v10, v10, v43
v_mfma_f32_16x16x32_bf16 v[220:223], a[32:35], v[28:31], v[220:223]
ds_read_b128 a[20:23], v8 offset:34368
v_add_f32 v11, v11, v44
v_mfma_f32_16x16x32_bf16 v[224:227], a[32:35], v[32:35], v[224:227]
v_exp_f32 v51, v51
v_mfma_f32_16x16x32_bf16 v[228:231], a[32:35], v[36:39], v[228:231]
v_add_f32 v11, v11, v45
v_add_f32 v11, v11, v46
v_mfma_f32_16x16x32_bf16 v[240:243], a[36:39], v[36:39], v[240:243]
ds_read_b128 a[24:27], v8 offset:34432
v_add_f32 v11, v11, v47
v_mfma_f32_16x16x32_bf16 v[236:239], a[36:39], v[32:35], v[236:239]
v_add_f32 v12, v12, v48
v_add_f32 v12, v12, v49
v_mfma_f32_16x16x32_bf16 v[232:235], a[36:39], v[28:31], v[232:235]
s_waitcnt lgkmcnt(3)
v_add_f32 v12, v12, v50
v_mfma_f32_16x16x32_bf16 v[244:247], a[40:43], v[28:31], v[244:247]
ds_read_b128 a[28:31], v8 offset:34496
v_add_f32 v12, v12, v51
v_mfma_f32_16x16x32_bf16 v[248:251], a[40:43], v[32:35], v[248:251]
v_mfma_f32_16x16x32_bf16 a[0:3], a[40:43], v[36:39], a[0:3]
v_mfma_f32_16x16x32_bf16 a[12:15], a[44:47], v[36:39], a[12:15]
ds_read_b128 a[32:35], v8 offset:34560
v_mfma_f32_16x16x32_bf16 a[8:11], a[44:47], v[32:35], a[8:11]
v_mfma_f32_16x16x32_bf16 a[4:7], a[44:47], v[28:31], a[4:7]
s_waitcnt lgkmcnt(3)
LS_33:
v_mfma_f32_16x16x32_bf16 v[52:55], a[16:19], a[48:51], v[16:19]
ds_read_b128 a[36:39], v8 offset:34624
v_cvt_pk_bf16_f32 v30, v40, v41
v_mfma_f32_16x16x32_bf16 v[52:55], a[20:23], a[60:63], v[52:55]
v_exp_f32 v64, v64
v_mfma_f32_16x16x32_bf16 v[56:59], a[20:23], a[64:67], v[20:23]
v_exp_f32 v65, v65
v_mfma_f32_16x16x32_bf16 v[56:59], a[16:19], a[52:55], v[56:59]
ds_read_b128 a[40:43], v8 offset:34688
v_cvt_pk_bf16_f32 v31, v42, v43
v_mfma_f32_16x16x32_bf16 v[60:63], a[16:19], a[56:59], v[24:27]
v_exp_f32 v66, v66
v_mfma_f32_16x16x32_bf16 v[60:63], a[20:23], a[68:71], v[60:63]
s_waitcnt lgkmcnt(3)
v_cvt_pk_bf16_f32 v34, v44, v45
v_mfma_f32_16x16x32_bf16 v[60:63], a[24:27], a[80:83], v[60:63]
ds_read_b128 a[44:47], v8 offset:34752
v_cvt_pk_bf16_f32 v35, v46, v47
v_mfma_f32_16x16x32_bf16 v[60:63], a[28:31], a[92:95], v[60:63]
v_exp_f32 v67, v67
v_mfma_f32_16x16x32_bf16 v[56:59], a[28:31], a[88:91], v[56:59]
v_exp_f32 v68, v68
v_mfma_f32_16x16x32_bf16 v[56:59], a[24:27], a[76:79], v[56:59]
ds_read_b128 a[16:19], v8 offset:33792
v_cvt_pk_bf16_f32 v38, v48, v49
v_mfma_f32_16x16x32_bf16 v[52:55], a[24:27], a[72:75], v[52:55]
v_exp_f32 v69, v69
v_mfma_f32_16x16x32_bf16 v[52:55], a[28:31], a[84:87], v[52:55]
s_waitcnt lgkmcnt(3)
v_cvt_pk_bf16_f32 v39, v50, v51
v_mfma_f32_16x16x32_bf16 v[52:55], a[32:35], a[96:99], v[52:55]
ds_read_b128 a[20:23], v8 offset:33856
v_cvt_pk_bf16_f32 v28, v64, v65
v_mfma_f32_16x16x32_bf16 v[52:55], a[36:39], a[108:111], v[52:55]
v_exp_f32 v70, v70
v_mfma_f32_16x16x32_bf16 v[56:59], a[36:39], a[112:115], v[56:59]
v_exp_f32 v71, v71
v_mfma_f32_16x16x32_bf16 v[56:59], a[32:35], a[100:103], v[56:59]
ds_read_b128 a[24:27], v8 offset:33920
v_cvt_pk_bf16_f32 v29, v66, v67
v_mfma_f32_16x16x32_bf16 v[60:63], a[32:35], a[104:107], v[60:63]
v_exp_f32 v72, v72
v_mfma_f32_16x16x32_bf16 v[60:63], a[36:39], a[116:119], v[60:63]
s_waitcnt lgkmcnt(3)
v_cvt_pk_bf16_f32 v32, v68, v69
v_mfma_f32_16x16x32_bf16 v[60:63], a[40:43], a[128:131], v[60:63]
ds_read_b128 a[28:31], v8 offset:33984
v_cvt_pk_bf16_f32 v33, v70, v71
v_mfma_f32_16x16x32_bf16 v[60:63], a[44:47], a[140:143], v[60:63]
v_exp_f32 v73, v73
v_mfma_f32_16x16x32_bf16 v[56:59], a[44:47], a[136:139], v[56:59]
s_waitcnt vmcnt(12)
s_barrier
v_mfma_f32_16x16x32_bf16 v[56:59], a[40:43], a[124:127], v[56:59]
ds_read_b128 a[32:35], v8 offset:34048
v_cvt_pk_bf16_f32 v36, v72, v73
v_mfma_f32_16x16x32_bf16 v[52:55], a[40:43], a[120:123], v[52:55]
s_add_u32 m0, s17, 16896
s_mov_b32 s50, 180224
v_mfma_f32_16x16x32_bf16 v[52:55], a[44:47], a[132:135], v[52:55]
s_waitcnt lgkmcnt(3)
v_add_f32 v10, v10, v64
v_mfma_f32_16x16x32_bf16 v[40:43], a[16:19], a[48:51], v[16:19]
ds_read_b128 a[36:39], v8 offset:34112
v_add_f32 v10, v10, v65
v_mfma_f32_16x16x32_bf16 v[40:43], a[20:23], a[60:63], v[40:43]
buffer_load_dwordx4 v0, s[24:27], s50 offen offset:0 nt lds
v_mfma_f32_16x16x32_bf16 v[44:47], a[20:23], a[64:67], v[20:23]
v_exp_f32 v74, v74
v_mfma_f32_16x16x32_bf16 v[44:47], a[16:19], a[52:55], v[44:47]
ds_read_b128 a[40:43], v8 offset:34176
v_max3_f32 v13, v52, v53, v54
v_mfma_f32_16x16x32_bf16 v[48:51], a[16:19], a[56:59], v[24:27]
buffer_load_dwordx4 v1, s[24:27], s50 offen offset:1056 nt lds
v_mfma_f32_16x16x32_bf16 v[48:51], a[20:23], a[68:71], v[48:51]
s_waitcnt lgkmcnt(3)
v_max3_f32 v13, v13, v55, v56
v_mfma_f32_16x16x32_bf16 v[48:51], a[24:27], a[80:83], v[48:51]
ds_read_b128 a[44:47], v8 offset:34240
v_max3_f32 v13, v13, v57, v58
v_mfma_f32_16x16x32_bf16 v[48:51], a[28:31], a[92:95], v[48:51]
v_exp_f32 v75, v75
v_mfma_f32_16x16x32_bf16 v[44:47], a[28:31], a[88:91], v[44:47]
buffer_load_dwordx4 v2, s[24:27], s50 offen offset:2112 nt lds
v_mfma_f32_16x16x32_bf16 v[44:47], a[24:27], a[76:79], v[44:47]
v_add_u32 v9, 84480, v9
ds_read_b64_tr_b16 a[16:17], v9 offset:50688
v_mfma_f32_16x16x32_bf16 v[40:43], a[24:27], a[72:75], v[40:43]
ds_read_b64_tr_b16 a[18:19], v9 offset:51200
v_cvt_pk_bf16_f32 v37, v74, v75
v_mfma_f32_16x16x32_bf16 v[40:43], a[28:31], a[84:87], v[40:43]
s_waitcnt lgkmcnt(4)
v_max3_f32 v13, v13, v59, v60
v_mfma_f32_16x16x32_bf16 v[40:43], a[32:35], a[96:99], v[40:43]
ds_read_b64_tr_b16 a[20:21], v9 offset:50720
v_max3_f32 v13, v13, v61, v62
v_mfma_f32_16x16x32_bf16 v[40:43], a[36:39], a[108:111], v[40:43]
ds_read_b64_tr_b16 a[22:23], v9 offset:51232
v_add_f32 v10, v10, v66
v_mfma_f32_16x16x32_bf16 v[44:47], a[36:39], a[112:115], v[44:47]
buffer_load_dwordx4 v3, s[24:27], s50 offen offset:3168 nt lds
v_mfma_f32_16x16x32_bf16 v[44:47], a[32:35], a[100:103], v[44:47]
ds_read_b64_tr_b16 a[24:25], v9 offset:50752
v_add_f32 v10, v10, v67
v_mfma_f32_16x16x32_bf16 v[48:51], a[32:35], a[104:107], v[48:51]
ds_read_b64_tr_b16 a[26:27], v9 offset:51264
v_add_f32 v11, v11, v68
v_mfma_f32_16x16x32_bf16 v[48:51], a[36:39], a[116:119], v[48:51]
s_waitcnt lgkmcnt(6)
v_add_f32 v11, v11, v69
v_mfma_f32_16x16x32_bf16 v[48:51], a[40:43], a[128:131], v[48:51]
ds_read_b64_tr_b16 a[28:29], v9 offset:50784
v_add_f32 v11, v11, v70
v_mfma_f32_16x16x32_bf16 v[48:51], a[44:47], a[140:143], v[48:51]
ds_read_b64_tr_b16 a[30:31], v9 offset:51296
v_add_f32 v11, v11, v71
v_mfma_f32_16x16x32_bf16 v[44:47], a[44:47], a[136:139], v[44:47]
v_add_f32 v12, v12, v72
v_add_f32 v12, v12, v73
v_mfma_f32_16x16x32_bf16 v[44:47], a[40:43], a[124:127], v[44:47]
ds_read_b64_tr_b16 a[32:33], v9 offset:50816
v_add_f32 v12, v12, v74
v_mfma_f32_16x16x32_bf16 v[40:43], a[40:43], a[120:123], v[40:43]
ds_read_b64_tr_b16 a[34:35], v9 offset:51328
v_add_f32 v12, v12, v75
v_mfma_f32_16x16x32_bf16 v[40:43], a[44:47], a[132:135], v[40:43]
s_waitcnt lgkmcnt(6)
v_max_f32 v13, v13, v63
LS_34:
v_mfma_f32_16x16x32_bf16 v[76:79], a[16:19], v[28:31], v[76:79]
ds_read_b64_tr_b16 a[36:37], v9 offset:50848
v_mfma_f32_16x16x32_bf16 v[80:83], a[16:19], v[32:35], v[80:83]
ds_read_b64_tr_b16 a[38:39], v9 offset:51360
v_mfma_f32_16x16x32_bf16 v[84:87], a[16:19], v[36:39], v[84:87]
v_mfma_f32_16x16x32_bf16 v[96:99], a[20:23], v[36:39], v[96:99]
ds_read_b64_tr_b16 a[40:41], v9 offset:50880
v_max3_f32 v13, v13, v40, v41
v_mfma_f32_16x16x32_bf16 v[92:95], a[20:23], v[32:35], v[92:95]
ds_read_b64_tr_b16 a[42:43], v9 offset:51392
v_max3_f32 v13, v13, v42, v43
v_mfma_f32_16x16x32_bf16 v[88:91], a[20:23], v[28:31], v[88:91]
s_waitcnt lgkmcnt(6)
v_max3_f32 v13, v13, v44, v45
v_mfma_f32_16x16x32_bf16 v[100:103], a[24:27], v[28:31], v[100:103]
ds_read_b64_tr_b16 a[44:45], v9 offset:50912
v_max3_f32 v13, v13, v46, v47
v_mfma_f32_16x16x32_bf16 v[104:107], a[24:27], v[32:35], v[104:107]
ds_read_b64_tr_b16 a[46:47], v9 offset:51424
v_max3_f32 v13, v13, v48, v49
v_mfma_f32_16x16x32_bf16 v[108:111], a[24:27], v[36:39], v[108:111]
v_max3_f32 v13, v13, v50, v51
v_mfma_f32_16x16x32_bf16 v[120:123], a[28:31], v[36:39], v[120:123]
ds_read_b64_tr_b16 a[16:17], v9 offset:50944
v_cmp_lt_f32 vcc, s47, v13
v_mfma_f32_16x16x32_bf16 v[116:119], a[28:31], v[32:35], v[116:119]
ds_read_b64_tr_b16 a[18:19], v9 offset:51456
v_mfma_f32_16x16x32_bf16 v[112:115], a[28:31], v[28:31], v[112:115]
s_waitcnt lgkmcnt(6)
s_cbranch_vccnz RARE_h0j9
RET_h0j9:
v_mfma_f32_16x16x32_bf16 v[124:127], a[32:35], v[28:31], v[124:127]
ds_read_b64_tr_b16 a[20:21], v9 offset:50976
ds_read_b64_tr_b16 a[22:23], v9 offset:51488
v_mfma_f32_16x16x32_bf16 v[128:131], a[32:35], v[32:35], v[128:131]
v_exp_f32 v40, v40
v_mfma_f32_16x16x32_bf16 v[132:135], a[32:35], v[36:39], v[132:135]
v_exp_f32 v41, v41
v_mfma_f32_16x16x32_bf16 v[144:147], a[36:39], v[36:39], v[144:147]
ds_read_b64_tr_b16 a[24:25], v9 offset:51008
ds_read_b64_tr_b16 a[26:27], v9 offset:51520
v_mfma_f32_16x16x32_bf16 v[140:143], a[36:39], v[32:35], v[140:143]
v_exp_f32 v42, v42
v_mfma_f32_16x16x32_bf16 v[136:139], a[36:39], v[28:31], v[136:139]
s_waitcnt lgkmcnt(6)
v_add_f32 v10, v10, v40
v_mfma_f32_16x16x32_bf16 v[148:151], a[40:43], v[28:31], v[148:151]
ds_read_b64_tr_b16 a[28:29], v9 offset:51040
ds_read_b64_tr_b16 a[30:31], v9 offset:51552
v_mfma_f32_16x16x32_bf16 v[152:155], a[40:43], v[32:35], v[152:155]
v_exp_f32 v43, v43
v_mfma_f32_16x16x32_bf16 v[156:159], a[40:43], v[36:39], v[156:159]
s_waitcnt vmcnt(12)
s_barrier
v_mfma_f32_16x16x32_bf16 v[168:171], a[44:47], v[36:39], v[168:171]
ds_read_b64_tr_b16 a[32:33], v9 offset:51072
ds_read_b64_tr_b16 a[34:35], v9 offset:51584
v_mfma_f32_16x16x32_bf16 v[164:167], a[44:47], v[32:35], v[164:167]
s_add_u32 m0, s17, 50688
s_mov_b32 s50, 212992
v_mfma_f32_16x16x32_bf16 v[160:163], a[44:47], v[28:31], v[160:163]
s_waitcnt lgkmcnt(6)
v_add_f32 v10, v10, v41
v_mfma_f32_16x16x32_bf16 v[172:175], a[16:19], v[28:31], v[172:175]
ds_read_b64_tr_b16 a[36:37], v9 offset:51104
ds_read_b64_tr_b16 a[38:39], v9 offset:51616
v_mfma_f32_16x16x32_bf16 v[176:179], a[16:19], v[32:35], v[176:179]
buffer_load_dwordx4 v0, s[20:23], s50 offen offset:0 nt lds
v_mfma_f32_16x16x32_bf16 v[180:183], a[16:19], v[36:39], v[180:183]
v_exp_f32 v44, v44
v_mfma_f32_16x16x32_bf16 v[192:195], a[20:23], v[36:39], v[192:195]
ds_read_b64_tr_b16 a[40:41], v9 offset:51136
ds_read_b64_tr_b16 a[42:43], v9 offset:51648
v_mfma_f32_16x16x32_bf16 v[188:191], a[20:23], v[32:35], v[188:191]
buffer_load_dwordx4 v1, s[20:23], s50 offen offset:1056 nt lds
v_mfma_f32_16x16x32_bf16 v[184:187], a[20:23], v[28:31], v[184:187]
s_waitcnt lgkmcnt(6)
v_add_f32 v10, v10, v42
v_mfma_f32_16x16x32_bf16 v[196:199], a[24:27], v[28:31], v[196:199]
ds_read_b64_tr_b16 a[44:45], v9 offset:51168
ds_read_b64_tr_b16 a[46:47], v9 offset:51680
v_mfma_f32_16x16x32_bf16 v[200:203], a[24:27], v[32:35], v[200:203]
buffer_load_dwordx4 v2, s[20:23], s50 offen offset:2112 nt lds
v_mfma_f32_16x16x32_bf16 v[204:207], a[24:27], v[36:39], v[204:207]
v_exp_f32 v45, v45
v_mfma_f32_16x16x32_bf16 v[216:219], a[28:31], v[36:39], v[216:219]
v_subrev_u32 v8, 16896, v8
ds_read_b128 a[16:19], v8 offset:0
v_mfma_f32_16x16x32_bf16 v[212:215], a[28:31], v[32:35], v[212:215]
v_exp_f32 v46, v46
v_mfma_f32_16x16x32_bf16 v[208:211], a[28:31], v[28:31], v[208:211]
s_waitcnt lgkmcnt(5)
v_add_f32 v10, v10, v43
v_mfma_f32_16x16x32_bf16 v[220:223], a[32:35], v[28:31], v[220:223]
ds_read_b128 a[20:23], v8 offset:64
v_add_f32 v11, v11, v44
v_mfma_f32_16x16x32_bf16 v[224:227], a[32:35], v[32:35], v[224:227]
v_exp_f32 v47, v47
v_mfma_f32_16x16x32_bf16 v[228:231], a[32:35], v[36:39], v[228:231]
v_exp_f32 v48, v48
v_mfma_f32_16x16x32_bf16 v[240:243], a[36:39], v[36:39], v[240:243]
ds_read_b128 a[24:27], v8 offset:128
v_add_f32 v11, v11, v45
v_mfma_f32_16x16x32_bf16 v[236:239], a[36:39], v[32:35], v[236:239]
v_exp_f32 v49, v49
v_mfma_f32_16x16x32_bf16 v[232:235], a[36:39], v[28:31], v[232:235]
s_waitcnt lgkmcnt(3)
v_add_f32 v11, v11, v46
v_mfma_f32_16x16x32_bf16 v[244:247], a[40:43], v[28:31], v[244:247]
ds_read_b128 a[28:31], v8 offset:192
v_exp_f32 v50, v50
v_mfma_f32_16x16x32_bf16 v[248:251], a[40:43], v[32:35], v[248:251]
v_exp_f32 v51, v51
v_mfma_f32_16x16x32_bf16 a[0:3], a[40:43], v[36:39], a[0:3]
buffer_load_dwordx4 v3, s[20:23], s50 offen offset:3168 nt lds
v_mfma_f32_16x16x32_bf16 a[12:15], a[44:47], v[36:39], a[12:15]
ds_read_b128 a[32:35], v8 offset:256
v_add_f32 v11, v11, v47
v_add_f32 v12, v12, v48
v_mfma_f32_16x16x32_bf16 a[8:11], a[44:47], v[32:35], a[8:11]
v_add_f32 v12, v12, v49
v_add_f32 v12, v12, v50
v_mfma_f32_16x16x32_bf16 a[4:7], a[44:47], v[28:31], a[4:7]
s_waitcnt lgkmcnt(3)
v_add_f32 v12, v12, v51
LS_35:
v_mfma_f32_16x16x32_bf16 v[64:67], a[16:19], a[48:51], v[16:19]
ds_read_b128 a[36:39], v8 offset:320
v_cvt_pk_bf16_f32 v28, v40, v41
v_mfma_f32_16x16x32_bf16 v[64:67], a[20:23], a[60:63], v[64:67]
s_add_u32 m0, s17, 67584
s_mov_b32 s50, 196608
v_mfma_f32_16x16x32_bf16 v[68:71], a[20:23], a[64:67], v[20:23]
buffer_load_dwordx4 v0, s[24:27], s50 offen offset:0 nt lds
v_mfma_f32_16x16x32_bf16 v[68:71], a[16:19], a[52:55], v[68:71]
ds_read_b128 a[40:43], v8 offset:384
v_cvt_pk_bf16_f32 v29, v42, v43
v_mfma_f32_16x16x32_bf16 v[72:75], a[16:19], a[56:59], v[24:27]
v_exp_f32 v52, v52
v_mfma_f32_16x16x32_bf16 v[72:75], a[20:23], a[68:71], v[72:75]
s_waitcnt lgkmcnt(3)
v_cvt_pk_bf16_f32 v32, v44, v45
v_mfma_f32_16x16x32_bf16 v[72:75], a[24:27], a[80:83], v[72:75]
ds_read_b128 a[44:47], v8 offset:448
v_cvt_pk_bf16_f32 v33, v46, v47
v_mfma_f32_16x16x32_bf16 v[72:75], a[28:31], a[92:95], v[72:75]
buffer_load_dwordx4 v1, s[24:27], s50 offen offset:1056 nt lds
v_mfma_f32_16x16x32_bf16 v[68:71], a[28:31], a[88:91], v[68:71]
v_exp_f32 v53, v53
v_mfma_f32_16x16x32_bf16 v[68:71], a[24:27], a[76:79], v[68:71]
ds_read_b128 a[16:19], v8 offset:512
v_cvt_pk_bf16_f32 v36, v48, v49
v_mfma_f32_16x16x32_bf16 v[64:67], a[24:27], a[72:75], v[64:67]
v_exp_f32 v54, v54
v_mfma_f32_16x16x32_bf16 v[64:67], a[28:31], a[84:87], v[64:67]
s_waitcnt lgkmcnt(3)
v_cvt_pk_bf16_f32 v37, v50, v51
v_mfma_f32_16x16x32_bf16 v[64:67], a[32:35], a[96:99], v[64:67]
ds_read_b128 a[20:23], v8 offset:576
v_cvt_pk_bf16_f32 v30, v52, v53
v_mfma_f32_16x16x32_bf16 v[64:67], a[36:39], a[108:111], v[64:67]
v_exp_f32 v55, v55
v_mfma_f32_16x16x32_bf16 v[68:71], a[36:39], a[112:115], v[68:71]
v_exp_f32 v56, v56
v_mfma_f32_16x16x32_bf16 v[68:71], a[32:35], a[100:103], v[68:71]
ds_read_b128 a[24:27], v8 offset:640
v_cvt_pk_bf16_f32 v31, v54, v55
v_mfma_f32_16x16x32_bf16 v[72:75], a[32:35], a[104:107], v[72:75]
v_exp_f32 v57, v57
v_mfma_f32_16x16x32_bf16 v[72:75], a[36:39], a[116:119], v[72:75]
s_waitcnt lgkmcnt(3)
v_cvt_pk_bf16_f32 v34, v56, v57
v_mfma_f32_16x16x32_bf16 v[72:75], a[40:43], a[128:131], v[72:75]
ds_read_b128 a[28:31], v8 offset:704
v_add_f32 v10, v10, v52
v_mfma_f32_16x16x32_bf16 v[72:75], a[44:47], a[140:143], v[72:75]
v_exp_f32 v58, v58
v_mfma_f32_16x16x32_bf16 v[68:71], a[44:47], a[136:139], v[68:71]
s_waitcnt vmcnt(14)
s_barrier
v_mfma_f32_16x16x32_bf16 v[68:71], a[40:43], a[124:127], v[68:71]
ds_read_b128 a[32:35], v8 offset:768
v_add_f32 v10, v10, v53
v_mfma_f32_16x16x32_bf16 v[64:67], a[40:43], a[120:123], v[64:67]
v_exp_f32 v59, v59
v_mfma_f32_16x16x32_bf16 v[64:67], a[44:47], a[132:135], v[64:67]
s_waitcnt lgkmcnt(3)
v_cvt_pk_bf16_f32 v35, v58, v59
v_mfma_f32_16x16x32_bf16 v[40:43], a[16:19], a[48:51], v[16:19]
ds_read_b128 a[36:39], v8 offset:832
v_add_f32 v10, v10, v54
v_mfma_f32_16x16x32_bf16 v[40:43], a[20:23], a[60:63], v[40:43]
v_exp_f32 v60, v60
v_mfma_f32_16x16x32_bf16 v[44:47], a[20:23], a[64:67], v[20:23]
v_exp_f32 v61, v61
v_mfma_f32_16x16x32_bf16 v[44:47], a[16:19], a[52:55], v[44:47]
ds_read_b128 a[40:43], v8 offset:896
v_max3_f32 v13, v64, v65, v66
v_mfma_f32_16x16x32_bf16 v[48:51], a[16:19], a[56:59], v[24:27]
v_exp_f32 v62, v62
v_mfma_f32_16x16x32_bf16 v[48:51], a[20:23], a[68:71], v[48:51]
s_waitcnt lgkmcnt(3)
v_max3_f32 v13, v13, v67, v68
v_mfma_f32_16x16x32_bf16 v[48:51], a[24:27], a[80:83], v[48:51]
ds_read_b128 a[44:47], v8 offset:960
v_max3_f32 v13, v13, v69, v70
v_mfma_f32_16x16x32_bf16 v[48:51], a[28:31], a[92:95], v[48:51]
v_exp_f32 v63, v63
v_mfma_f32_16x16x32_bf16 v[44:47], a[28:31], a[88:91], v[44:47]
buffer_load_dwordx4 v2, s[24:27], s50 offen offset:2112 nt lds
v_mfma_f32_16x16x32_bf16 v[44:47], a[24:27], a[76:79], v[44:47]
v_subrev_u32 v9, 84480, v9
ds_read_b64_tr_b16 a[16:17], v9 offset:33792
v_mfma_f32_16x16x32_bf16 v[40:43], a[24:27], a[72:75], v[40:43]
ds_read_b64_tr_b16 a[18:19], v9 offset:34304
v_cvt_pk_bf16_f32 v38, v60, v61
v_mfma_f32_16x16x32_bf16 v[40:43], a[28:31], a[84:87], v[40:43]
s_waitcnt lgkmcnt(4)
v_cvt_pk_bf16_f32 v39, v62, v63
v_mfma_f32_16x16x32_bf16 v[40:43], a[32:35], a[96:99], v[40:43]
ds_read_b64_tr_b16 a[20:21], v9 offset:33824
v_max3_f32 v13, v13, v71, v72
v_mfma_f32_16x16x32_bf16 v[40:43], a[36:39], a[108:111], v[40:43]
ds_read_b64_tr_b16 a[22:23], v9 offset:34336
v_max3_f32 v13, v13, v73, v74
v_mfma_f32_16x16x32_bf16 v[44:47], a[36:39], a[112:115], v[44:47]
buffer_load_dwordx4 v3, s[24:27], s50 offen offset:3168 nt lds
v_mfma_f32_16x16x32_bf16 v[44:47], a[32:35], a[100:103], v[44:47]
ds_read_b64_tr_b16 a[24:25], v9 offset:33856
v_add_f32 v10, v10, v55
v_mfma_f32_16x16x32_bf16 v[48:51], a[32:35], a[104:107], v[48:51]
ds_read_b64_tr_b16 a[26:27], v9 offset:34368
v_add_f32 v11, v11, v56
v_mfma_f32_16x16x32_bf16 v[48:51], a[36:39], a[116:119], v[48:51]
s_waitcnt lgkmcnt(6)
v_add_f32 v11, v11, v57
v_mfma_f32_16x16x32_bf16 v[48:51], a[40:43], a[128:131], v[48:51]
ds_read_b64_tr_b16 a[28:29], v9 offset:33888
v_add_f32 v11, v11, v58
v_mfma_f32_16x16x32_bf16 v[48:51], a[44:47], a[140:143], v[48:51]
ds_read_b64_tr_b16 a[30:31], v9 offset:34400
v_add_f32 v11, v11, v59
v_mfma_f32_16x16x32_bf16 v[44:47], a[44:47], a[136:139], v[44:47]
v_add_f32 v12, v12, v60
v_add_f32 v12, v12, v61
v_mfma_f32_16x16x32_bf16 v[44:47], a[40:43], a[124:127], v[44:47]
ds_read_b64_tr_b16 a[32:33], v9 offset:33920
v_add_f32 v12, v12, v62
v_mfma_f32_16x16x32_bf16 v[40:43], a[40:43], a[120:123], v[40:43]
ds_read_b64_tr_b16 a[34:35], v9 offset:34432
v_add_f32 v12, v12, v63
v_mfma_f32_16x16x32_bf16 v[40:43], a[44:47], a[132:135], v[40:43]
s_waitcnt lgkmcnt(6)
v_max_f32 v13, v13, v75
LS_36:
v_mfma_f32_16x16x32_bf16 v[76:79], a[16:19], v[28:31], v[76:79]
ds_read_b64_tr_b16 a[36:37], v9 offset:33952
v_mfma_f32_16x16x32_bf16 v[80:83], a[16:19], v[32:35], v[80:83]
ds_read_b64_tr_b16 a[38:39], v9 offset:34464
v_mfma_f32_16x16x32_bf16 v[84:87], a[16:19], v[36:39], v[84:87]
v_mfma_f32_16x16x32_bf16 v[96:99], a[20:23], v[36:39], v[96:99]
ds_read_b64_tr_b16 a[40:41], v9 offset:33984
v_max3_f32 v13, v13, v40, v41
v_mfma_f32_16x16x32_bf16 v[92:95], a[20:23], v[32:35], v[92:95]
ds_read_b64_tr_b16 a[42:43], v9 offset:34496
v_max3_f32 v13, v13, v42, v43
v_mfma_f32_16x16x32_bf16 v[88:91], a[20:23], v[28:31], v[88:91]
s_waitcnt lgkmcnt(6)
v_max3_f32 v13, v13, v44, v45
v_mfma_f32_16x16x32_bf16 v[100:103], a[24:27], v[28:31], v[100:103]
ds_read_b64_tr_b16 a[44:45], v9 offset:34016
v_max3_f32 v13, v13, v46, v47
v_mfma_f32_16x16x32_bf16 v[104:107], a[24:27], v[32:35], v[104:107]
ds_read_b64_tr_b16 a[46:47], v9 offset:34528
v_max3_f32 v13, v13, v48, v49
v_mfma_f32_16x16x32_bf16 v[108:111], a[24:27], v[36:39], v[108:111]
v_max3_f32 v13, v13, v50, v51
v_mfma_f32_16x16x32_bf16 v[120:123], a[28:31], v[36:39], v[120:123]
ds_read_b64_tr_b16 a[16:17], v9 offset:34048
v_cmp_lt_f32 vcc, s47, v13
v_mfma_f32_16x16x32_bf16 v[116:119], a[28:31], v[32:35], v[116:119]
ds_read_b64_tr_b16 a[18:19], v9 offset:34560
v_mfma_f32_16x16x32_bf16 v[112:115], a[28:31], v[28:31], v[112:115]
s_waitcnt lgkmcnt(6)
s_cbranch_vccnz RARE_h0j10
RET_h0j10:
v_mfma_f32_16x16x32_bf16 v[124:127], a[32:35], v[28:31], v[124:127]
ds_read_b64_tr_b16 a[20:21], v9 offset:34080
ds_read_b64_tr_b16 a[22:23], v9 offset:34592
v_mfma_f32_16x16x32_bf16 v[128:131], a[32:35], v[32:35], v[128:131]
v_exp_f32 v40, v40
v_mfma_f32_16x16x32_bf16 v[132:135], a[32:35], v[36:39], v[132:135]
v_exp_f32 v41, v41
v_mfma_f32_16x16x32_bf16 v[144:147], a[36:39], v[36:39], v[144:147]
ds_read_b64_tr_b16 a[24:25], v9 offset:34112
ds_read_b64_tr_b16 a[26:27], v9 offset:34624
v_mfma_f32_16x16x32_bf16 v[140:143], a[36:39], v[32:35], v[140:143]
v_exp_f32 v42, v42
v_mfma_f32_16x16x32_bf16 v[136:139], a[36:39], v[28:31], v[136:139]
s_waitcnt lgkmcnt(6)
v_add_f32 v10, v10, v40
v_mfma_f32_16x16x32_bf16 v[148:151], a[40:43], v[28:31], v[148:151]
ds_read_b64_tr_b16 a[28:29], v9 offset:34144
ds_read_b64_tr_b16 a[30:31], v9 offset:34656
v_mfma_f32_16x16x32_bf16 v[152:155], a[40:43], v[32:35], v[152:155]
v_exp_f32 v43, v43
v_mfma_f32_16x16x32_bf16 v[156:159], a[40:43], v[36:39], v[156:159]
s_waitcnt vmcnt(12)
s_barrier
v_mfma_f32_16x16x32_bf16 v[168:171], a[44:47], v[36:39], v[168:171]
ds_read_b64_tr_b16 a[32:33], v9 offset:34176
ds_read_b64_tr_b16 a[34:35], v9 offset:34688
v_mfma_f32_16x16x32_bf16 v[164:167], a[44:47], v[32:35], v[164:167]
v_exp_f32 v44, v44
v_mfma_f32_16x16x32_bf16 v[160:163], a[44:47], v[28:31], v[160:163]
s_waitcnt lgkmcnt(6)
v_add_f32 v10, v10, v41
v_mfma_f32_16x16x32_bf16 v[172:175], a[16:19], v[28:31], v[172:175]
ds_read_b64_tr_b16 a[36:37], v9 offset:34208
ds_read_b64_tr_b16 a[38:39], v9 offset:34720
v_mfma_f32_16x16x32_bf16 v[176:179], a[16:19], v[32:35], v[176:179]
v_exp_f32 v45, v45
v_mfma_f32_16x16x32_bf16 v[180:183], a[16:19], v[36:39], v[180:183]
v_exp_f32 v46, v46
v_mfma_f32_16x16x32_bf16 v[192:195], a[20:23], v[36:39], v[192:195]
ds_read_b64_tr_b16 a[40:41], v9 offset:34240
ds_read_b64_tr_b16 a[42:43], v9 offset:34752
v_mfma_f32_16x16x32_bf16 v[188:191], a[20:23], v[32:35], v[188:191]
v_exp_f32 v47, v47
v_mfma_f32_16x16x32_bf16 v[184:187], a[20:23], v[28:31], v[184:187]
s_waitcnt lgkmcnt(6)
v_add_f32 v10, v10, v42
v_mfma_f32_16x16x32_bf16 v[196:199], a[24:27], v[28:31], v[196:199]
ds_read_b64_tr_b16 a[44:45], v9 offset:34272
ds_read_b64_tr_b16 a[46:47], v9 offset:34784
v_mfma_f32_16x16x32_bf16 v[200:203], a[24:27], v[32:35], v[200:203]
v_exp_f32 v48, v48
v_mfma_f32_16x16x32_bf16 v[204:207], a[24:27], v[36:39], v[204:207]
v_exp_f32 v49, v49
v_mfma_f32_16x16x32_bf16 v[216:219], a[28:31], v[36:39], v[216:219]
v_add_u32 v8, 84480, v8
ds_read_b128 a[16:19], v8 offset:34304
v_mfma_f32_16x16x32_bf16 v[212:215], a[28:31], v[32:35], v[212:215]
v_exp_f32 v50, v50
v_mfma_f32_16x16x32_bf16 v[208:211], a[28:31], v[28:31], v[208:211]
s_waitcnt lgkmcnt(5)
v_add_f32 v10, v10, v43
v_mfma_f32_16x16x32_bf16 v[220:223], a[32:35], v[28:31], v[220:223]
ds_read_b128 a[20:23], v8 offset:34368
v_add_f32 v11, v11, v44
v_mfma_f32_16x16x32_bf16 v[224:227], a[32:35], v[32:35], v[224:227]
v_exp_f32 v51, v51
v_mfma_f32_16x16x32_bf16 v[228:231], a[32:35], v[36:39], v[228:231]
v_add_f32 v11, v11, v45
v_add_f32 v11, v11, v46
v_mfma_f32_16x16x32_bf16 v[240:243], a[36:39], v[36:39], v[240:243]
ds_read_b128 a[24:27], v8 offset:34432
v_add_f32 v11, v11, v47
v_mfma_f32_16x16x32_bf16 v[236:239], a[36:39], v[32:35], v[236:239]
v_add_f32 v12, v12, v48
v_add_f32 v12, v12, v49
v_mfma_f32_16x16x32_bf16 v[232:235], a[36:39], v[28:31], v[232:235]
s_waitcnt lgkmcnt(3)
v_add_f32 v12, v12, v50
v_mfma_f32_16x16x32_bf16 v[244:247], a[40:43], v[28:31], v[244:247]
ds_read_b128 a[28:31], v8 offset:34496
v_add_f32 v12, v12, v51
v_mfma_f32_16x16x32_bf16 v[248:251], a[40:43], v[32:35], v[248:251]
v_mfma_f32_16x16x32_bf16 a[0:3], a[40:43], v[36:39], a[0:3]
v_mfma_f32_16x16x32_bf16 a[12:15], a[44:47], v[36:39], a[12:15]
ds_read_b128 a[32:35], v8 offset:34560
v_mfma_f32_16x16x32_bf16 a[8:11], a[44:47], v[32:35], a[8:11]
v_mfma_f32_16x16x32_bf16 a[4:7], a[44:47], v[28:31], a[4:7]
s_waitcnt lgkmcnt(3)
LS_37:
v_mfma_f32_16x16x32_bf16 v[52:55], a[16:19], a[48:51], v[16:19]
ds_read_b128 a[36:39], v8 offset:34624
v_cvt_pk_bf16_f32 v30, v40, v41
v_mfma_f32_16x16x32_bf16 v[52:55], a[20:23], a[60:63], v[52:55]
s_add_u32 m0, s17, 0
s_mov_b32 s50, 229376
v_mfma_f32_16x16x32_bf16 v[56:59], a[20:23], a[64:67], v[20:23]
buffer_load_dwordx4 v0, s[20:23], s50 offen offset:0 nt lds
v_mfma_f32_16x16x32_bf16 v[56:59], a[16:19], a[52:55], v[56:59]
ds_read_b128 a[40:43], v8 offset:34688
v_cvt_pk_bf16_f32 v31, v42, v43
v_mfma_f32_16x16x32_bf16 v[60:63], a[16:19], a[56:59], v[24:27]
v_exp_f32 v64, v64
v_mfma_f32_16x16x32_bf16 v[60:63], a[20:23], a[68:71], v[60:63]
s_waitcnt lgkmcnt(3)
v_cvt_pk_bf16_f32 v34, v44, v45
v_mfma_f32_16x16x32_bf16 v[60:63], a[24:27], a[80:83], v[60:63]
ds_read_b128 a[44:47], v8 offset:34752
v_cvt_pk_bf16_f32 v35, v46, v47
v_mfma_f32_16x16x32_bf16 v[60:63], a[28:31], a[92:95], v[60:63]
buffer_load_dwordx4 v1, s[20:23], s50 offen offset:1056 nt lds
v_mfma_f32_16x16x32_bf16 v[56:59], a[28:31], a[88:91], v[56:59]
v_exp_f32 v65, v65
v_mfma_f32_16x16x32_bf16 v[56:59], a[24:27], a[76:79], v[56:59]
ds_read_b128 a[16:19], v8 offset:33792
v_cvt_pk_bf16_f32 v38, v48, v49
v_mfma_f32_16x16x32_bf16 v[52:55], a[24:27], a[72:75], v[52:55]
v_exp_f32 v66, v66
v_mfma_f32_16x16x32_bf16 v[52:55], a[28:31], a[84:87], v[52:55]
s_waitcnt lgkmcnt(3)
v_cvt_pk_bf16_f32 v39, v50, v51
v_mfma_f32_16x16x32_bf16 v[52:55], a[32:35], a[96:99], v[52:55]
ds_read_b128 a[20:23], v8 offset:33856
v_cvt_pk_bf16_f32 v28, v64, v65
v_mfma_f32_16x16x32_bf16 v[52:55], a[36:39], a[108:111], v[52:55]
v_exp_f32 v67, v67
v_mfma_f32_16x16x32_bf16 v[56:59], a[36:39], a[112:115], v[56:59]
v_exp_f32 v68, v68
v_mfma_f32_16x16x32_bf16 v[56:59], a[32:35], a[100:103], v[56:59]
ds_read_b128 a[24:27], v8 offset:33920
v_cvt_pk_bf16_f32 v29, v66, v67
v_mfma_f32_16x16x32_bf16 v[60:63], a[32:35], a[104:107], v[60:63]
v_exp_f32 v69, v69
v_mfma_f32_16x16x32_bf16 v[60:63], a[36:39], a[116:119], v[60:63]
s_waitcnt lgkmcnt(3)
v_cvt_pk_bf16_f32 v32, v68, v69
v_mfma_f32_16x16x32_bf16 v[60:63], a[40:43], a[128:131], v[60:63]
ds_read_b128 a[28:31], v8 offset:33984
v_add_f32 v10, v10, v64
v_mfma_f32_16x16x32_bf16 v[60:63], a[44:47], a[140:143], v[60:63]
v_exp_f32 v70, v70
v_mfma_f32_16x16x32_bf16 v[56:59], a[44:47], a[136:139], v[56:59]
s_waitcnt vmcnt(10)
s_barrier
v_mfma_f32_16x16x32_bf16 v[56:59], a[40:43], a[124:127], v[56:59]
ds_read_b128 a[32:35], v8 offset:34048
v_add_f32 v10, v10, v65
v_mfma_f32_16x16x32_bf16 v[52:55], a[40:43], a[120:123], v[52:55]
v_exp_f32 v71, v71
v_mfma_f32_16x16x32_bf16 v[52:55], a[44:47], a[132:135], v[52:55]
s_waitcnt lgkmcnt(3)
v_cvt_pk_bf16_f32 v33, v70, v71
v_mfma_f32_16x16x32_bf16 v[40:43], a[16:19], a[48:51], v[16:19]
ds_read_b128 a[36:39], v8 offset:34112
v_add_f32 v10, v10, v66
v_mfma_f32_16x16x32_bf16 v[40:43], a[20:23], a[60:63], v[40:43]
v_exp_f32 v72, v72
v_mfma_f32_16x16x32_bf16 v[44:47], a[20:23], a[64:67], v[20:23]
v_exp_f32 v73, v73
v_mfma_f32_16x16x32_bf16 v[44:47], a[16:19], a[52:55], v[44:47]
ds_read_b128 a[40:43], v8 offset:34176
v_max3_f32 v13, v52, v53, v54
v_mfma_f32_16x16x32_bf16 v[48:51], a[16:19], a[56:59], v[24:27]
v_exp_f32 v74, v74
v_mfma_f32_16x16x32_bf16 v[48:51], a[20:23], a[68:71], v[48:51]
s_waitcnt lgkmcnt(3)
v_max3_f32 v13, v13, v55, v56
v_mfma_f32_16x16x32_bf16 v[48:51], a[24:27], a[80:83], v[48:51]
ds_read_b128 a[44:47], v8 offset:34240
v_max3_f32 v13, v13, v57, v58
v_mfma_f32_16x16x32_bf16 v[48:51], a[28:31], a[92:95], v[48:51]
v_exp_f32 v75, v75
v_mfma_f32_16x16x32_bf16 v[44:47], a[28:31], a[88:91], v[44:47]
buffer_load_dwordx4 v2, s[20:23], s50 offen offset:2112 nt lds
v_mfma_f32_16x16x32_bf16 v[44:47], a[24:27], a[76:79], v[44:47]
ds_read_b64_tr_b16 a[16:17], v9 offset:16896
v_cvt_pk_bf16_f32 v36, v72, v73
v_mfma_f32_16x16x32_bf16 v[40:43], a[24:27], a[72:75], v[40:43]
ds_read_b64_tr_b16 a[18:19], v9 offset:17408
v_cvt_pk_bf16_f32 v37, v74, v75
v_mfma_f32_16x16x32_bf16 v[40:43], a[28:31], a[84:87], v[40:43]
s_waitcnt lgkmcnt(4)
v_max3_f32 v13, v13, v59, v60
v_mfma_f32_16x16x32_bf16 v[40:43], a[32:35], a[96:99], v[40:43]
ds_read_b64_tr_b16 a[20:21], v9 offset:16928
v_max3_f32 v13, v13, v61, v62
v_mfma_f32_16x16x32_bf16 v[40:43], a[36:39], a[108:111], v[40:43]
ds_read_b64_tr_b16 a[22:23], v9 offset:17440
v_add_f32 v10, v10, v67
v_mfma_f32_16x16x32_bf16 v[44:47], a[36:39], a[112:115], v[44:47]
buffer_load_dwordx4 v3, s[20:23], s50 offen offset:3168 nt lds
v_mfma_f32_16x16x32_bf16 v[44:47], a[32:35], a[100:103], v[44:47]
ds_read_b64_tr_b16 a[24:25], v9 offset:16960
v_add_f32 v11, v11, v68
v_mfma_f32_16x16x32_bf16 v[48:51], a[32:35], a[104:107], v[48:51]
ds_read_b64_tr_b16 a[26:27], v9 offset:17472
v_add_f32 v11, v11, v69
v_mfma_f32_16x16x32_bf16 v[48:51], a[36:39], a[116:119], v[48:51]
s_waitcnt lgkmcnt(6)
v_add_f32 v11, v11, v70
v_mfma_f32_16x16x32_bf16 v[48:51], a[40:43], a[128:131], v[48:51]
ds_read_b64_tr_b16 a[28:29], v9 offset:16992
v_add_f32 v11, v11, v71
v_mfma_f32_16x16x32_bf16 v[48:51], a[44:47], a[140:143], v[48:51]
ds_read_b64_tr_b16 a[30:31], v9 offset:17504
v_add_f32 v12, v12, v72
v_mfma_f32_16x16x32_bf16 v[44:47], a[44:47], a[136:139], v[44:47]
v_add_f32 v12, v12, v73
v_add_f32 v12, v12, v74
v_mfma_f32_16x16x32_bf16 v[44:47], a[40:43], a[124:127], v[44:47]
ds_read_b64_tr_b16 a[32:33], v9 offset:17024
v_add_f32 v12, v12, v75
v_mfma_f32_16x16x32_bf16 v[40:43], a[40:43], a[120:123], v[40:43]
ds_read_b64_tr_b16 a[34:35], v9 offset:17536
v_max_f32 v13, v13, v63
v_mfma_f32_16x16x32_bf16 v[40:43], a[44:47], a[132:135], v[40:43]
s_waitcnt lgkmcnt(6)
LS_38:
v_mfma_f32_16x16x32_bf16 v[76:79], a[16:19], v[28:31], v[76:79]
ds_read_b64_tr_b16 a[36:37], v9 offset:17056
v_mfma_f32_16x16x32_bf16 v[80:83], a[16:19], v[32:35], v[80:83]
ds_read_b64_tr_b16 a[38:39], v9 offset:17568
v_mfma_f32_16x16x32_bf16 v[84:87], a[16:19], v[36:39], v[84:87]
s_add_u32 m0, s17, 84480
s_mov_b32 s50, 212992
v_mfma_f32_16x16x32_bf16 v[96:99], a[20:23], v[36:39], v[96:99]
ds_read_b64_tr_b16 a[40:41], v9 offset:17088
v_max3_f32 v13, v13, v40, v41
v_mfma_f32_16x16x32_bf16 v[92:95], a[20:23], v[32:35], v[92:95]
ds_read_b64_tr_b16 a[42:43], v9 offset:17600
v_max3_f32 v13, v13, v42, v43
v_mfma_f32_16x16x32_bf16 v[88:91], a[20:23], v[28:31], v[88:91]
s_waitcnt lgkmcnt(6)
v_max3_f32 v13, v13, v44, v45
v_mfma_f32_16x16x32_bf16 v[100:103], a[24:27], v[28:31], v[100:103]
ds_read_b64_tr_b16 a[44:45], v9 offset:17120
v_max3_f32 v13, v13, v46, v47
v_mfma_f32_16x16x32_bf16 v[104:107], a[24:27], v[32:35], v[104:107]
ds_read_b64_tr_b16 a[46:47], v9 offset:17632
v_max3_f32 v13, v13, v48, v49
v_mfma_f32_16x16x32_bf16 v[108:111], a[24:27], v[36:39], v[108:111]
buffer_load_dwordx4 v0, s[24:27], s50 offen offset:0 nt lds
v_mfma_f32_16x16x32_bf16 v[120:123], a[28:31], v[36:39], v[120:123]
ds_read_b64_tr_b16 a[16:17], v9 offset:17152
v_max3_f32 v13, v13, v50, v51
v_mfma_f32_16x16x32_bf16 v[116:119], a[28:31], v[32:35], v[116:119]
ds_read_b64_tr_b16 a[18:19], v9 offset:17664
v_cmp_lt_f32 vcc, s47, v13
v_mfma_f32_16x16x32_bf16 v[112:115], a[28:31], v[28:31], v[112:115]
s_waitcnt lgkmcnt(6)
v_mfma_f32_16x16x32_bf16 v[124:127], a[32:35], v[28:31], v[124:127]
ds_read_b64_tr_b16 a[20:21], v9 offset:17184
ds_read_b64_tr_b16 a[22:23], v9 offset:17696
v_mfma_f32_16x16x32_bf16 v[128:131], a[32:35], v[32:35], v[128:131]
s_cbranch_vccnz RARE_h0j11
RET_h0j11:
v_mfma_f32_16x16x32_bf16 v[132:135], a[32:35], v[36:39], v[132:135]
buffer_load_dwordx4 v1, s[24:27], s50 offen offset:1056 nt lds
v_mfma_f32_16x16x32_bf16 v[144:147], a[36:39], v[36:39], v[144:147]
ds_read_b64_tr_b16 a[24:25], v9 offset:17216
ds_read_b64_tr_b16 a[26:27], v9 offset:17728
v_mfma_f32_16x16x32_bf16 v[140:143], a[36:39], v[32:35], v[140:143]
v_exp_f32 v40, v40
v_mfma_f32_16x16x32_bf16 v[136:139], a[36:39], v[28:31], v[136:139]
s_waitcnt lgkmcnt(6)
v_add_f32 v10, v10, v40
v_mfma_f32_16x16x32_bf16 v[148:151], a[40:43], v[28:31], v[148:151]
ds_read_b64_tr_b16 a[28:29], v9 offset:17248
ds_read_b64_tr_b16 a[30:31], v9 offset:17760
v_mfma_f32_16x16x32_bf16 v[152:155], a[40:43], v[32:35], v[152:155]
buffer_load_dwordx4 v2, s[24:27], s50 offen offset:2112 nt lds
v_mfma_f32_16x16x32_bf16 v[156:159], a[40:43], v[36:39], v[156:159]
s_waitcnt vmcnt(11)
s_barrier
v_mfma_f32_16x16x32_bf16 v[168:171], a[44:47], v[36:39], v[168:171]
ds_read_b64_tr_b16 a[32:33], v9 offset:17280
ds_read_b64_tr_b16 a[34:35], v9 offset:17792
v_mfma_f32_16x16x32_bf16 v[164:167], a[44:47], v[32:35], v[164:167]
v_exp_f32 v41, v41
v_mfma_f32_16x16x32_bf16 v[160:163], a[44:47], v[28:31], v[160:163]
s_waitcnt lgkmcnt(6)
v_add_f32 v10, v10, v41
v_mfma_f32_16x16x32_bf16 v[172:175], a[16:19], v[28:31], v[172:175]
ds_read_b64_tr_b16 a[36:37], v9 offset:17312
ds_read_b64_tr_b16 a[38:39], v9 offset:17824
v_mfma_f32_16x16x32_bf16 v[176:179], a[16:19], v[32:35], v[176:179]
v_exp_f32 v42, v42
v_mfma_f32_16x16x32_bf16 v[180:183], a[16:19], v[36:39], v[180:183]
v_exp_f32 v43, v43
v_mfma_f32_16x16x32_bf16 v[192:195], a[20:23], v[36:39], v[192:195]
ds_read_b64_tr_b16 a[40:41], v9 offset:17344
ds_read_b64_tr_b16 a[42:43], v9 offset:17856
v_mfma_f32_16x16x32_bf16 v[188:191], a[20:23], v[32:35], v[188:191]
v_exp_f32 v44, v44
v_mfma_f32_16x16x32_bf16 v[184:187], a[20:23], v[28:31], v[184:187]
s_waitcnt lgkmcnt(6)
v_add_f32 v10, v10, v42
v_mfma_f32_16x16x32_bf16 v[196:199], a[24:27], v[28:31], v[196:199]
ds_read_b64_tr_b16 a[44:45], v9 offset:17376
ds_read_b64_tr_b16 a[46:47], v9 offset:17888
v_mfma_f32_16x16x32_bf16 v[200:203], a[24:27], v[32:35], v[200:203]
v_exp_f32 v45, v45
v_mfma_f32_16x16x32_bf16 v[204:207], a[24:27], v[36:39], v[204:207]
v_exp_f32 v46, v46
v_mfma_f32_16x16x32_bf16 v[216:219], a[28:31], v[36:39], v[216:219]
v_subrev_u32 v8, 67584, v8
ds_read_b128 a[16:19], v8 offset:33792
v_mfma_f32_16x16x32_bf16 v[212:215], a[28:31], v[32:35], v[212:215]
v_exp_f32 v47, v47
v_mfma_f32_16x16x32_bf16 v[208:211], a[28:31], v[28:31], v[208:211]
s_waitcnt lgkmcnt(5)
v_add_f32 v10, v10, v43
v_mfma_f32_16x16x32_bf16 v[220:223], a[32:35], v[28:31], v[220:223]
ds_read_b128 a[20:23], v8 offset:33856
v_add_f32 v11, v11, v44
v_mfma_f32_16x16x32_bf16 v[224:227], a[32:35], v[32:35], v[224:227]
v_exp_f32 v48, v48
v_mfma_f32_16x16x32_bf16 v[228:231], a[32:35], v[36:39], v[228:231]
v_exp_f32 v49, v49
v_mfma_f32_16x16x32_bf16 v[240:243], a[36:39], v[36:39], v[240:243]
ds_read_b128 a[24:27], v8 offset:33920
v_add_f32 v11, v11, v45
v_mfma_f32_16x16x32_bf16 v[236:239], a[36:39], v[32:35], v[236:239]
v_exp_f32 v50, v50
v_mfma_f32_16x16x32_bf16 v[232:235], a[36:39], v[28:31], v[232:235]
s_waitcnt lgkmcnt(3)
v_add_f32 v11, v11, v46
v_mfma_f32_16x16x32_bf16 v[244:247], a[40:43], v[28:31], v[244:247]
ds_read_b128 a[28:31], v8 offset:33984
v_add_f32 v11, v11, v47
v_mfma_f32_16x16x32_bf16 v[248:251], a[40:43], v[32:35], v[248:251]
v_exp_f32 v51, v51
v_mfma_f32_16x16x32_bf16 a[0:3], a[40:43], v[36:39], a[0:3]
buffer_load_dwordx4 v3, s[24:27], s50 offen offset:3168 nt lds
v_mfma_f32_16x16x32_bf16 a[12:15], a[44:47], v[36:39], a[12:15]
ds_read_b128 a[32:35], v8 offset:34048
v_add_f32 v12, v12, v48
v_mfma_f32_16x16x32_bf16 a[8:11], a[44:47], v[32:35], a[8:11]
v_add_f32 v12, v12, v49
v_add_f32 v12, v12, v50
v_mfma_f32_16x16x32_bf16 a[4:7], a[44:47], v[28:31], a[4:7]
s_waitcnt lgkmcnt(3)
v_add_f32 v12, v12, v51
LS_39:
v_mfma_f32_16x16x32_bf16 v[64:67], a[16:19], a[48:51], v[16:19]
ds_read_b128 a[36:39], v8 offset:34112
v_cvt_pk_bf16_f32 v28, v40, v41
v_mfma_f32_16x16x32_bf16 v[64:67], a[20:23], a[60:63], v[64:67]
v_exp_f32 v52, v52
v_mfma_f32_16x16x32_bf16 v[68:71], a[20:23], a[64:67], v[20:23]
v_exp_f32 v53, v53
v_mfma_f32_16x16x32_bf16 v[68:71], a[16:19], a[52:55], v[68:71]
ds_read_b128 a[40:43], v8 offset:34176
v_cvt_pk_bf16_f32 v29, v42, v43
v_mfma_f32_16x16x32_bf16 v[72:75], a[16:19], a[56:59], v[24:27]
v_exp_f32 v54, v54
v_mfma_f32_16x16x32_bf16 v[72:75], a[20:23], a[68:71], v[72:75]
s_waitcnt lgkmcnt(3)
v_cvt_pk_bf16_f32 v32, v44, v45
v_mfma_f32_16x16x32_bf16 v[72:75], a[24:27], a[80:83], v[72:75]
ds_read_b128 a[44:47], v8 offset:34240
v_cvt_pk_bf16_f32 v33, v46, v47
v_mfma_f32_16x16x32_bf16 v[72:75], a[28:31], a[92:95], v[72:75]
v_exp_f32 v55, v55
v_mfma_f32_16x16x32_bf16 v[68:71], a[28:31], a[88:91], v[68:71]
v_exp_f32 v56, v56
v_mfma_f32_16x16x32_bf16 v[68:71], a[24:27], a[76:79], v[68:71]
ds_read_b128 a[16:19], v8 offset:34304
v_cvt_pk_bf16_f32 v36, v48, v49
v_mfma_f32_16x16x32_bf16 v[64:67], a[24:27], a[72:75], v[64:67]
v_exp_f32 v57, v57
v_mfma_f32_16x16x32_bf16 v[64:67], a[28:31], a[84:87], v[64:67]
s_waitcnt lgkmcnt(3)
v_cvt_pk_bf16_f32 v37, v50, v51
v_mfma_f32_16x16x32_bf16 v[64:67], a[32:35], a[96:99], v[64:67]
ds_read_b128 a[20:23], v8 offset:34368
v_cvt_pk_bf16_f32 v30, v52, v53
v_mfma_f32_16x16x32_bf16 v[64:67], a[36:39], a[108:111], v[64:67]
v_exp_f32 v58, v58
v_mfma_f32_16x16x32_bf16 v[68:71], a[36:39], a[112:115], v[68:71]
v_exp_f32 v59, v59
v_mfma_f32_16x16x32_bf16 v[68:71], a[32:35], a[100:103], v[68:71]
ds_read_b128 a[24:27], v8 offset:34432
v_cvt_pk_bf16_f32 v31, v54, v55
v_mfma_f32_16x16x32_bf16 v[72:75], a[32:35], a[104:107], v[72:75]
v_exp_f32 v60, v60
v_mfma_f32_16x16x32_bf16 v[72:75], a[36:39], a[116:119], v[72:75]
s_waitcnt lgkmcnt(3)
v_cvt_pk_bf16_f32 v34, v56, v57
v_mfma_f32_16x16x32_bf16 v[72:75], a[40:43], a[128:131], v[72:75]
ds_read_b128 a[28:31], v8 offset:34496
v_cvt_pk_bf16_f32 v35, v58, v59
v_mfma_f32_16x16x32_bf16 v[72:75], a[44:47], a[140:143], v[72:75]
v_exp_f32 v61, v61
v_mfma_f32_16x16x32_bf16 v[68:71], a[44:47], a[136:139], v[68:71]
s_waitcnt vmcnt(8)
s_barrier
v_mfma_f32_16x16x32_bf16 v[68:71], a[40:43], a[124:127], v[68:71]
ds_read_b128 a[32:35], v8 offset:34560
v_cvt_pk_bf16_f32 v38, v60, v61
v_mfma_f32_16x16x32_bf16 v[64:67], a[40:43], a[120:123], v[64:67]
v_exp_f32 v62, v62
v_mfma_f32_16x16x32_bf16 v[64:67], a[44:47], a[132:135], v[64:67]
s_waitcnt lgkmcnt(3)
v_add_f32 v10, v10, v52
v_mfma_f32_16x16x32_bf16 v[40:43], a[16:19], a[48:51], v[16:19]
ds_read_b128 a[36:39], v8 offset:34624
v_add_f32 v10, v10, v53
v_mfma_f32_16x16x32_bf16 v[40:43], a[20:23], a[60:63], v[40:43]
v_exp_f32 v63, v63
v_mfma_f32_16x16x32_bf16 v[44:47], a[20:23], a[64:67], v[20:23]
v_cvt_pk_bf16_f32 v39, v62, v63
v_add_f32 v10, v10, v54
v_mfma_f32_16x16x32_bf16 v[44:47], a[16:19], a[52:55], v[44:47]
ds_read_b128 a[40:43], v8 offset:34688
v_max3_f32 v13, v64, v65, v66
v_mfma_f32_16x16x32_bf16 v[48:51], a[16:19], a[56:59], v[24:27]
v_max3_f32 v13, v13, v67, v68
v_add_f32 v10, v10, v55
v_mfma_f32_16x16x32_bf16 v[48:51], a[20:23], a[68:71], v[48:51]
s_waitcnt lgkmcnt(3)
v_max3_f32 v13, v13, v69, v70
v_mfma_f32_16x16x32_bf16 v[48:51], a[24:27], a[80:83], v[48:51]
ds_read_b128 a[44:47], v8 offset:34752
v_max3_f32 v13, v13, v71, v72
v_mfma_f32_16x16x32_bf16 v[48:51], a[28:31], a[92:95], v[48:51]
v_max3_f32 v13, v13, v73, v74
v_add_f32 v11, v11, v56
v_mfma_f32_16x16x32_bf16 v[44:47], a[28:31], a[88:91], v[44:47]
v_add_f32 v11, v11, v57
v_add_f32 v11, v11, v58
v_mfma_f32_16x16x32_bf16 v[44:47], a[24:27], a[76:79], v[44:47]
v_add_u32 v9, 67584, v9
ds_read_b64_tr_b16 a[16:17], v9 offset:0
v_mfma_f32_16x16x32_bf16 v[40:43], a[24:27], a[72:75], v[40:43]
ds_read_b64_tr_b16 a[18:19], v9 offset:512
v_add_f32 v11, v11, v59
v_mfma_f32_16x16x32_bf16 v[40:43], a[28:31], a[84:87], v[40:43]
s_waitcnt lgkmcnt(4)
v_add_f32 v12, v12, v60
v_mfma_f32_16x16x32_bf16 v[40:43], a[32:35], a[96:99], v[40:43]
ds_read_b64_tr_b16 a[20:21], v9 offset:32
v_add_f32 v12, v12, v61
v_mfma_f32_16x16x32_bf16 v[40:43], a[36:39], a[108:111], v[40:43]
ds_read_b64_tr_b16 a[22:23], v9 offset:544
v_add_f32 v12, v12, v62
v_mfma_f32_16x16x32_bf16 v[44:47], a[36:39], a[112:115], v[44:47]
v_add_f32 v12, v12, v63
v_max_f32 v13, v13, v75
v_mfma_f32_16x16x32_bf16 v[44:47], a[32:35], a[100:103], v[44:47]
ds_read_b64_tr_b16 a[24:25], v9 offset:64
v_mfma_f32_16x16x32_bf16 v[48:51], a[32:35], a[104:107], v[48:51]
ds_read_b64_tr_b16 a[26:27], v9 offset:576
v_mfma_f32_16x16x32_bf16 v[48:51], a[36:39], a[116:119], v[48:51]
s_waitcnt lgkmcnt(6)
v_mfma_f32_16x16x32_bf16 v[48:51], a[40:43], a[128:131], v[48:51]
ds_read_b64_tr_b16 a[28:29], v9 offset:96
v_mfma_f32_16x16x32_bf16 v[48:51], a[44:47], a[140:143], v[48:51]
ds_read_b64_tr_b16 a[30:31], v9 offset:608
v_mfma_f32_16x16x32_bf16 v[44:47], a[44:47], a[136:139], v[44:47]
v_mfma_f32_16x16x32_bf16 v[44:47], a[40:43], a[124:127], v[44:47]
ds_read_b64_tr_b16 a[32:33], v9 offset:128
v_mfma_f32_16x16x32_bf16 v[40:43], a[40:43], a[120:123], v[40:43]
ds_read_b64_tr_b16 a[34:35], v9 offset:640
v_mfma_f32_16x16x32_bf16 v[40:43], a[44:47], a[132:135], v[40:43]
s_waitcnt lgkmcnt(6)
LS_40:
v_mfma_f32_16x16x32_bf16 v[76:79], a[16:19], v[28:31], v[76:79]
ds_read_b64_tr_b16 a[36:37], v9 offset:160
v_mfma_f32_16x16x32_bf16 v[80:83], a[16:19], v[32:35], v[80:83]
ds_read_b64_tr_b16 a[38:39], v9 offset:672
v_mfma_f32_16x16x32_bf16 v[84:87], a[16:19], v[36:39], v[84:87]
s_add_u32 m0, s17, 101376
s_mov_b32 s50, 245760
v_mfma_f32_16x16x32_bf16 v[96:99], a[20:23], v[36:39], v[96:99]
ds_read_b64_tr_b16 a[40:41], v9 offset:192
v_max3_f32 v13, v13, v40, v41
v_mfma_f32_16x16x32_bf16 v[92:95], a[20:23], v[32:35], v[92:95]
ds_read_b64_tr_b16 a[42:43], v9 offset:704
v_max3_f32 v13, v13, v42, v43
v_mfma_f32_16x16x32_bf16 v[88:91], a[20:23], v[28:31], v[88:91]
s_waitcnt lgkmcnt(6)
v_max3_f32 v13, v13, v44, v45
v_mfma_f32_16x16x32_bf16 v[100:103], a[24:27], v[28:31], v[100:103]
ds_read_b64_tr_b16 a[44:45], v9 offset:224
v_max3_f32 v13, v13, v46, v47
v_mfma_f32_16x16x32_bf16 v[104:107], a[24:27], v[32:35], v[104:107]
ds_read_b64_tr_b16 a[46:47], v9 offset:736
v_max3_f32 v13, v13, v48, v49
v_mfma_f32_16x16x32_bf16 v[108:111], a[24:27], v[36:39], v[108:111]
buffer_load_dwordx4 v0, s[20:23], s50 offen offset:0 nt lds
v_mfma_f32_16x16x32_bf16 v[120:123], a[28:31], v[36:39], v[120:123]
ds_read_b64_tr_b16 a[16:17], v9 offset:256
v_max3_f32 v13, v13, v50, v51
v_mfma_f32_16x16x32_bf16 v[116:119], a[28:31], v[32:35], v[116:119]
ds_read_b64_tr_b16 a[18:19], v9 offset:768
v_cmp_lt_f32 vcc, s47, v13
v_mfma_f32_16x16x32_bf16 v[112:115], a[28:31], v[28:31], v[112:115]
s_waitcnt lgkmcnt(6)
v_mfma_f32_16x16x32_bf16 v[124:127], a[32:35], v[28:31], v[124:127]
ds_read_b64_tr_b16 a[20:21], v9 offset:288
ds_read_b64_tr_b16 a[22:23], v9 offset:800
v_mfma_f32_16x16x32_bf16 v[128:131], a[32:35], v[32:35], v[128:131]
s_cbranch_vccnz RARE_h0j12
RET_h0j12:
v_mfma_f32_16x16x32_bf16 v[132:135], a[32:35], v[36:39], v[132:135]
buffer_load_dwordx4 v1, s[20:23], s50 offen offset:1056 nt lds
v_mfma_f32_16x16x32_bf16 v[144:147], a[36:39], v[36:39], v[144:147]
ds_read_b64_tr_b16 a[24:25], v9 offset:320
ds_read_b64_tr_b16 a[26:27], v9 offset:832
v_mfma_f32_16x16x32_bf16 v[140:143], a[36:39], v[32:35], v[140:143]
v_exp_f32 v40, v40
v_mfma_f32_16x16x32_bf16 v[136:139], a[36:39], v[28:31], v[136:139]
s_waitcnt lgkmcnt(6)
v_add_f32 v10, v10, v40
v_mfma_f32_16x16x32_bf16 v[148:151], a[40:43], v[28:31], v[148:151]
ds_read_b64_tr_b16 a[28:29], v9 offset:352
ds_read_b64_tr_b16 a[30:31], v9 offset:864
v_mfma_f32_16x16x32_bf16 v[152:155], a[40:43], v[32:35], v[152:155]
buffer_load_dwordx4 v2, s[20:23], s50 offen offset:2112 nt lds
v_mfma_f32_16x16x32_bf16 v[156:159], a[40:43], v[36:39], v[156:159]
s_waitcnt vmcnt(7)
s_barrier
v_mfma_f32_16x16x32_bf16 v[168:171], a[44:47], v[36:39], v[168:171]
ds_read_b64_tr_b16 a[32:33], v9 offset:384
ds_read_b64_tr_b16 a[34:35], v9 offset:896
v_mfma_f32_16x16x32_bf16 v[164:167], a[44:47], v[32:35], v[164:167]
buffer_load_dwordx4 v3, s[20:23], s50 offen offset:3168 nt lds
v_mfma_f32_16x16x32_bf16 v[160:163], a[44:47], v[28:31], v[160:163]
s_waitcnt lgkmcnt(6)
s_add_u32 m0, s17, 135168
s_add_u32 s50, s99, 512
v_mfma_f32_16x16x32_bf16 v[172:175], a[16:19], v[28:31], v[172:175]
ds_read_b64_tr_b16 a[36:37], v9 offset:416
ds_read_b64_tr_b16 a[38:39], v9 offset:928
v_mfma_f32_16x16x32_bf16 v[176:179], a[16:19], v[32:35], v[176:179]
buffer_load_dwordx4 v4, s[28:31], s50 offen offset:0 lds
v_mfma_f32_16x16x32_bf16 v[180:183], a[16:19], v[36:39], v[180:183]
v_exp_f32 v41, v41
v_mfma_f32_16x16x32_bf16 v[192:195], a[20:23], v[36:39], v[192:195]
ds_read_b64_tr_b16 a[40:41], v9 offset:448
ds_read_b64_tr_b16 a[42:43], v9 offset:960
v_add_f32 v10, v10, v41
v_mfma_f32_16x16x32_bf16 v[188:191], a[20:23], v[32:35], v[188:191]
buffer_load_dwordx4 v5, s[28:31], s50 offen offset:1056 lds
v_mfma_f32_16x16x32_bf16 v[184:187], a[20:23], v[28:31], v[184:187]
s_waitcnt lgkmcnt(6)
v_exp_f32 v42, v42
v_mfma_f32_16x16x32_bf16 v[196:199], a[24:27], v[28:31], v[196:199]
ds_read_b64_tr_b16 a[44:45], v9 offset:480
ds_read_b64_tr_b16 a[46:47], v9 offset:992
v_add_f32 v10, v10, v42
v_mfma_f32_16x16x32_bf16 v[200:203], a[24:27], v[32:35], v[200:203]
buffer_load_dwordx4 v6, s[28:31], s50 offen offset:2112 lds
v_mfma_f32_16x16x32_bf16 v[204:207], a[24:27], v[36:39], v[204:207]
v_exp_f32 v43, v43
v_mfma_f32_16x16x32_bf16 v[216:219], a[28:31], v[36:39], v[216:219]
v_subrev_u32 v8, 16896, v8
ds_read_b128 a[16:19], v8 offset:512
v_add_f32 v10, v10, v43
v_mfma_f32_16x16x32_bf16 v[212:215], a[28:31], v[32:35], v[212:215]
v_exp_f32 v44, v44
v_mfma_f32_16x16x32_bf16 v[208:211], a[28:31], v[28:31], v[208:211]
s_waitcnt lgkmcnt(5)
v_exp_f32 v45, v45
v_mfma_f32_16x16x32_bf16 v[220:223], a[32:35], v[28:31], v[220:223]
ds_read_b128 a[20:23], v8 offset:576
v_exp_f32 v46, v46
v_mfma_f32_16x16x32_bf16 v[224:227], a[32:35], v[32:35], v[224:227]
v_exp_f32 v47, v47
v_mfma_f32_16x16x32_bf16 v[228:231], a[32:35], v[36:39], v[228:231]
v_exp_f32 v48, v48
v_mfma_f32_16x16x32_bf16 v[240:243], a[36:39], v[36:39], v[240:243]
ds_read_b128 a[24:27], v8 offset:640
v_exp_f32 v49, v49
v_mfma_f32_16x16x32_bf16 v[236:239], a[36:39], v[32:35], v[236:239]
v_exp_f32 v50, v50
v_mfma_f32_16x16x32_bf16 v[232:235], a[36:39], v[28:31], v[232:235]
s_waitcnt lgkmcnt(3)
v_add_f32 v11, v11, v44
v_mfma_f32_16x16x32_bf16 v[244:247], a[40:43], v[28:31], v[244:247]
ds_read_b128 a[28:31], v8 offset:704
v_exp_f32 v51, v51
v_mfma_f32_16x16x32_bf16 v[248:251], a[40:43], v[32:35], v[248:251]
buffer_load_dwordx4 v7, s[28:31], s50 offen offset:3168 lds
v_mfma_f32_16x16x32_bf16 a[0:3], a[40:43], v[36:39], a[0:3]
v_add_f32 v11, v11, v45
v_add_f32 v11, v11, v46
v_mfma_f32_16x16x32_bf16 a[12:15], a[44:47], v[36:39], a[12:15]
ds_read_b128 a[32:35], v8 offset:768
v_add_f32 v11, v11, v47
v_add_f32 v12, v12, v48
v_mfma_f32_16x16x32_bf16 a[8:11], a[44:47], v[32:35], a[8:11]
v_add_f32 v12, v12, v49
v_add_f32 v12, v12, v50
v_mfma_f32_16x16x32_bf16 a[4:7], a[44:47], v[28:31], a[4:7]
s_waitcnt lgkmcnt(3)
v_add_f32 v12, v12, v51
LS_41:
v_mfma_f32_16x16x32_bf16 v[52:55], a[16:19], a[48:51], v[16:19]
ds_read_b128 a[36:39], v8 offset:832
v_cvt_pk_bf16_f32 v30, v40, v41
v_mfma_f32_16x16x32_bf16 v[52:55], a[20:23], a[60:63], v[52:55]
s_add_u32 m0, s17, 118272
s_mov_b32 s50, 229376
v_mfma_f32_16x16x32_bf16 v[56:59], a[20:23], a[64:67], v[20:23]
buffer_load_dwordx4 v0, s[24:27], s50 offen offset:0 nt lds
v_mfma_f32_16x16x32_bf16 v[56:59], a[16:19], a[52:55], v[56:59]
ds_read_b128 a[40:43], v8 offset:896
v_cvt_pk_bf16_f32 v31, v42, v43
v_mfma_f32_16x16x32_bf16 v[60:63], a[16:19], a[56:59], v[24:27]
v_exp_f32 v64, v64
v_mfma_f32_16x16x32_bf16 v[60:63], a[20:23], a[68:71], v[60:63]
s_waitcnt lgkmcnt(3)
v_cvt_pk_bf16_f32 v34, v44, v45
v_mfma_f32_16x16x32_bf16 v[60:63], a[24:27], a[80:83], v[60:63]
ds_read_b128 a[44:47], v8 offset:960
v_cvt_pk_bf16_f32 v35, v46, v47
v_mfma_f32_16x16x32_bf16 v[60:63], a[28:31], a[92:95], v[60:63]
buffer_load_dwordx4 v1, s[24:27], s50 offen offset:1056 nt lds
v_mfma_f32_16x16x32_bf16 v[56:59], a[28:31], a[88:91], v[56:59]
v_exp_f32 v65, v65
v_mfma_f32_16x16x32_bf16 v[56:59], a[24:27], a[76:79], v[56:59]
ds_read_b128 a[16:19], v8 offset:0
v_cvt_pk_bf16_f32 v38, v48, v49
v_mfma_f32_16x16x32_bf16 v[52:55], a[24:27], a[72:75], v[52:55]
v_exp_f32 v66, v66
v_mfma_f32_16x16x32_bf16 v[52:55], a[28:31], a[84:87], v[52:55]
s_waitcnt lgkmcnt(3)
v_cvt_pk_bf16_f32 v39, v50, v51
v_mfma_f32_16x16x32_bf16 v[52:55], a[32:35], a[96:99], v[52:55]
ds_read_b128 a[20:23], v8 offset:64
v_cvt_pk_bf16_f32 v28, v64, v65
v_mfma_f32_16x16x32_bf16 v[52:55], a[36:39], a[108:111], v[52:55]
v_exp_f32 v67, v67
v_mfma_f32_16x16x32_bf16 v[56:59], a[36:39], a[112:115], v[56:59]
v_exp_f32 v68, v68
v_mfma_f32_16x16x32_bf16 v[56:59], a[32:35], a[100:103], v[56:59]
ds_read_b128 a[24:27], v8 offset:128
v_cvt_pk_bf16_f32 v29, v66, v67
v_mfma_f32_16x16x32_bf16 v[60:63], a[32:35], a[104:107], v[60:63]
v_exp_f32 v69, v69
v_mfma_f32_16x16x32_bf16 v[60:63], a[36:39], a[116:119], v[60:63]
s_waitcnt lgkmcnt(3)
v_cvt_pk_bf16_f32 v32, v68, v69
v_mfma_f32_16x16x32_bf16 v[60:63], a[40:43], a[128:131], v[60:63]
ds_read_b128 a[28:31], v8 offset:192
v_add_f32 v10, v10, v64
v_mfma_f32_16x16x32_bf16 v[60:63], a[44:47], a[140:143], v[60:63]
v_exp_f32 v70, v70
v_mfma_f32_16x16x32_bf16 v[56:59], a[44:47], a[136:139], v[56:59]
s_waitcnt vmcnt(10)
s_barrier
v_mfma_f32_16x16x32_bf16 v[56:59], a[40:43], a[124:127], v[56:59]
ds_read_b128 a[32:35], v8 offset:256
v_add_f32 v10, v10, v65
v_mfma_f32_16x16x32_bf16 v[52:55], a[40:43], a[120:123], v[52:55]
v_exp_f32 v71, v71
v_mfma_f32_16x16x32_bf16 v[52:55], a[44:47], a[132:135], v[52:55]
s_waitcnt lgkmcnt(3)
v_cvt_pk_bf16_f32 v33, v70, v71
v_mfma_f32_16x16x32_bf16 v[40:43], a[16:19], a[48:51], v[16:19]
ds_read_b128 a[36:39], v8 offset:320
v_add_f32 v10, v10, v66
v_mfma_f32_16x16x32_bf16 v[40:43], a[20:23], a[60:63], v[40:43]
v_exp_f32 v72, v72
v_mfma_f32_16x16x32_bf16 v[44:47], a[20:23], a[64:67], v[20:23]
v_exp_f32 v73, v73
v_mfma_f32_16x16x32_bf16 v[44:47], a[16:19], a[52:55], v[44:47]
ds_read_b128 a[40:43], v8 offset:384
v_max3_f32 v13, v52, v53, v54
v_mfma_f32_16x16x32_bf16 v[48:51], a[16:19], a[56:59], v[24:27]
v_exp_f32 v74, v74
v_mfma_f32_16x16x32_bf16 v[48:51], a[20:23], a[68:71], v[48:51]
s_waitcnt lgkmcnt(3)
v_max3_f32 v13, v13, v55, v56
v_mfma_f32_16x16x32_bf16 v[48:51], a[24:27], a[80:83], v[48:51]
ds_read_b128 a[44:47], v8 offset:448
v_max3_f32 v13, v13, v57, v58
v_mfma_f32_16x16x32_bf16 v[48:51], a[28:31], a[92:95], v[48:51]
v_exp_f32 v75, v75
v_mfma_f32_16x16x32_bf16 v[44:47], a[28:31], a[88:91], v[44:47]
buffer_load_dwordx4 v2, s[24:27], s50 offen offset:2112 nt lds
v_mfma_f32_16x16x32_bf16 v[44:47], a[24:27], a[76:79], v[44:47]
ds_read_b64_tr_b16 a[16:17], v9 offset:16896
v_cvt_pk_bf16_f32 v36, v72, v73
v_mfma_f32_16x16x32_bf16 v[40:43], a[24:27], a[72:75], v[40:43]
ds_read_b64_tr_b16 a[18:19], v9 offset:17408
v_cvt_pk_bf16_f32 v37, v74, v75
v_mfma_f32_16x16x32_bf16 v[40:43], a[28:31], a[84:87], v[40:43]
s_waitcnt lgkmcnt(4)
v_max3_f32 v13, v13, v59, v60
v_mfma_f32_16x16x32_bf16 v[40:43], a[32:35], a[96:99], v[40:43]
ds_read_b64_tr_b16 a[20:21], v9 offset:16928
v_max3_f32 v13, v13, v61, v62
v_mfma_f32_16x16x32_bf16 v[40:43], a[36:39], a[108:111], v[40:43]
ds_read_b64_tr_b16 a[22:23], v9 offset:17440
v_add_f32 v10, v10, v67
v_mfma_f32_16x16x32_bf16 v[44:47], a[36:39], a[112:115], v[44:47]
buffer_load_dwordx4 v3, s[24:27], s50 offen offset:3168 nt lds
v_mfma_f32_16x16x32_bf16 v[44:47], a[32:35], a[100:103], v[44:47]
ds_read_b64_tr_b16 a[24:25], v9 offset:16960
v_add_f32 v11, v11, v68
v_mfma_f32_16x16x32_bf16 v[48:51], a[32:35], a[104:107], v[48:51]
ds_read_b64_tr_b16 a[26:27], v9 offset:17472
v_add_f32 v11, v11, v69
v_mfma_f32_16x16x32_bf16 v[48:51], a[36:39], a[116:119], v[48:51]
s_waitcnt lgkmcnt(6)
v_add_f32 v11, v11, v70
v_mfma_f32_16x16x32_bf16 v[48:51], a[40:43], a[128:131], v[48:51]
ds_read_b64_tr_b16 a[28:29], v9 offset:16992
v_add_f32 v11, v11, v71
v_mfma_f32_16x16x32_bf16 v[48:51], a[44:47], a[140:143], v[48:51]
ds_read_b64_tr_b16 a[30:31], v9 offset:17504
v_add_f32 v12, v12, v72
v_mfma_f32_16x16x32_bf16 v[44:47], a[44:47], a[136:139], v[44:47]
v_add_f32 v12, v12, v73
v_add_f32 v12, v12, v74
v_mfma_f32_16x16x32_bf16 v[44:47], a[40:43], a[124:127], v[44:47]
ds_read_b64_tr_b16 a[32:33], v9 offset:17024
v_add_f32 v12, v12, v75
v_mfma_f32_16x16x32_bf16 v[40:43], a[40:43], a[120:123], v[40:43]
ds_read_b64_tr_b16 a[34:35], v9 offset:17536
v_max_f32 v13, v13, v63
v_mfma_f32_16x16x32_bf16 v[40:43], a[44:47], a[132:135], v[40:43]
s_waitcnt lgkmcnt(6)
LS_42:
v_mfma_f32_16x16x32_bf16 v[76:79], a[16:19], v[28:31], v[76:79]
ds_read_b64_tr_b16 a[36:37], v9 offset:17056
v_mfma_f32_16x16x32_bf16 v[80:83], a[16:19], v[32:35], v[80:83]
ds_read_b64_tr_b16 a[38:39], v9 offset:17568
v_mfma_f32_16x16x32_bf16 v[84:87], a[16:19], v[36:39], v[84:87]
s_add_u32 m0, s17, 67584
s_mov_b32 s50, 245760
v_mfma_f32_16x16x32_bf16 v[96:99], a[20:23], v[36:39], v[96:99]
ds_read_b64_tr_b16 a[40:41], v9 offset:17088
v_max3_f32 v13, v13, v40, v41
v_mfma_f32_16x16x32_bf16 v[92:95], a[20:23], v[32:35], v[92:95]
ds_read_b64_tr_b16 a[42:43], v9 offset:17600
v_max3_f32 v13, v13, v42, v43
v_mfma_f32_16x16x32_bf16 v[88:91], a[20:23], v[28:31], v[88:91]
s_waitcnt lgkmcnt(6)
v_max3_f32 v13, v13, v44, v45
v_mfma_f32_16x16x32_bf16 v[100:103], a[24:27], v[28:31], v[100:103]
ds_read_b64_tr_b16 a[44:45], v9 offset:17120
v_max3_f32 v13, v13, v46, v47
v_mfma_f32_16x16x32_bf16 v[104:107], a[24:27], v[32:35], v[104:107]
ds_read_b64_tr_b16 a[46:47], v9 offset:17632
v_max3_f32 v13, v13, v48, v49
v_mfma_f32_16x16x32_bf16 v[108:111], a[24:27], v[36:39], v[108:111]
buffer_load_dwordx4 v0, s[24:27], s50 offen offset:0 nt lds
v_mfma_f32_16x16x32_bf16 v[120:123], a[28:31], v[36:39], v[120:123]
ds_read_b64_tr_b16 a[16:17], v9 offset:17152
v_max3_f32 v13, v13, v50, v51
v_mfma_f32_16x16x32_bf16 v[116:119], a[28:31], v[32:35], v[116:119]
ds_read_b64_tr_b16 a[18:19], v9 offset:17664
v_cmp_lt_f32 vcc, s47, v13
v_mfma_f32_16x16x32_bf16 v[112:115], a[28:31], v[28:31], v[112:115]
s_waitcnt lgkmcnt(6)
v_mfma_f32_16x16x32_bf16 v[124:127], a[32:35], v[28:31], v[124:127]
ds_read_b64_tr_b16 a[20:21], v9 offset:17184
ds_read_b64_tr_b16 a[22:23], v9 offset:17696
v_mfma_f32_16x16x32_bf16 v[128:131], a[32:35], v[32:35], v[128:131]
s_cbranch_vccnz RARE_h0j13
RET_h0j13:
v_mfma_f32_16x16x32_bf16 v[132:135], a[32:35], v[36:39], v[132:135]
buffer_load_dwordx4 v1, s[24:27], s50 offen offset:1056 nt lds
v_mfma_f32_16x16x32_bf16 v[144:147], a[36:39], v[36:39], v[144:147]
ds_read_b64_tr_b16 a[24:25], v9 offset:17216
ds_read_b64_tr_b16 a[26:27], v9 offset:17728
v_mfma_f32_16x16x32_bf16 v[140:143], a[36:39], v[32:35], v[140:143]
buffer_load_dwordx4 v2, s[24:27], s50 offen offset:2112 nt lds
v_mfma_f32_16x16x32_bf16 v[136:139], a[36:39], v[28:31], v[136:139]
s_waitcnt lgkmcnt(6)
v_exp_f32 v40, v40
v_mfma_f32_16x16x32_bf16 v[148:151], a[40:43], v[28:31], v[148:151]
ds_read_b64_tr_b16 a[28:29], v9 offset:17248
ds_read_b64_tr_b16 a[30:31], v9 offset:17760
v_add_f32 v10, v10, v40
v_mfma_f32_16x16x32_bf16 v[152:155], a[40:43], v[32:35], v[152:155]
buffer_load_dwordx4 v3, s[24:27], s50 offen offset:3168 nt lds
v_mfma_f32_16x16x32_bf16 v[156:159], a[40:43], v[36:39], v[156:159]
s_waitcnt vmcnt(12)
s_barrier
v_mfma_f32_16x16x32_bf16 v[168:171], a[44:47], v[36:39], v[168:171]
ds_read_b64_tr_b16 a[32:33], v9 offset:17280
ds_read_b64_tr_b16 a[34:35], v9 offset:17792
v_mfma_f32_16x16x32_bf16 v[164:167], a[44:47], v[32:35], v[164:167]
s_add_u32 m0, s52, 0
s_add_u32 s50, s18, 0
v_mfma_f32_16x16x32_bf16 v[160:163], a[44:47], v[28:31], v[160:163]
s_waitcnt lgkmcnt(6)
v_exp_f32 v41, v41
v_mfma_f32_16x16x32_bf16 v[172:175], a[16:19], v[28:31], v[172:175]
ds_read_b64_tr_b16 a[36:37], v9 offset:17312
ds_read_b64_tr_b16 a[38:39], v9 offset:17824
buffer_load_dwordx4 v14, s[36:39], s50 offen lds
v_mfma_f32_16x16x32_bf16 v[176:179], a[16:19], v[32:35], v[176:179]
v_exp_f32 v42, v42
v_add_f32 v10, v10, v41
v_mfma_f32_16x16x32_bf16 v[180:183], a[16:19], v[36:39], v[180:183]
v_exp_f32 v43, v43
v_mfma_f32_16x16x32_bf16 v[192:195], a[20:23], v[36:39], v[192:195]
ds_read_b64_tr_b16 a[40:41], v9 offset:17344
ds_read_b64_tr_b16 a[42:43], v9 offset:17856
buffer_load_dwordx4 v253, s[36:39], s50 offen offset:1024 lds
v_mfma_f32_16x16x32_bf16 v[188:191], a[20:23], v[32:35], v[188:191]
s_add_u32 m0, s52, 2048
s_add_u32 s50, s18, 14336
v_mfma_f32_16x16x32_bf16 v[184:187], a[20:23], v[28:31], v[184:187]
s_waitcnt lgkmcnt(6)
buffer_load_dwordx4 v14, s[36:39], s50 offen lds
v_mfma_f32_16x16x32_bf16 v[196:199], a[24:27], v[28:31], v[196:199]
ds_read_b64_tr_b16 a[44:45], v9 offset:17376
ds_read_b64_tr_b16 a[46:47], v9 offset:17888
v_add_f32 v10, v10, v42
v_mfma_f32_16x16x32_bf16 v[200:203], a[24:27], v[32:35], v[200:203]
v_exp_f32 v44, v44
v_mfma_f32_16x16x32_bf16 v[204:207], a[24:27], v[36:39], v[204:207]
v_exp_f32 v45, v45
v_mfma_f32_16x16x32_bf16 v[216:219], a[28:31], v[36:39], v[216:219]
v_add_u32 v8, 84480, v8
ds_read_b128 a[16:19], v8 offset:16896
buffer_load_dwordx4 v253, s[36:39], s50 offen offset:1024 lds
v_mfma_f32_16x16x32_bf16 v[212:215], a[28:31], v[32:35], v[212:215]
s_add_u32 m0, s52, 4096
s_add_u32 s50, s18, 28672
v_mfma_f32_16x16x32_bf16 v[208:211], a[28:31], v[28:31], v[208:211]
s_waitcnt lgkmcnt(5)
buffer_load_dwordx4 v14, s[36:39], s50 offen lds
v_mfma_f32_16x16x32_bf16 v[220:223], a[32:35], v[28:31], v[220:223]
ds_read_b128 a[20:23], v8 offset:16960
v_exp_f32 v46, v46
v_mfma_f32_16x16x32_bf16 v[224:227], a[32:35], v[32:35], v[224:227]
v_exp_f32 v47, v47
v_mfma_f32_16x16x32_bf16 v[228:231], a[32:35], v[36:39], v[228:231]
v_exp_f32 v48, v48
v_mfma_f32_16x16x32_bf16 v[240:243], a[36:39], v[36:39], v[240:243]
ds_read_b128 a[24:27], v8 offset:17024
v_exp_f32 v49, v49
v_mfma_f32_16x16x32_bf16 v[236:239], a[36:39], v[32:35], v[236:239]
v_exp_f32 v50, v50
v_mfma_f32_16x16x32_bf16 v[232:235], a[36:39], v[28:31], v[232:235]
s_waitcnt lgkmcnt(3)
v_add_f32 v10, v10, v43
v_mfma_f32_16x16x32_bf16 v[244:247], a[40:43], v[28:31], v[244:247]
ds_read_b128 a[28:31], v8 offset:17088
v_exp_f32 v51, v51
v_mfma_f32_16x16x32_bf16 v[248:251], a[40:43], v[32:35], v[248:251]
v_add_f32 v11, v11, v44
v_add_f32 v11, v11, v45
v_mfma_f32_16x16x32_bf16 a[0:3], a[40:43], v[36:39], a[0:3]
v_add_f32 v11, v11, v46
v_add_f32 v11, v11, v47
v_mfma_f32_16x16x32_bf16 a[12:15], a[44:47], v[36:39], a[12:15]
ds_read_b128 a[32:35], v8 offset:17152
v_add_f32 v12, v12, v48
v_add_f32 v12, v12, v49
v_mfma_f32_16x16x32_bf16 a[8:11], a[44:47], v[32:35], a[8:11]
v_add_f32 v12, v12, v50
v_add_f32 v12, v12, v51
v_mfma_f32_16x16x32_bf16 a[4:7], a[44:47], v[28:31], a[4:7]
s_waitcnt lgkmcnt(3)
buffer_load_dwordx4 v253, s[36:39], s50 offen offset:1024 lds
LS_43:
v_mfma_f32_16x16x32_bf16 v[64:67], a[16:19], a[48:51], v[16:19]
ds_read_b128 a[36:39], v8 offset:17216
v_cvt_pk_bf16_f32 v28, v40, v41
v_mfma_f32_16x16x32_bf16 v[64:67], a[20:23], a[60:63], v[64:67]
v_exp_f32 v52, v52
v_mfma_f32_16x16x32_bf16 v[68:71], a[20:23], a[64:67], v[20:23]
v_exp_f32 v53, v53
v_mfma_f32_16x16x32_bf16 v[68:71], a[16:19], a[52:55], v[68:71]
ds_read_b128 a[40:43], v8 offset:17280
v_cvt_pk_bf16_f32 v29, v42, v43
v_mfma_f32_16x16x32_bf16 v[72:75], a[16:19], a[56:59], v[24:27]
v_exp_f32 v54, v54
v_mfma_f32_16x16x32_bf16 v[72:75], a[20:23], a[68:71], v[72:75]
s_waitcnt lgkmcnt(3)
v_cvt_pk_bf16_f32 v32, v44, v45
v_mfma_f32_16x16x32_bf16 v[72:75], a[24:27], a[80:83], v[72:75]
ds_read_b128 a[44:47], v8 offset:17344
v_cvt_pk_bf16_f32 v33, v46, v47
v_mfma_f32_16x16x32_bf16 v[72:75], a[28:31], a[92:95], v[72:75]
v_exp_f32 v55, v55
v_mfma_f32_16x16x32_bf16 v[68:71], a[28:31], a[88:91], v[68:71]
v_exp_f32 v56, v56
v_mfma_f32_16x16x32_bf16 v[68:71], a[24:27], a[76:79], v[68:71]
ds_read_b128 a[16:19], v8 offset:17408
v_cvt_pk_bf16_f32 v36, v48, v49
v_mfma_f32_16x16x32_bf16 v[64:67], a[24:27], a[72:75], v[64:67]
v_exp_f32 v57, v57
v_mfma_f32_16x16x32_bf16 v[64:67], a[28:31], a[84:87], v[64:67]
s_waitcnt lgkmcnt(3)
v_cvt_pk_bf16_f32 v37, v50, v51
v_mfma_f32_16x16x32_bf16 v[64:67], a[32:35], a[96:99], v[64:67]
ds_read_b128 a[20:23], v8 offset:17472
v_cvt_pk_bf16_f32 v30, v52, v53
v_mfma_f32_16x16x32_bf16 v[64:67], a[36:39], a[108:111], v[64:67]
v_exp_f32 v58, v58
v_mfma_f32_16x16x32_bf16 v[68:71], a[36:39], a[112:115], v[68:71]
v_exp_f32 v59, v59
v_mfma_f32_16x16x32_bf16 v[68:71], a[32:35], a[100:103], v[68:71]
ds_read_b128 a[24:27], v8 offset:17536
v_cvt_pk_bf16_f32 v31, v54, v55
v_mfma_f32_16x16x32_bf16 v[72:75], a[32:35], a[104:107], v[72:75]
v_exp_f32 v60, v60
v_mfma_f32_16x16x32_bf16 v[72:75], a[36:39], a[116:119], v[72:75]
s_waitcnt lgkmcnt(3)
v_cvt_pk_bf16_f32 v34, v56, v57
v_mfma_f32_16x16x32_bf16 v[72:75], a[40:43], a[128:131], v[72:75]
ds_read_b128 a[28:31], v8 offset:17600
v_cvt_pk_bf16_f32 v35, v58, v59
v_mfma_f32_16x16x32_bf16 v[72:75], a[44:47], a[140:143], v[72:75]
v_exp_f32 v61, v61
v_mfma_f32_16x16x32_bf16 v[68:71], a[44:47], a[136:139], v[68:71]
s_waitcnt vmcnt(10)
s_barrier
v_mfma_f32_16x16x32_bf16 v[68:71], a[40:43], a[124:127], v[68:71]
ds_read_b128 a[32:35], v8 offset:17664
v_cvt_pk_bf16_f32 v38, v60, v61
v_mfma_f32_16x16x32_bf16 v[64:67], a[40:43], a[120:123], v[64:67]
s_add_u32 m0, s17, 84480
s_add_u32 s50, s99, 262656
v_mfma_f32_16x16x32_bf16 v[64:67], a[44:47], a[132:135], v[64:67]
s_waitcnt lgkmcnt(3)
v_add_f32 v10, v10, v52
v_mfma_f32_16x16x32_bf16 v[40:43], a[16:19], a[48:51], v[16:19]
ds_read_b128 a[36:39], v8 offset:17728
v_add_f32 v10, v10, v53
v_mfma_f32_16x16x32_bf16 v[40:43], a[20:23], a[60:63], v[40:43]
buffer_load_dwordx4 v4, s[28:31], s50 offen offset:0 lds
v_mfma_f32_16x16x32_bf16 v[44:47], a[20:23], a[64:67], v[20:23]
v_exp_f32 v62, v62
v_mfma_f32_16x16x32_bf16 v[44:47], a[16:19], a[52:55], v[44:47]
ds_read_b128 a[40:43], v8 offset:17792
v_max3_f32 v13, v64, v65, v66
v_mfma_f32_16x16x32_bf16 v[48:51], a[16:19], a[56:59], v[24:27]
buffer_load_dwordx4 v5, s[28:31], s50 offen offset:1056 lds
v_mfma_f32_16x16x32_bf16 v[48:51], a[20:23], a[68:71], v[48:51]
s_waitcnt lgkmcnt(3)
v_max3_f32 v13, v13, v67, v68
v_mfma_f32_16x16x32_bf16 v[48:51], a[24:27], a[80:83], v[48:51]
ds_read_b128 a[44:47], v8 offset:17856
v_max3_f32 v13, v13, v69, v70
v_mfma_f32_16x16x32_bf16 v[48:51], a[28:31], a[92:95], v[48:51]
v_exp_f32 v63, v63
v_mfma_f32_16x16x32_bf16 v[44:47], a[28:31], a[88:91], v[44:47]
buffer_load_dwordx4 v6, s[28:31], s50 offen offset:2112 lds
v_mfma_f32_16x16x32_bf16 v[44:47], a[24:27], a[76:79], v[44:47]
ds_read_b64_tr_b16 a[16:17], v9 offset:50688
v_cvt_pk_bf16_f32 v39, v62, v63
v_mfma_f32_16x16x32_bf16 v[40:43], a[24:27], a[72:75], v[40:43]
ds_read_b64_tr_b16 a[18:19], v9 offset:51200
v_max3_f32 v13, v13, v71, v72
v_mfma_f32_16x16x32_bf16 v[40:43], a[28:31], a[84:87], v[40:43]
s_waitcnt lgkmcnt(4)
v_max3_f32 v13, v13, v73, v74
v_mfma_f32_16x16x32_bf16 v[40:43], a[32:35], a[96:99], v[40:43]
ds_read_b64_tr_b16 a[20:21], v9 offset:50720
v_add_f32 v10, v10, v54
v_mfma_f32_16x16x32_bf16 v[40:43], a[36:39], a[108:111], v[40:43]
ds_read_b64_tr_b16 a[22:23], v9 offset:51232
v_add_f32 v10, v10, v55
v_mfma_f32_16x16x32_bf16 v[44:47], a[36:39], a[112:115], v[44:47]
buffer_load_dwordx4 v7, s[28:31], s50 offen offset:3168 lds
v_mfma_f32_16x16x32_bf16 v[44:47], a[32:35], a[100:103], v[44:47]
ds_read_b64_tr_b16 a[24:25], v9 offset:50752
v_add_f32 v11, v11, v56
v_mfma_f32_16x16x32_bf16 v[48:51], a[32:35], a[104:107], v[48:51]
ds_read_b64_tr_b16 a[26:27], v9 offset:51264
v_add_f32 v11, v11, v57
v_mfma_f32_16x16x32_bf16 v[48:51], a[36:39], a[116:119], v[48:51]
s_waitcnt lgkmcnt(6)
v_add_f32 v11, v11, v58
v_mfma_f32_16x16x32_bf16 v[48:51], a[40:43], a[128:131], v[48:51]
ds_read_b64_tr_b16 a[28:29], v9 offset:50784
v_add_f32 v11, v11, v59
v_mfma_f32_16x16x32_bf16 v[48:51], a[44:47], a[140:143], v[48:51]
ds_read_b64_tr_b16 a[30:31], v9 offset:51296
v_add_f32 v12, v12, v60
v_mfma_f32_16x16x32_bf16 v[44:47], a[44:47], a[136:139], v[44:47]
v_add_f32 v12, v12, v61
v_add_f32 v12, v12, v62
v_mfma_f32_16x16x32_bf16 v[44:47], a[40:43], a[124:127], v[44:47]
ds_read_b64_tr_b16 a[32:33], v9 offset:50816
v_add_f32 v12, v12, v63
v_mfma_f32_16x16x32_bf16 v[40:43], a[40:43], a[120:123], v[40:43]
ds_read_b64_tr_b16 a[34:35], v9 offset:51328
v_max_f32 v13, v13, v75
v_mfma_f32_16x16x32_bf16 v[40:43], a[44:47], a[132:135], v[40:43]
s_waitcnt lgkmcnt(6)
LS_44:
v_mfma_f32_16x16x32_bf16 v[76:79], a[16:19], v[28:31], v[76:79]
ds_read_b64_tr_b16 a[36:37], v9 offset:50848
s_add_u32 m0, s53, 0
s_add_u32 s50, s19, 0
v_mfma_f32_16x16x32_bf16 v[80:83], a[16:19], v[32:35], v[80:83]
ds_read_b64_tr_b16 a[38:39], v9 offset:51360
buffer_load_dwordx4 v14, s[36:39], s50 offen lds
v_mfma_f32_16x16x32_bf16 v[84:87], a[16:19], v[36:39], v[84:87]
v_mfma_f32_16x16x32_bf16 v[96:99], a[20:23], v[36:39], v[96:99]
ds_read_b64_tr_b16 a[40:41], v9 offset:50880
v_max3_f32 v13, v13, v40, v41
buffer_load_dwordx4 v253, s[36:39], s50 offen offset:1024 lds
v_mfma_f32_16x16x32_bf16 v[92:95], a[20:23], v[32:35], v[92:95]
ds_read_b64_tr_b16 a[42:43], v9 offset:51392
s_add_u32 m0, s53, 2048
s_add_u32 s50, s19, 14336
v_mfma_f32_16x16x32_bf16 v[88:91], a[20:23], v[28:31], v[88:91]
s_waitcnt lgkmcnt(6)
v_max3_f32 v13, v13, v42, v43
buffer_load_dwordx4 v14, s[36:39], s50 offen lds
v_mfma_f32_16x16x32_bf16 v[100:103], a[24:27], v[28:31], v[100:103]
ds_read_b64_tr_b16 a[44:45], v9 offset:50912
v_max3_f32 v13, v13, v44, v45
v_mfma_f32_16x16x32_bf16 v[104:107], a[24:27], v[32:35], v[104:107]
ds_read_b64_tr_b16 a[46:47], v9 offset:51424
v_max3_f32 v13, v13, v46, v47
buffer_load_dwordx4 v253, s[36:39], s50 offen offset:1024 lds
v_mfma_f32_16x16x32_bf16 v[108:111], a[24:27], v[36:39], v[108:111]
v_max3_f32 v13, v13, v48, v49
s_add_u32 m0, s53, 4096
s_add_u32 s50, s19, 28672
v_mfma_f32_16x16x32_bf16 v[120:123], a[28:31], v[36:39], v[120:123]
ds_read_b64_tr_b16 a[16:17], v9 offset:50944
v_max3_f32 v13, v13, v50, v51
buffer_load_dwordx4 v14, s[36:39], s50 offen lds
v_mfma_f32_16x16x32_bf16 v[116:119], a[28:31], v[32:35], v[116:119]
ds_read_b64_tr_b16 a[18:19], v9 offset:51456
v_cmp_lt_f32 vcc, s47, v13
v_mfma_f32_16x16x32_bf16 v[112:115], a[28:31], v[28:31], v[112:115]
s_waitcnt lgkmcnt(6)
buffer_load_dwordx4 v253, s[36:39], s50 offen offset:1024 lds
v_mfma_f32_16x16x32_bf16 v[124:127], a[32:35], v[28:31], v[124:127]
ds_read_b64_tr_b16 a[20:21], v9 offset:50976
ds_read_b64_tr_b16 a[22:23], v9 offset:51488
s_cbranch_vccnz RARE_h0j14
RET_h0j14:
v_mfma_f32_16x16x32_bf16 v[128:131], a[32:35], v[32:35], v[128:131]
v_exp_f32 v40, v40
v_mfma_f32_16x16x32_bf16 v[132:135], a[32:35], v[36:39], v[132:135]
v_exp_f32 v41, v41
v_add_f32 v10, v10, v40
v_mfma_f32_16x16x32_bf16 v[144:147], a[36:39], v[36:39], v[144:147]
ds_read_b64_tr_b16 a[24:25], v9 offset:51008
ds_read_b64_tr_b16 a[26:27], v9 offset:51520
v_mfma_f32_16x16x32_bf16 v[140:143], a[36:39], v[32:35], v[140:143]
v_exp_f32 v42, v42
v_add_f32 v10, v10, v41
v_mfma_f32_16x16x32_bf16 v[136:139], a[36:39], v[28:31], v[136:139]
s_waitcnt lgkmcnt(6)
v_add_f32 v10, v10, v42
v_mfma_f32_16x16x32_bf16 v[148:151], a[40:43], v[28:31], v[148:151]
ds_read_b64_tr_b16 a[28:29], v9 offset:51040
ds_read_b64_tr_b16 a[30:31], v9 offset:51552
v_mfma_f32_16x16x32_bf16 v[152:155], a[40:43], v[32:35], v[152:155]
v_exp_f32 v43, v43
v_mfma_f32_16x16x32_bf16 v[156:159], a[40:43], v[36:39], v[156:159]
s_waitcnt vmcnt(16)
s_barrier
v_add_f32 v10, v10, v43
v_mfma_f32_16x16x32_bf16 v[168:171], a[44:47], v[36:39], v[168:171]
ds_read_b64_tr_b16 a[32:33], v9 offset:51072
ds_read_b64_tr_b16 a[34:35], v9 offset:51584
v_mfma_f32_16x16x32_bf16 v[164:167], a[44:47], v[32:35], v[164:167]
s_add_u32 m0, s17, 101376
s_add_u32 s50, s100, 512
v_mfma_f32_16x16x32_bf16 v[160:163], a[44:47], v[28:31], v[160:163]
s_waitcnt lgkmcnt(6)
buffer_load_dwordx4 v4, s[28:31], s50 offen offset:0 lds
v_mfma_f32_16x16x32_bf16 v[172:175], a[16:19], v[28:31], v[172:175]
ds_read_b64_tr_b16 a[36:37], v9 offset:51104
ds_read_b64_tr_b16 a[38:39], v9 offset:51616
v_mfma_f32_16x16x32_bf16 v[176:179], a[16:19], v[32:35], v[176:179]
buffer_load_dwordx4 v5, s[28:31], s50 offen offset:1056 lds
v_mfma_f32_16x16x32_bf16 v[180:183], a[16:19], v[36:39], v[180:183]
v_exp_f32 v44, v44
v_mfma_f32_16x16x32_bf16 v[192:195], a[20:23], v[36:39], v[192:195]
ds_read_b64_tr_b16 a[40:41], v9 offset:51136
ds_read_b64_tr_b16 a[42:43], v9 offset:51648
v_add_f32 v11, v11, v44
v_mfma_f32_16x16x32_bf16 v[188:191], a[20:23], v[32:35], v[188:191]
buffer_load_dwordx4 v6, s[28:31], s50 offen offset:2112 lds
v_mfma_f32_16x16x32_bf16 v[184:187], a[20:23], v[28:31], v[184:187]
s_waitcnt lgkmcnt(6)
v_exp_f32 v45, v45
v_mfma_f32_16x16x32_bf16 v[196:199], a[24:27], v[28:31], v[196:199]
ds_read_b64_tr_b16 a[44:45], v9 offset:51168
ds_read_b64_tr_b16 a[46:47], v9 offset:51680
v_mfma_f32_16x16x32_bf16 v[200:203], a[24:27], v[32:35], v[200:203]
v_exp_f32 v46, v46
v_add_f32 v11, v11, v45
v_mfma_f32_16x16x32_bf16 v[204:207], a[24:27], v[36:39], v[204:207]
v_exp_f32 v47, v47
v_mfma_f32_16x16x32_bf16 v[216:219], a[28:31], v[36:39], v[216:219]
ds_read_b64_tr_b16 a[16:17], v9 offset:0
ds_read_b64_tr_b16 a[18:19], v9 offset:512
v_mfma_f32_16x16x32_bf16 v[212:215], a[28:31], v[32:35], v[212:215]
v_exp_f32 v48, v48
v_add_f32 v11, v11, v46
v_mfma_f32_16x16x32_bf16 v[208:211], a[28:31], v[28:31], v[208:211]
s_waitcnt lgkmcnt(6)
v_exp_f32 v49, v49
v_mfma_f32_16x16x32_bf16 v[220:223], a[32:35], v[28:31], v[220:223]
ds_read_b64_tr_b16 a[20:21], v9 offset:32
ds_read_b64_tr_b16 a[22:23], v9 offset:544
v_add_f32 v11, v11, v47
v_mfma_f32_16x16x32_bf16 v[224:227], a[32:35], v[32:35], v[224:227]
v_exp_f32 v50, v50
v_add_f32 v12, v12, v48
v_mfma_f32_16x16x32_bf16 v[228:231], a[32:35], v[36:39], v[228:231]
v_exp_f32 v51, v51
v_add_f32 v12, v12, v49
v_mfma_f32_16x16x32_bf16 v[240:243], a[36:39], v[36:39], v[240:243]
ds_read_b64_tr_b16 a[24:25], v9 offset:64
ds_read_b64_tr_b16 a[26:27], v9 offset:576
v_add_f32 v12, v12, v50
v_mfma_f32_16x16x32_bf16 v[236:239], a[36:39], v[32:35], v[236:239]
buffer_load_dwordx4 v7, s[28:31], s50 offen offset:3168 lds
v_add_f32 v12, v12, v51
v_mfma_f32_16x16x32_bf16 v[232:235], a[36:39], v[28:31], v[232:235]
s_waitcnt lgkmcnt(6)
v_mfma_f32_16x16x32_bf16 v[244:247], a[40:43], v[28:31], v[244:247]
ds_read_b64_tr_b16 a[28:29], v9 offset:96
ds_read_b64_tr_b16 a[30:31], v9 offset:608
v_mfma_f32_16x16x32_bf16 v[248:251], a[40:43], v[32:35], v[248:251]
v_mfma_f32_16x16x32_bf16 a[0:3], a[40:43], v[36:39], a[0:3]
v_mfma_f32_16x16x32_bf16 a[12:15], a[44:47], v[36:39], a[12:15]
ds_read_b64_tr_b16 a[32:33], v9 offset:128
ds_read_b64_tr_b16 a[34:35], v9 offset:640
v_mfma_f32_16x16x32_bf16 a[8:11], a[44:47], v[32:35], a[8:11]
v_mfma_f32_16x16x32_bf16 a[4:7], a[44:47], v[28:31], a[4:7]
s_waitcnt lgkmcnt(6)
LS_45:
v_exp_f32 v64, v64
v_exp_f32 v65, v65
v_exp_f32 v66, v66
v_exp_f32 v67, v67
v_exp_f32 v68, v68
v_exp_f32 v69, v69
v_exp_f32 v70, v70
v_exp_f32 v71, v71
v_exp_f32 v72, v72
v_exp_f32 v73, v73
v_exp_f32 v74, v74
v_exp_f32 v75, v75
v_cvt_pk_bf16_f32 v30, v40, v41
v_cvt_pk_bf16_f32 v31, v42, v43
v_cvt_pk_bf16_f32 v34, v44, v45
v_cvt_pk_bf16_f32 v35, v46, v47
v_cvt_pk_bf16_f32 v38, v48, v49
v_cvt_pk_bf16_f32 v39, v50, v51
v_add_f32 v10, v10, v64
v_add_f32 v10, v10, v65
v_cvt_pk_bf16_f32 v28, v64, v65
v_add_f32 v10, v10, v66
v_add_f32 v10, v10, v67
v_cvt_pk_bf16_f32 v29, v66, v67
v_add_f32 v11, v11, v68
v_add_f32 v11, v11, v69
v_cvt_pk_bf16_f32 v32, v68, v69
v_add_f32 v11, v11, v70
v_add_f32 v11, v11, v71
v_cvt_pk_bf16_f32 v33, v70, v71
v_add_f32 v12, v12, v72
v_add_f32 v12, v12, v73
v_cvt_pk_bf16_f32 v36, v72, v73
v_add_f32 v12, v12, v74
v_add_f32 v12, v12, v75
v_cvt_pk_bf16_f32 v37, v74, v75
v_mfma_f32_16x16x32_bf16 v[76:79], a[16:19], v[28:31], v[76:79]
ds_read_b64_tr_b16 a[36:37], v9 offset:160
s_add_u32 m0, s54, 0
s_add_u32 s50, s84, 0
v_mov_b32 v40, v10
v_mfma_f32_16x16x32_bf16 v[80:83], a[16:19], v[32:35], v[80:83]
ds_read_b64_tr_b16 a[38:39], v9 offset:672
v_mov_b32 v41, v11
v_mov_b32 v42, v12
buffer_load_dwordx4 v14, s[36:39], s50 offen lds
v_mfma_f32_16x16x32_bf16 v[84:87], a[16:19], v[36:39], v[84:87]
v_permlane32_swap_b32 v10, v40
buffer_load_dwordx4 v253, s[36:39], s50 offen offset:1024 lds
v_mfma_f32_16x16x32_bf16 v[96:99], a[20:23], v[36:39], v[96:99]
ds_read_b64_tr_b16 a[40:41], v9 offset:192
v_permlane32_swap_b32 v11, v41
v_permlane32_swap_b32 v12, v42
v_add_f32 v10, v10, v40
v_mfma_f32_16x16x32_bf16 v[92:95], a[20:23], v[32:35], v[92:95]
ds_read_b64_tr_b16 a[42:43], v9 offset:704
v_add_f32 v11, v11, v41
v_add_f32 v12, v12, v42
v_mov_b32 v40, v10
v_mfma_f32_16x16x32_bf16 v[88:91], a[20:23], v[28:31], v[88:91]
s_waitcnt lgkmcnt(6)
v_mov_b32 v41, v11
v_mov_b32 v42, v12
v_mfma_f32_16x16x32_bf16 v[100:103], a[24:27], v[28:31], v[100:103]
ds_read_b64_tr_b16 a[44:45], v9 offset:224
s_add_u32 m0, s54, 2048
s_add_u32 s50, s84, 14336
v_permlane16_swap_b32 v10, v40
v_mfma_f32_16x16x32_bf16 v[104:107], a[24:27], v[32:35], v[104:107]
ds_read_b64_tr_b16 a[46:47], v9 offset:736
v_permlane16_swap_b32 v11, v41
v_permlane16_swap_b32 v12, v42
v_add_f32 v10, v10, v40
buffer_load_dwordx4 v14, s[36:39], s50 offen lds
v_mfma_f32_16x16x32_bf16 v[108:111], a[24:27], v[36:39], v[108:111]
v_add_f32 v11, v11, v41
v_add_f32 v12, v12, v42
v_rcp_f32 v10, v10
buffer_load_dwordx4 v253, s[36:39], s50 offen offset:1024 lds
v_mfma_f32_16x16x32_bf16 v[120:123], a[28:31], v[36:39], v[120:123]
ds_read_b64_tr_b16 a[16:17], v9 offset:256
v_rcp_f32 v11, v11
v_rcp_f32 v12, v12
v_mfma_f32_16x16x32_bf16 v[116:119], a[28:31], v[32:35], v[116:119]
ds_read_b64_tr_b16 a[18:19], v9 offset:768
s_add_u32 m0, s54, 4096
s_add_u32 s50, s84, 28672
v_mul_f32 v76, v10, v76
v_mul_f32 v77, v10, v77
v_mfma_f32_16x16x32_bf16 v[112:115], a[28:31], v[28:31], v[112:115]
s_waitcnt lgkmcnt(6)
buffer_load_dwordx4 v14, s[36:39], s50 offen lds
v_mul_f32 v78, v10, v78
v_mul_f32 v79, v10, v79
v_mul_f32 v80, v11, v80
v_mfma_f32_16x16x32_bf16 v[124:127], a[32:35], v[28:31], v[124:127]
ds_read_b64_tr_b16 a[20:21], v9 offset:288
ds_read_b64_tr_b16 a[22:23], v9 offset:800
buffer_load_dwordx4 v253, s[36:39], s50 offen offset:1024 lds
v_mul_f32 v81, v11, v81
v_mul_f32 v82, v11, v82
v_mfma_f32_16x16x32_bf16 v[128:131], a[32:35], v[32:35], v[128:131]
v_mul_f32 v83, v11, v83
v_cvt_pk_bf16_f32 v52, v76, v77
v_cvt_pk_bf16_f32 v53, v78, v79
v_mul_f32 v84, v12, v84
v_mul_f32 v85, v12, v85
v_mul_f32 v86, v12, v86
v_mfma_f32_16x16x32_bf16 v[132:135], a[32:35], v[36:39], v[132:135]
v_mul_f32 v87, v12, v87
v_cvt_pk_bf16_f32 v56, v80, v81
v_cvt_pk_bf16_f32 v57, v82, v83
v_mul_f32 v96, v12, v96
v_mul_f32 v97, v12, v97
v_mul_f32 v98, v12, v98
v_mfma_f32_16x16x32_bf16 v[144:147], a[36:39], v[36:39], v[144:147]
ds_read_b64_tr_b16 a[24:25], v9 offset:320
ds_read_b64_tr_b16 a[26:27], v9 offset:832
v_mul_f32 v99, v12, v99
v_cvt_pk_bf16_f32 v60, v84, v85
v_cvt_pk_bf16_f32 v61, v86, v87
v_mul_f32 v92, v11, v92
v_mfma_f32_16x16x32_bf16 v[140:143], a[36:39], v[32:35], v[140:143]
v_mul_f32 v93, v11, v93
v_mul_f32 v94, v11, v94
v_mul_f32 v95, v11, v95
v_cvt_pk_bf16_f32 v62, v96, v97
v_cvt_pk_bf16_f32 v63, v98, v99
v_mul_f32 v88, v10, v88
v_mfma_f32_16x16x32_bf16 v[136:139], a[36:39], v[28:31], v[136:139]
s_waitcnt lgkmcnt(6)
v_mul_f32 v89, v10, v89
v_mul_f32 v90, v10, v90
v_mul_f32 v91, v10, v91
v_cvt_pk_bf16_f32 v58, v92, v93
v_cvt_pk_bf16_f32 v59, v94, v95
v_mfma_f32_16x16x32_bf16 v[148:151], a[40:43], v[28:31], v[148:151]
ds_read_b64_tr_b16 a[28:29], v9 offset:352
ds_read_b64_tr_b16 a[30:31], v9 offset:864
v_mul_f32 v100, v10, v100
v_mul_f32 v101, v10, v101
v_mul_f32 v102, v10, v102
v_mul_f32 v103, v10, v103
v_mfma_f32_16x16x32_bf16 v[152:155], a[40:43], v[32:35], v[152:155]
v_cvt_pk_bf16_f32 v54, v88, v89
v_cvt_pk_bf16_f32 v55, v90, v91
v_cvt_pk_bf16_f32 v64, v100, v101
v_cvt_pk_bf16_f32 v65, v102, v103
v_mul_f32 v104, v11, v104
v_mul_f32 v105, v11, v105
v_mfma_f32_16x16x32_bf16 v[156:159], a[40:43], v[36:39], v[156:159]
s_waitcnt vmcnt(34)
s_barrier
v_mul_f32 v106, v11, v106
v_mul_f32 v107, v11, v107
v_accvgpr_write_b32 a144, v52
v_accvgpr_write_b32 a145, v53
v_mfma_f32_16x16x32_bf16 v[168:171], a[44:47], v[36:39], v[168:171]
ds_read_b64_tr_b16 a[32:33], v9 offset:384
ds_read_b64_tr_b16 a[34:35], v9 offset:896
s_add_u32 m0, s17, 118272
s_add_u32 s50, s100, 262656
v_accvgpr_write_b32 a146, v54
v_accvgpr_write_b32 a147, v55
v_mfma_f32_16x16x32_bf16 v[164:167], a[44:47], v[32:35], v[164:167]
buffer_load_dwordx4 v4, s[28:31], s50 offen offset:0 lds
v_cvt_pk_bf16_f32 v68, v104, v105
v_cvt_pk_bf16_f32 v69, v106, v107
v_mul_f32 v108, v12, v108
v_mul_f32 v109, v12, v109
v_mfma_f32_16x16x32_bf16 v[160:163], a[44:47], v[28:31], v[160:163]
s_waitcnt lgkmcnt(6)
buffer_load_dwordx4 v5, s[28:31], s50 offen offset:1056 lds
v_mul_f32 v110, v12, v110
v_mul_f32 v111, v12, v111
v_mul_f32 v120, v12, v120
v_mfma_f32_16x16x32_bf16 v[172:175], a[16:19], v[28:31], v[172:175]
ds_read_b64_tr_b16 a[36:37], v9 offset:416
ds_read_b64_tr_b16 a[38:39], v9 offset:928
buffer_load_dwordx4 v6, s[28:31], s50 offen offset:2112 lds
v_mul_f32 v121, v12, v121
v_mul_f32 v122, v12, v122
v_mfma_f32_16x16x32_bf16 v[176:179], a[16:19], v[32:35], v[176:179]
buffer_load_dwordx4 v7, s[28:31], s50 offen offset:3168 lds
v_mul_f32 v123, v12, v123
v_cvt_pk_bf16_f32 v52, v108, v109
v_cvt_pk_bf16_f32 v53, v110, v111
v_mul_f32 v116, v11, v116
v_mfma_f32_16x16x32_bf16 v[180:183], a[16:19], v[36:39], v[180:183]
v_mul_f32 v117, v11, v117
v_mul_f32 v118, v11, v118
v_mul_f32 v119, v11, v119
v_cvt_pk_bf16_f32 v54, v120, v121
v_cvt_pk_bf16_f32 v55, v122, v123
v_mul_f32 v112, v10, v112
v_mfma_f32_16x16x32_bf16 v[192:195], a[20:23], v[36:39], v[192:195]
ds_read_b64_tr_b16 a[40:41], v9 offset:448
ds_read_b64_tr_b16 a[42:43], v9 offset:960
v_mul_f32 v113, v10, v113
v_mul_f32 v114, v10, v114
v_mul_f32 v115, v10, v115
v_cvt_pk_bf16_f32 v70, v116, v117
v_mfma_f32_16x16x32_bf16 v[188:191], a[20:23], v[32:35], v[188:191]
v_cvt_pk_bf16_f32 v71, v118, v119
v_accvgpr_write_b32 a148, v56
v_accvgpr_write_b32 a149, v57
v_accvgpr_write_b32 a150, v58
v_accvgpr_write_b32 a151, v59
v_cvt_pk_bf16_f32 v66, v112, v113
v_mfma_f32_16x16x32_bf16 v[184:187], a[20:23], v[28:31], v[184:187]
s_waitcnt lgkmcnt(6)
v_cvt_pk_bf16_f32 v67, v114, v115
v_mul_f32 v124, v10, v124
v_mul_f32 v125, v10, v125
v_mul_f32 v126, v10, v126
v_mul_f32 v127, v10, v127
v_mfma_f32_16x16x32_bf16 v[196:199], a[24:27], v[28:31], v[196:199]
ds_read_b64_tr_b16 a[44:45], v9 offset:480
ds_read_b64_tr_b16 a[46:47], v9 offset:992
s_waitcnt vmcnt(24)
v_accvgpr_write_b32 a152, v60
v_accvgpr_write_b32 a153, v61
v_accvgpr_write_b32 a154, v62
v_mfma_f32_16x16x32_bf16 v[200:203], a[24:27], v[32:35], v[200:203]
v_add_u32 v48, s52, v254
v_accvgpr_write_b32 a155, v63
v_cvt_pk_bf16_f32 v56, v124, v125
v_cvt_pk_bf16_f32 v57, v126, v127
v_mul_f32 v128, v11, v128
v_mul_f32 v129, v11, v129
v_mfma_f32_16x16x32_bf16 v[204:207], a[24:27], v[36:39], v[204:207]
v_xor_b32 v49, 64, v48
v_mul_f32 v130, v11, v130
v_mul_f32 v131, v11, v131
v_accvgpr_write_b32 a156, v64
v_accvgpr_write_b32 a157, v65
v_accvgpr_write_b32 a158, v66
v_mfma_f32_16x16x32_bf16 v[216:219], a[28:31], v[36:39], v[216:219]
ds_read_b64_tr_b16 a[16:17], v15 offset:50688
ds_read_b64_tr_b16 a[18:19], v15 offset:51200
ds_read_b128 a[120:123], v48 offset:0
v_accvgpr_write_b32 a159, v67
v_cvt_pk_bf16_f32 v60, v128, v129
v_cvt_pk_bf16_f32 v61, v130, v131
v_mfma_f32_16x16x32_bf16 v[212:215], a[28:31], v[32:35], v[212:215]
ds_read_b128 a[124:127], v48 offset:2048
v_mul_f32 v132, v12, v132
v_mul_f32 v133, v12, v133
v_mul_f32 v134, v12, v134
v_mul_f32 v135, v12, v135
v_mul_f32 v144, v12, v144
v_mfma_f32_16x16x32_bf16 v[208:211], a[28:31], v[28:31], v[208:211]
s_waitcnt lgkmcnt(8)
ds_read_b128 a[128:131], v48 offset:4096
v_mul_f32 v145, v12, v145
v_mul_f32 v146, v12, v146
v_mul_f32 v147, v12, v147
v_cvt_pk_bf16_f32 v64, v132, v133
v_mfma_f32_16x16x32_bf16 v[220:223], a[32:35], v[28:31], v[220:223]
ds_read_b64_tr_b16 a[20:21], v15 offset:50696
ds_read_b64_tr_b16 a[22:23], v15 offset:51208
ds_read_b128 a[132:135], v49 offset:0
v_cvt_pk_bf16_f32 v65, v134, v135
v_mul_f32 v140, v11, v140
v_mul_f32 v141, v11, v141
v_mfma_f32_16x16x32_bf16 v[224:227], a[32:35], v[32:35], v[224:227]
ds_read_b128 a[136:139], v49 offset:2048
v_mul_f32 v142, v11, v142
v_mul_f32 v143, v11, v143
v_cvt_pk_bf16_f32 v66, v144, v145
v_cvt_pk_bf16_f32 v67, v146, v147
v_mul_f32 v136, v10, v136
v_mfma_f32_16x16x32_bf16 v[228:231], a[32:35], v[36:39], v[228:231]
ds_read_b128 a[140:143], v49 offset:4096
v_mul_f32 v137, v10, v137
v_mul_f32 v138, v10, v138
v_mul_f32 v139, v10, v139
v_cvt_pk_bf16_f32 v62, v140, v141
v_cvt_pk_bf16_f32 v63, v142, v143
v_mfma_f32_16x16x32_bf16 v[240:243], a[36:39], v[36:39], v[240:243]
ds_read_b64_tr_b16 a[24:25], v15 offset:50752
ds_read_b64_tr_b16 a[26:27], v15 offset:51264
v_accvgpr_write_b32 a160, v68
v_accvgpr_write_b32 a161, v69
v_accvgpr_write_b32 a162, v70
v_accvgpr_write_b32 a163, v71
v_mfma_f32_16x16x32_bf16 v[236:239], a[36:39], v[32:35], v[236:239]
v_cvt_pk_bf16_f32 v58, v136, v137
v_cvt_pk_bf16_f32 v59, v138, v139
v_mul_f32 v148, v10, v148
v_mul_f32 v149, v10, v149
v_mul_f32 v150, v10, v150
v_mul_f32 v151, v10, v151
v_mfma_f32_16x16x32_bf16 v[232:235], a[36:39], v[28:31], v[232:235]
s_waitcnt lgkmcnt(12)
v_accvgpr_write_b32 a164, v52
v_accvgpr_write_b32 a165, v53
v_accvgpr_write_b32 a166, v54
v_accvgpr_write_b32 a167, v55
v_cvt_pk_bf16_f32 v68, v148, v149
v_mfma_f32_16x16x32_bf16 v[244:247], a[40:43], v[28:31], v[244:247]
ds_read_b64_tr_b16 a[28:29], v15 offset:50760
ds_read_b64_tr_b16 a[30:31], v15 offset:51272
s_waitcnt lgkmcnt(4)
v_cvt_pk_bf16_f32 v69, v150, v151
v_mul_f32 v152, v11, v152
v_mul_f32 v153, v11, v153
v_mul_f32 v154, v11, v154
v_mfma_f32_16x16x32_bf16 v[248:251], a[40:43], v[32:35], v[248:251]
v_mul_f32 v155, v11, v155
v_accvgpr_write_b32 a168, v56
v_accvgpr_write_b32 a169, v57
v_accvgpr_write_b32 a170, v58
v_accvgpr_write_b32 a171, v59
v_cvt_pk_bf16_f32 v52, v152, v153
v_mfma_f32_16x16x32_bf16 a[0:3], a[40:43], v[36:39], a[0:3]
v_cvt_pk_bf16_f32 v53, v154, v155
v_mul_f32 v156, v12, v156
v_mul_f32 v157, v12, v157
v_mul_f32 v158, v12, v158
v_mul_f32 v159, v12, v159
v_mul_f32 v168, v12, v168
v_mfma_f32_16x16x32_bf16 a[12:15], a[44:47], v[36:39], a[12:15]
ds_read_b64_tr_b16 a[32:33], v15 offset:50816
ds_read_b64_tr_b16 a[34:35], v15 offset:51328
v_mul_f32 v169, v12, v169
v_mul_f32 v170, v12, v170
v_mul_f32 v171, v12, v171
v_cvt_pk_bf16_f32 v56, v156, v157
v_cvt_pk_bf16_f32 v57, v158, v159
v_mfma_f32_16x16x32_bf16 a[8:11], a[44:47], v[32:35], a[8:11]
v_mul_f32 v164, v11, v164
v_mul_f32 v165, v11, v165
v_mul_f32 v166, v11, v166
v_mul_f32 v167, v11, v167
v_cvt_pk_bf16_f32 v58, v168, v169
v_cvt_pk_bf16_f32 v59, v170, v171
v_mfma_f32_16x16x32_bf16 a[4:7], a[44:47], v[28:31], a[4:7]
s_waitcnt lgkmcnt(9)
v_mul_f32 v160, v10, v160
v_mul_f32 v161, v10, v161
v_mul_f32 v162, v10, v162
v_mul_f32 v163, v10, v163
v_cvt_pk_bf16_f32 v54, v164, v165
LS_46:
v_mfma_f32_16x16x32_bf16 v[76:79], a[16:19], a[120:123], 0
ds_read_b64_tr_b16 a[36:37], v15 offset:50824
s_add_u32 m0, s52, 0
s_add_u32 s50, s85, 0
v_cvt_pk_bf16_f32 v55, v166, v167
v_accvgpr_write_b32 a172, v60
v_accvgpr_write_b32 a173, v61
v_accvgpr_write_b32 a174, v62
v_mfma_f32_16x16x32_bf16 v[80:83], a[16:19], a[124:127], 0
ds_read_b64_tr_b16 a[38:39], v15 offset:51336
v_accvgpr_write_b32 a175, v63
v_cvt_pk_bf16_f32 v70, v160, v161
v_cvt_pk_bf16_f32 v71, v162, v163
v_mul_f32 v172, v10, v172
v_mul_f32 v173, v10, v173
v_mfma_f32_16x16x32_bf16 v[84:87], a[16:19], a[128:131], 0
v_mul_f32 v174, v10, v174
v_mul_f32 v175, v10, v175
v_accvgpr_write_b32 a176, v64
v_accvgpr_write_b32 a177, v65
v_accvgpr_write_b32 a178, v66
v_accvgpr_write_b32 a179, v67
v_mfma_f32_16x16x32_bf16 v[96:99], a[20:23], a[128:131], 0
ds_read_b64_tr_b16 a[40:41], v15 offset:50880
v_cvt_pk_bf16_f32 v60, v172, v173
v_cvt_pk_bf16_f32 v61, v174, v175
v_mul_f32 v176, v11, v176
v_mul_f32 v177, v11, v177
v_mul_f32 v178, v11, v178
v_mul_f32 v179, v11, v179
v_mfma_f32_16x16x32_bf16 v[92:95], a[20:23], a[124:127], 0
ds_read_b64_tr_b16 a[42:43], v15 offset:51392
v_accvgpr_write_b32 a180, v68
v_accvgpr_write_b32 a181, v69
v_accvgpr_write_b32 a182, v70
v_accvgpr_write_b32 a183, v71
v_cvt_pk_bf16_f32 v64, v176, v177
v_mfma_f32_16x16x32_bf16 v[88:91], a[20:23], a[120:123], 0
s_waitcnt lgkmcnt(6)
v_cvt_pk_bf16_f32 v65, v178, v179
v_mul_f32 v180, v12, v180
v_mul_f32 v181, v12, v181
v_mul_f32 v182, v12, v182
v_mul_f32 v183, v12, v183
v_mfma_f32_16x16x32_bf16 v[100:103], a[24:27], a[120:123], 0
ds_read_b64_tr_b16 a[44:45], v15 offset:50888
v_mul_f32 v192, v12, v192
v_mul_f32 v193, v12, v193
v_mul_f32 v194, v12, v194
v_mul_f32 v195, v12, v195
v_cvt_pk_bf16_f32 v68, v180, v181
v_cvt_pk_bf16_f32 v69, v182, v183
v_mfma_f32_16x16x32_bf16 v[104:107], a[24:27], a[124:127], 0
ds_read_b64_tr_b16 a[46:47], v15 offset:51400
v_mul_f32 v184, v10, v184
v_mul_f32 v185, v10, v185
v_mul_f32 v186, v10, v186
v_mul_f32 v187, v10, v187
v_mul_f32 v188, v11, v188
v_mfma_f32_16x16x32_bf16 v[108:111], a[24:27], a[128:131], 0
v_mul_f32 v189, v11, v189
v_mul_f32 v190, v11, v190
v_mul_f32 v191, v11, v191
v_cvt_pk_bf16_f32 v70, v192, v193
v_cvt_pk_bf16_f32 v71, v194, v195
v_cvt_pk_bf16_f32 v62, v184, v185
v_mfma_f32_16x16x32_bf16 v[120:123], a[28:31], a[128:131], 0
ds_read_b64_tr_b16 a[16:17], v15 offset:50944
v_cvt_pk_bf16_f32 v63, v186, v187
buffer_load_dwordx4 v14, s[36:39], s50 offen lds
v_accvgpr_write_b32 a192, v60
v_accvgpr_write_b32 a193, v61
v_cvt_pk_bf16_f32 v66, v188, v189
v_cvt_pk_bf16_f32 v67, v190, v191
v_mfma_f32_16x16x32_bf16 v[116:119], a[28:31], a[124:127], 0
ds_read_b64_tr_b16 a[18:19], v15 offset:51456
v_accvgpr_write_b32 a194, v62
v_accvgpr_write_b32 a195, v63
v_mul_f32 v204, v12, v204
v_mul_f32 v205, v12, v205
v_mul_f32 v206, v12, v206
v_mfma_f32_16x16x32_bf16 v[112:115], a[28:31], a[120:123], 0
s_waitcnt lgkmcnt(6)
v_mul_f32 v207, v12, v207
v_accvgpr_write_b32 a184, v52
v_accvgpr_write_b32 a185, v53
v_accvgpr_write_b32 a186, v54
v_accvgpr_write_b32 a187, v55
v_mfma_f32_16x16x32_bf16 v[124:127], a[32:35], a[120:123], 0
ds_read_b64_tr_b16 a[20:21], v15 offset:50952
v_accvgpr_write_b32 a196, v64
v_accvgpr_write_b32 a197, v65
v_accvgpr_write_b32 a198, v66
v_accvgpr_write_b32 a199, v67
v_mul_f32 v196, v10, v196
v_mul_f32 v197, v10, v197
v_mfma_f32_16x16x32_bf16 v[128:131], a[32:35], a[124:127], 0
ds_read_b64_tr_b16 a[22:23], v15 offset:51464
v_mul_f32 v198, v10, v198
v_mul_f32 v199, v10, v199
v_mul_f32 v216, v12, v216
v_mul_f32 v217, v12, v217
v_mul_f32 v218, v12, v218
v_mfma_f32_16x16x32_bf16 v[132:135], a[32:35], a[128:131], 0
v_mul_f32 v219, v12, v219
v_cvt_pk_bf16_f32 v60, v204, v205
v_cvt_pk_bf16_f32 v61, v206, v207
v_mul_f32 v220, v10, v220
v_mul_f32 v221, v10, v221
v_mul_f32 v222, v10, v222
v_mfma_f32_16x16x32_bf16 v[144:147], a[36:39], a[128:131], 0
ds_read_b64_tr_b16 a[24:25], v15 offset:51008
v_mul_f32 v223, v10, v223
v_mul_f32 v232, v10, v232
v_mul_f32 v233, v10, v233
v_mul_f32 v234, v10, v234
v_mul_f32 v235, v10, v235
buffer_load_dwordx4 v253, s[36:39], s50 offen offset:1024 lds
v_mfma_f32_16x16x32_bf16 v[140:143], a[36:39], a[124:127], 0
ds_read_b64_tr_b16 a[26:27], v15 offset:51520
s_add_u32 m0, s52, 2048
s_add_u32 s50, s85, 14336
v_accvgpr_write_b32 a188, v56
v_accvgpr_write_b32 a189, v57
v_accvgpr_write_b32 a190, v58
v_mfma_f32_16x16x32_bf16 v[136:139], a[36:39], a[120:123], 0
s_waitcnt lgkmcnt(6)
v_accvgpr_write_b32 a191, v59
v_cvt_pk_bf16_f32 v52, v196, v197
v_cvt_pk_bf16_f32 v53, v198, v199
v_mul_f32 v200, v11, v200
v_mul_f32 v201, v11, v201
v_mfma_f32_16x16x32_bf16 v[148:151], a[40:43], a[120:123], 0
ds_read_b64_tr_b16 a[28:29], v15 offset:51016
v_mul_f32 v202, v11, v202
v_mul_f32 v203, v11, v203
v_mul_f32 v212, v11, v212
v_mul_f32 v213, v11, v213
v_mul_f32 v214, v11, v214
v_mul_f32 v215, v11, v215
v_mfma_f32_16x16x32_bf16 v[152:155], a[40:43], a[124:127], 0
ds_read_b64_tr_b16 a[30:31], v15 offset:51528
v_cvt_pk_bf16_f32 v62, v216, v217
v_cvt_pk_bf16_f32 v63, v218, v219
v_cvt_pk_bf16_f32 v64, v220, v221
v_cvt_pk_bf16_f32 v65, v222, v223
v_cvt_pk_bf16_f32 v66, v232, v233
v_mfma_f32_16x16x32_bf16 v[156:159], a[40:43], a[128:131], 0
s_waitcnt vmcnt(22)
s_barrier
v_cvt_pk_bf16_f32 v67, v234, v235
v_accvgpr_read_b32 v204, a0
v_accvgpr_read_b32 v205, a1
v_accvgpr_read_b32 v206, a2
v_mfma_f32_16x16x32_bf16 v[168:171], a[44:47], a[128:131], 0
ds_read_b64_tr_b16 a[32:33], v15 offset:51072
v_accvgpr_read_b32 v207, a3
v_cvt_pk_bf16_f32 v56, v200, v201
v_cvt_pk_bf16_f32 v57, v202, v203
v_mul_f32 v208, v10, v208
v_mul_f32 v209, v10, v209
v_mul_f32 v210, v10, v210
v_mfma_f32_16x16x32_bf16 v[164:167], a[44:47], a[124:127], 0
ds_read_b64_tr_b16 a[34:35], v15 offset:51584
v_mul_f32 v211, v10, v211
v_cvt_pk_bf16_f32 v58, v212, v213
v_cvt_pk_bf16_f32 v59, v214, v215
v_accvgpr_write_b32 a216, v64
v_accvgpr_write_b32 a217, v65
v_mfma_f32_16x16x32_bf16 v[160:163], a[44:47], a[120:123], 0
s_waitcnt lgkmcnt(6)
v_accvgpr_write_b32 a218, v66
v_accvgpr_write_b32 a219, v67
v_mul_f32 v204, v12, v204
v_mul_f32 v205, v12, v205
v_mul_f32 v206, v12, v206
v_mfma_f32_16x16x32_bf16 v[172:175], a[16:19], a[120:123], 0
ds_read_b64_tr_b16 a[36:37], v15 offset:51080
v_mul_f32 v207, v12, v207
v_accvgpr_read_b32 v216, a12
v_accvgpr_read_b32 v217, a13
v_accvgpr_read_b32 v218, a14
v_accvgpr_read_b32 v219, a15
buffer_load_dwordx4 v14, s[36:39], s50 offen lds
v_mfma_f32_16x16x32_bf16 v[176:179], a[16:19], a[124:127], 0
ds_read_b64_tr_b16 a[38:39], v15 offset:51592
v_cvt_pk_bf16_f32 v54, v208, v209
v_cvt_pk_bf16_f32 v55, v210, v211
v_accvgpr_read_b32 v212, a8
v_accvgpr_read_b32 v213, a9
v_accvgpr_read_b32 v214, a10
v_mfma_f32_16x16x32_bf16 v[180:183], a[16:19], a[128:131], 0
v_accvgpr_read_b32 v215, a11
v_mul_f32 v216, v12, v216
v_mul_f32 v217, v12, v217
v_mul_f32 v218, v12, v218
v_mul_f32 v219, v12, v219
v_cvt_pk_bf16_f32 v64, v204, v205
v_mfma_f32_16x16x32_bf16 v[192:195], a[20:23], a[128:131], 0
ds_read_b64_tr_b16 a[40:41], v15 offset:51136
v_cvt_pk_bf16_f32 v65, v206, v207
v_accvgpr_write_b32 a212, v60
v_accvgpr_write_b32 a213, v61
v_accvgpr_write_b32 a214, v62
v_accvgpr_write_b32 a215, v63
v_accvgpr_read_b32 v208, a4
v_mfma_f32_16x16x32_bf16 v[188:191], a[20:23], a[124:127], 0
ds_read_b64_tr_b16 a[42:43], v15 offset:51648
v_accvgpr_read_b32 v209, a5
v_accvgpr_read_b32 v210, a6
v_accvgpr_read_b32 v211, a7
v_mul_f32 v212, v11, v212
v_mul_f32 v213, v11, v213
v_mfma_f32_16x16x32_bf16 v[184:187], a[20:23], a[120:123], 0
s_waitcnt lgkmcnt(6)
v_mul_f32 v214, v11, v214
v_mul_f32 v215, v11, v215
v_cvt_pk_bf16_f32 v66, v216, v217
v_cvt_pk_bf16_f32 v67, v218, v219
buffer_load_dwordx4 v253, s[36:39], s50 offen offset:1024 lds
v_mfma_f32_16x16x32_bf16 v[196:199], a[24:27], a[120:123], 0
ds_read_b64_tr_b16 a[44:45], v15 offset:51144
s_add_u32 m0, s52, 4096
s_add_u32 s50, s85, 28672
v_accvgpr_write_b32 a208, v56
v_accvgpr_write_b32 a209, v57
v_accvgpr_write_b32 a210, v58
v_accvgpr_write_b32 a211, v59
v_mfma_f32_16x16x32_bf16 v[200:203], a[24:27], a[124:127], 0
ds_read_b64_tr_b16 a[46:47], v15 offset:51656
v_mul_f32 v208, v10, v208
v_mul_f32 v209, v10, v209
v_mul_f32 v210, v10, v210
v_mul_f32 v211, v10, v211
v_cvt_pk_bf16_f32 v62, v212, v213
v_mfma_f32_16x16x32_bf16 v[204:207], a[24:27], a[128:131], 0
v_cvt_pk_bf16_f32 v63, v214, v215
v_cvt_pk_bf16_f32 v58, v208, v209
v_cvt_pk_bf16_f32 v59, v210, v211
buffer_load_dwordx4 v14, s[36:39], s50 offen lds
v_accvgpr_write_b32 a200, v68
v_accvgpr_write_b32 a201, v69
v_mfma_f32_16x16x32_bf16 v[216:219], a[28:31], a[128:131], 0
ds_read_b64_tr_b16 a[16:17], v15 offset:0
v_accvgpr_write_b32 a202, v70
v_accvgpr_write_b32 a203, v71
v_mul_f32 v224, v11, v224
v_mul_f32 v225, v11, v225
v_mul_f32 v226, v11, v226
v_mul_f32 v227, v11, v227
v_mfma_f32_16x16x32_bf16 v[212:215], a[28:31], a[124:127], 0
ds_read_b64_tr_b16 a[18:19], v15 offset:512
v_accvgpr_write_b32 a204, v52
v_accvgpr_write_b32 a205, v53
v_accvgpr_write_b32 a206, v54
v_accvgpr_write_b32 a207, v55
v_cvt_pk_bf16_f32 v68, v224, v225
v_mfma_f32_16x16x32_bf16 v[208:211], a[28:31], a[120:123], 0
s_waitcnt lgkmcnt(6)
v_cvt_pk_bf16_f32 v69, v226, v227
v_mul_f32 v228, v12, v228
v_mul_f32 v229, v12, v229
v_mul_f32 v230, v12, v230
v_mul_f32 v231, v12, v231
v_mfma_f32_16x16x32_bf16 v[220:223], a[32:35], a[120:123], 0
ds_read_b64_tr_b16 a[20:21], v15 offset:8
buffer_load_dwordx4 v253, s[36:39], s50 offen offset:1024 lds
v_mul_f32 v240, v12, v240
v_mul_f32 v241, v12, v241
v_mul_f32 v242, v12, v242
v_mul_f32 v243, v12, v243
v_cvt_pk_bf16_f32 v52, v228, v229
v_mfma_f32_16x16x32_bf16 v[224:227], a[32:35], a[124:127], 0
ds_read_b64_tr_b16 a[22:23], v15 offset:520
v_cvt_pk_bf16_f32 v53, v230, v231
s_add_u32 m0, s17, 67584
s_add_u32 s50, s101, 512
v_mul_f32 v236, v11, v236
v_mul_f32 v237, v11, v237
v_mfma_f32_16x16x32_bf16 v[228:231], a[32:35], a[128:131], 0
v_mul_f32 v238, v11, v238
v_mul_f32 v239, v11, v239
v_cvt_pk_bf16_f32 v54, v240, v241
v_cvt_pk_bf16_f32 v55, v242, v243
buffer_load_dwordx4 v4, s[28:31], s50 offen offset:0 lds
v_mfma_f32_16x16x32_bf16 v[240:243], a[36:39], a[128:131], 0
ds_read_b64_tr_b16 a[24:25], v15 offset:64
v_cvt_pk_bf16_f32 v70, v236, v237
v_cvt_pk_bf16_f32 v71, v238, v239
v_mul_f32 v244, v10, v244
v_mul_f32 v245, v10, v245
v_mul_f32 v246, v10, v246
v_mfma_f32_16x16x32_bf16 v[236:239], a[36:39], a[124:127], 0
ds_read_b64_tr_b16 a[26:27], v15 offset:576
v_mul_f32 v247, v10, v247
v_cvt_pk_bf16_f32 v56, v244, v245
v_mul_f32 v248, v11, v248
v_mul_f32 v249, v11, v249
v_mul_f32 v250, v11, v250
v_mfma_f32_16x16x32_bf16 v[232:235], a[36:39], a[120:123], 0
s_waitcnt lgkmcnt(6)
v_cvt_pk_bf16_f32 v57, v246, v247
v_mul_f32 v251, v11, v251
buffer_load_dwordx4 v5, s[28:31], s50 offen offset:1056 lds
v_mfma_f32_16x16x32_bf16 v[244:247], a[40:43], a[120:123], 0
ds_read_b64_tr_b16 a[28:29], v15 offset:72
v_cvt_pk_bf16_f32 v60, v248, v249
v_cvt_pk_bf16_f32 v61, v250, v251
v_mfma_f32_16x16x32_bf16 v[248:251], a[40:43], a[124:127], 0
ds_read_b64_tr_b16 a[30:31], v15 offset:584
v_accvgpr_write_b32 a220, v68
v_accvgpr_write_b32 a221, v69
v_mfma_f32_16x16x32_bf16 a[0:3], a[40:43], a[128:131], 0
buffer_load_dwordx4 v6, s[28:31], s50 offen offset:2112 lds
v_mfma_f32_16x16x32_bf16 a[12:15], a[44:47], a[128:131], 0
ds_read_b64_tr_b16 a[32:33], v15 offset:128
v_accvgpr_write_b32 a224, v52
v_accvgpr_write_b32 a225, v53
v_mfma_f32_16x16x32_bf16 a[8:11], a[44:47], a[124:127], 0
ds_read_b64_tr_b16 a[34:35], v15 offset:640
v_accvgpr_write_b32 a226, v54
v_mfma_f32_16x16x32_bf16 a[4:7], a[44:47], a[120:123], 0
s_waitcnt lgkmcnt(6)
buffer_load_dwordx4 v7, s[28:31], s50 offen offset:3168 lds
LS_47:
v_mfma_f32_16x16x32_bf16 v[76:79], a[16:19], a[132:135], v[76:79]
ds_read_b64_tr_b16 a[36:37], v15 offset:136
s_waitcnt vmcnt(24)
v_mfma_f32_16x16x32_bf16 v[80:83], a[16:19], a[136:139], v[80:83]
ds_read_b64_tr_b16 a[38:39], v15 offset:648
v_add_u32 v74, s53, v254
v_mfma_f32_16x16x32_bf16 v[84:87], a[16:19], a[140:143], v[84:87]
v_xor_b32 v75, 64, v74
v_accvgpr_write_b32 a227, v55
v_mfma_f32_16x16x32_bf16 v[96:99], a[20:23], a[140:143], v[96:99]
ds_read_b64_tr_b16 a[40:41], v15 offset:192
ds_read_b128 a[48:51], v74 offset:0
v_accvgpr_write_b32 a222, v70
v_mfma_f32_16x16x32_bf16 v[92:95], a[20:23], a[136:139], v[92:95]
ds_read_b64_tr_b16 a[42:43], v15 offset:704
ds_read_b128 a[52:55], v74 offset:2048
v_mfma_f32_16x16x32_bf16 v[88:91], a[20:23], a[132:135], v[88:91]
s_waitcnt lgkmcnt(8)
ds_read_b128 a[56:59], v74 offset:4096
v_mfma_f32_16x16x32_bf16 v[100:103], a[24:27], a[132:135], v[100:103]
ds_read_b64_tr_b16 a[44:45], v15 offset:200
ds_read_b128 a[60:63], v75 offset:0
v_accvgpr_write_b32 a223, v71
v_mfma_f32_16x16x32_bf16 v[104:107], a[24:27], a[136:139], v[104:107]
ds_read_b64_tr_b16 a[46:47], v15 offset:712
v_accvgpr_write_b32 a228, v56
v_mfma_f32_16x16x32_bf16 v[108:111], a[24:27], a[140:143], v[108:111]
v_accvgpr_write_b32 a229, v57
v_accvgpr_write_b32 a232, v60
v_mfma_f32_16x16x32_bf16 v[120:123], a[28:31], a[140:143], v[120:123]
ds_read_b64_tr_b16 a[16:17], v15 offset:256
v_accvgpr_write_b32 a233, v61
v_accvgpr_write_b32 a236, v64
v_mfma_f32_16x16x32_bf16 v[116:119], a[28:31], a[136:139], v[116:119]
ds_read_b64_tr_b16 a[18:19], v15 offset:768
v_accvgpr_write_b32 a237, v65
v_mfma_f32_16x16x32_bf16 v[112:115], a[28:31], a[132:135], v[112:115]
s_waitcnt lgkmcnt(10)
v_accvgpr_write_b32 a238, v66
v_mfma_f32_16x16x32_bf16 v[124:127], a[32:35], a[132:135], v[124:127]
ds_read_b64_tr_b16 a[20:21], v15 offset:264
v_accvgpr_write_b32 a239, v67
v_accvgpr_write_b32 a234, v62
v_mfma_f32_16x16x32_bf16 v[128:131], a[32:35], a[136:139], v[128:131]
ds_read_b64_tr_b16 a[22:23], v15 offset:776
v_accvgpr_write_b32 a235, v63
v_mfma_f32_16x16x32_bf16 v[132:135], a[32:35], a[140:143], v[132:135]
v_accvgpr_write_b32 a230, v58
v_accvgpr_write_b32 a231, v59
v_mfma_f32_16x16x32_bf16 v[144:147], a[36:39], a[140:143], v[144:147]
ds_read_b64_tr_b16 a[24:25], v15 offset:320
ds_read_b128 a[64:67], v75 offset:2048
v_mfma_f32_16x16x32_bf16 v[140:143], a[36:39], a[136:139], v[140:143]
ds_read_b64_tr_b16 a[26:27], v15 offset:832
ds_read_b128 a[68:71], v75 offset:4096
v_mfma_f32_16x16x32_bf16 v[136:139], a[36:39], a[132:135], v[136:139]
s_waitcnt lgkmcnt(8)
s_waitcnt vmcnt(14)
v_mfma_f32_16x16x32_bf16 v[148:151], a[40:43], a[132:135], v[148:151]
ds_read_b64_tr_b16 a[28:29], v15 offset:328
v_add_u32 v74, s54, v254
v_mfma_f32_16x16x32_bf16 v[152:155], a[40:43], a[136:139], v[152:155]
ds_read_b64_tr_b16 a[30:31], v15 offset:840
v_xor_b32 v75, 64, v74
v_mfma_f32_16x16x32_bf16 v[156:159], a[40:43], a[140:143], v[156:159]
s_waitcnt vmcnt(20)
s_barrier
s_waitcnt lgkmcnt(2)
v_mfma_f32_16x16x32_bf16 v[168:171], a[44:47], a[140:143], v[168:171]
ds_read_b64_tr_b16 a[32:33], v15 offset:384
ds_read_b128 a[72:75], v74 offset:0
v_mfma_f32_16x16x32_bf16 v[164:167], a[44:47], a[136:139], v[164:167]
ds_read_b64_tr_b16 a[34:35], v15 offset:896
s_add_u32 m0, s53, 0
s_add_u32 s50, s96, 0
v_mfma_f32_16x16x32_bf16 v[160:163], a[44:47], a[132:135], v[160:163]
s_waitcnt lgkmcnt(9)
ds_read_b128 a[76:79], v74 offset:2048
buffer_load_dwordx4 v14, s[36:39], s50 offen lds
v_mfma_f32_16x16x32_bf16 v[172:175], a[16:19], a[132:135], v[172:175]
ds_read_b64_tr_b16 a[36:37], v15 offset:392
ds_read_b128 a[80:83], v74 offset:4096
buffer_load_dwordx4 v253, s[36:39], s50 offen offset:1024 lds
v_mfma_f32_16x16x32_bf16 v[176:179], a[16:19], a[136:139], v[176:179]
ds_read_b64_tr_b16 a[38:39], v15 offset:904
ds_read_b128 a[84:87], v75 offset:0
v_mfma_f32_16x16x32_bf16 v[180:183], a[16:19], a[140:143], v[180:183]
s_add_u32 m0, s53, 2048
s_add_u32 s50, s96, 14336
v_mfma_f32_16x16x32_bf16 v[192:195], a[20:23], a[140:143], v[192:195]
ds_read_b64_tr_b16 a[40:41], v15 offset:448
ds_read_b128 a[88:91], v75 offset:2048
buffer_load_dwordx4 v14, s[36:39], s50 offen lds
v_mfma_f32_16x16x32_bf16 v[188:191], a[20:23], a[136:139], v[188:191]
ds_read_b64_tr_b16 a[42:43], v15 offset:960
ds_read_b128 a[92:95], v75 offset:4096
v_mfma_f32_16x16x32_bf16 v[184:187], a[20:23], a[132:135], v[184:187]
s_waitcnt lgkmcnt(12)
buffer_load_dwordx4 v253, s[36:39], s50 offen offset:1024 lds
v_mfma_f32_16x16x32_bf16 v[196:199], a[24:27], a[132:135], v[196:199]
ds_read_b64_tr_b16 a[44:45], v15 offset:456
s_add_u32 m0, s53, 4096
s_add_u32 s50, s96, 28672
v_mfma_f32_16x16x32_bf16 v[200:203], a[24:27], a[136:139], v[200:203]
ds_read_b64_tr_b16 a[46:47], v15 offset:968
buffer_load_dwordx4 v14, s[36:39], s50 offen lds
v_mfma_f32_16x16x32_bf16 v[204:207], a[24:27], a[140:143], v[204:207]
buffer_load_dwordx4 v253, s[36:39], s50 offen offset:1024 lds
s_waitcnt lgkmcnt(2)
v_mfma_f32_16x16x32_bf16 v[216:219], a[28:31], a[140:143], v[216:219]
ds_read_b64_tr_b16 a[16:17], v15 offset:16896
s_add_u32 m0, s54, 0
s_add_u32 s50, s97, 0
v_mfma_f32_16x16x32_bf16 v[212:215], a[28:31], a[136:139], v[212:215]
ds_read_b64_tr_b16 a[18:19], v15 offset:17408
buffer_load_dwordx4 v14, s[36:39], s50 offen lds
v_mfma_f32_16x16x32_bf16 v[208:211], a[28:31], a[132:135], v[208:211]
s_waitcnt lgkmcnt(9)
buffer_load_dwordx4 v253, s[36:39], s50 offen offset:1024 lds
v_mfma_f32_16x16x32_bf16 v[220:223], a[32:35], a[132:135], v[220:223]
ds_read_b64_tr_b16 a[20:21], v15 offset:16904
s_add_u32 m0, s54, 2048
s_add_u32 s50, s97, 14336
v_mfma_f32_16x16x32_bf16 v[224:227], a[32:35], a[136:139], v[224:227]
ds_read_b64_tr_b16 a[22:23], v15 offset:17416
buffer_load_dwordx4 v14, s[36:39], s50 offen lds
v_mfma_f32_16x16x32_bf16 v[228:231], a[32:35], a[140:143], v[228:231]
buffer_load_dwordx4 v253, s[36:39], s50 offen offset:1024 lds
v_mfma_f32_16x16x32_bf16 v[240:243], a[36:39], a[140:143], v[240:243]
ds_read_b64_tr_b16 a[24:25], v15 offset:16960
s_add_u32 m0, s54, 4096
s_add_u32 s50, s97, 28672
v_mfma_f32_16x16x32_bf16 v[236:239], a[36:39], a[136:139], v[236:239]
ds_read_b64_tr_b16 a[26:27], v15 offset:17472
buffer_load_dwordx4 v14, s[36:39], s50 offen lds
v_mfma_f32_16x16x32_bf16 v[232:235], a[36:39], a[132:135], v[232:235]
s_waitcnt lgkmcnt(6)
buffer_load_dwordx4 v253, s[36:39], s50 offen offset:1024 lds
v_mfma_f32_16x16x32_bf16 v[244:247], a[40:43], a[132:135], v[244:247]
ds_read_b64_tr_b16 a[28:29], v15 offset:16968
s_add_u32 m0, s17, 135168
s_add_u32 s50, s101, 262656
v_mfma_f32_16x16x32_bf16 v[248:251], a[40:43], a[136:139], v[248:251]
ds_read_b64_tr_b16 a[30:31], v15 offset:17480
buffer_load_dwordx4 v4, s[28:31], s50 offen offset:0 lds
v_mfma_f32_16x16x32_bf16 a[0:3], a[40:43], a[140:143], a[0:3]
buffer_load_dwordx4 v5, s[28:31], s50 offen offset:1056 lds
v_mfma_f32_16x16x32_bf16 a[12:15], a[44:47], a[140:143], a[12:15]
ds_read_b64_tr_b16 a[32:33], v15 offset:17024
buffer_load_dwordx4 v6, s[28:31], s50 offen offset:2112 lds
v_mfma_f32_16x16x32_bf16 a[8:11], a[44:47], a[136:139], a[8:11]
ds_read_b64_tr_b16 a[34:35], v15 offset:17536
v_mfma_f32_16x16x32_bf16 a[4:7], a[44:47], a[132:135], a[4:7]
s_waitcnt lgkmcnt(6)
buffer_load_dwordx4 v7, s[28:31], s50 offen offset:3168 lds
LS_48:
v_mfma_f32_16x16x32_bf16 v[76:79], a[16:19], a[48:51], v[76:79]
ds_read_b64_tr_b16 a[36:37], v15 offset:17032
s_waitcnt vmcnt(20)
v_mfma_f32_16x16x32_bf16 v[80:83], a[16:19], a[52:55], v[80:83]
ds_read_b64_tr_b16 a[38:39], v15 offset:17544
v_add_u32 v74, s52, v254
v_mfma_f32_16x16x32_bf16 v[84:87], a[16:19], a[56:59], v[84:87]
v_xor_b32 v75, 64, v74
v_lshrrev_b32 v73, 9, v252
v_mfma_f32_16x16x32_bf16 v[96:99], a[20:23], a[56:59], v[96:99]
ds_read_b64_tr_b16 a[40:41], v15 offset:17088
ds_read_b128 a[96:99], v74 offset:0
v_mfma_f32_16x16x32_bf16 v[92:95], a[20:23], a[52:55], v[92:95]
ds_read_b64_tr_b16 a[42:43], v15 offset:17600
ds_read_b128 a[100:103], v74 offset:2048
v_mfma_f32_16x16x32_bf16 v[88:91], a[20:23], a[48:51], v[88:91]
s_waitcnt lgkmcnt(8)
ds_read_b128 a[104:107], v74 offset:4096
v_mfma_f32_16x16x32_bf16 v[100:103], a[24:27], a[48:51], v[100:103]
ds_read_b64_tr_b16 a[44:45], v15 offset:17096
ds_read_b128 a[108:111], v75 offset:0
v_mfma_f32_16x16x32_bf16 v[104:107], a[24:27], a[52:55], v[104:107]
ds_read_b64_tr_b16 a[46:47], v15 offset:17608
ds_read_b128 a[112:115], v75 offset:2048
v_mfma_f32_16x16x32_bf16 v[108:111], a[24:27], a[56:59], v[108:111]
ds_read_b128 a[116:119], v75 offset:4096
v_mul_u32_u24 v73, 24576, v73
v_mfma_f32_16x16x32_bf16 v[120:123], a[28:31], a[56:59], v[120:123]
ds_read_b64_tr_b16 a[16:17], v15 offset:17152
v_add_u32 v0, v0, v73
v_mfma_f32_16x16x32_bf16 v[116:119], a[28:31], a[52:55], v[116:119]
ds_read_b64_tr_b16 a[18:19], v15 offset:17664
v_add_u32 v1, v1, v73
v_mfma_f32_16x16x32_bf16 v[112:115], a[28:31], a[48:51], v[112:115]
s_waitcnt lgkmcnt(12)
v_add_u32 v2, v2, v73
v_mfma_f32_16x16x32_bf16 v[124:127], a[32:35], a[48:51], v[124:127]
ds_read_b64_tr_b16 a[20:21], v15 offset:17160
s_waitcnt lgkmcnt(3)
v_mfma_f32_16x16x32_bf16 v[128:131], a[32:35], a[52:55], v[128:131]
ds_read_b64_tr_b16 a[22:23], v15 offset:17672
v_add_u32 v3, v3, v73
v_mfma_f32_16x16x32_bf16 v[132:135], a[32:35], a[56:59], v[132:135]
s_add_u32 m0, s52, 0
s_add_u32 s50, s98, 0
v_mfma_f32_16x16x32_bf16 v[144:147], a[36:39], a[56:59], v[144:147]
ds_read_b64_tr_b16 a[24:25], v15 offset:17216
buffer_load_dwordx4 v14, s[36:39], s50 offen lds
v_mfma_f32_16x16x32_bf16 v[140:143], a[36:39], a[52:55], v[140:143]
ds_read_b64_tr_b16 a[26:27], v15 offset:17728
v_mfma_f32_16x16x32_bf16 v[136:139], a[36:39], a[48:51], v[136:139]
s_waitcnt lgkmcnt(8)
buffer_load_dwordx4 v253, s[36:39], s50 offen offset:1024 lds
v_mfma_f32_16x16x32_bf16 v[148:151], a[40:43], a[48:51], v[148:151]
ds_read_b64_tr_b16 a[28:29], v15 offset:17224
v_mfma_f32_16x16x32_bf16 v[152:155], a[40:43], a[52:55], v[152:155]
ds_read_b64_tr_b16 a[30:31], v15 offset:17736
v_mfma_f32_16x16x32_bf16 v[156:159], a[40:43], a[56:59], v[156:159]
s_waitcnt vmcnt(28)
s_barrier
v_mfma_f32_16x16x32_bf16 v[168:171], a[44:47], a[56:59], v[168:171]
ds_read_b64_tr_b16 a[32:33], v15 offset:17280
v_mfma_f32_16x16x32_bf16 v[164:167], a[44:47], a[52:55], v[164:167]
ds_read_b64_tr_b16 a[34:35], v15 offset:17792
v_mfma_f32_16x16x32_bf16 v[160:163], a[44:47], a[48:51], v[160:163]
s_waitcnt lgkmcnt(6)
v_mfma_f32_16x16x32_bf16 v[172:175], a[16:19], a[48:51], v[172:175]
ds_read_b64_tr_b16 a[36:37], v15 offset:17288
v_mfma_f32_16x16x32_bf16 v[176:179], a[16:19], a[52:55], v[176:179]
ds_read_b64_tr_b16 a[38:39], v15 offset:17800
v_mfma_f32_16x16x32_bf16 v[180:183], a[16:19], a[56:59], v[180:183]
s_add_u32 m0, s52, 2048
s_add_u32 s50, s98, 14336
v_mfma_f32_16x16x32_bf16 v[192:195], a[20:23], a[56:59], v[192:195]
ds_read_b64_tr_b16 a[40:41], v15 offset:17344
buffer_load_dwordx4 v14, s[36:39], s50 offen lds
v_mfma_f32_16x16x32_bf16 v[188:191], a[20:23], a[52:55], v[188:191]
ds_read_b64_tr_b16 a[42:43], v15 offset:17856
v_mfma_f32_16x16x32_bf16 v[184:187], a[20:23], a[48:51], v[184:187]
s_waitcnt lgkmcnt(6)
buffer_load_dwordx4 v253, s[36:39], s50 offen offset:1024 lds
v_mfma_f32_16x16x32_bf16 v[196:199], a[24:27], a[48:51], v[196:199]
ds_read_b64_tr_b16 a[44:45], v15 offset:17352
v_mfma_f32_16x16x32_bf16 v[200:203], a[24:27], a[52:55], v[200:203]
ds_read_b64_tr_b16 a[46:47], v15 offset:17864
v_mfma_f32_16x16x32_bf16 v[204:207], a[24:27], a[56:59], v[204:207]
s_add_u32 m0, s52, 4096
s_add_u32 s50, s98, 28672
v_mfma_f32_16x16x32_bf16 v[216:219], a[28:31], a[56:59], v[216:219]
ds_read_b64_tr_b16 a[16:17], v15 offset:33792
buffer_load_dwordx4 v14, s[36:39], s50 offen lds
v_mfma_f32_16x16x32_bf16 v[212:215], a[28:31], a[52:55], v[212:215]
ds_read_b64_tr_b16 a[18:19], v15 offset:34304
v_mfma_f32_16x16x32_bf16 v[208:211], a[28:31], a[48:51], v[208:211]
s_waitcnt lgkmcnt(6)
buffer_load_dwordx4 v253, s[36:39], s50 offen offset:1024 lds
v_mfma_f32_16x16x32_bf16 v[220:223], a[32:35], a[48:51], v[220:223]
ds_read_b64_tr_b16 a[20:21], v15 offset:33800
v_mfma_f32_16x16x32_bf16 v[224:227], a[32:35], a[52:55], v[224:227]
ds_read_b64_tr_b16 a[22:23], v15 offset:34312
v_mfma_f32_16x16x32_bf16 v[228:231], a[32:35], a[56:59], v[228:231]
s_add_u32 m0, s17, 84480
s_add_u32 s50, s45, 512
v_mfma_f32_16x16x32_bf16 v[240:243], a[36:39], a[56:59], v[240:243]
ds_read_b64_tr_b16 a[24:25], v15 offset:33856
v_mfma_f32_16x16x32_bf16 v[236:239], a[36:39], a[52:55], v[236:239]
ds_read_b64_tr_b16 a[26:27], v15 offset:34368
v_mfma_f32_16x16x32_bf16 v[232:235], a[36:39], a[48:51], v[232:235]
s_waitcnt lgkmcnt(6)
buffer_load_dwordx4 v4, s[28:31], s50 offen offset:0 lds
v_mfma_f32_16x16x32_bf16 v[244:247], a[40:43], a[48:51], v[244:247]
ds_read_b64_tr_b16 a[28:29], v15 offset:33864
v_mfma_f32_16x16x32_bf16 v[248:251], a[40:43], a[52:55], v[248:251]
ds_read_b64_tr_b16 a[30:31], v15 offset:34376
buffer_load_dwordx4 v5, s[28:31], s50 offen offset:1056 lds
v_mfma_f32_16x16x32_bf16 a[0:3], a[40:43], a[56:59], a[0:3]
v_mfma_f32_16x16x32_bf16 a[12:15], a[44:47], a[56:59], a[12:15]
ds_read_b64_tr_b16 a[32:33], v15 offset:33920
buffer_load_dwordx4 v6, s[28:31], s50 offen offset:2112 lds
v_mfma_f32_16x16x32_bf16 a[8:11], a[44:47], a[52:55], a[8:11]
ds_read_b64_tr_b16 a[34:35], v15 offset:34432
v_mfma_f32_16x16x32_bf16 a[4:7], a[44:47], a[48:51], a[4:7]
s_waitcnt lgkmcnt(6)
buffer_load_dwordx4 v7, s[28:31], s50 offen offset:3168 lds
LS_49:
v_mfma_f32_16x16x32_bf16 v[76:79], a[16:19], a[60:63], v[76:79]
ds_read_b64_tr_b16 a[36:37], v15 offset:33928
s_waitcnt vmcnt(20)
v_mfma_f32_16x16x32_bf16 v[80:83], a[16:19], a[64:67], v[80:83]
ds_read_b64_tr_b16 a[38:39], v15 offset:34440
v_add_u32 v74, s53, v254
v_mfma_f32_16x16x32_bf16 v[84:87], a[16:19], a[68:71], v[84:87]
v_xor_b32 v75, 64, v74
v_mfma_f32_16x16x32_bf16 v[96:99], a[20:23], a[68:71], v[96:99]
ds_read_b64_tr_b16 a[40:41], v15 offset:33984
ds_read_b128 v[16:19], v74 offset:0
v_mfma_f32_16x16x32_bf16 v[92:95], a[20:23], a[64:67], v[92:95]
ds_read_b64_tr_b16 a[42:43], v15 offset:34496
ds_read_b128 v[20:23], v74 offset:2048
v_mfma_f32_16x16x32_bf16 v[88:91], a[20:23], a[60:63], v[88:91]
s_waitcnt lgkmcnt(8)
ds_read_b128 v[24:27], v74 offset:4096
v_mfma_f32_16x16x32_bf16 v[100:103], a[24:27], a[60:63], v[100:103]
ds_read_b64_tr_b16 a[44:45], v15 offset:33992
ds_read_b128 v[28:31], v75 offset:0
v_mfma_f32_16x16x32_bf16 v[104:107], a[24:27], a[64:67], v[104:107]
ds_read_b64_tr_b16 a[46:47], v15 offset:34504
ds_read_b128 v[32:35], v75 offset:2048
v_mfma_f32_16x16x32_bf16 v[108:111], a[24:27], a[68:71], v[108:111]
ds_read_b128 v[36:39], v75 offset:4096
v_mfma_f32_16x16x32_bf16 v[120:123], a[28:31], a[68:71], v[120:123]
ds_read_b64_tr_b16 a[16:17], v15 offset:34048
s_waitcnt vmcnt(14)
v_mfma_f32_16x16x32_bf16 v[116:119], a[28:31], a[64:67], v[116:119]
ds_read_b64_tr_b16 a[18:19], v15 offset:34560
v_add_u32 v74, s54, v254
v_mfma_f32_16x16x32_bf16 v[112:115], a[28:31], a[60:63], v[112:115]
s_waitcnt lgkmcnt(12)
v_xor_b32 v75, 64, v74
v_mfma_f32_16x16x32_bf16 v[124:127], a[32:35], a[60:63], v[124:127]
ds_read_b64_tr_b16 a[20:21], v15 offset:34056
ds_read_b128 v[40:43], v74 offset:0
v_mfma_f32_16x16x32_bf16 v[128:131], a[32:35], a[64:67], v[128:131]
ds_read_b64_tr_b16 a[22:23], v15 offset:34568
ds_read_b128 v[44:47], v74 offset:2048
v_mfma_f32_16x16x32_bf16 v[132:135], a[32:35], a[68:71], v[132:135]
ds_read_b128 v[48:51], v74 offset:4096
v_mfma_f32_16x16x32_bf16 v[144:147], a[36:39], a[68:71], v[144:147]
ds_read_b64_tr_b16 a[24:25], v15 offset:34112
ds_read_b128 v[52:55], v75 offset:0
v_mfma_f32_16x16x32_bf16 v[140:143], a[36:39], a[64:67], v[140:143]
ds_read_b64_tr_b16 a[26:27], v15 offset:34624
ds_read_b128 v[56:59], v75 offset:2048
v_mfma_f32_16x16x32_bf16 v[136:139], a[36:39], a[60:63], v[136:139]
s_waitcnt lgkmcnt(13)
ds_read_b128 v[60:63], v75 offset:4096
v_mfma_f32_16x16x32_bf16 v[148:151], a[40:43], a[60:63], v[148:151]
ds_read_b64_tr_b16 a[28:29], v15 offset:34120
v_mfma_f32_16x16x32_bf16 v[152:155], a[40:43], a[64:67], v[152:155]
ds_read_b64_tr_b16 a[30:31], v15 offset:34632
v_mfma_f32_16x16x32_bf16 v[156:159], a[40:43], a[68:71], v[156:159]
s_waitcnt vmcnt(10)
s_barrier
v_mfma_f32_16x16x32_bf16 v[168:171], a[44:47], a[68:71], v[168:171]
ds_read_b64_tr_b16 a[32:33], v15 offset:34176
v_mfma_f32_16x16x32_bf16 v[164:167], a[44:47], a[64:67], v[164:167]
ds_read_b64_tr_b16 a[34:35], v15 offset:34688
v_mfma_f32_16x16x32_bf16 v[160:163], a[44:47], a[60:63], v[160:163]
s_waitcnt lgkmcnt(11)
v_mfma_f32_16x16x32_bf16 v[172:175], a[16:19], a[60:63], v[172:175]
ds_read_b64_tr_b16 a[36:37], v15 offset:34184
v_mfma_f32_16x16x32_bf16 v[176:179], a[16:19], a[64:67], v[176:179]
ds_read_b64_tr_b16 a[38:39], v15 offset:34696
v_mfma_f32_16x16x32_bf16 v[180:183], a[16:19], a[68:71], v[180:183]
s_add_u32 m0, s17, 101376
s_add_u32 s50, s45, 262656
v_mfma_f32_16x16x32_bf16 v[192:195], a[20:23], a[68:71], v[192:195]
ds_read_b64_tr_b16 a[40:41], v15 offset:34240
v_mfma_f32_16x16x32_bf16 v[188:191], a[20:23], a[64:67], v[188:191]
ds_read_b64_tr_b16 a[42:43], v15 offset:34752
v_mfma_f32_16x16x32_bf16 v[184:187], a[20:23], a[60:63], v[184:187]
s_waitcnt lgkmcnt(6)
v_mfma_f32_16x16x32_bf16 v[196:199], a[24:27], a[60:63], v[196:199]
ds_read_b64_tr_b16 a[44:45], v15 offset:34248
v_mfma_f32_16x16x32_bf16 v[200:203], a[24:27], a[64:67], v[200:203]
ds_read_b64_tr_b16 a[46:47], v15 offset:34760
v_mfma_f32_16x16x32_bf16 v[204:207], a[24:27], a[68:71], v[204:207]
buffer_load_dwordx4 v4, s[28:31], s50 offen offset:0 lds
v_mfma_f32_16x16x32_bf16 v[216:219], a[28:31], a[68:71], v[216:219]
v_subrev_u32 v15, 50688, v15
ds_read_b64_tr_b16 a[16:17], v15 offset:33792
v_mfma_f32_16x16x32_bf16 v[212:215], a[28:31], a[64:67], v[212:215]
ds_read_b64_tr_b16 a[18:19], v15 offset:34304
v_mfma_f32_16x16x32_bf16 v[208:211], a[28:31], a[60:63], v[208:211]
s_waitcnt lgkmcnt(6)
v_mfma_f32_16x16x32_bf16 v[220:223], a[32:35], a[60:63], v[220:223]
v_mov_b32 v72, v15
v_add_u32 v72, 50688, v72
ds_read_b64_tr_b16 a[20:21], v72 offset:50688
v_mfma_f32_16x16x32_bf16 v[224:227], a[32:35], a[64:67], v[224:227]
ds_read_b64_tr_b16 a[22:23], v72 offset:51200
v_mfma_f32_16x16x32_bf16 v[228:231], a[32:35], a[68:71], v[228:231]
buffer_load_dwordx4 v5, s[28:31], s50 offen offset:1056 lds
v_mfma_f32_16x16x32_bf16 v[240:243], a[36:39], a[68:71], v[240:243]
ds_read_b64_tr_b16 a[24:25], v15 offset:33800
v_mfma_f32_16x16x32_bf16 v[236:239], a[36:39], a[64:67], v[236:239]
ds_read_b64_tr_b16 a[26:27], v15 offset:34312
v_mfma_f32_16x16x32_bf16 v[232:235], a[36:39], a[60:63], v[232:235]
s_waitcnt lgkmcnt(6)
v_mfma_f32_16x16x32_bf16 v[244:247], a[40:43], a[60:63], v[244:247]
ds_read_b64_tr_b16 a[28:29], v72 offset:50696
v_mfma_f32_16x16x32_bf16 v[248:251], a[40:43], a[64:67], v[248:251]
ds_read_b64_tr_b16 a[30:31], v72 offset:51208
v_mfma_f32_16x16x32_bf16 a[0:3], a[40:43], a[68:71], a[0:3]
buffer_load_dwordx4 v6, s[28:31], s50 offen offset:2112 lds
v_mfma_f32_16x16x32_bf16 a[12:15], a[44:47], a[68:71], a[12:15]
ds_read_b64_tr_b16 a[32:33], v15 offset:33856
v_mfma_f32_16x16x32_bf16 a[8:11], a[44:47], a[64:67], a[8:11]
ds_read_b64_tr_b16 a[34:35], v15 offset:34368
v_mfma_f32_16x16x32_bf16 a[4:7], a[44:47], a[60:63], a[4:7]
s_waitcnt lgkmcnt(6)
buffer_load_dwordx4 v7, s[28:31], s50 offen offset:3168 lds
LS_50:
v_mfma_f32_16x16x32_bf16 v[76:79], a[16:19], a[72:75], v[76:79]
ds_read_b64_tr_b16 a[36:37], v72 offset:50752
s_waitcnt vmcnt(8)
v_mfma_f32_16x16x32_bf16 v[76:79], a[20:23], a[84:87], v[76:79]
ds_read_b64_tr_b16 a[38:39], v72 offset:51264
v_add_u32 v74, s52, v254
v_mfma_f32_16x16x32_bf16 v[80:83], a[20:23], a[88:91], v[80:83]
v_xor_b32 v75, 64, v74
v_mfma_f32_16x16x32_bf16 v[80:83], a[16:19], a[76:79], v[80:83]
ds_read_b64_tr_b16 a[40:41], v15 offset:33864
ds_read_b128 a[120:123], v74 offset:0
v_mfma_f32_16x16x32_bf16 v[84:87], a[16:19], a[80:83], v[84:87]
ds_read_b64_tr_b16 a[42:43], v15 offset:34376
ds_read_b128 a[124:127], v74 offset:2048
v_mfma_f32_16x16x32_bf16 v[84:87], a[20:23], a[92:95], v[84:87]
s_waitcnt lgkmcnt(8)
ds_read_b128 a[128:131], v74 offset:4096
v_mfma_f32_16x16x32_bf16 v[96:99], a[28:31], a[92:95], v[96:99]
ds_read_b64_tr_b16 a[44:45], v72 offset:50760
ds_read_b128 a[132:135], v75 offset:0
v_mfma_f32_16x16x32_bf16 v[96:99], a[24:27], a[80:83], v[96:99]
ds_read_b64_tr_b16 a[46:47], v72 offset:51272
ds_read_b128 a[136:139], v75 offset:2048
v_mfma_f32_16x16x32_bf16 v[92:95], a[24:27], a[76:79], v[92:95]
ds_read_b128 a[140:143], v75 offset:4096
v_mfma_f32_16x16x32_bf16 v[92:95], a[28:31], a[88:91], v[92:95]
ds_read_b64_tr_b16 a[16:17], v15 offset:33920
v_mfma_f32_16x16x32_bf16 v[88:91], a[28:31], a[84:87], v[88:91]
ds_read_b64_tr_b16 a[18:19], v15 offset:34432
v_mfma_f32_16x16x32_bf16 v[88:91], a[24:27], a[72:75], v[88:91]
s_waitcnt lgkmcnt(12)
v_mfma_f32_16x16x32_bf16 v[100:103], a[32:35], a[72:75], v[100:103]
ds_read_b64_tr_b16 a[20:21], v72 offset:50816
v_mfma_f32_16x16x32_bf16 v[100:103], a[36:39], a[84:87], v[100:103]
ds_read_b64_tr_b16 a[22:23], v72 offset:51328
v_mfma_f32_16x16x32_bf16 v[104:107], a[36:39], a[88:91], v[104:107]
v_mfma_f32_16x16x32_bf16 v[104:107], a[32:35], a[76:79], v[104:107]
ds_read_b64_tr_b16 a[24:25], v15 offset:33928
v_mfma_f32_16x16x32_bf16 v[108:111], a[32:35], a[80:83], v[108:111]
ds_read_b64_tr_b16 a[26:27], v15 offset:34440
v_mfma_f32_16x16x32_bf16 v[108:111], a[36:39], a[92:95], v[108:111]
s_waitcnt lgkmcnt(8)
v_mfma_f32_16x16x32_bf16 v[120:123], a[44:47], a[92:95], v[120:123]
ds_read_b64_tr_b16 a[28:29], v72 offset:50824
v_mfma_f32_16x16x32_bf16 v[120:123], a[40:43], a[80:83], v[120:123]
ds_read_b64_tr_b16 a[30:31], v72 offset:51336
v_mfma_f32_16x16x32_bf16 v[116:119], a[40:43], a[76:79], v[116:119]
s_barrier
v_mfma_f32_16x16x32_bf16 v[116:119], a[44:47], a[88:91], v[116:119]
ds_read_b64_tr_b16 a[32:33], v15 offset:33984
v_mfma_f32_16x16x32_bf16 v[112:115], a[44:47], a[84:87], v[112:115]
ds_read_b64_tr_b16 a[34:35], v15 offset:34496
v_mfma_f32_16x16x32_bf16 v[112:115], a[40:43], a[72:75], v[112:115]
s_waitcnt lgkmcnt(6)
v_mfma_f32_16x16x32_bf16 v[124:127], a[16:19], a[72:75], v[124:127]
ds_read_b64_tr_b16 a[36:37], v72 offset:50880
v_mfma_f32_16x16x32_bf16 v[124:127], a[20:23], a[84:87], v[124:127]
ds_read_b64_tr_b16 a[38:39], v72 offset:51392
v_mfma_f32_16x16x32_bf16 v[128:131], a[20:23], a[88:91], v[128:131]
s_add_u32 m0, s17, 118272
s_add_u32 s50, s46, 512
v_mfma_f32_16x16x32_bf16 v[128:131], a[16:19], a[76:79], v[128:131]
ds_read_b64_tr_b16 a[40:41], v15 offset:33992
v_mfma_f32_16x16x32_bf16 v[132:135], a[16:19], a[80:83], v[132:135]
ds_read_b64_tr_b16 a[42:43], v15 offset:34504
v_mfma_f32_16x16x32_bf16 v[132:135], a[20:23], a[92:95], v[132:135]
s_waitcnt lgkmcnt(6)
v_mfma_f32_16x16x32_bf16 v[144:147], a[28:31], a[92:95], v[144:147]
ds_read_b64_tr_b16 a[44:45], v72 offset:50888
v_mfma_f32_16x16x32_bf16 v[144:147], a[24:27], a[80:83], v[144:147]
ds_read_b64_tr_b16 a[46:47], v72 offset:51400
v_mfma_f32_16x16x32_bf16 v[140:143], a[24:27], a[76:79], v[140:143]
buffer_load_dwordx4 v4, s[28:31], s50 offen offset:0 lds
v_mfma_f32_16x16x32_bf16 v[140:143], a[28:31], a[88:91], v[140:143]
ds_read_b64_tr_b16 a[16:17], v15 offset:34048
v_mfma_f32_16x16x32_bf16 v[136:139], a[28:31], a[84:87], v[136:139]
ds_read_b64_tr_b16 a[18:19], v15 offset:34560
v_mfma_f32_16x16x32_bf16 v[136:139], a[24:27], a[72:75], v[136:139]
s_waitcnt lgkmcnt(6)
v_mfma_f32_16x16x32_bf16 v[148:151], a[32:35], a[72:75], v[148:151]
ds_read_b64_tr_b16 a[20:21], v72 offset:50944
v_mfma_f32_16x16x32_bf16 v[148:151], a[36:39], a[84:87], v[148:151]
ds_read_b64_tr_b16 a[22:23], v72 offset:51456
v_mfma_f32_16x16x32_bf16 v[152:155], a[36:39], a[88:91], v[152:155]
buffer_load_dwordx4 v5, s[28:31], s50 offen offset:1056 lds
v_mfma_f32_16x16x32_bf16 v[152:155], a[32:35], a[76:79], v[152:155]
ds_read_b64_tr_b16 a[24:25], v15 offset:34056
v_mfma_f32_16x16x32_bf16 v[156:159], a[32:35], a[80:83], v[156:159]
ds_read_b64_tr_b16 a[26:27], v15 offset:34568
v_mfma_f32_16x16x32_bf16 v[156:159], a[36:39], a[92:95], v[156:159]
s_waitcnt lgkmcnt(6)
v_mfma_f32_16x16x32_bf16 v[168:171], a[44:47], a[92:95], v[168:171]
ds_read_b64_tr_b16 a[28:29], v72 offset:50952
v_mfma_f32_16x16x32_bf16 v[168:171], a[40:43], a[80:83], v[168:171]
ds_read_b64_tr_b16 a[30:31], v72 offset:51464
v_mfma_f32_16x16x32_bf16 v[164:167], a[40:43], a[76:79], v[164:167]
buffer_load_dwordx4 v6, s[28:31], s50 offen offset:2112 lds
v_mfma_f32_16x16x32_bf16 v[164:167], a[44:47], a[88:91], v[164:167]
ds_read_b64_tr_b16 a[32:33], v15 offset:34112
v_mfma_f32_16x16x32_bf16 v[160:163], a[44:47], a[84:87], v[160:163]
ds_read_b64_tr_b16 a[34:35], v15 offset:34624
v_mfma_f32_16x16x32_bf16 v[160:163], a[40:43], a[72:75], v[160:163]
s_waitcnt lgkmcnt(6)
buffer_load_dwordx4 v7, s[28:31], s50 offen offset:3168 lds
LS_51:
v_mfma_f32_16x16x32_bf16 v[172:175], a[16:19], a[72:75], v[172:175]
ds_read_b64_tr_b16 a[36:37], v72 offset:51008
s_add_u32 s87, s49, 0
v_mfma_f32_16x16x32_bf16 v[172:175], a[20:23], a[84:87], v[172:175]
ds_read_b64_tr_b16 a[38:39], v72 offset:51520
s_and_b32 s87, s87, 7
v_mfma_f32_16x16x32_bf16 v[176:179], a[20:23], a[88:91], v[176:179]
s_lshl_b32 s18, s87, 10
v_mfma_f32_16x16x32_bf16 v[176:179], a[16:19], a[76:79], v[176:179]
ds_read_b64_tr_b16 a[40:41], v15 offset:34120
s_add_u32 s18, s18, 0
v_mfma_f32_16x16x32_bf16 v[180:183], a[16:19], a[80:83], v[180:183]
ds_read_b64_tr_b16 a[42:43], v15 offset:34632
v_mfma_f32_16x16x32_bf16 v[180:183], a[20:23], a[92:95], v[180:183]
s_waitcnt lgkmcnt(6)
v_mfma_f32_16x16x32_bf16 v[192:195], a[28:31], a[92:95], v[192:195]
ds_read_b64_tr_b16 a[44:45], v72 offset:51016
s_waitcnt vmcnt(4)
s_barrier
v_mfma_f32_16x16x32_bf16 v[192:195], a[24:27], a[80:83], v[192:195]
ds_read_b64_tr_b16 a[46:47], v72 offset:51528
v_mfma_f32_16x16x32_bf16 v[188:191], a[24:27], a[76:79], v[188:191]
s_add_u32 m0, s17, 33792
s_add_u32 s50, s46, 262656
v_mfma_f32_16x16x32_bf16 v[188:191], a[28:31], a[88:91], v[188:191]
ds_read_b64_tr_b16 a[16:17], v15 offset:34176
v_mfma_f32_16x16x32_bf16 v[184:187], a[28:31], a[84:87], v[184:187]
ds_read_b64_tr_b16 a[18:19], v15 offset:34688
v_mfma_f32_16x16x32_bf16 v[184:187], a[24:27], a[72:75], v[184:187]
s_waitcnt lgkmcnt(6)
v_mfma_f32_16x16x32_bf16 v[196:199], a[32:35], a[72:75], v[196:199]
ds_read_b64_tr_b16 a[20:21], v72 offset:51072
v_mfma_f32_16x16x32_bf16 v[196:199], a[36:39], a[84:87], v[196:199]
ds_read_b64_tr_b16 a[22:23], v72 offset:51584
v_mfma_f32_16x16x32_bf16 v[200:203], a[36:39], a[88:91], v[200:203]
buffer_load_dwordx4 v4, s[28:31], s50 offen offset:0 lds
v_mfma_f32_16x16x32_bf16 v[200:203], a[32:35], a[76:79], v[200:203]
ds_read_b64_tr_b16 a[24:25], v15 offset:34184
v_mfma_f32_16x16x32_bf16 v[204:207], a[32:35], a[80:83], v[204:207]
ds_read_b64_tr_b16 a[26:27], v15 offset:34696
v_mfma_f32_16x16x32_bf16 v[204:207], a[36:39], a[92:95], v[204:207]
s_waitcnt lgkmcnt(6)
v_mfma_f32_16x16x32_bf16 v[216:219], a[44:47], a[92:95], v[216:219]
ds_read_b64_tr_b16 a[28:29], v72 offset:51080
v_mfma_f32_16x16x32_bf16 v[216:219], a[40:43], a[80:83], v[216:219]
ds_read_b64_tr_b16 a[30:31], v72 offset:51592
v_mfma_f32_16x16x32_bf16 v[212:215], a[40:43], a[76:79], v[212:215]
buffer_load_dwordx4 v5, s[28:31], s50 offen offset:1056 lds
v_mfma_f32_16x16x32_bf16 v[212:215], a[44:47], a[88:91], v[212:215]
ds_read_b64_tr_b16 a[32:33], v15 offset:34240
v_mfma_f32_16x16x32_bf16 v[208:211], a[44:47], a[84:87], v[208:211]
ds_read_b64_tr_b16 a[34:35], v15 offset:34752
v_mfma_f32_16x16x32_bf16 v[208:211], a[40:43], a[72:75], v[208:211]
s_waitcnt lgkmcnt(6)
v_mfma_f32_16x16x32_bf16 v[220:223], a[16:19], a[72:75], v[220:223]
ds_read_b64_tr_b16 a[36:37], v72 offset:51136
v_mfma_f32_16x16x32_bf16 v[220:223], a[20:23], a[84:87], v[220:223]
ds_read_b64_tr_b16 a[38:39], v72 offset:51648
v_mfma_f32_16x16x32_bf16 v[224:227], a[20:23], a[88:91], v[224:227]
buffer_load_dwordx4 v6, s[28:31], s50 offen offset:2112 lds
v_mfma_f32_16x16x32_bf16 v[224:227], a[16:19], a[76:79], v[224:227]
ds_read_b64_tr_b16 a[40:41], v15 offset:34248
v_mfma_f32_16x16x32_bf16 v[228:231], a[16:19], a[80:83], v[228:231]
ds_read_b64_tr_b16 a[42:43], v15 offset:34760
v_mfma_f32_16x16x32_bf16 v[228:231], a[20:23], a[92:95], v[228:231]
s_waitcnt lgkmcnt(6)
v_mfma_f32_16x16x32_bf16 v[240:243], a[28:31], a[92:95], v[240:243]
ds_read_b64_tr_b16 a[44:45], v72 offset:51144
v_mfma_f32_16x16x32_bf16 v[240:243], a[24:27], a[80:83], v[240:243]
ds_read_b64_tr_b16 a[46:47], v72 offset:51656
v_mfma_f32_16x16x32_bf16 v[236:239], a[24:27], a[76:79], v[236:239]
buffer_load_dwordx4 v7, s[28:31], s50 offen offset:3168 lds
v_mfma_f32_16x16x32_bf16 v[236:239], a[28:31], a[88:91], v[236:239]
ds_read_b64_tr_b16 a[16:17], v15 offset:50688
v_mfma_f32_16x16x32_bf16 v[232:235], a[28:31], a[84:87], v[232:235]
ds_read_b64_tr_b16 a[18:19], v15 offset:51200
v_mfma_f32_16x16x32_bf16 v[232:235], a[24:27], a[72:75], v[232:235]
s_waitcnt lgkmcnt(6)
v_mfma_f32_16x16x32_bf16 v[244:247], a[32:35], a[72:75], v[244:247]
ds_read_b64_tr_b16 a[20:21], v72 offset:16896
v_mfma_f32_16x16x32_bf16 v[244:247], a[36:39], a[84:87], v[244:247]
ds_read_b64_tr_b16 a[22:23], v72 offset:17408
s_add_u32 m0, s17, 16896
s_mov_b32 s50, 262144
v_mfma_f32_16x16x32_bf16 v[248:251], a[36:39], a[88:91], v[248:251]
buffer_load_dwordx4 v0, s[20:23], s50 offen offset:0 nt lds
v_mfma_f32_16x16x32_bf16 v[248:251], a[32:35], a[76:79], v[248:251]
ds_read_b64_tr_b16 a[24:25], v15 offset:50696
v_mfma_f32_16x16x32_bf16 a[0:3], a[32:35], a[80:83], a[0:3]
ds_read_b64_tr_b16 a[26:27], v15 offset:51208
v_mfma_f32_16x16x32_bf16 a[0:3], a[36:39], a[92:95], a[0:3]
s_waitcnt lgkmcnt(6)
buffer_load_dwordx4 v1, s[20:23], s50 offen offset:1056 nt lds
v_mfma_f32_16x16x32_bf16 a[12:15], a[44:47], a[92:95], a[12:15]
ds_read_b64_tr_b16 a[28:29], v72 offset:16904
v_mfma_f32_16x16x32_bf16 a[12:15], a[40:43], a[80:83], a[12:15]
ds_read_b64_tr_b16 a[30:31], v72 offset:17416
v_mfma_f32_16x16x32_bf16 a[8:11], a[40:43], a[76:79], a[8:11]
buffer_load_dwordx4 v2, s[20:23], s50 offen offset:2112 nt lds
v_mfma_f32_16x16x32_bf16 a[8:11], a[44:47], a[88:91], a[8:11]
ds_read_b64_tr_b16 a[32:33], v15 offset:50752
v_mfma_f32_16x16x32_bf16 a[4:7], a[44:47], a[84:87], a[4:7]
ds_read_b64_tr_b16 a[34:35], v15 offset:51264
v_mfma_f32_16x16x32_bf16 a[4:7], a[40:43], a[72:75], a[4:7]
s_waitcnt lgkmcnt(6)
buffer_load_dwordx4 v3, s[20:23], s50 offen offset:3168 nt lds
LS_52:
v_mfma_f32_16x16x32_bf16 v[76:79], a[16:19], a[96:99], v[76:79]
ds_read_b64_tr_b16 a[36:37], v72 offset:16960
v_mfma_f32_16x16x32_bf16 v[76:79], a[20:23], a[108:111], v[76:79]
ds_read_b64_tr_b16 a[38:39], v72 offset:17472
v_mfma_f32_16x16x32_bf16 v[80:83], a[20:23], a[112:115], v[80:83]
s_add_u32 m0, s17, 50688
s_add_u32 s50, s57, 512
v_mfma_f32_16x16x32_bf16 v[80:83], a[16:19], a[100:103], v[80:83]
ds_read_b64_tr_b16 a[40:41], v15 offset:50760
v_mfma_f32_16x16x32_bf16 v[84:87], a[16:19], a[104:107], v[84:87]
ds_read_b64_tr_b16 a[42:43], v15 offset:51272
v_mfma_f32_16x16x32_bf16 v[84:87], a[20:23], a[116:119], v[84:87]
s_waitcnt lgkmcnt(6)
v_mfma_f32_16x16x32_bf16 v[96:99], a[28:31], a[116:119], v[96:99]
ds_read_b64_tr_b16 a[44:45], v72 offset:16968
v_mfma_f32_16x16x32_bf16 v[96:99], a[24:27], a[104:107], v[96:99]
ds_read_b64_tr_b16 a[46:47], v72 offset:17480
v_mfma_f32_16x16x32_bf16 v[92:95], a[24:27], a[100:103], v[92:95]
buffer_load_dwordx4 v4, s[28:31], s50 offen offset:0 lds
v_mfma_f32_16x16x32_bf16 v[92:95], a[28:31], a[112:115], v[92:95]
ds_read_b64_tr_b16 a[16:17], v15 offset:50816
v_mfma_f32_16x16x32_bf16 v[88:91], a[28:31], a[108:111], v[88:91]
ds_read_b64_tr_b16 a[18:19], v15 offset:51328
v_mfma_f32_16x16x32_bf16 v[88:91], a[24:27], a[96:99], v[88:91]
s_waitcnt lgkmcnt(6)
v_mfma_f32_16x16x32_bf16 v[100:103], a[32:35], a[96:99], v[100:103]
ds_read_b64_tr_b16 a[20:21], v72 offset:17024
v_mfma_f32_16x16x32_bf16 v[100:103], a[36:39], a[108:111], v[100:103]
ds_read_b64_tr_b16 a[22:23], v72 offset:17536
v_mfma_f32_16x16x32_bf16 v[104:107], a[36:39], a[112:115], v[104:107]
buffer_load_dwordx4 v5, s[28:31], s50 offen offset:1056 lds
v_mfma_f32_16x16x32_bf16 v[104:107], a[32:35], a[100:103], v[104:107]
ds_read_b64_tr_b16 a[24:25], v15 offset:50824
v_mfma_f32_16x16x32_bf16 v[108:111], a[32:35], a[104:107], v[108:111]
ds_read_b64_tr_b16 a[26:27], v15 offset:51336
v_mfma_f32_16x16x32_bf16 v[108:111], a[36:39], a[116:119], v[108:111]
s_waitcnt lgkmcnt(6)
v_mfma_f32_16x16x32_bf16 v[120:123], a[44:47], a[116:119], v[120:123]
ds_read_b64_tr_b16 a[28:29], v72 offset:17032
v_mfma_f32_16x16x32_bf16 v[120:123], a[40:43], a[104:107], v[120:123]
ds_read_b64_tr_b16 a[30:31], v72 offset:17544
v_mfma_f32_16x16x32_bf16 v[116:119], a[40:43], a[100:103], v[116:119]
s_barrier
v_mfma_f32_16x16x32_bf16 v[116:119], a[44:47], a[112:115], v[116:119]
ds_read_b64_tr_b16 a[32:33], v15 offset:50880
v_mfma_f32_16x16x32_bf16 v[112:115], a[44:47], a[108:111], v[112:115]
ds_read_b64_tr_b16 a[34:35], v15 offset:51392
v_mfma_f32_16x16x32_bf16 v[112:115], a[40:43], a[96:99], v[112:115]
s_waitcnt lgkmcnt(6)
v_mfma_f32_16x16x32_bf16 v[124:127], a[16:19], a[96:99], v[124:127]
ds_read_b64_tr_b16 a[36:37], v72 offset:17088
v_mfma_f32_16x16x32_bf16 v[124:127], a[20:23], a[108:111], v[124:127]
ds_read_b64_tr_b16 a[38:39], v72 offset:17600
v_mfma_f32_16x16x32_bf16 v[128:131], a[20:23], a[112:115], v[128:131]
buffer_load_dwordx4 v6, s[28:31], s50 offen offset:2112 lds
v_mfma_f32_16x16x32_bf16 v[128:131], a[16:19], a[100:103], v[128:131]
ds_read_b64_tr_b16 a[40:41], v15 offset:50888
v_mfma_f32_16x16x32_bf16 v[132:135], a[16:19], a[104:107], v[132:135]
ds_read_b64_tr_b16 a[42:43], v15 offset:51400
v_mfma_f32_16x16x32_bf16 v[132:135], a[20:23], a[116:119], v[132:135]
s_waitcnt lgkmcnt(6)
v_mfma_f32_16x16x32_bf16 v[144:147], a[28:31], a[116:119], v[144:147]
ds_read_b64_tr_b16 a[44:45], v72 offset:17096
v_mfma_f32_16x16x32_bf16 v[144:147], a[24:27], a[104:107], v[144:147]
ds_read_b64_tr_b16 a[46:47], v72 offset:17608
v_mfma_f32_16x16x32_bf16 v[140:143], a[24:27], a[100:103], v[140:143]
buffer_load_dwordx4 v7, s[28:31], s50 offen offset:3168 lds
v_mfma_f32_16x16x32_bf16 v[140:143], a[28:31], a[112:115], v[140:143]
ds_read_b64_tr_b16 a[16:17], v15 offset:50944
v_mfma_f32_16x16x32_bf16 v[136:139], a[28:31], a[108:111], v[136:139]
ds_read_b64_tr_b16 a[18:19], v15 offset:51456
v_mfma_f32_16x16x32_bf16 v[136:139], a[24:27], a[96:99], v[136:139]
s_waitcnt lgkmcnt(6)
v_mfma_f32_16x16x32_bf16 v[148:151], a[32:35], a[96:99], v[148:151]
ds_read_b64_tr_b16 a[20:21], v72 offset:17152
v_mfma_f32_16x16x32_bf16 v[148:151], a[36:39], a[108:111], v[148:151]
ds_read_b64_tr_b16 a[22:23], v72 offset:17664
s_add_u32 m0, s17, 0
s_mov_b32 s50, 270336
v_mfma_f32_16x16x32_bf16 v[152:155], a[36:39], a[112:115], v[152:155]
buffer_load_dwordx4 v0, s[20:23], s50 offen offset:0 nt lds
v_mfma_f32_16x16x32_bf16 v[152:155], a[32:35], a[100:103], v[152:155]
ds_read_b64_tr_b16 a[24:25], v15 offset:50952
v_mfma_f32_16x16x32_bf16 v[156:159], a[32:35], a[104:107], v[156:159]
ds_read_b64_tr_b16 a[26:27], v15 offset:51464
v_mfma_f32_16x16x32_bf16 v[156:159], a[36:39], a[116:119], v[156:159]
s_waitcnt lgkmcnt(6)
buffer_load_dwordx4 v1, s[20:23], s50 offen offset:1056 nt lds
v_mfma_f32_16x16x32_bf16 v[168:171], a[44:47], a[116:119], v[168:171]
ds_read_b64_tr_b16 a[28:29], v72 offset:17160
v_mfma_f32_16x16x32_bf16 v[168:171], a[40:43], a[104:107], v[168:171]
ds_read_b64_tr_b16 a[30:31], v72 offset:17672
v_mfma_f32_16x16x32_bf16 v[164:167], a[40:43], a[100:103], v[164:167]
buffer_load_dwordx4 v2, s[20:23], s50 offen offset:2112 nt lds
v_mfma_f32_16x16x32_bf16 v[164:167], a[44:47], a[112:115], v[164:167]
ds_read_b64_tr_b16 a[32:33], v15 offset:51008
v_mfma_f32_16x16x32_bf16 v[160:163], a[44:47], a[108:111], v[160:163]
ds_read_b64_tr_b16 a[34:35], v15 offset:51520
v_mfma_f32_16x16x32_bf16 v[160:163], a[40:43], a[96:99], v[160:163]
s_waitcnt lgkmcnt(6)
buffer_load_dwordx4 v3, s[20:23], s50 offen offset:3168 nt lds
LS_53:
v_mfma_f32_16x16x32_bf16 v[172:175], a[16:19], a[96:99], v[172:175]
ds_read_b64_tr_b16 a[36:37], v72 offset:17216
v_mfma_f32_16x16x32_bf16 v[172:175], a[20:23], a[108:111], v[172:175]
ds_read_b64_tr_b16 a[38:39], v72 offset:17728
v_mfma_f32_16x16x32_bf16 v[176:179], a[20:23], a[112:115], v[176:179]
s_add_u32 m0, s17, 67584
s_add_u32 s50, s57, 262656
v_mfma_f32_16x16x32_bf16 v[176:179], a[16:19], a[100:103], v[176:179]
ds_read_b64_tr_b16 a[40:41], v15 offset:51016
v_mfma_f32_16x16x32_bf16 v[180:183], a[16:19], a[104:107], v[180:183]
ds_read_b64_tr_b16 a[42:43], v15 offset:51528
v_mfma_f32_16x16x32_bf16 v[180:183], a[20:23], a[116:119], v[180:183]
s_waitcnt lgkmcnt(6)
v_mfma_f32_16x16x32_bf16 v[192:195], a[28:31], a[116:119], v[192:195]
ds_read_b64_tr_b16 a[44:45], v72 offset:17224
v_mfma_f32_16x16x32_bf16 v[192:195], a[24:27], a[104:107], v[192:195]
ds_read_b64_tr_b16 a[46:47], v72 offset:17736
v_mfma_f32_16x16x32_bf16 v[188:191], a[24:27], a[100:103], v[188:191]
buffer_load_dwordx4 v4, s[28:31], s50 offen offset:0 lds
v_mfma_f32_16x16x32_bf16 v[188:191], a[28:31], a[112:115], v[188:191]
ds_read_b64_tr_b16 a[16:17], v15 offset:51072
v_mfma_f32_16x16x32_bf16 v[184:187], a[28:31], a[108:111], v[184:187]
ds_read_b64_tr_b16 a[18:19], v15 offset:51584
v_mfma_f32_16x16x32_bf16 v[184:187], a[24:27], a[96:99], v[184:187]
s_waitcnt lgkmcnt(6)
v_mfma_f32_16x16x32_bf16 v[196:199], a[32:35], a[96:99], v[196:199]
ds_read_b64_tr_b16 a[20:21], v72 offset:17280
v_mfma_f32_16x16x32_bf16 v[196:199], a[36:39], a[108:111], v[196:199]
ds_read_b64_tr_b16 a[22:23], v72 offset:17792
v_mfma_f32_16x16x32_bf16 v[200:203], a[36:39], a[112:115], v[200:203]
buffer_load_dwordx4 v5, s[28:31], s50 offen offset:1056 lds
v_mfma_f32_16x16x32_bf16 v[200:203], a[32:35], a[100:103], v[200:203]
ds_read_b64_tr_b16 a[24:25], v15 offset:51080
v_mfma_f32_16x16x32_bf16 v[204:207], a[32:35], a[104:107], v[204:207]
ds_read_b64_tr_b16 a[26:27], v15 offset:51592
v_mfma_f32_16x16x32_bf16 v[204:207], a[36:39], a[116:119], v[204:207]
s_waitcnt lgkmcnt(6)
v_mfma_f32_16x16x32_bf16 v[216:219], a[44:47], a[116:119], v[216:219]
ds_read_b64_tr_b16 a[28:29], v72 offset:17288
v_mfma_f32_16x16x32_bf16 v[216:219], a[40:43], a[104:107], v[216:219]
ds_read_b64_tr_b16 a[30:31], v72 offset:17800
v_mfma_f32_16x16x32_bf16 v[212:215], a[40:43], a[100:103], v[212:215]
s_waitcnt vmcnt(14)
s_barrier
v_mfma_f32_16x16x32_bf16 v[212:215], a[44:47], a[112:115], v[212:215]
ds_read_b64_tr_b16 a[32:33], v15 offset:51136
v_mfma_f32_16x16x32_bf16 v[208:211], a[44:47], a[108:111], v[208:211]
ds_read_b64_tr_b16 a[34:35], v15 offset:51648
v_mfma_f32_16x16x32_bf16 v[208:211], a[40:43], a[96:99], v[208:211]
s_waitcnt lgkmcnt(6)
v_mfma_f32_16x16x32_bf16 v[220:223], a[16:19], a[96:99], v[220:223]
ds_read_b64_tr_b16 a[36:37], v72 offset:17344
v_mfma_f32_16x16x32_bf16 v[220:223], a[20:23], a[108:111], v[220:223]
ds_read_b64_tr_b16 a[38:39], v72 offset:17856
v_mfma_f32_16x16x32_bf16 v[224:227], a[20:23], a[112:115], v[224:227]
buffer_load_dwordx4 v6, s[28:31], s50 offen offset:2112 lds
v_mfma_f32_16x16x32_bf16 v[224:227], a[16:19], a[100:103], v[224:227]
ds_read_b64_tr_b16 a[40:41], v15 offset:51144
v_mfma_f32_16x16x32_bf16 v[228:231], a[16:19], a[104:107], v[228:231]
ds_read_b64_tr_b16 a[42:43], v15 offset:51656
v_mfma_f32_16x16x32_bf16 v[228:231], a[20:23], a[116:119], v[228:231]
s_waitcnt lgkmcnt(6)
v_mfma_f32_16x16x32_bf16 v[240:243], a[28:31], a[116:119], v[240:243]
ds_read_b64_tr_b16 a[44:45], v72 offset:17352
v_mfma_f32_16x16x32_bf16 v[240:243], a[24:27], a[104:107], v[240:243]
ds_read_b64_tr_b16 a[46:47], v72 offset:17864
v_mfma_f32_16x16x32_bf16 v[236:239], a[24:27], a[100:103], v[236:239]
buffer_load_dwordx4 v7, s[28:31], s50 offen offset:3168 lds
v_mfma_f32_16x16x32_bf16 v[236:239], a[28:31], a[112:115], v[236:239]
v_add_u32 v15, 50688, v15
ds_read_b64_tr_b16 a[16:17], v15 offset:33792
v_mfma_f32_16x16x32_bf16 v[232:235], a[28:31], a[108:111], v[232:235]
ds_read_b64_tr_b16 a[18:19], v15 offset:34304
v_mfma_f32_16x16x32_bf16 v[232:235], a[24:27], a[96:99], v[232:235]
s_waitcnt lgkmcnt(6)
v_mfma_f32_16x16x32_bf16 v[244:247], a[32:35], a[96:99], v[244:247]
v_subrev_u32 v72, 84480, v72
ds_read_b64_tr_b16 a[20:21], v72 offset:33792
v_mfma_f32_16x16x32_bf16 v[244:247], a[36:39], a[108:111], v[244:247]
ds_read_b64_tr_b16 a[22:23], v72 offset:34304
s_add_u32 m0, s17, 135168
s_mov_b32 s50, 262144
v_mfma_f32_16x16x32_bf16 v[248:251], a[36:39], a[112:115], v[248:251]
buffer_load_dwordx4 v0, s[24:27], s50 offen offset:0 nt lds
v_mfma_f32_16x16x32_bf16 v[248:251], a[32:35], a[100:103], v[248:251]
ds_read_b64_tr_b16 a[24:25], v15 offset:33800
v_mfma_f32_16x16x32_bf16 a[0:3], a[32:35], a[104:107], a[0:3]
ds_read_b64_tr_b16 a[26:27], v15 offset:34312
v_mfma_f32_16x16x32_bf16 a[0:3], a[36:39], a[116:119], a[0:3]
s_waitcnt lgkmcnt(6)
buffer_load_dwordx4 v1, s[24:27], s50 offen offset:1056 nt lds
v_mfma_f32_16x16x32_bf16 a[12:15], a[44:47], a[116:119], a[12:15]
ds_read_b64_tr_b16 a[28:29], v72 offset:33800
v_mfma_f32_16x16x32_bf16 a[12:15], a[40:43], a[104:107], a[12:15]
ds_read_b64_tr_b16 a[30:31], v72 offset:34312
v_mfma_f32_16x16x32_bf16 a[8:11], a[40:43], a[100:103], a[8:11]
buffer_load_dwordx4 v2, s[24:27], s50 offen offset:2112 nt lds
v_mfma_f32_16x16x32_bf16 a[8:11], a[44:47], a[112:115], a[8:11]
ds_read_b64_tr_b16 a[32:33], v15 offset:33856
v_mfma_f32_16x16x32_bf16 a[4:7], a[44:47], a[108:111], a[4:7]
ds_read_b64_tr_b16 a[34:35], v15 offset:34368
v_mfma_f32_16x16x32_bf16 a[4:7], a[40:43], a[96:99], a[4:7]
s_waitcnt lgkmcnt(6)
buffer_load_dwordx4 v3, s[24:27], s50 offen offset:3168 nt lds
LS_54:
v_mfma_f32_16x16x32_bf16 v[76:79], a[16:19], v[16:19], v[76:79]
ds_read_b64_tr_b16 a[36:37], v72 offset:33856
v_mfma_f32_16x16x32_bf16 v[76:79], a[20:23], v[28:31], v[76:79]
ds_read_b64_tr_b16 a[38:39], v72 offset:34368
v_mfma_f32_16x16x32_bf16 v[80:83], a[20:23], v[32:35], v[80:83]
s_cmp_ge_u32 s87, 3
s_cselect_b32 s56, 3, 0
s_cselect_b32 s6, 64, 0
v_mfma_f32_16x16x32_bf16 v[80:83], a[16:19], v[20:23], v[80:83]
ds_read_b64_tr_b16 a[40:41], v15 offset:33864
s_sub_u32 s56, s87, s56
v_mfma_f32_16x16x32_bf16 v[84:87], a[16:19], v[24:27], v[84:87]
ds_read_b64_tr_b16 a[42:43], v15 offset:34376
s_mul_i32 s56, s56, 14336
v_mfma_f32_16x16x32_bf16 v[84:87], a[20:23], v[36:39], v[84:87]
s_waitcnt lgkmcnt(6)
s_add_u32 s56, s56, s13
v_mfma_f32_16x16x32_bf16 v[96:99], a[28:31], v[36:39], v[96:99]
ds_read_b64_tr_b16 a[44:45], v72 offset:33864
s_add_u32 s6, s6, s56
v_mfma_f32_16x16x32_bf16 v[96:99], a[24:27], v[24:27], v[96:99]
ds_read_b64_tr_b16 a[46:47], v72 offset:34376
v_mfma_f32_16x16x32_bf16 v[92:95], a[24:27], v[20:23], v[92:95]
s_cmp_lt_u32 s87, 6
s_cselect_b32 s18, s18, 268435456
s_cselect_b32 s6, s6, 268435456
v_mfma_f32_16x16x32_bf16 v[92:95], a[28:31], v[32:35], v[92:95]
ds_read_b64_tr_b16 a[16:17], v15 offset:33920
s_add_u32 s99, s44, s13
v_mfma_f32_16x16x32_bf16 v[88:91], a[28:31], v[28:31], v[88:91]
ds_read_b64_tr_b16 a[18:19], v15 offset:34432
s_add_u32 s13, s13, 128
v_mfma_f32_16x16x32_bf16 v[88:91], a[24:27], v[16:19], v[88:91]
s_waitcnt lgkmcnt(6)
v_mfma_f32_16x16x32_bf16 v[100:103], a[32:35], v[16:19], v[100:103]
ds_read_b64_tr_b16 a[20:21], v72 offset:33920
v_mfma_f32_16x16x32_bf16 v[100:103], a[36:39], v[28:31], v[100:103]
ds_read_b64_tr_b16 a[22:23], v72 offset:34432
v_mfma_f32_16x16x32_bf16 v[104:107], a[36:39], v[32:35], v[104:107]
s_cmp_eq_u32 s13, 896
s_cselect_b32 s13, 0, s13
v_mfma_f32_16x16x32_bf16 v[104:107], a[32:35], v[20:23], v[104:107]
ds_read_b64_tr_b16 a[24:25], v15 offset:33928
s_add_u32 s87, s49, 1
v_mfma_f32_16x16x32_bf16 v[108:111], a[32:35], v[24:27], v[108:111]
ds_read_b64_tr_b16 a[26:27], v15 offset:34440
s_and_b32 s87, s87, 7
v_mfma_f32_16x16x32_bf16 v[108:111], a[36:39], v[36:39], v[108:111]
s_waitcnt lgkmcnt(6)
s_lshl_b32 s19, s87, 10
v_mfma_f32_16x16x32_bf16 v[120:123], a[44:47], v[36:39], v[120:123]
ds_read_b64_tr_b16 a[28:29], v72 offset:33928
s_add_u32 s19, s19, 6144
v_mfma_f32_16x16x32_bf16 v[120:123], a[40:43], v[24:27], v[120:123]
ds_read_b64_tr_b16 a[30:31], v72 offset:34440
v_mfma_f32_16x16x32_bf16 v[116:119], a[40:43], v[20:23], v[116:119]
s_barrier
v_mfma_f32_16x16x32_bf16 v[116:119], a[44:47], v[32:35], v[116:119]
ds_read_b64_tr_b16 a[32:33], v15 offset:33984
v_mfma_f32_16x16x32_bf16 v[112:115], a[44:47], v[28:31], v[112:115]
ds_read_b64_tr_b16 a[34:35], v15 offset:34496
v_mfma_f32_16x16x32_bf16 v[112:115], a[40:43], v[16:19], v[112:115]
s_waitcnt lgkmcnt(6)
v_mfma_f32_16x16x32_bf16 v[124:127], a[16:19], v[16:19], v[124:127]
ds_read_b64_tr_b16 a[36:37], v72 offset:33984
v_mfma_f32_16x16x32_bf16 v[124:127], a[20:23], v[28:31], v[124:127]
ds_read_b64_tr_b16 a[38:39], v72 offset:34496
v_mfma_f32_16x16x32_bf16 v[128:131], a[20:23], v[32:35], v[128:131]
s_add_u32 m0, s17, 84480
s_add_u32 s50, s58, 512
v_mfma_f32_16x16x32_bf16 v[128:131], a[16:19], v[20:23], v[128:131]
ds_read_b64_tr_b16 a[40:41], v15 offset:33992
v_mfma_f32_16x16x32_bf16 v[132:135], a[16:19], v[24:27], v[132:135]
ds_read_b64_tr_b16 a[42:43], v15 offset:34504
v_mfma_f32_16x16x32_bf16 v[132:135], a[20:23], v[36:39], v[132:135]
s_waitcnt lgkmcnt(6)
v_mfma_f32_16x16x32_bf16 v[144:147], a[28:31], v[36:39], v[144:147]
ds_read_b64_tr_b16 a[44:45], v72 offset:33992
v_mfma_f32_16x16x32_bf16 v[144:147], a[24:27], v[24:27], v[144:147]
ds_read_b64_tr_b16 a[46:47], v72 offset:34504
v_mfma_f32_16x16x32_bf16 v[140:143], a[24:27], v[20:23], v[140:143]
buffer_load_dwordx4 v4, s[28:31], s50 offen offset:0 lds
v_mfma_f32_16x16x32_bf16 v[140:143], a[28:31], v[32:35], v[140:143]
ds_read_b64_tr_b16 a[16:17], v15 offset:34048
v_mfma_f32_16x16x32_bf16 v[136:139], a[28:31], v[28:31], v[136:139]
ds_read_b64_tr_b16 a[18:19], v15 offset:34560
v_mfma_f32_16x16x32_bf16 v[136:139], a[24:27], v[16:19], v[136:139]
s_waitcnt lgkmcnt(6)
v_mfma_f32_16x16x32_bf16 v[148:151], a[32:35], v[16:19], v[148:151]
ds_read_b64_tr_b16 a[20:21], v72 offset:34048
v_mfma_f32_16x16x32_bf16 v[148:151], a[36:39], v[28:31], v[148:151]
ds_read_b64_tr_b16 a[22:23], v72 offset:34560
v_mfma_f32_16x16x32_bf16 v[152:155], a[36:39], v[32:35], v[152:155]
buffer_load_dwordx4 v5, s[28:31], s50 offen offset:1056 lds
v_mfma_f32_16x16x32_bf16 v[152:155], a[32:35], v[20:23], v[152:155]
ds_read_b64_tr_b16 a[24:25], v15 offset:34056
v_mfma_f32_16x16x32_bf16 v[156:159], a[32:35], v[24:27], v[156:159]
ds_read_b64_tr_b16 a[26:27], v15 offset:34568
v_mfma_f32_16x16x32_bf16 v[156:159], a[36:39], v[36:39], v[156:159]
s_waitcnt lgkmcnt(6)
v_mfma_f32_16x16x32_bf16 v[168:171], a[44:47], v[36:39], v[168:171]
ds_read_b64_tr_b16 a[28:29], v72 offset:34056
v_mfma_f32_16x16x32_bf16 v[168:171], a[40:43], v[24:27], v[168:171]
ds_read_b64_tr_b16 a[30:31], v72 offset:34568
v_mfma_f32_16x16x32_bf16 v[164:167], a[40:43], v[20:23], v[164:167]
buffer_load_dwordx4 v6, s[28:31], s50 offen offset:2112 lds
v_mfma_f32_16x16x32_bf16 v[164:167], a[44:47], v[32:35], v[164:167]
ds_read_b64_tr_b16 a[32:33], v15 offset:34112
v_mfma_f32_16x16x32_bf16 v[160:163], a[44:47], v[28:31], v[160:163]
ds_read_b64_tr_b16 a[34:35], v15 offset:34624
v_mfma_f32_16x16x32_bf16 v[160:163], a[40:43], v[16:19], v[160:163]
s_waitcnt lgkmcnt(6)
buffer_load_dwordx4 v7, s[28:31], s50 offen offset:3168 lds
LS_55:
v_mfma_f32_16x16x32_bf16 v[172:175], a[16:19], v[16:19], v[172:175]
ds_read_b64_tr_b16 a[36:37], v72 offset:34112
v_mfma_f32_16x16x32_bf16 v[172:175], a[20:23], v[28:31], v[172:175]
ds_read_b64_tr_b16 a[38:39], v72 offset:34624
v_mfma_f32_16x16x32_bf16 v[176:179], a[20:23], v[32:35], v[176:179]
s_add_u32 m0, s17, 101376
s_add_u32 s50, s58, 262656
v_mfma_f32_16x16x32_bf16 v[176:179], a[16:19], v[20:23], v[176:179]
ds_read_b64_tr_b16 a[40:41], v15 offset:34120
v_mfma_f32_16x16x32_bf16 v[180:183], a[16:19], v[24:27], v[180:183]
ds_read_b64_tr_b16 a[42:43], v15 offset:34632
v_mfma_f32_16x16x32_bf16 v[180:183], a[20:23], v[36:39], v[180:183]
s_waitcnt lgkmcnt(6)
v_mfma_f32_16x16x32_bf16 v[192:195], a[28:31], v[36:39], v[192:195]
ds_read_b64_tr_b16 a[44:45], v72 offset:34120
v_mfma_f32_16x16x32_bf16 v[192:195], a[24:27], v[24:27], v[192:195]
ds_read_b64_tr_b16 a[46:47], v72 offset:34632
v_mfma_f32_16x16x32_bf16 v[188:191], a[24:27], v[20:23], v[188:191]
buffer_load_dwordx4 v4, s[28:31], s50 offen offset:0 lds
v_mfma_f32_16x16x32_bf16 v[188:191], a[28:31], v[32:35], v[188:191]
ds_read_b64_tr_b16 a[16:17], v15 offset:34176
v_mfma_f32_16x16x32_bf16 v[184:187], a[28:31], v[28:31], v[184:187]
ds_read_b64_tr_b16 a[18:19], v15 offset:34688
v_mfma_f32_16x16x32_bf16 v[184:187], a[24:27], v[16:19], v[184:187]
s_waitcnt lgkmcnt(6)
v_mfma_f32_16x16x32_bf16 v[196:199], a[32:35], v[16:19], v[196:199]
ds_read_b64_tr_b16 a[20:21], v72 offset:34176
v_mfma_f32_16x16x32_bf16 v[196:199], a[36:39], v[28:31], v[196:199]
ds_read_b64_tr_b16 a[22:23], v72 offset:34688
v_mfma_f32_16x16x32_bf16 v[200:203], a[36:39], v[32:35], v[200:203]
buffer_load_dwordx4 v5, s[28:31], s50 offen offset:1056 lds
v_mfma_f32_16x16x32_bf16 v[200:203], a[32:35], v[20:23], v[200:203]
ds_read_b64_tr_b16 a[24:25], v15 offset:34184
v_mfma_f32_16x16x32_bf16 v[204:207], a[32:35], v[24:27], v[204:207]
ds_read_b64_tr_b16 a[26:27], v15 offset:34696
v_mfma_f32_16x16x32_bf16 v[204:207], a[36:39], v[36:39], v[204:207]
s_waitcnt lgkmcnt(6)
v_mfma_f32_16x16x32_bf16 v[216:219], a[44:47], v[36:39], v[216:219]
ds_read_b64_tr_b16 a[28:29], v72 offset:34184
v_mfma_f32_16x16x32_bf16 v[216:219], a[40:43], v[24:27], v[216:219]
ds_read_b64_tr_b16 a[30:31], v72 offset:34696
v_mfma_f32_16x16x32_bf16 v[212:215], a[40:43], v[20:23], v[212:215]
s_waitcnt vmcnt(10)
s_barrier
v_mfma_f32_16x16x32_bf16 v[212:215], a[44:47], v[32:35], v[212:215]
ds_read_b64_tr_b16 a[32:33], v15 offset:34240
v_mfma_f32_16x16x32_bf16 v[208:211], a[44:47], v[28:31], v[208:211]
ds_read_b64_tr_b16 a[34:35], v15 offset:34752
v_mfma_f32_16x16x32_bf16 v[208:211], a[40:43], v[16:19], v[208:211]
s_waitcnt lgkmcnt(6)
v_mfma_f32_16x16x32_bf16 v[220:223], a[16:19], v[16:19], v[220:223]
ds_read_b64_tr_b16 a[36:37], v72 offset:34240
v_mfma_f32_16x16x32_bf16 v[220:223], a[20:23], v[28:31], v[220:223]
ds_read_b64_tr_b16 a[38:39], v72 offset:34752
v_mfma_f32_16x16x32_bf16 v[224:227], a[20:23], v[32:35], v[224:227]
buffer_load_dwordx4 v6, s[28:31], s50 offen offset:2112 lds
v_mfma_f32_16x16x32_bf16 v[224:227], a[16:19], v[20:23], v[224:227]
ds_read_b64_tr_b16 a[40:41], v15 offset:34248
v_mfma_f32_16x16x32_bf16 v[228:231], a[16:19], v[24:27], v[228:231]
ds_read_b64_tr_b16 a[42:43], v15 offset:34760
v_mfma_f32_16x16x32_bf16 v[228:231], a[20:23], v[36:39], v[228:231]
s_waitcnt lgkmcnt(6)
v_mfma_f32_16x16x32_bf16 v[240:243], a[28:31], v[36:39], v[240:243]
ds_read_b64_tr_b16 a[44:45], v72 offset:34248
v_mfma_f32_16x16x32_bf16 v[240:243], a[24:27], v[24:27], v[240:243]
ds_read_b64_tr_b16 a[46:47], v72 offset:34760
v_mfma_f32_16x16x32_bf16 v[236:239], a[24:27], v[20:23], v[236:239]
buffer_load_dwordx4 v7, s[28:31], s50 offen offset:3168 lds
v_mfma_f32_16x16x32_bf16 v[236:239], a[28:31], v[32:35], v[236:239]
v_subrev_u32 v15, 67584, v15
ds_read_b64_tr_b16 a[16:17], v15 offset:33792
v_mfma_f32_16x16x32_bf16 v[232:235], a[28:31], v[28:31], v[232:235]
ds_read_b64_tr_b16 a[18:19], v15 offset:34304
v_mfma_f32_16x16x32_bf16 v[232:235], a[24:27], v[16:19], v[232:235]
s_waitcnt lgkmcnt(6)
v_mfma_f32_16x16x32_bf16 v[244:247], a[32:35], v[16:19], v[244:247]
v_add_u32 v72, 67584, v72
ds_read_b64_tr_b16 a[20:21], v72 offset:0
v_mfma_f32_16x16x32_bf16 v[244:247], a[36:39], v[28:31], v[244:247]
ds_read_b64_tr_b16 a[22:23], v72 offset:512
v_mfma_f32_16x16x32_bf16 v[248:251], a[36:39], v[32:35], v[248:251]
s_cmp_ge_u32 s87, 3
s_cselect_b32 s56, 3, 0
s_cselect_b32 s7, 64, 0
v_mfma_f32_16x16x32_bf16 v[248:251], a[32:35], v[20:23], v[248:251]
ds_read_b64_tr_b16 a[24:25], v15 offset:33800
s_sub_u32 s56, s87, s56
v_mfma_f32_16x16x32_bf16 a[0:3], a[32:35], v[24:27], a[0:3]
ds_read_b64_tr_b16 a[26:27], v15 offset:34312
s_mul_i32 s56, s56, 14336
v_mfma_f32_16x16x32_bf16 a[0:3], a[36:39], v[36:39], a[0:3]
s_waitcnt lgkmcnt(6)
s_add_u32 s56, s56, s13
v_mfma_f32_16x16x32_bf16 a[12:15], a[44:47], v[36:39], a[12:15]
ds_read_b64_tr_b16 a[28:29], v72 offset:8
s_add_u32 s7, s7, s56
v_mfma_f32_16x16x32_bf16 a[12:15], a[40:43], v[24:27], a[12:15]
ds_read_b64_tr_b16 a[30:31], v72 offset:520
v_mfma_f32_16x16x32_bf16 a[8:11], a[40:43], v[20:23], a[8:11]
s_cmp_lt_u32 s87, 6
s_cselect_b32 s19, s19, 268435456
s_cselect_b32 s7, s7, 268435456
v_mfma_f32_16x16x32_bf16 a[8:11], a[44:47], v[32:35], a[8:11]
ds_read_b64_tr_b16 a[32:33], v15 offset:33856
s_add_u32 s100, s44, s13
v_mfma_f32_16x16x32_bf16 a[4:7], a[44:47], v[28:31], a[4:7]
ds_read_b64_tr_b16 a[34:35], v15 offset:34368
s_add_u32 s13, s13, 128
v_mfma_f32_16x16x32_bf16 a[4:7], a[40:43], v[16:19], a[4:7]
s_waitcnt lgkmcnt(6)
LS_56:
v_mfma_f32_16x16x32_bf16 v[76:79], a[16:19], v[40:43], v[76:79]
ds_read_b64_tr_b16 a[36:37], v72 offset:64
v_bfe_u32 v5, v252, 6, 3
v_mfma_f32_16x16x32_bf16 v[76:79], a[20:23], v[52:55], v[76:79]
ds_read_b64_tr_b16 a[38:39], v72 offset:576
v_mul_u32_u24 v4, 896, v5
v_mfma_f32_16x16x32_bf16 v[80:83], a[20:23], v[56:59], v[80:83]
s_cmp_eq_u32 s13, 896
s_cselect_b32 s13, 0, s13
v_mfma_f32_16x16x32_bf16 v[80:83], a[16:19], v[44:47], v[80:83]
ds_read_b64_tr_b16 a[40:41], v15 offset:33864
s_add_u32 s87, s49, 2
v_mfma_f32_16x16x32_bf16 v[84:87], a[16:19], v[48:51], v[84:87]
ds_read_b64_tr_b16 a[42:43], v15 offset:34376
s_and_b32 s87, s87, 7
v_mfma_f32_16x16x32_bf16 v[84:87], a[20:23], v[60:63], v[84:87]
s_waitcnt lgkmcnt(6)
s_lshl_b32 s84, s87, 10
v_mfma_f32_16x16x32_bf16 v[96:99], a[28:31], v[60:63], v[96:99]
ds_read_b64_tr_b16 a[44:45], v72 offset:72
s_add_u32 s84, s84, 12288
v_mfma_f32_16x16x32_bf16 v[96:99], a[24:27], v[48:51], v[96:99]
ds_read_b64_tr_b16 a[46:47], v72 offset:584
v_lshrrev_b32 v5, 2, v5
v_mfma_f32_16x16x32_bf16 v[92:95], a[24:27], v[44:47], v[92:95]
s_cmp_ge_u32 s87, 3
s_cselect_b32 s56, 3, 0
s_cselect_b32 s8, 64, 0
v_mfma_f32_16x16x32_bf16 v[92:95], a[28:31], v[56:59], v[92:95]
ds_read_b64_tr_b16 a[16:17], v15 offset:33920
s_sub_u32 s56, s87, s56
v_mfma_f32_16x16x32_bf16 v[88:91], a[28:31], v[52:55], v[88:91]
ds_read_b64_tr_b16 a[18:19], v15 offset:34432
s_mul_i32 s56, s56, 14336
v_mfma_f32_16x16x32_bf16 v[88:91], a[24:27], v[40:43], v[88:91]
s_waitcnt lgkmcnt(6)
s_add_u32 s56, s56, s13
v_mfma_f32_16x16x32_bf16 v[100:103], a[32:35], v[40:43], v[100:103]
ds_read_b64_tr_b16 a[20:21], v72 offset:128
s_add_u32 s8, s8, s56
v_mfma_f32_16x16x32_bf16 v[100:103], a[36:39], v[52:55], v[100:103]
ds_read_b64_tr_b16 a[22:23], v72 offset:640
v_lshlrev_b32 v5, 5, v5
v_mfma_f32_16x16x32_bf16 v[104:107], a[36:39], v[56:59], v[104:107]
s_cmp_lt_u32 s87, 6
s_cselect_b32 s84, s84, 268435456
s_cselect_b32 s8, s8, 268435456
v_mfma_f32_16x16x32_bf16 v[104:107], a[32:35], v[44:47], v[104:107]
ds_read_b64_tr_b16 a[24:25], v15 offset:33928
v_and_b32 v6, 48, v252
v_mfma_f32_16x16x32_bf16 v[108:111], a[32:35], v[48:51], v[108:111]
ds_read_b64_tr_b16 a[26:27], v15 offset:34440
s_add_u32 s101, s44, s13
v_mfma_f32_16x16x32_bf16 v[108:111], a[36:39], v[60:63], v[108:111]
s_waitcnt lgkmcnt(6)
v_xor_b32 v5, v5, v6
v_mfma_f32_16x16x32_bf16 v[120:123], a[44:47], v[60:63], v[120:123]
ds_read_b64_tr_b16 a[28:29], v72 offset:136
s_add_u32 s13, s13, 128
v_mfma_f32_16x16x32_bf16 v[120:123], a[40:43], v[48:51], v[120:123]
ds_read_b64_tr_b16 a[30:31], v72 offset:648
v_add3_u32 v4, v4, v5, s86
v_mfma_f32_16x16x32_bf16 v[116:119], a[40:43], v[44:47], v[116:119]
s_barrier
v_lshrrev_b32 v5, 9, v252
v_mfma_f32_16x16x32_bf16 v[116:119], a[44:47], v[56:59], v[116:119]
ds_read_b64_tr_b16 a[32:33], v15 offset:33984
v_lshl_add_u32 v4, v5, 6, v4
v_mfma_f32_16x16x32_bf16 v[112:115], a[44:47], v[52:55], v[112:115]
ds_read_b64_tr_b16 a[34:35], v15 offset:34496
v_add_u32 v5, 6112, v4
v_mfma_f32_16x16x32_bf16 v[112:115], a[40:43], v[40:43], v[112:115]
s_waitcnt lgkmcnt(6)
v_add_u32 v6, 12224, v4
v_mfma_f32_16x16x32_bf16 v[124:127], a[16:19], v[40:43], v[124:127]
ds_read_b64_tr_b16 a[36:37], v72 offset:192
v_add_u32 v7, 18336, v4
v_mfma_f32_16x16x32_bf16 v[124:127], a[20:23], v[52:55], v[124:127]
ds_read_b64_tr_b16 a[38:39], v72 offset:704
v_mfma_f32_16x16x32_bf16 v[128:131], a[20:23], v[56:59], v[128:131]
s_add_u32 m0, s17, 33792
s_mov_b32 s50, 278528
v_mfma_f32_16x16x32_bf16 v[128:131], a[16:19], v[44:47], v[128:131]
ds_read_b64_tr_b16 a[40:41], v15 offset:33992
v_mfma_f32_16x16x32_bf16 v[132:135], a[16:19], v[48:51], v[132:135]
ds_read_b64_tr_b16 a[42:43], v15 offset:34504
v_mfma_f32_16x16x32_bf16 v[132:135], a[20:23], v[60:63], v[132:135]
s_waitcnt lgkmcnt(6)
v_mfma_f32_16x16x32_bf16 v[144:147], a[28:31], v[60:63], v[144:147]
ds_read_b64_tr_b16 a[44:45], v72 offset:200
v_mfma_f32_16x16x32_bf16 v[144:147], a[24:27], v[48:51], v[144:147]
ds_read_b64_tr_b16 a[46:47], v72 offset:712
v_mfma_f32_16x16x32_bf16 v[140:143], a[24:27], v[44:47], v[140:143]
buffer_load_dwordx4 v0, s[20:23], s50 offen offset:0 nt lds
v_mfma_f32_16x16x32_bf16 v[140:143], a[28:31], v[56:59], v[140:143]
ds_read_b64_tr_b16 a[16:17], v15 offset:34048
s_lshr_b32 s4, s2, 3
s_lshl_b32 s4, s4, 2
v_mfma_f32_16x16x32_bf16 v[136:139], a[28:31], v[52:55], v[136:139]
ds_read_b64_tr_b16 a[18:19], v15 offset:34560
s_add_u32 s4, s4, s16
s_lshl_b32 s4, s4, 7
v_mfma_f32_16x16x32_bf16 v[136:139], a[24:27], v[40:43], v[136:139]
s_waitcnt lgkmcnt(6)
v_mfma_f32_16x16x32_bf16 v[148:151], a[32:35], v[40:43], v[148:151]
ds_read_b64_tr_b16 a[20:21], v72 offset:256
buffer_load_dwordx4 v1, s[20:23], s50 offen offset:1056 nt lds
v_mfma_f32_16x16x32_bf16 v[148:151], a[36:39], v[52:55], v[148:151]
ds_read_b64_tr_b16 a[22:23], v72 offset:768
s_cmp_eq_u32 s13, 896
s_cselect_b32 s13, 0, s13
v_mfma_f32_16x16x32_bf16 v[152:155], a[36:39], v[56:59], v[152:155]
s_add_u32 s4, s4, 0xd95c
s_mov_b32 s5, L_code_end-L_pc-4
v_mfma_f32_16x16x32_bf16 v[152:155], a[32:35], v[44:47], v[152:155]
ds_read_b64_tr_b16 a[24:25], v15 offset:34056
buffer_load_dwordx4 v2, s[20:23], s50 offen offset:2112 nt lds
v_mfma_f32_16x16x32_bf16 v[156:159], a[32:35], v[48:51], v[156:159]
ds_read_b64_tr_b16 a[26:27], v15 offset:34568
s_add_u32 s87, s49, 3
v_mfma_f32_16x16x32_bf16 v[156:159], a[36:39], v[60:63], v[156:159]
s_waitcnt lgkmcnt(6)
v_lshlrev_b32 v68, 10, v252
v_mfma_f32_16x16x32_bf16 v[168:171], a[44:47], v[60:63], v[168:171]
ds_read_b64_tr_b16 a[28:29], v72 offset:264
s_and_b32 s87, s87, 7
v_add_u32 v68, s4, v68
v_mfma_f32_16x16x32_bf16 v[168:171], a[40:43], v[48:51], v[168:171]
ds_read_b64_tr_b16 a[30:31], v72 offset:776
s_lshl_b32 s85, s87, 10
v_mfma_f32_16x16x32_bf16 v[164:167], a[40:43], v[44:47], v[164:167]
v_min_u32 v68, s5, v68
s_add_u32 s85, s85, 18432
v_mfma_f32_16x16x32_bf16 v[164:167], a[44:47], v[56:59], v[164:167]
ds_read_b64_tr_b16 a[32:33], v15 offset:34112
buffer_load_dwordx4 v3, s[20:23], s50 offen offset:3168 nt lds
v_mfma_f32_16x16x32_bf16 v[160:163], a[44:47], v[52:55], v[160:163]
ds_read_b64_tr_b16 a[34:35], v15 offset:34624
global_load_dword a255, v68, s[66:67]
v_mfma_f32_16x16x32_bf16 v[160:163], a[40:43], v[40:43], v[160:163]
s_waitcnt lgkmcnt(6)
LS_57:
v_mfma_f32_16x16x32_bf16 v[172:175], a[16:19], v[40:43], v[172:175]
ds_read_b64_tr_b16 a[36:37], v72 offset:320
s_cmp_ge_u32 s87, 3
s_cselect_b32 s56, 3, 0
s_cselect_b32 s9, 64, 0
v_mfma_f32_16x16x32_bf16 v[172:175], a[20:23], v[52:55], v[172:175]
ds_read_b64_tr_b16 a[38:39], v72 offset:832
s_sub_u32 s56, s87, s56
v_mfma_f32_16x16x32_bf16 v[176:179], a[20:23], v[56:59], v[176:179]
s_mul_i32 s56, s56, 14336
s_add_u32 m0, s17, 118272
s_mov_b32 s50, 270336
v_mfma_f32_16x16x32_bf16 v[176:179], a[16:19], v[44:47], v[176:179]
ds_read_b64_tr_b16 a[40:41], v15 offset:34120
s_add_u32 s56, s56, s13
v_mfma_f32_16x16x32_bf16 v[180:183], a[16:19], v[48:51], v[180:183]
ds_read_b64_tr_b16 a[42:43], v15 offset:34632
s_add_u32 s9, s9, s56
v_mfma_f32_16x16x32_bf16 v[180:183], a[20:23], v[60:63], v[180:183]
s_waitcnt lgkmcnt(6)
s_cmp_lt_u32 s87, 6
s_cselect_b32 s85, s85, 268435456
s_cselect_b32 s9, s9, 268435456
v_mfma_f32_16x16x32_bf16 v[192:195], a[28:31], v[60:63], v[192:195]
ds_read_b64_tr_b16 a[44:45], v72 offset:328
s_add_u32 s45, s44, s13
v_mfma_f32_16x16x32_bf16 v[192:195], a[24:27], v[48:51], v[192:195]
ds_read_b64_tr_b16 a[46:47], v72 offset:840
s_add_u32 s13, s13, 128
v_mfma_f32_16x16x32_bf16 v[188:191], a[24:27], v[44:47], v[188:191]
s_cmp_eq_u32 s13, 896
s_cselect_b32 s13, 0, s13
v_mfma_f32_16x16x32_bf16 v[188:191], a[28:31], v[56:59], v[188:191]
ds_read_b64_tr_b16 a[16:17], v15 offset:34176
s_add_u32 s87, s49, 4
v_mfma_f32_16x16x32_bf16 v[184:187], a[28:31], v[52:55], v[184:187]
ds_read_b64_tr_b16 a[18:19], v15 offset:34688
s_and_b32 s87, s87, 7
v_mfma_f32_16x16x32_bf16 v[184:187], a[24:27], v[40:43], v[184:187]
s_waitcnt lgkmcnt(6)
s_lshl_b32 s96, s87, 10
v_mfma_f32_16x16x32_bf16 v[196:199], a[32:35], v[40:43], v[196:199]
ds_read_b64_tr_b16 a[20:21], v72 offset:384
s_add_u32 s96, s96, 24576
v_mfma_f32_16x16x32_bf16 v[196:199], a[36:39], v[52:55], v[196:199]
ds_read_b64_tr_b16 a[22:23], v72 offset:896
s_cmp_ge_u32 s87, 3
s_cselect_b32 s56, 3, 0
s_cselect_b32 s10, 64, 0
v_mfma_f32_16x16x32_bf16 v[200:203], a[36:39], v[56:59], v[200:203]
s_sub_u32 s56, s87, s56
buffer_load_dwordx4 v0, s[24:27], s50 offen offset:0 nt lds
v_mfma_f32_16x16x32_bf16 v[200:203], a[32:35], v[44:47], v[200:203]
ds_read_b64_tr_b16 a[24:25], v15 offset:34184
s_mul_i32 s56, s56, 14336
v_mfma_f32_16x16x32_bf16 v[204:207], a[32:35], v[48:51], v[204:207]
ds_read_b64_tr_b16 a[26:27], v15 offset:34696
s_add_u32 s56, s56, s13
v_mfma_f32_16x16x32_bf16 v[204:207], a[36:39], v[60:63], v[204:207]
s_waitcnt lgkmcnt(6)
s_add_u32 s10, s10, s56
v_mfma_f32_16x16x32_bf16 v[216:219], a[44:47], v[60:63], v[216:219]
ds_read_b64_tr_b16 a[28:29], v72 offset:392
s_cmp_lt_u32 s87, 6
s_cselect_b32 s96, s96, 268435456
s_cselect_b32 s10, s10, 268435456
v_mfma_f32_16x16x32_bf16 v[216:219], a[40:43], v[48:51], v[216:219]
ds_read_b64_tr_b16 a[30:31], v72 offset:904
s_add_u32 s46, s44, s13
v_mfma_f32_16x16x32_bf16 v[212:215], a[40:43], v[44:47], v[212:215]
s_add_u32 s13, s13, 128
s_waitcnt vmcnt(6)
s_barrier
v_mfma_f32_16x16x32_bf16 v[212:215], a[44:47], v[56:59], v[212:215]
ds_read_b64_tr_b16 a[32:33], v15 offset:34240
s_cmp_eq_u32 s13, 896
s_cselect_b32 s13, 0, s13
v_mfma_f32_16x16x32_bf16 v[208:211], a[44:47], v[52:55], v[208:211]
ds_read_b64_tr_b16 a[34:35], v15 offset:34752
s_add_u32 s87, s49, 5
v_mfma_f32_16x16x32_bf16 v[208:211], a[40:43], v[40:43], v[208:211]
s_waitcnt lgkmcnt(6)
s_and_b32 s87, s87, 7
v_mfma_f32_16x16x32_bf16 v[220:223], a[16:19], v[40:43], v[220:223]
ds_read_b64_tr_b16 a[36:37], v72 offset:448
s_lshl_b32 s97, s87, 10
v_mfma_f32_16x16x32_bf16 v[220:223], a[20:23], v[52:55], v[220:223]
ds_read_b64_tr_b16 a[38:39], v72 offset:960
s_add_u32 s97, s97, 30720
v_mfma_f32_16x16x32_bf16 v[224:227], a[20:23], v[56:59], v[224:227]
s_cmp_ge_u32 s87, 3
s_cselect_b32 s56, 3, 0
s_cselect_b32 s11, 64, 0
v_mfma_f32_16x16x32_bf16 v[224:227], a[16:19], v[44:47], v[224:227]
ds_read_b64_tr_b16 a[40:41], v15 offset:34248
s_sub_u32 s56, s87, s56
v_mfma_f32_16x16x32_bf16 v[228:231], a[16:19], v[48:51], v[228:231]
ds_read_b64_tr_b16 a[42:43], v15 offset:34760
s_mul_i32 s56, s56, 14336
v_mfma_f32_16x16x32_bf16 v[228:231], a[20:23], v[60:63], v[228:231]
s_waitcnt lgkmcnt(6)
s_add_u32 s56, s56, s13
v_mfma_f32_16x16x32_bf16 v[240:243], a[28:31], v[60:63], v[240:243]
ds_read_b64_tr_b16 a[44:45], v72 offset:456
s_add_u32 s11, s11, s56
v_mfma_f32_16x16x32_bf16 v[240:243], a[24:27], v[48:51], v[240:243]
ds_read_b64_tr_b16 a[46:47], v72 offset:968
s_cmp_lt_u32 s87, 6
s_cselect_b32 s97, s97, 268435456
s_cselect_b32 s11, s11, 268435456
v_mfma_f32_16x16x32_bf16 v[236:239], a[24:27], v[44:47], v[236:239]
s_add_u32 s57, s44, s13
buffer_load_dwordx4 v1, s[24:27], s50 offen offset:1056 nt lds
v_mfma_f32_16x16x32_bf16 v[236:239], a[28:31], v[56:59], v[236:239]
v_add_u32 v15, 67584, v15
ds_read_b64_tr_b16 a[16:17], v15 offset:0
s_add_u32 s13, s13, 128
v_mfma_f32_16x16x32_bf16 v[232:235], a[28:31], v[52:55], v[232:235]
ds_read_b64_tr_b16 a[18:19], v15 offset:512
s_cmp_eq_u32 s13, 896
s_cselect_b32 s13, 0, s13
v_mfma_f32_16x16x32_bf16 v[232:235], a[24:27], v[40:43], v[232:235]
s_waitcnt lgkmcnt(6)
s_add_u32 s87, s49, 6
v_mfma_f32_16x16x32_bf16 v[244:247], a[32:35], v[40:43], v[244:247]
ds_read_b64_tr_b16 a[20:21], v72 offset:33792
s_and_b32 s87, s87, 7
v_mfma_f32_16x16x32_bf16 v[244:247], a[36:39], v[52:55], v[244:247]
ds_read_b64_tr_b16 a[22:23], v72 offset:34304
s_lshl_b32 s98, s87, 10
v_mfma_f32_16x16x32_bf16 v[248:251], a[36:39], v[56:59], v[248:251]
s_add_u32 s98, s98, 36864
buffer_load_dwordx4 v2, s[24:27], s50 offen offset:2112 nt lds
v_mfma_f32_16x16x32_bf16 v[248:251], a[32:35], v[44:47], v[248:251]
ds_read_b64_tr_b16 a[24:25], v15 offset:8
s_cmp_ge_u32 s87, 3
s_cselect_b32 s56, 3, 0
s_cselect_b32 s12, 64, 0
v_mfma_f32_16x16x32_bf16 a[0:3], a[32:35], v[48:51], a[0:3]
ds_read_b64_tr_b16 a[26:27], v15 offset:520
s_sub_u32 s56, s87, s56
v_mfma_f32_16x16x32_bf16 a[0:3], a[36:39], v[60:63], a[0:3]
s_waitcnt lgkmcnt(6)
s_mul_i32 s56, s56, 14336
v_mfma_f32_16x16x32_bf16 a[12:15], a[44:47], v[60:63], a[12:15]
ds_read_b64_tr_b16 a[28:29], v72 offset:33800
s_add_u32 s56, s56, s13
v_mfma_f32_16x16x32_bf16 a[12:15], a[40:43], v[48:51], a[12:15]
ds_read_b64_tr_b16 a[30:31], v72 offset:34312
s_add_u32 s12, s12, s56
v_mfma_f32_16x16x32_bf16 a[8:11], a[40:43], v[44:47], a[8:11]
s_cmp_lt_u32 s87, 6
s_cselect_b32 s98, s98, 268435456
s_cselect_b32 s12, s12, 268435456
v_mfma_f32_16x16x32_bf16 a[8:11], a[44:47], v[56:59], a[8:11]
ds_read_b64_tr_b16 a[32:33], v15 offset:64
s_add_u32 s58, s44, s13
v_mfma_f32_16x16x32_bf16 a[4:7], a[44:47], v[52:55], a[4:7]
ds_read_b64_tr_b16 a[34:35], v15 offset:576
s_add_u32 s13, s13, 128
buffer_load_dwordx4 v3, s[24:27], s50 offen offset:3168 nt lds
v_mfma_f32_16x16x32_bf16 a[4:7], a[40:43], v[40:43], a[4:7]
s_waitcnt lgkmcnt(6)
s_cmp_eq_u32 s13, 896
s_cselect_b32 s13, 0, s13
LS_58:
v_mfma_f32_16x16x32_bf16 v[76:79], a[16:19], a[120:123], v[76:79]
ds_read_b64_tr_b16 a[36:37], v72 offset:33856
v_mfma_f32_16x16x32_bf16 v[76:79], a[20:23], a[132:135], v[76:79]
ds_read_b64_tr_b16 a[38:39], v72 offset:34368
v_mfma_f32_16x16x32_bf16 v[80:83], a[20:23], a[136:139], v[80:83]
v_mfma_f32_16x16x32_bf16 v[80:83], a[16:19], a[124:127], v[80:83]
ds_read_b64_tr_b16 a[40:41], v15 offset:72
v_mfma_f32_16x16x32_bf16 v[84:87], a[16:19], a[128:131], v[84:87]
ds_read_b64_tr_b16 a[42:43], v15 offset:584
s_nop 1
v_mul_f32 v76, s48, v76
v_mfma_f32_16x16x32_bf16 v[84:87], a[20:23], a[140:143], v[84:87]
s_waitcnt lgkmcnt(6)
v_mul_f32 v77, s48, v77
v_mfma_f32_16x16x32_bf16 v[96:99], a[28:31], a[140:143], v[96:99]
ds_read_b64_tr_b16 a[44:45], v72 offset:33864
v_mul_f32 v78, s48, v78
v_mfma_f32_16x16x32_bf16 v[96:99], a[24:27], a[128:131], v[96:99]
ds_read_b64_tr_b16 a[46:47], v72 offset:34376
v_mul_f32 v79, s48, v79
v_mfma_f32_16x16x32_bf16 v[92:95], a[24:27], a[124:127], v[92:95]
v_cvt_pk_bf16_f32 v16, v76, v77
v_cvt_pk_bf16_f32 v17, v78, v79
v_mfma_f32_16x16x32_bf16 v[92:95], a[28:31], a[136:139], v[92:95]
ds_read_b64_tr_b16 a[16:17], v15 offset:128
v_mul_f32 v80, s48, v80
v_mfma_f32_16x16x32_bf16 v[88:91], a[28:31], a[132:135], v[88:91]
ds_read_b64_tr_b16 a[18:19], v15 offset:640
v_mul_f32 v81, s48, v81
v_mfma_f32_16x16x32_bf16 v[88:91], a[24:27], a[120:123], v[88:91]
s_waitcnt lgkmcnt(6)
v_mul_f32 v82, s48, v82
v_mfma_f32_16x16x32_bf16 v[100:103], a[32:35], a[120:123], v[100:103]
ds_read_b64_tr_b16 a[20:21], v72 offset:33920
v_mul_f32 v83, s48, v83
v_mfma_f32_16x16x32_bf16 v[100:103], a[36:39], a[132:135], v[100:103]
ds_read_b64_tr_b16 a[22:23], v72 offset:34432
v_mul_f32 v92, s48, v92
v_mfma_f32_16x16x32_bf16 v[104:107], a[36:39], a[136:139], v[104:107]
v_mul_f32 v88, s48, v88
v_mul_f32 v89, s48, v89
v_mfma_f32_16x16x32_bf16 v[104:107], a[32:35], a[124:127], v[104:107]
ds_read_b64_tr_b16 a[24:25], v15 offset:136
v_mul_f32 v90, s48, v90
v_mfma_f32_16x16x32_bf16 v[108:111], a[32:35], a[128:131], v[108:111]
ds_read_b64_tr_b16 a[26:27], v15 offset:648
v_mul_f32 v91, s48, v91
v_mfma_f32_16x16x32_bf16 v[108:111], a[36:39], a[140:143], v[108:111]
s_waitcnt lgkmcnt(6)
v_mul_f32 v93, s48, v93
v_mfma_f32_16x16x32_bf16 v[120:123], a[44:47], a[140:143], v[120:123]
ds_read_b64_tr_b16 a[28:29], v72 offset:33928
v_mul_f32 v94, s48, v94
v_mfma_f32_16x16x32_bf16 v[120:123], a[40:43], a[128:131], v[120:123]
ds_read_b64_tr_b16 a[30:31], v72 offset:34440
v_mul_f32 v95, s48, v95
v_mfma_f32_16x16x32_bf16 v[116:119], a[40:43], a[124:127], v[116:119]
s_barrier
v_cvt_pk_bf16_f32 v18, v88, v89
v_mfma_f32_16x16x32_bf16 v[116:119], a[44:47], a[136:139], v[116:119]
ds_read_b64_tr_b16 a[32:33], v15 offset:192
v_cvt_pk_bf16_f32 v19, v90, v91
v_mfma_f32_16x16x32_bf16 v[112:115], a[44:47], a[132:135], v[112:115]
ds_read_b64_tr_b16 a[34:35], v15 offset:704
v_accvgpr_write_b32 a48, v16
v_mfma_f32_16x16x32_bf16 v[112:115], a[40:43], a[120:123], v[112:115]
s_waitcnt lgkmcnt(6)
v_accvgpr_write_b32 a49, v17
v_mfma_f32_16x16x32_bf16 v[124:127], a[16:19], a[120:123], v[124:127]
ds_read_b64_tr_b16 a[36:37], v72 offset:33984
v_cvt_pk_bf16_f32 v20, v80, v81
v_mfma_f32_16x16x32_bf16 v[124:127], a[20:23], a[132:135], v[124:127]
ds_read_b64_tr_b16 a[38:39], v72 offset:34496
v_cvt_pk_bf16_f32 v21, v82, v83
v_mfma_f32_16x16x32_bf16 v[128:131], a[20:23], a[136:139], v[128:131]
s_add_u32 m0, s17, 50688
s_mov_b32 s50, 286720
v_mfma_f32_16x16x32_bf16 v[128:131], a[16:19], a[124:127], v[128:131]
ds_read_b64_tr_b16 a[40:41], v15 offset:200
v_mul_f32 v84, s48, v84
v_mfma_f32_16x16x32_bf16 v[132:135], a[16:19], a[128:131], v[132:135]
ds_read_b64_tr_b16 a[42:43], v15 offset:712
v_mul_f32 v85, s48, v85
v_mfma_f32_16x16x32_bf16 v[132:135], a[20:23], a[140:143], v[132:135]
s_waitcnt lgkmcnt(6)
v_mul_f32 v86, s48, v86
v_mfma_f32_16x16x32_bf16 v[144:147], a[28:31], a[140:143], v[144:147]
ds_read_b64_tr_b16 a[44:45], v72 offset:33992
v_mul_f32 v87, s48, v87
v_mfma_f32_16x16x32_bf16 v[144:147], a[24:27], a[128:131], v[144:147]
ds_read_b64_tr_b16 a[46:47], v72 offset:34504
v_mul_f32 v96, s48, v96
v_mfma_f32_16x16x32_bf16 v[140:143], a[24:27], a[124:127], v[140:143]
buffer_load_dwordx4 v0, s[20:23], s50 offen offset:0 nt lds
v_mfma_f32_16x16x32_bf16 v[140:143], a[28:31], a[136:139], v[140:143]
ds_read_b64_tr_b16 a[16:17], v15 offset:256
v_mul_f32 v97, s48, v97
v_mfma_f32_16x16x32_bf16 v[136:139], a[28:31], a[132:135], v[136:139]
ds_read_b64_tr_b16 a[18:19], v15 offset:768
v_mul_f32 v98, s48, v98
v_mfma_f32_16x16x32_bf16 v[136:139], a[24:27], a[120:123], v[136:139]
s_waitcnt lgkmcnt(6)
v_mul_f32 v99, s48, v99
v_mfma_f32_16x16x32_bf16 v[148:151], a[32:35], a[120:123], v[148:151]
ds_read_b64_tr_b16 a[20:21], v72 offset:34048
v_cvt_pk_bf16_f32 v22, v92, v93
v_mfma_f32_16x16x32_bf16 v[148:151], a[36:39], a[132:135], v[148:151]
ds_read_b64_tr_b16 a[22:23], v72 offset:34560
v_cvt_pk_bf16_f32 v23, v94, v95
v_mfma_f32_16x16x32_bf16 v[152:155], a[36:39], a[136:139], v[152:155]
buffer_load_dwordx4 v1, s[20:23], s50 offen offset:1056 nt lds
v_mfma_f32_16x16x32_bf16 v[152:155], a[32:35], a[124:127], v[152:155]
ds_read_b64_tr_b16 a[24:25], v15 offset:264
v_accvgpr_write_b32 a50, v18
v_mfma_f32_16x16x32_bf16 v[156:159], a[32:35], a[128:131], v[156:159]
ds_read_b64_tr_b16 a[26:27], v15 offset:776
v_accvgpr_write_b32 a51, v19
v_mfma_f32_16x16x32_bf16 v[156:159], a[36:39], a[140:143], v[156:159]
s_waitcnt lgkmcnt(6)
v_accvgpr_write_b32 a52, v20
v_mfma_f32_16x16x32_bf16 v[168:171], a[44:47], a[140:143], v[168:171]
ds_read_b64_tr_b16 a[28:29], v72 offset:34056
buffer_load_dwordx4 v2, s[20:23], s50 offen offset:2112 nt lds
v_mfma_f32_16x16x32_bf16 v[168:171], a[40:43], a[128:131], v[168:171]
ds_read_b64_tr_b16 a[30:31], v72 offset:34568
v_accvgpr_write_b32 a53, v21
v_cvt_pk_bf16_f32 v24, v84, v85
v_mfma_f32_16x16x32_bf16 v[164:167], a[40:43], a[124:127], v[164:167]
v_cvt_pk_bf16_f32 v25, v86, v87
v_cvt_pk_bf16_f32 v26, v96, v97
v_cvt_pk_bf16_f32 v27, v98, v99
v_mfma_f32_16x16x32_bf16 v[164:167], a[44:47], a[136:139], v[164:167]
ds_read_b64_tr_b16 a[32:33], v15 offset:320
buffer_load_dwordx4 v3, s[20:23], s50 offen offset:3168 nt lds
v_mfma_f32_16x16x32_bf16 v[160:163], a[44:47], a[132:135], v[160:163]
ds_read_b64_tr_b16 a[34:35], v15 offset:832
v_accvgpr_write_b32 a54, v22
v_accvgpr_write_b32 a55, v23
v_mfma_f32_16x16x32_bf16 v[160:163], a[40:43], a[120:123], v[160:163]
s_waitcnt lgkmcnt(6)
v_accvgpr_write_b32 a56, v24
v_accvgpr_write_b32 a57, v25
LS_59:
v_mfma_f32_16x16x32_bf16 v[172:175], a[16:19], a[120:123], v[172:175]
ds_read_b64_tr_b16 a[36:37], v72 offset:34112
s_add_u32 m0, s17, 67584
s_mov_b32 s50, 278528
v_mfma_f32_16x16x32_bf16 v[172:175], a[20:23], a[132:135], v[172:175]
ds_read_b64_tr_b16 a[38:39], v72 offset:34624
buffer_load_dwordx4 v0, s[24:27], s50 offen offset:0 nt lds
v_mfma_f32_16x16x32_bf16 v[176:179], a[20:23], a[136:139], v[176:179]
v_accvgpr_write_b32 a58, v26
v_accvgpr_write_b32 a59, v27
v_mul_f32 v100, s48, v100
v_mfma_f32_16x16x32_bf16 v[176:179], a[16:19], a[124:127], v[176:179]
ds_read_b64_tr_b16 a[40:41], v15 offset:328
v_mul_f32 v101, s48, v101
v_mul_f32 v102, s48, v102
v_mfma_f32_16x16x32_bf16 v[180:183], a[16:19], a[128:131], v[180:183]
ds_read_b64_tr_b16 a[42:43], v15 offset:840
buffer_load_dwordx4 v1, s[24:27], s50 offen offset:1056 nt lds
v_mfma_f32_16x16x32_bf16 v[180:183], a[20:23], a[140:143], v[180:183]
s_waitcnt lgkmcnt(6)
v_mul_f32 v103, s48, v103
v_mul_f32 v112, s48, v112
v_mfma_f32_16x16x32_bf16 v[192:195], a[28:31], a[140:143], v[192:195]
ds_read_b64_tr_b16 a[44:45], v72 offset:34120
v_mul_f32 v113, s48, v113
v_mul_f32 v114, s48, v114
v_mul_f32 v115, s48, v115
v_mfma_f32_16x16x32_bf16 v[192:195], a[24:27], a[128:131], v[192:195]
ds_read_b64_tr_b16 a[46:47], v72 offset:34632
buffer_load_dwordx4 v2, s[24:27], s50 offen offset:2112 nt lds
v_cvt_pk_bf16_f32 v32, v100, v101
v_mfma_f32_16x16x32_bf16 v[188:191], a[24:27], a[124:127], v[188:191]
v_cvt_pk_bf16_f32 v33, v102, v103
v_mul_f32 v104, s48, v104
v_mul_f32 v105, s48, v105
v_mul_f32 v106, s48, v106
v_mfma_f32_16x16x32_bf16 v[188:191], a[28:31], a[136:139], v[188:191]
ds_read_b64_tr_b16 a[16:17], v15 offset:384
v_mul_f32 v107, s48, v107
v_mul_f32 v116, s48, v116
v_mul_f32 v117, s48, v117
v_mfma_f32_16x16x32_bf16 v[184:187], a[28:31], a[132:135], v[184:187]
ds_read_b64_tr_b16 a[18:19], v15 offset:896
buffer_load_dwordx4 v3, s[24:27], s50 offen offset:3168 nt lds
v_mul_f32 v118, s48, v118
v_mfma_f32_16x16x32_bf16 v[184:187], a[24:27], a[120:123], v[184:187]
s_waitcnt lgkmcnt(6)
v_mul_f32 v119, s48, v119
v_cvt_pk_bf16_f32 v34, v112, v113
v_cvt_pk_bf16_f32 v35, v114, v115
v_mfma_f32_16x16x32_bf16 v[196:199], a[32:35], a[120:123], v[196:199]
ds_read_b64_tr_b16 a[20:21], v72 offset:34176
v_accvgpr_write_b32 a60, v32
v_accvgpr_write_b32 a61, v33
v_cvt_pk_bf16_f32 v36, v104, v105
v_mfma_f32_16x16x32_bf16 v[196:199], a[36:39], a[132:135], v[196:199]
ds_read_b64_tr_b16 a[22:23], v72 offset:34688
v_cvt_pk_bf16_f32 v37, v106, v107
v_mul_f32 v108, s48, v108
v_mul_f32 v109, s48, v109
v_mfma_f32_16x16x32_bf16 v[200:203], a[36:39], a[136:139], v[200:203]
v_mul_f32 v110, s48, v110
v_mul_f32 v111, s48, v111
v_mul_f32 v120, s48, v120
v_mul_f32 v121, s48, v121
v_mfma_f32_16x16x32_bf16 v[200:203], a[32:35], a[124:127], v[200:203]
ds_read_b64_tr_b16 a[24:25], v15 offset:392
v_mul_f32 v122, s48, v122
v_mul_f32 v123, s48, v123
v_cvt_pk_bf16_f32 v38, v116, v117
v_mfma_f32_16x16x32_bf16 v[204:207], a[32:35], a[128:131], v[204:207]
ds_read_b64_tr_b16 a[26:27], v15 offset:904
v_cvt_pk_bf16_f32 v39, v118, v119
v_accvgpr_write_b32 a62, v34
v_accvgpr_write_b32 a63, v35
v_mfma_f32_16x16x32_bf16 v[204:207], a[36:39], a[140:143], v[204:207]
s_waitcnt lgkmcnt(6)
v_accvgpr_write_b32 a64, v36
v_accvgpr_write_b32 a65, v37
v_cvt_pk_bf16_f32 v64, v108, v109
v_mfma_f32_16x16x32_bf16 v[216:219], a[44:47], a[140:143], v[216:219]
ds_read_b64_tr_b16 a[28:29], v72 offset:34184
v_cvt_pk_bf16_f32 v65, v110, v111
v_cvt_pk_bf16_f32 v66, v120, v121
v_cvt_pk_bf16_f32 v67, v122, v123
v_accvgpr_write_b32 a66, v38
v_mfma_f32_16x16x32_bf16 v[216:219], a[40:43], a[128:131], v[216:219]
ds_read_b64_tr_b16 a[30:31], v72 offset:34696
v_accvgpr_write_b32 a67, v39
v_accvgpr_write_b32 a68, v64
v_accvgpr_write_b32 a69, v65
v_accvgpr_write_b32 a70, v66
v_mfma_f32_16x16x32_bf16 v[212:215], a[40:43], a[124:127], v[212:215]
s_waitcnt vmcnt(41)
s_barrier
v_accvgpr_write_b32 a71, v67
v_mul_f32 v124, s48, v124
v_mul_f32 v125, s48, v125
v_mfma_f32_16x16x32_bf16 v[212:215], a[44:47], a[136:139], v[212:215]
ds_read_b64_tr_b16 a[32:33], v15 offset:448
v_mul_f32 v126, s48, v126
v_mul_f32 v127, s48, v127
v_mul_f32 v136, s48, v136
v_mul_f32 v137, s48, v137
v_mfma_f32_16x16x32_bf16 v[208:211], a[44:47], a[132:135], v[208:211]
ds_read_b64_tr_b16 a[34:35], v15 offset:960
v_mul_f32 v138, s48, v138
v_mul_f32 v139, s48, v139
v_cvt_pk_bf16_f32 v68, v124, v125
v_cvt_pk_bf16_f32 v69, v126, v127
v_mfma_f32_16x16x32_bf16 v[208:211], a[40:43], a[120:123], v[208:211]
s_waitcnt lgkmcnt(6)
v_mul_f32 v128, s48, v128
v_mul_f32 v129, s48, v129
v_mul_f32 v130, s48, v130
v_mul_f32 v131, s48, v131
v_mfma_f32_16x16x32_bf16 v[220:223], a[16:19], a[120:123], v[220:223]
ds_read_b64_tr_b16 a[36:37], v72 offset:34240
v_mul_f32 v140, s48, v140
v_mul_f32 v141, s48, v141
v_mul_f32 v142, s48, v142
v_mul_f32 v143, s48, v143
v_mfma_f32_16x16x32_bf16 v[220:223], a[20:23], a[132:135], v[220:223]
ds_read_b64_tr_b16 a[38:39], v72 offset:34752
v_cvt_pk_bf16_f32 v70, v136, v137
v_cvt_pk_bf16_f32 v71, v138, v139
v_accvgpr_write_b32 a72, v68
v_accvgpr_write_b32 a73, v69
v_mfma_f32_16x16x32_bf16 v[224:227], a[20:23], a[136:139], v[224:227]
v_cvt_pk_bf16_f32 v16, v128, v129
v_cvt_pk_bf16_f32 v17, v130, v131
v_mul_f32 v132, s48, v132
v_mul_f32 v133, s48, v133
v_mul_f32 v134, s48, v134
v_mfma_f32_16x16x32_bf16 v[224:227], a[16:19], a[124:127], v[224:227]
ds_read_b64_tr_b16 a[40:41], v15 offset:456
v_mul_f32 v135, s48, v135
v_mul_f32 v144, s48, v144
v_mul_f32 v145, s48, v145
v_mul_f32 v146, s48, v146
v_mfma_f32_16x16x32_bf16 v[228:231], a[16:19], a[128:131], v[228:231]
ds_read_b64_tr_b16 a[42:43], v15 offset:968
v_mul_f32 v147, s48, v147
v_cvt_pk_bf16_f32 v18, v140, v141
v_cvt_pk_bf16_f32 v19, v142, v143
v_accvgpr_write_b32 a74, v70
v_mfma_f32_16x16x32_bf16 v[228:231], a[20:23], a[140:143], v[228:231]
s_waitcnt lgkmcnt(6)
v_accvgpr_write_b32 a75, v71
v_accvgpr_write_b32 a76, v16
v_accvgpr_write_b32 a77, v17
v_cvt_pk_bf16_f32 v20, v132, v133
v_mfma_f32_16x16x32_bf16 v[240:243], a[28:31], a[140:143], v[240:243]
ds_read_b64_tr_b16 a[44:45], v72 offset:34248
v_cvt_pk_bf16_f32 v21, v134, v135
v_cvt_pk_bf16_f32 v22, v144, v145
v_cvt_pk_bf16_f32 v23, v146, v147
v_accvgpr_write_b32 a78, v18
v_mfma_f32_16x16x32_bf16 v[240:243], a[24:27], a[128:131], v[240:243]
ds_read_b64_tr_b16 a[46:47], v72 offset:34760
v_accvgpr_write_b32 a79, v19
v_accvgpr_write_b32 a80, v20
v_accvgpr_write_b32 a81, v21
v_accvgpr_write_b32 a82, v22
v_mfma_f32_16x16x32_bf16 v[236:239], a[24:27], a[124:127], v[236:239]
v_accvgpr_write_b32 a83, v23
v_mul_f32 v148, s48, v148
v_mul_f32 v149, s48, v149
v_mul_f32 v150, s48, v150
v_mul_f32 v151, s48, v151
v_mfma_f32_16x16x32_bf16 v[236:239], a[28:31], a[136:139], v[236:239]
v_subrev_u32 v8, 84480, v8
ds_read_b128 a[16:19], v8 offset:17408
v_mul_f32 v160, s48, v160
v_mul_f32 v161, s48, v161
v_mul_f32 v162, s48, v162
v_mfma_f32_16x16x32_bf16 v[232:235], a[28:31], a[132:135], v[232:235]
v_mul_f32 v163, s48, v163
v_cvt_pk_bf16_f32 v24, v148, v149
v_cvt_pk_bf16_f32 v25, v150, v151
v_mul_f32 v152, s48, v152
v_mul_f32 v153, s48, v153
v_mfma_f32_16x16x32_bf16 v[232:235], a[24:27], a[120:123], v[232:235]
s_waitcnt lgkmcnt(5)
v_mul_f32 v154, s48, v154
v_mul_f32 v155, s48, v155
v_mul_f32 v164, s48, v164
v_mul_f32 v165, s48, v165
v_mfma_f32_16x16x32_bf16 v[244:247], a[32:35], a[120:123], v[244:247]
ds_read_b128 a[20:23], v8 offset:16896
v_mul_f32 v166, s48, v166
v_mul_f32 v167, s48, v167
v_cvt_pk_bf16_f32 v26, v160, v161
v_cvt_pk_bf16_f32 v27, v162, v163
v_mfma_f32_16x16x32_bf16 v[244:247], a[36:39], a[132:135], v[244:247]
v_accvgpr_write_b32 a84, v24
v_accvgpr_write_b32 a85, v25
v_cvt_pk_bf16_f32 v32, v152, v153
v_cvt_pk_bf16_f32 v33, v154, v155
v_mul_f32 v156, s48, v156
v_mfma_f32_16x16x32_bf16 v[248:251], a[36:39], a[136:139], v[248:251]
v_mul_f32 v157, s48, v157
v_mul_f32 v158, s48, v158
v_mul_f32 v159, s48, v159
v_mul_f32 v168, s48, v168
v_mul_f32 v169, s48, v169
v_mfma_f32_16x16x32_bf16 v[248:251], a[32:35], a[124:127], v[248:251]
ds_read_b128 a[24:27], v8 offset:17472
v_mul_f32 v170, s48, v170
v_mul_f32 v171, s48, v171
v_cvt_pk_bf16_f32 v34, v164, v165
v_cvt_pk_bf16_f32 v35, v166, v167
v_mfma_f32_16x16x32_bf16 a[0:3], a[32:35], a[128:131], a[0:3]
v_accvgpr_write_b32 a86, v26
v_accvgpr_write_b32 a87, v27
v_accvgpr_write_b32 a88, v32
v_accvgpr_write_b32 a89, v33
v_cvt_pk_bf16_f32 v36, v156, v157
v_mfma_f32_16x16x32_bf16 a[0:3], a[36:39], a[140:143], a[0:3]
s_waitcnt lgkmcnt(3)
v_cvt_pk_bf16_f32 v37, v158, v159
v_cvt_pk_bf16_f32 v38, v168, v169
v_cvt_pk_bf16_f32 v39, v170, v171
v_accvgpr_write_b32 a90, v34
v_mfma_f32_16x16x32_bf16 a[12:15], a[44:47], a[140:143], a[12:15]
ds_read_b128 a[28:31], v8 offset:16960
v_accvgpr_write_b32 a91, v35
v_accvgpr_write_b32 a92, v36
v_accvgpr_write_b32 a93, v37
v_accvgpr_write_b32 a94, v38
v_mfma_f32_16x16x32_bf16 a[12:15], a[40:43], a[128:131], a[12:15]
v_accvgpr_write_b32 a95, v39
v_mul_f32 v172, s48, v172
v_mul_f32 v173, s48, v173
v_mul_f32 v174, s48, v174
v_mul_f32 v175, s48, v175
v_mfma_f32_16x16x32_bf16 a[8:11], a[40:43], a[124:127], a[8:11]
v_mul_f32 v184, s48, v184
v_mul_f32 v185, s48, v185
v_mul_f32 v186, s48, v186
v_mul_f32 v187, s48, v187
v_cvt_pk_bf16_f32 v64, v172, v173
v_mfma_f32_16x16x32_bf16 a[8:11], a[44:47], a[136:139], a[8:11]
ds_read_b128 a[32:35], v8 offset:17536
v_cvt_pk_bf16_f32 v65, v174, v175
v_mul_f32 v176, s48, v176
v_mul_f32 v177, s48, v177
v_mul_f32 v178, s48, v178
v_mfma_f32_16x16x32_bf16 a[4:7], a[44:47], a[132:135], a[4:7]
v_mul_f32 v179, s48, v179
v_mul_f32 v188, s48, v188
v_mul_f32 v189, s48, v189
v_mul_f32 v190, s48, v190
v_mul_f32 v191, s48, v191
v_mfma_f32_16x16x32_bf16 a[4:7], a[40:43], a[120:123], a[4:7]
s_waitcnt lgkmcnt(3)
v_cvt_pk_bf16_f32 v66, v184, v185
v_cvt_pk_bf16_f32 v67, v186, v187
v_accvgpr_write_b32 a96, v64
v_accvgpr_write_b32 a97, v65
LS_60:
v_mfma_f32_16x16x32_bf16 v[52:55], a[16:19], a[48:51], 0
ds_read_b128 a[36:39], v8 offset:17024
v_cvt_pk_bf16_f32 v68, v176, v177
v_cvt_pk_bf16_f32 v69, v178, v179
v_mul_f32 v180, s48, v180
v_mul_f32 v181, s48, v181
v_mfma_f32_16x16x32_bf16 v[56:59], a[16:19], a[52:55], 0
v_mul_f32 v182, s48, v182
v_mul_f32 v183, s48, v183
v_mul_f32 v192, s48, v192
v_mul_f32 v193, s48, v193
v_mul_f32 v194, s48, v194
v_mfma_f32_16x16x32_bf16 v[60:63], a[16:19], a[56:59], 0
v_mul_f32 v195, s48, v195
v_cvt_pk_bf16_f32 v70, v188, v189
v_cvt_pk_bf16_f32 v71, v190, v191
v_accvgpr_write_b32 a98, v66
v_accvgpr_write_b32 a99, v67
v_mfma_f32_16x16x32_bf16 v[48:51], a[20:23], a[56:59], 0
ds_read_b128 a[40:43], v8 offset:17600
v_accvgpr_write_b32 a100, v68
v_accvgpr_write_b32 a101, v69
v_cvt_pk_bf16_f32 v16, v180, v181
v_cvt_pk_bf16_f32 v17, v182, v183
v_mfma_f32_16x16x32_bf16 v[44:47], a[20:23], a[52:55], 0
s_waitcnt vmcnt(33)
s_barrier
v_cvt_pk_bf16_f32 v18, v192, v193
v_cvt_pk_bf16_f32 v19, v194, v195
v_accvgpr_write_b32 a102, v70
v_mfma_f32_16x16x32_bf16 v[40:43], a[20:23], a[48:51], 0
s_waitcnt lgkmcnt(3)
s_add_u32 m0, s17, 84480
s_mov_b32 s50, 327680
v_accvgpr_write_b32 a103, v71
v_accvgpr_write_b32 a104, v16
v_mfma_f32_16x16x32_bf16 v[52:55], a[24:27], a[60:63], v[52:55]
ds_read_b128 a[44:47], v8 offset:17088
buffer_load_dwordx4 v0, s[20:23], s50 offen offset:0 nt lds
v_accvgpr_write_b32 a105, v17
v_accvgpr_write_b32 a106, v18
v_mfma_f32_16x16x32_bf16 v[56:59], a[24:27], a[64:67], v[56:59]
v_accvgpr_write_b32 a107, v19
v_mul_f32 v196, s48, v196
v_mul_f32 v197, s48, v197
v_mul_f32 v198, s48, v198
v_mul_f32 v199, s48, v199
v_mfma_f32_16x16x32_bf16 v[60:63], a[24:27], a[68:71], v[60:63]
v_mul_f32 v208, s48, v208
v_mul_f32 v209, s48, v209
v_mul_f32 v210, s48, v210
v_mul_f32 v211, s48, v211
v_cvt_pk_bf16_f32 v20, v196, v197
v_mfma_f32_16x16x32_bf16 v[48:51], a[28:31], a[68:71], v[48:51]
ds_read_b128 a[16:19], v8 offset:17664
buffer_load_dwordx4 v1, s[20:23], s50 offen offset:1056 nt lds
v_cvt_pk_bf16_f32 v21, v198, v199
v_mul_f32 v200, s48, v200
v_mul_f32 v201, s48, v201
v_mfma_f32_16x16x32_bf16 v[44:47], a[28:31], a[64:67], v[44:47]
v_mul_f32 v202, s48, v202
v_mul_f32 v203, s48, v203
v_mul_f32 v212, s48, v212
v_mul_f32 v213, s48, v213
v_mul_f32 v214, s48, v214
v_mfma_f32_16x16x32_bf16 v[40:43], a[28:31], a[60:63], v[40:43]
s_waitcnt lgkmcnt(3)
v_mul_f32 v215, s48, v215
v_cvt_pk_bf16_f32 v22, v208, v209
v_cvt_pk_bf16_f32 v23, v210, v211
v_accvgpr_write_b32 a108, v20
v_mfma_f32_16x16x32_bf16 v[52:55], a[32:35], a[72:75], v[52:55]
ds_read_b128 a[20:23], v8 offset:17152
buffer_load_dwordx4 v2, s[20:23], s50 offen offset:2112 nt lds
v_accvgpr_write_b32 a109, v21
v_cvt_pk_bf16_f32 v24, v200, v201
v_cvt_pk_bf16_f32 v25, v202, v203
v_mfma_f32_16x16x32_bf16 v[56:59], a[32:35], a[76:79], v[56:59]
v_mul_f32 v204, s48, v204
v_mul_f32 v205, s48, v205
v_mul_f32 v206, s48, v206
v_mul_f32 v207, s48, v207
v_mul_f32 v216, s48, v216
v_mfma_f32_16x16x32_bf16 v[60:63], a[32:35], a[80:83], v[60:63]
v_mul_f32 v217, s48, v217
v_mul_f32 v218, s48, v218
v_mul_f32 v219, s48, v219
v_cvt_pk_bf16_f32 v26, v212, v213
v_cvt_pk_bf16_f32 v27, v214, v215
v_mfma_f32_16x16x32_bf16 v[48:51], a[36:39], a[80:83], v[48:51]
ds_read_b128 a[24:27], v8 offset:17728
buffer_load_dwordx4 v3, s[20:23], s50 offen offset:3168 nt lds
v_accvgpr_write_b32 a110, v22
v_accvgpr_write_b32 a111, v23
v_accvgpr_write_b32 a112, v24
v_mfma_f32_16x16x32_bf16 v[44:47], a[36:39], a[76:79], v[44:47]
s_add_u32 m0, s17, 101376
s_mov_b32 s50, 286720
v_accvgpr_write_b32 a113, v25
v_cvt_pk_bf16_f32 v32, v204, v205
v_cvt_pk_bf16_f32 v33, v206, v207
v_mfma_f32_16x16x32_bf16 v[40:43], a[36:39], a[72:75], v[40:43]
s_waitcnt lgkmcnt(3)
buffer_load_dwordx4 v0, s[24:27], s50 offen offset:0 nt lds
v_cvt_pk_bf16_f32 v34, v216, v217
v_cvt_pk_bf16_f32 v35, v218, v219
v_mfma_f32_16x16x32_bf16 v[52:55], a[40:43], a[84:87], v[52:55]
ds_read_b128 a[28:31], v8 offset:17216
v_accvgpr_write_b32 a114, v26
v_accvgpr_write_b32 a115, v27
v_accvgpr_write_b32 a116, v32
v_accvgpr_write_b32 a117, v33
v_accvgpr_write_b32 a118, v34
v_mfma_f32_16x16x32_bf16 v[56:59], a[40:43], a[88:91], v[56:59]
v_accvgpr_write_b32 a119, v35
v_mul_f32 v220, s48, v220
v_mul_f32 v221, s48, v221
v_mul_f32 v222, s48, v222
v_mul_f32 v223, s48, v223
v_mfma_f32_16x16x32_bf16 v[60:63], a[40:43], a[92:95], v[60:63]
buffer_load_dwordx4 v1, s[24:27], s50 offen offset:1056 nt lds
v_mul_f32 v232, s48, v232
v_mul_f32 v233, s48, v233
v_mul_f32 v234, s48, v234
v_mfma_f32_16x16x32_bf16 v[48:51], a[44:47], a[92:95], v[48:51]
ds_read_b128 a[32:35], v8 offset:17792
v_mul_f32 v235, s48, v235
v_cvt_pk_bf16_f32 v36, v220, v221
v_cvt_pk_bf16_f32 v37, v222, v223
v_mul_f32 v224, s48, v224
v_mul_f32 v225, s48, v225
v_mfma_f32_16x16x32_bf16 v[44:47], a[44:47], a[88:91], v[44:47]
v_mul_f32 v226, s48, v226
v_mul_f32 v227, s48, v227
v_mul_f32 v236, s48, v236
v_mul_f32 v237, s48, v237
v_mul_f32 v238, s48, v238
v_mfma_f32_16x16x32_bf16 v[40:43], a[44:47], a[84:87], v[40:43]
s_waitcnt lgkmcnt(3)
buffer_load_dwordx4 v2, s[24:27], s50 offen offset:2112 nt lds
v_mul_f32 v239, s48, v239
v_cvt_pk_bf16_f32 v38, v232, v233
v_mfma_f32_16x16x32_bf16 v[52:55], a[16:19], a[96:99], v[52:55]
ds_read_b128 a[36:39], v8 offset:17280
v_cvt_pk_bf16_f32 v39, v234, v235
v_cvt_pk_bf16_f32 v64, v224, v225
v_cvt_pk_bf16_f32 v65, v226, v227
v_mul_f32 v228, s48, v228
v_mul_f32 v229, s48, v229
v_mfma_f32_16x16x32_bf16 v[56:59], a[16:19], a[100:103], v[56:59]
v_mul_f32 v230, s48, v230
v_mul_f32 v231, s48, v231
v_mul_f32 v240, s48, v240
v_mul_f32 v241, s48, v241
v_mul_f32 v242, s48, v242
v_mul_f32 v243, s48, v243
v_mfma_f32_16x16x32_bf16 v[60:63], a[16:19], a[104:107], v[60:63]
buffer_load_dwordx4 v3, s[24:27], s50 offen offset:3168 nt lds
v_cvt_pk_bf16_f32 v66, v236, v237
v_cvt_pk_bf16_f32 v67, v238, v239
v_accvgpr_write_b32 a120, v36
v_accvgpr_write_b32 a121, v37
v_mfma_f32_16x16x32_bf16 v[48:51], a[20:23], a[104:107], v[48:51]
ds_read_b128 a[40:43], v8 offset:17856
v_accvgpr_write_b32 a122, v38
v_accvgpr_write_b32 a123, v39
v_cvt_pk_bf16_f32 v68, v228, v229
v_cvt_pk_bf16_f32 v69, v230, v231
v_cvt_pk_bf16_f32 v70, v240, v241
v_mfma_f32_16x16x32_bf16 v[44:47], a[20:23], a[100:103], v[44:47]
v_cvt_pk_bf16_f32 v71, v242, v243
v_accvgpr_write_b32 a124, v64
v_accvgpr_write_b32 a125, v65
v_accvgpr_write_b32 a126, v66
v_accvgpr_write_b32 a127, v67
v_accvgpr_write_b32 a128, v68
v_mfma_f32_16x16x32_bf16 v[40:43], a[20:23], a[96:99], v[40:43]
s_waitcnt lgkmcnt(3)
v_accvgpr_write_b32 a129, v69
v_accvgpr_write_b32 a130, v70
v_accvgpr_write_b32 a131, v71
v_accvgpr_read_b32 v208, a4
v_accvgpr_read_b32 v209, a5
v_mfma_f32_16x16x32_bf16 v[52:55], a[24:27], a[108:111], v[52:55]
ds_read_b128 a[44:47], v8 offset:17344
v_accvgpr_read_b32 v210, a6
v_accvgpr_read_b32 v211, a7
v_mul_f32 v244, s48, v244
v_mul_f32 v245, s48, v245
v_mul_f32 v246, s48, v246
v_mfma_f32_16x16x32_bf16 v[56:59], a[24:27], a[112:115], v[56:59]
v_mul_f32 v247, s48, v247
v_accvgpr_read_b32 v212, a8
v_accvgpr_read_b32 v213, a9
v_accvgpr_read_b32 v214, a10
v_accvgpr_read_b32 v215, a11
v_mfma_f32_16x16x32_bf16 v[60:63], a[24:27], a[116:119], v[60:63]
v_mul_f32 v208, s48, v208
v_mul_f32 v209, s48, v209
v_mul_f32 v210, s48, v210
v_mul_f32 v211, s48, v211
v_cvt_pk_bf16_f32 v16, v244, v245
v_mfma_f32_16x16x32_bf16 v[48:51], a[28:31], a[116:119], v[48:51]
ds_read_b128 a[16:19], v8 offset:0
v_cvt_pk_bf16_f32 v17, v246, v247
v_mul_f32 v248, s48, v248
v_mul_f32 v249, s48, v249
v_mul_f32 v250, s48, v250
v_mul_f32 v251, s48, v251
v_mfma_f32_16x16x32_bf16 v[44:47], a[28:31], a[112:115], v[44:47]
v_accvgpr_read_b32 v204, a0
v_accvgpr_read_b32 v205, a1
v_accvgpr_read_b32 v206, a2
v_accvgpr_read_b32 v207, a3
v_accvgpr_read_b32 v216, a12
v_mfma_f32_16x16x32_bf16 v[40:43], a[28:31], a[108:111], v[40:43]
s_waitcnt lgkmcnt(3)
v_accvgpr_read_b32 v217, a13
v_accvgpr_read_b32 v218, a14
v_accvgpr_read_b32 v219, a15
v_mul_f32 v212, s48, v212
v_mfma_f32_16x16x32_bf16 v[52:55], a[32:35], a[120:123], v[52:55]
ds_read_b128 a[20:23], v8 offset:64
v_mul_f32 v213, s48, v213
v_mul_f32 v214, s48, v214
v_mul_f32 v215, s48, v215
v_cvt_pk_bf16_f32 v18, v208, v209
v_cvt_pk_bf16_f32 v19, v210, v211
v_mfma_f32_16x16x32_bf16 v[56:59], a[32:35], a[124:127], v[56:59]
v_cvt_pk_bf16_f32 v20, v248, v249
v_cvt_pk_bf16_f32 v21, v250, v251
v_mul_f32 v204, s48, v204
v_mul_f32 v205, s48, v205
v_mul_f32 v206, s48, v206
v_mfma_f32_16x16x32_bf16 v[60:63], a[32:35], a[128:131], v[60:63]
v_mul_f32 v207, s48, v207
v_mul_f32 v216, s48, v216
v_mul_f32 v217, s48, v217
v_mul_f32 v218, s48, v218
v_mul_f32 v219, s48, v219
v_mfma_f32_16x16x32_bf16 v[48:51], a[36:39], a[128:131], v[48:51]
ds_read_b128 a[24:27], v8 offset:128
v_accvgpr_write_b32 a132, v16
v_accvgpr_write_b32 a133, v17
v_cvt_pk_bf16_f32 v22, v212, v213
v_cvt_pk_bf16_f32 v23, v214, v215
v_accvgpr_write_b32 a134, v18
v_mfma_f32_16x16x32_bf16 v[44:47], a[36:39], a[124:127], v[44:47]
v_accvgpr_write_b32 a135, v19
v_cvt_pk_bf16_f32 v24, v204, v205
v_cvt_pk_bf16_f32 v25, v206, v207
v_accvgpr_write_b32 a136, v20
v_accvgpr_write_b32 a137, v21
v_mfma_f32_16x16x32_bf16 v[40:43], a[36:39], a[120:123], v[40:43]
s_waitcnt lgkmcnt(3)
v_cvt_pk_bf16_f32 v26, v216, v217
v_cvt_pk_bf16_f32 v27, v218, v219
v_accvgpr_write_b32 a138, v22
v_accvgpr_write_b32 a139, v23
v_mfma_f32_16x16x32_bf16 v[52:55], a[40:43], a[132:135], v[52:55]
ds_read_b128 a[28:31], v8 offset:192
v_accvgpr_write_b32 a140, v24
v_accvgpr_write_b32 a141, v25
v_accvgpr_write_b32 a142, v26
v_accvgpr_write_b32 a143, v27
v_mfma_f32_16x16x32_bf16 v[56:59], a[40:43], a[136:139], v[56:59]
s_nop 0
v_mfma_f32_16x16x32_bf16 v[60:63], a[40:43], a[140:143], v[60:63]
v_mfma_f32_16x16x32_bf16 v[48:51], a[44:47], a[140:143], v[48:51]
ds_read_b128 a[32:35], v8 offset:256
v_mfma_f32_16x16x32_bf16 v[44:47], a[44:47], a[136:139], v[44:47]
v_mfma_f32_16x16x32_bf16 v[40:43], a[44:47], a[132:135], v[40:43]
s_waitcnt lgkmcnt(3)
v_max3_f32 v10, v52, v53, v54
v_max3_f32 v11, v56, v57, v58
s_nop 0
v_max3_f32 v12, v60, v61, v62
LS_61:
v_mfma_f32_16x16x32_bf16 v[64:67], a[16:19], a[48:51], 0
ds_read_b128 a[36:39], v8 offset:320
v_max_f32 v10, v10, v55
v_max_f32 v11, v11, v59
v_max_f32 v12, v12, v63
v_mfma_f32_16x16x32_bf16 v[64:67], a[20:23], a[60:63], v[64:67]
v_max3_f32 v10, v10, v40, v41
v_max3_f32 v11, v11, v44, v45
v_mfma_f32_16x16x32_bf16 v[68:71], a[20:23], a[64:67], 0
v_max3_f32 v12, v12, v48, v49
v_max3_f32 v10, v10, v42, v43
v_max3_f32 v11, v11, v46, v47
v_mfma_f32_16x16x32_bf16 v[68:71], a[16:19], a[52:55], v[68:71]
ds_read_b128 a[40:43], v8 offset:384
v_max3_f32 v12, v12, v50, v51
v_mov_b32 v30, v10
v_mov_b32 v34, v11
v_mfma_f32_16x16x32_bf16 v[72:75], a[16:19], a[56:59], 0
v_mov_b32 v38, v12
v_mfma_f32_16x16x32_bf16 v[72:75], a[20:23], a[68:71], v[72:75]
s_waitcnt lgkmcnt(3)
v_permlane32_swap_b32 v10, v30
v_permlane32_swap_b32 v11, v34
v_mfma_f32_16x16x32_bf16 v[72:75], a[24:27], a[80:83], v[72:75]
ds_read_b128 a[44:47], v8 offset:448
v_permlane32_swap_b32 v12, v38
v_max_f32 v10, v10, v30
v_max_f32 v11, v11, v34
v_mfma_f32_16x16x32_bf16 v[72:75], a[28:31], a[92:95], v[72:75]
v_max_f32 v12, v12, v38
v_mov_b32 v30, v10
v_mov_b32 v34, v11
v_mfma_f32_16x16x32_bf16 v[68:71], a[28:31], a[88:91], v[68:71]
v_mov_b32 v38, v12
v_mfma_f32_16x16x32_bf16 v[68:71], a[24:27], a[76:79], v[68:71]
ds_read_b128 a[16:19], v8 offset:512
v_permlane16_swap_b32 v10, v30
v_permlane16_swap_b32 v11, v34
v_mfma_f32_16x16x32_bf16 v[64:67], a[24:27], a[72:75], v[64:67]
v_permlane16_swap_b32 v12, v38
v_max_f32 v10, v10, v30
v_max_f32 v11, v11, v34
v_mfma_f32_16x16x32_bf16 v[64:67], a[28:31], a[84:87], v[64:67]
s_waitcnt lgkmcnt(3)
v_max_f32 v12, v12, v38
v_ceil_f32 v10, v10
v_ceil_f32 v11, v11
v_mfma_f32_16x16x32_bf16 v[64:67], a[32:35], a[96:99], v[64:67]
ds_read_b128 a[20:23], v8 offset:576
v_ceil_f32 v12, v12
v_sub_f32 v16, 0, v10
v_sub_f32 v20, 0, v11
v_mfma_f32_16x16x32_bf16 v[64:67], a[36:39], a[108:111], v[64:67]
v_sub_f32 v24, 0, v12
v_mov_b32 v10, 0
v_mov_b32 v11, 0
v_mov_b32 v17, v16
v_mov_b32 v18, v16
v_mov_b32 v19, v16
v_mov_b32 v21, v20
v_mfma_f32_16x16x32_bf16 v[68:71], a[36:39], a[112:115], v[68:71]
v_mov_b32 v12, 0
v_add_f32 v40, v40, v16
v_add_f32 v41, v41, v16
v_add_f32 v42, v42, v16
v_add_f32 v43, v43, v16
v_add_f32 v44, v44, v20
v_add_f32 v45, v45, v20
v_add_f32 v46, v46, v20
v_mfma_f32_16x16x32_bf16 v[68:71], a[32:35], a[100:103], v[68:71]
ds_read_b128 a[24:27], v8 offset:640
v_exp_f32 v40, v40
v_exp_f32 v41, v41
v_exp_f32 v42, v42
v_mfma_f32_16x16x32_bf16 v[72:75], a[32:35], a[104:107], v[72:75]
v_add_f32 v47, v47, v20
v_add_f32 v48, v48, v24
v_add_f32 v49, v49, v24
v_add_f32 v50, v50, v24
v_add_f32 v51, v51, v24
v_exp_f32 v43, v43
v_mfma_f32_16x16x32_bf16 v[72:75], a[36:39], a[116:119], v[72:75]
s_waitcnt lgkmcnt(3)
v_exp_f32 v44, v44
v_exp_f32 v45, v45
v_exp_f32 v46, v46
v_mov_b32 v22, v20
v_mfma_f32_16x16x32_bf16 v[72:75], a[40:43], a[128:131], v[72:75]
ds_read_b128 a[28:31], v8 offset:704
v_exp_f32 v47, v47
v_exp_f32 v48, v48
v_exp_f32 v49, v49
v_mfma_f32_16x16x32_bf16 v[72:75], a[44:47], a[140:143], v[72:75]
v_exp_f32 v50, v50
v_exp_f32 v51, v51
v_mov_b32 v23, v20
v_mov_b32 v25, v24
v_mov_b32 v26, v24
v_mfma_f32_16x16x32_bf16 v[68:71], a[44:47], a[136:139], v[68:71]
s_waitcnt vmcnt(33)
s_barrier
v_mov_b32 v27, v24
v_add_f32 v10, v10, v40
v_add_f32 v10, v10, v41
v_add_f32 v10, v10, v42
v_add_f32 v10, v10, v43
v_add_f32 v11, v11, v44
v_mfma_f32_16x16x32_bf16 v[68:71], a[40:43], a[124:127], v[68:71]
ds_read_b128 a[32:35], v8 offset:768
v_add_f32 v11, v11, v45
v_add_f32 v11, v11, v46
v_add_f32 v11, v11, v47
v_cvt_pk_bf16_f32 v28, v40, v41
v_cvt_pk_bf16_f32 v29, v42, v43
v_cvt_pk_bf16_f32 v32, v44, v45
v_mfma_f32_16x16x32_bf16 v[64:67], a[40:43], a[120:123], v[64:67]
v_cvt_pk_bf16_f32 v33, v46, v47
v_add_f32 v12, v12, v48
v_add_f32 v12, v12, v49
v_add_f32 v12, v12, v50
v_add_f32 v12, v12, v51
v_cvt_pk_bf16_f32 v36, v48, v49
v_cvt_pk_bf16_f32 v37, v50, v51
v_mfma_f32_16x16x32_bf16 v[64:67], a[44:47], a[132:135], v[64:67]
s_waitcnt lgkmcnt(3)
s_add_u32 m0, s17, 16896
s_mov_b32 s50, 335872
v_add_f32 v52, v52, v16
v_mfma_f32_16x16x32_bf16 v[40:43], a[16:19], a[48:51], v[16:19]
ds_read_b128 a[36:39], v8 offset:832
buffer_load_dwordx4 v0, s[20:23], s50 offen offset:0 nt lds
v_add_f32 v53, v53, v16
v_mfma_f32_16x16x32_bf16 v[40:43], a[20:23], a[60:63], v[40:43]
v_exp_f32 v52, v52
v_exp_f32 v53, v53
v_mfma_f32_16x16x32_bf16 v[44:47], a[20:23], a[64:67], v[20:23]
v_add_f32 v54, v54, v16
v_add_f32 v55, v55, v16
v_add_f32 v56, v56, v20
v_add_f32 v57, v57, v20
v_mfma_f32_16x16x32_bf16 v[44:47], a[16:19], a[52:55], v[44:47]
ds_read_b128 a[40:43], v8 offset:896
buffer_load_dwordx4 v1, s[20:23], s50 offen offset:1056 nt lds
v_add_f32 v58, v58, v20
v_mfma_f32_16x16x32_bf16 v[48:51], a[16:19], a[56:59], v[24:27]
v_exp_f32 v54, v54
v_exp_f32 v55, v55
v_mfma_f32_16x16x32_bf16 v[48:51], a[20:23], a[68:71], v[48:51]
s_waitcnt lgkmcnt(3)
v_exp_f32 v56, v56
v_add_f32 v59, v59, v20
v_mfma_f32_16x16x32_bf16 v[48:51], a[24:27], a[80:83], v[48:51]
ds_read_b128 a[44:47], v8 offset:960
v_exp_f32 v57, v57
v_add_f32 v60, v60, v24
v_mfma_f32_16x16x32_bf16 v[48:51], a[28:31], a[92:95], v[48:51]
v_exp_f32 v58, v58
v_exp_f32 v59, v59
v_mfma_f32_16x16x32_bf16 v[44:47], a[28:31], a[88:91], v[44:47]
v_exp_f32 v60, v60
buffer_load_dwordx4 v2, s[20:23], s50 offen offset:2112 nt lds
v_mfma_f32_16x16x32_bf16 v[44:47], a[24:27], a[76:79], v[44:47]
v_add_u32 v9, 16896, v9
ds_read_b64_tr_b16 a[16:17], v9 offset:50688
v_add_f32 v61, v61, v24
v_add_f32 v62, v62, v24
v_mfma_f32_16x16x32_bf16 v[40:43], a[24:27], a[72:75], v[40:43]
ds_read_b64_tr_b16 a[18:19], v9 offset:51200
v_exp_f32 v61, v61
v_add_f32 v63, v63, v24
v_mfma_f32_16x16x32_bf16 v[40:43], a[28:31], a[84:87], v[40:43]
s_waitcnt lgkmcnt(4)
v_exp_f32 v62, v62
v_add_f32 v64, v64, v16
v_mfma_f32_16x16x32_bf16 v[40:43], a[32:35], a[96:99], v[40:43]
ds_read_b64_tr_b16 a[20:21], v9 offset:50720
v_exp_f32 v63, v63
v_add_f32 v65, v65, v16
v_mfma_f32_16x16x32_bf16 v[40:43], a[36:39], a[108:111], v[40:43]
ds_read_b64_tr_b16 a[22:23], v9 offset:51232
v_add_f32 v66, v66, v16
v_add_f32 v67, v67, v16
v_add_f32 v68, v68, v20
v_mfma_f32_16x16x32_bf16 v[44:47], a[36:39], a[112:115], v[44:47]
v_add_f32 v69, v69, v20
v_add_f32 v70, v70, v20
v_add_f32 v71, v71, v20
v_add_f32 v72, v72, v24
v_mfma_f32_16x16x32_bf16 v[44:47], a[32:35], a[100:103], v[44:47]
ds_read_b64_tr_b16 a[24:25], v9 offset:50752
v_add_f32 v73, v73, v24
v_add_f32 v74, v74, v24
v_add_f32 v75, v75, v24
v_mfma_f32_16x16x32_bf16 v[48:51], a[32:35], a[104:107], v[48:51]
ds_read_b64_tr_b16 a[26:27], v9 offset:51264
v_max3_f32 v13, v64, v65, v66
buffer_load_dwordx4 v3, s[20:23], s50 offen offset:3168 nt lds
v_mfma_f32_16x16x32_bf16 v[48:51], a[36:39], a[116:119], v[48:51]
s_waitcnt lgkmcnt(6)
v_max3_f32 v13, v13, v67, v68
v_cvt_pk_bf16_f32 v30, v52, v53
v_cvt_pk_bf16_f32 v31, v54, v55
v_mfma_f32_16x16x32_bf16 v[48:51], a[40:43], a[128:131], v[48:51]
ds_read_b64_tr_b16 a[28:29], v9 offset:50784
v_max3_f32 v13, v13, v69, v70
v_cvt_pk_bf16_f32 v34, v56, v57
v_cvt_pk_bf16_f32 v35, v58, v59
v_mfma_f32_16x16x32_bf16 v[48:51], a[44:47], a[140:143], v[48:51]
ds_read_b64_tr_b16 a[30:31], v9 offset:51296
v_cvt_pk_bf16_f32 v38, v60, v61
v_cvt_pk_bf16_f32 v39, v62, v63
v_max3_f32 v13, v13, v71, v72
v_mfma_f32_16x16x32_bf16 v[44:47], a[44:47], a[136:139], v[44:47]
v_max3_f32 v13, v13, v73, v74
v_add_f32 v10, v10, v52
v_add_f32 v10, v10, v53
v_add_f32 v10, v10, v54
v_mfma_f32_16x16x32_bf16 v[44:47], a[40:43], a[124:127], v[44:47]
ds_read_b64_tr_b16 a[32:33], v9 offset:50816
v_add_f32 v10, v10, v55
v_add_f32 v11, v11, v56
v_add_f32 v11, v11, v57
v_add_f32 v11, v11, v58
v_mfma_f32_16x16x32_bf16 v[40:43], a[40:43], a[120:123], v[40:43]
ds_read_b64_tr_b16 a[34:35], v9 offset:51328
v_add_f32 v11, v11, v59
v_add_f32 v12, v12, v60
v_add_f32 v12, v12, v61
v_mfma_f32_16x16x32_bf16 v[40:43], a[44:47], a[132:135], v[40:43]
s_waitcnt lgkmcnt(6)
v_add_f32 v12, v12, v62
v_add_f32 v12, v12, v63
v_max_f32 v13, v13, v75
LS_62:
v_mfma_f32_16x16x32_bf16 v[76:79], a[16:19], v[28:31], 0
ds_read_b64_tr_b16 a[36:37], v9 offset:50848
v_mfma_f32_16x16x32_bf16 v[80:83], a[16:19], v[32:35], 0
ds_read_b64_tr_b16 a[38:39], v9 offset:51360
v_mfma_f32_16x16x32_bf16 v[84:87], a[16:19], v[36:39], 0
v_mfma_f32_16x16x32_bf16 v[96:99], a[20:23], v[36:39], 0
ds_read_b64_tr_b16 a[40:41], v9 offset:50880
v_max3_f32 v13, v13, v40, v41
v_mfma_f32_16x16x32_bf16 v[92:95], a[20:23], v[32:35], 0
ds_read_b64_tr_b16 a[42:43], v9 offset:51392
v_max3_f32 v13, v13, v42, v43
v_mfma_f32_16x16x32_bf16 v[88:91], a[20:23], v[28:31], 0
s_waitcnt lgkmcnt(6)
v_max3_f32 v13, v13, v44, v45
v_mfma_f32_16x16x32_bf16 v[100:103], a[24:27], v[28:31], 0
ds_read_b64_tr_b16 a[44:45], v9 offset:50912
v_max3_f32 v13, v13, v46, v47
v_mfma_f32_16x16x32_bf16 v[104:107], a[24:27], v[32:35], 0
ds_read_b64_tr_b16 a[46:47], v9 offset:51424
v_max3_f32 v13, v13, v48, v49
v_mfma_f32_16x16x32_bf16 v[108:111], a[24:27], v[36:39], 0
v_max3_f32 v13, v13, v50, v51
v_mfma_f32_16x16x32_bf16 v[120:123], a[28:31], v[36:39], 0
ds_read_b64_tr_b16 a[16:17], v9 offset:50944
v_cmp_lt_f32 vcc, s47, v13
v_mfma_f32_16x16x32_bf16 v[116:119], a[28:31], v[32:35], 0
ds_read_b64_tr_b16 a[18:19], v9 offset:51456
v_mfma_f32_16x16x32_bf16 v[112:115], a[28:31], v[28:31], 0
s_waitcnt lgkmcnt(6)
s_cbranch_vccnz RARE_h1j0
RET_h1j0:
v_mfma_f32_16x16x32_bf16 v[124:127], a[32:35], v[28:31], 0
ds_read_b64_tr_b16 a[20:21], v9 offset:50976
ds_read_b64_tr_b16 a[22:23], v9 offset:51488
v_mfma_f32_16x16x32_bf16 v[128:131], a[32:35], v[32:35], 0
v_exp_f32 v40, v40
v_mfma_f32_16x16x32_bf16 v[132:135], a[32:35], v[36:39], 0
v_exp_f32 v41, v41
v_mfma_f32_16x16x32_bf16 v[144:147], a[36:39], v[36:39], 0
ds_read_b64_tr_b16 a[24:25], v9 offset:51008
ds_read_b64_tr_b16 a[26:27], v9 offset:51520
v_mfma_f32_16x16x32_bf16 v[140:143], a[36:39], v[32:35], 0
v_exp_f32 v42, v42
v_mfma_f32_16x16x32_bf16 v[136:139], a[36:39], v[28:31], 0
s_waitcnt lgkmcnt(6)
v_add_f32 v10, v10, v40
v_mfma_f32_16x16x32_bf16 v[148:151], a[40:43], v[28:31], 0
ds_read_b64_tr_b16 a[28:29], v9 offset:51040
ds_read_b64_tr_b16 a[30:31], v9 offset:51552
v_mfma_f32_16x16x32_bf16 v[152:155], a[40:43], v[32:35], 0
v_exp_f32 v43, v43
v_mfma_f32_16x16x32_bf16 v[156:159], a[40:43], v[36:39], 0
s_waitcnt vmcnt(25)
s_barrier
v_mfma_f32_16x16x32_bf16 v[168:171], a[44:47], v[36:39], 0
ds_read_b64_tr_b16 a[32:33], v9 offset:51072
ds_read_b64_tr_b16 a[34:35], v9 offset:51584
v_mfma_f32_16x16x32_bf16 v[164:167], a[44:47], v[32:35], 0
s_add_u32 m0, s17, 0
s_mov_b32 s50, 327680
v_mfma_f32_16x16x32_bf16 v[160:163], a[44:47], v[28:31], 0
s_waitcnt lgkmcnt(6)
v_add_f32 v10, v10, v41
v_mfma_f32_16x16x32_bf16 v[172:175], a[16:19], v[28:31], 0
ds_read_b64_tr_b16 a[36:37], v9 offset:51104
ds_read_b64_tr_b16 a[38:39], v9 offset:51616
v_mfma_f32_16x16x32_bf16 v[176:179], a[16:19], v[32:35], 0
buffer_load_dwordx4 v0, s[24:27], s50 offen offset:0 nt lds
v_mfma_f32_16x16x32_bf16 v[180:183], a[16:19], v[36:39], 0
v_exp_f32 v44, v44
v_mfma_f32_16x16x32_bf16 v[192:195], a[20:23], v[36:39], 0
ds_read_b64_tr_b16 a[40:41], v9 offset:51136
ds_read_b64_tr_b16 a[42:43], v9 offset:51648
v_mfma_f32_16x16x32_bf16 v[188:191], a[20:23], v[32:35], 0
buffer_load_dwordx4 v1, s[24:27], s50 offen offset:1056 nt lds
v_mfma_f32_16x16x32_bf16 v[184:187], a[20:23], v[28:31], 0
s_waitcnt lgkmcnt(6)
v_add_f32 v10, v10, v42
v_mfma_f32_16x16x32_bf16 v[196:199], a[24:27], v[28:31], 0
ds_read_b64_tr_b16 a[44:45], v9 offset:51168
ds_read_b64_tr_b16 a[46:47], v9 offset:51680
v_mfma_f32_16x16x32_bf16 v[200:203], a[24:27], v[32:35], 0
buffer_load_dwordx4 v2, s[24:27], s50 offen offset:2112 nt lds
v_mfma_f32_16x16x32_bf16 v[204:207], a[24:27], v[36:39], 0
v_exp_f32 v45, v45
v_mfma_f32_16x16x32_bf16 v[216:219], a[28:31], v[36:39], 0
ds_read_b128 a[16:19], v8 offset:34304
v_add_f32 v10, v10, v43
v_mfma_f32_16x16x32_bf16 v[212:215], a[28:31], v[32:35], 0
v_exp_f32 v46, v46
v_mfma_f32_16x16x32_bf16 v[208:211], a[28:31], v[28:31], 0
s_waitcnt lgkmcnt(5)
v_add_f32 v11, v11, v44
v_mfma_f32_16x16x32_bf16 v[220:223], a[32:35], v[28:31], 0
ds_read_b128 a[20:23], v8 offset:34368
v_add_f32 v11, v11, v45
v_mfma_f32_16x16x32_bf16 v[224:227], a[32:35], v[32:35], 0
v_exp_f32 v47, v47
v_mfma_f32_16x16x32_bf16 v[228:231], a[32:35], v[36:39], 0
v_exp_f32 v48, v48
v_mfma_f32_16x16x32_bf16 v[240:243], a[36:39], v[36:39], 0
ds_read_b128 a[24:27], v8 offset:34432
v_add_f32 v11, v11, v46
v_mfma_f32_16x16x32_bf16 v[236:239], a[36:39], v[32:35], 0
v_exp_f32 v49, v49
v_mfma_f32_16x16x32_bf16 v[232:235], a[36:39], v[28:31], 0
s_waitcnt lgkmcnt(3)
v_add_f32 v11, v11, v47
v_mfma_f32_16x16x32_bf16 v[244:247], a[40:43], v[28:31], 0
ds_read_b128 a[28:31], v8 offset:34496
v_add_f32 v12, v12, v48
v_mfma_f32_16x16x32_bf16 v[248:251], a[40:43], v[32:35], 0
v_exp_f32 v50, v50
v_mfma_f32_16x16x32_bf16 a[0:3], a[40:43], v[36:39], 0
v_exp_f32 v51, v51
v_mfma_f32_16x16x32_bf16 a[12:15], a[44:47], v[36:39], 0
ds_read_b128 a[32:35], v8 offset:34560
buffer_load_dwordx4 v3, s[24:27], s50 offen offset:3168 nt lds
v_mfma_f32_16x16x32_bf16 a[8:11], a[44:47], v[32:35], 0
v_add_f32 v12, v12, v49
v_add_f32 v12, v12, v50
v_mfma_f32_16x16x32_bf16 a[4:7], a[44:47], v[28:31], 0
s_waitcnt lgkmcnt(3)
v_add_f32 v12, v12, v51
LS_63:
v_mfma_f32_16x16x32_bf16 v[52:55], a[16:19], a[48:51], v[16:19]
ds_read_b128 a[36:39], v8 offset:34624
v_cvt_pk_bf16_f32 v30, v40, v41
v_mfma_f32_16x16x32_bf16 v[52:55], a[20:23], a[60:63], v[52:55]
v_exp_f32 v64, v64
v_mfma_f32_16x16x32_bf16 v[56:59], a[20:23], a[64:67], v[20:23]
v_exp_f32 v65, v65
v_mfma_f32_16x16x32_bf16 v[56:59], a[16:19], a[52:55], v[56:59]
ds_read_b128 a[40:43], v8 offset:34688
v_cvt_pk_bf16_f32 v31, v42, v43
v_mfma_f32_16x16x32_bf16 v[60:63], a[16:19], a[56:59], v[24:27]
v_exp_f32 v66, v66
v_mfma_f32_16x16x32_bf16 v[60:63], a[20:23], a[68:71], v[60:63]
s_waitcnt lgkmcnt(3)
v_cvt_pk_bf16_f32 v34, v44, v45
v_mfma_f32_16x16x32_bf16 v[60:63], a[24:27], a[80:83], v[60:63]
ds_read_b128 a[44:47], v8 offset:34752
v_cvt_pk_bf16_f32 v35, v46, v47
v_mfma_f32_16x16x32_bf16 v[60:63], a[28:31], a[92:95], v[60:63]
v_exp_f32 v67, v67
v_mfma_f32_16x16x32_bf16 v[56:59], a[28:31], a[88:91], v[56:59]
v_exp_f32 v68, v68
v_mfma_f32_16x16x32_bf16 v[56:59], a[24:27], a[76:79], v[56:59]
ds_read_b128 a[16:19], v8 offset:33792
v_cvt_pk_bf16_f32 v38, v48, v49
v_mfma_f32_16x16x32_bf16 v[52:55], a[24:27], a[72:75], v[52:55]
v_exp_f32 v69, v69
v_mfma_f32_16x16x32_bf16 v[52:55], a[28:31], a[84:87], v[52:55]
s_waitcnt lgkmcnt(3)
v_cvt_pk_bf16_f32 v39, v50, v51
v_mfma_f32_16x16x32_bf16 v[52:55], a[32:35], a[96:99], v[52:55]
ds_read_b128 a[20:23], v8 offset:33856
v_cvt_pk_bf16_f32 v28, v64, v65
v_mfma_f32_16x16x32_bf16 v[52:55], a[36:39], a[108:111], v[52:55]
v_exp_f32 v70, v70
v_mfma_f32_16x16x32_bf16 v[56:59], a[36:39], a[112:115], v[56:59]
v_exp_f32 v71, v71
v_mfma_f32_16x16x32_bf16 v[56:59], a[32:35], a[100:103], v[56:59]
ds_read_b128 a[24:27], v8 offset:33920
v_cvt_pk_bf16_f32 v29, v66, v67
v_mfma_f32_16x16x32_bf16 v[60:63], a[32:35], a[104:107], v[60:63]
v_exp_f32 v72, v72
v_mfma_f32_16x16x32_bf16 v[60:63], a[36:39], a[116:119], v[60:63]
s_waitcnt lgkmcnt(3)
v_cvt_pk_bf16_f32 v32, v68, v69
v_mfma_f32_16x16x32_bf16 v[60:63], a[40:43], a[128:131], v[60:63]
ds_read_b128 a[28:31], v8 offset:33984
v_cvt_pk_bf16_f32 v33, v70, v71
v_mfma_f32_16x16x32_bf16 v[60:63], a[44:47], a[140:143], v[60:63]
v_exp_f32 v73, v73
v_mfma_f32_16x16x32_bf16 v[56:59], a[44:47], a[136:139], v[56:59]
s_waitcnt vmcnt(24)
s_barrier
v_mfma_f32_16x16x32_bf16 v[56:59], a[40:43], a[124:127], v[56:59]
ds_read_b128 a[32:35], v8 offset:34048
v_cvt_pk_bf16_f32 v36, v72, v73
v_mfma_f32_16x16x32_bf16 v[52:55], a[40:43], a[120:123], v[52:55]
s_add_u32 m0, s17, 135168
s_mov_b32 s50, 344064
v_mfma_f32_16x16x32_bf16 v[52:55], a[44:47], a[132:135], v[52:55]
s_waitcnt lgkmcnt(3)
v_add_f32 v10, v10, v64
v_mfma_f32_16x16x32_bf16 v[40:43], a[16:19], a[48:51], v[16:19]
ds_read_b128 a[36:39], v8 offset:34112
v_add_f32 v10, v10, v65
v_mfma_f32_16x16x32_bf16 v[40:43], a[20:23], a[60:63], v[40:43]
buffer_load_dwordx4 v0, s[20:23], s50 offen offset:0 nt lds
v_mfma_f32_16x16x32_bf16 v[44:47], a[20:23], a[64:67], v[20:23]
v_exp_f32 v74, v74
v_mfma_f32_16x16x32_bf16 v[44:47], a[16:19], a[52:55], v[44:47]
ds_read_b128 a[40:43], v8 offset:34176
v_max3_f32 v13, v52, v53, v54
v_mfma_f32_16x16x32_bf16 v[48:51], a[16:19], a[56:59], v[24:27]
buffer_load_dwordx4 v1, s[20:23], s50 offen offset:1056 nt lds
v_mfma_f32_16x16x32_bf16 v[48:51], a[20:23], a[68:71], v[48:51]
s_waitcnt lgkmcnt(3)
v_max3_f32 v13, v13, v55, v56
v_mfma_f32_16x16x32_bf16 v[48:51], a[24:27], a[80:83], v[48:51]
ds_read_b128 a[44:47], v8 offset:34240
v_max3_f32 v13, v13, v57, v58
v_mfma_f32_16x16x32_bf16 v[48:51], a[28:31], a[92:95], v[48:51]
v_exp_f32 v75, v75
v_mfma_f32_16x16x32_bf16 v[44:47], a[28:31], a[88:91], v[44:47]
buffer_load_dwordx4 v2, s[20:23], s50 offen offset:2112 nt lds
v_mfma_f32_16x16x32_bf16 v[44:47], a[24:27], a[76:79], v[44:47]
ds_read_b64_tr_b16 a[16:17], v9 offset:33792
v_cvt_pk_bf16_f32 v37, v74, v75
v_mfma_f32_16x16x32_bf16 v[40:43], a[24:27], a[72:75], v[40:43]
ds_read_b64_tr_b16 a[18:19], v9 offset:34304
v_max3_f32 v13, v13, v59, v60
v_mfma_f32_16x16x32_bf16 v[40:43], a[28:31], a[84:87], v[40:43]
s_waitcnt lgkmcnt(4)
v_max3_f32 v13, v13, v61, v62
v_mfma_f32_16x16x32_bf16 v[40:43], a[32:35], a[96:99], v[40:43]
ds_read_b64_tr_b16 a[20:21], v9 offset:33824
v_add_f32 v10, v10, v66
v_mfma_f32_16x16x32_bf16 v[40:43], a[36:39], a[108:111], v[40:43]
ds_read_b64_tr_b16 a[22:23], v9 offset:34336
v_add_f32 v10, v10, v67
v_mfma_f32_16x16x32_bf16 v[44:47], a[36:39], a[112:115], v[44:47]
buffer_load_dwordx4 v3, s[20:23], s50 offen offset:3168 nt lds
v_mfma_f32_16x16x32_bf16 v[44:47], a[32:35], a[100:103], v[44:47]
ds_read_b64_tr_b16 a[24:25], v9 offset:33856
v_add_f32 v11, v11, v68
v_mfma_f32_16x16x32_bf16 v[48:51], a[32:35], a[104:107], v[48:51]
ds_read_b64_tr_b16 a[26:27], v9 offset:34368
v_add_f32 v11, v11, v69
v_mfma_f32_16x16x32_bf16 v[48:51], a[36:39], a[116:119], v[48:51]
s_waitcnt lgkmcnt(6)
v_add_f32 v11, v11, v70
v_mfma_f32_16x16x32_bf16 v[48:51], a[40:43], a[128:131], v[48:51]
ds_read_b64_tr_b16 a[28:29], v9 offset:33888
v_add_f32 v11, v11, v71
v_mfma_f32_16x16x32_bf16 v[48:51], a[44:47], a[140:143], v[48:51]
ds_read_b64_tr_b16 a[30:31], v9 offset:34400
v_add_f32 v12, v12, v72
v_mfma_f32_16x16x32_bf16 v[44:47], a[44:47], a[136:139], v[44:47]
v_add_f32 v12, v12, v73
v_add_f32 v12, v12, v74
v_mfma_f32_16x16x32_bf16 v[44:47], a[40:43], a[124:127], v[44:47]
ds_read_b64_tr_b16 a[32:33], v9 offset:33920
v_add_f32 v12, v12, v75
v_mfma_f32_16x16x32_bf16 v[40:43], a[40:43], a[120:123], v[40:43]
ds_read_b64_tr_b16 a[34:35], v9 offset:34432
v_max_f32 v13, v13, v63
v_mfma_f32_16x16x32_bf16 v[40:43], a[44:47], a[132:135], v[40:43]
s_waitcnt lgkmcnt(6)
LS_64:
v_mfma_f32_16x16x32_bf16 v[76:79], a[16:19], v[28:31], v[76:79]
ds_read_b64_tr_b16 a[36:37], v9 offset:33952
v_mfma_f32_16x16x32_bf16 v[80:83], a[16:19], v[32:35], v[80:83]
ds_read_b64_tr_b16 a[38:39], v9 offset:34464
v_mfma_f32_16x16x32_bf16 v[84:87], a[16:19], v[36:39], v[84:87]
v_mfma_f32_16x16x32_bf16 v[96:99], a[20:23], v[36:39], v[96:99]
ds_read_b64_tr_b16 a[40:41], v9 offset:33984
v_max3_f32 v13, v13, v40, v41
v_mfma_f32_16x16x32_bf16 v[92:95], a[20:23], v[32:35], v[92:95]
ds_read_b64_tr_b16 a[42:43], v9 offset:34496
v_max3_f32 v13, v13, v42, v43
v_mfma_f32_16x16x32_bf16 v[88:91], a[20:23], v[28:31], v[88:91]
s_waitcnt lgkmcnt(6)
v_max3_f32 v13, v13, v44, v45
v_mfma_f32_16x16x32_bf16 v[100:103], a[24:27], v[28:31], v[100:103]
ds_read_b64_tr_b16 a[44:45], v9 offset:34016
v_max3_f32 v13, v13, v46, v47
v_mfma_f32_16x16x32_bf16 v[104:107], a[24:27], v[32:35], v[104:107]
ds_read_b64_tr_b16 a[46:47], v9 offset:34528
v_max3_f32 v13, v13, v48, v49
v_mfma_f32_16x16x32_bf16 v[108:111], a[24:27], v[36:39], v[108:111]
v_max3_f32 v13, v13, v50, v51
v_mfma_f32_16x16x32_bf16 v[120:123], a[28:31], v[36:39], v[120:123]
ds_read_b64_tr_b16 a[16:17], v9 offset:34048
v_cmp_lt_f32 vcc, s47, v13
v_mfma_f32_16x16x32_bf16 v[116:119], a[28:31], v[32:35], v[116:119]
ds_read_b64_tr_b16 a[18:19], v9 offset:34560
v_mfma_f32_16x16x32_bf16 v[112:115], a[28:31], v[28:31], v[112:115]
s_waitcnt lgkmcnt(6)
s_cbranch_vccnz RARE_h1j1
RET_h1j1:
v_mfma_f32_16x16x32_bf16 v[124:127], a[32:35], v[28:31], v[124:127]
ds_read_b64_tr_b16 a[20:21], v9 offset:34080
ds_read_b64_tr_b16 a[22:23], v9 offset:34592
v_mfma_f32_16x16x32_bf16 v[128:131], a[32:35], v[32:35], v[128:131]
v_exp_f32 v40, v40
v_mfma_f32_16x16x32_bf16 v[132:135], a[32:35], v[36:39], v[132:135]
v_exp_f32 v41, v41
v_mfma_f32_16x16x32_bf16 v[144:147], a[36:39], v[36:39], v[144:147]
ds_read_b64_tr_b16 a[24:25], v9 offset:34112
ds_read_b64_tr_b16 a[26:27], v9 offset:34624
v_mfma_f32_16x16x32_bf16 v[140:143], a[36:39], v[32:35], v[140:143]
v_exp_f32 v42, v42
v_mfma_f32_16x16x32_bf16 v[136:139], a[36:39], v[28:31], v[136:139]
s_waitcnt lgkmcnt(6)
v_add_f32 v10, v10, v40
v_mfma_f32_16x16x32_bf16 v[148:151], a[40:43], v[28:31], v[148:151]
ds_read_b64_tr_b16 a[28:29], v9 offset:34144
ds_read_b64_tr_b16 a[30:31], v9 offset:34656
v_mfma_f32_16x16x32_bf16 v[152:155], a[40:43], v[32:35], v[152:155]
v_exp_f32 v43, v43
v_mfma_f32_16x16x32_bf16 v[156:159], a[40:43], v[36:39], v[156:159]
s_waitcnt vmcnt(24)
s_barrier
v_mfma_f32_16x16x32_bf16 v[168:171], a[44:47], v[36:39], v[168:171]
ds_read_b64_tr_b16 a[32:33], v9 offset:34176
ds_read_b64_tr_b16 a[34:35], v9 offset:34688
v_mfma_f32_16x16x32_bf16 v[164:167], a[44:47], v[32:35], v[164:167]
s_add_u32 m0, s17, 33792
s_mov_b32 s50, 335872
v_mfma_f32_16x16x32_bf16 v[160:163], a[44:47], v[28:31], v[160:163]
s_waitcnt lgkmcnt(6)
v_add_f32 v10, v10, v41
v_mfma_f32_16x16x32_bf16 v[172:175], a[16:19], v[28:31], v[172:175]
ds_read_b64_tr_b16 a[36:37], v9 offset:34208
ds_read_b64_tr_b16 a[38:39], v9 offset:34720
v_mfma_f32_16x16x32_bf16 v[176:179], a[16:19], v[32:35], v[176:179]
buffer_load_dwordx4 v0, s[24:27], s50 offen offset:0 nt lds
v_mfma_f32_16x16x32_bf16 v[180:183], a[16:19], v[36:39], v[180:183]
v_exp_f32 v44, v44
v_mfma_f32_16x16x32_bf16 v[192:195], a[20:23], v[36:39], v[192:195]
ds_read_b64_tr_b16 a[40:41], v9 offset:34240
ds_read_b64_tr_b16 a[42:43], v9 offset:34752
v_mfma_f32_16x16x32_bf16 v[188:191], a[20:23], v[32:35], v[188:191]
buffer_load_dwordx4 v1, s[24:27], s50 offen offset:1056 nt lds
v_mfma_f32_16x16x32_bf16 v[184:187], a[20:23], v[28:31], v[184:187]
s_waitcnt lgkmcnt(6)
v_add_f32 v10, v10, v42
v_mfma_f32_16x16x32_bf16 v[196:199], a[24:27], v[28:31], v[196:199]
ds_read_b64_tr_b16 a[44:45], v9 offset:34272
ds_read_b64_tr_b16 a[46:47], v9 offset:34784
v_mfma_f32_16x16x32_bf16 v[200:203], a[24:27], v[32:35], v[200:203]
buffer_load_dwordx4 v2, s[24:27], s50 offen offset:2112 nt lds
v_mfma_f32_16x16x32_bf16 v[204:207], a[24:27], v[36:39], v[204:207]
v_exp_f32 v45, v45
v_mfma_f32_16x16x32_bf16 v[216:219], a[28:31], v[36:39], v[216:219]
ds_read_b128 a[16:19], v8 offset:50688
v_add_f32 v10, v10, v43
v_mfma_f32_16x16x32_bf16 v[212:215], a[28:31], v[32:35], v[212:215]
v_exp_f32 v46, v46
v_mfma_f32_16x16x32_bf16 v[208:211], a[28:31], v[28:31], v[208:211]
s_waitcnt lgkmcnt(5)
v_add_f32 v11, v11, v44
v_mfma_f32_16x16x32_bf16 v[220:223], a[32:35], v[28:31], v[220:223]
ds_read_b128 a[20:23], v8 offset:50752
v_add_f32 v11, v11, v45
v_mfma_f32_16x16x32_bf16 v[224:227], a[32:35], v[32:35], v[224:227]
v_exp_f32 v47, v47
v_mfma_f32_16x16x32_bf16 v[228:231], a[32:35], v[36:39], v[228:231]
v_exp_f32 v48, v48
v_mfma_f32_16x16x32_bf16 v[240:243], a[36:39], v[36:39], v[240:243]
ds_read_b128 a[24:27], v8 offset:50816
v_add_f32 v11, v11, v46
v_mfma_f32_16x16x32_bf16 v[236:239], a[36:39], v[32:35], v[236:239]
v_exp_f32 v49, v49
v_mfma_f32_16x16x32_bf16 v[232:235], a[36:39], v[28:31], v[232:235]
s_waitcnt lgkmcnt(3)
v_add_f32 v11, v11, v47
v_mfma_f32_16x16x32_bf16 v[244:247], a[40:43], v[28:31], v[244:247]
ds_read_b128 a[28:31], v8 offset:50880
v_add_f32 v12, v12, v48
v_mfma_f32_16x16x32_bf16 v[248:251], a[40:43], v[32:35], v[248:251]
v_exp_f32 v50, v50
v_mfma_f32_16x16x32_bf16 a[0:3], a[40:43], v[36:39], a[0:3]
v_exp_f32 v51, v51
v_mfma_f32_16x16x32_bf16 a[12:15], a[44:47], v[36:39], a[12:15]
ds_read_b128 a[32:35], v8 offset:50944
buffer_load_dwordx4 v3, s[24:27], s50 offen offset:3168 nt lds
v_mfma_f32_16x16x32_bf16 a[8:11], a[44:47], v[32:35], a[8:11]
v_add_f32 v12, v12, v49
v_add_f32 v12, v12, v50
v_mfma_f32_16x16x32_bf16 a[4:7], a[44:47], v[28:31], a[4:7]
s_waitcnt lgkmcnt(3)
v_add_f32 v12, v12, v51
LS_65:
v_mfma_f32_16x16x32_bf16 v[64:67], a[16:19], a[48:51], v[16:19]
ds_read_b128 a[36:39], v8 offset:51008
v_cvt_pk_bf16_f32 v28, v40, v41
v_mfma_f32_16x16x32_bf16 v[64:67], a[20:23], a[60:63], v[64:67]
v_exp_f32 v52, v52
v_mfma_f32_16x16x32_bf16 v[68:71], a[20:23], a[64:67], v[20:23]
v_exp_f32 v53, v53
v_mfma_f32_16x16x32_bf16 v[68:71], a[16:19], a[52:55], v[68:71]
ds_read_b128 a[40:43], v8 offset:51072
v_cvt_pk_bf16_f32 v29, v42, v43
v_mfma_f32_16x16x32_bf16 v[72:75], a[16:19], a[56:59], v[24:27]
v_exp_f32 v54, v54
v_mfma_f32_16x16x32_bf16 v[72:75], a[20:23], a[68:71], v[72:75]
s_waitcnt lgkmcnt(3)
v_cvt_pk_bf16_f32 v32, v44, v45
v_mfma_f32_16x16x32_bf16 v[72:75], a[24:27], a[80:83], v[72:75]
ds_read_b128 a[44:47], v8 offset:51136
v_cvt_pk_bf16_f32 v33, v46, v47
v_mfma_f32_16x16x32_bf16 v[72:75], a[28:31], a[92:95], v[72:75]
v_exp_f32 v55, v55
v_mfma_f32_16x16x32_bf16 v[68:71], a[28:31], a[88:91], v[68:71]
v_exp_f32 v56, v56
v_mfma_f32_16x16x32_bf16 v[68:71], a[24:27], a[76:79], v[68:71]
ds_read_b128 a[16:19], v8 offset:51200
v_cvt_pk_bf16_f32 v36, v48, v49
v_mfma_f32_16x16x32_bf16 v[64:67], a[24:27], a[72:75], v[64:67]
v_exp_f32 v57, v57
v_mfma_f32_16x16x32_bf16 v[64:67], a[28:31], a[84:87], v[64:67]
s_waitcnt lgkmcnt(3)
v_cvt_pk_bf16_f32 v37, v50, v51
v_mfma_f32_16x16x32_bf16 v[64:67], a[32:35], a[96:99], v[64:67]
ds_read_b128 a[20:23], v8 offset:51264
v_cvt_pk_bf16_f32 v30, v52, v53
v_mfma_f32_16x16x32_bf16 v[64:67], a[36:39], a[108:111], v[64:67]
v_exp_f32 v58, v58
v_mfma_f32_16x16x32_bf16 v[68:71], a[36:39], a[112:115], v[68:71]
v_exp_f32 v59, v59
v_mfma_f32_16x16x32_bf16 v[68:71], a[32:35], a[100:103], v[68:71]
ds_read_b128 a[24:27], v8 offset:51328
v_cvt_pk_bf16_f32 v31, v54, v55
v_mfma_f32_16x16x32_bf16 v[72:75], a[32:35], a[104:107], v[72:75]
v_exp_f32 v60, v60
v_mfma_f32_16x16x32_bf16 v[72:75], a[36:39], a[116:119], v[72:75]
s_waitcnt lgkmcnt(3)
v_cvt_pk_bf16_f32 v34, v56, v57
v_mfma_f32_16x16x32_bf16 v[72:75], a[40:43], a[128:131], v[72:75]
ds_read_b128 a[28:31], v8 offset:51392
v_cvt_pk_bf16_f32 v35, v58, v59
v_mfma_f32_16x16x32_bf16 v[72:75], a[44:47], a[140:143], v[72:75]
v_exp_f32 v61, v61
v_mfma_f32_16x16x32_bf16 v[68:71], a[44:47], a[136:139], v[68:71]
s_waitcnt vmcnt(24)
s_barrier
v_mfma_f32_16x16x32_bf16 v[68:71], a[40:43], a[124:127], v[68:71]
ds_read_b128 a[32:35], v8 offset:51456
v_cvt_pk_bf16_f32 v38, v60, v61
v_mfma_f32_16x16x32_bf16 v[64:67], a[40:43], a[120:123], v[64:67]
s_add_u32 m0, s17, 118272
s_mov_b32 s50, 352256
v_mfma_f32_16x16x32_bf16 v[64:67], a[44:47], a[132:135], v[64:67]
s_waitcnt lgkmcnt(3)
v_add_f32 v10, v10, v52
v_mfma_f32_16x16x32_bf16 v[40:43], a[16:19], a[48:51], v[16:19]
ds_read_b128 a[36:39], v8 offset:51520
v_add_f32 v10, v10, v53
v_mfma_f32_16x16x32_bf16 v[40:43], a[20:23], a[60:63], v[40:43]
buffer_load_dwordx4 v0, s[20:23], s50 offen offset:0 nt lds
v_mfma_f32_16x16x32_bf16 v[44:47], a[20:23], a[64:67], v[20:23]
v_exp_f32 v62, v62
v_mfma_f32_16x16x32_bf16 v[44:47], a[16:19], a[52:55], v[44:47]
ds_read_b128 a[40:43], v8 offset:51584
v_max3_f32 v13, v64, v65, v66
v_mfma_f32_16x16x32_bf16 v[48:51], a[16:19], a[56:59], v[24:27]
buffer_load_dwordx4 v1, s[20:23], s50 offen offset:1056 nt lds
v_mfma_f32_16x16x32_bf16 v[48:51], a[20:23], a[68:71], v[48:51]
s_waitcnt lgkmcnt(3)
v_max3_f32 v13, v13, v67, v68
v_mfma_f32_16x16x32_bf16 v[48:51], a[24:27], a[80:83], v[48:51]
ds_read_b128 a[44:47], v8 offset:51648
v_max3_f32 v13, v13, v69, v70
v_mfma_f32_16x16x32_bf16 v[48:51], a[28:31], a[92:95], v[48:51]
v_exp_f32 v63, v63
v_mfma_f32_16x16x32_bf16 v[44:47], a[28:31], a[88:91], v[44:47]
buffer_load_dwordx4 v2, s[20:23], s50 offen offset:2112 nt lds
v_mfma_f32_16x16x32_bf16 v[44:47], a[24:27], a[76:79], v[44:47]
v_subrev_u32 v9, 50688, v9
ds_read_b64_tr_b16 a[16:17], v9 offset:33792
v_mfma_f32_16x16x32_bf16 v[40:43], a[24:27], a[72:75], v[40:43]
ds_read_b64_tr_b16 a[18:19], v9 offset:34304
v_cvt_pk_bf16_f32 v39, v62, v63
v_mfma_f32_16x16x32_bf16 v[40:43], a[28:31], a[84:87], v[40:43]
s_waitcnt lgkmcnt(4)
v_max3_f32 v13, v13, v71, v72
v_mfma_f32_16x16x32_bf16 v[40:43], a[32:35], a[96:99], v[40:43]
ds_read_b64_tr_b16 a[20:21], v9 offset:33824
v_max3_f32 v13, v13, v73, v74
v_mfma_f32_16x16x32_bf16 v[40:43], a[36:39], a[108:111], v[40:43]
ds_read_b64_tr_b16 a[22:23], v9 offset:34336
v_add_f32 v10, v10, v54
v_mfma_f32_16x16x32_bf16 v[44:47], a[36:39], a[112:115], v[44:47]
buffer_load_dwordx4 v3, s[20:23], s50 offen offset:3168 nt lds
v_mfma_f32_16x16x32_bf16 v[44:47], a[32:35], a[100:103], v[44:47]
ds_read_b64_tr_b16 a[24:25], v9 offset:33856
v_add_f32 v10, v10, v55
v_mfma_f32_16x16x32_bf16 v[48:51], a[32:35], a[104:107], v[48:51]
ds_read_b64_tr_b16 a[26:27], v9 offset:34368
v_add_f32 v11, v11, v56
v_mfma_f32_16x16x32_bf16 v[48:51], a[36:39], a[116:119], v[48:51]
s_waitcnt lgkmcnt(6)
v_add_f32 v11, v11, v57
v_mfma_f32_16x16x32_bf16 v[48:51], a[40:43], a[128:131], v[48:51]
ds_read_b64_tr_b16 a[28:29], v9 offset:33888
v_add_f32 v11, v11, v58
v_mfma_f32_16x16x32_bf16 v[48:51], a[44:47], a[140:143], v[48:51]
ds_read_b64_tr_b16 a[30:31], v9 offset:34400
v_add_f32 v11, v11, v59
v_mfma_f32_16x16x32_bf16 v[44:47], a[44:47], a[136:139], v[44:47]
v_add_f32 v12, v12, v60
v_add_f32 v12, v12, v61
v_mfma_f32_16x16x32_bf16 v[44:47], a[40:43], a[124:127], v[44:47]
ds_read_b64_tr_b16 a[32:33], v9 offset:33920
v_add_f32 v12, v12, v62
v_mfma_f32_16x16x32_bf16 v[40:43], a[40:43], a[120:123], v[40:43]
ds_read_b64_tr_b16 a[34:35], v9 offset:34432
v_add_f32 v12, v12, v63
v_mfma_f32_16x16x32_bf16 v[40:43], a[44:47], a[132:135], v[40:43]
s_waitcnt lgkmcnt(6)
v_max_f32 v13, v13, v75
LS_66:
v_mfma_f32_16x16x32_bf16 v[76:79], a[16:19], v[28:31], v[76:79]
ds_read_b64_tr_b16 a[36:37], v9 offset:33952
v_mfma_f32_16x16x32_bf16 v[80:83], a[16:19], v[32:35], v[80:83]
ds_read_b64_tr_b16 a[38:39], v9 offset:34464
v_mfma_f32_16x16x32_bf16 v[84:87], a[16:19], v[36:39], v[84:87]
v_mfma_f32_16x16x32_bf16 v[96:99], a[20:23], v[36:39], v[96:99]
ds_read_b64_tr_b16 a[40:41], v9 offset:33984
v_max3_f32 v13, v13, v40, v41
v_mfma_f32_16x16x32_bf16 v[92:95], a[20:23], v[32:35], v[92:95]
ds_read_b64_tr_b16 a[42:43], v9 offset:34496
v_max3_f32 v13, v13, v42, v43
v_mfma_f32_16x16x32_bf16 v[88:91], a[20:23], v[28:31], v[88:91]
s_waitcnt lgkmcnt(6)
v_max3_f32 v13, v13, v44, v45
v_mfma_f32_16x16x32_bf16 v[100:103], a[24:27], v[28:31], v[100:103]
ds_read_b64_tr_b16 a[44:45], v9 offset:34016
v_max3_f32 v13, v13, v46, v47
v_mfma_f32_16x16x32_bf16 v[104:107], a[24:27], v[32:35], v[104:107]
ds_read_b64_tr_b16 a[46:47], v9 offset:34528
v_max3_f32 v13, v13, v48, v49
v_mfma_f32_16x16x32_bf16 v[108:111], a[24:27], v[36:39], v[108:111]
v_max3_f32 v13, v13, v50, v51
v_mfma_f32_16x16x32_bf16 v[120:123], a[28:31], v[36:39], v[120:123]
ds_read_b64_tr_b16 a[16:17], v9 offset:34048
v_cmp_lt_f32 vcc, s47, v13
v_mfma_f32_16x16x32_bf16 v[116:119], a[28:31], v[32:35], v[116:119]
ds_read_b64_tr_b16 a[18:19], v9 offset:34560
v_mfma_f32_16x16x32_bf16 v[112:115], a[28:31], v[28:31], v[112:115]
s_waitcnt lgkmcnt(6)
s_cbranch_vccnz RARE_h1j2
RET_h1j2:
v_mfma_f32_16x16x32_bf16 v[124:127], a[32:35], v[28:31], v[124:127]
ds_read_b64_tr_b16 a[20:21], v9 offset:34080
ds_read_b64_tr_b16 a[22:23], v9 offset:34592
v_mfma_f32_16x16x32_bf16 v[128:131], a[32:35], v[32:35], v[128:131]
v_exp_f32 v40, v40
v_mfma_f32_16x16x32_bf16 v[132:135], a[32:35], v[36:39], v[132:135]
v_exp_f32 v41, v41
v_mfma_f32_16x16x32_bf16 v[144:147], a[36:39], v[36:39], v[144:147]
ds_read_b64_tr_b16 a[24:25], v9 offset:34112
ds_read_b64_tr_b16 a[26:27], v9 offset:34624
v_mfma_f32_16x16x32_bf16 v[140:143], a[36:39], v[32:35], v[140:143]
v_exp_f32 v42, v42
v_mfma_f32_16x16x32_bf16 v[136:139], a[36:39], v[28:31], v[136:139]
s_waitcnt lgkmcnt(6)
v_add_f32 v10, v10, v40
v_mfma_f32_16x16x32_bf16 v[148:151], a[40:43], v[28:31], v[148:151]
ds_read_b64_tr_b16 a[28:29], v9 offset:34144
ds_read_b64_tr_b16 a[30:31], v9 offset:34656
v_mfma_f32_16x16x32_bf16 v[152:155], a[40:43], v[32:35], v[152:155]
v_exp_f32 v43, v43
v_mfma_f32_16x16x32_bf16 v[156:159], a[40:43], v[36:39], v[156:159]
s_waitcnt vmcnt(24)
s_barrier
v_mfma_f32_16x16x32_bf16 v[168:171], a[44:47], v[36:39], v[168:171]
ds_read_b64_tr_b16 a[32:33], v9 offset:34176
ds_read_b64_tr_b16 a[34:35], v9 offset:34688
v_mfma_f32_16x16x32_bf16 v[164:167], a[44:47], v[32:35], v[164:167]
s_add_u32 m0, s17, 50688
s_mov_b32 s50, 344064
v_mfma_f32_16x16x32_bf16 v[160:163], a[44:47], v[28:31], v[160:163]
s_waitcnt lgkmcnt(6)
v_add_f32 v10, v10, v41
v_mfma_f32_16x16x32_bf16 v[172:175], a[16:19], v[28:31], v[172:175]
ds_read_b64_tr_b16 a[36:37], v9 offset:34208
ds_read_b64_tr_b16 a[38:39], v9 offset:34720
v_mfma_f32_16x16x32_bf16 v[176:179], a[16:19], v[32:35], v[176:179]
buffer_load_dwordx4 v0, s[24:27], s50 offen offset:0 nt lds
v_mfma_f32_16x16x32_bf16 v[180:183], a[16:19], v[36:39], v[180:183]
v_exp_f32 v44, v44
v_mfma_f32_16x16x32_bf16 v[192:195], a[20:23], v[36:39], v[192:195]
ds_read_b64_tr_b16 a[40:41], v9 offset:34240
ds_read_b64_tr_b16 a[42:43], v9 offset:34752
v_mfma_f32_16x16x32_bf16 v[188:191], a[20:23], v[32:35], v[188:191]
buffer_load_dwordx4 v1, s[24:27], s50 offen offset:1056 nt lds
v_mfma_f32_16x16x32_bf16 v[184:187], a[20:23], v[28:31], v[184:187]
s_waitcnt lgkmcnt(6)
v_add_f32 v10, v10, v42
v_mfma_f32_16x16x32_bf16 v[196:199], a[24:27], v[28:31], v[196:199]
ds_read_b64_tr_b16 a[44:45], v9 offset:34272
ds_read_b64_tr_b16 a[46:47], v9 offset:34784
v_mfma_f32_16x16x32_bf16 v[200:203], a[24:27], v[32:35], v[200:203]
buffer_load_dwordx4 v2, s[24:27], s50 offen offset:2112 nt lds
v_mfma_f32_16x16x32_bf16 v[204:207], a[24:27], v[36:39], v[204:207]
v_exp_f32 v45, v45
v_mfma_f32_16x16x32_bf16 v[216:219], a[28:31], v[36:39], v[216:219]
v_add_u32 v8, 84480, v8
ds_read_b128 a[16:19], v8 offset:512
v_mfma_f32_16x16x32_bf16 v[212:215], a[28:31], v[32:35], v[212:215]
v_exp_f32 v46, v46
v_mfma_f32_16x16x32_bf16 v[208:211], a[28:31], v[28:31], v[208:211]
s_waitcnt lgkmcnt(5)
v_add_f32 v10, v10, v43
v_mfma_f32_16x16x32_bf16 v[220:223], a[32:35], v[28:31], v[220:223]
ds_read_b128 a[20:23], v8 offset:576
v_add_f32 v11, v11, v44
v_mfma_f32_16x16x32_bf16 v[224:227], a[32:35], v[32:35], v[224:227]
v_exp_f32 v47, v47
v_mfma_f32_16x16x32_bf16 v[228:231], a[32:35], v[36:39], v[228:231]
v_exp_f32 v48, v48
v_mfma_f32_16x16x32_bf16 v[240:243], a[36:39], v[36:39], v[240:243]
ds_read_b128 a[24:27], v8 offset:640
v_add_f32 v11, v11, v45
v_mfma_f32_16x16x32_bf16 v[236:239], a[36:39], v[32:35], v[236:239]
v_exp_f32 v49, v49
v_mfma_f32_16x16x32_bf16 v[232:235], a[36:39], v[28:31], v[232:235]
s_waitcnt lgkmcnt(3)
v_add_f32 v11, v11, v46
v_mfma_f32_16x16x32_bf16 v[244:247], a[40:43], v[28:31], v[244:247]
ds_read_b128 a[28:31], v8 offset:704
v_exp_f32 v50, v50
v_mfma_f32_16x16x32_bf16 v[248:251], a[40:43], v[32:35], v[248:251]
v_exp_f32 v51, v51
v_mfma_f32_16x16x32_bf16 a[0:3], a[40:43], v[36:39], a[0:3]
buffer_load_dwordx4 v3, s[24:27], s50 offen offset:3168 nt lds
v_mfma_f32_16x16x32_bf16 a[12:15], a[44:47], v[36:39], a[12:15]
ds_read_b128 a[32:35], v8 offset:768
v_add_f32 v11, v11, v47
v_add_f32 v12, v12, v48
v_mfma_f32_16x16x32_bf16 a[8:11], a[44:47], v[32:35], a[8:11]
v_add_f32 v12, v12, v49
v_add_f32 v12, v12, v50
v_mfma_f32_16x16x32_bf16 a[4:7], a[44:47], v[28:31], a[4:7]
s_waitcnt lgkmcnt(3)
v_add_f32 v12, v12, v51
LS_67:
v_mfma_f32_16x16x32_bf16 v[52:55], a[16:19], a[48:51], v[16:19]
ds_read_b128 a[36:39], v8 offset:832
v_cvt_pk_bf16_f32 v30, v40, v41
v_mfma_f32_16x16x32_bf16 v[52:55], a[20:23], a[60:63], v[52:55]
v_exp_f32 v64, v64
v_mfma_f32_16x16x32_bf16 v[56:59], a[20:23], a[64:67], v[20:23]
v_exp_f32 v65, v65
v_mfma_f32_16x16x32_bf16 v[56:59], a[16:19], a[52:55], v[56:59]
ds_read_b128 a[40:43], v8 offset:896
v_cvt_pk_bf16_f32 v31, v42, v43
v_mfma_f32_16x16x32_bf16 v[60:63], a[16:19], a[56:59], v[24:27]
v_exp_f32 v66, v66
v_mfma_f32_16x16x32_bf16 v[60:63], a[20:23], a[68:71], v[60:63]
s_waitcnt lgkmcnt(3)
v_cvt_pk_bf16_f32 v34, v44, v45
v_mfma_f32_16x16x32_bf16 v[60:63], a[24:27], a[80:83], v[60:63]
ds_read_b128 a[44:47], v8 offset:960
v_cvt_pk_bf16_f32 v35, v46, v47
v_mfma_f32_16x16x32_bf16 v[60:63], a[28:31], a[92:95], v[60:63]
v_exp_f32 v67, v67
v_mfma_f32_16x16x32_bf16 v[56:59], a[28:31], a[88:91], v[56:59]
v_exp_f32 v68, v68
v_mfma_f32_16x16x32_bf16 v[56:59], a[24:27], a[76:79], v[56:59]
ds_read_b128 a[16:19], v8 offset:0
v_cvt_pk_bf16_f32 v38, v48, v49
v_mfma_f32_16x16x32_bf16 v[52:55], a[24:27], a[72:75], v[52:55]
v_exp_f32 v69, v69
v_mfma_f32_16x16x32_bf16 v[52:55], a[28:31], a[84:87], v[52:55]
s_waitcnt lgkmcnt(3)
v_cvt_pk_bf16_f32 v39, v50, v51
v_mfma_f32_16x16x32_bf16 v[52:55], a[32:35], a[96:99], v[52:55]
ds_read_b128 a[20:23], v8 offset:64
v_cvt_pk_bf16_f32 v28, v64, v65
v_mfma_f32_16x16x32_bf16 v[52:55], a[36:39], a[108:111], v[52:55]
v_exp_f32 v70, v70
v_mfma_f32_16x16x32_bf16 v[56:59], a[36:39], a[112:115], v[56:59]
v_exp_f32 v71, v71
v_mfma_f32_16x16x32_bf16 v[56:59], a[32:35], a[100:103], v[56:59]
ds_read_b128 a[24:27], v8 offset:128
v_cvt_pk_bf16_f32 v29, v66, v67
v_mfma_f32_16x16x32_bf16 v[60:63], a[32:35], a[104:107], v[60:63]
v_exp_f32 v72, v72
v_mfma_f32_16x16x32_bf16 v[60:63], a[36:39], a[116:119], v[60:63]
s_waitcnt lgkmcnt(3)
v_cvt_pk_bf16_f32 v32, v68, v69
v_mfma_f32_16x16x32_bf16 v[60:63], a[40:43], a[128:131], v[60:63]
ds_read_b128 a[28:31], v8 offset:192
v_cvt_pk_bf16_f32 v33, v70, v71
v_mfma_f32_16x16x32_bf16 v[60:63], a[44:47], a[140:143], v[60:63]
v_exp_f32 v73, v73
v_mfma_f32_16x16x32_bf16 v[56:59], a[44:47], a[136:139], v[56:59]
s_waitcnt vmcnt(24)
s_barrier
v_mfma_f32_16x16x32_bf16 v[56:59], a[40:43], a[124:127], v[56:59]
ds_read_b128 a[32:35], v8 offset:256
v_cvt_pk_bf16_f32 v36, v72, v73
v_mfma_f32_16x16x32_bf16 v[52:55], a[40:43], a[120:123], v[52:55]
s_add_u32 m0, s17, 67584
s_mov_b32 s50, 393216
v_mfma_f32_16x16x32_bf16 v[52:55], a[44:47], a[132:135], v[52:55]
s_waitcnt lgkmcnt(3)
v_add_f32 v10, v10, v64
v_mfma_f32_16x16x32_bf16 v[40:43], a[16:19], a[48:51], v[16:19]
ds_read_b128 a[36:39], v8 offset:320
v_add_f32 v10, v10, v65
v_mfma_f32_16x16x32_bf16 v[40:43], a[20:23], a[60:63], v[40:43]
buffer_load_dwordx4 v0, s[20:23], s50 offen offset:0 nt lds
v_mfma_f32_16x16x32_bf16 v[44:47], a[20:23], a[64:67], v[20:23]
v_exp_f32 v74, v74
v_mfma_f32_16x16x32_bf16 v[44:47], a[16:19], a[52:55], v[44:47]
ds_read_b128 a[40:43], v8 offset:384
v_max3_f32 v13, v52, v53, v54
v_mfma_f32_16x16x32_bf16 v[48:51], a[16:19], a[56:59], v[24:27]
buffer_load_dwordx4 v1, s[20:23], s50 offen offset:1056 nt lds
v_mfma_f32_16x16x32_bf16 v[48:51], a[20:23], a[68:71], v[48:51]
s_waitcnt lgkmcnt(3)
v_max3_f32 v13, v13, v55, v56
v_mfma_f32_16x16x32_bf16 v[48:51], a[24:27], a[80:83], v[48:51]
ds_read_b128 a[44:47], v8 offset:448
v_max3_f32 v13, v13, v57, v58
v_mfma_f32_16x16x32_bf16 v[48:51], a[28:31], a[92:95], v[48:51]
v_exp_f32 v75, v75
v_mfma_f32_16x16x32_bf16 v[44:47], a[28:31], a[88:91], v[44:47]
buffer_load_dwordx4 v2, s[20:23], s50 offen offset:2112 nt lds
v_mfma_f32_16x16x32_bf16 v[44:47], a[24:27], a[76:79], v[44:47]
v_add_u32 v9, 50688, v9
ds_read_b64_tr_b16 a[16:17], v9 offset:16896
v_mfma_f32_16x16x32_bf16 v[40:43], a[24:27], a[72:75], v[40:43]
ds_read_b64_tr_b16 a[18:19], v9 offset:17408
v_cvt_pk_bf16_f32 v37, v74, v75
v_mfma_f32_16x16x32_bf16 v[40:43], a[28:31], a[84:87], v[40:43]
s_waitcnt lgkmcnt(4)
v_max3_f32 v13, v13, v59, v60
v_mfma_f32_16x16x32_bf16 v[40:43], a[32:35], a[96:99], v[40:43]
ds_read_b64_tr_b16 a[20:21], v9 offset:16928
v_max3_f32 v13, v13, v61, v62
v_mfma_f32_16x16x32_bf16 v[40:43], a[36:39], a[108:111], v[40:43]
ds_read_b64_tr_b16 a[22:23], v9 offset:17440
v_add_f32 v10, v10, v66
v_mfma_f32_16x16x32_bf16 v[44:47], a[36:39], a[112:115], v[44:47]
buffer_load_dwordx4 v3, s[20:23], s50 offen offset:3168 nt lds
v_mfma_f32_16x16x32_bf16 v[44:47], a[32:35], a[100:103], v[44:47]
ds_read_b64_tr_b16 a[24:25], v9 offset:16960
v_add_f32 v10, v10, v67
v_mfma_f32_16x16x32_bf16 v[48:51], a[32:35], a[104:107], v[48:51]
ds_read_b64_tr_b16 a[26:27], v9 offset:17472
v_add_f32 v11, v11, v68
v_mfma_f32_16x16x32_bf16 v[48:51], a[36:39], a[116:119], v[48:51]
s_waitcnt lgkmcnt(6)
v_add_f32 v11, v11, v69
v_mfma_f32_16x16x32_bf16 v[48:51], a[40:43], a[128:131], v[48:51]
ds_read_b64_tr_b16 a[28:29], v9 offset:16992
v_add_f32 v11, v11, v70
v_mfma_f32_16x16x32_bf16 v[48:51], a[44:47], a[140:143], v[48:51]
ds_read_b64_tr_b16 a[30:31], v9 offset:17504
v_add_f32 v11, v11, v71
v_mfma_f32_16x16x32_bf16 v[44:47], a[44:47], a[136:139], v[44:47]
v_add_f32 v12, v12, v72
v_add_f32 v12, v12, v73
v_mfma_f32_16x16x32_bf16 v[44:47], a[40:43], a[124:127], v[44:47]
ds_read_b64_tr_b16 a[32:33], v9 offset:17024
v_add_f32 v12, v12, v74
v_mfma_f32_16x16x32_bf16 v[40:43], a[40:43], a[120:123], v[40:43]
ds_read_b64_tr_b16 a[34:35], v9 offset:17536
v_add_f32 v12, v12, v75
v_mfma_f32_16x16x32_bf16 v[40:43], a[44:47], a[132:135], v[40:43]
s_waitcnt lgkmcnt(6)
v_max_f32 v13, v13, v63
LS_68:
v_mfma_f32_16x16x32_bf16 v[76:79], a[16:19], v[28:31], v[76:79]
ds_read_b64_tr_b16 a[36:37], v9 offset:17056
v_mfma_f32_16x16x32_bf16 v[80:83], a[16:19], v[32:35], v[80:83]
ds_read_b64_tr_b16 a[38:39], v9 offset:17568
v_mfma_f32_16x16x32_bf16 v[84:87], a[16:19], v[36:39], v[84:87]
v_mfma_f32_16x16x32_bf16 v[96:99], a[20:23], v[36:39], v[96:99]
ds_read_b64_tr_b16 a[40:41], v9 offset:17088
v_max3_f32 v13, v13, v40, v41
v_mfma_f32_16x16x32_bf16 v[92:95], a[20:23], v[32:35], v[92:95]
ds_read_b64_tr_b16 a[42:43], v9 offset:17600
v_max3_f32 v13, v13, v42, v43
v_mfma_f32_16x16x32_bf16 v[88:91], a[20:23], v[28:31], v[88:91]
s_waitcnt lgkmcnt(6)
v_max3_f32 v13, v13, v44, v45
v_mfma_f32_16x16x32_bf16 v[100:103], a[24:27], v[28:31], v[100:103]
ds_read_b64_tr_b16 a[44:45], v9 offset:17120
v_max3_f32 v13, v13, v46, v47
v_mfma_f32_16x16x32_bf16 v[104:107], a[24:27], v[32:35], v[104:107]
ds_read_b64_tr_b16 a[46:47], v9 offset:17632
v_max3_f32 v13, v13, v48, v49
v_mfma_f32_16x16x32_bf16 v[108:111], a[24:27], v[36:39], v[108:111]
v_max3_f32 v13, v13, v50, v51
v_mfma_f32_16x16x32_bf16 v[120:123], a[28:31], v[36:39], v[120:123]
ds_read_b64_tr_b16 a[16:17], v9 offset:17152
v_cmp_lt_f32 vcc, s47, v13
v_mfma_f32_16x16x32_bf16 v[116:119], a[28:31], v[32:35], v[116:119]
ds_read_b64_tr_b16 a[18:19], v9 offset:17664
v_mfma_f32_16x16x32_bf16 v[112:115], a[28:31], v[28:31], v[112:115]
s_waitcnt lgkmcnt(6)
s_cbranch_vccnz RARE_h1j3
RET_h1j3:
v_mfma_f32_16x16x32_bf16 v[124:127], a[32:35], v[28:31], v[124:127]
ds_read_b64_tr_b16 a[20:21], v9 offset:17184
ds_read_b64_tr_b16 a[22:23], v9 offset:17696
v_mfma_f32_16x16x32_bf16 v[128:131], a[32:35], v[32:35], v[128:131]
v_exp_f32 v40, v40
v_mfma_f32_16x16x32_bf16 v[132:135], a[32:35], v[36:39], v[132:135]
v_exp_f32 v41, v41
v_mfma_f32_16x16x32_bf16 v[144:147], a[36:39], v[36:39], v[144:147]
ds_read_b64_tr_b16 a[24:25], v9 offset:17216
ds_read_b64_tr_b16 a[26:27], v9 offset:17728
v_mfma_f32_16x16x32_bf16 v[140:143], a[36:39], v[32:35], v[140:143]
v_exp_f32 v42, v42
v_mfma_f32_16x16x32_bf16 v[136:139], a[36:39], v[28:31], v[136:139]
s_waitcnt lgkmcnt(6)
v_add_f32 v10, v10, v40
v_mfma_f32_16x16x32_bf16 v[148:151], a[40:43], v[28:31], v[148:151]
ds_read_b64_tr_b16 a[28:29], v9 offset:17248
ds_read_b64_tr_b16 a[30:31], v9 offset:17760
v_mfma_f32_16x16x32_bf16 v[152:155], a[40:43], v[32:35], v[152:155]
v_exp_f32 v43, v43
v_mfma_f32_16x16x32_bf16 v[156:159], a[40:43], v[36:39], v[156:159]
s_waitcnt vmcnt(24)
s_barrier
v_mfma_f32_16x16x32_bf16 v[168:171], a[44:47], v[36:39], v[168:171]
ds_read_b64_tr_b16 a[32:33], v9 offset:17280
ds_read_b64_tr_b16 a[34:35], v9 offset:17792
v_mfma_f32_16x16x32_bf16 v[164:167], a[44:47], v[32:35], v[164:167]
s_add_u32 m0, s17, 84480
s_mov_b32 s50, 352256
v_mfma_f32_16x16x32_bf16 v[160:163], a[44:47], v[28:31], v[160:163]
s_waitcnt lgkmcnt(6)
v_add_f32 v10, v10, v41
v_mfma_f32_16x16x32_bf16 v[172:175], a[16:19], v[28:31], v[172:175]
ds_read_b64_tr_b16 a[36:37], v9 offset:17312
ds_read_b64_tr_b16 a[38:39], v9 offset:17824
v_mfma_f32_16x16x32_bf16 v[176:179], a[16:19], v[32:35], v[176:179]
buffer_load_dwordx4 v0, s[24:27], s50 offen offset:0 nt lds
v_mfma_f32_16x16x32_bf16 v[180:183], a[16:19], v[36:39], v[180:183]
v_exp_f32 v44, v44
v_mfma_f32_16x16x32_bf16 v[192:195], a[20:23], v[36:39], v[192:195]
ds_read_b64_tr_b16 a[40:41], v9 offset:17344
ds_read_b64_tr_b16 a[42:43], v9 offset:17856
v_mfma_f32_16x16x32_bf16 v[188:191], a[20:23], v[32:35], v[188:191]
buffer_load_dwordx4 v1, s[24:27], s50 offen offset:1056 nt lds
v_mfma_f32_16x16x32_bf16 v[184:187], a[20:23], v[28:31], v[184:187]
s_waitcnt lgkmcnt(6)
v_add_f32 v10, v10, v42
v_mfma_f32_16x16x32_bf16 v[196:199], a[24:27], v[28:31], v[196:199]
ds_read_b64_tr_b16 a[44:45], v9 offset:17376
ds_read_b64_tr_b16 a[46:47], v9 offset:17888
v_mfma_f32_16x16x32_bf16 v[200:203], a[24:27], v[32:35], v[200:203]
buffer_load_dwordx4 v2, s[24:27], s50 offen offset:2112 nt lds
v_mfma_f32_16x16x32_bf16 v[204:207], a[24:27], v[36:39], v[204:207]
v_exp_f32 v45, v45
v_mfma_f32_16x16x32_bf16 v[216:219], a[28:31], v[36:39], v[216:219]
v_subrev_u32 v8, 84480, v8
ds_read_b128 a[16:19], v8 offset:16896
v_mfma_f32_16x16x32_bf16 v[212:215], a[28:31], v[32:35], v[212:215]
v_exp_f32 v46, v46
v_mfma_f32_16x16x32_bf16 v[208:211], a[28:31], v[28:31], v[208:211]
s_waitcnt lgkmcnt(5)
v_add_f32 v10, v10, v43
v_mfma_f32_16x16x32_bf16 v[220:223], a[32:35], v[28:31], v[220:223]
ds_read_b128 a[20:23], v8 offset:16960
v_add_f32 v11, v11, v44
v_mfma_f32_16x16x32_bf16 v[224:227], a[32:35], v[32:35], v[224:227]
v_exp_f32 v47, v47
v_mfma_f32_16x16x32_bf16 v[228:231], a[32:35], v[36:39], v[228:231]
v_exp_f32 v48, v48
v_mfma_f32_16x16x32_bf16 v[240:243], a[36:39], v[36:39], v[240:243]
ds_read_b128 a[24:27], v8 offset:17024
v_add_f32 v11, v11, v45
v_mfma_f32_16x16x32_bf16 v[236:239], a[36:39], v[32:35], v[236:239]
v_exp_f32 v49, v49
v_mfma_f32_16x16x32_bf16 v[232:235], a[36:39], v[28:31], v[232:235]
s_waitcnt lgkmcnt(3)
v_add_f32 v11, v11, v46
v_mfma_f32_16x16x32_bf16 v[244:247], a[40:43], v[28:31], v[244:247]
ds_read_b128 a[28:31], v8 offset:17088
v_exp_f32 v50, v50
v_mfma_f32_16x16x32_bf16 v[248:251], a[40:43], v[32:35], v[248:251]
v_exp_f32 v51, v51
v_mfma_f32_16x16x32_bf16 a[0:3], a[40:43], v[36:39], a[0:3]
buffer_load_dwordx4 v3, s[24:27], s50 offen offset:3168 nt lds
v_mfma_f32_16x16x32_bf16 a[12:15], a[44:47], v[36:39], a[12:15]
ds_read_b128 a[32:35], v8 offset:17152
v_add_f32 v11, v11, v47
v_add_f32 v12, v12, v48
v_mfma_f32_16x16x32_bf16 a[8:11], a[44:47], v[32:35], a[8:11]
v_add_f32 v12, v12, v49
v_add_f32 v12, v12, v50
v_mfma_f32_16x16x32_bf16 a[4:7], a[44:47], v[28:31], a[4:7]
s_waitcnt lgkmcnt(3)
v_add_f32 v12, v12, v51
LS_69:
v_mfma_f32_16x16x32_bf16 v[64:67], a[16:19], a[48:51], v[16:19]
ds_read_b128 a[36:39], v8 offset:17216
v_cvt_pk_bf16_f32 v28, v40, v41
v_mfma_f32_16x16x32_bf16 v[64:67], a[20:23], a[60:63], v[64:67]
v_exp_f32 v52, v52
v_mfma_f32_16x16x32_bf16 v[68:71], a[20:23], a[64:67], v[20:23]
v_exp_f32 v53, v53
v_mfma_f32_16x16x32_bf16 v[68:71], a[16:19], a[52:55], v[68:71]
ds_read_b128 a[40:43], v8 offset:17280
v_cvt_pk_bf16_f32 v29, v42, v43
v_mfma_f32_16x16x32_bf16 v[72:75], a[16:19], a[56:59], v[24:27]
v_exp_f32 v54, v54
v_mfma_f32_16x16x32_bf16 v[72:75], a[20:23], a[68:71], v[72:75]
s_waitcnt lgkmcnt(3)
v_cvt_pk_bf16_f32 v32, v44, v45
v_mfma_f32_16x16x32_bf16 v[72:75], a[24:27], a[80:83], v[72:75]
ds_read_b128 a[44:47], v8 offset:17344
v_cvt_pk_bf16_f32 v33, v46, v47
v_mfma_f32_16x16x32_bf16 v[72:75], a[28:31], a[92:95], v[72:75]
v_exp_f32 v55, v55
v_mfma_f32_16x16x32_bf16 v[68:71], a[28:31], a[88:91], v[68:71]
v_exp_f32 v56, v56
v_mfma_f32_16x16x32_bf16 v[68:71], a[24:27], a[76:79], v[68:71]
ds_read_b128 a[16:19], v8 offset:17408
v_cvt_pk_bf16_f32 v36, v48, v49
v_mfma_f32_16x16x32_bf16 v[64:67], a[24:27], a[72:75], v[64:67]
v_exp_f32 v57, v57
v_mfma_f32_16x16x32_bf16 v[64:67], a[28:31], a[84:87], v[64:67]
s_waitcnt lgkmcnt(3)
v_cvt_pk_bf16_f32 v37, v50, v51
v_mfma_f32_16x16x32_bf16 v[64:67], a[32:35], a[96:99], v[64:67]
ds_read_b128 a[20:23], v8 offset:17472
v_cvt_pk_bf16_f32 v30, v52, v53
v_mfma_f32_16x16x32_bf16 v[64:67], a[36:39], a[108:111], v[64:67]
v_exp_f32 v58, v58
v_mfma_f32_16x16x32_bf16 v[68:71], a[36:39], a[112:115], v[68:71]
v_exp_f32 v59, v59
v_mfma_f32_16x16x32_bf16 v[68:71], a[32:35], a[100:103], v[68:71]
ds_read_b128 a[24:27], v8 offset:17536
v_cvt_pk_bf16_f32 v31, v54, v55
v_mfma_f32_16x16x32_bf16 v[72:75], a[32:35], a[104:107], v[72:75]
v_exp_f32 v60, v60
v_mfma_f32_16x16x32_bf16 v[72:75], a[36:39], a[116:119], v[72:75]
s_waitcnt lgkmcnt(3)
v_cvt_pk_bf16_f32 v34, v56, v57
v_mfma_f32_16x16x32_bf16 v[72:75], a[40:43], a[128:131], v[72:75]
ds_read_b128 a[28:31], v8 offset:17600
v_cvt_pk_bf16_f32 v35, v58, v59
v_mfma_f32_16x16x32_bf16 v[72:75], a[44:47], a[140:143], v[72:75]
v_exp_f32 v61, v61
v_mfma_f32_16x16x32_bf16 v[68:71], a[44:47], a[136:139], v[68:71]
s_waitcnt vmcnt(24)
s_barrier
v_mfma_f32_16x16x32_bf16 v[68:71], a[40:43], a[124:127], v[68:71]
ds_read_b128 a[32:35], v8 offset:17664
v_cvt_pk_bf16_f32 v38, v60, v61
v_mfma_f32_16x16x32_bf16 v[64:67], a[40:43], a[120:123], v[64:67]
s_add_u32 m0, s17, 101376
s_mov_b32 s50, 401408
v_mfma_f32_16x16x32_bf16 v[64:67], a[44:47], a[132:135], v[64:67]
s_waitcnt lgkmcnt(3)
v_add_f32 v10, v10, v52
v_mfma_f32_16x16x32_bf16 v[40:43], a[16:19], a[48:51], v[16:19]
ds_read_b128 a[36:39], v8 offset:17728
v_add_f32 v10, v10, v53
v_mfma_f32_16x16x32_bf16 v[40:43], a[20:23], a[60:63], v[40:43]
buffer_load_dwordx4 v0, s[20:23], s50 offen offset:0 nt lds
v_mfma_f32_16x16x32_bf16 v[44:47], a[20:23], a[64:67], v[20:23]
v_exp_f32 v62, v62
v_mfma_f32_16x16x32_bf16 v[44:47], a[16:19], a[52:55], v[44:47]
ds_read_b128 a[40:43], v8 offset:17792
v_max3_f32 v13, v64, v65, v66
v_mfma_f32_16x16x32_bf16 v[48:51], a[16:19], a[56:59], v[24:27]
buffer_load_dwordx4 v1, s[20:23], s50 offen offset:1056 nt lds
v_mfma_f32_16x16x32_bf16 v[48:51], a[20:23], a[68:71], v[48:51]
s_waitcnt lgkmcnt(3)
v_max3_f32 v13, v13, v67, v68
v_mfma_f32_16x16x32_bf16 v[48:51], a[24:27], a[80:83], v[48:51]
ds_read_b128 a[44:47], v8 offset:17856
v_max3_f32 v13, v13, v69, v70
v_mfma_f32_16x16x32_bf16 v[48:51], a[28:31], a[92:95], v[48:51]
v_exp_f32 v63, v63
v_mfma_f32_16x16x32_bf16 v[44:47], a[28:31], a[88:91], v[44:47]
buffer_load_dwordx4 v2, s[20:23], s50 offen offset:2112 nt lds
v_mfma_f32_16x16x32_bf16 v[44:47], a[24:27], a[76:79], v[44:47]
v_subrev_u32 v9, 84480, v9
ds_read_b64_tr_b16 a[16:17], v9 offset:0
v_mfma_f32_16x16x32_bf16 v[40:43], a[24:27], a[72:75], v[40:43]
ds_read_b64_tr_b16 a[18:19], v9 offset:512
v_cvt_pk_bf16_f32 v39, v62, v63
v_mfma_f32_16x16x32_bf16 v[40:43], a[28:31], a[84:87], v[40:43]
s_waitcnt lgkmcnt(4)
v_max3_f32 v13, v13, v71, v72
v_mfma_f32_16x16x32_bf16 v[40:43], a[32:35], a[96:99], v[40:43]
ds_read_b64_tr_b16 a[20:21], v9 offset:32
v_max3_f32 v13, v13, v73, v74
v_mfma_f32_16x16x32_bf16 v[40:43], a[36:39], a[108:111], v[40:43]
ds_read_b64_tr_b16 a[22:23], v9 offset:544
v_add_f32 v10, v10, v54
v_mfma_f32_16x16x32_bf16 v[44:47], a[36:39], a[112:115], v[44:47]
buffer_load_dwordx4 v3, s[20:23], s50 offen offset:3168 nt lds
v_mfma_f32_16x16x32_bf16 v[44:47], a[32:35], a[100:103], v[44:47]
ds_read_b64_tr_b16 a[24:25], v9 offset:64
v_add_f32 v10, v10, v55
v_mfma_f32_16x16x32_bf16 v[48:51], a[32:35], a[104:107], v[48:51]
ds_read_b64_tr_b16 a[26:27], v9 offset:576
v_add_f32 v11, v11, v56
v_mfma_f32_16x16x32_bf16 v[48:51], a[36:39], a[116:119], v[48:51]
s_waitcnt lgkmcnt(6)
v_add_f32 v11, v11, v57
v_mfma_f32_16x16x32_bf16 v[48:51], a[40:43], a[128:131], v[48:51]
ds_read_b64_tr_b16 a[28:29], v9 offset:96
v_add_f32 v11, v11, v58
v_mfma_f32_16x16x32_bf16 v[48:51], a[44:47], a[140:143], v[48:51]
ds_read_b64_tr_b16 a[30:31], v9 offset:608
v_add_f32 v11, v11, v59
v_mfma_f32_16x16x32_bf16 v[44:47], a[44:47], a[136:139], v[44:47]
v_add_f32 v12, v12, v60
v_add_f32 v12, v12, v61
v_mfma_f32_16x16x32_bf16 v[44:47], a[40:43], a[124:127], v[44:47]
ds_read_b64_tr_b16 a[32:33], v9 offset:128
v_add_f32 v12, v12, v62
v_mfma_f32_16x16x32_bf16 v[40:43], a[40:43], a[120:123], v[40:43]
ds_read_b64_tr_b16 a[34:35], v9 offset:640
v_add_f32 v12, v12, v63
v_mfma_f32_16x16x32_bf16 v[40:43], a[44:47], a[132:135], v[40:43]
s_waitcnt lgkmcnt(6)
v_max_f32 v13, v13, v75
LS_70:
v_mfma_f32_16x16x32_bf16 v[76:79], a[16:19], v[28:31], v[76:79]
ds_read_b64_tr_b16 a[36:37], v9 offset:160
v_mfma_f32_16x16x32_bf16 v[80:83], a[16:19], v[32:35], v[80:83]
ds_read_b64_tr_b16 a[38:39], v9 offset:672
v_mfma_f32_16x16x32_bf16 v[84:87], a[16:19], v[36:39], v[84:87]
v_mfma_f32_16x16x32_bf16 v[96:99], a[20:23], v[36:39], v[96:99]
ds_read_b64_tr_b16 a[40:41], v9 offset:192
v_max3_f32 v13, v13, v40, v41
v_mfma_f32_16x16x32_bf16 v[92:95], a[20:23], v[32:35], v[92:95]
ds_read_b64_tr_b16 a[42:43], v9 offset:704
v_max3_f32 v13, v13, v42, v43
v_mfma_f32_16x16x32_bf16 v[88:91], a[20:23], v[28:31], v[88:91]
s_waitcnt lgkmcnt(6)
v_max3_f32 v13, v13, v44, v45
v_mfma_f32_16x16x32_bf16 v[100:103], a[24:27], v[28:31], v[100:103]
ds_read_b64_tr_b16 a[44:45], v9 offset:224
v_max3_f32 v13, v13, v46, v47
v_mfma_f32_16x16x32_bf16 v[104:107], a[24:27], v[32:35], v[104:107]
ds_read_b64_tr_b16 a[46:47], v9 offset:736
v_max3_f32 v13, v13, v48, v49
v_mfma_f32_16x16x32_bf16 v[108:111], a[24:27], v[36:39], v[108:111]
v_max3_f32 v13, v13, v50, v51
v_mfma_f32_16x16x32_bf16 v[120:123], a[28:31], v[36:39], v[120:123]
ds_read_b64_tr_b16 a[16:17], v9 offset:256
v_cmp_lt_f32 vcc, s47, v13
v_mfma_f32_16x16x32_bf16 v[116:119], a[28:31], v[32:35], v[116:119]
ds_read_b64_tr_b16 a[18:19], v9 offset:768
v_mfma_f32_16x16x32_bf16 v[112:115], a[28:31], v[28:31], v[112:115]
s_waitcnt lgkmcnt(6)
s_cbranch_vccnz RARE_h1j4
RET_h1j4:
v_mfma_f32_16x16x32_bf16 v[124:127], a[32:35], v[28:31], v[124:127]
ds_read_b64_tr_b16 a[20:21], v9 offset:288
ds_read_b64_tr_b16 a[22:23], v9 offset:800
v_mfma_f32_16x16x32_bf16 v[128:131], a[32:35], v[32:35], v[128:131]
v_exp_f32 v40, v40
v_mfma_f32_16x16x32_bf16 v[132:135], a[32:35], v[36:39], v[132:135]
v_exp_f32 v41, v41
v_mfma_f32_16x16x32_bf16 v[144:147], a[36:39], v[36:39], v[144:147]
ds_read_b64_tr_b16 a[24:25], v9 offset:320
ds_read_b64_tr_b16 a[26:27], v9 offset:832
v_mfma_f32_16x16x32_bf16 v[140:143], a[36:39], v[32:35], v[140:143]
v_exp_f32 v42, v42
v_mfma_f32_16x16x32_bf16 v[136:139], a[36:39], v[28:31], v[136:139]
s_waitcnt lgkmcnt(6)
v_add_f32 v10, v10, v40
v_mfma_f32_16x16x32_bf16 v[148:151], a[40:43], v[28:31], v[148:151]
ds_read_b64_tr_b16 a[28:29], v9 offset:352
ds_read_b64_tr_b16 a[30:31], v9 offset:864
v_mfma_f32_16x16x32_bf16 v[152:155], a[40:43], v[32:35], v[152:155]
v_exp_f32 v43, v43
v_mfma_f32_16x16x32_bf16 v[156:159], a[40:43], v[36:39], v[156:159]
s_waitcnt vmcnt(24)
s_barrier
v_mfma_f32_16x16x32_bf16 v[168:171], a[44:47], v[36:39], v[168:171]
ds_read_b64_tr_b16 a[32:33], v9 offset:384
ds_read_b64_tr_b16 a[34:35], v9 offset:896
v_mfma_f32_16x16x32_bf16 v[164:167], a[44:47], v[32:35], v[164:167]
s_add_u32 m0, s17, 16896
s_mov_b32 s50, 393216
v_mfma_f32_16x16x32_bf16 v[160:163], a[44:47], v[28:31], v[160:163]
s_waitcnt lgkmcnt(6)
v_add_f32 v10, v10, v41
v_mfma_f32_16x16x32_bf16 v[172:175], a[16:19], v[28:31], v[172:175]
ds_read_b64_tr_b16 a[36:37], v9 offset:416
ds_read_b64_tr_b16 a[38:39], v9 offset:928
v_mfma_f32_16x16x32_bf16 v[176:179], a[16:19], v[32:35], v[176:179]
buffer_load_dwordx4 v0, s[24:27], s50 offen offset:0 nt lds
v_mfma_f32_16x16x32_bf16 v[180:183], a[16:19], v[36:39], v[180:183]
v_exp_f32 v44, v44
v_mfma_f32_16x16x32_bf16 v[192:195], a[20:23], v[36:39], v[192:195]
ds_read_b64_tr_b16 a[40:41], v9 offset:448
ds_read_b64_tr_b16 a[42:43], v9 offset:960
v_mfma_f32_16x16x32_bf16 v[188:191], a[20:23], v[32:35], v[188:191]
buffer_load_dwordx4 v1, s[24:27], s50 offen offset:1056 nt lds
v_mfma_f32_16x16x32_bf16 v[184:187], a[20:23], v[28:31], v[184:187]
s_waitcnt lgkmcnt(6)
v_add_f32 v10, v10, v42
v_mfma_f32_16x16x32_bf16 v[196:199], a[24:27], v[28:31], v[196:199]
ds_read_b64_tr_b16 a[44:45], v9 offset:480
ds_read_b64_tr_b16 a[46:47], v9 offset:992
v_mfma_f32_16x16x32_bf16 v[200:203], a[24:27], v[32:35], v[200:203]
buffer_load_dwordx4 v2, s[24:27], s50 offen offset:2112 nt lds
v_mfma_f32_16x16x32_bf16 v[204:207], a[24:27], v[36:39], v[204:207]
v_exp_f32 v45, v45
v_mfma_f32_16x16x32_bf16 v[216:219], a[28:31], v[36:39], v[216:219]
v_add_u32 v8, 84480, v8
ds_read_b128 a[16:19], v8 offset:51200
v_mfma_f32_16x16x32_bf16 v[212:215], a[28:31], v[32:35], v[212:215]
v_exp_f32 v46, v46
v_mfma_f32_16x16x32_bf16 v[208:211], a[28:31], v[28:31], v[208:211]
s_waitcnt lgkmcnt(5)
v_add_f32 v10, v10, v43
v_mfma_f32_16x16x32_bf16 v[220:223], a[32:35], v[28:31], v[220:223]
ds_read_b128 a[20:23], v8 offset:51264
v_add_f32 v11, v11, v44
v_mfma_f32_16x16x32_bf16 v[224:227], a[32:35], v[32:35], v[224:227]
v_exp_f32 v47, v47
v_mfma_f32_16x16x32_bf16 v[228:231], a[32:35], v[36:39], v[228:231]
v_exp_f32 v48, v48
v_mfma_f32_16x16x32_bf16 v[240:243], a[36:39], v[36:39], v[240:243]
ds_read_b128 a[24:27], v8 offset:51328
v_add_f32 v11, v11, v45
v_mfma_f32_16x16x32_bf16 v[236:239], a[36:39], v[32:35], v[236:239]
v_exp_f32 v49, v49
v_mfma_f32_16x16x32_bf16 v[232:235], a[36:39], v[28:31], v[232:235]
s_waitcnt lgkmcnt(3)
v_add_f32 v11, v11, v46
v_mfma_f32_16x16x32_bf16 v[244:247], a[40:43], v[28:31], v[244:247]
ds_read_b128 a[28:31], v8 offset:51392
v_exp_f32 v50, v50
v_mfma_f32_16x16x32_bf16 v[248:251], a[40:43], v[32:35], v[248:251]
v_exp_f32 v51, v51
v_mfma_f32_16x16x32_bf16 a[0:3], a[40:43], v[36:39], a[0:3]
buffer_load_dwordx4 v3, s[24:27], s50 offen offset:3168 nt lds
v_mfma_f32_16x16x32_bf16 a[12:15], a[44:47], v[36:39], a[12:15]
ds_read_b128 a[32:35], v8 offset:51456
v_add_f32 v11, v11, v47
v_add_f32 v12, v12, v48
v_mfma_f32_16x16x32_bf16 a[8:11], a[44:47], v[32:35], a[8:11]
v_add_f32 v12, v12, v49
v_add_f32 v12, v12, v50
v_mfma_f32_16x16x32_bf16 a[4:7], a[44:47], v[28:31], a[4:7]
s_waitcnt lgkmcnt(3)
v_add_f32 v12, v12, v51
LS_71:
v_mfma_f32_16x16x32_bf16 v[52:55], a[16:19], a[48:51], v[16:19]
ds_read_b128 a[36:39], v8 offset:51520
v_cvt_pk_bf16_f32 v30, v40, v41
v_mfma_f32_16x16x32_bf16 v[52:55], a[20:23], a[60:63], v[52:55]
v_exp_f32 v64, v64
v_mfma_f32_16x16x32_bf16 v[56:59], a[20:23], a[64:67], v[20:23]
v_exp_f32 v65, v65
v_mfma_f32_16x16x32_bf16 v[56:59], a[16:19], a[52:55], v[56:59]
ds_read_b128 a[40:43], v8 offset:51584
v_cvt_pk_bf16_f32 v31, v42, v43
v_mfma_f32_16x16x32_bf16 v[60:63], a[16:19], a[56:59], v[24:27]
v_exp_f32 v66, v66
v_mfma_f32_16x16x32_bf16 v[60:63], a[20:23], a[68:71], v[60:63]
s_waitcnt lgkmcnt(3)
v_cvt_pk_bf16_f32 v34, v44, v45
v_mfma_f32_16x16x32_bf16 v[60:63], a[24:27], a[80:83], v[60:63]
ds_read_b128 a[44:47], v8 offset:51648
v_cvt_pk_bf16_f32 v35, v46, v47
v_mfma_f32_16x16x32_bf16 v[60:63], a[28:31], a[92:95], v[60:63]
v_exp_f32 v67, v67
v_mfma_f32_16x16x32_bf16 v[56:59], a[28:31], a[88:91], v[56:59]
v_exp_f32 v68, v68
v_mfma_f32_16x16x32_bf16 v[56:59], a[24:27], a[76:79], v[56:59]
ds_read_b128 a[16:19], v8 offset:50688
v_cvt_pk_bf16_f32 v38, v48, v49
v_mfma_f32_16x16x32_bf16 v[52:55], a[24:27], a[72:75], v[52:55]
v_exp_f32 v69, v69
v_mfma_f32_16x16x32_bf16 v[52:55], a[28:31], a[84:87], v[52:55]
s_waitcnt lgkmcnt(3)
v_cvt_pk_bf16_f32 v39, v50, v51
v_mfma_f32_16x16x32_bf16 v[52:55], a[32:35], a[96:99], v[52:55]
ds_read_b128 a[20:23], v8 offset:50752
v_cvt_pk_bf16_f32 v28, v64, v65
v_mfma_f32_16x16x32_bf16 v[52:55], a[36:39], a[108:111], v[52:55]
v_exp_f32 v70, v70
v_mfma_f32_16x16x32_bf16 v[56:59], a[36:39], a[112:115], v[56:59]
v_exp_f32 v71, v71
v_mfma_f32_16x16x32_bf16 v[56:59], a[32:35], a[100:103], v[56:59]
ds_read_b128 a[24:27], v8 offset:50816
v_cvt_pk_bf16_f32 v29, v66, v67
v_mfma_f32_16x16x32_bf16 v[60:63], a[32:35], a[104:107], v[60:63]
v_exp_f32 v72, v72
v_mfma_f32_16x16x32_bf16 v[60:63], a[36:39], a[116:119], v[60:63]
s_waitcnt lgkmcnt(3)
v_cvt_pk_bf16_f32 v32, v68, v69
v_mfma_f32_16x16x32_bf16 v[60:63], a[40:43], a[128:131], v[60:63]
ds_read_b128 a[28:31], v8 offset:50880
v_cvt_pk_bf16_f32 v33, v70, v71
v_mfma_f32_16x16x32_bf16 v[60:63], a[44:47], a[140:143], v[60:63]
v_exp_f32 v73, v73
v_mfma_f32_16x16x32_bf16 v[56:59], a[44:47], a[136:139], v[56:59]
s_waitcnt vmcnt(24)
s_barrier
v_mfma_f32_16x16x32_bf16 v[56:59], a[40:43], a[124:127], v[56:59]
ds_read_b128 a[32:35], v8 offset:50944
v_cvt_pk_bf16_f32 v36, v72, v73
v_mfma_f32_16x16x32_bf16 v[52:55], a[40:43], a[120:123], v[52:55]
v_exp_f32 v74, v74
v_mfma_f32_16x16x32_bf16 v[52:55], a[44:47], a[132:135], v[52:55]
s_waitcnt lgkmcnt(3)
v_add_f32 v10, v10, v64
v_mfma_f32_16x16x32_bf16 v[40:43], a[16:19], a[48:51], v[16:19]
ds_read_b128 a[36:39], v8 offset:51008
v_add_f32 v10, v10, v65
v_mfma_f32_16x16x32_bf16 v[40:43], a[20:23], a[60:63], v[40:43]
v_exp_f32 v75, v75
v_mfma_f32_16x16x32_bf16 v[44:47], a[20:23], a[64:67], v[20:23]
v_cvt_pk_bf16_f32 v37, v74, v75
v_add_f32 v10, v10, v66
v_mfma_f32_16x16x32_bf16 v[44:47], a[16:19], a[52:55], v[44:47]
ds_read_b128 a[40:43], v8 offset:51072
v_max3_f32 v13, v52, v53, v54
v_mfma_f32_16x16x32_bf16 v[48:51], a[16:19], a[56:59], v[24:27]
v_max3_f32 v13, v13, v55, v56
v_add_f32 v10, v10, v67
v_mfma_f32_16x16x32_bf16 v[48:51], a[20:23], a[68:71], v[48:51]
s_waitcnt lgkmcnt(3)
v_max3_f32 v13, v13, v57, v58
v_mfma_f32_16x16x32_bf16 v[48:51], a[24:27], a[80:83], v[48:51]
ds_read_b128 a[44:47], v8 offset:51136
v_max3_f32 v13, v13, v59, v60
v_mfma_f32_16x16x32_bf16 v[48:51], a[28:31], a[92:95], v[48:51]
v_max3_f32 v13, v13, v61, v62
v_add_f32 v11, v11, v68
v_mfma_f32_16x16x32_bf16 v[44:47], a[28:31], a[88:91], v[44:47]
v_add_f32 v11, v11, v69
v_add_f32 v11, v11, v70
v_mfma_f32_16x16x32_bf16 v[44:47], a[24:27], a[76:79], v[44:47]
ds_read_b64_tr_b16 a[16:17], v9 offset:33792
v_add_f32 v11, v11, v71
v_mfma_f32_16x16x32_bf16 v[40:43], a[24:27], a[72:75], v[40:43]
ds_read_b64_tr_b16 a[18:19], v9 offset:34304
v_add_f32 v12, v12, v72
v_mfma_f32_16x16x32_bf16 v[40:43], a[28:31], a[84:87], v[40:43]
s_waitcnt lgkmcnt(4)
v_add_f32 v12, v12, v73
v_mfma_f32_16x16x32_bf16 v[40:43], a[32:35], a[96:99], v[40:43]
ds_read_b64_tr_b16 a[20:21], v9 offset:33824
v_add_f32 v12, v12, v74
v_mfma_f32_16x16x32_bf16 v[40:43], a[36:39], a[108:111], v[40:43]
ds_read_b64_tr_b16 a[22:23], v9 offset:34336
v_add_f32 v12, v12, v75
v_mfma_f32_16x16x32_bf16 v[44:47], a[36:39], a[112:115], v[44:47]
v_max_f32 v13, v13, v63
v_mfma_f32_16x16x32_bf16 v[44:47], a[32:35], a[100:103], v[44:47]
ds_read_b64_tr_b16 a[24:25], v9 offset:33856
v_mfma_f32_16x16x32_bf16 v[48:51], a[32:35], a[104:107], v[48:51]
ds_read_b64_tr_b16 a[26:27], v9 offset:34368
v_mfma_f32_16x16x32_bf16 v[48:51], a[36:39], a[116:119], v[48:51]
s_waitcnt lgkmcnt(6)
v_mfma_f32_16x16x32_bf16 v[48:51], a[40:43], a[128:131], v[48:51]
ds_read_b64_tr_b16 a[28:29], v9 offset:33888
v_mfma_f32_16x16x32_bf16 v[48:51], a[44:47], a[140:143], v[48:51]
ds_read_b64_tr_b16 a[30:31], v9 offset:34400
v_mfma_f32_16x16x32_bf16 v[44:47], a[44:47], a[136:139], v[44:47]
v_mfma_f32_16x16x32_bf16 v[44:47], a[40:43], a[124:127], v[44:47]
ds_read_b64_tr_b16 a[32:33], v9 offset:33920
v_mfma_f32_16x16x32_bf16 v[40:43], a[40:43], a[120:123], v[40:43]
ds_read_b64_tr_b16 a[34:35], v9 offset:34432
v_mfma_f32_16x16x32_bf16 v[40:43], a[44:47], a[132:135], v[40:43]
s_waitcnt lgkmcnt(6)
LS_72:
v_mfma_f32_16x16x32_bf16 v[76:79], a[16:19], v[28:31], v[76:79]
ds_read_b64_tr_b16 a[36:37], v9 offset:33952
v_mfma_f32_16x16x32_bf16 v[80:83], a[16:19], v[32:35], v[80:83]
ds_read_b64_tr_b16 a[38:39], v9 offset:34464
v_mfma_f32_16x16x32_bf16 v[84:87], a[16:19], v[36:39], v[84:87]
s_add_u32 m0, s17, 0
s_mov_b32 s50, 409600
v_mfma_f32_16x16x32_bf16 v[96:99], a[20:23], v[36:39], v[96:99]
ds_read_b64_tr_b16 a[40:41], v9 offset:33984
v_max3_f32 v13, v13, v40, v41
v_mfma_f32_16x16x32_bf16 v[92:95], a[20:23], v[32:35], v[92:95]
ds_read_b64_tr_b16 a[42:43], v9 offset:34496
v_max3_f32 v13, v13, v42, v43
v_mfma_f32_16x16x32_bf16 v[88:91], a[20:23], v[28:31], v[88:91]
s_waitcnt lgkmcnt(6)
v_max3_f32 v13, v13, v44, v45
v_mfma_f32_16x16x32_bf16 v[100:103], a[24:27], v[28:31], v[100:103]
ds_read_b64_tr_b16 a[44:45], v9 offset:34016
v_max3_f32 v13, v13, v46, v47
v_mfma_f32_16x16x32_bf16 v[104:107], a[24:27], v[32:35], v[104:107]
ds_read_b64_tr_b16 a[46:47], v9 offset:34528
v_max3_f32 v13, v13, v48, v49
v_mfma_f32_16x16x32_bf16 v[108:111], a[24:27], v[36:39], v[108:111]
buffer_load_dwordx4 v0, s[20:23], s50 offen offset:0 nt lds
v_mfma_f32_16x16x32_bf16 v[120:123], a[28:31], v[36:39], v[120:123]
ds_read_b64_tr_b16 a[16:17], v9 offset:34048
v_max3_f32 v13, v13, v50, v51
v_mfma_f32_16x16x32_bf16 v[116:119], a[28:31], v[32:35], v[116:119]
ds_read_b64_tr_b16 a[18:19], v9 offset:34560
v_cmp_lt_f32 vcc, s47, v13
v_mfma_f32_16x16x32_bf16 v[112:115], a[28:31], v[28:31], v[112:115]
s_waitcnt lgkmcnt(6)
v_mfma_f32_16x16x32_bf16 v[124:127], a[32:35], v[28:31], v[124:127]
ds_read_b64_tr_b16 a[20:21], v9 offset:34080
ds_read_b64_tr_b16 a[22:23], v9 offset:34592
v_mfma_f32_16x16x32_bf16 v[128:131], a[32:35], v[32:35], v[128:131]
s_cbranch_vccnz RARE_h1j5
RET_h1j5:
v_mfma_f32_16x16x32_bf16 v[132:135], a[32:35], v[36:39], v[132:135]
buffer_load_dwordx4 v1, s[20:23], s50 offen offset:1056 nt lds
v_mfma_f32_16x16x32_bf16 v[144:147], a[36:39], v[36:39], v[144:147]
ds_read_b64_tr_b16 a[24:25], v9 offset:34112
ds_read_b64_tr_b16 a[26:27], v9 offset:34624
v_mfma_f32_16x16x32_bf16 v[140:143], a[36:39], v[32:35], v[140:143]
v_exp_f32 v40, v40
v_mfma_f32_16x16x32_bf16 v[136:139], a[36:39], v[28:31], v[136:139]
s_waitcnt lgkmcnt(6)
v_add_f32 v10, v10, v40
v_mfma_f32_16x16x32_bf16 v[148:151], a[40:43], v[28:31], v[148:151]
ds_read_b64_tr_b16 a[28:29], v9 offset:34144
ds_read_b64_tr_b16 a[30:31], v9 offset:34656
v_mfma_f32_16x16x32_bf16 v[152:155], a[40:43], v[32:35], v[152:155]
buffer_load_dwordx4 v2, s[20:23], s50 offen offset:2112 nt lds
v_mfma_f32_16x16x32_bf16 v[156:159], a[40:43], v[36:39], v[156:159]
s_waitcnt vmcnt(23)
s_barrier
v_mfma_f32_16x16x32_bf16 v[168:171], a[44:47], v[36:39], v[168:171]
ds_read_b64_tr_b16 a[32:33], v9 offset:34176
ds_read_b64_tr_b16 a[34:35], v9 offset:34688
v_mfma_f32_16x16x32_bf16 v[164:167], a[44:47], v[32:35], v[164:167]
v_exp_f32 v41, v41
v_mfma_f32_16x16x32_bf16 v[160:163], a[44:47], v[28:31], v[160:163]
s_waitcnt lgkmcnt(6)
v_add_f32 v10, v10, v41
v_mfma_f32_16x16x32_bf16 v[172:175], a[16:19], v[28:31], v[172:175]
ds_read_b64_tr_b16 a[36:37], v9 offset:34208
ds_read_b64_tr_b16 a[38:39], v9 offset:34720
v_mfma_f32_16x16x32_bf16 v[176:179], a[16:19], v[32:35], v[176:179]
v_exp_f32 v42, v42
v_mfma_f32_16x16x32_bf16 v[180:183], a[16:19], v[36:39], v[180:183]
v_exp_f32 v43, v43
v_mfma_f32_16x16x32_bf16 v[192:195], a[20:23], v[36:39], v[192:195]
ds_read_b64_tr_b16 a[40:41], v9 offset:34240
ds_read_b64_tr_b16 a[42:43], v9 offset:34752
v_mfma_f32_16x16x32_bf16 v[188:191], a[20:23], v[32:35], v[188:191]
v_exp_f32 v44, v44
v_mfma_f32_16x16x32_bf16 v[184:187], a[20:23], v[28:31], v[184:187]
s_waitcnt lgkmcnt(6)
v_add_f32 v10, v10, v42
v_mfma_f32_16x16x32_bf16 v[196:199], a[24:27], v[28:31], v[196:199]
ds_read_b64_tr_b16 a[44:45], v9 offset:34272
ds_read_b64_tr_b16 a[46:47], v9 offset:34784
v_mfma_f32_16x16x32_bf16 v[200:203], a[24:27], v[32:35], v[200:203]
v_exp_f32 v45, v45
v_mfma_f32_16x16x32_bf16 v[204:207], a[24:27], v[36:39], v[204:207]
v_exp_f32 v46, v46
v_mfma_f32_16x16x32_bf16 v[216:219], a[28:31], v[36:39], v[216:219]
ds_read_b128 a[16:19], v8 offset:33792
v_add_f32 v10, v10, v43
v_mfma_f32_16x16x32_bf16 v[212:215], a[28:31], v[32:35], v[212:215]
v_exp_f32 v47, v47
v_mfma_f32_16x16x32_bf16 v[208:211], a[28:31], v[28:31], v[208:211]
s_waitcnt lgkmcnt(5)
v_add_f32 v11, v11, v44
v_mfma_f32_16x16x32_bf16 v[220:223], a[32:35], v[28:31], v[220:223]
ds_read_b128 a[20:23], v8 offset:33856
v_add_f32 v11, v11, v45
v_mfma_f32_16x16x32_bf16 v[224:227], a[32:35], v[32:35], v[224:227]
v_exp_f32 v48, v48
v_mfma_f32_16x16x32_bf16 v[228:231], a[32:35], v[36:39], v[228:231]
v_exp_f32 v49, v49
v_mfma_f32_16x16x32_bf16 v[240:243], a[36:39], v[36:39], v[240:243]
ds_read_b128 a[24:27], v8 offset:33920
v_add_f32 v11, v11, v46
v_mfma_f32_16x16x32_bf16 v[236:239], a[36:39], v[32:35], v[236:239]
v_exp_f32 v50, v50
v_mfma_f32_16x16x32_bf16 v[232:235], a[36:39], v[28:31], v[232:235]
s_waitcnt lgkmcnt(3)
v_add_f32 v11, v11, v47
v_mfma_f32_16x16x32_bf16 v[244:247], a[40:43], v[28:31], v[244:247]
ds_read_b128 a[28:31], v8 offset:33984
v_add_f32 v12, v12, v48
v_mfma_f32_16x16x32_bf16 v[248:251], a[40:43], v[32:35], v[248:251]
v_exp_f32 v51, v51
v_mfma_f32_16x16x32_bf16 a[0:3], a[40:43], v[36:39], a[0:3]
buffer_load_dwordx4 v3, s[20:23], s50 offen offset:3168 nt lds
v_mfma_f32_16x16x32_bf16 a[12:15], a[44:47], v[36:39], a[12:15]
ds_read_b128 a[32:35], v8 offset:34048
v_add_f32 v12, v12, v49
v_mfma_f32_16x16x32_bf16 a[8:11], a[44:47], v[32:35], a[8:11]
v_add_f32 v12, v12, v50
v_add_f32 v12, v12, v51
v_mfma_f32_16x16x32_bf16 a[4:7], a[44:47], v[28:31], a[4:7]
s_waitcnt lgkmcnt(3)
LS_73:
v_mfma_f32_16x16x32_bf16 v[64:67], a[16:19], a[48:51], v[16:19]
ds_read_b128 a[36:39], v8 offset:34112
v_cvt_pk_bf16_f32 v28, v40, v41
v_mfma_f32_16x16x32_bf16 v[64:67], a[20:23], a[60:63], v[64:67]
s_add_u32 m0, s17, 135168
s_mov_b32 s50, 401408
v_mfma_f32_16x16x32_bf16 v[68:71], a[20:23], a[64:67], v[20:23]
buffer_load_dwordx4 v0, s[24:27], s50 offen offset:0 nt lds
v_mfma_f32_16x16x32_bf16 v[68:71], a[16:19], a[52:55], v[68:71]
ds_read_b128 a[40:43], v8 offset:34176
v_cvt_pk_bf16_f32 v29, v42, v43
v_mfma_f32_16x16x32_bf16 v[72:75], a[16:19], a[56:59], v[24:27]
v_exp_f32 v52, v52
v_mfma_f32_16x16x32_bf16 v[72:75], a[20:23], a[68:71], v[72:75]
s_waitcnt lgkmcnt(3)
v_cvt_pk_bf16_f32 v32, v44, v45
v_mfma_f32_16x16x32_bf16 v[72:75], a[24:27], a[80:83], v[72:75]
ds_read_b128 a[44:47], v8 offset:34240
v_cvt_pk_bf16_f32 v33, v46, v47
v_mfma_f32_16x16x32_bf16 v[72:75], a[28:31], a[92:95], v[72:75]
buffer_load_dwordx4 v1, s[24:27], s50 offen offset:1056 nt lds
v_mfma_f32_16x16x32_bf16 v[68:71], a[28:31], a[88:91], v[68:71]
v_exp_f32 v53, v53
v_mfma_f32_16x16x32_bf16 v[68:71], a[24:27], a[76:79], v[68:71]
ds_read_b128 a[16:19], v8 offset:34304
v_cvt_pk_bf16_f32 v36, v48, v49
v_mfma_f32_16x16x32_bf16 v[64:67], a[24:27], a[72:75], v[64:67]
v_exp_f32 v54, v54
v_mfma_f32_16x16x32_bf16 v[64:67], a[28:31], a[84:87], v[64:67]
s_waitcnt lgkmcnt(3)
v_cvt_pk_bf16_f32 v37, v50, v51
v_mfma_f32_16x16x32_bf16 v[64:67], a[32:35], a[96:99], v[64:67]
ds_read_b128 a[20:23], v8 offset:34368
v_cvt_pk_bf16_f32 v30, v52, v53
v_mfma_f32_16x16x32_bf16 v[64:67], a[36:39], a[108:111], v[64:67]
v_exp_f32 v55, v55
v_mfma_f32_16x16x32_bf16 v[68:71], a[36:39], a[112:115], v[68:71]
v_exp_f32 v56, v56
v_mfma_f32_16x16x32_bf16 v[68:71], a[32:35], a[100:103], v[68:71]
ds_read_b128 a[24:27], v8 offset:34432
v_cvt_pk_bf16_f32 v31, v54, v55
v_mfma_f32_16x16x32_bf16 v[72:75], a[32:35], a[104:107], v[72:75]
v_exp_f32 v57, v57
v_mfma_f32_16x16x32_bf16 v[72:75], a[36:39], a[116:119], v[72:75]
s_waitcnt lgkmcnt(3)
v_cvt_pk_bf16_f32 v34, v56, v57
v_mfma_f32_16x16x32_bf16 v[72:75], a[40:43], a[128:131], v[72:75]
ds_read_b128 a[28:31], v8 offset:34496
v_add_f32 v10, v10, v52
v_mfma_f32_16x16x32_bf16 v[72:75], a[44:47], a[140:143], v[72:75]
v_exp_f32 v58, v58
v_mfma_f32_16x16x32_bf16 v[68:71], a[44:47], a[136:139], v[68:71]
s_waitcnt vmcnt(22)
s_barrier
v_mfma_f32_16x16x32_bf16 v[68:71], a[40:43], a[124:127], v[68:71]
ds_read_b128 a[32:35], v8 offset:34560
v_add_f32 v10, v10, v53
v_mfma_f32_16x16x32_bf16 v[64:67], a[40:43], a[120:123], v[64:67]
v_exp_f32 v59, v59
v_mfma_f32_16x16x32_bf16 v[64:67], a[44:47], a[132:135], v[64:67]
s_waitcnt lgkmcnt(3)
v_cvt_pk_bf16_f32 v35, v58, v59
v_mfma_f32_16x16x32_bf16 v[40:43], a[16:19], a[48:51], v[16:19]
ds_read_b128 a[36:39], v8 offset:34624
v_add_f32 v10, v10, v54
v_mfma_f32_16x16x32_bf16 v[40:43], a[20:23], a[60:63], v[40:43]
v_exp_f32 v60, v60
v_mfma_f32_16x16x32_bf16 v[44:47], a[20:23], a[64:67], v[20:23]
v_exp_f32 v61, v61
v_mfma_f32_16x16x32_bf16 v[44:47], a[16:19], a[52:55], v[44:47]
ds_read_b128 a[40:43], v8 offset:34688
v_max3_f32 v13, v64, v65, v66
v_mfma_f32_16x16x32_bf16 v[48:51], a[16:19], a[56:59], v[24:27]
v_exp_f32 v62, v62
v_mfma_f32_16x16x32_bf16 v[48:51], a[20:23], a[68:71], v[48:51]
s_waitcnt lgkmcnt(3)
v_max3_f32 v13, v13, v67, v68
v_mfma_f32_16x16x32_bf16 v[48:51], a[24:27], a[80:83], v[48:51]
ds_read_b128 a[44:47], v8 offset:34752
v_max3_f32 v13, v13, v69, v70
v_mfma_f32_16x16x32_bf16 v[48:51], a[28:31], a[92:95], v[48:51]
v_exp_f32 v63, v63
v_mfma_f32_16x16x32_bf16 v[44:47], a[28:31], a[88:91], v[44:47]
buffer_load_dwordx4 v2, s[24:27], s50 offen offset:2112 nt lds
v_mfma_f32_16x16x32_bf16 v[44:47], a[24:27], a[76:79], v[44:47]
ds_read_b64_tr_b16 a[16:17], v9 offset:50688
v_cvt_pk_bf16_f32 v38, v60, v61
v_mfma_f32_16x16x32_bf16 v[40:43], a[24:27], a[72:75], v[40:43]
ds_read_b64_tr_b16 a[18:19], v9 offset:51200
v_cvt_pk_bf16_f32 v39, v62, v63
v_mfma_f32_16x16x32_bf16 v[40:43], a[28:31], a[84:87], v[40:43]
s_waitcnt lgkmcnt(4)
v_max3_f32 v13, v13, v71, v72
v_mfma_f32_16x16x32_bf16 v[40:43], a[32:35], a[96:99], v[40:43]
ds_read_b64_tr_b16 a[20:21], v9 offset:50720
v_max3_f32 v13, v13, v73, v74
v_mfma_f32_16x16x32_bf16 v[40:43], a[36:39], a[108:111], v[40:43]
ds_read_b64_tr_b16 a[22:23], v9 offset:51232
v_add_f32 v10, v10, v55
v_mfma_f32_16x16x32_bf16 v[44:47], a[36:39], a[112:115], v[44:47]
buffer_load_dwordx4 v3, s[24:27], s50 offen offset:3168 nt lds
v_mfma_f32_16x16x32_bf16 v[44:47], a[32:35], a[100:103], v[44:47]
ds_read_b64_tr_b16 a[24:25], v9 offset:50752
v_add_f32 v11, v11, v56
v_mfma_f32_16x16x32_bf16 v[48:51], a[32:35], a[104:107], v[48:51]
ds_read_b64_tr_b16 a[26:27], v9 offset:51264
v_add_f32 v11, v11, v57
v_mfma_f32_16x16x32_bf16 v[48:51], a[36:39], a[116:119], v[48:51]
s_waitcnt lgkmcnt(6)
v_add_f32 v11, v11, v58
v_mfma_f32_16x16x32_bf16 v[48:51], a[40:43], a[128:131], v[48:51]
ds_read_b64_tr_b16 a[28:29], v9 offset:50784
v_add_f32 v11, v11, v59
v_mfma_f32_16x16x32_bf16 v[48:51], a[44:47], a[140:143], v[48:51]
ds_read_b64_tr_b16 a[30:31], v9 offset:51296
v_add_f32 v12, v12, v60
v_mfma_f32_16x16x32_bf16 v[44:47], a[44:47], a[136:139], v[44:47]
v_add_f32 v12, v12, v61
v_add_f32 v12, v12, v62
v_mfma_f32_16x16x32_bf16 v[44:47], a[40:43], a[124:127], v[44:47]
ds_read_b64_tr_b16 a[32:33], v9 offset:50816
v_add_f32 v12, v12, v63
v_mfma_f32_16x16x32_bf16 v[40:43], a[40:43], a[120:123], v[40:43]
ds_read_b64_tr_b16 a[34:35], v9 offset:51328
v_max_f32 v13, v13, v75
v_mfma_f32_16x16x32_bf16 v[40:43], a[44:47], a[132:135], v[40:43]
s_waitcnt lgkmcnt(6)
LS_74:
v_mfma_f32_16x16x32_bf16 v[76:79], a[16:19], v[28:31], v[76:79]
ds_read_b64_tr_b16 a[36:37], v9 offset:50848
v_mfma_f32_16x16x32_bf16 v[80:83], a[16:19], v[32:35], v[80:83]
ds_read_b64_tr_b16 a[38:39], v9 offset:51360
v_mfma_f32_16x16x32_bf16 v[84:87], a[16:19], v[36:39], v[84:87]
s_add_u32 m0, s17, 33792
s_mov_b32 s50, 417792
v_mfma_f32_16x16x32_bf16 v[96:99], a[20:23], v[36:39], v[96:99]
ds_read_b64_tr_b16 a[40:41], v9 offset:50880
v_max3_f32 v13, v13, v40, v41
v_mfma_f32_16x16x32_bf16 v[92:95], a[20:23], v[32:35], v[92:95]
ds_read_b64_tr_b16 a[42:43], v9 offset:51392
v_max3_f32 v13, v13, v42, v43
v_mfma_f32_16x16x32_bf16 v[88:91], a[20:23], v[28:31], v[88:91]
s_waitcnt lgkmcnt(6)
v_max3_f32 v13, v13, v44, v45
v_mfma_f32_16x16x32_bf16 v[100:103], a[24:27], v[28:31], v[100:103]
ds_read_b64_tr_b16 a[44:45], v9 offset:50912
v_max3_f32 v13, v13, v46, v47
v_mfma_f32_16x16x32_bf16 v[104:107], a[24:27], v[32:35], v[104:107]
ds_read_b64_tr_b16 a[46:47], v9 offset:51424
v_max3_f32 v13, v13, v48, v49
v_mfma_f32_16x16x32_bf16 v[108:111], a[24:27], v[36:39], v[108:111]
buffer_load_dwordx4 v0, s[20:23], s50 offen offset:0 nt lds
v_mfma_f32_16x16x32_bf16 v[120:123], a[28:31], v[36:39], v[120:123]
ds_read_b64_tr_b16 a[16:17], v9 offset:50944
v_max3_f32 v13, v13, v50, v51
v_mfma_f32_16x16x32_bf16 v[116:119], a[28:31], v[32:35], v[116:119]
ds_read_b64_tr_b16 a[18:19], v9 offset:51456
v_cmp_lt_f32 vcc, s47, v13
v_mfma_f32_16x16x32_bf16 v[112:115], a[28:31], v[28:31], v[112:115]
s_waitcnt lgkmcnt(6)
v_mfma_f32_16x16x32_bf16 v[124:127], a[32:35], v[28:31], v[124:127]
ds_read_b64_tr_b16 a[20:21], v9 offset:50976
ds_read_b64_tr_b16 a[22:23], v9 offset:51488
v_mfma_f32_16x16x32_bf16 v[128:131], a[32:35], v[32:35], v[128:131]
s_cbranch_vccnz RARE_h1j6
RET_h1j6:
v_mfma_f32_16x16x32_bf16 v[132:135], a[32:35], v[36:39], v[132:135]
buffer_load_dwordx4 v1, s[20:23], s50 offen offset:1056 nt lds
v_mfma_f32_16x16x32_bf16 v[144:147], a[36:39], v[36:39], v[144:147]
ds_read_b64_tr_b16 a[24:25], v9 offset:51008
ds_read_b64_tr_b16 a[26:27], v9 offset:51520
v_mfma_f32_16x16x32_bf16 v[140:143], a[36:39], v[32:35], v[140:143]
v_exp_f32 v40, v40
v_mfma_f32_16x16x32_bf16 v[136:139], a[36:39], v[28:31], v[136:139]
s_waitcnt lgkmcnt(6)
v_add_f32 v10, v10, v40
v_mfma_f32_16x16x32_bf16 v[148:151], a[40:43], v[28:31], v[148:151]
ds_read_b64_tr_b16 a[28:29], v9 offset:51040
ds_read_b64_tr_b16 a[30:31], v9 offset:51552
v_mfma_f32_16x16x32_bf16 v[152:155], a[40:43], v[32:35], v[152:155]
buffer_load_dwordx4 v2, s[20:23], s50 offen offset:2112 nt lds
v_mfma_f32_16x16x32_bf16 v[156:159], a[40:43], v[36:39], v[156:159]
s_waitcnt vmcnt(23)
s_barrier
v_mfma_f32_16x16x32_bf16 v[168:171], a[44:47], v[36:39], v[168:171]
ds_read_b64_tr_b16 a[32:33], v9 offset:51072
ds_read_b64_tr_b16 a[34:35], v9 offset:51584
v_mfma_f32_16x16x32_bf16 v[164:167], a[44:47], v[32:35], v[164:167]
v_exp_f32 v41, v41
v_mfma_f32_16x16x32_bf16 v[160:163], a[44:47], v[28:31], v[160:163]
s_waitcnt lgkmcnt(6)
v_add_f32 v10, v10, v41
v_mfma_f32_16x16x32_bf16 v[172:175], a[16:19], v[28:31], v[172:175]
ds_read_b64_tr_b16 a[36:37], v9 offset:51104
ds_read_b64_tr_b16 a[38:39], v9 offset:51616
v_mfma_f32_16x16x32_bf16 v[176:179], a[16:19], v[32:35], v[176:179]
v_exp_f32 v42, v42
v_mfma_f32_16x16x32_bf16 v[180:183], a[16:19], v[36:39], v[180:183]
v_exp_f32 v43, v43
v_mfma_f32_16x16x32_bf16 v[192:195], a[20:23], v[36:39], v[192:195]
ds_read_b64_tr_b16 a[40:41], v9 offset:51136
ds_read_b64_tr_b16 a[42:43], v9 offset:51648
v_mfma_f32_16x16x32_bf16 v[188:191], a[20:23], v[32:35], v[188:191]
v_exp_f32 v44, v44
v_mfma_f32_16x16x32_bf16 v[184:187], a[20:23], v[28:31], v[184:187]
s_waitcnt lgkmcnt(6)
v_add_f32 v10, v10, v42
v_mfma_f32_16x16x32_bf16 v[196:199], a[24:27], v[28:31], v[196:199]
ds_read_b64_tr_b16 a[44:45], v9 offset:51168
ds_read_b64_tr_b16 a[46:47], v9 offset:51680
v_mfma_f32_16x16x32_bf16 v[200:203], a[24:27], v[32:35], v[200:203]
v_exp_f32 v45, v45
v_mfma_f32_16x16x32_bf16 v[204:207], a[24:27], v[36:39], v[204:207]
v_exp_f32 v46, v46
v_mfma_f32_16x16x32_bf16 v[216:219], a[28:31], v[36:39], v[216:219]
v_subrev_u32 v8, 50688, v8
ds_read_b128 a[16:19], v8 offset:34304
v_mfma_f32_16x16x32_bf16 v[212:215], a[28:31], v[32:35], v[212:215]
v_exp_f32 v47, v47
v_mfma_f32_16x16x32_bf16 v[208:211], a[28:31], v[28:31], v[208:211]
s_waitcnt lgkmcnt(5)
v_add_f32 v10, v10, v43
v_mfma_f32_16x16x32_bf16 v[220:223], a[32:35], v[28:31], v[220:223]
ds_read_b128 a[20:23], v8 offset:34368
v_add_f32 v11, v11, v44
v_mfma_f32_16x16x32_bf16 v[224:227], a[32:35], v[32:35], v[224:227]
v_exp_f32 v48, v48
v_mfma_f32_16x16x32_bf16 v[228:231], a[32:35], v[36:39], v[228:231]
v_exp_f32 v49, v49
v_mfma_f32_16x16x32_bf16 v[240:243], a[36:39], v[36:39], v[240:243]
ds_read_b128 a[24:27], v8 offset:34432
v_add_f32 v11, v11, v45
v_mfma_f32_16x16x32_bf16 v[236:239], a[36:39], v[32:35], v[236:239]
v_exp_f32 v50, v50
v_mfma_f32_16x16x32_bf16 v[232:235], a[36:39], v[28:31], v[232:235]
s_waitcnt lgkmcnt(3)
v_add_f32 v11, v11, v46
v_mfma_f32_16x16x32_bf16 v[244:247], a[40:43], v[28:31], v[244:247]
ds_read_b128 a[28:31], v8 offset:34496
v_add_f32 v11, v11, v47
v_mfma_f32_16x16x32_bf16 v[248:251], a[40:43], v[32:35], v[248:251]
v_exp_f32 v51, v51
v_mfma_f32_16x16x32_bf16 a[0:3], a[40:43], v[36:39], a[0:3]
buffer_load_dwordx4 v3, s[20:23], s50 offen offset:3168 nt lds
v_mfma_f32_16x16x32_bf16 a[12:15], a[44:47], v[36:39], a[12:15]
ds_read_b128 a[32:35], v8 offset:34560
v_add_f32 v12, v12, v48
v_mfma_f32_16x16x32_bf16 a[8:11], a[44:47], v[32:35], a[8:11]
v_add_f32 v12, v12, v49
v_add_f32 v12, v12, v50
v_mfma_f32_16x16x32_bf16 a[4:7], a[44:47], v[28:31], a[4:7]
s_waitcnt lgkmcnt(3)
v_add_f32 v12, v12, v51
LS_75:
v_mfma_f32_16x16x32_bf16 v[52:55], a[16:19], a[48:51], v[16:19]
ds_read_b128 a[36:39], v8 offset:34624
v_cvt_pk_bf16_f32 v30, v40, v41
v_mfma_f32_16x16x32_bf16 v[52:55], a[20:23], a[60:63], v[52:55]
v_exp_f32 v64, v64
v_mfma_f32_16x16x32_bf16 v[56:59], a[20:23], a[64:67], v[20:23]
v_exp_f32 v65, v65
v_mfma_f32_16x16x32_bf16 v[56:59], a[16:19], a[52:55], v[56:59]
ds_read_b128 a[40:43], v8 offset:34688
v_cvt_pk_bf16_f32 v31, v42, v43
v_mfma_f32_16x16x32_bf16 v[60:63], a[16:19], a[56:59], v[24:27]
v_exp_f32 v66, v66
v_mfma_f32_16x16x32_bf16 v[60:63], a[20:23], a[68:71], v[60:63]
s_waitcnt lgkmcnt(3)
v_cvt_pk_bf16_f32 v34, v44, v45
v_mfma_f32_16x16x32_bf16 v[60:63], a[24:27], a[80:83], v[60:63]
ds_read_b128 a[44:47], v8 offset:34752
v_cvt_pk_bf16_f32 v35, v46, v47
v_mfma_f32_16x16x32_bf16 v[60:63], a[28:31], a[92:95], v[60:63]
v_exp_f32 v67, v67
v_mfma_f32_16x16x32_bf16 v[56:59], a[28:31], a[88:91], v[56:59]
v_exp_f32 v68, v68
v_mfma_f32_16x16x32_bf16 v[56:59], a[24:27], a[76:79], v[56:59]
ds_read_b128 a[16:19], v8 offset:33792
v_cvt_pk_bf16_f32 v38, v48, v49
v_mfma_f32_16x16x32_bf16 v[52:55], a[24:27], a[72:75], v[52:55]
v_exp_f32 v69, v69
v_mfma_f32_16x16x32_bf16 v[52:55], a[28:31], a[84:87], v[52:55]
s_waitcnt lgkmcnt(3)
v_cvt_pk_bf16_f32 v39, v50, v51
v_mfma_f32_16x16x32_bf16 v[52:55], a[32:35], a[96:99], v[52:55]
ds_read_b128 a[20:23], v8 offset:33856
v_cvt_pk_bf16_f32 v28, v64, v65
v_mfma_f32_16x16x32_bf16 v[52:55], a[36:39], a[108:111], v[52:55]
v_exp_f32 v70, v70
v_mfma_f32_16x16x32_bf16 v[56:59], a[36:39], a[112:115], v[56:59]
v_exp_f32 v71, v71
v_mfma_f32_16x16x32_bf16 v[56:59], a[32:35], a[100:103], v[56:59]
ds_read_b128 a[24:27], v8 offset:33920
v_cvt_pk_bf16_f32 v29, v66, v67
v_mfma_f32_16x16x32_bf16 v[60:63], a[32:35], a[104:107], v[60:63]
v_exp_f32 v72, v72
v_mfma_f32_16x16x32_bf16 v[60:63], a[36:39], a[116:119], v[60:63]
s_waitcnt lgkmcnt(3)
v_cvt_pk_bf16_f32 v32, v68, v69
v_mfma_f32_16x16x32_bf16 v[60:63], a[40:43], a[128:131], v[60:63]
ds_read_b128 a[28:31], v8 offset:33984
v_cvt_pk_bf16_f32 v33, v70, v71
v_mfma_f32_16x16x32_bf16 v[60:63], a[44:47], a[140:143], v[60:63]
v_exp_f32 v73, v73
v_mfma_f32_16x16x32_bf16 v[56:59], a[44:47], a[136:139], v[56:59]
s_waitcnt vmcnt(20)
s_barrier
v_mfma_f32_16x16x32_bf16 v[56:59], a[40:43], a[124:127], v[56:59]
ds_read_b128 a[32:35], v8 offset:34048
v_cvt_pk_bf16_f32 v36, v72, v73
v_mfma_f32_16x16x32_bf16 v[52:55], a[40:43], a[120:123], v[52:55]
v_exp_f32 v74, v74
v_mfma_f32_16x16x32_bf16 v[52:55], a[44:47], a[132:135], v[52:55]
s_waitcnt lgkmcnt(3)
v_add_f32 v10, v10, v64
v_mfma_f32_16x16x32_bf16 v[40:43], a[16:19], a[48:51], v[16:19]
ds_read_b128 a[36:39], v8 offset:34112
v_add_f32 v10, v10, v65
v_mfma_f32_16x16x32_bf16 v[40:43], a[20:23], a[60:63], v[40:43]
v_exp_f32 v75, v75
v_mfma_f32_16x16x32_bf16 v[44:47], a[20:23], a[64:67], v[20:23]
v_cvt_pk_bf16_f32 v37, v74, v75
v_add_f32 v10, v10, v66
v_mfma_f32_16x16x32_bf16 v[44:47], a[16:19], a[52:55], v[44:47]
ds_read_b128 a[40:43], v8 offset:34176
v_max3_f32 v13, v52, v53, v54
v_mfma_f32_16x16x32_bf16 v[48:51], a[16:19], a[56:59], v[24:27]
v_max3_f32 v13, v13, v55, v56
v_add_f32 v10, v10, v67
v_mfma_f32_16x16x32_bf16 v[48:51], a[20:23], a[68:71], v[48:51]
s_waitcnt lgkmcnt(3)
v_max3_f32 v13, v13, v57, v58
v_mfma_f32_16x16x32_bf16 v[48:51], a[24:27], a[80:83], v[48:51]
ds_read_b128 a[44:47], v8 offset:34240
v_max3_f32 v13, v13, v59, v60
v_mfma_f32_16x16x32_bf16 v[48:51], a[28:31], a[92:95], v[48:51]
v_max3_f32 v13, v13, v61, v62
v_add_f32 v11, v11, v68
v_mfma_f32_16x16x32_bf16 v[44:47], a[28:31], a[88:91], v[44:47]
v_add_f32 v11, v11, v69
v_add_f32 v11, v11, v70
v_mfma_f32_16x16x32_bf16 v[44:47], a[24:27], a[76:79], v[44:47]
v_add_u32 v9, 84480, v9
ds_read_b64_tr_b16 a[16:17], v9 offset:0
v_mfma_f32_16x16x32_bf16 v[40:43], a[24:27], a[72:75], v[40:43]
ds_read_b64_tr_b16 a[18:19], v9 offset:512
v_add_f32 v11, v11, v71
v_mfma_f32_16x16x32_bf16 v[40:43], a[28:31], a[84:87], v[40:43]
s_waitcnt lgkmcnt(4)
v_add_f32 v12, v12, v72
v_mfma_f32_16x16x32_bf16 v[40:43], a[32:35], a[96:99], v[40:43]
ds_read_b64_tr_b16 a[20:21], v9 offset:32
v_add_f32 v12, v12, v73
v_mfma_f32_16x16x32_bf16 v[40:43], a[36:39], a[108:111], v[40:43]
ds_read_b64_tr_b16 a[22:23], v9 offset:544
v_add_f32 v12, v12, v74
v_mfma_f32_16x16x32_bf16 v[44:47], a[36:39], a[112:115], v[44:47]
v_add_f32 v12, v12, v75
v_max_f32 v13, v13, v63
v_mfma_f32_16x16x32_bf16 v[44:47], a[32:35], a[100:103], v[44:47]
ds_read_b64_tr_b16 a[24:25], v9 offset:64
v_mfma_f32_16x16x32_bf16 v[48:51], a[32:35], a[104:107], v[48:51]
ds_read_b64_tr_b16 a[26:27], v9 offset:576
v_mfma_f32_16x16x32_bf16 v[48:51], a[36:39], a[116:119], v[48:51]
s_waitcnt lgkmcnt(6)
v_mfma_f32_16x16x32_bf16 v[48:51], a[40:43], a[128:131], v[48:51]
ds_read_b64_tr_b16 a[28:29], v9 offset:96
v_mfma_f32_16x16x32_bf16 v[48:51], a[44:47], a[140:143], v[48:51]
ds_read_b64_tr_b16 a[30:31], v9 offset:608
v_mfma_f32_16x16x32_bf16 v[44:47], a[44:47], a[136:139], v[44:47]
v_mfma_f32_16x16x32_bf16 v[44:47], a[40:43], a[124:127], v[44:47]
ds_read_b64_tr_b16 a[32:33], v9 offset:128
v_mfma_f32_16x16x32_bf16 v[40:43], a[40:43], a[120:123], v[40:43]
ds_read_b64_tr_b16 a[34:35], v9 offset:640
v_mfma_f32_16x16x32_bf16 v[40:43], a[44:47], a[132:135], v[40:43]
s_waitcnt lgkmcnt(6)
LS_76:
v_mfma_f32_16x16x32_bf16 v[76:79], a[16:19], v[28:31], v[76:79]
ds_read_b64_tr_b16 a[36:37], v9 offset:160
v_mfma_f32_16x16x32_bf16 v[80:83], a[16:19], v[32:35], v[80:83]
ds_read_b64_tr_b16 a[38:39], v9 offset:672
v_mfma_f32_16x16x32_bf16 v[84:87], a[16:19], v[36:39], v[84:87]
s_add_u32 m0, s17, 118272
s_mov_b32 s50, 409600
v_mfma_f32_16x16x32_bf16 v[96:99], a[20:23], v[36:39], v[96:99]
ds_read_b64_tr_b16 a[40:41], v9 offset:192
v_max3_f32 v13, v13, v40, v41
v_mfma_f32_16x16x32_bf16 v[92:95], a[20:23], v[32:35], v[92:95]
ds_read_b64_tr_b16 a[42:43], v9 offset:704
v_max3_f32 v13, v13, v42, v43
v_mfma_f32_16x16x32_bf16 v[88:91], a[20:23], v[28:31], v[88:91]
s_waitcnt lgkmcnt(6)
v_max3_f32 v13, v13, v44, v45
v_mfma_f32_16x16x32_bf16 v[100:103], a[24:27], v[28:31], v[100:103]
ds_read_b64_tr_b16 a[44:45], v9 offset:224
v_max3_f32 v13, v13, v46, v47
v_mfma_f32_16x16x32_bf16 v[104:107], a[24:27], v[32:35], v[104:107]
ds_read_b64_tr_b16 a[46:47], v9 offset:736
v_max3_f32 v13, v13, v48, v49
v_mfma_f32_16x16x32_bf16 v[108:111], a[24:27], v[36:39], v[108:111]
buffer_load_dwordx4 v0, s[24:27], s50 offen offset:0 nt lds
v_mfma_f32_16x16x32_bf16 v[120:123], a[28:31], v[36:39], v[120:123]
ds_read_b64_tr_b16 a[16:17], v9 offset:256
v_max3_f32 v13, v13, v50, v51
v_mfma_f32_16x16x32_bf16 v[116:119], a[28:31], v[32:35], v[116:119]
ds_read_b64_tr_b16 a[18:19], v9 offset:768
v_cmp_lt_f32 vcc, s47, v13
v_mfma_f32_16x16x32_bf16 v[112:115], a[28:31], v[28:31], v[112:115]
s_waitcnt lgkmcnt(6)
v_mfma_f32_16x16x32_bf16 v[124:127], a[32:35], v[28:31], v[124:127]
ds_read_b64_tr_b16 a[20:21], v9 offset:288
ds_read_b64_tr_b16 a[22:23], v9 offset:800
v_mfma_f32_16x16x32_bf16 v[128:131], a[32:35], v[32:35], v[128:131]
s_cbranch_vccnz RARE_h1j7
RET_h1j7:
v_mfma_f32_16x16x32_bf16 v[132:135], a[32:35], v[36:39], v[132:135]
buffer_load_dwordx4 v1, s[24:27], s50 offen offset:1056 nt lds
v_mfma_f32_16x16x32_bf16 v[144:147], a[36:39], v[36:39], v[144:147]
ds_read_b64_tr_b16 a[24:25], v9 offset:320
ds_read_b64_tr_b16 a[26:27], v9 offset:832
v_mfma_f32_16x16x32_bf16 v[140:143], a[36:39], v[32:35], v[140:143]
v_exp_f32 v40, v40
v_mfma_f32_16x16x32_bf16 v[136:139], a[36:39], v[28:31], v[136:139]
s_waitcnt lgkmcnt(6)
v_add_f32 v10, v10, v40
v_mfma_f32_16x16x32_bf16 v[148:151], a[40:43], v[28:31], v[148:151]
ds_read_b64_tr_b16 a[28:29], v9 offset:352
ds_read_b64_tr_b16 a[30:31], v9 offset:864
v_mfma_f32_16x16x32_bf16 v[152:155], a[40:43], v[32:35], v[152:155]
buffer_load_dwordx4 v2, s[24:27], s50 offen offset:2112 nt lds
v_mfma_f32_16x16x32_bf16 v[156:159], a[40:43], v[36:39], v[156:159]
s_waitcnt vmcnt(19)
s_barrier
v_mfma_f32_16x16x32_bf16 v[168:171], a[44:47], v[36:39], v[168:171]
ds_read_b64_tr_b16 a[32:33], v9 offset:384
ds_read_b64_tr_b16 a[34:35], v9 offset:896
v_mfma_f32_16x16x32_bf16 v[164:167], a[44:47], v[32:35], v[164:167]
v_exp_f32 v41, v41
v_mfma_f32_16x16x32_bf16 v[160:163], a[44:47], v[28:31], v[160:163]
s_waitcnt lgkmcnt(6)
v_add_f32 v10, v10, v41
v_mfma_f32_16x16x32_bf16 v[172:175], a[16:19], v[28:31], v[172:175]
ds_read_b64_tr_b16 a[36:37], v9 offset:416
ds_read_b64_tr_b16 a[38:39], v9 offset:928
v_mfma_f32_16x16x32_bf16 v[176:179], a[16:19], v[32:35], v[176:179]
v_exp_f32 v42, v42
v_mfma_f32_16x16x32_bf16 v[180:183], a[16:19], v[36:39], v[180:183]
v_exp_f32 v43, v43
v_mfma_f32_16x16x32_bf16 v[192:195], a[20:23], v[36:39], v[192:195]
ds_read_b64_tr_b16 a[40:41], v9 offset:448
ds_read_b64_tr_b16 a[42:43], v9 offset:960
v_mfma_f32_16x16x32_bf16 v[188:191], a[20:23], v[32:35], v[188:191]
v_exp_f32 v44, v44
v_mfma_f32_16x16x32_bf16 v[184:187], a[20:23], v[28:31], v[184:187]
s_waitcnt lgkmcnt(6)
v_add_f32 v10, v10, v42
v_mfma_f32_16x16x32_bf16 v[196:199], a[24:27], v[28:31], v[196:199]
ds_read_b64_tr_b16 a[44:45], v9 offset:480
ds_read_b64_tr_b16 a[46:47], v9 offset:992
v_mfma_f32_16x16x32_bf16 v[200:203], a[24:27], v[32:35], v[200:203]
v_exp_f32 v45, v45
v_mfma_f32_16x16x32_bf16 v[204:207], a[24:27], v[36:39], v[204:207]
v_exp_f32 v46, v46
v_mfma_f32_16x16x32_bf16 v[216:219], a[28:31], v[36:39], v[216:219]
v_add_u32 v8, 50688, v8
ds_read_b128 a[16:19], v8 offset:16896
v_mfma_f32_16x16x32_bf16 v[212:215], a[28:31], v[32:35], v[212:215]
v_exp_f32 v47, v47
v_mfma_f32_16x16x32_bf16 v[208:211], a[28:31], v[28:31], v[208:211]
s_waitcnt lgkmcnt(5)
v_add_f32 v10, v10, v43
v_mfma_f32_16x16x32_bf16 v[220:223], a[32:35], v[28:31], v[220:223]
ds_read_b128 a[20:23], v8 offset:16960
v_add_f32 v11, v11, v44
v_mfma_f32_16x16x32_bf16 v[224:227], a[32:35], v[32:35], v[224:227]
v_exp_f32 v48, v48
v_mfma_f32_16x16x32_bf16 v[228:231], a[32:35], v[36:39], v[228:231]
v_exp_f32 v49, v49
v_mfma_f32_16x16x32_bf16 v[240:243], a[36:39], v[36:39], v[240:243]
ds_read_b128 a[24:27], v8 offset:17024
v_add_f32 v11, v11, v45
v_mfma_f32_16x16x32_bf16 v[236:239], a[36:39], v[32:35], v[236:239]
v_exp_f32 v50, v50
v_mfma_f32_16x16x32_bf16 v[232:235], a[36:39], v[28:31], v[232:235]
s_waitcnt lgkmcnt(3)
v_add_f32 v11, v11, v46
v_mfma_f32_16x16x32_bf16 v[244:247], a[40:43], v[28:31], v[244:247]
ds_read_b128 a[28:31], v8 offset:17088
v_add_f32 v11, v11, v47
v_mfma_f32_16x16x32_bf16 v[248:251], a[40:43], v[32:35], v[248:251]
v_exp_f32 v51, v51
v_mfma_f32_16x16x32_bf16 a[0:3], a[40:43], v[36:39], a[0:3]
buffer_load_dwordx4 v3, s[24:27], s50 offen offset:3168 nt lds
v_mfma_f32_16x16x32_bf16 a[12:15], a[44:47], v[36:39], a[12:15]
ds_read_b128 a[32:35], v8 offset:17152
v_add_f32 v12, v12, v48
v_mfma_f32_16x16x32_bf16 a[8:11], a[44:47], v[32:35], a[8:11]
v_add_f32 v12, v12, v49
v_add_f32 v12, v12, v50
v_mfma_f32_16x16x32_bf16 a[4:7], a[44:47], v[28:31], a[4:7]
s_waitcnt lgkmcnt(3)
v_add_f32 v12, v12, v51
LS_77:
v_mfma_f32_16x16x32_bf16 v[64:67], a[16:19], a[48:51], v[16:19]
ds_read_b128 a[36:39], v8 offset:17216
v_cvt_pk_bf16_f32 v28, v40, v41
v_mfma_f32_16x16x32_bf16 v[64:67], a[20:23], a[60:63], v[64:67]
s_add_u32 m0, s17, 50688
s_mov_b32 s50, 458752
v_mfma_f32_16x16x32_bf16 v[68:71], a[20:23], a[64:67], v[20:23]
buffer_load_dwordx4 v0, s[20:23], s50 offen offset:0 nt lds
v_mfma_f32_16x16x32_bf16 v[68:71], a[16:19], a[52:55], v[68:71]
ds_read_b128 a[40:43], v8 offset:17280
v_cvt_pk_bf16_f32 v29, v42, v43
v_mfma_f32_16x16x32_bf16 v[72:75], a[16:19], a[56:59], v[24:27]
v_exp_f32 v52, v52
v_mfma_f32_16x16x32_bf16 v[72:75], a[20:23], a[68:71], v[72:75]
s_waitcnt lgkmcnt(3)
v_cvt_pk_bf16_f32 v32, v44, v45
v_mfma_f32_16x16x32_bf16 v[72:75], a[24:27], a[80:83], v[72:75]
ds_read_b128 a[44:47], v8 offset:17344
v_cvt_pk_bf16_f32 v33, v46, v47
v_mfma_f32_16x16x32_bf16 v[72:75], a[28:31], a[92:95], v[72:75]
buffer_load_dwordx4 v1, s[20:23], s50 offen offset:1056 nt lds
v_mfma_f32_16x16x32_bf16 v[68:71], a[28:31], a[88:91], v[68:71]
v_exp_f32 v53, v53
v_mfma_f32_16x16x32_bf16 v[68:71], a[24:27], a[76:79], v[68:71]
ds_read_b128 a[16:19], v8 offset:17408
v_cvt_pk_bf16_f32 v36, v48, v49
v_mfma_f32_16x16x32_bf16 v[64:67], a[24:27], a[72:75], v[64:67]
v_exp_f32 v54, v54
v_mfma_f32_16x16x32_bf16 v[64:67], a[28:31], a[84:87], v[64:67]
s_waitcnt lgkmcnt(3)
v_cvt_pk_bf16_f32 v37, v50, v51
v_mfma_f32_16x16x32_bf16 v[64:67], a[32:35], a[96:99], v[64:67]
ds_read_b128 a[20:23], v8 offset:17472
v_cvt_pk_bf16_f32 v30, v52, v53
v_mfma_f32_16x16x32_bf16 v[64:67], a[36:39], a[108:111], v[64:67]
v_exp_f32 v55, v55
v_mfma_f32_16x16x32_bf16 v[68:71], a[36:39], a[112:115], v[68:71]
v_exp_f32 v56, v56
v_mfma_f32_16x16x32_bf16 v[68:71], a[32:35], a[100:103], v[68:71]
ds_read_b128 a[24:27], v8 offset:17536
v_cvt_pk_bf16_f32 v31, v54, v55
v_mfma_f32_16x16x32_bf16 v[72:75], a[32:35], a[104:107], v[72:75]
v_exp_f32 v57, v57
v_mfma_f32_16x16x32_bf16 v[72:75], a[36:39], a[116:119], v[72:75]
s_waitcnt lgkmcnt(3)
v_cvt_pk_bf16_f32 v34, v56, v57
v_mfma_f32_16x16x32_bf16 v[72:75], a[40:43], a[128:131], v[72:75]
ds_read_b128 a[28:31], v8 offset:17600
v_add_f32 v10, v10, v52
v_mfma_f32_16x16x32_bf16 v[72:75], a[44:47], a[140:143], v[72:75]
v_exp_f32 v58, v58
v_mfma_f32_16x16x32_bf16 v[68:71], a[44:47], a[136:139], v[68:71]
s_waitcnt vmcnt(18)
s_barrier
v_mfma_f32_16x16x32_bf16 v[68:71], a[40:43], a[124:127], v[68:71]
ds_read_b128 a[32:35], v8 offset:17664
v_add_f32 v10, v10, v53
v_mfma_f32_16x16x32_bf16 v[64:67], a[40:43], a[120:123], v[64:67]
v_exp_f32 v59, v59
v_mfma_f32_16x16x32_bf16 v[64:67], a[44:47], a[132:135], v[64:67]
s_waitcnt lgkmcnt(3)
v_cvt_pk_bf16_f32 v35, v58, v59
v_mfma_f32_16x16x32_bf16 v[40:43], a[16:19], a[48:51], v[16:19]
ds_read_b128 a[36:39], v8 offset:17728
v_add_f32 v10, v10, v54
v_mfma_f32_16x16x32_bf16 v[40:43], a[20:23], a[60:63], v[40:43]
v_exp_f32 v60, v60
v_mfma_f32_16x16x32_bf16 v[44:47], a[20:23], a[64:67], v[20:23]
v_exp_f32 v61, v61
v_mfma_f32_16x16x32_bf16 v[44:47], a[16:19], a[52:55], v[44:47]
ds_read_b128 a[40:43], v8 offset:17792
v_max3_f32 v13, v64, v65, v66
v_mfma_f32_16x16x32_bf16 v[48:51], a[16:19], a[56:59], v[24:27]
v_exp_f32 v62, v62
v_mfma_f32_16x16x32_bf16 v[48:51], a[20:23], a[68:71], v[48:51]
s_waitcnt lgkmcnt(3)
v_max3_f32 v13, v13, v67, v68
v_mfma_f32_16x16x32_bf16 v[48:51], a[24:27], a[80:83], v[48:51]
ds_read_b128 a[44:47], v8 offset:17856
v_max3_f32 v13, v13, v69, v70
v_mfma_f32_16x16x32_bf16 v[48:51], a[28:31], a[92:95], v[48:51]
v_exp_f32 v63, v63
v_mfma_f32_16x16x32_bf16 v[44:47], a[28:31], a[88:91], v[44:47]
buffer_load_dwordx4 v2, s[20:23], s50 offen offset:2112 nt lds
v_mfma_f32_16x16x32_bf16 v[44:47], a[24:27], a[76:79], v[44:47]
v_subrev_u32 v9, 84480, v9
ds_read_b64_tr_b16 a[16:17], v9 offset:16896
v_mfma_f32_16x16x32_bf16 v[40:43], a[24:27], a[72:75], v[40:43]
ds_read_b64_tr_b16 a[18:19], v9 offset:17408
v_cvt_pk_bf16_f32 v38, v60, v61
v_mfma_f32_16x16x32_bf16 v[40:43], a[28:31], a[84:87], v[40:43]
s_waitcnt lgkmcnt(4)
v_cvt_pk_bf16_f32 v39, v62, v63
v_mfma_f32_16x16x32_bf16 v[40:43], a[32:35], a[96:99], v[40:43]
ds_read_b64_tr_b16 a[20:21], v9 offset:16928
v_max3_f32 v13, v13, v71, v72
v_mfma_f32_16x16x32_bf16 v[40:43], a[36:39], a[108:111], v[40:43]
ds_read_b64_tr_b16 a[22:23], v9 offset:17440
v_max3_f32 v13, v13, v73, v74
v_mfma_f32_16x16x32_bf16 v[44:47], a[36:39], a[112:115], v[44:47]
buffer_load_dwordx4 v3, s[20:23], s50 offen offset:3168 nt lds
v_mfma_f32_16x16x32_bf16 v[44:47], a[32:35], a[100:103], v[44:47]
ds_read_b64_tr_b16 a[24:25], v9 offset:16960
v_add_f32 v10, v10, v55
v_mfma_f32_16x16x32_bf16 v[48:51], a[32:35], a[104:107], v[48:51]
ds_read_b64_tr_b16 a[26:27], v9 offset:17472
v_add_f32 v11, v11, v56
v_mfma_f32_16x16x32_bf16 v[48:51], a[36:39], a[116:119], v[48:51]
s_waitcnt lgkmcnt(6)
v_add_f32 v11, v11, v57
v_mfma_f32_16x16x32_bf16 v[48:51], a[40:43], a[128:131], v[48:51]
ds_read_b64_tr_b16 a[28:29], v9 offset:16992
v_add_f32 v11, v11, v58
v_mfma_f32_16x16x32_bf16 v[48:51], a[44:47], a[140:143], v[48:51]
ds_read_b64_tr_b16 a[30:31], v9 offset:17504
v_add_f32 v11, v11, v59
v_mfma_f32_16x16x32_bf16 v[44:47], a[44:47], a[136:139], v[44:47]
v_add_f32 v12, v12, v60
v_add_f32 v12, v12, v61
v_mfma_f32_16x16x32_bf16 v[44:47], a[40:43], a[124:127], v[44:47]
ds_read_b64_tr_b16 a[32:33], v9 offset:17024
v_add_f32 v12, v12, v62
v_mfma_f32_16x16x32_bf16 v[40:43], a[40:43], a[120:123], v[40:43]
ds_read_b64_tr_b16 a[34:35], v9 offset:17536
v_add_f32 v12, v12, v63
v_mfma_f32_16x16x32_bf16 v[40:43], a[44:47], a[132:135], v[40:43]
s_waitcnt lgkmcnt(6)
v_max_f32 v13, v13, v75
LS_78:
v_mfma_f32_16x16x32_bf16 v[76:79], a[16:19], v[28:31], v[76:79]
ds_read_b64_tr_b16 a[36:37], v9 offset:17056
v_mfma_f32_16x16x32_bf16 v[80:83], a[16:19], v[32:35], v[80:83]
ds_read_b64_tr_b16 a[38:39], v9 offset:17568
v_mfma_f32_16x16x32_bf16 v[84:87], a[16:19], v[36:39], v[84:87]
v_mfma_f32_16x16x32_bf16 v[96:99], a[20:23], v[36:39], v[96:99]
ds_read_b64_tr_b16 a[40:41], v9 offset:17088
v_max3_f32 v13, v13, v40, v41
v_mfma_f32_16x16x32_bf16 v[92:95], a[20:23], v[32:35], v[92:95]
ds_read_b64_tr_b16 a[42:43], v9 offset:17600
v_max3_f32 v13, v13, v42, v43
v_mfma_f32_16x16x32_bf16 v[88:91], a[20:23], v[28:31], v[88:91]
s_waitcnt lgkmcnt(6)
v_max3_f32 v13, v13, v44, v45
v_mfma_f32_16x16x32_bf16 v[100:103], a[24:27], v[28:31], v[100:103]
ds_read_b64_tr_b16 a[44:45], v9 offset:17120
v_max3_f32 v13, v13, v46, v47
v_mfma_f32_16x16x32_bf16 v[104:107], a[24:27], v[32:35], v[104:107]
ds_read_b64_tr_b16 a[46:47], v9 offset:17632
v_max3_f32 v13, v13, v48, v49
v_mfma_f32_16x16x32_bf16 v[108:111], a[24:27], v[36:39], v[108:111]
v_max3_f32 v13, v13, v50, v51
v_mfma_f32_16x16x32_bf16 v[120:123], a[28:31], v[36:39], v[120:123]
ds_read_b64_tr_b16 a[16:17], v9 offset:17152
v_cmp_lt_f32 vcc, s47, v13
v_mfma_f32_16x16x32_bf16 v[116:119], a[28:31], v[32:35], v[116:119]
ds_read_b64_tr_b16 a[18:19], v9 offset:17664
v_mfma_f32_16x16x32_bf16 v[112:115], a[28:31], v[28:31], v[112:115]
s_waitcnt lgkmcnt(6)
s_cbranch_vccnz RARE_h1j8
RET_h1j8:
v_mfma_f32_16x16x32_bf16 v[124:127], a[32:35], v[28:31], v[124:127]
ds_read_b64_tr_b16 a[20:21], v9 offset:17184
ds_read_b64_tr_b16 a[22:23], v9 offset:17696
v_mfma_f32_16x16x32_bf16 v[128:131], a[32:35], v[32:35], v[128:131]
v_exp_f32 v40, v40
v_mfma_f32_16x16x32_bf16 v[132:135], a[32:35], v[36:39], v[132:135]
v_exp_f32 v41, v41
v_mfma_f32_16x16x32_bf16 v[144:147], a[36:39], v[36:39], v[144:147]
ds_read_b64_tr_b16 a[24:25], v9 offset:17216
ds_read_b64_tr_b16 a[26:27], v9 offset:17728
v_mfma_f32_16x16x32_bf16 v[140:143], a[36:39], v[32:35], v[140:143]
v_exp_f32 v42, v42
v_mfma_f32_16x16x32_bf16 v[136:139], a[36:39], v[28:31], v[136:139]
s_waitcnt lgkmcnt(6)
v_add_f32 v10, v10, v40
v_mfma_f32_16x16x32_bf16 v[148:151], a[40:43], v[28:31], v[148:151]
ds_read_b64_tr_b16 a[28:29], v9 offset:17248
ds_read_b64_tr_b16 a[30:31], v9 offset:17760
v_mfma_f32_16x16x32_bf16 v[152:155], a[40:43], v[32:35], v[152:155]
v_exp_f32 v43, v43
v_mfma_f32_16x16x32_bf16 v[156:159], a[40:43], v[36:39], v[156:159]
s_waitcnt vmcnt(16)
s_barrier
v_mfma_f32_16x16x32_bf16 v[168:171], a[44:47], v[36:39], v[168:171]
ds_read_b64_tr_b16 a[32:33], v9 offset:17280
ds_read_b64_tr_b16 a[34:35], v9 offset:17792
v_mfma_f32_16x16x32_bf16 v[164:167], a[44:47], v[32:35], v[164:167]
v_exp_f32 v44, v44
v_mfma_f32_16x16x32_bf16 v[160:163], a[44:47], v[28:31], v[160:163]
s_waitcnt lgkmcnt(6)
v_add_f32 v10, v10, v41
v_mfma_f32_16x16x32_bf16 v[172:175], a[16:19], v[28:31], v[172:175]
ds_read_b64_tr_b16 a[36:37], v9 offset:17312
ds_read_b64_tr_b16 a[38:39], v9 offset:17824
v_mfma_f32_16x16x32_bf16 v[176:179], a[16:19], v[32:35], v[176:179]
v_exp_f32 v45, v45
v_mfma_f32_16x16x32_bf16 v[180:183], a[16:19], v[36:39], v[180:183]
v_exp_f32 v46, v46
v_mfma_f32_16x16x32_bf16 v[192:195], a[20:23], v[36:39], v[192:195]
ds_read_b64_tr_b16 a[40:41], v9 offset:17344
ds_read_b64_tr_b16 a[42:43], v9 offset:17856
v_mfma_f32_16x16x32_bf16 v[188:191], a[20:23], v[32:35], v[188:191]
v_exp_f32 v47, v47
v_mfma_f32_16x16x32_bf16 v[184:187], a[20:23], v[28:31], v[184:187]
s_waitcnt lgkmcnt(6)
v_add_f32 v10, v10, v42
v_mfma_f32_16x16x32_bf16 v[196:199], a[24:27], v[28:31], v[196:199]
ds_read_b64_tr_b16 a[44:45], v9 offset:17376
ds_read_b64_tr_b16 a[46:47], v9 offset:17888
v_mfma_f32_16x16x32_bf16 v[200:203], a[24:27], v[32:35], v[200:203]
v_exp_f32 v48, v48
v_mfma_f32_16x16x32_bf16 v[204:207], a[24:27], v[36:39], v[204:207]
v_exp_f32 v49, v49
v_mfma_f32_16x16x32_bf16 v[216:219], a[28:31], v[36:39], v[216:219]
v_subrev_u32 v8, 84480, v8
ds_read_b128 a[16:19], v8 offset:512
v_mfma_f32_16x16x32_bf16 v[212:215], a[28:31], v[32:35], v[212:215]
v_exp_f32 v50, v50
v_mfma_f32_16x16x32_bf16 v[208:211], a[28:31], v[28:31], v[208:211]
s_waitcnt lgkmcnt(5)
v_add_f32 v10, v10, v43
v_mfma_f32_16x16x32_bf16 v[220:223], a[32:35], v[28:31], v[220:223]
ds_read_b128 a[20:23], v8 offset:576
v_add_f32 v11, v11, v44
v_mfma_f32_16x16x32_bf16 v[224:227], a[32:35], v[32:35], v[224:227]
v_exp_f32 v51, v51
v_mfma_f32_16x16x32_bf16 v[228:231], a[32:35], v[36:39], v[228:231]
v_add_f32 v11, v11, v45
v_add_f32 v11, v11, v46
v_mfma_f32_16x16x32_bf16 v[240:243], a[36:39], v[36:39], v[240:243]
ds_read_b128 a[24:27], v8 offset:640
v_add_f32 v11, v11, v47
v_mfma_f32_16x16x32_bf16 v[236:239], a[36:39], v[32:35], v[236:239]
v_add_f32 v12, v12, v48
v_add_f32 v12, v12, v49
v_mfma_f32_16x16x32_bf16 v[232:235], a[36:39], v[28:31], v[232:235]
s_waitcnt lgkmcnt(3)
v_add_f32 v12, v12, v50
v_mfma_f32_16x16x32_bf16 v[244:247], a[40:43], v[28:31], v[244:247]
ds_read_b128 a[28:31], v8 offset:704
v_add_f32 v12, v12, v51
v_mfma_f32_16x16x32_bf16 v[248:251], a[40:43], v[32:35], v[248:251]
v_mfma_f32_16x16x32_bf16 a[0:3], a[40:43], v[36:39], a[0:3]
v_mfma_f32_16x16x32_bf16 a[12:15], a[44:47], v[36:39], a[12:15]
ds_read_b128 a[32:35], v8 offset:768
v_mfma_f32_16x16x32_bf16 a[8:11], a[44:47], v[32:35], a[8:11]
v_mfma_f32_16x16x32_bf16 a[4:7], a[44:47], v[28:31], a[4:7]
s_waitcnt lgkmcnt(3)
LS_79:
v_mfma_f32_16x16x32_bf16 v[52:55], a[16:19], a[48:51], v[16:19]
ds_read_b128 a[36:39], v8 offset:832
v_cvt_pk_bf16_f32 v30, v40, v41
v_mfma_f32_16x16x32_bf16 v[52:55], a[20:23], a[60:63], v[52:55]
s_add_u32 m0, s17, 67584
s_mov_b32 s50, 417792
v_mfma_f32_16x16x32_bf16 v[56:59], a[20:23], a[64:67], v[20:23]
buffer_load_dwordx4 v0, s[24:27], s50 offen offset:0 nt lds
v_mfma_f32_16x16x32_bf16 v[56:59], a[16:19], a[52:55], v[56:59]
ds_read_b128 a[40:43], v8 offset:896
v_cvt_pk_bf16_f32 v31, v42, v43
v_mfma_f32_16x16x32_bf16 v[60:63], a[16:19], a[56:59], v[24:27]
v_exp_f32 v64, v64
v_mfma_f32_16x16x32_bf16 v[60:63], a[20:23], a[68:71], v[60:63]
s_waitcnt lgkmcnt(3)
v_cvt_pk_bf16_f32 v34, v44, v45
v_mfma_f32_16x16x32_bf16 v[60:63], a[24:27], a[80:83], v[60:63]
ds_read_b128 a[44:47], v8 offset:960
v_cvt_pk_bf16_f32 v35, v46, v47
v_mfma_f32_16x16x32_bf16 v[60:63], a[28:31], a[92:95], v[60:63]
buffer_load_dwordx4 v1, s[24:27], s50 offen offset:1056 nt lds
v_mfma_f32_16x16x32_bf16 v[56:59], a[28:31], a[88:91], v[56:59]
v_exp_f32 v65, v65
v_mfma_f32_16x16x32_bf16 v[56:59], a[24:27], a[76:79], v[56:59]
ds_read_b128 a[16:19], v8 offset:0
v_cvt_pk_bf16_f32 v38, v48, v49
v_mfma_f32_16x16x32_bf16 v[52:55], a[24:27], a[72:75], v[52:55]
v_exp_f32 v66, v66
v_mfma_f32_16x16x32_bf16 v[52:55], a[28:31], a[84:87], v[52:55]
s_waitcnt lgkmcnt(3)
v_cvt_pk_bf16_f32 v39, v50, v51
v_mfma_f32_16x16x32_bf16 v[52:55], a[32:35], a[96:99], v[52:55]
ds_read_b128 a[20:23], v8 offset:64
v_cvt_pk_bf16_f32 v28, v64, v65
v_mfma_f32_16x16x32_bf16 v[52:55], a[36:39], a[108:111], v[52:55]
v_exp_f32 v67, v67
v_mfma_f32_16x16x32_bf16 v[56:59], a[36:39], a[112:115], v[56:59]
v_exp_f32 v68, v68
v_mfma_f32_16x16x32_bf16 v[56:59], a[32:35], a[100:103], v[56:59]
ds_read_b128 a[24:27], v8 offset:128
v_cvt_pk_bf16_f32 v29, v66, v67
v_mfma_f32_16x16x32_bf16 v[60:63], a[32:35], a[104:107], v[60:63]
v_exp_f32 v69, v69
v_mfma_f32_16x16x32_bf16 v[60:63], a[36:39], a[116:119], v[60:63]
s_waitcnt lgkmcnt(3)
v_cvt_pk_bf16_f32 v32, v68, v69
v_mfma_f32_16x16x32_bf16 v[60:63], a[40:43], a[128:131], v[60:63]
ds_read_b128 a[28:31], v8 offset:192
v_add_f32 v10, v10, v64
v_mfma_f32_16x16x32_bf16 v[60:63], a[44:47], a[140:143], v[60:63]
v_exp_f32 v70, v70
v_mfma_f32_16x16x32_bf16 v[56:59], a[44:47], a[136:139], v[56:59]
s_waitcnt vmcnt(14)
s_barrier
v_mfma_f32_16x16x32_bf16 v[56:59], a[40:43], a[124:127], v[56:59]
ds_read_b128 a[32:35], v8 offset:256
v_add_f32 v10, v10, v65
v_mfma_f32_16x16x32_bf16 v[52:55], a[40:43], a[120:123], v[52:55]
v_exp_f32 v71, v71
v_mfma_f32_16x16x32_bf16 v[52:55], a[44:47], a[132:135], v[52:55]
s_waitcnt lgkmcnt(3)
v_cvt_pk_bf16_f32 v33, v70, v71
v_mfma_f32_16x16x32_bf16 v[40:43], a[16:19], a[48:51], v[16:19]
ds_read_b128 a[36:39], v8 offset:320
v_add_f32 v10, v10, v66
v_mfma_f32_16x16x32_bf16 v[40:43], a[20:23], a[60:63], v[40:43]
v_exp_f32 v72, v72
v_mfma_f32_16x16x32_bf16 v[44:47], a[20:23], a[64:67], v[20:23]
v_exp_f32 v73, v73
v_mfma_f32_16x16x32_bf16 v[44:47], a[16:19], a[52:55], v[44:47]
ds_read_b128 a[40:43], v8 offset:384
v_max3_f32 v13, v52, v53, v54
v_mfma_f32_16x16x32_bf16 v[48:51], a[16:19], a[56:59], v[24:27]
v_exp_f32 v74, v74
v_mfma_f32_16x16x32_bf16 v[48:51], a[20:23], a[68:71], v[48:51]
s_waitcnt lgkmcnt(3)
v_max3_f32 v13, v13, v55, v56
v_mfma_f32_16x16x32_bf16 v[48:51], a[24:27], a[80:83], v[48:51]
ds_read_b128 a[44:47], v8 offset:448
v_max3_f32 v13, v13, v57, v58
v_mfma_f32_16x16x32_bf16 v[48:51], a[28:31], a[92:95], v[48:51]
v_exp_f32 v75, v75
v_mfma_f32_16x16x32_bf16 v[44:47], a[28:31], a[88:91], v[44:47]
buffer_load_dwordx4 v2, s[24:27], s50 offen offset:2112 nt lds
v_mfma_f32_16x16x32_bf16 v[44:47], a[24:27], a[76:79], v[44:47]
v_add_u32 v9, 84480, v9
ds_read_b64_tr_b16 a[16:17], v9 offset:50688
v_mfma_f32_16x16x32_bf16 v[40:43], a[24:27], a[72:75], v[40:43]
ds_read_b64_tr_b16 a[18:19], v9 offset:51200
v_cvt_pk_bf16_f32 v36, v72, v73
v_mfma_f32_16x16x32_bf16 v[40:43], a[28:31], a[84:87], v[40:43]
s_waitcnt lgkmcnt(4)
v_cvt_pk_bf16_f32 v37, v74, v75
v_mfma_f32_16x16x32_bf16 v[40:43], a[32:35], a[96:99], v[40:43]
ds_read_b64_tr_b16 a[20:21], v9 offset:50720
v_max3_f32 v13, v13, v59, v60
v_mfma_f32_16x16x32_bf16 v[40:43], a[36:39], a[108:111], v[40:43]
ds_read_b64_tr_b16 a[22:23], v9 offset:51232
v_max3_f32 v13, v13, v61, v62
v_mfma_f32_16x16x32_bf16 v[44:47], a[36:39], a[112:115], v[44:47]
buffer_load_dwordx4 v3, s[24:27], s50 offen offset:3168 nt lds
v_mfma_f32_16x16x32_bf16 v[44:47], a[32:35], a[100:103], v[44:47]
ds_read_b64_tr_b16 a[24:25], v9 offset:50752
v_add_f32 v10, v10, v67
v_mfma_f32_16x16x32_bf16 v[48:51], a[32:35], a[104:107], v[48:51]
ds_read_b64_tr_b16 a[26:27], v9 offset:51264
v_add_f32 v11, v11, v68
v_mfma_f32_16x16x32_bf16 v[48:51], a[36:39], a[116:119], v[48:51]
s_waitcnt lgkmcnt(6)
v_add_f32 v11, v11, v69
v_mfma_f32_16x16x32_bf16 v[48:51], a[40:43], a[128:131], v[48:51]
ds_read_b64_tr_b16 a[28:29], v9 offset:50784
v_add_f32 v11, v11, v70
v_mfma_f32_16x16x32_bf16 v[48:51], a[44:47], a[140:143], v[48:51]
ds_read_b64_tr_b16 a[30:31], v9 offset:51296
v_add_f32 v11, v11, v71
v_mfma_f32_16x16x32_bf16 v[44:47], a[44:47], a[136:139], v[44:47]
v_add_f32 v12, v12, v72
v_add_f32 v12, v12, v73
v_mfma_f32_16x16x32_bf16 v[44:47], a[40:43], a[124:127], v[44:47]
ds_read_b64_tr_b16 a[32:33], v9 offset:50816
v_add_f32 v12, v12, v74
v_mfma_f32_16x16x32_bf16 v[40:43], a[40:43], a[120:123], v[40:43]
ds_read_b64_tr_b16 a[34:35], v9 offset:51328
v_add_f32 v12, v12, v75
v_mfma_f32_16x16x32_bf16 v[40:43], a[44:47], a[132:135], v[40:43]
s_waitcnt lgkmcnt(6)
v_max_f32 v13, v13, v63
LS_80:
v_mfma_f32_16x16x32_bf16 v[76:79], a[16:19], v[28:31], v[76:79]
ds_read_b64_tr_b16 a[36:37], v9 offset:50848
v_mfma_f32_16x16x32_bf16 v[80:83], a[16:19], v[32:35], v[80:83]
ds_read_b64_tr_b16 a[38:39], v9 offset:51360
v_mfma_f32_16x16x32_bf16 v[84:87], a[16:19], v[36:39], v[84:87]
s_add_u32 m0, s17, 84480
s_mov_b32 s50, 466944
v_mfma_f32_16x16x32_bf16 v[96:99], a[20:23], v[36:39], v[96:99]
ds_read_b64_tr_b16 a[40:41], v9 offset:50880
v_max3_f32 v13, v13, v40, v41
v_mfma_f32_16x16x32_bf16 v[92:95], a[20:23], v[32:35], v[92:95]
ds_read_b64_tr_b16 a[42:43], v9 offset:51392
v_max3_f32 v13, v13, v42, v43
v_mfma_f32_16x16x32_bf16 v[88:91], a[20:23], v[28:31], v[88:91]
s_waitcnt lgkmcnt(6)
v_max3_f32 v13, v13, v44, v45
v_mfma_f32_16x16x32_bf16 v[100:103], a[24:27], v[28:31], v[100:103]
ds_read_b64_tr_b16 a[44:45], v9 offset:50912
v_max3_f32 v13, v13, v46, v47
v_mfma_f32_16x16x32_bf16 v[104:107], a[24:27], v[32:35], v[104:107]
ds_read_b64_tr_b16 a[46:47], v9 offset:51424
v_max3_f32 v13, v13, v48, v49
v_mfma_f32_16x16x32_bf16 v[108:111], a[24:27], v[36:39], v[108:111]
buffer_load_dwordx4 v0, s[20:23], s50 offen offset:0 nt lds
v_mfma_f32_16x16x32_bf16 v[120:123], a[28:31], v[36:39], v[120:123]
ds_read_b64_tr_b16 a[16:17], v9 offset:50944
v_max3_f32 v13, v13, v50, v51
v_mfma_f32_16x16x32_bf16 v[116:119], a[28:31], v[32:35], v[116:119]
ds_read_b64_tr_b16 a[18:19], v9 offset:51456
v_cmp_lt_f32 vcc, s47, v13
v_mfma_f32_16x16x32_bf16 v[112:115], a[28:31], v[28:31], v[112:115]
s_waitcnt lgkmcnt(6)
v_mfma_f32_16x16x32_bf16 v[124:127], a[32:35], v[28:31], v[124:127]
ds_read_b64_tr_b16 a[20:21], v9 offset:50976
ds_read_b64_tr_b16 a[22:23], v9 offset:51488
v_mfma_f32_16x16x32_bf16 v[128:131], a[32:35], v[32:35], v[128:131]
s_cbranch_vccnz RARE_h1j9
RET_h1j9:
v_mfma_f32_16x16x32_bf16 v[132:135], a[32:35], v[36:39], v[132:135]
buffer_load_dwordx4 v1, s[20:23], s50 offen offset:1056 nt lds
v_mfma_f32_16x16x32_bf16 v[144:147], a[36:39], v[36:39], v[144:147]
ds_read_b64_tr_b16 a[24:25], v9 offset:51008
ds_read_b64_tr_b16 a[26:27], v9 offset:51520
v_mfma_f32_16x16x32_bf16 v[140:143], a[36:39], v[32:35], v[140:143]
v_exp_f32 v40, v40
v_mfma_f32_16x16x32_bf16 v[136:139], a[36:39], v[28:31], v[136:139]
s_waitcnt lgkmcnt(6)
v_add_f32 v10, v10, v40
v_mfma_f32_16x16x32_bf16 v[148:151], a[40:43], v[28:31], v[148:151]
ds_read_b64_tr_b16 a[28:29], v9 offset:51040
ds_read_b64_tr_b16 a[30:31], v9 offset:51552
v_mfma_f32_16x16x32_bf16 v[152:155], a[40:43], v[32:35], v[152:155]
buffer_load_dwordx4 v2, s[20:23], s50 offen offset:2112 nt lds
v_mfma_f32_16x16x32_bf16 v[156:159], a[40:43], v[36:39], v[156:159]
s_waitcnt vmcnt(15)
s_barrier
v_mfma_f32_16x16x32_bf16 v[168:171], a[44:47], v[36:39], v[168:171]
ds_read_b64_tr_b16 a[32:33], v9 offset:51072
ds_read_b64_tr_b16 a[34:35], v9 offset:51584
v_mfma_f32_16x16x32_bf16 v[164:167], a[44:47], v[32:35], v[164:167]
v_exp_f32 v41, v41
v_mfma_f32_16x16x32_bf16 v[160:163], a[44:47], v[28:31], v[160:163]
s_waitcnt lgkmcnt(6)
v_add_f32 v10, v10, v41
v_mfma_f32_16x16x32_bf16 v[172:175], a[16:19], v[28:31], v[172:175]
ds_read_b64_tr_b16 a[36:37], v9 offset:51104
ds_read_b64_tr_b16 a[38:39], v9 offset:51616
v_mfma_f32_16x16x32_bf16 v[176:179], a[16:19], v[32:35], v[176:179]
v_exp_f32 v42, v42
v_mfma_f32_16x16x32_bf16 v[180:183], a[16:19], v[36:39], v[180:183]
v_exp_f32 v43, v43
v_mfma_f32_16x16x32_bf16 v[192:195], a[20:23], v[36:39], v[192:195]
ds_read_b64_tr_b16 a[40:41], v9 offset:51136
ds_read_b64_tr_b16 a[42:43], v9 offset:51648
v_mfma_f32_16x16x32_bf16 v[188:191], a[20:23], v[32:35], v[188:191]
v_exp_f32 v44, v44
v_mfma_f32_16x16x32_bf16 v[184:187], a[20:23], v[28:31], v[184:187]
s_waitcnt lgkmcnt(6)
v_add_f32 v10, v10, v42
v_mfma_f32_16x16x32_bf16 v[196:199], a[24:27], v[28:31], v[196:199]
ds_read_b64_tr_b16 a[44:45], v9 offset:51168
ds_read_b64_tr_b16 a[46:47], v9 offset:51680
v_mfma_f32_16x16x32_bf16 v[200:203], a[24:27], v[32:35], v[200:203]
v_exp_f32 v45, v45
v_mfma_f32_16x16x32_bf16 v[204:207], a[24:27], v[36:39], v[204:207]
v_exp_f32 v46, v46
v_mfma_f32_16x16x32_bf16 v[216:219], a[28:31], v[36:39], v[216:219]
ds_read_b128 a[16:19], v8 offset:33792
v_add_f32 v10, v10, v43
v_mfma_f32_16x16x32_bf16 v[212:215], a[28:31], v[32:35], v[212:215]
v_exp_f32 v47, v47
v_mfma_f32_16x16x32_bf16 v[208:211], a[28:31], v[28:31], v[208:211]
s_waitcnt lgkmcnt(5)
v_add_f32 v11, v11, v44
v_mfma_f32_16x16x32_bf16 v[220:223], a[32:35], v[28:31], v[220:223]
ds_read_b128 a[20:23], v8 offset:33856
v_add_f32 v11, v11, v45
v_mfma_f32_16x16x32_bf16 v[224:227], a[32:35], v[32:35], v[224:227]
v_exp_f32 v48, v48
v_mfma_f32_16x16x32_bf16 v[228:231], a[32:35], v[36:39], v[228:231]
v_exp_f32 v49, v49
v_mfma_f32_16x16x32_bf16 v[240:243], a[36:39], v[36:39], v[240:243]
ds_read_b128 a[24:27], v8 offset:33920
v_add_f32 v11, v11, v46
v_mfma_f32_16x16x32_bf16 v[236:239], a[36:39], v[32:35], v[236:239]
v_exp_f32 v50, v50
v_mfma_f32_16x16x32_bf16 v[232:235], a[36:39], v[28:31], v[232:235]
s_waitcnt lgkmcnt(3)
v_add_f32 v11, v11, v47
v_mfma_f32_16x16x32_bf16 v[244:247], a[40:43], v[28:31], v[244:247]
ds_read_b128 a[28:31], v8 offset:33984
v_add_f32 v12, v12, v48
v_mfma_f32_16x16x32_bf16 v[248:251], a[40:43], v[32:35], v[248:251]
v_exp_f32 v51, v51
v_mfma_f32_16x16x32_bf16 a[0:3], a[40:43], v[36:39], a[0:3]
buffer_load_dwordx4 v3, s[20:23], s50 offen offset:3168 nt lds
v_mfma_f32_16x16x32_bf16 a[12:15], a[44:47], v[36:39], a[12:15]
ds_read_b128 a[32:35], v8 offset:34048
v_add_f32 v12, v12, v49
v_mfma_f32_16x16x32_bf16 a[8:11], a[44:47], v[32:35], a[8:11]
v_add_f32 v12, v12, v50
v_add_f32 v12, v12, v51
v_mfma_f32_16x16x32_bf16 a[4:7], a[44:47], v[28:31], a[4:7]
s_waitcnt lgkmcnt(3)
LS_81:
v_mfma_f32_16x16x32_bf16 v[64:67], a[16:19], a[48:51], v[16:19]
ds_read_b128 a[36:39], v8 offset:34112
v_cvt_pk_bf16_f32 v28, v40, v41
v_mfma_f32_16x16x32_bf16 v[64:67], a[20:23], a[60:63], v[64:67]
s_add_u32 m0, s17, 101376
s_mov_b32 s50, 458752
v_mfma_f32_16x16x32_bf16 v[68:71], a[20:23], a[64:67], v[20:23]
buffer_load_dwordx4 v0, s[24:27], s50 offen offset:0 nt lds
v_mfma_f32_16x16x32_bf16 v[68:71], a[16:19], a[52:55], v[68:71]
ds_read_b128 a[40:43], v8 offset:34176
v_cvt_pk_bf16_f32 v29, v42, v43
v_mfma_f32_16x16x32_bf16 v[72:75], a[16:19], a[56:59], v[24:27]
v_exp_f32 v52, v52
v_mfma_f32_16x16x32_bf16 v[72:75], a[20:23], a[68:71], v[72:75]
s_waitcnt lgkmcnt(3)
v_cvt_pk_bf16_f32 v32, v44, v45
v_mfma_f32_16x16x32_bf16 v[72:75], a[24:27], a[80:83], v[72:75]
ds_read_b128 a[44:47], v8 offset:34240
v_cvt_pk_bf16_f32 v33, v46, v47
v_mfma_f32_16x16x32_bf16 v[72:75], a[28:31], a[92:95], v[72:75]
buffer_load_dwordx4 v1, s[24:27], s50 offen offset:1056 nt lds
v_mfma_f32_16x16x32_bf16 v[68:71], a[28:31], a[88:91], v[68:71]
v_exp_f32 v53, v53
v_mfma_f32_16x16x32_bf16 v[68:71], a[24:27], a[76:79], v[68:71]
ds_read_b128 a[16:19], v8 offset:34304
v_cvt_pk_bf16_f32 v36, v48, v49
v_mfma_f32_16x16x32_bf16 v[64:67], a[24:27], a[72:75], v[64:67]
v_exp_f32 v54, v54
v_mfma_f32_16x16x32_bf16 v[64:67], a[28:31], a[84:87], v[64:67]
s_waitcnt lgkmcnt(3)
v_cvt_pk_bf16_f32 v37, v50, v51
v_mfma_f32_16x16x32_bf16 v[64:67], a[32:35], a[96:99], v[64:67]
ds_read_b128 a[20:23], v8 offset:34368
v_cvt_pk_bf16_f32 v30, v52, v53
v_mfma_f32_16x16x32_bf16 v[64:67], a[36:39], a[108:111], v[64:67]
v_exp_f32 v55, v55
v_mfma_f32_16x16x32_bf16 v[68:71], a[36:39], a[112:115], v[68:71]
v_exp_f32 v56, v56
v_mfma_f32_16x16x32_bf16 v[68:71], a[32:35], a[100:103], v[68:71]
ds_read_b128 a[24:27], v8 offset:34432
v_cvt_pk_bf16_f32 v31, v54, v55
v_mfma_f32_16x16x32_bf16 v[72:75], a[32:35], a[104:107], v[72:75]
v_exp_f32 v57, v57
v_mfma_f32_16x16x32_bf16 v[72:75], a[36:39], a[116:119], v[72:75]
s_waitcnt lgkmcnt(3)
v_cvt_pk_bf16_f32 v34, v56, v57
v_mfma_f32_16x16x32_bf16 v[72:75], a[40:43], a[128:131], v[72:75]
ds_read_b128 a[28:31], v8 offset:34496
v_add_f32 v10, v10, v52
v_mfma_f32_16x16x32_bf16 v[72:75], a[44:47], a[140:143], v[72:75]
v_exp_f32 v58, v58
v_mfma_f32_16x16x32_bf16 v[68:71], a[44:47], a[136:139], v[68:71]
s_waitcnt vmcnt(14)
s_barrier
v_mfma_f32_16x16x32_bf16 v[68:71], a[40:43], a[124:127], v[68:71]
ds_read_b128 a[32:35], v8 offset:34560
v_add_f32 v10, v10, v53
v_mfma_f32_16x16x32_bf16 v[64:67], a[40:43], a[120:123], v[64:67]
v_exp_f32 v59, v59
v_mfma_f32_16x16x32_bf16 v[64:67], a[44:47], a[132:135], v[64:67]
s_waitcnt lgkmcnt(3)
v_cvt_pk_bf16_f32 v35, v58, v59
v_mfma_f32_16x16x32_bf16 v[40:43], a[16:19], a[48:51], v[16:19]
ds_read_b128 a[36:39], v8 offset:34624
v_add_f32 v10, v10, v54
v_mfma_f32_16x16x32_bf16 v[40:43], a[20:23], a[60:63], v[40:43]
v_exp_f32 v60, v60
v_mfma_f32_16x16x32_bf16 v[44:47], a[20:23], a[64:67], v[20:23]
v_exp_f32 v61, v61
v_mfma_f32_16x16x32_bf16 v[44:47], a[16:19], a[52:55], v[44:47]
ds_read_b128 a[40:43], v8 offset:34688
v_max3_f32 v13, v64, v65, v66
v_mfma_f32_16x16x32_bf16 v[48:51], a[16:19], a[56:59], v[24:27]
v_exp_f32 v62, v62
v_mfma_f32_16x16x32_bf16 v[48:51], a[20:23], a[68:71], v[48:51]
s_waitcnt lgkmcnt(3)
v_max3_f32 v13, v13, v67, v68
v_mfma_f32_16x16x32_bf16 v[48:51], a[24:27], a[80:83], v[48:51]
ds_read_b128 a[44:47], v8 offset:34752
v_max3_f32 v13, v13, v69, v70
v_mfma_f32_16x16x32_bf16 v[48:51], a[28:31], a[92:95], v[48:51]
v_exp_f32 v63, v63
v_mfma_f32_16x16x32_bf16 v[44:47], a[28:31], a[88:91], v[44:47]
buffer_load_dwordx4 v2, s[24:27], s50 offen offset:2112 nt lds
v_mfma_f32_16x16x32_bf16 v[44:47], a[24:27], a[76:79], v[44:47]
ds_read_b64_tr_b16 a[16:17], v9 offset:33792
v_cvt_pk_bf16_f32 v38, v60, v61
v_mfma_f32_16x16x32_bf16 v[40:43], a[24:27], a[72:75], v[40:43]
ds_read_b64_tr_b16 a[18:19], v9 offset:34304
v_cvt_pk_bf16_f32 v39, v62, v63
v_mfma_f32_16x16x32_bf16 v[40:43], a[28:31], a[84:87], v[40:43]
s_waitcnt lgkmcnt(4)
v_max3_f32 v13, v13, v71, v72
v_mfma_f32_16x16x32_bf16 v[40:43], a[32:35], a[96:99], v[40:43]
ds_read_b64_tr_b16 a[20:21], v9 offset:33824
v_max3_f32 v13, v13, v73, v74
v_mfma_f32_16x16x32_bf16 v[40:43], a[36:39], a[108:111], v[40:43]
ds_read_b64_tr_b16 a[22:23], v9 offset:34336
v_add_f32 v10, v10, v55
v_mfma_f32_16x16x32_bf16 v[44:47], a[36:39], a[112:115], v[44:47]
buffer_load_dwordx4 v3, s[24:27], s50 offen offset:3168 nt lds
v_mfma_f32_16x16x32_bf16 v[44:47], a[32:35], a[100:103], v[44:47]
ds_read_b64_tr_b16 a[24:25], v9 offset:33856
v_add_f32 v11, v11, v56
v_mfma_f32_16x16x32_bf16 v[48:51], a[32:35], a[104:107], v[48:51]
ds_read_b64_tr_b16 a[26:27], v9 offset:34368
v_add_f32 v11, v11, v57
v_mfma_f32_16x16x32_bf16 v[48:51], a[36:39], a[116:119], v[48:51]
s_waitcnt lgkmcnt(6)
v_add_f32 v11, v11, v58
v_mfma_f32_16x16x32_bf16 v[48:51], a[40:43], a[128:131], v[48:51]
ds_read_b64_tr_b16 a[28:29], v9 offset:33888
v_add_f32 v11, v11, v59
v_mfma_f32_16x16x32_bf16 v[48:51], a[44:47], a[140:143], v[48:51]
ds_read_b64_tr_b16 a[30:31], v9 offset:34400
v_add_f32 v12, v12, v60
v_mfma_f32_16x16x32_bf16 v[44:47], a[44:47], a[136:139], v[44:47]
v_add_f32 v12, v12, v61
v_add_f32 v12, v12, v62
v_mfma_f32_16x16x32_bf16 v[44:47], a[40:43], a[124:127], v[44:47]
ds_read_b64_tr_b16 a[32:33], v9 offset:33920
v_add_f32 v12, v12, v63
v_mfma_f32_16x16x32_bf16 v[40:43], a[40:43], a[120:123], v[40:43]
ds_read_b64_tr_b16 a[34:35], v9 offset:34432
v_max_f32 v13, v13, v75
v_mfma_f32_16x16x32_bf16 v[40:43], a[44:47], a[132:135], v[40:43]
s_waitcnt lgkmcnt(6)
LS_82:
v_mfma_f32_16x16x32_bf16 v[76:79], a[16:19], v[28:31], v[76:79]
ds_read_b64_tr_b16 a[36:37], v9 offset:33952
v_mfma_f32_16x16x32_bf16 v[80:83], a[16:19], v[32:35], v[80:83]
ds_read_b64_tr_b16 a[38:39], v9 offset:34464
v_mfma_f32_16x16x32_bf16 v[84:87], a[16:19], v[36:39], v[84:87]
v_mfma_f32_16x16x32_bf16 v[96:99], a[20:23], v[36:39], v[96:99]
ds_read_b64_tr_b16 a[40:41], v9 offset:33984
v_max3_f32 v13, v13, v40, v41
v_mfma_f32_16x16x32_bf16 v[92:95], a[20:23], v[32:35], v[92:95]
ds_read_b64_tr_b16 a[42:43], v9 offset:34496
v_max3_f32 v13, v13, v42, v43
v_mfma_f32_16x16x32_bf16 v[88:91], a[20:23], v[28:31], v[88:91]
s_waitcnt lgkmcnt(6)
v_max3_f32 v13, v13, v44, v45
v_mfma_f32_16x16x32_bf16 v[100:103], a[24:27], v[28:31], v[100:103]
ds_read_b64_tr_b16 a[44:45], v9 offset:34016
v_max3_f32 v13, v13, v46, v47
v_mfma_f32_16x16x32_bf16 v[104:107], a[24:27], v[32:35], v[104:107]
ds_read_b64_tr_b16 a[46:47], v9 offset:34528
v_max3_f32 v13, v13, v48, v49
v_mfma_f32_16x16x32_bf16 v[108:111], a[24:27], v[36:39], v[108:111]
v_max3_f32 v13, v13, v50, v51
v_mfma_f32_16x16x32_bf16 v[120:123], a[28:31], v[36:39], v[120:123]
ds_read_b64_tr_b16 a[16:17], v9 offset:34048
v_cmp_lt_f32 vcc, s47, v13
v_mfma_f32_16x16x32_bf16 v[116:119], a[28:31], v[32:35], v[116:119]
ds_read_b64_tr_b16 a[18:19], v9 offset:34560
v_mfma_f32_16x16x32_bf16 v[112:115], a[28:31], v[28:31], v[112:115]
s_waitcnt lgkmcnt(6)
s_cbranch_vccnz RARE_h1j10
RET_h1j10:
v_mfma_f32_16x16x32_bf16 v[124:127], a[32:35], v[28:31], v[124:127]
ds_read_b64_tr_b16 a[20:21], v9 offset:34080
ds_read_b64_tr_b16 a[22:23], v9 offset:34592
v_mfma_f32_16x16x32_bf16 v[128:131], a[32:35], v[32:35], v[128:131]
v_exp_f32 v40, v40
v_mfma_f32_16x16x32_bf16 v[132:135], a[32:35], v[36:39], v[132:135]
v_exp_f32 v41, v41
v_mfma_f32_16x16x32_bf16 v[144:147], a[36:39], v[36:39], v[144:147]
ds_read_b64_tr_b16 a[24:25], v9 offset:34112
ds_read_b64_tr_b16 a[26:27], v9 offset:34624
v_mfma_f32_16x16x32_bf16 v[140:143], a[36:39], v[32:35], v[140:143]
v_exp_f32 v42, v42
v_mfma_f32_16x16x32_bf16 v[136:139], a[36:39], v[28:31], v[136:139]
s_waitcnt lgkmcnt(6)
v_add_f32 v10, v10, v40
v_mfma_f32_16x16x32_bf16 v[148:151], a[40:43], v[28:31], v[148:151]
ds_read_b64_tr_b16 a[28:29], v9 offset:34144
ds_read_b64_tr_b16 a[30:31], v9 offset:34656
v_mfma_f32_16x16x32_bf16 v[152:155], a[40:43], v[32:35], v[152:155]
v_exp_f32 v43, v43
v_mfma_f32_16x16x32_bf16 v[156:159], a[40:43], v[36:39], v[156:159]
s_waitcnt vmcnt(12)
s_barrier
v_mfma_f32_16x16x32_bf16 v[168:171], a[44:47], v[36:39], v[168:171]
ds_read_b64_tr_b16 a[32:33], v9 offset:34176
ds_read_b64_tr_b16 a[34:35], v9 offset:34688
v_mfma_f32_16x16x32_bf16 v[164:167], a[44:47], v[32:35], v[164:167]
v_exp_f32 v44, v44
v_mfma_f32_16x16x32_bf16 v[160:163], a[44:47], v[28:31], v[160:163]
s_waitcnt lgkmcnt(6)
v_add_f32 v10, v10, v41
v_mfma_f32_16x16x32_bf16 v[172:175], a[16:19], v[28:31], v[172:175]
ds_read_b64_tr_b16 a[36:37], v9 offset:34208
ds_read_b64_tr_b16 a[38:39], v9 offset:34720
v_mfma_f32_16x16x32_bf16 v[176:179], a[16:19], v[32:35], v[176:179]
v_exp_f32 v45, v45
v_mfma_f32_16x16x32_bf16 v[180:183], a[16:19], v[36:39], v[180:183]
v_exp_f32 v46, v46
v_mfma_f32_16x16x32_bf16 v[192:195], a[20:23], v[36:39], v[192:195]
ds_read_b64_tr_b16 a[40:41], v9 offset:34240
ds_read_b64_tr_b16 a[42:43], v9 offset:34752
v_mfma_f32_16x16x32_bf16 v[188:191], a[20:23], v[32:35], v[188:191]
v_exp_f32 v47, v47
v_mfma_f32_16x16x32_bf16 v[184:187], a[20:23], v[28:31], v[184:187]
s_waitcnt lgkmcnt(6)
v_add_f32 v10, v10, v42
v_mfma_f32_16x16x32_bf16 v[196:199], a[24:27], v[28:31], v[196:199]
ds_read_b64_tr_b16 a[44:45], v9 offset:34272
ds_read_b64_tr_b16 a[46:47], v9 offset:34784
v_mfma_f32_16x16x32_bf16 v[200:203], a[24:27], v[32:35], v[200:203]
v_exp_f32 v48, v48
v_mfma_f32_16x16x32_bf16 v[204:207], a[24:27], v[36:39], v[204:207]
v_exp_f32 v49, v49
v_mfma_f32_16x16x32_bf16 v[216:219], a[28:31], v[36:39], v[216:219]
ds_read_b128 a[16:19], v8 offset:51200
v_add_f32 v10, v10, v43
v_mfma_f32_16x16x32_bf16 v[212:215], a[28:31], v[32:35], v[212:215]
v_exp_f32 v50, v50
v_mfma_f32_16x16x32_bf16 v[208:211], a[28:31], v[28:31], v[208:211]
s_waitcnt lgkmcnt(5)
v_add_f32 v11, v11, v44
v_mfma_f32_16x16x32_bf16 v[220:223], a[32:35], v[28:31], v[220:223]
ds_read_b128 a[20:23], v8 offset:51264
v_add_f32 v11, v11, v45
v_mfma_f32_16x16x32_bf16 v[224:227], a[32:35], v[32:35], v[224:227]
v_exp_f32 v51, v51
v_mfma_f32_16x16x32_bf16 v[228:231], a[32:35], v[36:39], v[228:231]
v_add_f32 v11, v11, v46
v_add_f32 v11, v11, v47
v_mfma_f32_16x16x32_bf16 v[240:243], a[36:39], v[36:39], v[240:243]
ds_read_b128 a[24:27], v8 offset:51328
v_add_f32 v12, v12, v48
v_mfma_f32_16x16x32_bf16 v[236:239], a[36:39], v[32:35], v[236:239]
v_add_f32 v12, v12, v49
v_add_f32 v12, v12, v50
v_mfma_f32_16x16x32_bf16 v[232:235], a[36:39], v[28:31], v[232:235]
s_waitcnt lgkmcnt(3)
v_add_f32 v12, v12, v51
v_mfma_f32_16x16x32_bf16 v[244:247], a[40:43], v[28:31], v[244:247]
ds_read_b128 a[28:31], v8 offset:51392
v_mfma_f32_16x16x32_bf16 v[248:251], a[40:43], v[32:35], v[248:251]
v_mfma_f32_16x16x32_bf16 a[0:3], a[40:43], v[36:39], a[0:3]
v_mfma_f32_16x16x32_bf16 a[12:15], a[44:47], v[36:39], a[12:15]
ds_read_b128 a[32:35], v8 offset:51456
v_mfma_f32_16x16x32_bf16 a[8:11], a[44:47], v[32:35], a[8:11]
v_mfma_f32_16x16x32_bf16 a[4:7], a[44:47], v[28:31], a[4:7]
s_waitcnt lgkmcnt(3)
LS_83:
v_mfma_f32_16x16x32_bf16 v[52:55], a[16:19], a[48:51], v[16:19]
ds_read_b128 a[36:39], v8 offset:51520
v_cvt_pk_bf16_f32 v30, v40, v41
v_mfma_f32_16x16x32_bf16 v[52:55], a[20:23], a[60:63], v[52:55]
s_add_u32 m0, s17, 16896
s_mov_b32 s50, 475136
v_mfma_f32_16x16x32_bf16 v[56:59], a[20:23], a[64:67], v[20:23]
buffer_load_dwordx4 v0, s[20:23], s50 offen offset:0 nt lds
v_mfma_f32_16x16x32_bf16 v[56:59], a[16:19], a[52:55], v[56:59]
ds_read_b128 a[40:43], v8 offset:51584
v_cvt_pk_bf16_f32 v31, v42, v43
v_mfma_f32_16x16x32_bf16 v[60:63], a[16:19], a[56:59], v[24:27]
v_exp_f32 v64, v64
v_mfma_f32_16x16x32_bf16 v[60:63], a[20:23], a[68:71], v[60:63]
s_waitcnt lgkmcnt(3)
v_cvt_pk_bf16_f32 v34, v44, v45
v_mfma_f32_16x16x32_bf16 v[60:63], a[24:27], a[80:83], v[60:63]
ds_read_b128 a[44:47], v8 offset:51648
v_cvt_pk_bf16_f32 v35, v46, v47
v_mfma_f32_16x16x32_bf16 v[60:63], a[28:31], a[92:95], v[60:63]
buffer_load_dwordx4 v1, s[20:23], s50 offen offset:1056 nt lds
v_mfma_f32_16x16x32_bf16 v[56:59], a[28:31], a[88:91], v[56:59]
v_exp_f32 v65, v65
v_mfma_f32_16x16x32_bf16 v[56:59], a[24:27], a[76:79], v[56:59]
ds_read_b128 a[16:19], v8 offset:50688
v_cvt_pk_bf16_f32 v38, v48, v49
v_mfma_f32_16x16x32_bf16 v[52:55], a[24:27], a[72:75], v[52:55]
v_exp_f32 v66, v66
v_mfma_f32_16x16x32_bf16 v[52:55], a[28:31], a[84:87], v[52:55]
s_waitcnt lgkmcnt(3)
v_cvt_pk_bf16_f32 v39, v50, v51
v_mfma_f32_16x16x32_bf16 v[52:55], a[32:35], a[96:99], v[52:55]
ds_read_b128 a[20:23], v8 offset:50752
v_cvt_pk_bf16_f32 v28, v64, v65
v_mfma_f32_16x16x32_bf16 v[52:55], a[36:39], a[108:111], v[52:55]
v_exp_f32 v67, v67
v_mfma_f32_16x16x32_bf16 v[56:59], a[36:39], a[112:115], v[56:59]
v_exp_f32 v68, v68
v_mfma_f32_16x16x32_bf16 v[56:59], a[32:35], a[100:103], v[56:59]
ds_read_b128 a[24:27], v8 offset:50816
v_cvt_pk_bf16_f32 v29, v66, v67
v_mfma_f32_16x16x32_bf16 v[60:63], a[32:35], a[104:107], v[60:63]
v_exp_f32 v69, v69
v_mfma_f32_16x16x32_bf16 v[60:63], a[36:39], a[116:119], v[60:63]
s_waitcnt lgkmcnt(3)
v_cvt_pk_bf16_f32 v32, v68, v69
v_mfma_f32_16x16x32_bf16 v[60:63], a[40:43], a[128:131], v[60:63]
ds_read_b128 a[28:31], v8 offset:50880
v_add_f32 v10, v10, v64
v_mfma_f32_16x16x32_bf16 v[60:63], a[44:47], a[140:143], v[60:63]
v_exp_f32 v70, v70
v_mfma_f32_16x16x32_bf16 v[56:59], a[44:47], a[136:139], v[56:59]
s_waitcnt vmcnt(10)
s_barrier
v_mfma_f32_16x16x32_bf16 v[56:59], a[40:43], a[124:127], v[56:59]
ds_read_b128 a[32:35], v8 offset:50944
v_add_f32 v10, v10, v65
v_mfma_f32_16x16x32_bf16 v[52:55], a[40:43], a[120:123], v[52:55]
v_exp_f32 v71, v71
v_mfma_f32_16x16x32_bf16 v[52:55], a[44:47], a[132:135], v[52:55]
s_waitcnt lgkmcnt(3)
v_cvt_pk_bf16_f32 v33, v70, v71
v_mfma_f32_16x16x32_bf16 v[40:43], a[16:19], a[48:51], v[16:19]
ds_read_b128 a[36:39], v8 offset:51008
v_add_f32 v10, v10, v66
v_mfma_f32_16x16x32_bf16 v[40:43], a[20:23], a[60:63], v[40:43]
v_exp_f32 v72, v72
v_mfma_f32_16x16x32_bf16 v[44:47], a[20:23], a[64:67], v[20:23]
v_exp_f32 v73, v73
v_mfma_f32_16x16x32_bf16 v[44:47], a[16:19], a[52:55], v[44:47]
ds_read_b128 a[40:43], v8 offset:51072
v_max3_f32 v13, v52, v53, v54
v_mfma_f32_16x16x32_bf16 v[48:51], a[16:19], a[56:59], v[24:27]
v_exp_f32 v74, v74
v_mfma_f32_16x16x32_bf16 v[48:51], a[20:23], a[68:71], v[48:51]
s_waitcnt lgkmcnt(3)
v_max3_f32 v13, v13, v55, v56
v_mfma_f32_16x16x32_bf16 v[48:51], a[24:27], a[80:83], v[48:51]
ds_read_b128 a[44:47], v8 offset:51136
v_max3_f32 v13, v13, v57, v58
v_mfma_f32_16x16x32_bf16 v[48:51], a[28:31], a[92:95], v[48:51]
v_exp_f32 v75, v75
v_mfma_f32_16x16x32_bf16 v[44:47], a[28:31], a[88:91], v[44:47]
buffer_load_dwordx4 v2, s[20:23], s50 offen offset:2112 nt lds
v_mfma_f32_16x16x32_bf16 v[44:47], a[24:27], a[76:79], v[44:47]
v_subrev_u32 v9, 50688, v9
ds_read_b64_tr_b16 a[16:17], v9 offset:33792
v_mfma_f32_16x16x32_bf16 v[40:43], a[24:27], a[72:75], v[40:43]
ds_read_b64_tr_b16 a[18:19], v9 offset:34304
v_cvt_pk_bf16_f32 v36, v72, v73
v_mfma_f32_16x16x32_bf16 v[40:43], a[28:31], a[84:87], v[40:43]
s_waitcnt lgkmcnt(4)
v_cvt_pk_bf16_f32 v37, v74, v75
v_mfma_f32_16x16x32_bf16 v[40:43], a[32:35], a[96:99], v[40:43]
ds_read_b64_tr_b16 a[20:21], v9 offset:33824
v_max3_f32 v13, v13, v59, v60
v_mfma_f32_16x16x32_bf16 v[40:43], a[36:39], a[108:111], v[40:43]
ds_read_b64_tr_b16 a[22:23], v9 offset:34336
v_max3_f32 v13, v13, v61, v62
v_mfma_f32_16x16x32_bf16 v[44:47], a[36:39], a[112:115], v[44:47]
buffer_load_dwordx4 v3, s[20:23], s50 offen offset:3168 nt lds
v_mfma_f32_16x16x32_bf16 v[44:47], a[32:35], a[100:103], v[44:47]
ds_read_b64_tr_b16 a[24:25], v9 offset:33856
v_add_f32 v10, v10, v67
v_mfma_f32_16x16x32_bf16 v[48:51], a[32:35], a[104:107], v[48:51]
ds_read_b64_tr_b16 a[26:27], v9 offset:34368
v_add_f32 v11, v11, v68
v_mfma_f32_16x16x32_bf16 v[48:51], a[36:39], a[116:119], v[48:51]
s_waitcnt lgkmcnt(6)
v_add_f32 v11, v11, v69
v_mfma_f32_16x16x32_bf16 v[48:51], a[40:43], a[128:131], v[48:51]
ds_read_b64_tr_b16 a[28:29], v9 offset:33888
v_add_f32 v11, v11, v70
v_mfma_f32_16x16x32_bf16 v[48:51], a[44:47], a[140:143], v[48:51]
ds_read_b64_tr_b16 a[30:31], v9 offset:34400
v_add_f32 v11, v11, v71
v_mfma_f32_16x16x32_bf16 v[44:47], a[44:47], a[136:139], v[44:47]
v_add_f32 v12, v12, v72
v_add_f32 v12, v12, v73
v_mfma_f32_16x16x32_bf16 v[44:47], a[40:43], a[124:127], v[44:47]
ds_read_b64_tr_b16 a[32:33], v9 offset:33920
v_add_f32 v12, v12, v74
v_mfma_f32_16x16x32_bf16 v[40:43], a[40:43], a[120:123], v[40:43]
ds_read_b64_tr_b16 a[34:35], v9 offset:34432
v_add_f32 v12, v12, v75
v_mfma_f32_16x16x32_bf16 v[40:43], a[44:47], a[132:135], v[40:43]
s_waitcnt lgkmcnt(6)
v_max_f32 v13, v13, v63
LS_84:
v_mfma_f32_16x16x32_bf16 v[76:79], a[16:19], v[28:31], v[76:79]
ds_read_b64_tr_b16 a[36:37], v9 offset:33952
v_mfma_f32_16x16x32_bf16 v[80:83], a[16:19], v[32:35], v[80:83]
ds_read_b64_tr_b16 a[38:39], v9 offset:34464
v_mfma_f32_16x16x32_bf16 v[84:87], a[16:19], v[36:39], v[84:87]
s_add_u32 m0, s17, 0
s_mov_b32 s50, 466944
v_mfma_f32_16x16x32_bf16 v[96:99], a[20:23], v[36:39], v[96:99]
ds_read_b64_tr_b16 a[40:41], v9 offset:33984
v_max3_f32 v13, v13, v40, v41
v_mfma_f32_16x16x32_bf16 v[92:95], a[20:23], v[32:35], v[92:95]
ds_read_b64_tr_b16 a[42:43], v9 offset:34496
v_max3_f32 v13, v13, v42, v43
v_mfma_f32_16x16x32_bf16 v[88:91], a[20:23], v[28:31], v[88:91]
s_waitcnt lgkmcnt(6)
v_max3_f32 v13, v13, v44, v45
v_mfma_f32_16x16x32_bf16 v[100:103], a[24:27], v[28:31], v[100:103]
ds_read_b64_tr_b16 a[44:45], v9 offset:34016
v_max3_f32 v13, v13, v46, v47
v_mfma_f32_16x16x32_bf16 v[104:107], a[24:27], v[32:35], v[104:107]
ds_read_b64_tr_b16 a[46:47], v9 offset:34528
v_max3_f32 v13, v13, v48, v49
v_mfma_f32_16x16x32_bf16 v[108:111], a[24:27], v[36:39], v[108:111]
buffer_load_dwordx4 v0, s[24:27], s50 offen offset:0 nt lds
v_mfma_f32_16x16x32_bf16 v[120:123], a[28:31], v[36:39], v[120:123]
ds_read_b64_tr_b16 a[16:17], v9 offset:34048
v_max3_f32 v13, v13, v50, v51
v_mfma_f32_16x16x32_bf16 v[116:119], a[28:31], v[32:35], v[116:119]
ds_read_b64_tr_b16 a[18:19], v9 offset:34560
v_cmp_lt_f32 vcc, s47, v13
v_mfma_f32_16x16x32_bf16 v[112:115], a[28:31], v[28:31], v[112:115]
s_waitcnt lgkmcnt(6)
v_mfma_f32_16x16x32_bf16 v[124:127], a[32:35], v[28:31], v[124:127]
ds_read_b64_tr_b16 a[20:21], v9 offset:34080
ds_read_b64_tr_b16 a[22:23], v9 offset:34592
v_mfma_f32_16x16x32_bf16 v[128:131], a[32:35], v[32:35], v[128:131]
s_cbranch_vccnz RARE_h1j11
RET_h1j11:
v_mfma_f32_16x16x32_bf16 v[132:135], a[32:35], v[36:39], v[132:135]
buffer_load_dwordx4 v1, s[24:27], s50 offen offset:1056 nt lds
v_mfma_f32_16x16x32_bf16 v[144:147], a[36:39], v[36:39], v[144:147]
ds_read_b64_tr_b16 a[24:25], v9 offset:34112
ds_read_b64_tr_b16 a[26:27], v9 offset:34624
v_mfma_f32_16x16x32_bf16 v[140:143], a[36:39], v[32:35], v[140:143]
v_exp_f32 v40, v40
v_mfma_f32_16x16x32_bf16 v[136:139], a[36:39], v[28:31], v[136:139]
s_waitcnt lgkmcnt(6)
v_add_f32 v10, v10, v40
v_mfma_f32_16x16x32_bf16 v[148:151], a[40:43], v[28:31], v[148:151]
ds_read_b64_tr_b16 a[28:29], v9 offset:34144
ds_read_b64_tr_b16 a[30:31], v9 offset:34656
v_mfma_f32_16x16x32_bf16 v[152:155], a[40:43], v[32:35], v[152:155]
buffer_load_dwordx4 v2, s[24:27], s50 offen offset:2112 nt lds
v_mfma_f32_16x16x32_bf16 v[156:159], a[40:43], v[36:39], v[156:159]
s_waitcnt vmcnt(11)
s_barrier
v_mfma_f32_16x16x32_bf16 v[168:171], a[44:47], v[36:39], v[168:171]
ds_read_b64_tr_b16 a[32:33], v9 offset:34176
ds_read_b64_tr_b16 a[34:35], v9 offset:34688
v_mfma_f32_16x16x32_bf16 v[164:167], a[44:47], v[32:35], v[164:167]
buffer_load_dwordx4 v3, s[24:27], s50 offen offset:3168 nt lds
v_mfma_f32_16x16x32_bf16 v[160:163], a[44:47], v[28:31], v[160:163]
s_waitcnt lgkmcnt(6)
s_add_u32 m0, s17, 135168
s_add_u32 s50, s99, 0
v_mfma_f32_16x16x32_bf16 v[172:175], a[16:19], v[28:31], v[172:175]
ds_read_b64_tr_b16 a[36:37], v9 offset:34208
ds_read_b64_tr_b16 a[38:39], v9 offset:34720
v_mfma_f32_16x16x32_bf16 v[176:179], a[16:19], v[32:35], v[176:179]
buffer_load_dwordx4 v4, s[32:35], s50 offen offset:0 lds
v_mfma_f32_16x16x32_bf16 v[180:183], a[16:19], v[36:39], v[180:183]
v_exp_f32 v41, v41
v_mfma_f32_16x16x32_bf16 v[192:195], a[20:23], v[36:39], v[192:195]
ds_read_b64_tr_b16 a[40:41], v9 offset:34240
ds_read_b64_tr_b16 a[42:43], v9 offset:34752
v_add_f32 v10, v10, v41
v_mfma_f32_16x16x32_bf16 v[188:191], a[20:23], v[32:35], v[188:191]
buffer_load_dwordx4 v5, s[32:35], s50 offen offset:1056 lds
v_mfma_f32_16x16x32_bf16 v[184:187], a[20:23], v[28:31], v[184:187]
s_waitcnt lgkmcnt(6)
v_exp_f32 v42, v42
v_mfma_f32_16x16x32_bf16 v[196:199], a[24:27], v[28:31], v[196:199]
ds_read_b64_tr_b16 a[44:45], v9 offset:34272
ds_read_b64_tr_b16 a[46:47], v9 offset:34784
v_add_f32 v10, v10, v42
v_mfma_f32_16x16x32_bf16 v[200:203], a[24:27], v[32:35], v[200:203]
buffer_load_dwordx4 v6, s[32:35], s50 offen offset:2112 lds
v_mfma_f32_16x16x32_bf16 v[204:207], a[24:27], v[36:39], v[204:207]
v_exp_f32 v43, v43
v_mfma_f32_16x16x32_bf16 v[216:219], a[28:31], v[36:39], v[216:219]
v_add_u32 v8, 84480, v8
ds_read_b128 a[16:19], v8 offset:0
v_add_f32 v10, v10, v43
v_mfma_f32_16x16x32_bf16 v[212:215], a[28:31], v[32:35], v[212:215]
v_exp_f32 v44, v44
v_mfma_f32_16x16x32_bf16 v[208:211], a[28:31], v[28:31], v[208:211]
s_waitcnt lgkmcnt(5)
v_exp_f32 v45, v45
v_mfma_f32_16x16x32_bf16 v[220:223], a[32:35], v[28:31], v[220:223]
ds_read_b128 a[20:23], v8 offset:64
v_exp_f32 v46, v46
v_mfma_f32_16x16x32_bf16 v[224:227], a[32:35], v[32:35], v[224:227]
v_exp_f32 v47, v47
v_mfma_f32_16x16x32_bf16 v[228:231], a[32:35], v[36:39], v[228:231]
v_exp_f32 v48, v48
v_mfma_f32_16x16x32_bf16 v[240:243], a[36:39], v[36:39], v[240:243]
ds_read_b128 a[24:27], v8 offset:128
v_exp_f32 v49, v49
v_mfma_f32_16x16x32_bf16 v[236:239], a[36:39], v[32:35], v[236:239]
v_exp_f32 v50, v50
v_mfma_f32_16x16x32_bf16 v[232:235], a[36:39], v[28:31], v[232:235]
s_waitcnt lgkmcnt(3)
v_add_f32 v11, v11, v44
v_mfma_f32_16x16x32_bf16 v[244:247], a[40:43], v[28:31], v[244:247]
ds_read_b128 a[28:31], v8 offset:192
v_exp_f32 v51, v51
v_mfma_f32_16x16x32_bf16 v[248:251], a[40:43], v[32:35], v[248:251]
buffer_load_dwordx4 v7, s[32:35], s50 offen offset:3168 lds
v_mfma_f32_16x16x32_bf16 a[0:3], a[40:43], v[36:39], a[0:3]
v_add_f32 v11, v11, v45
v_add_f32 v11, v11, v46
v_mfma_f32_16x16x32_bf16 a[12:15], a[44:47], v[36:39], a[12:15]
ds_read_b128 a[32:35], v8 offset:256
v_add_f32 v11, v11, v47
v_add_f32 v12, v12, v48
v_mfma_f32_16x16x32_bf16 a[8:11], a[44:47], v[32:35], a[8:11]
v_add_f32 v12, v12, v49
v_add_f32 v12, v12, v50
v_mfma_f32_16x16x32_bf16 a[4:7], a[44:47], v[28:31], a[4:7]
s_waitcnt lgkmcnt(3)
v_add_f32 v12, v12, v51
LS_85:
v_mfma_f32_16x16x32_bf16 v[64:67], a[16:19], a[48:51], v[16:19]
ds_read_b128 a[36:39], v8 offset:320
v_cvt_pk_bf16_f32 v28, v40, v41
v_mfma_f32_16x16x32_bf16 v[64:67], a[20:23], a[60:63], v[64:67]
v_exp_f32 v52, v52
v_mfma_f32_16x16x32_bf16 v[68:71], a[20:23], a[64:67], v[20:23]
v_exp_f32 v53, v53
v_mfma_f32_16x16x32_bf16 v[68:71], a[16:19], a[52:55], v[68:71]
ds_read_b128 a[40:43], v8 offset:384
v_cvt_pk_bf16_f32 v29, v42, v43
v_mfma_f32_16x16x32_bf16 v[72:75], a[16:19], a[56:59], v[24:27]
v_exp_f32 v54, v54
v_mfma_f32_16x16x32_bf16 v[72:75], a[20:23], a[68:71], v[72:75]
s_waitcnt lgkmcnt(3)
v_cvt_pk_bf16_f32 v32, v44, v45
v_mfma_f32_16x16x32_bf16 v[72:75], a[24:27], a[80:83], v[72:75]
ds_read_b128 a[44:47], v8 offset:448
v_cvt_pk_bf16_f32 v33, v46, v47
v_mfma_f32_16x16x32_bf16 v[72:75], a[28:31], a[92:95], v[72:75]
v_exp_f32 v55, v55
v_mfma_f32_16x16x32_bf16 v[68:71], a[28:31], a[88:91], v[68:71]
v_exp_f32 v56, v56
v_mfma_f32_16x16x32_bf16 v[68:71], a[24:27], a[76:79], v[68:71]
ds_read_b128 a[16:19], v8 offset:512
v_cvt_pk_bf16_f32 v36, v48, v49
v_mfma_f32_16x16x32_bf16 v[64:67], a[24:27], a[72:75], v[64:67]
v_exp_f32 v57, v57
v_mfma_f32_16x16x32_bf16 v[64:67], a[28:31], a[84:87], v[64:67]
s_waitcnt lgkmcnt(3)
v_cvt_pk_bf16_f32 v37, v50, v51
v_mfma_f32_16x16x32_bf16 v[64:67], a[32:35], a[96:99], v[64:67]
ds_read_b128 a[20:23], v8 offset:576
v_cvt_pk_bf16_f32 v30, v52, v53
v_mfma_f32_16x16x32_bf16 v[64:67], a[36:39], a[108:111], v[64:67]
v_exp_f32 v58, v58
v_mfma_f32_16x16x32_bf16 v[68:71], a[36:39], a[112:115], v[68:71]
v_exp_f32 v59, v59
v_mfma_f32_16x16x32_bf16 v[68:71], a[32:35], a[100:103], v[68:71]
ds_read_b128 a[24:27], v8 offset:640
v_cvt_pk_bf16_f32 v31, v54, v55
v_mfma_f32_16x16x32_bf16 v[72:75], a[32:35], a[104:107], v[72:75]
v_exp_f32 v60, v60
v_mfma_f32_16x16x32_bf16 v[72:75], a[36:39], a[116:119], v[72:75]
s_waitcnt lgkmcnt(3)
v_cvt_pk_bf16_f32 v34, v56, v57
v_mfma_f32_16x16x32_bf16 v[72:75], a[40:43], a[128:131], v[72:75]
ds_read_b128 a[28:31], v8 offset:704
v_cvt_pk_bf16_f32 v35, v58, v59
v_mfma_f32_16x16x32_bf16 v[72:75], a[44:47], a[140:143], v[72:75]
v_exp_f32 v61, v61
v_mfma_f32_16x16x32_bf16 v[68:71], a[44:47], a[136:139], v[68:71]
s_waitcnt vmcnt(12)
s_barrier
v_mfma_f32_16x16x32_bf16 v[68:71], a[40:43], a[124:127], v[68:71]
ds_read_b128 a[32:35], v8 offset:768
v_cvt_pk_bf16_f32 v38, v60, v61
v_mfma_f32_16x16x32_bf16 v[64:67], a[40:43], a[120:123], v[64:67]
v_exp_f32 v62, v62
v_mfma_f32_16x16x32_bf16 v[64:67], a[44:47], a[132:135], v[64:67]
s_waitcnt lgkmcnt(3)
v_add_f32 v10, v10, v52
v_mfma_f32_16x16x32_bf16 v[40:43], a[16:19], a[48:51], v[16:19]
ds_read_b128 a[36:39], v8 offset:832
v_add_f32 v10, v10, v53
v_mfma_f32_16x16x32_bf16 v[40:43], a[20:23], a[60:63], v[40:43]
v_exp_f32 v63, v63
v_mfma_f32_16x16x32_bf16 v[44:47], a[20:23], a[64:67], v[20:23]
v_cvt_pk_bf16_f32 v39, v62, v63
v_add_f32 v10, v10, v54
v_mfma_f32_16x16x32_bf16 v[44:47], a[16:19], a[52:55], v[44:47]
ds_read_b128 a[40:43], v8 offset:896
v_max3_f32 v13, v64, v65, v66
v_mfma_f32_16x16x32_bf16 v[48:51], a[16:19], a[56:59], v[24:27]
v_max3_f32 v13, v13, v67, v68
v_add_f32 v10, v10, v55
v_mfma_f32_16x16x32_bf16 v[48:51], a[20:23], a[68:71], v[48:51]
s_waitcnt lgkmcnt(3)
v_max3_f32 v13, v13, v69, v70
v_mfma_f32_16x16x32_bf16 v[48:51], a[24:27], a[80:83], v[48:51]
ds_read_b128 a[44:47], v8 offset:960
v_max3_f32 v13, v13, v71, v72
v_mfma_f32_16x16x32_bf16 v[48:51], a[28:31], a[92:95], v[48:51]
v_max3_f32 v13, v13, v73, v74
v_add_f32 v11, v11, v56
v_mfma_f32_16x16x32_bf16 v[44:47], a[28:31], a[88:91], v[44:47]
v_add_f32 v11, v11, v57
v_add_f32 v11, v11, v58
v_mfma_f32_16x16x32_bf16 v[44:47], a[24:27], a[76:79], v[44:47]
v_add_u32 v9, 50688, v9
ds_read_b64_tr_b16 a[16:17], v9 offset:16896
v_mfma_f32_16x16x32_bf16 v[40:43], a[24:27], a[72:75], v[40:43]
ds_read_b64_tr_b16 a[18:19], v9 offset:17408
v_add_f32 v11, v11, v59
v_mfma_f32_16x16x32_bf16 v[40:43], a[28:31], a[84:87], v[40:43]
s_waitcnt lgkmcnt(4)
v_add_f32 v12, v12, v60
v_mfma_f32_16x16x32_bf16 v[40:43], a[32:35], a[96:99], v[40:43]
ds_read_b64_tr_b16 a[20:21], v9 offset:16928
v_add_f32 v12, v12, v61
v_mfma_f32_16x16x32_bf16 v[40:43], a[36:39], a[108:111], v[40:43]
ds_read_b64_tr_b16 a[22:23], v9 offset:17440
v_add_f32 v12, v12, v62
v_mfma_f32_16x16x32_bf16 v[44:47], a[36:39], a[112:115], v[44:47]
v_add_f32 v12, v12, v63
v_max_f32 v13, v13, v75
v_mfma_f32_16x16x32_bf16 v[44:47], a[32:35], a[100:103], v[44:47]
ds_read_b64_tr_b16 a[24:25], v9 offset:16960
v_mfma_f32_16x16x32_bf16 v[48:51], a[32:35], a[104:107], v[48:51]
ds_read_b64_tr_b16 a[26:27], v9 offset:17472
v_mfma_f32_16x16x32_bf16 v[48:51], a[36:39], a[116:119], v[48:51]
s_waitcnt lgkmcnt(6)
v_mfma_f32_16x16x32_bf16 v[48:51], a[40:43], a[128:131], v[48:51]
ds_read_b64_tr_b16 a[28:29], v9 offset:16992
v_mfma_f32_16x16x32_bf16 v[48:51], a[44:47], a[140:143], v[48:51]
ds_read_b64_tr_b16 a[30:31], v9 offset:17504
v_mfma_f32_16x16x32_bf16 v[44:47], a[44:47], a[136:139], v[44:47]
v_mfma_f32_16x16x32_bf16 v[44:47], a[40:43], a[124:127], v[44:47]
ds_read_b64_tr_b16 a[32:33], v9 offset:17024
v_mfma_f32_16x16x32_bf16 v[40:43], a[40:43], a[120:123], v[40:43]
ds_read_b64_tr_b16 a[34:35], v9 offset:17536
v_mfma_f32_16x16x32_bf16 v[40:43], a[44:47], a[132:135], v[40:43]
s_waitcnt lgkmcnt(6)
LS_86:
v_mfma_f32_16x16x32_bf16 v[76:79], a[16:19], v[28:31], v[76:79]
ds_read_b64_tr_b16 a[36:37], v9 offset:17056
v_mfma_f32_16x16x32_bf16 v[80:83], a[16:19], v[32:35], v[80:83]
ds_read_b64_tr_b16 a[38:39], v9 offset:17568
v_mfma_f32_16x16x32_bf16 v[84:87], a[16:19], v[36:39], v[84:87]
s_add_u32 m0, s17, 33792
s_mov_b32 s50, 483328
v_mfma_f32_16x16x32_bf16 v[96:99], a[20:23], v[36:39], v[96:99]
ds_read_b64_tr_b16 a[40:41], v9 offset:17088
v_max3_f32 v13, v13, v40, v41
v_mfma_f32_16x16x32_bf16 v[92:95], a[20:23], v[32:35], v[92:95]
ds_read_b64_tr_b16 a[42:43], v9 offset:17600
v_max3_f32 v13, v13, v42, v43
v_mfma_f32_16x16x32_bf16 v[88:91], a[20:23], v[28:31], v[88:91]
s_waitcnt lgkmcnt(6)
v_max3_f32 v13, v13, v44, v45
v_mfma_f32_16x16x32_bf16 v[100:103], a[24:27], v[28:31], v[100:103]
ds_read_b64_tr_b16 a[44:45], v9 offset:17120
v_max3_f32 v13, v13, v46, v47
v_mfma_f32_16x16x32_bf16 v[104:107], a[24:27], v[32:35], v[104:107]
ds_read_b64_tr_b16 a[46:47], v9 offset:17632
v_max3_f32 v13, v13, v48, v49
v_mfma_f32_16x16x32_bf16 v[108:111], a[24:27], v[36:39], v[108:111]
buffer_load_dwordx4 v0, s[20:23], s50 offen offset:0 nt lds
v_mfma_f32_16x16x32_bf16 v[120:123], a[28:31], v[36:39], v[120:123]
ds_read_b64_tr_b16 a[16:17], v9 offset:17152
v_max3_f32 v13, v13, v50, v51
v_mfma_f32_16x16x32_bf16 v[116:119], a[28:31], v[32:35], v[116:119]
ds_read_b64_tr_b16 a[18:19], v9 offset:17664
v_cmp_lt_f32 vcc, s47, v13
v_mfma_f32_16x16x32_bf16 v[112:115], a[28:31], v[28:31], v[112:115]
s_waitcnt lgkmcnt(6)
v_mfma_f32_16x16x32_bf16 v[124:127], a[32:35], v[28:31], v[124:127]
ds_read_b64_tr_b16 a[20:21], v9 offset:17184
ds_read_b64_tr_b16 a[22:23], v9 offset:17696
v_mfma_f32_16x16x32_bf16 v[128:131], a[32:35], v[32:35], v[128:131]
s_cbranch_vccnz RARE_h1j12
RET_h1j12:
v_mfma_f32_16x16x32_bf16 v[132:135], a[32:35], v[36:39], v[132:135]
buffer_load_dwordx4 v1, s[20:23], s50 offen offset:1056 nt lds
v_mfma_f32_16x16x32_bf16 v[144:147], a[36:39], v[36:39], v[144:147]
ds_read_b64_tr_b16 a[24:25], v9 offset:17216
ds_read_b64_tr_b16 a[26:27], v9 offset:17728
v_mfma_f32_16x16x32_bf16 v[140:143], a[36:39], v[32:35], v[140:143]
v_exp_f32 v40, v40
v_mfma_f32_16x16x32_bf16 v[136:139], a[36:39], v[28:31], v[136:139]
s_waitcnt lgkmcnt(6)
v_add_f32 v10, v10, v40
v_mfma_f32_16x16x32_bf16 v[148:151], a[40:43], v[28:31], v[148:151]
ds_read_b64_tr_b16 a[28:29], v9 offset:17248
ds_read_b64_tr_b16 a[30:31], v9 offset:17760
v_mfma_f32_16x16x32_bf16 v[152:155], a[40:43], v[32:35], v[152:155]
buffer_load_dwordx4 v2, s[20:23], s50 offen offset:2112 nt lds
v_mfma_f32_16x16x32_bf16 v[156:159], a[40:43], v[36:39], v[156:159]
s_waitcnt vmcnt(11)
s_barrier
v_mfma_f32_16x16x32_bf16 v[168:171], a[44:47], v[36:39], v[168:171]
ds_read_b64_tr_b16 a[32:33], v9 offset:17280
ds_read_b64_tr_b16 a[34:35], v9 offset:17792
v_mfma_f32_16x16x32_bf16 v[164:167], a[44:47], v[32:35], v[164:167]
buffer_load_dwordx4 v3, s[20:23], s50 offen offset:3168 nt lds
v_mfma_f32_16x16x32_bf16 v[160:163], a[44:47], v[28:31], v[160:163]
s_waitcnt lgkmcnt(6)
s_add_u32 m0, s17, 118272
s_add_u32 s50, s99, 114688
v_mfma_f32_16x16x32_bf16 v[172:175], a[16:19], v[28:31], v[172:175]
ds_read_b64_tr_b16 a[36:37], v9 offset:17312
ds_read_b64_tr_b16 a[38:39], v9 offset:17824
v_mfma_f32_16x16x32_bf16 v[176:179], a[16:19], v[32:35], v[176:179]
buffer_load_dwordx4 v4, s[32:35], s50 offen offset:0 lds
v_mfma_f32_16x16x32_bf16 v[180:183], a[16:19], v[36:39], v[180:183]
v_exp_f32 v41, v41
v_mfma_f32_16x16x32_bf16 v[192:195], a[20:23], v[36:39], v[192:195]
ds_read_b64_tr_b16 a[40:41], v9 offset:17344
ds_read_b64_tr_b16 a[42:43], v9 offset:17856
v_add_f32 v10, v10, v41
v_mfma_f32_16x16x32_bf16 v[188:191], a[20:23], v[32:35], v[188:191]
buffer_load_dwordx4 v5, s[32:35], s50 offen offset:1056 lds
v_mfma_f32_16x16x32_bf16 v[184:187], a[20:23], v[28:31], v[184:187]
s_waitcnt lgkmcnt(6)
v_exp_f32 v42, v42
v_mfma_f32_16x16x32_bf16 v[196:199], a[24:27], v[28:31], v[196:199]
ds_read_b64_tr_b16 a[44:45], v9 offset:17376
ds_read_b64_tr_b16 a[46:47], v9 offset:17888
v_add_f32 v10, v10, v42
v_mfma_f32_16x16x32_bf16 v[200:203], a[24:27], v[32:35], v[200:203]
buffer_load_dwordx4 v6, s[32:35], s50 offen offset:2112 lds
v_mfma_f32_16x16x32_bf16 v[204:207], a[24:27], v[36:39], v[204:207]
v_exp_f32 v43, v43
v_mfma_f32_16x16x32_bf16 v[216:219], a[28:31], v[36:39], v[216:219]
v_subrev_u32 v8, 84480, v8
ds_read_b128 a[16:19], v8 offset:17408
v_add_f32 v10, v10, v43
v_mfma_f32_16x16x32_bf16 v[212:215], a[28:31], v[32:35], v[212:215]
v_exp_f32 v44, v44
v_mfma_f32_16x16x32_bf16 v[208:211], a[28:31], v[28:31], v[208:211]
s_waitcnt lgkmcnt(5)
v_exp_f32 v45, v45
v_mfma_f32_16x16x32_bf16 v[220:223], a[32:35], v[28:31], v[220:223]
ds_read_b128 a[20:23], v8 offset:17472
v_exp_f32 v46, v46
v_mfma_f32_16x16x32_bf16 v[224:227], a[32:35], v[32:35], v[224:227]
v_exp_f32 v47, v47
v_mfma_f32_16x16x32_bf16 v[228:231], a[32:35], v[36:39], v[228:231]
v_exp_f32 v48, v48
v_mfma_f32_16x16x32_bf16 v[240:243], a[36:39], v[36:39], v[240:243]
ds_read_b128 a[24:27], v8 offset:17536
v_exp_f32 v49, v49
v_mfma_f32_16x16x32_bf16 v[236:239], a[36:39], v[32:35], v[236:239]
v_exp_f32 v50, v50
v_mfma_f32_16x16x32_bf16 v[232:235], a[36:39], v[28:31], v[232:235]
s_waitcnt lgkmcnt(3)
v_add_f32 v11, v11, v44
v_mfma_f32_16x16x32_bf16 v[244:247], a[40:43], v[28:31], v[244:247]
ds_read_b128 a[28:31], v8 offset:17600
v_exp_f32 v51, v51
v_mfma_f32_16x16x32_bf16 v[248:251], a[40:43], v[32:35], v[248:251]
buffer_load_dwordx4 v7, s[32:35], s50 offen offset:3168 lds
v_mfma_f32_16x16x32_bf16 a[0:3], a[40:43], v[36:39], a[0:3]
v_add_f32 v11, v11, v45
v_add_f32 v11, v11, v46
v_mfma_f32_16x16x32_bf16 a[12:15], a[44:47], v[36:39], a[12:15]
ds_read_b128 a[32:35], v8 offset:17664
v_add_f32 v11, v11, v47
v_add_f32 v12, v12, v48
v_mfma_f32_16x16x32_bf16 a[8:11], a[44:47], v[32:35], a[8:11]
v_add_f32 v12, v12, v49
v_add_f32 v12, v12, v50
v_mfma_f32_16x16x32_bf16 a[4:7], a[44:47], v[28:31], a[4:7]
s_waitcnt lgkmcnt(3)
v_add_f32 v12, v12, v51
LS_87:
v_mfma_f32_16x16x32_bf16 v[52:55], a[16:19], a[48:51], v[16:19]
ds_read_b128 a[36:39], v8 offset:17728
v_cvt_pk_bf16_f32 v30, v40, v41
v_mfma_f32_16x16x32_bf16 v[52:55], a[20:23], a[60:63], v[52:55]
s_add_u32 m0, s17, 50688
s_mov_b32 s50, 475136
v_mfma_f32_16x16x32_bf16 v[56:59], a[20:23], a[64:67], v[20:23]
buffer_load_dwordx4 v0, s[24:27], s50 offen offset:0 nt lds
v_mfma_f32_16x16x32_bf16 v[56:59], a[16:19], a[52:55], v[56:59]
ds_read_b128 a[40:43], v8 offset:17792
v_cvt_pk_bf16_f32 v31, v42, v43
v_mfma_f32_16x16x32_bf16 v[60:63], a[16:19], a[56:59], v[24:27]
v_exp_f32 v64, v64
v_mfma_f32_16x16x32_bf16 v[60:63], a[20:23], a[68:71], v[60:63]
s_waitcnt lgkmcnt(3)
v_cvt_pk_bf16_f32 v34, v44, v45
v_mfma_f32_16x16x32_bf16 v[60:63], a[24:27], a[80:83], v[60:63]
ds_read_b128 a[44:47], v8 offset:17856
v_cvt_pk_bf16_f32 v35, v46, v47
v_mfma_f32_16x16x32_bf16 v[60:63], a[28:31], a[92:95], v[60:63]
buffer_load_dwordx4 v1, s[24:27], s50 offen offset:1056 nt lds
v_mfma_f32_16x16x32_bf16 v[56:59], a[28:31], a[88:91], v[56:59]
v_exp_f32 v65, v65
v_mfma_f32_16x16x32_bf16 v[56:59], a[24:27], a[76:79], v[56:59]
ds_read_b128 a[16:19], v8 offset:16896
v_cvt_pk_bf16_f32 v38, v48, v49
v_mfma_f32_16x16x32_bf16 v[52:55], a[24:27], a[72:75], v[52:55]
v_exp_f32 v66, v66
v_mfma_f32_16x16x32_bf16 v[52:55], a[28:31], a[84:87], v[52:55]
s_waitcnt lgkmcnt(3)
v_cvt_pk_bf16_f32 v39, v50, v51
v_mfma_f32_16x16x32_bf16 v[52:55], a[32:35], a[96:99], v[52:55]
ds_read_b128 a[20:23], v8 offset:16960
v_cvt_pk_bf16_f32 v28, v64, v65
v_mfma_f32_16x16x32_bf16 v[52:55], a[36:39], a[108:111], v[52:55]
v_exp_f32 v67, v67
v_mfma_f32_16x16x32_bf16 v[56:59], a[36:39], a[112:115], v[56:59]
v_exp_f32 v68, v68
v_mfma_f32_16x16x32_bf16 v[56:59], a[32:35], a[100:103], v[56:59]
ds_read_b128 a[24:27], v8 offset:17024
v_cvt_pk_bf16_f32 v29, v66, v67
v_mfma_f32_16x16x32_bf16 v[60:63], a[32:35], a[104:107], v[60:63]
v_exp_f32 v69, v69
v_mfma_f32_16x16x32_bf16 v[60:63], a[36:39], a[116:119], v[60:63]
s_waitcnt lgkmcnt(3)
v_cvt_pk_bf16_f32 v32, v68, v69
v_mfma_f32_16x16x32_bf16 v[60:63], a[40:43], a[128:131], v[60:63]
ds_read_b128 a[28:31], v8 offset:17088
v_add_f32 v10, v10, v64
v_mfma_f32_16x16x32_bf16 v[60:63], a[44:47], a[140:143], v[60:63]
v_exp_f32 v70, v70
v_mfma_f32_16x16x32_bf16 v[56:59], a[44:47], a[136:139], v[56:59]
s_waitcnt vmcnt(14)
s_barrier
v_mfma_f32_16x16x32_bf16 v[56:59], a[40:43], a[124:127], v[56:59]
ds_read_b128 a[32:35], v8 offset:17152
v_add_f32 v10, v10, v65
v_mfma_f32_16x16x32_bf16 v[52:55], a[40:43], a[120:123], v[52:55]
v_exp_f32 v71, v71
v_mfma_f32_16x16x32_bf16 v[52:55], a[44:47], a[132:135], v[52:55]
s_waitcnt lgkmcnt(3)
v_cvt_pk_bf16_f32 v33, v70, v71
v_mfma_f32_16x16x32_bf16 v[40:43], a[16:19], a[48:51], v[16:19]
ds_read_b128 a[36:39], v8 offset:17216
v_add_f32 v10, v10, v66
v_mfma_f32_16x16x32_bf16 v[40:43], a[20:23], a[60:63], v[40:43]
v_exp_f32 v72, v72
v_mfma_f32_16x16x32_bf16 v[44:47], a[20:23], a[64:67], v[20:23]
v_exp_f32 v73, v73
v_mfma_f32_16x16x32_bf16 v[44:47], a[16:19], a[52:55], v[44:47]
ds_read_b128 a[40:43], v8 offset:17280
v_max3_f32 v13, v52, v53, v54
v_mfma_f32_16x16x32_bf16 v[48:51], a[16:19], a[56:59], v[24:27]
v_exp_f32 v74, v74
v_mfma_f32_16x16x32_bf16 v[48:51], a[20:23], a[68:71], v[48:51]
s_waitcnt lgkmcnt(3)
v_max3_f32 v13, v13, v55, v56
v_mfma_f32_16x16x32_bf16 v[48:51], a[24:27], a[80:83], v[48:51]
ds_read_b128 a[44:47], v8 offset:17344
v_max3_f32 v13, v13, v57, v58
v_mfma_f32_16x16x32_bf16 v[48:51], a[28:31], a[92:95], v[48:51]
v_exp_f32 v75, v75
v_mfma_f32_16x16x32_bf16 v[44:47], a[28:31], a[88:91], v[44:47]
buffer_load_dwordx4 v2, s[24:27], s50 offen offset:2112 nt lds
v_mfma_f32_16x16x32_bf16 v[44:47], a[24:27], a[76:79], v[44:47]
v_subrev_u32 v9, 84480, v9
ds_read_b64_tr_b16 a[16:17], v9 offset:0
v_mfma_f32_16x16x32_bf16 v[40:43], a[24:27], a[72:75], v[40:43]
ds_read_b64_tr_b16 a[18:19], v9 offset:512
v_cvt_pk_bf16_f32 v36, v72, v73
v_mfma_f32_16x16x32_bf16 v[40:43], a[28:31], a[84:87], v[40:43]
s_waitcnt lgkmcnt(4)
v_cvt_pk_bf16_f32 v37, v74, v75
v_mfma_f32_16x16x32_bf16 v[40:43], a[32:35], a[96:99], v[40:43]
ds_read_b64_tr_b16 a[20:21], v9 offset:32
v_max3_f32 v13, v13, v59, v60
v_mfma_f32_16x16x32_bf16 v[40:43], a[36:39], a[108:111], v[40:43]
ds_read_b64_tr_b16 a[22:23], v9 offset:544
v_max3_f32 v13, v13, v61, v62
v_mfma_f32_16x16x32_bf16 v[44:47], a[36:39], a[112:115], v[44:47]
buffer_load_dwordx4 v3, s[24:27], s50 offen offset:3168 nt lds
v_mfma_f32_16x16x32_bf16 v[44:47], a[32:35], a[100:103], v[44:47]
ds_read_b64_tr_b16 a[24:25], v9 offset:64
v_add_f32 v10, v10, v67
v_mfma_f32_16x16x32_bf16 v[48:51], a[32:35], a[104:107], v[48:51]
ds_read_b64_tr_b16 a[26:27], v9 offset:576
v_add_f32 v11, v11, v68
v_mfma_f32_16x16x32_bf16 v[48:51], a[36:39], a[116:119], v[48:51]
s_waitcnt lgkmcnt(6)
v_add_f32 v11, v11, v69
v_mfma_f32_16x16x32_bf16 v[48:51], a[40:43], a[128:131], v[48:51]
ds_read_b64_tr_b16 a[28:29], v9 offset:96
v_add_f32 v11, v11, v70
v_mfma_f32_16x16x32_bf16 v[48:51], a[44:47], a[140:143], v[48:51]
ds_read_b64_tr_b16 a[30:31], v9 offset:608
v_add_f32 v11, v11, v71
v_mfma_f32_16x16x32_bf16 v[44:47], a[44:47], a[136:139], v[44:47]
v_add_f32 v12, v12, v72
v_add_f32 v12, v12, v73
v_mfma_f32_16x16x32_bf16 v[44:47], a[40:43], a[124:127], v[44:47]
ds_read_b64_tr_b16 a[32:33], v9 offset:128
v_add_f32 v12, v12, v74
v_mfma_f32_16x16x32_bf16 v[40:43], a[40:43], a[120:123], v[40:43]
ds_read_b64_tr_b16 a[34:35], v9 offset:640
v_add_f32 v12, v12, v75
v_mfma_f32_16x16x32_bf16 v[40:43], a[44:47], a[132:135], v[40:43]
s_waitcnt lgkmcnt(6)
v_max_f32 v13, v13, v63
LS_88:
v_mfma_f32_16x16x32_bf16 v[76:79], a[16:19], v[28:31], v[76:79]
ds_read_b64_tr_b16 a[36:37], v9 offset:160
v_mfma_f32_16x16x32_bf16 v[80:83], a[16:19], v[32:35], v[80:83]
ds_read_b64_tr_b16 a[38:39], v9 offset:672
v_mfma_f32_16x16x32_bf16 v[84:87], a[16:19], v[36:39], v[84:87]
s_add_u32 m0, s17, 67584
s_mov_b32 s50, 483328
v_mfma_f32_16x16x32_bf16 v[96:99], a[20:23], v[36:39], v[96:99]
ds_read_b64_tr_b16 a[40:41], v9 offset:192
v_max3_f32 v13, v13, v40, v41
v_mfma_f32_16x16x32_bf16 v[92:95], a[20:23], v[32:35], v[92:95]
ds_read_b64_tr_b16 a[42:43], v9 offset:704
v_max3_f32 v13, v13, v42, v43
v_mfma_f32_16x16x32_bf16 v[88:91], a[20:23], v[28:31], v[88:91]
s_waitcnt lgkmcnt(6)
v_max3_f32 v13, v13, v44, v45
v_mfma_f32_16x16x32_bf16 v[100:103], a[24:27], v[28:31], v[100:103]
ds_read_b64_tr_b16 a[44:45], v9 offset:224
v_max3_f32 v13, v13, v46, v47
v_mfma_f32_16x16x32_bf16 v[104:107], a[24:27], v[32:35], v[104:107]
ds_read_b64_tr_b16 a[46:47], v9 offset:736
v_max3_f32 v13, v13, v48, v49
v_mfma_f32_16x16x32_bf16 v[108:111], a[24:27], v[36:39], v[108:111]
buffer_load_dwordx4 v0, s[24:27], s50 offen offset:0 nt lds
v_mfma_f32_16x16x32_bf16 v[120:123], a[28:31], v[36:39], v[120:123]
ds_read_b64_tr_b16 a[16:17], v9 offset:256
v_max3_f32 v13, v13, v50, v51
v_mfma_f32_16x16x32_bf16 v[116:119], a[28:31], v[32:35], v[116:119]
ds_read_b64_tr_b16 a[18:19], v9 offset:768
v_cmp_lt_f32 vcc, s47, v13
v_mfma_f32_16x16x32_bf16 v[112:115], a[28:31], v[28:31], v[112:115]
s_waitcnt lgkmcnt(6)
v_mfma_f32_16x16x32_bf16 v[124:127], a[32:35], v[28:31], v[124:127]
ds_read_b64_tr_b16 a[20:21], v9 offset:288
ds_read_b64_tr_b16 a[22:23], v9 offset:800
v_mfma_f32_16x16x32_bf16 v[128:131], a[32:35], v[32:35], v[128:131]
s_cbranch_vccnz RARE_h1j13
RET_h1j13:
v_mfma_f32_16x16x32_bf16 v[132:135], a[32:35], v[36:39], v[132:135]
buffer_load_dwordx4 v1, s[24:27], s50 offen offset:1056 nt lds
v_mfma_f32_16x16x32_bf16 v[144:147], a[36:39], v[36:39], v[144:147]
ds_read_b64_tr_b16 a[24:25], v9 offset:320
ds_read_b64_tr_b16 a[26:27], v9 offset:832
v_mfma_f32_16x16x32_bf16 v[140:143], a[36:39], v[32:35], v[140:143]
v_exp_f32 v40, v40
v_mfma_f32_16x16x32_bf16 v[136:139], a[36:39], v[28:31], v[136:139]
s_waitcnt lgkmcnt(6)
v_add_f32 v10, v10, v40
v_mfma_f32_16x16x32_bf16 v[148:151], a[40:43], v[28:31], v[148:151]
ds_read_b64_tr_b16 a[28:29], v9 offset:352
ds_read_b64_tr_b16 a[30:31], v9 offset:864
v_mfma_f32_16x16x32_bf16 v[152:155], a[40:43], v[32:35], v[152:155]
buffer_load_dwordx4 v2, s[24:27], s50 offen offset:2112 nt lds
v_mfma_f32_16x16x32_bf16 v[156:159], a[40:43], v[36:39], v[156:159]
s_waitcnt vmcnt(11)
s_barrier
v_mfma_f32_16x16x32_bf16 v[168:171], a[44:47], v[36:39], v[168:171]
ds_read_b64_tr_b16 a[32:33], v9 offset:384
ds_read_b64_tr_b16 a[34:35], v9 offset:896
v_mfma_f32_16x16x32_bf16 v[164:167], a[44:47], v[32:35], v[164:167]
buffer_load_dwordx4 v3, s[24:27], s50 offen offset:3168 nt lds
v_mfma_f32_16x16x32_bf16 v[160:163], a[44:47], v[28:31], v[160:163]
s_waitcnt lgkmcnt(6)
s_add_u32 m0, s17, 84480
s_add_u32 s50, s99, 229376
v_mfma_f32_16x16x32_bf16 v[172:175], a[16:19], v[28:31], v[172:175]
ds_read_b64_tr_b16 a[36:37], v9 offset:416
ds_read_b64_tr_b16 a[38:39], v9 offset:928
v_mfma_f32_16x16x32_bf16 v[176:179], a[16:19], v[32:35], v[176:179]
buffer_load_dwordx4 v4, s[32:35], s50 offen offset:0 lds
v_mfma_f32_16x16x32_bf16 v[180:183], a[16:19], v[36:39], v[180:183]
v_exp_f32 v41, v41
v_mfma_f32_16x16x32_bf16 v[192:195], a[20:23], v[36:39], v[192:195]
ds_read_b64_tr_b16 a[40:41], v9 offset:448
ds_read_b64_tr_b16 a[42:43], v9 offset:960
v_add_f32 v10, v10, v41
v_mfma_f32_16x16x32_bf16 v[188:191], a[20:23], v[32:35], v[188:191]
buffer_load_dwordx4 v5, s[32:35], s50 offen offset:1056 lds
v_mfma_f32_16x16x32_bf16 v[184:187], a[20:23], v[28:31], v[184:187]
s_waitcnt lgkmcnt(6)
v_exp_f32 v42, v42
v_mfma_f32_16x16x32_bf16 v[196:199], a[24:27], v[28:31], v[196:199]
ds_read_b64_tr_b16 a[44:45], v9 offset:480
ds_read_b64_tr_b16 a[46:47], v9 offset:992
v_add_f32 v10, v10, v42
v_mfma_f32_16x16x32_bf16 v[200:203], a[24:27], v[32:35], v[200:203]
buffer_load_dwordx4 v6, s[32:35], s50 offen offset:2112 lds
v_mfma_f32_16x16x32_bf16 v[204:207], a[24:27], v[36:39], v[204:207]
v_exp_f32 v43, v43
v_mfma_f32_16x16x32_bf16 v[216:219], a[28:31], v[36:39], v[216:219]
ds_read_b128 a[16:19], v8 offset:33792
v_exp_f32 v44, v44
v_mfma_f32_16x16x32_bf16 v[212:215], a[28:31], v[32:35], v[212:215]
v_exp_f32 v45, v45
v_mfma_f32_16x16x32_bf16 v[208:211], a[28:31], v[28:31], v[208:211]
s_waitcnt lgkmcnt(5)
v_add_f32 v10, v10, v43
v_mfma_f32_16x16x32_bf16 v[220:223], a[32:35], v[28:31], v[220:223]
ds_read_b128 a[20:23], v8 offset:33856
v_exp_f32 v46, v46
v_mfma_f32_16x16x32_bf16 v[224:227], a[32:35], v[32:35], v[224:227]
v_exp_f32 v47, v47
v_mfma_f32_16x16x32_bf16 v[228:231], a[32:35], v[36:39], v[228:231]
v_exp_f32 v48, v48
v_mfma_f32_16x16x32_bf16 v[240:243], a[36:39], v[36:39], v[240:243]
ds_read_b128 a[24:27], v8 offset:33920
v_exp_f32 v49, v49
v_mfma_f32_16x16x32_bf16 v[236:239], a[36:39], v[32:35], v[236:239]
v_exp_f32 v50, v50
v_mfma_f32_16x16x32_bf16 v[232:235], a[36:39], v[28:31], v[232:235]
s_waitcnt lgkmcnt(3)
v_add_f32 v11, v11, v44
v_mfma_f32_16x16x32_bf16 v[244:247], a[40:43], v[28:31], v[244:247]
ds_read_b128 a[28:31], v8 offset:33984
v_exp_f32 v51, v51
v_mfma_f32_16x16x32_bf16 v[248:251], a[40:43], v[32:35], v[248:251]
buffer_load_dwordx4 v7, s[32:35], s50 offen offset:3168 lds
v_mfma_f32_16x16x32_bf16 a[0:3], a[40:43], v[36:39], a[0:3]
v_add_f32 v11, v11, v45
v_add_f32 v11, v11, v46
v_mfma_f32_16x16x32_bf16 a[12:15], a[44:47], v[36:39], a[12:15]
ds_read_b128 a[32:35], v8 offset:34048
v_add_f32 v11, v11, v47
v_add_f32 v12, v12, v48
v_mfma_f32_16x16x32_bf16 a[8:11], a[44:47], v[32:35], a[8:11]
v_add_f32 v12, v12, v49
v_add_f32 v12, v12, v50
v_mfma_f32_16x16x32_bf16 a[4:7], a[44:47], v[28:31], a[4:7]
s_waitcnt lgkmcnt(3)
v_add_f32 v12, v12, v51
LS_89:
v_mfma_f32_16x16x32_bf16 v[64:67], a[16:19], a[48:51], v[16:19]
ds_read_b128 a[36:39], v8 offset:34112
v_cvt_pk_bf16_f32 v28, v40, v41
v_mfma_f32_16x16x32_bf16 v[64:67], a[20:23], a[60:63], v[64:67]
s_add_u32 m0, s17, 101376
s_add_u32 s50, s99, 344064
v_mfma_f32_16x16x32_bf16 v[68:71], a[20:23], a[64:67], v[20:23]
buffer_load_dwordx4 v4, s[32:35], s50 offen offset:0 lds
v_mfma_f32_16x16x32_bf16 v[68:71], a[16:19], a[52:55], v[68:71]
ds_read_b128 a[40:43], v8 offset:34176
v_cvt_pk_bf16_f32 v29, v42, v43
v_mfma_f32_16x16x32_bf16 v[72:75], a[16:19], a[56:59], v[24:27]
v_exp_f32 v52, v52
v_mfma_f32_16x16x32_bf16 v[72:75], a[20:23], a[68:71], v[72:75]
s_waitcnt lgkmcnt(3)
v_cvt_pk_bf16_f32 v32, v44, v45
v_mfma_f32_16x16x32_bf16 v[72:75], a[24:27], a[80:83], v[72:75]
ds_read_b128 a[44:47], v8 offset:34240
v_cvt_pk_bf16_f32 v33, v46, v47
v_mfma_f32_16x16x32_bf16 v[72:75], a[28:31], a[92:95], v[72:75]
buffer_load_dwordx4 v5, s[32:35], s50 offen offset:1056 lds
v_mfma_f32_16x16x32_bf16 v[68:71], a[28:31], a[88:91], v[68:71]
v_exp_f32 v53, v53
v_mfma_f32_16x16x32_bf16 v[68:71], a[24:27], a[76:79], v[68:71]
ds_read_b128 a[16:19], v8 offset:34304
v_cvt_pk_bf16_f32 v36, v48, v49
v_mfma_f32_16x16x32_bf16 v[64:67], a[24:27], a[72:75], v[64:67]
v_exp_f32 v54, v54
v_mfma_f32_16x16x32_bf16 v[64:67], a[28:31], a[84:87], v[64:67]
s_waitcnt lgkmcnt(3)
v_cvt_pk_bf16_f32 v37, v50, v51
v_mfma_f32_16x16x32_bf16 v[64:67], a[32:35], a[96:99], v[64:67]
ds_read_b128 a[20:23], v8 offset:34368
v_cvt_pk_bf16_f32 v30, v52, v53
v_mfma_f32_16x16x32_bf16 v[64:67], a[36:39], a[108:111], v[64:67]
v_exp_f32 v55, v55
v_mfma_f32_16x16x32_bf16 v[68:71], a[36:39], a[112:115], v[68:71]
v_exp_f32 v56, v56
v_mfma_f32_16x16x32_bf16 v[68:71], a[32:35], a[100:103], v[68:71]
ds_read_b128 a[24:27], v8 offset:34432
v_cvt_pk_bf16_f32 v31, v54, v55
v_mfma_f32_16x16x32_bf16 v[72:75], a[32:35], a[104:107], v[72:75]
v_exp_f32 v57, v57
v_mfma_f32_16x16x32_bf16 v[72:75], a[36:39], a[116:119], v[72:75]
s_waitcnt lgkmcnt(3)
v_cvt_pk_bf16_f32 v34, v56, v57
v_mfma_f32_16x16x32_bf16 v[72:75], a[40:43], a[128:131], v[72:75]
ds_read_b128 a[28:31], v8 offset:34496
v_add_f32 v10, v10, v52
v_mfma_f32_16x16x32_bf16 v[72:75], a[44:47], a[140:143], v[72:75]
v_exp_f32 v58, v58
v_mfma_f32_16x16x32_bf16 v[68:71], a[44:47], a[136:139], v[68:71]
s_waitcnt vmcnt(10)
s_barrier
v_mfma_f32_16x16x32_bf16 v[68:71], a[40:43], a[124:127], v[68:71]
ds_read_b128 a[32:35], v8 offset:34560
v_add_f32 v10, v10, v53
v_mfma_f32_16x16x32_bf16 v[64:67], a[40:43], a[120:123], v[64:67]
v_exp_f32 v59, v59
v_mfma_f32_16x16x32_bf16 v[64:67], a[44:47], a[132:135], v[64:67]
s_waitcnt lgkmcnt(3)
v_cvt_pk_bf16_f32 v35, v58, v59
v_mfma_f32_16x16x32_bf16 v[40:43], a[16:19], a[48:51], v[16:19]
ds_read_b128 a[36:39], v8 offset:34624
v_add_f32 v10, v10, v54
v_mfma_f32_16x16x32_bf16 v[40:43], a[20:23], a[60:63], v[40:43]
v_exp_f32 v60, v60
v_mfma_f32_16x16x32_bf16 v[44:47], a[20:23], a[64:67], v[20:23]
v_exp_f32 v61, v61
v_mfma_f32_16x16x32_bf16 v[44:47], a[16:19], a[52:55], v[44:47]
ds_read_b128 a[40:43], v8 offset:34688
v_max3_f32 v13, v64, v65, v66
v_mfma_f32_16x16x32_bf16 v[48:51], a[16:19], a[56:59], v[24:27]
v_exp_f32 v62, v62
v_mfma_f32_16x16x32_bf16 v[48:51], a[20:23], a[68:71], v[48:51]
s_waitcnt lgkmcnt(3)
v_max3_f32 v13, v13, v67, v68
v_mfma_f32_16x16x32_bf16 v[48:51], a[24:27], a[80:83], v[48:51]
ds_read_b128 a[44:47], v8 offset:34752
v_max3_f32 v13, v13, v69, v70
v_mfma_f32_16x16x32_bf16 v[48:51], a[28:31], a[92:95], v[48:51]
v_exp_f32 v63, v63
v_mfma_f32_16x16x32_bf16 v[44:47], a[28:31], a[88:91], v[44:47]
buffer_load_dwordx4 v6, s[32:35], s50 offen offset:2112 lds
v_mfma_f32_16x16x32_bf16 v[44:47], a[24:27], a[76:79], v[44:47]
ds_read_b64_tr_b16 a[16:17], v9 offset:50688
v_cvt_pk_bf16_f32 v38, v60, v61
v_mfma_f32_16x16x32_bf16 v[40:43], a[24:27], a[72:75], v[40:43]
ds_read_b64_tr_b16 a[18:19], v9 offset:51200
v_cvt_pk_bf16_f32 v39, v62, v63
v_mfma_f32_16x16x32_bf16 v[40:43], a[28:31], a[84:87], v[40:43]
s_waitcnt lgkmcnt(4)
v_max3_f32 v13, v13, v71, v72
v_mfma_f32_16x16x32_bf16 v[40:43], a[32:35], a[96:99], v[40:43]
ds_read_b64_tr_b16 a[20:21], v9 offset:50720
v_max3_f32 v13, v13, v73, v74
v_mfma_f32_16x16x32_bf16 v[40:43], a[36:39], a[108:111], v[40:43]
ds_read_b64_tr_b16 a[22:23], v9 offset:51232
v_add_f32 v10, v10, v55
v_mfma_f32_16x16x32_bf16 v[44:47], a[36:39], a[112:115], v[44:47]
buffer_load_dwordx4 v7, s[32:35], s50 offen offset:3168 lds
v_mfma_f32_16x16x32_bf16 v[44:47], a[32:35], a[100:103], v[44:47]
ds_read_b64_tr_b16 a[24:25], v9 offset:50752
v_add_f32 v11, v11, v56
v_mfma_f32_16x16x32_bf16 v[48:51], a[32:35], a[104:107], v[48:51]
ds_read_b64_tr_b16 a[26:27], v9 offset:51264
v_add_f32 v11, v11, v57
v_mfma_f32_16x16x32_bf16 v[48:51], a[36:39], a[116:119], v[48:51]
s_waitcnt lgkmcnt(6)
v_add_f32 v11, v11, v58
v_mfma_f32_16x16x32_bf16 v[48:51], a[40:43], a[128:131], v[48:51]
ds_read_b64_tr_b16 a[28:29], v9 offset:50784
v_add_f32 v11, v11, v59
v_mfma_f32_16x16x32_bf16 v[48:51], a[44:47], a[140:143], v[48:51]
ds_read_b64_tr_b16 a[30:31], v9 offset:51296
v_add_f32 v12, v12, v60
v_mfma_f32_16x16x32_bf16 v[44:47], a[44:47], a[136:139], v[44:47]
v_add_f32 v12, v12, v61
v_add_f32 v12, v12, v62
v_mfma_f32_16x16x32_bf16 v[44:47], a[40:43], a[124:127], v[44:47]
ds_read_b64_tr_b16 a[32:33], v9 offset:50816
v_add_f32 v12, v12, v63
v_mfma_f32_16x16x32_bf16 v[40:43], a[40:43], a[120:123], v[40:43]
ds_read_b64_tr_b16 a[34:35], v9 offset:51328
v_max_f32 v13, v13, v75
v_mfma_f32_16x16x32_bf16 v[40:43], a[44:47], a[132:135], v[40:43]
s_waitcnt lgkmcnt(6)
LS_90:
v_mfma_f32_16x16x32_bf16 v[76:79], a[16:19], v[28:31], v[76:79]
ds_read_b64_tr_b16 a[36:37], v9 offset:50848
v_mfma_f32_16x16x32_bf16 v[80:83], a[16:19], v[32:35], v[80:83]
ds_read_b64_tr_b16 a[38:39], v9 offset:51360
v_mfma_f32_16x16x32_bf16 v[84:87], a[16:19], v[36:39], v[84:87]
s_add_u32 m0, s17, 16896
s_add_u32 s50, s100, 0
v_mfma_f32_16x16x32_bf16 v[96:99], a[20:23], v[36:39], v[96:99]
ds_read_b64_tr_b16 a[40:41], v9 offset:50880
v_max3_f32 v13, v13, v40, v41
v_mfma_f32_16x16x32_bf16 v[92:95], a[20:23], v[32:35], v[92:95]
ds_read_b64_tr_b16 a[42:43], v9 offset:51392
v_max3_f32 v13, v13, v42, v43
v_mfma_f32_16x16x32_bf16 v[88:91], a[20:23], v[28:31], v[88:91]
s_waitcnt lgkmcnt(6)
v_max3_f32 v13, v13, v44, v45
v_mfma_f32_16x16x32_bf16 v[100:103], a[24:27], v[28:31], v[100:103]
ds_read_b64_tr_b16 a[44:45], v9 offset:50912
v_max3_f32 v13, v13, v46, v47
v_mfma_f32_16x16x32_bf16 v[104:107], a[24:27], v[32:35], v[104:107]
ds_read_b64_tr_b16 a[46:47], v9 offset:51424
v_max3_f32 v13, v13, v48, v49
v_mfma_f32_16x16x32_bf16 v[108:111], a[24:27], v[36:39], v[108:111]
buffer_load_dwordx4 v4, s[32:35], s50 offen offset:0 lds
v_mfma_f32_16x16x32_bf16 v[120:123], a[28:31], v[36:39], v[120:123]
ds_read_b64_tr_b16 a[16:17], v9 offset:50944
v_max3_f32 v13, v13, v50, v51
v_mfma_f32_16x16x32_bf16 v[116:119], a[28:31], v[32:35], v[116:119]
ds_read_b64_tr_b16 a[18:19], v9 offset:51456
v_cmp_lt_f32 vcc, s47, v13
v_mfma_f32_16x16x32_bf16 v[112:115], a[28:31], v[28:31], v[112:115]
s_waitcnt lgkmcnt(6)
v_mfma_f32_16x16x32_bf16 v[124:127], a[32:35], v[28:31], v[124:127]
ds_read_b64_tr_b16 a[20:21], v9 offset:50976
ds_read_b64_tr_b16 a[22:23], v9 offset:51488
v_mfma_f32_16x16x32_bf16 v[128:131], a[32:35], v[32:35], v[128:131]
s_cbranch_vccnz RARE_h1j14
RET_h1j14:
v_mfma_f32_16x16x32_bf16 v[132:135], a[32:35], v[36:39], v[132:135]
buffer_load_dwordx4 v5, s[32:35], s50 offen offset:1056 lds
v_mfma_f32_16x16x32_bf16 v[144:147], a[36:39], v[36:39], v[144:147]
ds_read_b64_tr_b16 a[24:25], v9 offset:51008
ds_read_b64_tr_b16 a[26:27], v9 offset:51520
v_mfma_f32_16x16x32_bf16 v[140:143], a[36:39], v[32:35], v[140:143]
v_exp_f32 v40, v40
v_mfma_f32_16x16x32_bf16 v[136:139], a[36:39], v[28:31], v[136:139]
s_waitcnt lgkmcnt(6)
buffer_load_dwordx4 v6, s[32:35], s50 offen offset:2112 lds
v_mfma_f32_16x16x32_bf16 v[148:151], a[40:43], v[28:31], v[148:151]
ds_read_b64_tr_b16 a[28:29], v9 offset:51040
ds_read_b64_tr_b16 a[30:31], v9 offset:51552
v_mfma_f32_16x16x32_bf16 v[152:155], a[40:43], v[32:35], v[152:155]
v_exp_f32 v41, v41
v_add_f32 v10, v10, v40
v_mfma_f32_16x16x32_bf16 v[156:159], a[40:43], v[36:39], v[156:159]
s_waitcnt vmcnt(11)
s_barrier
v_mfma_f32_16x16x32_bf16 v[168:171], a[44:47], v[36:39], v[168:171]
ds_read_b64_tr_b16 a[32:33], v9 offset:51072
ds_read_b64_tr_b16 a[34:35], v9 offset:51584
v_mfma_f32_16x16x32_bf16 v[164:167], a[44:47], v[32:35], v[164:167]
v_exp_f32 v42, v42
v_add_f32 v10, v10, v41
v_mfma_f32_16x16x32_bf16 v[160:163], a[44:47], v[28:31], v[160:163]
s_waitcnt lgkmcnt(6)
v_add_f32 v10, v10, v42
v_mfma_f32_16x16x32_bf16 v[172:175], a[16:19], v[28:31], v[172:175]
ds_read_b64_tr_b16 a[36:37], v9 offset:51104
ds_read_b64_tr_b16 a[38:39], v9 offset:51616
v_mfma_f32_16x16x32_bf16 v[176:179], a[16:19], v[32:35], v[176:179]
v_exp_f32 v43, v43
v_mfma_f32_16x16x32_bf16 v[180:183], a[16:19], v[36:39], v[180:183]
v_exp_f32 v44, v44
v_add_f32 v10, v10, v43
v_mfma_f32_16x16x32_bf16 v[192:195], a[20:23], v[36:39], v[192:195]
ds_read_b64_tr_b16 a[40:41], v9 offset:51136
ds_read_b64_tr_b16 a[42:43], v9 offset:51648
v_mfma_f32_16x16x32_bf16 v[188:191], a[20:23], v[32:35], v[188:191]
v_exp_f32 v45, v45
v_add_f32 v11, v11, v44
v_mfma_f32_16x16x32_bf16 v[184:187], a[20:23], v[28:31], v[184:187]
s_waitcnt lgkmcnt(6)
v_add_f32 v11, v11, v45
v_mfma_f32_16x16x32_bf16 v[196:199], a[24:27], v[28:31], v[196:199]
ds_read_b64_tr_b16 a[44:45], v9 offset:51168
ds_read_b64_tr_b16 a[46:47], v9 offset:51680
v_mfma_f32_16x16x32_bf16 v[200:203], a[24:27], v[32:35], v[200:203]
v_exp_f32 v46, v46
v_mfma_f32_16x16x32_bf16 v[204:207], a[24:27], v[36:39], v[204:207]
v_exp_f32 v47, v47
v_add_f32 v11, v11, v46
v_mfma_f32_16x16x32_bf16 v[216:219], a[28:31], v[36:39], v[216:219]
v_add_u32 v9, 67584, v9
ds_read_b64_tr_b16 a[16:17], v9 offset:0
ds_read_b64_tr_b16 a[18:19], v9 offset:512
v_mfma_f32_16x16x32_bf16 v[212:215], a[28:31], v[32:35], v[212:215]
v_exp_f32 v48, v48
v_mfma_f32_16x16x32_bf16 v[208:211], a[28:31], v[28:31], v[208:211]
s_waitcnt lgkmcnt(6)
v_add_f32 v11, v11, v47
v_mfma_f32_16x16x32_bf16 v[220:223], a[32:35], v[28:31], v[220:223]
ds_read_b64_tr_b16 a[20:21], v9 offset:32
ds_read_b64_tr_b16 a[22:23], v9 offset:544
v_mfma_f32_16x16x32_bf16 v[224:227], a[32:35], v[32:35], v[224:227]
v_exp_f32 v49, v49
v_add_f32 v12, v12, v48
v_mfma_f32_16x16x32_bf16 v[228:231], a[32:35], v[36:39], v[228:231]
v_exp_f32 v50, v50
v_mfma_f32_16x16x32_bf16 v[240:243], a[36:39], v[36:39], v[240:243]
ds_read_b64_tr_b16 a[24:25], v9 offset:64
ds_read_b64_tr_b16 a[26:27], v9 offset:576
v_mfma_f32_16x16x32_bf16 v[236:239], a[36:39], v[32:35], v[236:239]
v_exp_f32 v51, v51
v_add_f32 v12, v12, v49
v_mfma_f32_16x16x32_bf16 v[232:235], a[36:39], v[28:31], v[232:235]
s_waitcnt lgkmcnt(6)
v_add_f32 v12, v12, v50
v_mfma_f32_16x16x32_bf16 v[244:247], a[40:43], v[28:31], v[244:247]
ds_read_b64_tr_b16 a[28:29], v9 offset:96
ds_read_b64_tr_b16 a[30:31], v9 offset:608
v_mfma_f32_16x16x32_bf16 v[248:251], a[40:43], v[32:35], v[248:251]
buffer_load_dwordx4 v7, s[32:35], s50 offen offset:3168 lds
v_add_f32 v12, v12, v51
v_mfma_f32_16x16x32_bf16 a[0:3], a[40:43], v[36:39], a[0:3]
v_mfma_f32_16x16x32_bf16 a[12:15], a[44:47], v[36:39], a[12:15]
ds_read_b64_tr_b16 a[32:33], v9 offset:128
ds_read_b64_tr_b16 a[34:35], v9 offset:640
v_mfma_f32_16x16x32_bf16 a[8:11], a[44:47], v[32:35], a[8:11]
v_mfma_f32_16x16x32_bf16 a[4:7], a[44:47], v[28:31], a[4:7]
s_waitcnt lgkmcnt(6)
LS_91:
v_exp_f32 v64, v64
v_exp_f32 v65, v65
v_exp_f32 v66, v66
v_exp_f32 v67, v67
v_exp_f32 v68, v68
v_exp_f32 v69, v69
v_exp_f32 v70, v70
v_exp_f32 v71, v71
v_exp_f32 v72, v72
v_exp_f32 v73, v73
v_exp_f32 v74, v74
v_exp_f32 v75, v75
v_cvt_pk_bf16_f32 v30, v40, v41
v_cvt_pk_bf16_f32 v31, v42, v43
v_cvt_pk_bf16_f32 v34, v44, v45
v_cvt_pk_bf16_f32 v35, v46, v47
v_cvt_pk_bf16_f32 v38, v48, v49
v_cvt_pk_bf16_f32 v39, v50, v51
v_add_f32 v10, v10, v64
v_add_f32 v10, v10, v65
v_cvt_pk_bf16_f32 v28, v64, v65
v_add_f32 v10, v10, v66
v_add_f32 v10, v10, v67
v_cvt_pk_bf16_f32 v29, v66, v67
v_add_f32 v11, v11, v68
v_add_f32 v11, v11, v69
v_cvt_pk_bf16_f32 v32, v68, v69
v_add_f32 v11, v11, v70
v_add_f32 v11, v11, v71
v_cvt_pk_bf16_f32 v33, v70, v71
v_add_f32 v12, v12, v72
v_add_f32 v12, v12, v73
v_cvt_pk_bf16_f32 v36, v72, v73
v_add_f32 v12, v12, v74
v_add_f32 v12, v12, v75
v_cvt_pk_bf16_f32 v37, v74, v75
v_mfma_f32_16x16x32_bf16 v[76:79], a[16:19], v[28:31], v[76:79]
ds_read_b64_tr_b16 a[36:37], v9 offset:160
s_add_u32 m0, s17, 0
s_add_u32 s50, s100, 114688
v_mfma_f32_16x16x32_bf16 v[80:83], a[16:19], v[32:35], v[80:83]
ds_read_b64_tr_b16 a[38:39], v9 offset:672
v_mov_b32 v40, v10
v_mov_b32 v41, v11
v_mfma_f32_16x16x32_bf16 v[84:87], a[16:19], v[36:39], v[84:87]
v_mov_b32 v42, v12
buffer_load_dwordx4 v4, s[32:35], s50 offen offset:0 lds
v_mfma_f32_16x16x32_bf16 v[96:99], a[20:23], v[36:39], v[96:99]
ds_read_b64_tr_b16 a[40:41], v9 offset:192
v_permlane32_swap_b32 v10, v40
v_permlane32_swap_b32 v11, v41
v_mfma_f32_16x16x32_bf16 v[92:95], a[20:23], v[32:35], v[92:95]
ds_read_b64_tr_b16 a[42:43], v9 offset:704
v_permlane32_swap_b32 v12, v42
v_add_f32 v10, v10, v40
v_mfma_f32_16x16x32_bf16 v[88:91], a[20:23], v[28:31], v[88:91]
s_waitcnt lgkmcnt(6)
v_add_f32 v11, v11, v41
v_add_f32 v12, v12, v42
v_mfma_f32_16x16x32_bf16 v[100:103], a[24:27], v[28:31], v[100:103]
ds_read_b64_tr_b16 a[44:45], v9 offset:224
v_mov_b32 v40, v10
v_mov_b32 v41, v11
v_mfma_f32_16x16x32_bf16 v[104:107], a[24:27], v[32:35], v[104:107]
ds_read_b64_tr_b16 a[46:47], v9 offset:736
v_mov_b32 v42, v12
v_mfma_f32_16x16x32_bf16 v[108:111], a[24:27], v[36:39], v[108:111]
v_permlane16_swap_b32 v10, v40
v_permlane16_swap_b32 v11, v41
buffer_load_dwordx4 v5, s[32:35], s50 offen offset:1056 lds
v_mfma_f32_16x16x32_bf16 v[120:123], a[28:31], v[36:39], v[120:123]
ds_read_b64_tr_b16 a[16:17], v9 offset:256
v_permlane16_swap_b32 v12, v42
v_add_f32 v10, v10, v40
v_add_f32 v11, v11, v41
v_mfma_f32_16x16x32_bf16 v[116:119], a[28:31], v[32:35], v[116:119]
ds_read_b64_tr_b16 a[18:19], v9 offset:768
v_add_f32 v12, v12, v42
v_rcp_f32 v10, v10
v_mfma_f32_16x16x32_bf16 v[112:115], a[28:31], v[28:31], v[112:115]
s_waitcnt lgkmcnt(6)
v_rcp_f32 v11, v11
v_mul_f32 v76, v10, v76
v_mfma_f32_16x16x32_bf16 v[124:127], a[32:35], v[28:31], v[124:127]
ds_read_b64_tr_b16 a[20:21], v9 offset:288
ds_read_b64_tr_b16 a[22:23], v9 offset:800
v_rcp_f32 v12, v12
v_mfma_f32_16x16x32_bf16 v[128:131], a[32:35], v[32:35], v[128:131]
buffer_load_dwordx4 v6, s[32:35], s50 offen offset:2112 lds
v_mfma_f32_16x16x32_bf16 v[132:135], a[32:35], v[36:39], v[132:135]
v_mul_f32 v77, v10, v77
v_mul_f32 v78, v10, v78
v_mfma_f32_16x16x32_bf16 v[144:147], a[36:39], v[36:39], v[144:147]
ds_read_b64_tr_b16 a[24:25], v9 offset:320
ds_read_b64_tr_b16 a[26:27], v9 offset:832
v_mfma_f32_16x16x32_bf16 v[140:143], a[36:39], v[32:35], v[140:143]
buffer_load_dwordx4 v7, s[32:35], s50 offen offset:3168 lds
v_mfma_f32_16x16x32_bf16 v[136:139], a[36:39], v[28:31], v[136:139]
s_waitcnt lgkmcnt(6)
v_mul_f32 v79, v10, v79
v_mfma_f32_16x16x32_bf16 v[148:151], a[40:43], v[28:31], v[148:151]
ds_read_b64_tr_b16 a[28:29], v9 offset:352
ds_read_b64_tr_b16 a[30:31], v9 offset:864
v_mfma_f32_16x16x32_bf16 v[152:155], a[40:43], v[32:35], v[152:155]
v_mul_f32 v88, v10, v88
v_mul_f32 v89, v10, v89
v_mfma_f32_16x16x32_bf16 v[156:159], a[40:43], v[36:39], v[156:159]
s_waitcnt vmcnt(32)
s_barrier
v_mfma_f32_16x16x32_bf16 v[168:171], a[44:47], v[36:39], v[168:171]
ds_read_b64_tr_b16 a[32:33], v9 offset:384
ds_read_b64_tr_b16 a[34:35], v9 offset:896
v_mfma_f32_16x16x32_bf16 v[164:167], a[44:47], v[32:35], v[164:167]
v_mul_f32 v90, v10, v90
v_mul_f32 v91, v10, v91
v_mfma_f32_16x16x32_bf16 v[160:163], a[44:47], v[28:31], v[160:163]
s_waitcnt lgkmcnt(6)
v_mul_f32 v80, v11, v80
v_mfma_f32_16x16x32_bf16 v[172:175], a[16:19], v[28:31], v[172:175]
ds_read_b64_tr_b16 a[36:37], v9 offset:416
ds_read_b64_tr_b16 a[38:39], v9 offset:928
v_mfma_f32_16x16x32_bf16 v[176:179], a[16:19], v[32:35], v[176:179]
v_mul_f32 v81, v11, v81
v_mul_f32 v82, v11, v82
v_mul_f32 v83, v11, v83
v_mfma_f32_16x16x32_bf16 v[180:183], a[16:19], v[36:39], v[180:183]
v_mul_f32 v92, v11, v92
v_mul_f32 v93, v11, v93
v_mul_f32 v94, v11, v94
v_mfma_f32_16x16x32_bf16 v[192:195], a[20:23], v[36:39], v[192:195]
ds_read_b64_tr_b16 a[40:41], v9 offset:448
ds_read_b64_tr_b16 a[42:43], v9 offset:960
v_mul_f32 v95, v11, v95
v_mfma_f32_16x16x32_bf16 v[188:191], a[20:23], v[32:35], v[188:191]
v_cvt_pk_bf16_f32 v64, v76, v77
v_cvt_pk_bf16_f32 v65, v78, v79
v_cvt_pk_bf16_f32 v66, v88, v89
v_mfma_f32_16x16x32_bf16 v[184:187], a[20:23], v[28:31], v[184:187]
s_waitcnt lgkmcnt(6)
v_cvt_pk_bf16_f32 v67, v90, v91
v_mul_f32 v84, v12, v84
v_mul_f32 v85, v12, v85
v_mfma_f32_16x16x32_bf16 v[196:199], a[24:27], v[28:31], v[196:199]
ds_read_b64_tr_b16 a[44:45], v9 offset:480
ds_read_b64_tr_b16 a[46:47], v9 offset:992
v_mul_f32 v86, v12, v86
v_mul_f32 v87, v12, v87
v_mul_f32 v96, v12, v96
v_mfma_f32_16x16x32_bf16 v[200:203], a[24:27], v[32:35], v[200:203]
v_mul_f32 v97, v12, v97
v_mul_f32 v98, v12, v98
v_mul_f32 v99, v12, v99
v_mul_f32 v100, v10, v100
v_mul_f32 v101, v10, v101
v_mul_f32 v102, v10, v102
v_mfma_f32_16x16x32_bf16 v[204:207], a[24:27], v[36:39], v[204:207]
v_mul_f32 v103, v10, v103
v_cvt_pk_bf16_f32 v68, v80, v81
v_cvt_pk_bf16_f32 v69, v82, v83
v_cvt_pk_bf16_f32 v70, v92, v93
v_cvt_pk_bf16_f32 v71, v94, v95
v_accvgpr_write_b32 a48, v64
v_accvgpr_write_b32 a49, v65
v_accvgpr_write_b32 a50, v66
v_mfma_f32_16x16x32_bf16 v[216:219], a[28:31], v[36:39], v[216:219]
v_and_b32 v8, 0x1c0, v252
v_bfe_u32 v15, v252, 8, 1
v_lshl_add_u32 v8, v15, 5, v8
v_bfe_u32 v15, v252, 4, 2
v_lshl_add_u32 v8, v15, 3, v8
s_lshl_b32 s87, s49, 5
s_and_b32 s87, s87, 32
v_xor_b32 v8, s87, v8
v_lshrrev_b32 v14, 9, v252
v_mul_u32_u24 v14, 1056, v14
v_add_u32 v15, v8, v14
v_xor_b32 v8, 32, v8
v_add_u32 v8, v8, v14
v_add_u32 v15, 101376, v15
ds_read_b64_tr_b16 a[16:17], v15 offset:33792
ds_read_b64_tr_b16 a[18:19], v15 offset:35904
v_mfma_f32_16x16x32_bf16 v[212:215], a[28:31], v[32:35], v[212:215]
v_accvgpr_write_b32 a51, v67
v_mul_f32 v112, v10, v112
v_mfma_f32_16x16x32_bf16 v[208:211], a[28:31], v[28:31], v[208:211]
s_waitcnt lgkmcnt(6)
v_mul_f32 v113, v10, v113
v_mfma_f32_16x16x32_bf16 v[220:223], a[32:35], v[28:31], v[220:223]
ds_read_b64_tr_b16 a[20:21], v15 offset:38016
ds_read_b64_tr_b16 a[22:23], v15 offset:40128
v_mfma_f32_16x16x32_bf16 v[224:227], a[32:35], v[32:35], v[224:227]
v_mul_f32 v114, v10, v114
v_mul_f32 v115, v10, v115
v_mfma_f32_16x16x32_bf16 v[228:231], a[32:35], v[36:39], v[228:231]
v_cvt_pk_bf16_f32 v72, v84, v85
v_cvt_pk_bf16_f32 v73, v86, v87
v_mfma_f32_16x16x32_bf16 v[240:243], a[36:39], v[36:39], v[240:243]
ds_read_b64_tr_b16 a[24:25], v15 offset:42240
ds_read_b64_tr_b16 a[26:27], v15 offset:44352
v_mfma_f32_16x16x32_bf16 v[236:239], a[36:39], v[32:35], v[236:239]
v_cvt_pk_bf16_f32 v74, v96, v97
v_cvt_pk_bf16_f32 v75, v98, v99
v_mfma_f32_16x16x32_bf16 v[232:235], a[36:39], v[28:31], v[232:235]
s_waitcnt lgkmcnt(6)
v_mul_f32 v104, v11, v104
v_mfma_f32_16x16x32_bf16 v[244:247], a[40:43], v[28:31], v[244:247]
ds_read_b64_tr_b16 a[28:29], v15 offset:46464
ds_read_b64_tr_b16 a[30:31], v15 offset:48576
v_mfma_f32_16x16x32_bf16 v[248:251], a[40:43], v[32:35], v[248:251]
v_mul_f32 v105, v11, v105
v_mul_f32 v106, v11, v106
v_mfma_f32_16x16x32_bf16 a[0:3], a[40:43], v[36:39], a[0:3]
v_mul_f32 v107, v11, v107
v_accvgpr_write_b32 a52, v68
v_mfma_f32_16x16x32_bf16 a[12:15], a[44:47], v[36:39], a[12:15]
v_add_u32 v8, 101376, v8
ds_read_b64_tr_b16 a[32:33], v8 offset:46464
ds_read_b64_tr_b16 a[34:35], v8 offset:48576
v_mfma_f32_16x16x32_bf16 a[8:11], a[44:47], v[32:35], a[8:11]
v_accvgpr_write_b32 a53, v69
v_accvgpr_write_b32 a54, v70
v_mfma_f32_16x16x32_bf16 a[4:7], a[44:47], v[28:31], a[4:7]
s_waitcnt lgkmcnt(6)
v_accvgpr_write_b32 a55, v71
LS_92:
v_mfma_f32_16x16x32_bf16 v[16:19], a[16:19], a[144:147], 0
ds_read_b64_tr_b16 a[36:37], v8 offset:42240
v_mov_b32 v0, -1
v_mfma_f32_16x16x32_bf16 v[16:19], a[20:23], a[156:159], v[16:19]
ds_read_b64_tr_b16 a[38:39], v8 offset:44352
v_mov_b32 v1, -1
v_mfma_f32_16x16x32_bf16 v[20:23], a[20:23], a[160:163], 0
s_add_u32 m0, s17, 33792
s_add_u32 s50, s100, 229376
v_mfma_f32_16x16x32_bf16 v[20:23], a[16:19], a[148:151], v[20:23]
ds_read_b64_tr_b16 a[40:41], v8 offset:38016
v_mov_b32 v2, -1
v_mfma_f32_16x16x32_bf16 v[24:27], a[16:19], a[152:155], 0
ds_read_b64_tr_b16 a[42:43], v8 offset:40128
v_mov_b32 v3, -1
v_mfma_f32_16x16x32_bf16 v[24:27], a[20:23], a[164:167], v[24:27]
s_waitcnt lgkmcnt(6)
v_cvt_pk_bf16_f32 v64, v100, v101
v_mfma_f32_16x16x32_bf16 v[24:27], a[24:27], a[176:179], v[24:27]
ds_read_b64_tr_b16 a[44:45], v8 offset:33792
v_cvt_pk_bf16_f32 v65, v102, v103
v_mfma_f32_16x16x32_bf16 v[24:27], a[28:31], a[188:191], v[24:27]
ds_read_b64_tr_b16 a[46:47], v8 offset:35904
v_mul_f32 v116, v11, v116
v_mfma_f32_16x16x32_bf16 v[20:23], a[28:31], a[184:187], v[20:23]
buffer_load_dwordx4 v4, s[32:35], s50 offen offset:0 lds
v_mfma_f32_16x16x32_bf16 v[20:23], a[24:27], a[172:175], v[20:23]
ds_read_b64_tr_b16 a[16:17], v15 offset:34304
v_mul_f32 v117, v11, v117
v_mfma_f32_16x16x32_bf16 v[16:19], a[24:27], a[168:171], v[16:19]
ds_read_b64_tr_b16 a[18:19], v15 offset:36416
v_mul_f32 v118, v11, v118
v_mfma_f32_16x16x32_bf16 v[16:19], a[28:31], a[180:183], v[16:19]
s_waitcnt lgkmcnt(6)
v_mul_f32 v119, v11, v119
v_mfma_f32_16x16x32_bf16 v[28:31], a[32:35], a[180:183], 0
ds_read_b64_tr_b16 a[20:21], v15 offset:38528
v_cvt_pk_bf16_f32 v66, v112, v113
v_mfma_f32_16x16x32_bf16 v[28:31], a[36:39], a[168:171], v[28:31]
ds_read_b64_tr_b16 a[22:23], v15 offset:40640
v_cvt_pk_bf16_f32 v67, v114, v115
v_mfma_f32_16x16x32_bf16 v[32:35], a[36:39], a[172:175], 0
buffer_load_dwordx4 v5, s[32:35], s50 offen offset:1056 lds
v_mfma_f32_16x16x32_bf16 v[32:35], a[32:35], a[184:187], v[32:35]
ds_read_b64_tr_b16 a[24:25], v15 offset:42752
v_accvgpr_write_b32 a56, v72
v_mfma_f32_16x16x32_bf16 v[36:39], a[32:35], a[188:191], 0
ds_read_b64_tr_b16 a[26:27], v15 offset:44864
v_accvgpr_write_b32 a57, v73
v_mfma_f32_16x16x32_bf16 v[36:39], a[36:39], a[176:179], v[36:39]
s_waitcnt lgkmcnt(6)
v_accvgpr_write_b32 a58, v74
v_mfma_f32_16x16x32_bf16 v[36:39], a[40:43], a[164:167], v[36:39]
ds_read_b64_tr_b16 a[28:29], v15 offset:46976
v_accvgpr_write_b32 a59, v75
v_mfma_f32_16x16x32_bf16 v[36:39], a[44:47], a[152:155], v[36:39]
ds_read_b64_tr_b16 a[30:31], v15 offset:49088
v_mul_f32 v108, v12, v108
v_mfma_f32_16x16x32_bf16 v[32:35], a[44:47], a[148:151], v[32:35]
s_waitcnt vmcnt(26)
s_barrier
v_mfma_f32_16x16x32_bf16 v[32:35], a[40:43], a[160:163], v[32:35]
ds_read_b64_tr_b16 a[32:33], v8 offset:46976
v_mul_f32 v109, v12, v109
v_mfma_f32_16x16x32_bf16 v[28:31], a[40:43], a[156:159], v[28:31]
ds_read_b64_tr_b16 a[34:35], v8 offset:49088
v_mul_f32 v110, v12, v110
v_mfma_f32_16x16x32_bf16 v[28:31], a[44:47], a[144:147], v[28:31]
s_waitcnt lgkmcnt(6)
v_mul_f32 v111, v12, v111
v_mfma_f32_16x16x32_bf16 v[40:43], a[16:19], a[144:147], 0
ds_read_b64_tr_b16 a[36:37], v8 offset:42752
v_cvt_pk_bf16_f32 v68, v104, v105
v_mfma_f32_16x16x32_bf16 v[40:43], a[20:23], a[156:159], v[40:43]
ds_read_b64_tr_b16 a[38:39], v8 offset:44864
v_cvt_pk_bf16_f32 v69, v106, v107
v_mfma_f32_16x16x32_bf16 v[44:47], a[20:23], a[160:163], 0
buffer_load_dwordx4 v6, s[32:35], s50 offen offset:2112 lds
v_mfma_f32_16x16x32_bf16 v[44:47], a[16:19], a[148:151], v[44:47]
ds_read_b64_tr_b16 a[40:41], v8 offset:38528
v_mul_f32 v120, v12, v120
v_mfma_f32_16x16x32_bf16 v[48:51], a[16:19], a[152:155], 0
ds_read_b64_tr_b16 a[42:43], v8 offset:40640
v_mul_f32 v121, v12, v121
v_mfma_f32_16x16x32_bf16 v[48:51], a[20:23], a[164:167], v[48:51]
s_waitcnt lgkmcnt(6)
v_mul_f32 v122, v12, v122
v_mfma_f32_16x16x32_bf16 v[48:51], a[24:27], a[176:179], v[48:51]
ds_read_b64_tr_b16 a[44:45], v8 offset:34304
v_mul_f32 v123, v12, v123
v_mfma_f32_16x16x32_bf16 v[48:51], a[28:31], a[188:191], v[48:51]
ds_read_b64_tr_b16 a[46:47], v8 offset:36416
v_cvt_pk_bf16_f32 v70, v116, v117
v_mfma_f32_16x16x32_bf16 v[44:47], a[28:31], a[184:187], v[44:47]
buffer_load_dwordx4 v7, s[32:35], s50 offen offset:3168 lds
v_mfma_f32_16x16x32_bf16 v[44:47], a[24:27], a[172:175], v[44:47]
ds_read_b64_tr_b16 a[16:17], v15 offset:16896
v_cvt_pk_bf16_f32 v71, v118, v119
v_mfma_f32_16x16x32_bf16 v[40:43], a[24:27], a[168:171], v[40:43]
ds_read_b64_tr_b16 a[18:19], v15 offset:19008
v_cvt_pk_bf16_f32 v72, v108, v109
v_mfma_f32_16x16x32_bf16 v[40:43], a[28:31], a[180:183], v[40:43]
s_waitcnt lgkmcnt(6)
v_cvt_pk_bf16_f32 v73, v110, v111
v_mfma_f32_16x16x32_bf16 v[52:55], a[32:35], a[180:183], 0
ds_read_b64_tr_b16 a[20:21], v15 offset:21120
s_add_u32 m0, s17, 50688
s_add_u32 s50, s100, 344064
v_mfma_f32_16x16x32_bf16 v[52:55], a[36:39], a[168:171], v[52:55]
ds_read_b64_tr_b16 a[22:23], v15 offset:23232
buffer_load_dwordx4 v4, s[32:35], s50 offen offset:0 lds
v_mfma_f32_16x16x32_bf16 v[56:59], a[36:39], a[172:175], 0
s_mov_b32 s51, 36864
buffer_store_dwordx4 v[0:3], v252, s[40:43], s51 offen sc1
v_accvgpr_write_b32 a60, v64
v_mfma_f32_16x16x32_bf16 v[56:59], a[32:35], a[184:187], v[56:59]
ds_read_b64_tr_b16 a[24:25], v15 offset:25344
v_accvgpr_write_b32 a61, v65
v_cvt_pk_bf16_f32 v74, v120, v121
v_mfma_f32_16x16x32_bf16 v[60:63], a[32:35], a[188:191], 0
ds_read_b64_tr_b16 a[26:27], v15 offset:27456
buffer_load_dwordx4 v5, s[32:35], s50 offen offset:1056 lds
v_mfma_f32_16x16x32_bf16 v[60:63], a[36:39], a[176:179], v[60:63]
s_waitcnt lgkmcnt(6)
v_cvt_pk_bf16_f32 v75, v122, v123
v_accvgpr_write_b32 a62, v66
v_mfma_f32_16x16x32_bf16 v[60:63], a[40:43], a[164:167], v[60:63]
ds_read_b64_tr_b16 a[28:29], v15 offset:29568
v_accvgpr_write_b32 a63, v67
v_accvgpr_write_b32 a64, v68
v_mfma_f32_16x16x32_bf16 v[60:63], a[44:47], a[152:155], v[60:63]
ds_read_b64_tr_b16 a[30:31], v15 offset:31680
buffer_load_dwordx4 v6, s[32:35], s50 offen offset:2112 lds
v_mfma_f32_16x16x32_bf16 v[56:59], a[44:47], a[148:151], v[56:59]
v_accvgpr_write_b32 a65, v69
v_accvgpr_write_b32 a68, v72
v_accvgpr_write_b32 a69, v73
v_mfma_f32_16x16x32_bf16 v[56:59], a[40:43], a[160:163], v[56:59]
ds_read_b64_tr_b16 a[32:33], v8 offset:29568
v_accvgpr_write_b32 a70, v74
v_accvgpr_write_b32 a71, v75
v_mfma_f32_16x16x32_bf16 v[52:55], a[40:43], a[156:159], v[52:55]
ds_read_b64_tr_b16 a[34:35], v8 offset:31680
buffer_load_dwordx4 v7, s[32:35], s50 offen offset:3168 lds
v_mfma_f32_16x16x32_bf16 v[52:55], a[44:47], a[144:147], v[52:55]
s_waitcnt lgkmcnt(6)
v_accvgpr_write_b32 a66, v70
v_accvgpr_write_b32 a67, v71
LS_93:
v_mfma_f32_16x16x32_bf16 v[16:19], a[16:19], a[192:195], v[16:19]
ds_read_b64_tr_b16 a[36:37], v8 offset:25344
s_add_u32 m0, s17, 67584
s_add_u32 s50, s101, 0
v_mfma_f32_16x16x32_bf16 v[16:19], a[20:23], a[204:207], v[16:19]
ds_read_b64_tr_b16 a[38:39], v8 offset:27456
buffer_load_dwordx4 v4, s[32:35], s50 offen offset:0 lds
v_mfma_f32_16x16x32_bf16 v[20:23], a[20:23], a[208:211], v[20:23]
v_mul_f32 v132, v12, v132
v_mul_f32 v133, v12, v133
v_mul_f32 v134, v12, v134
v_mfma_f32_16x16x32_bf16 v[20:23], a[16:19], a[196:199], v[20:23]
ds_read_b64_tr_b16 a[40:41], v8 offset:21120
v_mul_f32 v135, v12, v135
v_mul_f32 v144, v12, v144
v_mfma_f32_16x16x32_bf16 v[24:27], a[16:19], a[200:203], v[24:27]
ds_read_b64_tr_b16 a[42:43], v8 offset:23232
buffer_load_dwordx4 v5, s[32:35], s50 offen offset:1056 lds
v_mfma_f32_16x16x32_bf16 v[24:27], a[20:23], a[212:215], v[24:27]
s_waitcnt lgkmcnt(6)
v_mul_f32 v145, v12, v145
v_mul_f32 v146, v12, v146
v_mfma_f32_16x16x32_bf16 v[24:27], a[24:27], a[224:227], v[24:27]
ds_read_b64_tr_b16 a[44:45], v8 offset:16896
s_mov_b32 s51, 37888
buffer_store_dwordx4 v[0:3], v252, s[40:43], s51 offen sc1
v_mfma_f32_16x16x32_bf16 v[24:27], a[28:31], a[236:239], v[24:27]
ds_read_b64_tr_b16 a[46:47], v8 offset:19008
buffer_load_dwordx4 v6, s[32:35], s50 offen offset:2112 lds
v_mfma_f32_16x16x32_bf16 v[20:23], a[28:31], a[232:235], v[20:23]
v_mul_f32 v147, v12, v147
v_mul_f32 v128, v11, v128
v_mul_f32 v129, v11, v129
v_mfma_f32_16x16x32_bf16 v[20:23], a[24:27], a[220:223], v[20:23]
ds_read_b64_tr_b16 a[16:17], v15 offset:17408
v_mul_f32 v130, v11, v130
v_mul_f32 v131, v11, v131
v_mfma_f32_16x16x32_bf16 v[16:19], a[24:27], a[216:219], v[16:19]
ds_read_b64_tr_b16 a[18:19], v15 offset:19520
buffer_load_dwordx4 v7, s[32:35], s50 offen offset:3168 lds
v_mfma_f32_16x16x32_bf16 v[16:19], a[28:31], a[228:231], v[16:19]
s_waitcnt lgkmcnt(6)
v_cvt_pk_bf16_f32 v72, v132, v133
v_cvt_pk_bf16_f32 v73, v134, v135
v_mfma_f32_16x16x32_bf16 v[28:31], a[32:35], a[228:231], v[28:31]
ds_read_b64_tr_b16 a[20:21], v15 offset:21632
v_mul_f32 v140, v11, v140
v_mul_f32 v141, v11, v141
v_mfma_f32_16x16x32_bf16 v[28:31], a[36:39], a[216:219], v[28:31]
ds_read_b64_tr_b16 a[22:23], v15 offset:23744
v_mul_f32 v142, v11, v142
v_mul_f32 v143, v11, v143
v_mfma_f32_16x16x32_bf16 v[32:35], a[36:39], a[220:223], v[32:35]
v_cvt_pk_bf16_f32 v74, v144, v145
v_cvt_pk_bf16_f32 v75, v146, v147
v_cvt_pk_bf16_f32 v68, v128, v129
v_mfma_f32_16x16x32_bf16 v[32:35], a[32:35], a[232:235], v[32:35]
ds_read_b64_tr_b16 a[24:25], v15 offset:25856
v_cvt_pk_bf16_f32 v69, v130, v131
v_accvgpr_write_b32 a80, v72
v_mfma_f32_16x16x32_bf16 v[36:39], a[32:35], a[236:239], v[36:39]
ds_read_b64_tr_b16 a[26:27], v15 offset:27968
v_accvgpr_write_b32 a81, v73
v_cvt_pk_bf16_f32 v70, v140, v141
v_mfma_f32_16x16x32_bf16 v[36:39], a[36:39], a[224:227], v[36:39]
s_waitcnt lgkmcnt(6)
v_cvt_pk_bf16_f32 v71, v142, v143
v_accvgpr_write_b32 a82, v74
v_mfma_f32_16x16x32_bf16 v[36:39], a[40:43], a[212:215], v[36:39]
ds_read_b64_tr_b16 a[28:29], v15 offset:30080
v_accvgpr_write_b32 a83, v75
v_mul_f32 v156, v12, v156
v_mfma_f32_16x16x32_bf16 v[36:39], a[44:47], a[200:203], v[36:39]
ds_read_b64_tr_b16 a[30:31], v15 offset:32192
v_mul_f32 v157, v12, v157
v_mul_f32 v158, v12, v158
v_mfma_f32_16x16x32_bf16 v[32:35], a[44:47], a[196:199], v[32:35]
s_waitcnt vmcnt(26)
s_barrier
v_mul_f32 v159, v12, v159
v_mfma_f32_16x16x32_bf16 v[32:35], a[40:43], a[208:211], v[32:35]
ds_read_b64_tr_b16 a[32:33], v8 offset:30080
v_mul_f32 v168, v12, v168
v_mul_f32 v169, v12, v169
v_mfma_f32_16x16x32_bf16 v[28:31], a[40:43], a[204:207], v[28:31]
ds_read_b64_tr_b16 a[34:35], v8 offset:32192
s_mov_b32 s51, 38912
buffer_store_dwordx4 v[0:3], v252, s[40:43], s51 offen sc1
v_mfma_f32_16x16x32_bf16 v[28:31], a[44:47], a[192:195], v[28:31]
s_waitcnt lgkmcnt(6)
v_mul_f32 v170, v12, v170
v_mul_f32 v171, v12, v171
v_mfma_f32_16x16x32_bf16 v[40:43], a[16:19], a[192:195], v[40:43]
ds_read_b64_tr_b16 a[36:37], v8 offset:25856
v_accvgpr_write_b32 a76, v68
v_accvgpr_write_b32 a77, v69
v_mfma_f32_16x16x32_bf16 v[40:43], a[20:23], a[204:207], v[40:43]
ds_read_b64_tr_b16 a[38:39], v8 offset:27968
v_accvgpr_write_b32 a78, v70
v_accvgpr_write_b32 a79, v71
v_mfma_f32_16x16x32_bf16 v[44:47], a[20:23], a[208:211], v[44:47]
v_mul_f32 v152, v11, v152
v_mul_f32 v153, v11, v153
v_mul_f32 v154, v11, v154
v_mfma_f32_16x16x32_bf16 v[44:47], a[16:19], a[196:199], v[44:47]
ds_read_b64_tr_b16 a[40:41], v8 offset:21632
v_mul_f32 v155, v11, v155
v_cvt_pk_bf16_f32 v72, v156, v157
v_cvt_pk_bf16_f32 v73, v158, v159
v_mfma_f32_16x16x32_bf16 v[48:51], a[16:19], a[200:203], v[48:51]
ds_read_b64_tr_b16 a[42:43], v8 offset:23744
v_mul_f32 v164, v11, v164
v_mul_f32 v165, v11, v165
v_mul_f32 v166, v11, v166
v_mfma_f32_16x16x32_bf16 v[48:51], a[20:23], a[212:215], v[48:51]
s_waitcnt lgkmcnt(6)
v_mul_f32 v167, v11, v167
v_cvt_pk_bf16_f32 v74, v168, v169
v_cvt_pk_bf16_f32 v75, v170, v171
v_mfma_f32_16x16x32_bf16 v[48:51], a[24:27], a[224:227], v[48:51]
ds_read_b64_tr_b16 a[44:45], v8 offset:17408
v_mul_f32 v124, v10, v124
v_mul_f32 v125, v10, v125
v_mul_f32 v126, v10, v126
v_mfma_f32_16x16x32_bf16 v[48:51], a[28:31], a[236:239], v[48:51]
ds_read_b64_tr_b16 a[46:47], v8 offset:19520
v_mul_f32 v127, v10, v127
v_mul_f32 v136, v10, v136
v_mul_f32 v137, v10, v137
v_mfma_f32_16x16x32_bf16 v[44:47], a[28:31], a[232:235], v[44:47]
v_mul_f32 v138, v10, v138
v_mul_f32 v139, v10, v139
v_cvt_pk_bf16_f32 v68, v152, v153
v_cvt_pk_bf16_f32 v69, v154, v155
v_cvt_pk_bf16_f32 v70, v164, v165
v_mfma_f32_16x16x32_bf16 v[44:47], a[24:27], a[220:223], v[44:47]
v_subrev_u32 v15, 50688, v15
ds_read_b64_tr_b16 a[16:17], v15 offset:33792
v_cvt_pk_bf16_f32 v71, v166, v167
v_cvt_pk_bf16_f32 v64, v124, v125
v_cvt_pk_bf16_f32 v65, v126, v127
v_mfma_f32_16x16x32_bf16 v[40:43], a[24:27], a[216:219], v[40:43]
ds_read_b64_tr_b16 a[18:19], v15 offset:35904
v_cvt_pk_bf16_f32 v66, v136, v137
v_cvt_pk_bf16_f32 v67, v138, v139
v_accvgpr_write_b32 a92, v72
v_accvgpr_write_b32 a93, v73
v_mfma_f32_16x16x32_bf16 v[40:43], a[28:31], a[228:231], v[40:43]
s_waitcnt lgkmcnt(6)
v_accvgpr_write_b32 a94, v74
v_accvgpr_write_b32 a95, v75
v_accvgpr_write_b32 a72, v64
v_accvgpr_write_b32 a73, v65
v_mfma_f32_16x16x32_bf16 v[52:55], a[32:35], a[228:231], v[52:55]
ds_read_b64_tr_b16 a[20:21], v15 offset:38016
v_mul_f32 v148, v10, v148
v_mul_f32 v149, v10, v149
v_mul_f32 v150, v10, v150
v_mul_f32 v151, v10, v151
v_mfma_f32_16x16x32_bf16 v[52:55], a[36:39], a[216:219], v[52:55]
ds_read_b64_tr_b16 a[22:23], v15 offset:40128
v_accvgpr_write_b32 a74, v66
v_accvgpr_write_b32 a75, v67
v_accvgpr_write_b32 a88, v68
v_accvgpr_write_b32 a89, v69
v_mfma_f32_16x16x32_bf16 v[56:59], a[36:39], a[220:223], v[56:59]
s_mov_b32 s51, 39936
buffer_store_dwordx4 v[0:3], v252, s[40:43], s51 offen sc1
v_mul_f32 v160, v10, v160
v_mul_f32 v161, v10, v161
v_mul_f32 v162, v10, v162
v_mfma_f32_16x16x32_bf16 v[56:59], a[32:35], a[232:235], v[56:59]
ds_read_b64_tr_b16 a[24:25], v15 offset:42240
v_mul_f32 v163, v10, v163
v_accvgpr_write_b32 a90, v70
v_accvgpr_write_b32 a91, v71
v_cvt_pk_bf16_f32 v64, v148, v149
v_mfma_f32_16x16x32_bf16 v[60:63], a[32:35], a[236:239], v[60:63]
ds_read_b64_tr_b16 a[26:27], v15 offset:44352
v_cvt_pk_bf16_f32 v65, v150, v151
v_cvt_pk_bf16_f32 v66, v160, v161
v_cvt_pk_bf16_f32 v67, v162, v163
v_accvgpr_write_b32 a84, v64
v_mfma_f32_16x16x32_bf16 v[60:63], a[36:39], a[224:227], v[60:63]
s_waitcnt lgkmcnt(6)
v_accvgpr_write_b32 a85, v65
v_accvgpr_write_b32 a86, v66
v_accvgpr_write_b32 a87, v67
v_mul_f32 v172, v10, v172
v_mfma_f32_16x16x32_bf16 v[60:63], a[40:43], a[212:215], v[60:63]
ds_read_b64_tr_b16 a[28:29], v15 offset:46464
v_mul_f32 v173, v10, v173
v_mul_f32 v174, v10, v174
v_mul_f32 v175, v10, v175
v_mul_f32 v184, v10, v184
v_mfma_f32_16x16x32_bf16 v[60:63], a[44:47], a[200:203], v[60:63]
ds_read_b64_tr_b16 a[30:31], v15 offset:48576
v_mul_f32 v185, v10, v185
v_mul_f32 v186, v10, v186
v_mul_f32 v187, v10, v187
v_mul_f32 v176, v11, v176
v_mfma_f32_16x16x32_bf16 v[56:59], a[44:47], a[196:199], v[56:59]
v_mul_f32 v177, v11, v177
v_mul_f32 v178, v11, v178
v_mul_f32 v179, v11, v179
v_cvt_pk_bf16_f32 v64, v172, v173
v_cvt_pk_bf16_f32 v65, v174, v175
v_mfma_f32_16x16x32_bf16 v[56:59], a[40:43], a[208:211], v[56:59]
v_subrev_u32 v8, 50688, v8
ds_read_b64_tr_b16 a[32:33], v8 offset:46464
v_mul_f32 v188, v11, v188
v_mul_f32 v189, v11, v189
v_mul_f32 v190, v11, v190
v_mfma_f32_16x16x32_bf16 v[52:55], a[40:43], a[204:207], v[52:55]
ds_read_b64_tr_b16 a[34:35], v8 offset:48576
v_mul_f32 v191, v11, v191
v_cvt_pk_bf16_f32 v66, v184, v185
v_cvt_pk_bf16_f32 v67, v186, v187
v_cvt_pk_bf16_f32 v68, v176, v177
v_mfma_f32_16x16x32_bf16 v[52:55], a[44:47], a[192:195], v[52:55]
s_waitcnt lgkmcnt(6)
v_cvt_pk_bf16_f32 v69, v178, v179
v_accvgpr_write_b32 a96, v64
v_accvgpr_write_b32 a97, v65
LS_94:
v_mfma_f32_16x16x32_bf16 v[16:19], a[16:19], a[48:51], v[16:19]
ds_read_b64_tr_b16 a[36:37], v8 offset:42240
s_add_u32 m0, s17, 135168
s_add_u32 s50, s101, 114688
v_cvt_pk_bf16_f32 v70, v188, v189
v_mfma_f32_16x16x32_bf16 v[16:19], a[20:23], a[60:63], v[16:19]
ds_read_b64_tr_b16 a[38:39], v8 offset:44352
buffer_load_dwordx4 v4, s[32:35], s50 offen offset:0 lds
v_cvt_pk_bf16_f32 v71, v190, v191
v_mul_f32 v196, v10, v196
v_mfma_f32_16x16x32_bf16 v[20:23], a[20:23], a[64:67], v[20:23]
v_mul_f32 v197, v10, v197
v_mul_f32 v198, v10, v198
v_mul_f32 v199, v10, v199
v_accvgpr_write_b32 a98, v66
v_mfma_f32_16x16x32_bf16 v[20:23], a[16:19], a[52:55], v[20:23]
ds_read_b64_tr_b16 a[40:41], v8 offset:38016
v_accvgpr_write_b32 a99, v67
v_mul_f32 v208, v10, v208
v_mul_f32 v209, v10, v209
v_mfma_f32_16x16x32_bf16 v[24:27], a[16:19], a[56:59], v[24:27]
ds_read_b64_tr_b16 a[42:43], v8 offset:40128
buffer_load_dwordx4 v5, s[32:35], s50 offen offset:1056 lds
v_mul_f32 v210, v10, v210
v_mul_f32 v211, v10, v211
v_mfma_f32_16x16x32_bf16 v[24:27], a[20:23], a[68:71], v[24:27]
s_waitcnt lgkmcnt(6)
v_accvgpr_write_b32 a100, v68
v_accvgpr_write_b32 a101, v69
v_accvgpr_write_b32 a102, v70
v_mfma_f32_16x16x32_bf16 v[24:27], a[24:27], a[80:83], v[24:27]
ds_read_b64_tr_b16 a[44:45], v8 offset:33792
s_mov_b32 s51, 40960
buffer_store_dwordx4 v[0:3], v252, s[40:43], s51 offen sc1
v_accvgpr_write_b32 a103, v71
v_mfma_f32_16x16x32_bf16 v[24:27], a[28:31], a[92:95], v[24:27]
ds_read_b64_tr_b16 a[46:47], v8 offset:35904
buffer_load_dwordx4 v6, s[32:35], s50 offen offset:2112 lds
v_mul_f32 v200, v11, v200
v_mul_f32 v201, v11, v201
v_mfma_f32_16x16x32_bf16 v[20:23], a[28:31], a[88:91], v[20:23]
v_mul_f32 v202, v11, v202
v_mul_f32 v203, v11, v203
v_cvt_pk_bf16_f32 v64, v196, v197
v_cvt_pk_bf16_f32 v65, v198, v199
v_mul_f32 v212, v11, v212
v_mfma_f32_16x16x32_bf16 v[20:23], a[24:27], a[76:79], v[20:23]
ds_read_b64_tr_b16 a[16:17], v15 offset:34304
v_mul_f32 v213, v11, v213
v_mul_f32 v214, v11, v214
v_mul_f32 v215, v11, v215
v_cvt_pk_bf16_f32 v66, v208, v209
v_mfma_f32_16x16x32_bf16 v[16:19], a[24:27], a[72:75], v[16:19]
ds_read_b64_tr_b16 a[18:19], v15 offset:36416
buffer_load_dwordx4 v7, s[32:35], s50 offen offset:3168 lds
v_cvt_pk_bf16_f32 v67, v210, v211
v_mul_f32 v180, v12, v180
v_mfma_f32_16x16x32_bf16 v[16:19], a[28:31], a[84:87], v[16:19]
s_waitcnt lgkmcnt(6)
v_mul_f32 v181, v12, v181
v_mul_f32 v182, v12, v182
v_mul_f32 v183, v12, v183
v_mfma_f32_16x16x32_bf16 v[28:31], a[32:35], a[84:87], v[28:31]
ds_read_b64_tr_b16 a[20:21], v15 offset:38528
v_mul_f32 v192, v12, v192
v_mul_f32 v193, v12, v193
v_mul_f32 v194, v12, v194
v_mfma_f32_16x16x32_bf16 v[28:31], a[36:39], a[72:75], v[28:31]
ds_read_b64_tr_b16 a[22:23], v15 offset:40640
v_mul_f32 v195, v12, v195
v_cvt_pk_bf16_f32 v68, v200, v201
v_cvt_pk_bf16_f32 v69, v202, v203
v_accvgpr_write_b32 a108, v64
v_mfma_f32_16x16x32_bf16 v[32:35], a[36:39], a[76:79], v[32:35]
v_accvgpr_write_b32 a109, v65
v_cvt_pk_bf16_f32 v70, v212, v213
v_cvt_pk_bf16_f32 v71, v214, v215
v_mul_f32 v220, v10, v220
v_mfma_f32_16x16x32_bf16 v[32:35], a[32:35], a[88:91], v[32:35]
ds_read_b64_tr_b16 a[24:25], v15 offset:42752
v_mul_f32 v221, v10, v221
v_mul_f32 v222, v10, v222
v_mul_f32 v223, v10, v223
v_mfma_f32_16x16x32_bf16 v[36:39], a[32:35], a[92:95], v[36:39]
ds_read_b64_tr_b16 a[26:27], v15 offset:44864
v_accvgpr_write_b32 a110, v66
v_accvgpr_write_b32 a111, v67
v_mul_f32 v232, v10, v232
v_mul_f32 v233, v10, v233
v_mfma_f32_16x16x32_bf16 v[36:39], a[36:39], a[80:83], v[36:39]
s_waitcnt lgkmcnt(6)
v_mul_f32 v234, v10, v234
v_mul_f32 v235, v10, v235
v_cvt_pk_bf16_f32 v72, v180, v181
v_mfma_f32_16x16x32_bf16 v[36:39], a[40:43], a[68:71], v[36:39]
ds_read_b64_tr_b16 a[28:29], v15 offset:46976
v_cvt_pk_bf16_f32 v73, v182, v183
v_cvt_pk_bf16_f32 v74, v192, v193
v_cvt_pk_bf16_f32 v75, v194, v195
v_mfma_f32_16x16x32_bf16 v[36:39], a[44:47], a[56:59], v[36:39]
ds_read_b64_tr_b16 a[30:31], v15 offset:49088
v_accvgpr_write_b32 a112, v68
v_accvgpr_write_b32 a113, v69
v_accvgpr_write_b32 a114, v70
v_accvgpr_write_b32 a115, v71
v_mfma_f32_16x16x32_bf16 v[32:35], a[44:47], a[52:55], v[32:35]
s_waitcnt vmcnt(29)
s_barrier
v_mul_f32 v224, v11, v224
v_mul_f32 v225, v11, v225
v_mfma_f32_16x16x32_bf16 v[32:35], a[40:43], a[64:67], v[32:35]
ds_read_b64_tr_b16 a[32:33], v8 offset:46976
v_mul_f32 v226, v11, v226
v_mul_f32 v227, v11, v227
v_cvt_pk_bf16_f32 v64, v220, v221
v_mfma_f32_16x16x32_bf16 v[28:31], a[40:43], a[60:63], v[28:31]
ds_read_b64_tr_b16 a[34:35], v8 offset:49088
s_mov_b32 s51, 41984
buffer_store_dwordx4 v[0:3], v252, s[40:43], s51 offen sc1
v_cvt_pk_bf16_f32 v65, v222, v223
v_mul_f32 v236, v11, v236
v_mfma_f32_16x16x32_bf16 v[28:31], a[44:47], a[48:51], v[28:31]
s_waitcnt lgkmcnt(6)
v_mul_f32 v237, v11, v237
v_mul_f32 v238, v11, v238
v_mul_f32 v239, v11, v239
v_cvt_pk_bf16_f32 v66, v232, v233
v_mfma_f32_16x16x32_bf16 v[40:43], a[16:19], a[48:51], v[40:43]
ds_read_b64_tr_b16 a[36:37], v8 offset:42752
v_cvt_pk_bf16_f32 v67, v234, v235
v_accvgpr_read_b32 v208, a4
v_accvgpr_read_b32 v209, a5
v_accvgpr_read_b32 v210, a6
v_mfma_f32_16x16x32_bf16 v[40:43], a[20:23], a[60:63], v[40:43]
ds_read_b64_tr_b16 a[38:39], v8 offset:44864
v_accvgpr_read_b32 v211, a7
v_accvgpr_write_b32 a104, v72
v_accvgpr_write_b32 a105, v73
v_accvgpr_write_b32 a106, v74
v_mfma_f32_16x16x32_bf16 v[44:47], a[20:23], a[64:67], v[44:47]
v_accvgpr_write_b32 a107, v75
v_mul_f32 v204, v12, v204
v_mul_f32 v205, v12, v205
v_mul_f32 v206, v12, v206
v_mfma_f32_16x16x32_bf16 v[44:47], a[16:19], a[52:55], v[44:47]
ds_read_b64_tr_b16 a[40:41], v8 offset:38528
v_mul_f32 v207, v12, v207
v_mul_f32 v216, v12, v216
v_mul_f32 v217, v12, v217
v_mfma_f32_16x16x32_bf16 v[48:51], a[16:19], a[56:59], v[48:51]
ds_read_b64_tr_b16 a[42:43], v8 offset:40640
v_mul_f32 v218, v12, v218
v_mul_f32 v219, v12, v219
v_cvt_pk_bf16_f32 v68, v224, v225
v_cvt_pk_bf16_f32 v69, v226, v227
v_mfma_f32_16x16x32_bf16 v[48:51], a[20:23], a[68:71], v[48:51]
s_waitcnt lgkmcnt(6)
v_accvgpr_write_b32 a120, v64
v_accvgpr_write_b32 a121, v65
v_cvt_pk_bf16_f32 v70, v236, v237
v_mfma_f32_16x16x32_bf16 v[48:51], a[24:27], a[80:83], v[48:51]
ds_read_b64_tr_b16 a[44:45], v8 offset:34304
v_cvt_pk_bf16_f32 v71, v238, v239
v_accvgpr_write_b32 a122, v66
v_accvgpr_write_b32 a123, v67
v_mfma_f32_16x16x32_bf16 v[48:51], a[28:31], a[92:95], v[48:51]
ds_read_b64_tr_b16 a[46:47], v8 offset:36416
v_accvgpr_read_b32 v212, a8
v_accvgpr_read_b32 v213, a9
v_accvgpr_read_b32 v214, a10
v_accvgpr_read_b32 v215, a11
v_mfma_f32_16x16x32_bf16 v[44:47], a[28:31], a[88:91], v[44:47]
v_mul_f32 v208, v10, v208
v_mul_f32 v209, v10, v209
v_mul_f32 v210, v10, v210
v_mul_f32 v211, v10, v211
v_mfma_f32_16x16x32_bf16 v[44:47], a[24:27], a[76:79], v[44:47]
v_add_u32 v15, 50688, v15
ds_read_b64_tr_b16 a[16:17], v15 offset:0
v_cvt_pk_bf16_f32 v72, v204, v205
v_cvt_pk_bf16_f32 v73, v206, v207
v_mfma_f32_16x16x32_bf16 v[40:43], a[24:27], a[72:75], v[40:43]
ds_read_b64_tr_b16 a[18:19], v15 offset:2112
v_cvt_pk_bf16_f32 v74, v216, v217
v_cvt_pk_bf16_f32 v75, v218, v219
v_accvgpr_write_b32 a124, v68
v_accvgpr_write_b32 a125, v69
v_mfma_f32_16x16x32_bf16 v[40:43], a[28:31], a[84:87], v[40:43]
s_waitcnt lgkmcnt(6)
v_accvgpr_write_b32 a126, v70
v_accvgpr_write_b32 a127, v71
v_mul_f32 v212, v11, v212
v_mfma_f32_16x16x32_bf16 v[52:55], a[32:35], a[84:87], v[52:55]
ds_read_b64_tr_b16 a[20:21], v15 offset:4224
v_mul_f32 v213, v11, v213
v_mul_f32 v214, v11, v214
v_mul_f32 v215, v11, v215
v_mfma_f32_16x16x32_bf16 v[52:55], a[36:39], a[72:75], v[52:55]
ds_read_b64_tr_b16 a[22:23], v15 offset:6336
v_cvt_pk_bf16_f32 v66, v208, v209
v_cvt_pk_bf16_f32 v67, v210, v211
v_accvgpr_write_b32 a116, v72
v_accvgpr_write_b32 a117, v73
v_mfma_f32_16x16x32_bf16 v[56:59], a[36:39], a[76:79], v[56:59]
v_accvgpr_write_b32 a118, v74
v_accvgpr_write_b32 a119, v75
v_mul_f32 v228, v12, v228
v_mul_f32 v229, v12, v229
v_mfma_f32_16x16x32_bf16 v[56:59], a[32:35], a[88:91], v[56:59]
ds_read_b64_tr_b16 a[24:25], v15 offset:8448
v_mul_f32 v230, v12, v230
v_mul_f32 v231, v12, v231
v_mul_f32 v240, v12, v240
v_mfma_f32_16x16x32_bf16 v[60:63], a[32:35], a[92:95], v[60:63]
ds_read_b64_tr_b16 a[26:27], v15 offset:10560
v_mul_f32 v241, v12, v241
v_mul_f32 v242, v12, v242
v_mul_f32 v243, v12, v243
v_cvt_pk_bf16_f32 v70, v212, v213
v_mfma_f32_16x16x32_bf16 v[60:63], a[36:39], a[80:83], v[60:63]
s_waitcnt lgkmcnt(6)
v_cvt_pk_bf16_f32 v71, v214, v215
v_cvt_pk_bf16_f32 v72, v228, v229
v_cvt_pk_bf16_f32 v73, v230, v231
v_mfma_f32_16x16x32_bf16 v[60:63], a[40:43], a[68:71], v[60:63]
ds_read_b64_tr_b16 a[28:29], v15 offset:12672
v_cvt_pk_bf16_f32 v74, v240, v241
v_cvt_pk_bf16_f32 v75, v242, v243
v_accvgpr_read_b32 v204, a0
v_mfma_f32_16x16x32_bf16 v[60:63], a[44:47], a[56:59], v[60:63]
ds_read_b64_tr_b16 a[30:31], v15 offset:14784
v_accvgpr_read_b32 v205, a1
v_accvgpr_read_b32 v206, a2
v_accvgpr_read_b32 v207, a3
v_accvgpr_read_b32 v216, a12
v_mfma_f32_16x16x32_bf16 v[56:59], a[44:47], a[52:55], v[56:59]
v_accvgpr_read_b32 v217, a13
v_accvgpr_read_b32 v218, a14
v_accvgpr_read_b32 v219, a15
v_accvgpr_write_b32 a128, v72
v_mfma_f32_16x16x32_bf16 v[56:59], a[40:43], a[64:67], v[56:59]
v_add_u32 v8, 50688, v8
ds_read_b64_tr_b16 a[32:33], v8 offset:12672
v_accvgpr_write_b32 a129, v73
v_accvgpr_write_b32 a130, v74
v_mfma_f32_16x16x32_bf16 v[52:55], a[40:43], a[60:63], v[52:55]
ds_read_b64_tr_b16 a[34:35], v8 offset:14784
v_accvgpr_write_b32 a131, v75
v_mul_f32 v204, v12, v204
v_mul_f32 v205, v12, v205
v_mul_f32 v206, v12, v206
v_mfma_f32_16x16x32_bf16 v[52:55], a[44:47], a[48:51], v[52:55]
s_waitcnt lgkmcnt(6)
v_mul_f32 v207, v12, v207
v_mul_f32 v216, v12, v216
v_mul_f32 v217, v12, v217
LS_95:
v_mfma_f32_16x16x32_bf16 v[16:19], a[16:19], a[96:99], v[16:19]
ds_read_b64_tr_b16 a[36:37], v8 offset:8448
v_mul_f32 v218, v12, v218
v_mul_f32 v219, v12, v219
v_cvt_pk_bf16_f32 v72, v204, v205
v_mfma_f32_16x16x32_bf16 v[16:19], a[20:23], a[108:111], v[16:19]
ds_read_b64_tr_b16 a[38:39], v8 offset:10560
v_cvt_pk_bf16_f32 v73, v206, v207
v_cvt_pk_bf16_f32 v74, v216, v217
v_cvt_pk_bf16_f32 v75, v218, v219
v_mul_f32 v248, v11, v248
v_mfma_f32_16x16x32_bf16 v[20:23], a[20:23], a[112:115], v[20:23]
v_mul_f32 v249, v11, v249
v_mul_f32 v250, v11, v250
v_mul_f32 v251, v11, v251
v_accvgpr_write_b32 a140, v72
v_mfma_f32_16x16x32_bf16 v[20:23], a[16:19], a[100:103], v[20:23]
ds_read_b64_tr_b16 a[40:41], v8 offset:4224
v_cvt_pk_bf16_f32 v68, v248, v249
v_cvt_pk_bf16_f32 v69, v250, v251
v_accvgpr_write_b32 a141, v73
v_mfma_f32_16x16x32_bf16 v[24:27], a[16:19], a[104:107], v[24:27]
ds_read_b64_tr_b16 a[42:43], v8 offset:6336
v_accvgpr_write_b32 a142, v74
v_accvgpr_write_b32 a143, v75
v_mul_f32 v244, v10, v244
v_mul_f32 v245, v10, v245
v_mfma_f32_16x16x32_bf16 v[24:27], a[20:23], a[116:119], v[24:27]
s_waitcnt lgkmcnt(6)
v_mul_f32 v246, v10, v246
v_mul_f32 v247, v10, v247
v_accvgpr_write_b32 a136, v68
v_mfma_f32_16x16x32_bf16 v[24:27], a[24:27], a[128:131], v[24:27]
ds_read_b64_tr_b16 a[44:45], v8 offset:0
v_accvgpr_write_b32 a137, v69
v_accvgpr_write_b32 a138, v70
v_accvgpr_write_b32 a139, v71
v_mfma_f32_16x16x32_bf16 v[24:27], a[28:31], a[140:143], v[24:27]
ds_read_b64_tr_b16 a[46:47], v8 offset:2112
v_cvt_pk_bf16_f32 v64, v244, v245
v_cvt_pk_bf16_f32 v65, v246, v247
v_mfma_f32_16x16x32_bf16 v[20:23], a[28:31], a[136:139], v[20:23]
v_accvgpr_write_b32 a132, v64
v_accvgpr_write_b32 a133, v65
v_accvgpr_write_b32 a134, v66
v_mfma_f32_16x16x32_bf16 v[20:23], a[24:27], a[124:127], v[20:23]
ds_read_b64_tr_b16 a[16:17], v15 offset:512
v_accvgpr_write_b32 a135, v67
v_mfma_f32_16x16x32_bf16 v[16:19], a[24:27], a[120:123], v[16:19]
ds_read_b64_tr_b16 a[18:19], v15 offset:2624
v_mfma_f32_16x16x32_bf16 v[16:19], a[28:31], a[132:135], v[16:19]
s_waitcnt lgkmcnt(6)
v_mfma_f32_16x16x32_bf16 v[28:31], a[32:35], a[132:135], v[28:31]
ds_read_b64_tr_b16 a[20:21], v15 offset:4736
v_mfma_f32_16x16x32_bf16 v[28:31], a[36:39], a[120:123], v[28:31]
ds_read_b64_tr_b16 a[22:23], v15 offset:6848
v_mfma_f32_16x16x32_bf16 v[32:35], a[36:39], a[124:127], v[32:35]
s_add_u32 m0, s17, 118272
s_add_u32 s50, s101, 229376
v_mfma_f32_16x16x32_bf16 v[32:35], a[32:35], a[136:139], v[32:35]
ds_read_b64_tr_b16 a[24:25], v15 offset:8960
v_mfma_f32_16x16x32_bf16 v[36:39], a[32:35], a[140:143], v[36:39]
ds_read_b64_tr_b16 a[26:27], v15 offset:11072
v_mfma_f32_16x16x32_bf16 v[36:39], a[36:39], a[128:131], v[36:39]
s_waitcnt lgkmcnt(6)
v_mfma_f32_16x16x32_bf16 v[36:39], a[40:43], a[116:119], v[36:39]
ds_read_b64_tr_b16 a[28:29], v15 offset:13184
v_mfma_f32_16x16x32_bf16 v[36:39], a[44:47], a[104:107], v[36:39]
ds_read_b64_tr_b16 a[30:31], v15 offset:15296
v_mfma_f32_16x16x32_bf16 v[32:35], a[44:47], a[100:103], v[32:35]
s_waitcnt vmcnt(26)
s_barrier
v_mfma_f32_16x16x32_bf16 v[32:35], a[40:43], a[112:115], v[32:35]
ds_read_b64_tr_b16 a[32:33], v8 offset:13184
v_mfma_f32_16x16x32_bf16 v[28:31], a[40:43], a[108:111], v[28:31]
ds_read_b64_tr_b16 a[34:35], v8 offset:15296
v_mfma_f32_16x16x32_bf16 v[28:31], a[44:47], a[96:99], v[28:31]
s_waitcnt lgkmcnt(6)
v_mfma_f32_16x16x32_bf16 v[40:43], a[16:19], a[96:99], v[40:43]
ds_read_b64_tr_b16 a[36:37], v8 offset:8960
v_mfma_f32_16x16x32_bf16 v[40:43], a[20:23], a[108:111], v[40:43]
ds_read_b64_tr_b16 a[38:39], v8 offset:11072
v_mfma_f32_16x16x32_bf16 v[44:47], a[20:23], a[112:115], v[44:47]
buffer_load_dwordx4 v4, s[32:35], s50 offen offset:0 lds
v_mfma_f32_16x16x32_bf16 v[44:47], a[16:19], a[100:103], v[44:47]
ds_read_b64_tr_b16 a[40:41], v8 offset:4736
v_mfma_f32_16x16x32_bf16 v[48:51], a[16:19], a[104:107], v[48:51]
ds_read_b64_tr_b16 a[42:43], v8 offset:6848
v_mfma_f32_16x16x32_bf16 v[48:51], a[20:23], a[116:119], v[48:51]
s_waitcnt lgkmcnt(6)
v_mfma_f32_16x16x32_bf16 v[48:51], a[24:27], a[128:131], v[48:51]
ds_read_b64_tr_b16 a[44:45], v8 offset:512
v_lshrrev_b32 v156, 8, v252
v_mfma_f32_16x16x32_bf16 v[48:51], a[28:31], a[140:143], v[48:51]
ds_read_b64_tr_b16 a[46:47], v8 offset:2624
v_bfe_u32 v148, v252, 6, 2
v_mfma_f32_16x16x32_bf16 v[44:47], a[28:31], a[136:139], v[44:47]
buffer_load_dwordx4 v5, s[32:35], s50 offen offset:1056 lds
v_mfma_f32_16x16x32_bf16 v[44:47], a[24:27], a[124:127], v[44:47]
v_subrev_u32 v15, 101376, v15
ds_read_b64_tr_b16 a[16:17], v15 offset:16896
v_mfma_f32_16x16x32_bf16 v[40:43], a[24:27], a[120:123], v[40:43]
ds_read_b64_tr_b16 a[18:19], v15 offset:19008
v_cmp_eq_u32 vcc, v156, v148
v_mfma_f32_16x16x32_bf16 v[40:43], a[28:31], a[132:135], v[40:43]
s_waitcnt lgkmcnt(6)
v_and_b32 v148, 16, v252
v_mfma_f32_16x16x32_bf16 v[52:55], a[32:35], a[132:135], v[52:55]
ds_read_b64_tr_b16 a[20:21], v15 offset:21120
v_mov_b32 v149, 0x3f80
v_mfma_f32_16x16x32_bf16 v[52:55], a[36:39], a[120:123], v[52:55]
ds_read_b64_tr_b16 a[22:23], v15 offset:23232
v_lshlrev_b32 v148, v148, v149
v_mfma_f32_16x16x32_bf16 v[56:59], a[36:39], a[124:127], v[56:59]
buffer_load_dwordx4 v6, s[32:35], s50 offen offset:2112 lds
v_mfma_f32_16x16x32_bf16 v[56:59], a[32:35], a[136:139], v[56:59]
ds_read_b64_tr_b16 a[24:25], v15 offset:25344
v_cndmask_b32 v148, 0, v148, vcc
v_mfma_f32_16x16x32_bf16 v[60:63], a[32:35], a[140:143], v[60:63]
ds_read_b64_tr_b16 a[26:27], v15 offset:27456
v_and_b32 v149, 32, v252
v_mfma_f32_16x16x32_bf16 v[60:63], a[36:39], a[128:131], v[60:63]
s_waitcnt lgkmcnt(6)
v_cmp_eq_u32 vcc, 0, v149
v_mfma_f32_16x16x32_bf16 v[60:63], a[40:43], a[116:119], v[60:63]
ds_read_b64_tr_b16 a[28:29], v15 offset:29568
v_mov_b32 v154, 0
v_mfma_f32_16x16x32_bf16 v[60:63], a[44:47], a[104:107], v[60:63]
ds_read_b64_tr_b16 a[30:31], v15 offset:31680
v_mov_b32 v155, 0
v_mfma_f32_16x16x32_bf16 v[56:59], a[44:47], a[100:103], v[56:59]
buffer_load_dwordx4 v7, s[32:35], s50 offen offset:3168 lds
v_mfma_f32_16x16x32_bf16 v[56:59], a[40:43], a[112:115], v[56:59]
v_subrev_u32 v8, 101376, v8
ds_read_b64_tr_b16 a[32:33], v8 offset:29568
v_mfma_f32_16x16x32_bf16 v[52:55], a[40:43], a[108:111], v[52:55]
ds_read_b64_tr_b16 a[34:35], v8 offset:31680
v_cndmask_b32 v150, 0, v148, vcc
v_mfma_f32_16x16x32_bf16 v[52:55], a[44:47], a[96:99], v[52:55]
s_waitcnt lgkmcnt(6)
v_sub_u32 v151, v148, v150
LS_96:
v_mfma_f32_16x16x32_bf16 v[76:79], a[16:19], a[144:147], 0
ds_read_b64_tr_b16 a[36:37], v8 offset:25344
v_mov_b32 v148, 0
v_mfma_f32_16x16x32_bf16 v[76:79], a[20:23], a[156:159], v[76:79]
ds_read_b64_tr_b16 a[38:39], v8 offset:27456
v_mov_b32 v152, v150
v_mfma_f32_16x16x32_bf16 v[80:83], a[20:23], a[160:163], 0
s_add_u32 m0, s17, 84480
s_add_u32 s50, s101, 344064
v_mfma_f32_16x16x32_bf16 v[80:83], a[16:19], a[148:151], v[80:83]
ds_read_b64_tr_b16 a[40:41], v8 offset:21120
v_mov_b32 v153, v151
v_mfma_f32_16x16x32_bf16 v[84:87], a[16:19], a[152:155], 0
ds_read_b64_tr_b16 a[42:43], v8 offset:23232
v_bfe_u32 v149, v252, 4, 4
v_mfma_f32_16x16x32_bf16 v[84:87], a[20:23], a[164:167], v[84:87]
s_waitcnt lgkmcnt(6)
v_mul_u32_u24 v149, 896, v149
v_mfma_f32_16x16x32_bf16 v[84:87], a[24:27], a[176:179], v[84:87]
ds_read_b64_tr_b16 a[44:45], v8 offset:16896
v_lshl_add_u32 v156, v156, 4, v149
v_mfma_f32_16x16x32_bf16 v[84:87], a[28:31], a[188:191], v[84:87]
ds_read_b64_tr_b16 a[46:47], v8 offset:19008
v_mov_b32 v149, 0
v_mfma_f32_16x16x32_bf16 v[80:83], a[28:31], a[184:187], v[80:83]
buffer_load_dwordx4 v4, s[32:35], s50 offen offset:0 lds
v_mfma_f32_16x16x32_bf16 v[80:83], a[24:27], a[172:175], v[80:83]
ds_read_b64_tr_b16 a[16:17], v15 offset:17408
s_lshl_b32 s56, s16, 7
v_mfma_f32_16x16x32_bf16 v[76:79], a[24:27], a[168:171], v[76:79]
ds_read_b64_tr_b16 a[18:19], v15 offset:19520
v_bfe_u32 v158, v252, 4, 3
v_mfma_f32_16x16x32_bf16 v[76:79], a[28:31], a[180:183], v[76:79]
s_waitcnt lgkmcnt(6)
v_lshlrev_b32 v158, 2, v158
v_mfma_f32_16x16x32_bf16 v[88:91], a[32:35], a[180:183], 0
ds_read_b64_tr_b16 a[20:21], v15 offset:21632
v_add_u32 v158, s56, v158
v_mfma_f32_16x16x32_bf16 v[88:91], a[36:39], a[168:171], v[88:91]
ds_read_b64_tr_b16 a[22:23], v15 offset:23744
s_lshl_b32 s87, s49, 2
v_mfma_f32_16x16x32_bf16 v[92:95], a[36:39], a[172:175], 0
buffer_load_dwordx4 v5, s[32:35], s50 offen offset:1056 lds
v_mfma_f32_16x16x32_bf16 v[92:95], a[32:35], a[184:187], v[92:95]
ds_read_b64_tr_b16 a[24:25], v15 offset:25856
s_add_u32 s56, s56, s87
v_mfma_f32_16x16x32_bf16 v[96:99], a[32:35], a[188:191], 0
ds_read_b64_tr_b16 a[26:27], v15 offset:27968
v_lshlrev_b32 v157, 8, v252
v_mfma_f32_16x16x32_bf16 v[96:99], a[36:39], a[176:179], v[96:99]
s_waitcnt lgkmcnt(6)
v_add_u32 v157, s56, v157
v_mfma_f32_16x16x32_bf16 v[96:99], a[40:43], a[164:167], v[96:99]
ds_read_b64_tr_b16 a[28:29], v15 offset:30080
v_cvt_pk_bf16_f32 v124, v16, v17
v_mfma_f32_16x16x32_bf16 v[96:99], a[44:47], a[152:155], v[96:99]
ds_read_b64_tr_b16 a[30:31], v15 offset:32192
v_cvt_pk_bf16_f32 v125, v18, v19
v_mfma_f32_16x16x32_bf16 v[92:95], a[44:47], a[148:151], v[92:95]
s_waitcnt vmcnt(28)
s_barrier
v_mfma_f32_16x16x32_bf16 v[92:95], a[40:43], a[160:163], v[92:95]
ds_read_b64_tr_b16 a[32:33], v8 offset:30080
v_cvt_pk_bf16_f32 v126, v28, v29
v_mfma_f32_16x16x32_bf16 v[88:91], a[40:43], a[156:159], v[88:91]
ds_read_b64_tr_b16 a[34:35], v8 offset:32192
v_cvt_pk_bf16_f32 v127, v30, v31
v_mfma_f32_16x16x32_bf16 v[88:91], a[44:47], a[144:147], v[88:91]
s_waitcnt lgkmcnt(6)
v_cvt_pk_bf16_f32 v128, v20, v21
v_mfma_f32_16x16x32_bf16 v[100:103], a[16:19], a[144:147], 0
ds_read_b64_tr_b16 a[36:37], v8 offset:25856
v_cvt_pk_bf16_f32 v129, v22, v23
v_mfma_f32_16x16x32_bf16 v[100:103], a[20:23], a[156:159], v[100:103]
ds_read_b64_tr_b16 a[38:39], v8 offset:27968
v_cvt_pk_bf16_f32 v130, v32, v33
v_mfma_f32_16x16x32_bf16 v[104:107], a[20:23], a[160:163], 0
buffer_load_dwordx4 v6, s[32:35], s50 offen offset:2112 lds
v_mfma_f32_16x16x32_bf16 v[104:107], a[16:19], a[148:151], v[104:107]
ds_read_b64_tr_b16 a[40:41], v8 offset:21632
v_cvt_pk_bf16_f32 v131, v34, v35
v_mfma_f32_16x16x32_bf16 v[108:111], a[16:19], a[152:155], 0
ds_read_b64_tr_b16 a[42:43], v8 offset:23744
v_cvt_pk_bf16_f32 v132, v24, v25
v_mfma_f32_16x16x32_bf16 v[108:111], a[20:23], a[164:167], v[108:111]
s_waitcnt lgkmcnt(6)
v_cvt_pk_bf16_f32 v133, v26, v27
v_mfma_f32_16x16x32_bf16 v[108:111], a[24:27], a[176:179], v[108:111]
ds_read_b64_tr_b16 a[44:45], v8 offset:17408
v_cvt_pk_bf16_f32 v134, v36, v37
v_mfma_f32_16x16x32_bf16 v[108:111], a[28:31], a[188:191], v[108:111]
ds_read_b64_tr_b16 a[46:47], v8 offset:19520
v_cvt_pk_bf16_f32 v135, v38, v39
v_mfma_f32_16x16x32_bf16 v[104:107], a[28:31], a[184:187], v[104:107]
buffer_load_dwordx4 v7, s[32:35], s50 offen offset:3168 lds
v_mfma_f32_16x16x32_bf16 v[104:107], a[24:27], a[172:175], v[104:107]
ds_read_b64_tr_b16 a[16:17], v15 offset:0
v_cvt_pk_bf16_f32 v136, v40, v41
v_mfma_f32_16x16x32_bf16 v[100:103], a[24:27], a[168:171], v[100:103]
ds_read_b64_tr_b16 a[18:19], v15 offset:2112
v_cvt_pk_bf16_f32 v137, v42, v43
v_mfma_f32_16x16x32_bf16 v[100:103], a[28:31], a[180:183], v[100:103]
s_waitcnt lgkmcnt(6)
v_cvt_pk_bf16_f32 v138, v52, v53
v_mfma_f32_16x16x32_bf16 v[112:115], a[32:35], a[180:183], 0
ds_read_b64_tr_b16 a[20:21], v15 offset:4224
v_cvt_pk_bf16_f32 v139, v54, v55
v_mfma_f32_16x16x32_bf16 v[112:115], a[36:39], a[168:171], v[112:115]
ds_read_b64_tr_b16 a[22:23], v15 offset:6336
v_cvt_pk_bf16_f32 v140, v44, v45
v_mfma_f32_16x16x32_bf16 v[116:119], a[36:39], a[172:175], 0
s_mov_b32 s51, 0
buffer_store_dwordx4 v[124:127], v252, s[40:43], s51 offen sc1
v_mfma_f32_16x16x32_bf16 v[116:119], a[32:35], a[184:187], v[116:119]
ds_read_b64_tr_b16 a[24:25], v15 offset:8448
v_cvt_pk_bf16_f32 v141, v46, v47
v_mfma_f32_16x16x32_bf16 v[120:123], a[32:35], a[188:191], 0
ds_read_b64_tr_b16 a[26:27], v15 offset:10560
v_cvt_pk_bf16_f32 v142, v56, v57
v_mfma_f32_16x16x32_bf16 v[120:123], a[36:39], a[176:179], v[120:123]
s_waitcnt lgkmcnt(6)
v_cvt_pk_bf16_f32 v143, v58, v59
v_mfma_f32_16x16x32_bf16 v[120:123], a[40:43], a[164:167], v[120:123]
ds_read_b64_tr_b16 a[28:29], v15 offset:12672
v_cvt_pk_bf16_f32 v144, v48, v49
v_mfma_f32_16x16x32_bf16 v[120:123], a[44:47], a[152:155], v[120:123]
ds_read_b64_tr_b16 a[30:31], v15 offset:14784
v_cvt_pk_bf16_f32 v145, v50, v51
v_mfma_f32_16x16x32_bf16 v[116:119], a[44:47], a[148:151], v[116:119]
v_cvt_pk_bf16_f32 v146, v60, v61
v_cvt_pk_bf16_f32 v147, v62, v63
v_mfma_f32_16x16x32_bf16 v[116:119], a[40:43], a[160:163], v[116:119]
ds_read_b64_tr_b16 a[32:33], v8 offset:12672
v_mov_b32 v251, 0
v_mfma_f32_16x16x32_bf16 v[112:115], a[40:43], a[156:159], v[112:115]
ds_read_b64_tr_b16 a[34:35], v8 offset:14784
v_mfma_f32_16x16x32_bf16 v[112:115], a[44:47], a[144:147], v[112:115]
s_waitcnt lgkmcnt(6)
LS_97:
v_mfma_f32_16x16x32_bf16 v[76:79], a[16:19], a[192:195], v[76:79]
ds_read_b64_tr_b16 a[36:37], v8 offset:8448
s_mov_b32 s51, 1024
buffer_store_dwordx4 v[128:131], v252, s[40:43], s51 offen sc1
v_mfma_f32_16x16x32_bf16 v[76:79], a[20:23], a[204:207], v[76:79]
ds_read_b64_tr_b16 a[38:39], v8 offset:10560
s_mov_b32 s51, 2048
buffer_store_dwordx4 v[132:135], v252, s[40:43], s51 offen sc1
v_mfma_f32_16x16x32_bf16 v[80:83], a[20:23], a[208:211], v[80:83]
s_mov_b32 s51, 3072
buffer_store_dwordx4 v[136:139], v252, s[40:43], s51 offen sc1
v_mfma_f32_16x16x32_bf16 v[80:83], a[16:19], a[196:199], v[80:83]
ds_read_b64_tr_b16 a[40:41], v8 offset:4224
s_mov_b32 s51, 4096
buffer_store_dwordx4 v[140:143], v252, s[40:43], s51 offen sc1
v_mfma_f32_16x16x32_bf16 v[84:87], a[16:19], a[200:203], v[84:87]
ds_read_b64_tr_b16 a[42:43], v8 offset:6336
buffer_load_dword v159, v251, s[72:75], 0 offen sc1
v_mfma_f32_16x16x32_bf16 v[84:87], a[20:23], a[212:215], v[84:87]
s_waitcnt lgkmcnt(6)
s_mov_b32 s51, 5120
buffer_store_dwordx4 v[144:147], v252, s[40:43], s51 offen sc1
v_mfma_f32_16x16x32_bf16 v[84:87], a[24:27], a[224:227], v[84:87]
ds_read_b64_tr_b16 a[44:45], v8 offset:0
v_mfma_f32_16x16x32_bf16 v[84:87], a[28:31], a[236:239], v[84:87]
ds_read_b64_tr_b16 a[46:47], v8 offset:2112
v_mfma_f32_16x16x32_bf16 v[80:83], a[28:31], a[232:235], v[80:83]
s_add_u32 m0, s17, 101376
s_add_u32 s50, s45, 0
v_mfma_f32_16x16x32_bf16 v[80:83], a[24:27], a[220:223], v[80:83]
ds_read_b64_tr_b16 a[16:17], v15 offset:512
v_mfma_f32_16x16x32_bf16 v[76:79], a[24:27], a[216:219], v[76:79]
ds_read_b64_tr_b16 a[18:19], v15 offset:2624
v_mfma_f32_16x16x32_bf16 v[76:79], a[28:31], a[228:231], v[76:79]
s_waitcnt lgkmcnt(6)
v_mfma_f32_16x16x32_bf16 v[88:91], a[32:35], a[228:231], v[88:91]
ds_read_b64_tr_b16 a[20:21], v15 offset:4736
v_mfma_f32_16x16x32_bf16 v[88:91], a[36:39], a[216:219], v[88:91]
ds_read_b64_tr_b16 a[22:23], v15 offset:6848
v_mfma_f32_16x16x32_bf16 v[92:95], a[36:39], a[220:223], v[92:95]
buffer_load_dwordx4 v4, s[32:35], s50 offen offset:0 lds
v_mfma_f32_16x16x32_bf16 v[92:95], a[32:35], a[232:235], v[92:95]
ds_read_b64_tr_b16 a[24:25], v15 offset:8960
v_mfma_f32_16x16x32_bf16 v[96:99], a[32:35], a[236:239], v[96:99]
ds_read_b64_tr_b16 a[26:27], v15 offset:11072
v_mfma_f32_16x16x32_bf16 v[96:99], a[36:39], a[224:227], v[96:99]
s_waitcnt lgkmcnt(6)
v_mfma_f32_16x16x32_bf16 v[96:99], a[40:43], a[212:215], v[96:99]
ds_read_b64_tr_b16 a[28:29], v15 offset:13184
v_mfma_f32_16x16x32_bf16 v[96:99], a[44:47], a[200:203], v[96:99]
ds_read_b64_tr_b16 a[30:31], v15 offset:15296
v_mfma_f32_16x16x32_bf16 v[92:95], a[44:47], a[196:199], v[92:95]
s_waitcnt vmcnt(34)
s_barrier
v_mfma_f32_16x16x32_bf16 v[92:95], a[40:43], a[208:211], v[92:95]
ds_read_b64_tr_b16 a[32:33], v8 offset:13184
v_mfma_f32_16x16x32_bf16 v[88:91], a[40:43], a[204:207], v[88:91]
ds_read_b64_tr_b16 a[34:35], v8 offset:15296
v_mfma_f32_16x16x32_bf16 v[88:91], a[44:47], a[192:195], v[88:91]
s_waitcnt lgkmcnt(6)
v_mfma_f32_16x16x32_bf16 v[100:103], a[16:19], a[192:195], v[100:103]
ds_read_b64_tr_b16 a[36:37], v8 offset:8960
v_mfma_f32_16x16x32_bf16 v[100:103], a[20:23], a[204:207], v[100:103]
ds_read_b64_tr_b16 a[38:39], v8 offset:11072
v_mfma_f32_16x16x32_bf16 v[104:107], a[20:23], a[208:211], v[104:107]
buffer_load_dwordx4 v5, s[32:35], s50 offen offset:1056 lds
v_mfma_f32_16x16x32_bf16 v[104:107], a[16:19], a[196:199], v[104:107]
ds_read_b64_tr_b16 a[40:41], v8 offset:4736
v_mfma_f32_16x16x32_bf16 v[108:111], a[16:19], a[200:203], v[108:111]
ds_read_b64_tr_b16 a[42:43], v8 offset:6848
v_mfma_f32_16x16x32_bf16 v[108:111], a[20:23], a[212:215], v[108:111]
s_waitcnt lgkmcnt(6)
v_mfma_f32_16x16x32_bf16 v[108:111], a[24:27], a[224:227], v[108:111]
ds_read_b64_tr_b16 a[44:45], v8 offset:512
v_mfma_f32_16x16x32_bf16 v[108:111], a[28:31], a[236:239], v[108:111]
ds_read_b64_tr_b16 a[46:47], v8 offset:2624
v_mfma_f32_16x16x32_bf16 v[104:107], a[28:31], a[232:235], v[104:107]
buffer_load_dwordx4 v6, s[32:35], s50 offen offset:2112 lds
v_mfma_f32_16x16x32_bf16 v[104:107], a[24:27], a[220:223], v[104:107]
ds_read_b64_tr_b16 a[16:17], v15 offset:33792
v_mfma_f32_16x16x32_bf16 v[100:103], a[24:27], a[216:219], v[100:103]
ds_read_b64_tr_b16 a[18:19], v15 offset:35904
v_mfma_f32_16x16x32_bf16 v[100:103], a[28:31], a[228:231], v[100:103]
s_waitcnt lgkmcnt(6)
v_mfma_f32_16x16x32_bf16 v[112:115], a[32:35], a[228:231], v[112:115]
ds_read_b64_tr_b16 a[20:21], v15 offset:38016
v_mfma_f32_16x16x32_bf16 v[112:115], a[36:39], a[216:219], v[112:115]
ds_read_b64_tr_b16 a[22:23], v15 offset:40128
v_mfma_f32_16x16x32_bf16 v[116:119], a[36:39], a[220:223], v[116:119]
buffer_load_dwordx4 v7, s[32:35], s50 offen offset:3168 lds
v_mfma_f32_16x16x32_bf16 v[116:119], a[32:35], a[232:235], v[116:119]
ds_read_b64_tr_b16 a[24:25], v15 offset:42240
v_mfma_f32_16x16x32_bf16 v[120:123], a[32:35], a[236:239], v[120:123]
ds_read_b64_tr_b16 a[26:27], v15 offset:44352
v_mfma_f32_16x16x32_bf16 v[120:123], a[36:39], a[224:227], v[120:123]
s_waitcnt lgkmcnt(6)
v_mfma_f32_16x16x32_bf16 v[120:123], a[40:43], a[212:215], v[120:123]
ds_read_b64_tr_b16 a[28:29], v15 offset:46464
v_mfma_f32_16x16x32_bf16 v[120:123], a[44:47], a[200:203], v[120:123]
ds_read_b64_tr_b16 a[30:31], v15 offset:48576
v_mfma_f32_16x16x32_bf16 v[116:119], a[44:47], a[196:199], v[116:119]
v_mfma_f32_16x16x32_bf16 v[116:119], a[40:43], a[208:211], v[116:119]
ds_read_b64_tr_b16 a[32:33], v8 offset:46464
v_mfma_f32_16x16x32_bf16 v[112:115], a[40:43], a[204:207], v[112:115]
ds_read_b64_tr_b16 a[34:35], v8 offset:48576
v_mfma_f32_16x16x32_bf16 v[112:115], a[44:47], a[192:195], v[112:115]
s_waitcnt lgkmcnt(6)
LS_98:
v_mfma_f32_16x16x32_bf16 v[76:79], a[16:19], a[48:51], v[76:79]
ds_read_b64_tr_b16 a[36:37], v8 offset:42240
v_mfma_f32_16x16x32_bf16 v[76:79], a[20:23], a[60:63], v[76:79]
ds_read_b64_tr_b16 a[38:39], v8 offset:44352
v_mfma_f32_16x16x32_bf16 v[80:83], a[20:23], a[64:67], v[80:83]
s_add_u32 m0, s17, 16896
s_add_u32 s50, s45, 114688
v_mfma_f32_16x16x32_bf16 v[80:83], a[16:19], a[52:55], v[80:83]
ds_read_b64_tr_b16 a[40:41], v8 offset:38016
v_mfma_f32_16x16x32_bf16 v[84:87], a[16:19], a[56:59], v[84:87]
ds_read_b64_tr_b16 a[42:43], v8 offset:40128
v_mfma_f32_16x16x32_bf16 v[84:87], a[20:23], a[68:71], v[84:87]
s_waitcnt lgkmcnt(6)
v_mfma_f32_16x16x32_bf16 v[84:87], a[24:27], a[80:83], v[84:87]
ds_read_b64_tr_b16 a[44:45], v8 offset:33792
v_mfma_f32_16x16x32_bf16 v[84:87], a[28:31], a[92:95], v[84:87]
ds_read_b64_tr_b16 a[46:47], v8 offset:35904
v_mfma_f32_16x16x32_bf16 v[80:83], a[28:31], a[88:91], v[80:83]
buffer_load_dwordx4 v4, s[32:35], s50 offen offset:0 lds
v_mfma_f32_16x16x32_bf16 v[80:83], a[24:27], a[76:79], v[80:83]
ds_read_b64_tr_b16 a[16:17], v15 offset:34304
v_mfma_f32_16x16x32_bf16 v[76:79], a[24:27], a[72:75], v[76:79]
ds_read_b64_tr_b16 a[18:19], v15 offset:36416
v_mfma_f32_16x16x32_bf16 v[76:79], a[28:31], a[84:87], v[76:79]
s_waitcnt lgkmcnt(6)
v_mfma_f32_16x16x32_bf16 v[88:91], a[32:35], a[84:87], v[88:91]
ds_read_b64_tr_b16 a[20:21], v15 offset:38528
v_mfma_f32_16x16x32_bf16 v[88:91], a[36:39], a[72:75], v[88:91]
ds_read_b64_tr_b16 a[22:23], v15 offset:40640
v_mfma_f32_16x16x32_bf16 v[92:95], a[36:39], a[76:79], v[92:95]
buffer_load_dwordx4 v5, s[32:35], s50 offen offset:1056 lds
v_mfma_f32_16x16x32_bf16 v[92:95], a[32:35], a[88:91], v[92:95]
ds_read_b64_tr_b16 a[24:25], v15 offset:42752
v_mfma_f32_16x16x32_bf16 v[96:99], a[32:35], a[92:95], v[96:99]
ds_read_b64_tr_b16 a[26:27], v15 offset:44864
v_mfma_f32_16x16x32_bf16 v[96:99], a[36:39], a[80:83], v[96:99]
s_waitcnt lgkmcnt(6)
v_mfma_f32_16x16x32_bf16 v[96:99], a[40:43], a[68:71], v[96:99]
ds_read_b64_tr_b16 a[28:29], v15 offset:46976
v_mfma_f32_16x16x32_bf16 v[96:99], a[44:47], a[56:59], v[96:99]
ds_read_b64_tr_b16 a[30:31], v15 offset:49088
v_mfma_f32_16x16x32_bf16 v[92:95], a[44:47], a[52:55], v[92:95]
s_waitcnt vmcnt(6)
v_mov_b32 v250, 1
buffer_store_dword v250, v157, s[80:83], 0 offen sc1
v_mfma_f32_16x16x32_bf16 v[92:95], a[40:43], a[64:67], v[92:95]
ds_read_b64_tr_b16 a[32:33], v8 offset:46976
v_mfma_f32_16x16x32_bf16 v[88:91], a[40:43], a[60:63], v[88:91]
ds_read_b64_tr_b16 a[34:35], v8 offset:49088
s_waitcnt vmcnt(35)
s_barrier
v_mfma_f32_16x16x32_bf16 v[88:91], a[44:47], a[48:51], v[88:91]
s_waitcnt lgkmcnt(6)
v_mfma_f32_16x16x32_bf16 v[100:103], a[16:19], a[48:51], v[100:103]
ds_read_b64_tr_b16 a[36:37], v8 offset:42752
v_mfma_f32_16x16x32_bf16 v[100:103], a[20:23], a[60:63], v[100:103]
ds_read_b64_tr_b16 a[38:39], v8 offset:44864
v_mfma_f32_16x16x32_bf16 v[104:107], a[20:23], a[64:67], v[104:107]
buffer_load_dwordx4 v6, s[32:35], s50 offen offset:2112 lds
v_mfma_f32_16x16x32_bf16 v[104:107], a[16:19], a[52:55], v[104:107]
ds_read_b64_tr_b16 a[40:41], v8 offset:38528
v_mfma_f32_16x16x32_bf16 v[108:111], a[16:19], a[56:59], v[108:111]
ds_read_b64_tr_b16 a[42:43], v8 offset:40640
v_mfma_f32_16x16x32_bf16 v[108:111], a[20:23], a[68:71], v[108:111]
s_waitcnt lgkmcnt(6)
v_mfma_f32_16x16x32_bf16 v[108:111], a[24:27], a[80:83], v[108:111]
ds_read_b64_tr_b16 a[44:45], v8 offset:34304
v_mfma_f32_16x16x32_bf16 v[108:111], a[28:31], a[92:95], v[108:111]
ds_read_b64_tr_b16 a[46:47], v8 offset:36416
v_mfma_f32_16x16x32_bf16 v[104:107], a[28:31], a[88:91], v[104:107]
buffer_load_dwordx4 v7, s[32:35], s50 offen offset:3168 lds
v_mfma_f32_16x16x32_bf16 v[104:107], a[24:27], a[76:79], v[104:107]
v_add_u32 v15, 50688, v15
ds_read_b64_tr_b16 a[16:17], v15 offset:0
v_mfma_f32_16x16x32_bf16 v[100:103], a[24:27], a[72:75], v[100:103]
ds_read_b64_tr_b16 a[18:19], v15 offset:2112
v_mfma_f32_16x16x32_bf16 v[100:103], a[28:31], a[84:87], v[100:103]
s_waitcnt lgkmcnt(6)
v_mfma_f32_16x16x32_bf16 v[112:115], a[32:35], a[84:87], v[112:115]
ds_read_b64_tr_b16 a[20:21], v15 offset:4224
v_mfma_f32_16x16x32_bf16 v[112:115], a[36:39], a[72:75], v[112:115]
ds_read_b64_tr_b16 a[22:23], v15 offset:6336
v_mfma_f32_16x16x32_bf16 v[116:119], a[36:39], a[76:79], v[116:119]
v_mfma_f32_16x16x32_bf16 v[116:119], a[32:35], a[88:91], v[116:119]
ds_read_b64_tr_b16 a[24:25], v15 offset:8448
v_mfma_f32_16x16x32_bf16 v[120:123], a[32:35], a[92:95], v[120:123]
ds_read_b64_tr_b16 a[26:27], v15 offset:10560
v_mfma_f32_16x16x32_bf16 v[120:123], a[36:39], a[80:83], v[120:123]
s_waitcnt lgkmcnt(6)
v_mfma_f32_16x16x32_bf16 v[120:123], a[40:43], a[68:71], v[120:123]
ds_read_b64_tr_b16 a[28:29], v15 offset:12672
v_mfma_f32_16x16x32_bf16 v[120:123], a[44:47], a[56:59], v[120:123]
ds_read_b64_tr_b16 a[30:31], v15 offset:14784
v_mfma_f32_16x16x32_bf16 v[116:119], a[44:47], a[52:55], v[116:119]
v_mfma_f32_16x16x32_bf16 v[116:119], a[40:43], a[64:67], v[116:119]
v_add_u32 v8, 50688, v8
ds_read_b64_tr_b16 a[32:33], v8 offset:12672
v_mfma_f32_16x16x32_bf16 v[112:115], a[40:43], a[60:63], v[112:115]
ds_read_b64_tr_b16 a[34:35], v8 offset:14784
v_mfma_f32_16x16x32_bf16 v[112:115], a[44:47], a[48:51], v[112:115]
s_waitcnt lgkmcnt(6)
LS_99:
v_mfma_f32_16x16x32_bf16 v[76:79], a[16:19], a[96:99], v[76:79]
ds_read_b64_tr_b16 a[36:37], v8 offset:8448
v_mfma_f32_16x16x32_bf16 v[76:79], a[20:23], a[108:111], v[76:79]
ds_read_b64_tr_b16 a[38:39], v8 offset:10560
v_mfma_f32_16x16x32_bf16 v[80:83], a[20:23], a[112:115], v[80:83]
s_add_u32 m0, s17, 0
s_add_u32 s50, s45, 229376
v_mfma_f32_16x16x32_bf16 v[80:83], a[16:19], a[100:103], v[80:83]
ds_read_b64_tr_b16 a[40:41], v8 offset:4224
v_mfma_f32_16x16x32_bf16 v[84:87], a[16:19], a[104:107], v[84:87]
ds_read_b64_tr_b16 a[42:43], v8 offset:6336
v_mfma_f32_16x16x32_bf16 v[84:87], a[20:23], a[116:119], v[84:87]
s_waitcnt lgkmcnt(6)
v_mfma_f32_16x16x32_bf16 v[84:87], a[24:27], a[128:131], v[84:87]
ds_read_b64_tr_b16 a[44:45], v8 offset:0
v_mfma_f32_16x16x32_bf16 v[84:87], a[28:31], a[140:143], v[84:87]
ds_read_b64_tr_b16 a[46:47], v8 offset:2112
v_mfma_f32_16x16x32_bf16 v[80:83], a[28:31], a[136:139], v[80:83]
buffer_load_dwordx4 v4, s[32:35], s50 offen offset:0 lds
v_mfma_f32_16x16x32_bf16 v[80:83], a[24:27], a[124:127], v[80:83]
ds_read_b64_tr_b16 a[16:17], v15 offset:512
v_mfma_f32_16x16x32_bf16 v[76:79], a[24:27], a[120:123], v[76:79]
ds_read_b64_tr_b16 a[18:19], v15 offset:2624
s_waitcnt vmcnt(11)
v_cmp_gt_u32 vcc, 8, v159
s_cbranch_vccnz SPIN_clr
RET_clr:
v_mfma_f32_16x16x32_bf16 v[76:79], a[28:31], a[132:135], v[76:79]
s_waitcnt lgkmcnt(6)
v_mfma_f32_16x16x32_bf16 v[88:91], a[32:35], a[132:135], v[88:91]
ds_read_b64_tr_b16 a[20:21], v15 offset:4736
v_mfma_f32_16x16x32_bf16 v[88:91], a[36:39], a[120:123], v[88:91]
ds_read_b64_tr_b16 a[22:23], v15 offset:6848
v_mfma_f32_16x16x32_bf16 v[92:95], a[36:39], a[124:127], v[92:95]
buffer_load_dwordx4 v5, s[32:35], s50 offen offset:1056 lds
v_mfma_f32_16x16x32_bf16 v[92:95], a[32:35], a[136:139], v[92:95]
ds_read_b64_tr_b16 a[24:25], v15 offset:8960
v_mfma_f32_16x16x32_bf16 v[96:99], a[32:35], a[140:143], v[96:99]
ds_read_b64_tr_b16 a[26:27], v15 offset:11072
v_mfma_f32_16x16x32_bf16 v[96:99], a[36:39], a[128:131], v[96:99]
s_waitcnt lgkmcnt(6)
v_mfma_f32_16x16x32_bf16 v[96:99], a[40:43], a[116:119], v[96:99]
ds_read_b64_tr_b16 a[28:29], v15 offset:13184
v_mfma_f32_16x16x32_bf16 v[96:99], a[44:47], a[104:107], v[96:99]
ds_read_b64_tr_b16 a[30:31], v15 offset:15296
v_mfma_f32_16x16x32_bf16 v[92:95], a[44:47], a[100:103], v[92:95]
s_waitcnt vmcnt(34)
s_barrier
v_mfma_f32_16x16x32_bf16 v[92:95], a[40:43], a[112:115], v[92:95]
ds_read_b64_tr_b16 a[32:33], v8 offset:13184
v_mfma_f32_16x16x32_bf16 v[88:91], a[40:43], a[108:111], v[88:91]
ds_read_b64_tr_b16 a[34:35], v8 offset:15296
v_cvt_pk_bf16_f32 v132, v84, v85
v_mfma_f32_16x16x32_bf16 v[88:91], a[44:47], a[96:99], v[88:91]
s_waitcnt lgkmcnt(6)
v_cvt_pk_bf16_f32 v133, v86, v87
v_mfma_f32_16x16x32_bf16 v[100:103], a[16:19], a[96:99], v[100:103]
ds_read_b64_tr_b16 a[36:37], v8 offset:8960
v_cvt_pk_bf16_f32 v134, v96, v97
v_mfma_f32_16x16x32_bf16 v[100:103], a[20:23], a[108:111], v[100:103]
ds_read_b64_tr_b16 a[38:39], v8 offset:11072
v_cvt_pk_bf16_f32 v135, v98, v99
v_mfma_f32_16x16x32_bf16 v[104:107], a[20:23], a[112:115], v[104:107]
buffer_load_dwordx4 v6, s[32:35], s50 offen offset:2112 lds
v_mfma_f32_16x16x32_bf16 v[104:107], a[16:19], a[100:103], v[104:107]
ds_read_b64_tr_b16 a[40:41], v8 offset:4736
v_cvt_pk_bf16_f32 v128, v80, v81
v_mfma_f32_16x16x32_bf16 v[108:111], a[16:19], a[104:107], v[108:111]
ds_read_b64_tr_b16 a[42:43], v8 offset:6848
v_cvt_pk_bf16_f32 v129, v82, v83
v_mfma_f32_16x16x32_bf16 v[108:111], a[20:23], a[116:119], v[108:111]
s_waitcnt lgkmcnt(6)
v_cvt_pk_bf16_f32 v130, v92, v93
v_mfma_f32_16x16x32_bf16 v[108:111], a[24:27], a[128:131], v[108:111]
ds_read_b64_tr_b16 a[44:45], v8 offset:512
v_cvt_pk_bf16_f32 v131, v94, v95
v_mfma_f32_16x16x32_bf16 v[108:111], a[28:31], a[140:143], v[108:111]
ds_read_b64_tr_b16 a[46:47], v8 offset:2624
v_cvt_pk_bf16_f32 v124, v76, v77
v_mfma_f32_16x16x32_bf16 v[104:107], a[28:31], a[136:139], v[104:107]
buffer_load_dwordx4 v7, s[32:35], s50 offen offset:3168 lds
v_mfma_f32_16x16x32_bf16 v[104:107], a[24:27], a[124:127], v[104:107]
ds_read_b64_tr_b16 a[16:17], v15 offset:16896
v_cvt_pk_bf16_f32 v125, v78, v79
v_mfma_f32_16x16x32_bf16 v[100:103], a[24:27], a[120:123], v[100:103]
ds_read_b64_tr_b16 a[18:19], v15 offset:19008
v_cvt_pk_bf16_f32 v126, v88, v89
v_mfma_f32_16x16x32_bf16 v[100:103], a[28:31], a[132:135], v[100:103]
s_waitcnt lgkmcnt(6)
v_cvt_pk_bf16_f32 v127, v90, v91
v_mfma_f32_16x16x32_bf16 v[112:115], a[32:35], a[132:135], v[112:115]
ds_read_b64_tr_b16 a[20:21], v15 offset:21120
v_mfma_f32_16x16x32_bf16 v[112:115], a[36:39], a[120:123], v[112:115]
ds_read_b64_tr_b16 a[22:23], v15 offset:23232
v_mfma_f32_16x16x32_bf16 v[116:119], a[36:39], a[124:127], v[116:119]
s_mov_b32 s51, 6144
buffer_store_dwordx4 v[124:127], v252, s[40:43], s51 offen sc1
v_mfma_f32_16x16x32_bf16 v[116:119], a[32:35], a[136:139], v[116:119]
ds_read_b64_tr_b16 a[24:25], v15 offset:25344
v_mfma_f32_16x16x32_bf16 v[120:123], a[32:35], a[140:143], v[120:123]
ds_read_b64_tr_b16 a[26:27], v15 offset:27456
v_mfma_f32_16x16x32_bf16 v[120:123], a[36:39], a[128:131], v[120:123]
s_waitcnt lgkmcnt(6)
v_mfma_f32_16x16x32_bf16 v[120:123], a[40:43], a[116:119], v[120:123]
ds_read_b64_tr_b16 a[28:29], v15 offset:29568
v_mfma_f32_16x16x32_bf16 v[120:123], a[44:47], a[104:107], v[120:123]
ds_read_b64_tr_b16 a[30:31], v15 offset:31680
v_mfma_f32_16x16x32_bf16 v[116:119], a[44:47], a[100:103], v[116:119]
s_mov_b32 s51, 7168
buffer_store_dwordx4 v[128:131], v252, s[40:43], s51 offen sc1
v_mfma_f32_16x16x32_bf16 v[116:119], a[40:43], a[112:115], v[116:119]
ds_read_b64_tr_b16 a[32:33], v8 offset:29568
v_mfma_f32_16x16x32_bf16 v[112:115], a[40:43], a[108:111], v[112:115]
ds_read_b64_tr_b16 a[34:35], v8 offset:31680
v_cvt_pk_bf16_f32 v144, v108, v109
v_mfma_f32_16x16x32_bf16 v[112:115], a[44:47], a[96:99], v[112:115]
s_waitcnt lgkmcnt(6)
v_cvt_pk_bf16_f32 v145, v110, v111
LS_100:
v_mfma_f32_16x16x32_bf16 v[16:19], a[16:19], a[144:147], 0
ds_read_b64_tr_b16 a[36:37], v8 offset:25344
v_cvt_pk_bf16_f32 v146, v120, v121
v_mfma_f32_16x16x32_bf16 v[16:19], a[20:23], a[156:159], v[16:19]
ds_read_b64_tr_b16 a[38:39], v8 offset:27456
v_cvt_pk_bf16_f32 v147, v122, v123
v_mfma_f32_16x16x32_bf16 v[20:23], a[20:23], a[160:163], 0
s_add_u32 m0, s17, 33792
s_add_u32 s50, s45, 344064
v_mfma_f32_16x16x32_bf16 v[20:23], a[16:19], a[148:151], v[20:23]
ds_read_b64_tr_b16 a[40:41], v8 offset:21120
v_cvt_pk_bf16_f32 v140, v104, v105
v_mfma_f32_16x16x32_bf16 v[24:27], a[16:19], a[152:155], 0
ds_read_b64_tr_b16 a[42:43], v8 offset:23232
v_cvt_pk_bf16_f32 v141, v106, v107
v_mfma_f32_16x16x32_bf16 v[24:27], a[20:23], a[164:167], v[24:27]
s_waitcnt lgkmcnt(6)
v_cvt_pk_bf16_f32 v142, v116, v117
v_mfma_f32_16x16x32_bf16 v[24:27], a[24:27], a[176:179], v[24:27]
ds_read_b64_tr_b16 a[44:45], v8 offset:16896
v_cvt_pk_bf16_f32 v143, v118, v119
v_mfma_f32_16x16x32_bf16 v[24:27], a[28:31], a[188:191], v[24:27]
ds_read_b64_tr_b16 a[46:47], v8 offset:19008
v_cvt_pk_bf16_f32 v136, v100, v101
v_mfma_f32_16x16x32_bf16 v[20:23], a[28:31], a[184:187], v[20:23]
buffer_load_dwordx4 v4, s[32:35], s50 offen offset:0 lds
v_mfma_f32_16x16x32_bf16 v[20:23], a[24:27], a[172:175], v[20:23]
ds_read_b64_tr_b16 a[16:17], v15 offset:17408
v_cvt_pk_bf16_f32 v137, v102, v103
v_mfma_f32_16x16x32_bf16 v[16:19], a[24:27], a[168:171], v[16:19]
ds_read_b64_tr_b16 a[18:19], v15 offset:19520
v_cvt_pk_bf16_f32 v138, v112, v113
v_mfma_f32_16x16x32_bf16 v[16:19], a[28:31], a[180:183], v[16:19]
s_waitcnt lgkmcnt(6)
v_cvt_pk_bf16_f32 v139, v114, v115
v_mfma_f32_16x16x32_bf16 v[28:31], a[32:35], a[180:183], 0
ds_read_b64_tr_b16 a[20:21], v15 offset:21632
s_lshl_b32 s56, s49, 2
v_mfma_f32_16x16x32_bf16 v[28:31], a[36:39], a[168:171], v[28:31]
ds_read_b64_tr_b16 a[22:23], v15 offset:23744
v_and_b32 v251, 28, v158
v_mfma_f32_16x16x32_bf16 v[32:35], a[36:39], a[172:175], 0
buffer_load_dwordx4 v5, s[32:35], s50 offen offset:1056 lds
v_mfma_f32_16x16x32_bf16 v[32:35], a[32:35], a[184:187], v[32:35]
ds_read_b64_tr_b16 a[24:25], v15 offset:25856
v_cmp_eq_u32 s[4:5], s56, v251
v_mfma_f32_16x16x32_bf16 v[36:39], a[32:35], a[188:191], 0
ds_read_b64_tr_b16 a[26:27], v15 offset:27968
v_mov_b32 v251, 7
v_mfma_f32_16x16x32_bf16 v[36:39], a[36:39], a[176:179], v[36:39]
s_waitcnt lgkmcnt(6)
s_nop 0
v_mfma_f32_16x16x32_bf16 v[36:39], a[40:43], a[164:167], v[36:39]
ds_read_b64_tr_b16 a[28:29], v15 offset:30080
v_cndmask_b32 v251, 0, v251, s[4:5]
v_mfma_f32_16x16x32_bf16 v[36:39], a[44:47], a[152:155], v[36:39]
ds_read_b64_tr_b16 a[30:31], v15 offset:32192
v_mfma_f32_16x16x32_bf16 v[32:35], a[44:47], a[148:151], v[32:35]
s_waitcnt vmcnt(33)
s_barrier
v_mfma_f32_16x16x32_bf16 v[32:35], a[40:43], a[160:163], v[32:35]
ds_read_b64_tr_b16 a[32:33], v8 offset:30080
v_mfma_f32_16x16x32_bf16 v[28:31], a[40:43], a[156:159], v[28:31]
ds_read_b64_tr_b16 a[34:35], v8 offset:32192
v_mfma_f32_16x16x32_bf16 v[28:31], a[44:47], a[144:147], v[28:31]
s_waitcnt lgkmcnt(6)
buffer_load_dword v159, v158, s[80:83], 0 offen sc1
v_mfma_f32_16x16x32_bf16 v[40:43], a[16:19], a[144:147], 0
ds_read_b64_tr_b16 a[36:37], v8 offset:25856
v_mfma_f32_16x16x32_bf16 v[40:43], a[20:23], a[156:159], v[40:43]
ds_read_b64_tr_b16 a[38:39], v8 offset:27968
v_mfma_f32_16x16x32_bf16 v[44:47], a[20:23], a[160:163], 0
buffer_load_dwordx4 v6, s[32:35], s50 offen offset:2112 lds
v_mfma_f32_16x16x32_bf16 v[44:47], a[16:19], a[148:151], v[44:47]
ds_read_b64_tr_b16 a[40:41], v8 offset:21632
v_mfma_f32_16x16x32_bf16 v[48:51], a[16:19], a[152:155], 0
ds_read_b64_tr_b16 a[42:43], v8 offset:23744
v_mfma_f32_16x16x32_bf16 v[48:51], a[20:23], a[164:167], v[48:51]
s_waitcnt lgkmcnt(6)
v_mfma_f32_16x16x32_bf16 v[48:51], a[24:27], a[176:179], v[48:51]
ds_read_b64_tr_b16 a[44:45], v8 offset:17408
v_mfma_f32_16x16x32_bf16 v[48:51], a[28:31], a[188:191], v[48:51]
ds_read_b64_tr_b16 a[46:47], v8 offset:19520
v_mfma_f32_16x16x32_bf16 v[44:47], a[28:31], a[184:187], v[44:47]
buffer_load_dwordx4 v7, s[32:35], s50 offen offset:3168 lds
v_mfma_f32_16x16x32_bf16 v[44:47], a[24:27], a[172:175], v[44:47]
v_add_u32 v15, 50688, v15
ds_read_b64_tr_b16 a[16:17], v15 offset:33792
v_mfma_f32_16x16x32_bf16 v[40:43], a[24:27], a[168:171], v[40:43]
ds_read_b64_tr_b16 a[18:19], v15 offset:35904
v_mfma_f32_16x16x32_bf16 v[40:43], a[28:31], a[180:183], v[40:43]
s_waitcnt lgkmcnt(6)
v_mfma_f32_16x16x32_bf16 v[52:55], a[32:35], a[180:183], 0
ds_read_b64_tr_b16 a[20:21], v15 offset:38016
v_mfma_f32_16x16x32_bf16 v[52:55], a[36:39], a[168:171], v[52:55]
ds_read_b64_tr_b16 a[22:23], v15 offset:40128
v_mfma_f32_16x16x32_bf16 v[56:59], a[36:39], a[172:175], 0
s_mov_b32 s51, 8192
buffer_store_dwordx4 v[132:135], v252, s[40:43], s51 offen sc1
v_mfma_f32_16x16x32_bf16 v[56:59], a[32:35], a[184:187], v[56:59]
ds_read_b64_tr_b16 a[24:25], v15 offset:42240
v_mfma_f32_16x16x32_bf16 v[60:63], a[32:35], a[188:191], 0
ds_read_b64_tr_b16 a[26:27], v15 offset:44352
v_mfma_f32_16x16x32_bf16 v[60:63], a[36:39], a[176:179], v[60:63]
s_waitcnt lgkmcnt(6)
v_mfma_f32_16x16x32_bf16 v[60:63], a[40:43], a[164:167], v[60:63]
ds_read_b64_tr_b16 a[28:29], v15 offset:46464
v_mfma_f32_16x16x32_bf16 v[60:63], a[44:47], a[152:155], v[60:63]
ds_read_b64_tr_b16 a[30:31], v15 offset:48576
v_mfma_f32_16x16x32_bf16 v[56:59], a[44:47], a[148:151], v[56:59]
s_mov_b32 s51, 9216
buffer_store_dwordx4 v[136:139], v252, s[40:43], s51 offen sc1
v_mfma_f32_16x16x32_bf16 v[56:59], a[40:43], a[160:163], v[56:59]
v_add_u32 v8, 50688, v8
ds_read_b64_tr_b16 a[32:33], v8 offset:46464
v_mfma_f32_16x16x32_bf16 v[52:55], a[40:43], a[156:159], v[52:55]
ds_read_b64_tr_b16 a[34:35], v8 offset:48576
v_mfma_f32_16x16x32_bf16 v[52:55], a[44:47], a[144:147], v[52:55]
s_waitcnt lgkmcnt(6)
LS_101:
v_mfma_f32_16x16x32_bf16 v[16:19], a[16:19], a[192:195], v[16:19]
ds_read_b64_tr_b16 a[36:37], v8 offset:42240
v_mfma_f32_16x16x32_bf16 v[16:19], a[20:23], a[204:207], v[16:19]
ds_read_b64_tr_b16 a[38:39], v8 offset:44352
v_mfma_f32_16x16x32_bf16 v[20:23], a[20:23], a[208:211], v[20:23]
s_mov_b32 s51, 10240
buffer_store_dwordx4 v[140:143], v252, s[40:43], s51 offen sc1
v_mfma_f32_16x16x32_bf16 v[20:23], a[16:19], a[196:199], v[20:23]
ds_read_b64_tr_b16 a[40:41], v8 offset:38016
v_mfma_f32_16x16x32_bf16 v[24:27], a[16:19], a[200:203], v[24:27]
ds_read_b64_tr_b16 a[42:43], v8 offset:40128
v_mfma_f32_16x16x32_bf16 v[24:27], a[20:23], a[212:215], v[24:27]
s_waitcnt lgkmcnt(6)
s_mov_b32 s51, 11264
buffer_store_dwordx4 v[144:147], v252, s[40:43], s51 offen sc1
v_mfma_f32_16x16x32_bf16 v[24:27], a[24:27], a[224:227], v[24:27]
ds_read_b64_tr_b16 a[44:45], v8 offset:33792
v_mfma_f32_16x16x32_bf16 v[24:27], a[28:31], a[236:239], v[24:27]
ds_read_b64_tr_b16 a[46:47], v8 offset:35904
v_mfma_f32_16x16x32_bf16 v[20:23], a[28:31], a[232:235], v[20:23]
s_add_u32 m0, s17, 50688
s_add_u32 s50, s46, 0
v_mfma_f32_16x16x32_bf16 v[20:23], a[24:27], a[220:223], v[20:23]
ds_read_b64_tr_b16 a[16:17], v15 offset:34304
v_mfma_f32_16x16x32_bf16 v[16:19], a[24:27], a[216:219], v[16:19]
ds_read_b64_tr_b16 a[18:19], v15 offset:36416
v_mfma_f32_16x16x32_bf16 v[16:19], a[28:31], a[228:231], v[16:19]
s_waitcnt lgkmcnt(6)
v_mfma_f32_16x16x32_bf16 v[28:31], a[32:35], a[228:231], v[28:31]
ds_read_b64_tr_b16 a[20:21], v15 offset:38528
v_mfma_f32_16x16x32_bf16 v[28:31], a[36:39], a[216:219], v[28:31]
ds_read_b64_tr_b16 a[22:23], v15 offset:40640
v_mfma_f32_16x16x32_bf16 v[32:35], a[36:39], a[220:223], v[32:35]
buffer_load_dwordx4 v4, s[32:35], s50 offen offset:0 lds
v_mfma_f32_16x16x32_bf16 v[32:35], a[32:35], a[232:235], v[32:35]
ds_read_b64_tr_b16 a[24:25], v15 offset:42752
v_mfma_f32_16x16x32_bf16 v[36:39], a[32:35], a[236:239], v[36:39]
ds_read_b64_tr_b16 a[26:27], v15 offset:44864
v_mfma_f32_16x16x32_bf16 v[36:39], a[36:39], a[224:227], v[36:39]
s_waitcnt lgkmcnt(6)
v_mfma_f32_16x16x32_bf16 v[36:39], a[40:43], a[212:215], v[36:39]
ds_read_b64_tr_b16 a[28:29], v15 offset:46976
v_mfma_f32_16x16x32_bf16 v[36:39], a[44:47], a[200:203], v[36:39]
ds_read_b64_tr_b16 a[30:31], v15 offset:49088
v_mfma_f32_16x16x32_bf16 v[32:35], a[44:47], a[196:199], v[32:35]
s_waitcnt vmcnt(36)
s_barrier
v_mfma_f32_16x16x32_bf16 v[32:35], a[40:43], a[208:211], v[32:35]
ds_read_b64_tr_b16 a[32:33], v8 offset:46976
v_mfma_f32_16x16x32_bf16 v[28:31], a[40:43], a[204:207], v[28:31]
ds_read_b64_tr_b16 a[34:35], v8 offset:49088
v_mfma_f32_16x16x32_bf16 v[28:31], a[44:47], a[192:195], v[28:31]
s_waitcnt lgkmcnt(6)
v_mfma_f32_16x16x32_bf16 v[40:43], a[16:19], a[192:195], v[40:43]
ds_read_b64_tr_b16 a[36:37], v8 offset:42752
v_mfma_f32_16x16x32_bf16 v[40:43], a[20:23], a[204:207], v[40:43]
ds_read_b64_tr_b16 a[38:39], v8 offset:44864
v_mfma_f32_16x16x32_bf16 v[44:47], a[20:23], a[208:211], v[44:47]
buffer_load_dwordx4 v5, s[32:35], s50 offen offset:1056 lds
v_mfma_f32_16x16x32_bf16 v[44:47], a[16:19], a[196:199], v[44:47]
ds_read_b64_tr_b16 a[40:41], v8 offset:38528
v_mfma_f32_16x16x32_bf16 v[48:51], a[16:19], a[200:203], v[48:51]
ds_read_b64_tr_b16 a[42:43], v8 offset:40640
v_mfma_f32_16x16x32_bf16 v[48:51], a[20:23], a[212:215], v[48:51]
s_waitcnt lgkmcnt(6)
v_mfma_f32_16x16x32_bf16 v[48:51], a[24:27], a[224:227], v[48:51]
ds_read_b64_tr_b16 a[44:45], v8 offset:34304
v_mfma_f32_16x16x32_bf16 v[48:51], a[28:31], a[236:239], v[48:51]
ds_read_b64_tr_b16 a[46:47], v8 offset:36416
v_mfma_f32_16x16x32_bf16 v[44:47], a[28:31], a[232:235], v[44:47]
buffer_load_dwordx4 v6, s[32:35], s50 offen offset:2112 lds
v_mfma_f32_16x16x32_bf16 v[44:47], a[24:27], a[220:223], v[44:47]
ds_read_b64_tr_b16 a[16:17], v15 offset:16896
v_mfma_f32_16x16x32_bf16 v[40:43], a[24:27], a[216:219], v[40:43]
ds_read_b64_tr_b16 a[18:19], v15 offset:19008
v_mfma_f32_16x16x32_bf16 v[40:43], a[28:31], a[228:231], v[40:43]
s_waitcnt lgkmcnt(6)
v_mfma_f32_16x16x32_bf16 v[52:55], a[32:35], a[228:231], v[52:55]
ds_read_b64_tr_b16 a[20:21], v15 offset:21120
v_mfma_f32_16x16x32_bf16 v[52:55], a[36:39], a[216:219], v[52:55]
ds_read_b64_tr_b16 a[22:23], v15 offset:23232
v_mfma_f32_16x16x32_bf16 v[56:59], a[36:39], a[220:223], v[56:59]
buffer_load_dwordx4 v7, s[32:35], s50 offen offset:3168 lds
v_mfma_f32_16x16x32_bf16 v[56:59], a[32:35], a[232:235], v[56:59]
ds_read_b64_tr_b16 a[24:25], v15 offset:25344
v_mfma_f32_16x16x32_bf16 v[60:63], a[32:35], a[236:239], v[60:63]
ds_read_b64_tr_b16 a[26:27], v15 offset:27456
v_mfma_f32_16x16x32_bf16 v[60:63], a[36:39], a[224:227], v[60:63]
s_waitcnt lgkmcnt(6)
v_mfma_f32_16x16x32_bf16 v[60:63], a[40:43], a[212:215], v[60:63]
ds_read_b64_tr_b16 a[28:29], v15 offset:29568
v_mfma_f32_16x16x32_bf16 v[60:63], a[44:47], a[200:203], v[60:63]
ds_read_b64_tr_b16 a[30:31], v15 offset:31680
v_mfma_f32_16x16x32_bf16 v[56:59], a[44:47], a[196:199], v[56:59]
v_mfma_f32_16x16x32_bf16 v[56:59], a[40:43], a[208:211], v[56:59]
ds_read_b64_tr_b16 a[32:33], v8 offset:29568
v_mfma_f32_16x16x32_bf16 v[52:55], a[40:43], a[204:207], v[52:55]
ds_read_b64_tr_b16 a[34:35], v8 offset:31680
v_mfma_f32_16x16x32_bf16 v[52:55], a[44:47], a[192:195], v[52:55]
s_waitcnt lgkmcnt(6)
LS_102:
v_mfma_f32_16x16x32_bf16 v[16:19], a[16:19], a[48:51], v[16:19]
ds_read_b64_tr_b16 a[36:37], v8 offset:25344
v_mfma_f32_16x16x32_bf16 v[16:19], a[20:23], a[60:63], v[16:19]
ds_read_b64_tr_b16 a[38:39], v8 offset:27456
v_mfma_f32_16x16x32_bf16 v[20:23], a[20:23], a[64:67], v[20:23]
s_add_u32 m0, s17, 67584
s_add_u32 s50, s46, 114688
v_mfma_f32_16x16x32_bf16 v[20:23], a[16:19], a[52:55], v[20:23]
ds_read_b64_tr_b16 a[40:41], v8 offset:21120
v_mfma_f32_16x16x32_bf16 v[24:27], a[16:19], a[56:59], v[24:27]
ds_read_b64_tr_b16 a[42:43], v8 offset:23232
v_mfma_f32_16x16x32_bf16 v[24:27], a[20:23], a[68:71], v[24:27]
s_waitcnt lgkmcnt(6)
v_mfma_f32_16x16x32_bf16 v[24:27], a[24:27], a[80:83], v[24:27]
ds_read_b64_tr_b16 a[44:45], v8 offset:16896
v_mfma_f32_16x16x32_bf16 v[24:27], a[28:31], a[92:95], v[24:27]
ds_read_b64_tr_b16 a[46:47], v8 offset:19008
v_mfma_f32_16x16x32_bf16 v[20:23], a[28:31], a[88:91], v[20:23]
buffer_load_dwordx4 v4, s[32:35], s50 offen offset:0 lds
v_mfma_f32_16x16x32_bf16 v[20:23], a[24:27], a[76:79], v[20:23]
ds_read_b64_tr_b16 a[16:17], v15 offset:17408
v_mfma_f32_16x16x32_bf16 v[16:19], a[24:27], a[72:75], v[16:19]
ds_read_b64_tr_b16 a[18:19], v15 offset:19520
v_mfma_f32_16x16x32_bf16 v[16:19], a[28:31], a[84:87], v[16:19]
s_waitcnt lgkmcnt(6)
v_mfma_f32_16x16x32_bf16 v[28:31], a[32:35], a[84:87], v[28:31]
ds_read_b64_tr_b16 a[20:21], v15 offset:21632
v_mfma_f32_16x16x32_bf16 v[28:31], a[36:39], a[72:75], v[28:31]
ds_read_b64_tr_b16 a[22:23], v15 offset:23744
v_mfma_f32_16x16x32_bf16 v[32:35], a[36:39], a[76:79], v[32:35]
buffer_load_dwordx4 v5, s[32:35], s50 offen offset:1056 lds
v_mfma_f32_16x16x32_bf16 v[32:35], a[32:35], a[88:91], v[32:35]
ds_read_b64_tr_b16 a[24:25], v15 offset:25856
v_mfma_f32_16x16x32_bf16 v[36:39], a[32:35], a[92:95], v[36:39]
ds_read_b64_tr_b16 a[26:27], v15 offset:27968
v_mfma_f32_16x16x32_bf16 v[36:39], a[36:39], a[80:83], v[36:39]
s_waitcnt lgkmcnt(6)
v_mfma_f32_16x16x32_bf16 v[36:39], a[40:43], a[68:71], v[36:39]
ds_read_b64_tr_b16 a[28:29], v15 offset:30080
v_mfma_f32_16x16x32_bf16 v[36:39], a[44:47], a[56:59], v[36:39]
ds_read_b64_tr_b16 a[30:31], v15 offset:32192
v_mfma_f32_16x16x32_bf16 v[32:35], a[44:47], a[52:55], v[32:35]
s_waitcnt vmcnt(6)
v_mov_b32 v250, 2
buffer_store_dword v250, v157, s[80:83], 0 offen sc1
v_mfma_f32_16x16x32_bf16 v[32:35], a[40:43], a[64:67], v[32:35]
ds_read_b64_tr_b16 a[32:33], v8 offset:30080
v_mfma_f32_16x16x32_bf16 v[28:31], a[40:43], a[60:63], v[28:31]
ds_read_b64_tr_b16 a[34:35], v8 offset:32192
s_waitcnt vmcnt(38)
s_barrier
v_mfma_f32_16x16x32_bf16 v[28:31], a[44:47], a[48:51], v[28:31]
s_waitcnt lgkmcnt(6)
v_mfma_f32_16x16x32_bf16 v[40:43], a[16:19], a[48:51], v[40:43]
ds_read_b64_tr_b16 a[36:37], v8 offset:25856
v_mfma_f32_16x16x32_bf16 v[40:43], a[20:23], a[60:63], v[40:43]
ds_read_b64_tr_b16 a[38:39], v8 offset:27968
v_mfma_f32_16x16x32_bf16 v[44:47], a[20:23], a[64:67], v[44:47]
buffer_load_dwordx4 v6, s[32:35], s50 offen offset:2112 lds
v_mfma_f32_16x16x32_bf16 v[44:47], a[16:19], a[52:55], v[44:47]
ds_read_b64_tr_b16 a[40:41], v8 offset:21632
v_mfma_f32_16x16x32_bf16 v[48:51], a[16:19], a[56:59], v[48:51]
ds_read_b64_tr_b16 a[42:43], v8 offset:23744
v_mfma_f32_16x16x32_bf16 v[48:51], a[20:23], a[68:71], v[48:51]
s_waitcnt lgkmcnt(6)
v_mfma_f32_16x16x32_bf16 v[48:51], a[24:27], a[80:83], v[48:51]
ds_read_b64_tr_b16 a[44:45], v8 offset:17408
v_mfma_f32_16x16x32_bf16 v[48:51], a[28:31], a[92:95], v[48:51]
ds_read_b64_tr_b16 a[46:47], v8 offset:19520
v_mfma_f32_16x16x32_bf16 v[44:47], a[28:31], a[88:91], v[44:47]
buffer_load_dwordx4 v7, s[32:35], s50 offen offset:3168 lds
v_mfma_f32_16x16x32_bf16 v[44:47], a[24:27], a[76:79], v[44:47]
v_subrev_u32 v15, 50688, v15
ds_read_b64_tr_b16 a[16:17], v15 offset:33792
v_mfma_f32_16x16x32_bf16 v[40:43], a[24:27], a[72:75], v[40:43]
ds_read_b64_tr_b16 a[18:19], v15 offset:35904
v_mfma_f32_16x16x32_bf16 v[40:43], a[28:31], a[84:87], v[40:43]
s_waitcnt lgkmcnt(6)
s_waitcnt vmcnt(15)
v_cmp_gt_u32 vcc, 1, v159
s_cbranch_vccnz SPIN_s0
RET_s0:
v_mfma_f32_16x16x32_bf16 v[52:55], a[32:35], a[84:87], v[52:55]
ds_read_b64_tr_b16 a[20:21], v15 offset:38016
v_mfma_f32_16x16x32_bf16 v[52:55], a[36:39], a[72:75], v[52:55]
ds_read_b64_tr_b16 a[22:23], v15 offset:40128
v_mfma_f32_16x16x32_bf16 v[56:59], a[36:39], a[76:79], v[56:59]
buffer_load_dwordx4 v[184:187], v252, s[76:79], s18 offen sc1
s_add_u32 s18, s18, 172032
v_mfma_f32_16x16x32_bf16 v[56:59], a[32:35], a[88:91], v[56:59]
ds_read_b64_tr_b16 a[24:25], v15 offset:42240
v_mfma_f32_16x16x32_bf16 v[60:63], a[32:35], a[92:95], v[60:63]
ds_read_b64_tr_b16 a[26:27], v15 offset:44352
v_mfma_f32_16x16x32_bf16 v[60:63], a[36:39], a[80:83], v[60:63]
s_waitcnt lgkmcnt(6)
v_mfma_f32_16x16x32_bf16 v[60:63], a[40:43], a[68:71], v[60:63]
ds_read_b64_tr_b16 a[28:29], v15 offset:46464
v_mfma_f32_16x16x32_bf16 v[60:63], a[44:47], a[56:59], v[60:63]
ds_read_b64_tr_b16 a[30:31], v15 offset:48576
v_mfma_f32_16x16x32_bf16 v[56:59], a[44:47], a[52:55], v[56:59]
buffer_load_dwordx4 v[188:191], v252, s[76:79], s18 offen sc1
s_add_u32 s18, s18, 172032
v_mfma_f32_16x16x32_bf16 v[56:59], a[40:43], a[64:67], v[56:59]
v_subrev_u32 v8, 50688, v8
ds_read_b64_tr_b16 a[32:33], v8 offset:46464
v_mfma_f32_16x16x32_bf16 v[52:55], a[40:43], a[60:63], v[52:55]
ds_read_b64_tr_b16 a[34:35], v8 offset:48576
v_mfma_f32_16x16x32_bf16 v[52:55], a[44:47], a[48:51], v[52:55]
s_waitcnt lgkmcnt(6)
LS_103:
v_mfma_f32_16x16x32_bf16 v[16:19], a[16:19], a[96:99], v[16:19]
ds_read_b64_tr_b16 a[36:37], v8 offset:42240
v_mfma_f32_16x16x32_bf16 v[16:19], a[20:23], a[108:111], v[16:19]
ds_read_b64_tr_b16 a[38:39], v8 offset:44352
v_mfma_f32_16x16x32_bf16 v[20:23], a[20:23], a[112:115], v[20:23]
buffer_load_dwordx4 v[192:195], v252, s[76:79], s18 offen sc1
s_add_u32 s18, s18, 172032
v_mfma_f32_16x16x32_bf16 v[20:23], a[16:19], a[100:103], v[20:23]
ds_read_b64_tr_b16 a[40:41], v8 offset:38016
v_mfma_f32_16x16x32_bf16 v[24:27], a[16:19], a[104:107], v[24:27]
ds_read_b64_tr_b16 a[42:43], v8 offset:40128
v_mfma_f32_16x16x32_bf16 v[24:27], a[20:23], a[116:119], v[24:27]
s_waitcnt lgkmcnt(6)
v_mfma_f32_16x16x32_bf16 v[24:27], a[24:27], a[128:131], v[24:27]
ds_read_b64_tr_b16 a[44:45], v8 offset:33792
v_mfma_f32_16x16x32_bf16 v[24:27], a[28:31], a[140:143], v[24:27]
ds_read_b64_tr_b16 a[46:47], v8 offset:35904
v_mfma_f32_16x16x32_bf16 v[20:23], a[28:31], a[136:139], v[20:23]
buffer_load_dwordx4 v[196:199], v252, s[76:79], s18 offen sc1
s_add_u32 s18, s18, 172032
v_mfma_f32_16x16x32_bf16 v[20:23], a[24:27], a[124:127], v[20:23]
ds_read_b64_tr_b16 a[16:17], v15 offset:34304
v_mfma_f32_16x16x32_bf16 v[16:19], a[24:27], a[120:123], v[16:19]
ds_read_b64_tr_b16 a[18:19], v15 offset:36416
v_mfma_f32_16x16x32_bf16 v[16:19], a[28:31], a[132:135], v[16:19]
s_waitcnt lgkmcnt(6)
v_mfma_f32_16x16x32_bf16 v[28:31], a[32:35], a[132:135], v[28:31]
ds_read_b64_tr_b16 a[20:21], v15 offset:38528
v_mfma_f32_16x16x32_bf16 v[28:31], a[36:39], a[120:123], v[28:31]
ds_read_b64_tr_b16 a[22:23], v15 offset:40640
v_mfma_f32_16x16x32_bf16 v[32:35], a[36:39], a[124:127], v[32:35]
buffer_load_dwordx4 v[200:203], v252, s[76:79], s18 offen sc1
s_add_u32 s18, s18, 172032
v_mfma_f32_16x16x32_bf16 v[32:35], a[32:35], a[136:139], v[32:35]
ds_read_b64_tr_b16 a[24:25], v15 offset:42752
v_mfma_f32_16x16x32_bf16 v[36:39], a[32:35], a[140:143], v[36:39]
ds_read_b64_tr_b16 a[26:27], v15 offset:44864
v_mfma_f32_16x16x32_bf16 v[36:39], a[36:39], a[128:131], v[36:39]
s_waitcnt lgkmcnt(6)
v_mfma_f32_16x16x32_bf16 v[36:39], a[40:43], a[116:119], v[36:39]
ds_read_b64_tr_b16 a[28:29], v15 offset:46976
v_mfma_f32_16x16x32_bf16 v[36:39], a[44:47], a[104:107], v[36:39]
ds_read_b64_tr_b16 a[30:31], v15 offset:49088
v_mfma_f32_16x16x32_bf16 v[32:35], a[44:47], a[100:103], v[32:35]
s_waitcnt vmcnt(34)
s_barrier
v_mfma_f32_16x16x32_bf16 v[32:35], a[40:43], a[112:115], v[32:35]
ds_read_b64_tr_b16 a[32:33], v8 offset:46976
v_mfma_f32_16x16x32_bf16 v[28:31], a[40:43], a[108:111], v[28:31]
ds_read_b64_tr_b16 a[34:35], v8 offset:49088
v_cvt_pk_bf16_f32 v132, v24, v25
v_mfma_f32_16x16x32_bf16 v[28:31], a[44:47], a[96:99], v[28:31]
s_waitcnt lgkmcnt(6)
v_cvt_pk_bf16_f32 v133, v26, v27
v_mfma_f32_16x16x32_bf16 v[40:43], a[16:19], a[96:99], v[40:43]
ds_read_b64_tr_b16 a[36:37], v8 offset:42752
v_cvt_pk_bf16_f32 v134, v36, v37
v_mfma_f32_16x16x32_bf16 v[40:43], a[20:23], a[108:111], v[40:43]
ds_read_b64_tr_b16 a[38:39], v8 offset:44864
v_cvt_pk_bf16_f32 v135, v38, v39
v_mfma_f32_16x16x32_bf16 v[44:47], a[20:23], a[112:115], v[44:47]
buffer_load_dwordx4 v[204:207], v252, s[76:79], s18 offen sc1
s_add_u32 s18, s18, 172032
v_mfma_f32_16x16x32_bf16 v[44:47], a[16:19], a[100:103], v[44:47]
ds_read_b64_tr_b16 a[40:41], v8 offset:38528
v_cvt_pk_bf16_f32 v128, v20, v21
v_mfma_f32_16x16x32_bf16 v[48:51], a[16:19], a[104:107], v[48:51]
ds_read_b64_tr_b16 a[42:43], v8 offset:40640
v_cvt_pk_bf16_f32 v129, v22, v23
v_mfma_f32_16x16x32_bf16 v[48:51], a[20:23], a[116:119], v[48:51]
s_waitcnt lgkmcnt(6)
v_cvt_pk_bf16_f32 v130, v32, v33
v_mfma_f32_16x16x32_bf16 v[48:51], a[24:27], a[128:131], v[48:51]
ds_read_b64_tr_b16 a[44:45], v8 offset:34304
v_cvt_pk_bf16_f32 v131, v34, v35
v_mfma_f32_16x16x32_bf16 v[48:51], a[28:31], a[140:143], v[48:51]
ds_read_b64_tr_b16 a[46:47], v8 offset:36416
v_cvt_pk_bf16_f32 v124, v16, v17
v_mfma_f32_16x16x32_bf16 v[44:47], a[28:31], a[136:139], v[44:47]
buffer_load_dwordx4 v[208:211], v252, s[76:79], s18 offen sc1
s_add_u32 s18, s18, 172032
v_mfma_f32_16x16x32_bf16 v[44:47], a[24:27], a[124:127], v[44:47]
v_add_u32 v15, 50688, v15
ds_read_b64_tr_b16 a[16:17], v15 offset:0
v_mfma_f32_16x16x32_bf16 v[40:43], a[24:27], a[120:123], v[40:43]
ds_read_b64_tr_b16 a[18:19], v15 offset:2112
v_cvt_pk_bf16_f32 v125, v18, v19
v_mfma_f32_16x16x32_bf16 v[40:43], a[28:31], a[132:135], v[40:43]
s_waitcnt lgkmcnt(6)
buffer_load_dwordx4 v[212:215], v252, s[76:79], s18 offen sc1
v_mfma_f32_16x16x32_bf16 v[52:55], a[32:35], a[132:135], v[52:55]
ds_read_b64_tr_b16 a[20:21], v15 offset:4224
v_cvt_pk_bf16_f32 v126, v28, v29
v_mfma_f32_16x16x32_bf16 v[52:55], a[36:39], a[120:123], v[52:55]
ds_read_b64_tr_b16 a[22:23], v15 offset:6336
s_add_u32 m0, s17, 135168
s_add_u32 s50, s46, 229376
v_mfma_f32_16x16x32_bf16 v[56:59], a[36:39], a[124:127], v[56:59]
buffer_load_dwordx4 v4, s[32:35], s50 offen offset:0 lds
v_mfma_f32_16x16x32_bf16 v[56:59], a[32:35], a[136:139], v[56:59]
ds_read_b64_tr_b16 a[24:25], v15 offset:8448
v_cvt_pk_bf16_f32 v127, v30, v31
v_mfma_f32_16x16x32_bf16 v[60:63], a[32:35], a[140:143], v[60:63]
ds_read_b64_tr_b16 a[26:27], v15 offset:10560
v_mfma_f32_16x16x32_bf16 v[60:63], a[36:39], a[128:131], v[60:63]
s_waitcnt lgkmcnt(6)
buffer_load_dwordx4 v5, s[32:35], s50 offen offset:1056 lds
v_mfma_f32_16x16x32_bf16 v[60:63], a[40:43], a[116:119], v[60:63]
ds_read_b64_tr_b16 a[28:29], v15 offset:12672
v_mfma_f32_16x16x32_bf16 v[60:63], a[44:47], a[104:107], v[60:63]
ds_read_b64_tr_b16 a[30:31], v15 offset:14784
v_mfma_f32_16x16x32_bf16 v[56:59], a[44:47], a[100:103], v[56:59]
buffer_load_dwordx4 v6, s[32:35], s50 offen offset:2112 lds
v_mfma_f32_16x16x32_bf16 v[56:59], a[40:43], a[112:115], v[56:59]
v_add_u32 v8, 50688, v8
ds_read_b64_tr_b16 a[32:33], v8 offset:12672
v_mfma_f32_16x16x32_bf16 v[52:55], a[40:43], a[108:111], v[52:55]
ds_read_b64_tr_b16 a[34:35], v8 offset:14784
v_cvt_pk_bf16_f32 v144, v48, v49
v_mfma_f32_16x16x32_bf16 v[52:55], a[44:47], a[96:99], v[52:55]
s_waitcnt lgkmcnt(6)
buffer_load_dwordx4 v7, s[32:35], s50 offen offset:3168 lds
LS_104:
v_mfma_f32_16x16x32_bf16 v[76:79], a[16:19], a[144:147], 0
ds_read_b64_tr_b16 a[36:37], v8 offset:8448
v_cvt_pk_bf16_f32 v145, v50, v51
v_mfma_f32_16x16x32_bf16 v[76:79], a[20:23], a[156:159], v[76:79]
ds_read_b64_tr_b16 a[38:39], v8 offset:10560
v_cvt_pk_bf16_f32 v146, v60, v61
v_mfma_f32_16x16x32_bf16 v[80:83], a[20:23], a[160:163], 0
s_add_u32 m0, s17, 118272
s_add_u32 s50, s46, 344064
v_mfma_f32_16x16x32_bf16 v[80:83], a[16:19], a[148:151], v[80:83]
ds_read_b64_tr_b16 a[40:41], v8 offset:4224
v_cvt_pk_bf16_f32 v147, v62, v63
v_mfma_f32_16x16x32_bf16 v[84:87], a[16:19], a[152:155], 0
ds_read_b64_tr_b16 a[42:43], v8 offset:6336
v_cvt_pk_bf16_f32 v140, v44, v45
v_mfma_f32_16x16x32_bf16 v[84:87], a[20:23], a[164:167], v[84:87]
s_waitcnt lgkmcnt(6)
v_cvt_pk_bf16_f32 v141, v46, v47
v_mfma_f32_16x16x32_bf16 v[84:87], a[24:27], a[176:179], v[84:87]
ds_read_b64_tr_b16 a[44:45], v8 offset:0
v_cvt_pk_bf16_f32 v142, v56, v57
v_mfma_f32_16x16x32_bf16 v[84:87], a[28:31], a[188:191], v[84:87]
ds_read_b64_tr_b16 a[46:47], v8 offset:2112
v_cvt_pk_bf16_f32 v143, v58, v59
v_mfma_f32_16x16x32_bf16 v[80:83], a[28:31], a[184:187], v[80:83]
buffer_load_dwordx4 v4, s[32:35], s50 offen offset:0 lds
v_mfma_f32_16x16x32_bf16 v[80:83], a[24:27], a[172:175], v[80:83]
ds_read_b64_tr_b16 a[16:17], v15 offset:512
v_cvt_pk_bf16_f32 v136, v40, v41
v_mfma_f32_16x16x32_bf16 v[76:79], a[24:27], a[168:171], v[76:79]
ds_read_b64_tr_b16 a[18:19], v15 offset:2624
v_cvt_pk_bf16_f32 v137, v42, v43
v_mfma_f32_16x16x32_bf16 v[76:79], a[28:31], a[180:183], v[76:79]
s_waitcnt lgkmcnt(6)
v_cvt_pk_bf16_f32 v138, v52, v53
v_mfma_f32_16x16x32_bf16 v[88:91], a[32:35], a[180:183], 0
ds_read_b64_tr_b16 a[20:21], v15 offset:4736
v_cvt_pk_bf16_f32 v139, v54, v55
v_mfma_f32_16x16x32_bf16 v[88:91], a[36:39], a[168:171], v[88:91]
ds_read_b64_tr_b16 a[22:23], v15 offset:6848
v_mfma_f32_16x16x32_bf16 v[92:95], a[36:39], a[172:175], 0
buffer_load_dwordx4 v5, s[32:35], s50 offen offset:1056 lds
v_mfma_f32_16x16x32_bf16 v[92:95], a[32:35], a[184:187], v[92:95]
ds_read_b64_tr_b16 a[24:25], v15 offset:8960
v_mfma_f32_16x16x32_bf16 v[96:99], a[32:35], a[188:191], 0
ds_read_b64_tr_b16 a[26:27], v15 offset:11072
v_mfma_f32_16x16x32_bf16 v[96:99], a[36:39], a[176:179], v[96:99]
s_waitcnt lgkmcnt(6)
v_mfma_f32_16x16x32_bf16 v[96:99], a[40:43], a[164:167], v[96:99]
ds_read_b64_tr_b16 a[28:29], v15 offset:13184
v_mfma_f32_16x16x32_bf16 v[96:99], a[44:47], a[152:155], v[96:99]
ds_read_b64_tr_b16 a[30:31], v15 offset:15296
v_mfma_f32_16x16x32_bf16 v[92:95], a[44:47], a[148:151], v[92:95]
s_waitcnt vmcnt(38)
s_barrier
v_mfma_f32_16x16x32_bf16 v[92:95], a[40:43], a[160:163], v[92:95]
ds_read_b64_tr_b16 a[32:33], v8 offset:13184
v_mfma_f32_16x16x32_bf16 v[88:91], a[40:43], a[156:159], v[88:91]
ds_read_b64_tr_b16 a[34:35], v8 offset:15296
v_mfma_f32_16x16x32_bf16 v[88:91], a[44:47], a[144:147], v[88:91]
s_waitcnt lgkmcnt(6)
buffer_load_dword v159, v158, s[80:83], 0 offen sc1
v_mfma_f32_16x16x32_bf16 v[100:103], a[16:19], a[144:147], 0
ds_read_b64_tr_b16 a[36:37], v8 offset:8960
v_mfma_f32_16x16x32_bf16 v[100:103], a[20:23], a[156:159], v[100:103]
ds_read_b64_tr_b16 a[38:39], v8 offset:11072
v_mfma_f32_16x16x32_bf16 v[104:107], a[20:23], a[160:163], 0
buffer_load_dwordx4 v6, s[32:35], s50 offen offset:2112 lds
v_mfma_f32_16x16x32_bf16 v[104:107], a[16:19], a[148:151], v[104:107]
ds_read_b64_tr_b16 a[40:41], v8 offset:4736
v_mfma_f32_16x16x32_bf16 v[108:111], a[16:19], a[152:155], 0
ds_read_b64_tr_b16 a[42:43], v8 offset:6848
v_mfma_f32_16x16x32_bf16 v[108:111], a[20:23], a[164:167], v[108:111]
s_waitcnt lgkmcnt(6)
v_mfma_f32_16x16x32_bf16 v[108:111], a[24:27], a[176:179], v[108:111]
ds_read_b64_tr_b16 a[44:45], v8 offset:512
v_mfma_f32_16x16x32_bf16 v[108:111], a[28:31], a[188:191], v[108:111]
ds_read_b64_tr_b16 a[46:47], v8 offset:2624
v_mfma_f32_16x16x32_bf16 v[104:107], a[28:31], a[184:187], v[104:107]
buffer_load_dwordx4 v7, s[32:35], s50 offen offset:3168 lds
v_mfma_f32_16x16x32_bf16 v[104:107], a[24:27], a[172:175], v[104:107]
v_subrev_u32 v15, 101376, v15
ds_read_b64_tr_b16 a[16:17], v15 offset:16896
v_mfma_f32_16x16x32_bf16 v[100:103], a[24:27], a[168:171], v[100:103]
ds_read_b64_tr_b16 a[18:19], v15 offset:19008
v_mfma_f32_16x16x32_bf16 v[100:103], a[28:31], a[180:183], v[100:103]
s_waitcnt lgkmcnt(6)
v_mfma_f32_16x16x32_bf16 v[112:115], a[32:35], a[180:183], 0
ds_read_b64_tr_b16 a[20:21], v15 offset:21120
v_mfma_f32_16x16x32_bf16 v[112:115], a[36:39], a[168:171], v[112:115]
ds_read_b64_tr_b16 a[22:23], v15 offset:23232
v_mfma_f32_16x16x32_bf16 v[116:119], a[36:39], a[172:175], 0
s_mov_b32 s51, 12288
buffer_store_dwordx4 v[124:127], v252, s[40:43], s51 offen sc1
v_mfma_f32_16x16x32_bf16 v[116:119], a[32:35], a[184:187], v[116:119]
ds_read_b64_tr_b16 a[24:25], v15 offset:25344
v_mfma_f32_16x16x32_bf16 v[120:123], a[32:35], a[188:191], 0
ds_read_b64_tr_b16 a[26:27], v15 offset:27456
v_mfma_f32_16x16x32_bf16 v[120:123], a[36:39], a[176:179], v[120:123]
s_waitcnt lgkmcnt(6)
v_mfma_f32_16x16x32_bf16 v[120:123], a[40:43], a[164:167], v[120:123]
ds_read_b64_tr_b16 a[28:29], v15 offset:29568
v_mfma_f32_16x16x32_bf16 v[120:123], a[44:47], a[152:155], v[120:123]
ds_read_b64_tr_b16 a[30:31], v15 offset:31680
v_mfma_f32_16x16x32_bf16 v[116:119], a[44:47], a[148:151], v[116:119]
s_mov_b32 s51, 13312
buffer_store_dwordx4 v[128:131], v252, s[40:43], s51 offen sc1
v_mfma_f32_16x16x32_bf16 v[116:119], a[40:43], a[160:163], v[116:119]
v_subrev_u32 v8, 101376, v8
ds_read_b64_tr_b16 a[32:33], v8 offset:29568
v_mfma_f32_16x16x32_bf16 v[112:115], a[40:43], a[156:159], v[112:115]
ds_read_b64_tr_b16 a[34:35], v8 offset:31680
v_mfma_f32_16x16x32_bf16 v[112:115], a[44:47], a[144:147], v[112:115]
s_waitcnt lgkmcnt(6)
LS_105:
v_mfma_f32_16x16x32_bf16 v[76:79], a[16:19], a[192:195], v[76:79]
ds_read_b64_tr_b16 a[36:37], v8 offset:25344
v_mfma_f32_16x16x32_bf16 v[76:79], a[20:23], a[204:207], v[76:79]
ds_read_b64_tr_b16 a[38:39], v8 offset:27456
s_mov_b32 s51, 14336
buffer_store_dwordx4 v[132:135], v252, s[40:43], s51 offen sc1
v_mfma_f32_16x16x32_bf16 v[80:83], a[20:23], a[208:211], v[80:83]
s_mov_b32 s51, 15360
buffer_store_dwordx4 v[136:139], v252, s[40:43], s51 offen sc1
v_mfma_f32_16x16x32_bf16 v[80:83], a[16:19], a[196:199], v[80:83]
ds_read_b64_tr_b16 a[40:41], v8 offset:21120
s_mov_b32 s51, 16384
buffer_store_dwordx4 v[140:143], v252, s[40:43], s51 offen sc1
v_mfma_f32_16x16x32_bf16 v[84:87], a[16:19], a[200:203], v[84:87]
ds_read_b64_tr_b16 a[42:43], v8 offset:23232
v_mfma_f32_16x16x32_bf16 v[84:87], a[20:23], a[212:215], v[84:87]
s_waitcnt lgkmcnt(6)
s_mov_b32 s51, 17408
buffer_store_dwordx4 v[144:147], v252, s[40:43], s51 offen sc1
v_mfma_f32_16x16x32_bf16 v[84:87], a[24:27], a[224:227], v[84:87]
ds_read_b64_tr_b16 a[44:45], v8 offset:16896
v_mfma_f32_16x16x32_bf16 v[84:87], a[28:31], a[236:239], v[84:87]
ds_read_b64_tr_b16 a[46:47], v8 offset:19008
v_mfma_f32_16x16x32_bf16 v[80:83], a[28:31], a[232:235], v[80:83]
s_add_u32 m0, s17, 84480
s_add_u32 s50, s57, 0
v_mfma_f32_16x16x32_bf16 v[80:83], a[24:27], a[220:223], v[80:83]
ds_read_b64_tr_b16 a[16:17], v15 offset:17408
v_mfma_f32_16x16x32_bf16 v[76:79], a[24:27], a[216:219], v[76:79]
ds_read_b64_tr_b16 a[18:19], v15 offset:19520
v_mfma_f32_16x16x32_bf16 v[76:79], a[28:31], a[228:231], v[76:79]
s_waitcnt lgkmcnt(6)
v_mfma_f32_16x16x32_bf16 v[88:91], a[32:35], a[228:231], v[88:91]
ds_read_b64_tr_b16 a[20:21], v15 offset:21632
v_mfma_f32_16x16x32_bf16 v[88:91], a[36:39], a[216:219], v[88:91]
ds_read_b64_tr_b16 a[22:23], v15 offset:23744
v_mfma_f32_16x16x32_bf16 v[92:95], a[36:39], a[220:223], v[92:95]
buffer_load_dwordx4 v4, s[32:35], s50 offen offset:0 lds
v_mfma_f32_16x16x32_bf16 v[92:95], a[32:35], a[232:235], v[92:95]
ds_read_b64_tr_b16 a[24:25], v15 offset:25856
v_mfma_f32_16x16x32_bf16 v[96:99], a[32:35], a[236:239], v[96:99]
ds_read_b64_tr_b16 a[26:27], v15 offset:27968
v_mfma_f32_16x16x32_bf16 v[96:99], a[36:39], a[224:227], v[96:99]
s_waitcnt lgkmcnt(6)
v_mfma_f32_16x16x32_bf16 v[96:99], a[40:43], a[212:215], v[96:99]
ds_read_b64_tr_b16 a[28:29], v15 offset:30080
v_mfma_f32_16x16x32_bf16 v[96:99], a[44:47], a[200:203], v[96:99]
ds_read_b64_tr_b16 a[30:31], v15 offset:32192
v_mfma_f32_16x16x32_bf16 v[92:95], a[44:47], a[196:199], v[92:95]
s_waitcnt vmcnt(44)
s_barrier
v_mfma_f32_16x16x32_bf16 v[92:95], a[40:43], a[208:211], v[92:95]
ds_read_b64_tr_b16 a[32:33], v8 offset:30080
v_mfma_f32_16x16x32_bf16 v[88:91], a[40:43], a[204:207], v[88:91]
ds_read_b64_tr_b16 a[34:35], v8 offset:32192
s_waitcnt vmcnt(16)
v_mfma_f32_16x16x32_bf16 v[164:167], v[150:153], v[186:189], 0
v_mfma_f32_16x16x32_bf16 v[164:167], v[150:153], v[194:197], v[164:167]
v_mfma_f32_16x16x32_bf16 v[164:167], v[150:153], v[202:205], v[164:167]
v_mfma_f32_16x16x32_bf16 v[164:167], v[150:153], v[210:213], v[164:167]
v_mfma_f32_16x16x32_bf16 v[160:163], v[150:153], v[190:193], 0
v_mfma_f32_16x16x32_bf16 v[160:163], v[150:153], v[198:201], v[160:163]
v_mfma_f32_16x16x32_bf16 v[160:163], v[150:153], v[206:209], v[160:163]
v_mfma_f32_16x16x32_bf16 v[160:163], v[152:155], v[184:187], v[160:163]
v_mfma_f32_16x16x32_bf16 v[160:163], v[148:151], v[212:215], v[160:163]
v_mfma_f32_16x16x32_bf16 v[88:91], a[44:47], a[192:195], v[88:91]
s_waitcnt lgkmcnt(6)
v_mfma_f32_16x16x32_bf16 v[100:103], a[16:19], a[192:195], v[100:103]
ds_read_b64_tr_b16 a[36:37], v8 offset:25856
v_mfma_f32_16x16x32_bf16 v[100:103], a[20:23], a[204:207], v[100:103]
ds_read_b64_tr_b16 a[38:39], v8 offset:27968
v_mfma_f32_16x16x32_bf16 v[104:107], a[20:23], a[208:211], v[104:107]
buffer_load_dwordx4 v5, s[32:35], s50 offen offset:1056 lds
v_mfma_f32_16x16x32_bf16 v[104:107], a[16:19], a[196:199], v[104:107]
ds_read_b64_tr_b16 a[40:41], v8 offset:21632
v_cvt_pk_bf16_f32 v176, v160, v161
v_mfma_f32_16x16x32_bf16 v[108:111], a[16:19], a[200:203], v[108:111]
ds_read_b64_tr_b16 a[42:43], v8 offset:23744
v_cvt_pk_bf16_f32 v177, v162, v163
v_mfma_f32_16x16x32_bf16 v[108:111], a[20:23], a[212:215], v[108:111]
s_waitcnt lgkmcnt(6)
v_cvt_pk_bf16_f32 v178, v164, v165
v_mfma_f32_16x16x32_bf16 v[108:111], a[24:27], a[224:227], v[108:111]
ds_read_b64_tr_b16 a[44:45], v8 offset:17408
v_cvt_pk_bf16_f32 v179, v166, v167
v_mfma_f32_16x16x32_bf16 v[108:111], a[28:31], a[236:239], v[108:111]
ds_read_b64_tr_b16 a[46:47], v8 offset:19520
v_mfma_f32_16x16x32_bf16 v[104:107], a[28:31], a[232:235], v[104:107]
buffer_load_dwordx4 v6, s[32:35], s50 offen offset:2112 lds
v_mfma_f32_16x16x32_bf16 v[104:107], a[24:27], a[220:223], v[104:107]
ds_read_b64_tr_b16 a[16:17], v15 offset:0
v_permlane32_swap_b32 v176, v178
v_mfma_f32_16x16x32_bf16 v[100:103], a[24:27], a[216:219], v[100:103]
ds_read_b64_tr_b16 a[18:19], v15 offset:2112
v_mfma_f32_16x16x32_bf16 v[100:103], a[28:31], a[228:231], v[100:103]
s_waitcnt lgkmcnt(6)
v_permlane32_swap_b32 v177, v179
v_mfma_f32_16x16x32_bf16 v[112:115], a[32:35], a[228:231], v[112:115]
ds_read_b64_tr_b16 a[20:21], v15 offset:4224
v_mfma_f32_16x16x32_bf16 v[112:115], a[36:39], a[216:219], v[112:115]
ds_read_b64_tr_b16 a[22:23], v15 offset:6336
v_permlane16_swap_b32 v176, v178
v_mfma_f32_16x16x32_bf16 v[116:119], a[36:39], a[220:223], v[116:119]
buffer_load_dwordx4 v7, s[32:35], s50 offen offset:3168 lds
v_mfma_f32_16x16x32_bf16 v[116:119], a[32:35], a[232:235], v[116:119]
ds_read_b64_tr_b16 a[24:25], v15 offset:8448
v_permlane16_swap_b32 v177, v179
v_mfma_f32_16x16x32_bf16 v[120:123], a[32:35], a[236:239], v[120:123]
ds_read_b64_tr_b16 a[26:27], v15 offset:10560
buffer_store_dwordx4 v[176:179], v156, s[68:71], s6 offen
v_mfma_f32_16x16x32_bf16 v[120:123], a[36:39], a[224:227], v[120:123]
s_waitcnt lgkmcnt(6)
v_mfma_f32_16x16x32_bf16 v[120:123], a[40:43], a[212:215], v[120:123]
ds_read_b64_tr_b16 a[28:29], v15 offset:12672
v_mfma_f32_16x16x32_bf16 v[120:123], a[44:47], a[200:203], v[120:123]
ds_read_b64_tr_b16 a[30:31], v15 offset:14784
v_mfma_f32_16x16x32_bf16 v[116:119], a[44:47], a[196:199], v[116:119]
v_mfma_f32_16x16x32_bf16 v[116:119], a[40:43], a[208:211], v[116:119]
ds_read_b64_tr_b16 a[32:33], v8 offset:12672
v_mfma_f32_16x16x32_bf16 v[112:115], a[40:43], a[204:207], v[112:115]
ds_read_b64_tr_b16 a[34:35], v8 offset:14784
v_mfma_f32_16x16x32_bf16 v[112:115], a[44:47], a[192:195], v[112:115]
s_waitcnt lgkmcnt(6)
LS_106:
v_mfma_f32_16x16x32_bf16 v[76:79], a[16:19], a[48:51], v[76:79]
ds_read_b64_tr_b16 a[36:37], v8 offset:8448
v_mfma_f32_16x16x32_bf16 v[76:79], a[20:23], a[60:63], v[76:79]
ds_read_b64_tr_b16 a[38:39], v8 offset:10560
v_mfma_f32_16x16x32_bf16 v[80:83], a[20:23], a[64:67], v[80:83]
s_add_u32 m0, s17, 101376
s_add_u32 s50, s57, 114688
v_mfma_f32_16x16x32_bf16 v[80:83], a[16:19], a[52:55], v[80:83]
ds_read_b64_tr_b16 a[40:41], v8 offset:4224
v_mfma_f32_16x16x32_bf16 v[84:87], a[16:19], a[56:59], v[84:87]
ds_read_b64_tr_b16 a[42:43], v8 offset:6336
v_mfma_f32_16x16x32_bf16 v[84:87], a[20:23], a[68:71], v[84:87]
s_waitcnt lgkmcnt(6)
v_mfma_f32_16x16x32_bf16 v[84:87], a[24:27], a[80:83], v[84:87]
ds_read_b64_tr_b16 a[44:45], v8 offset:0
v_mfma_f32_16x16x32_bf16 v[84:87], a[28:31], a[92:95], v[84:87]
ds_read_b64_tr_b16 a[46:47], v8 offset:2112
v_mfma_f32_16x16x32_bf16 v[80:83], a[28:31], a[88:91], v[80:83]
buffer_load_dwordx4 v4, s[32:35], s50 offen offset:0 lds
v_mfma_f32_16x16x32_bf16 v[80:83], a[24:27], a[76:79], v[80:83]
ds_read_b64_tr_b16 a[16:17], v15 offset:512
v_mfma_f32_16x16x32_bf16 v[76:79], a[24:27], a[72:75], v[76:79]
ds_read_b64_tr_b16 a[18:19], v15 offset:2624
v_mfma_f32_16x16x32_bf16 v[76:79], a[28:31], a[84:87], v[76:79]
s_waitcnt lgkmcnt(6)
v_mfma_f32_16x16x32_bf16 v[88:91], a[32:35], a[84:87], v[88:91]
ds_read_b64_tr_b16 a[20:21], v15 offset:4736
v_mfma_f32_16x16x32_bf16 v[88:91], a[36:39], a[72:75], v[88:91]
ds_read_b64_tr_b16 a[22:23], v15 offset:6848
v_mfma_f32_16x16x32_bf16 v[92:95], a[36:39], a[76:79], v[92:95]
buffer_load_dwordx4 v5, s[32:35], s50 offen offset:1056 lds
v_mfma_f32_16x16x32_bf16 v[92:95], a[32:35], a[88:91], v[92:95]
ds_read_b64_tr_b16 a[24:25], v15 offset:8960
v_mfma_f32_16x16x32_bf16 v[96:99], a[32:35], a[92:95], v[96:99]
ds_read_b64_tr_b16 a[26:27], v15 offset:11072
v_mfma_f32_16x16x32_bf16 v[96:99], a[36:39], a[80:83], v[96:99]
s_waitcnt lgkmcnt(6)
v_mfma_f32_16x16x32_bf16 v[96:99], a[40:43], a[68:71], v[96:99]
ds_read_b64_tr_b16 a[28:29], v15 offset:13184
v_mfma_f32_16x16x32_bf16 v[96:99], a[44:47], a[56:59], v[96:99]
ds_read_b64_tr_b16 a[30:31], v15 offset:15296
v_mfma_f32_16x16x32_bf16 v[92:95], a[44:47], a[52:55], v[92:95]
s_waitcnt vmcnt(7)
v_mov_b32 v250, 3
buffer_store_dword v250, v157, s[80:83], 0 offen sc1
v_mfma_f32_16x16x32_bf16 v[92:95], a[40:43], a[64:67], v[92:95]
ds_read_b64_tr_b16 a[32:33], v8 offset:13184
v_mfma_f32_16x16x32_bf16 v[88:91], a[40:43], a[60:63], v[88:91]
ds_read_b64_tr_b16 a[34:35], v8 offset:15296
s_waitcnt vmcnt(44)
s_barrier
v_mfma_f32_16x16x32_bf16 v[88:91], a[44:47], a[48:51], v[88:91]
s_waitcnt lgkmcnt(6)
v_mfma_f32_16x16x32_bf16 v[100:103], a[16:19], a[48:51], v[100:103]
ds_read_b64_tr_b16 a[36:37], v8 offset:8960
v_mfma_f32_16x16x32_bf16 v[100:103], a[20:23], a[60:63], v[100:103]
ds_read_b64_tr_b16 a[38:39], v8 offset:11072
v_mfma_f32_16x16x32_bf16 v[104:107], a[20:23], a[64:67], v[104:107]
buffer_load_dwordx4 v6, s[32:35], s50 offen offset:2112 lds
v_mfma_f32_16x16x32_bf16 v[104:107], a[16:19], a[52:55], v[104:107]
ds_read_b64_tr_b16 a[40:41], v8 offset:4736
v_mfma_f32_16x16x32_bf16 v[108:111], a[16:19], a[56:59], v[108:111]
ds_read_b64_tr_b16 a[42:43], v8 offset:6848
v_mfma_f32_16x16x32_bf16 v[108:111], a[20:23], a[68:71], v[108:111]
s_waitcnt lgkmcnt(6)
v_mfma_f32_16x16x32_bf16 v[108:111], a[24:27], a[80:83], v[108:111]
ds_read_b64_tr_b16 a[44:45], v8 offset:512
v_mfma_f32_16x16x32_bf16 v[108:111], a[28:31], a[92:95], v[108:111]
ds_read_b64_tr_b16 a[46:47], v8 offset:2624
v_mfma_f32_16x16x32_bf16 v[104:107], a[28:31], a[88:91], v[104:107]
buffer_load_dwordx4 v7, s[32:35], s50 offen offset:3168 lds
v_mfma_f32_16x16x32_bf16 v[104:107], a[24:27], a[76:79], v[104:107]
ds_read_b64_tr_b16 a[16:17], v15 offset:33792
v_mfma_f32_16x16x32_bf16 v[100:103], a[24:27], a[72:75], v[100:103]
ds_read_b64_tr_b16 a[18:19], v15 offset:35904
v_mfma_f32_16x16x32_bf16 v[100:103], a[28:31], a[84:87], v[100:103]
s_waitcnt lgkmcnt(6)
s_waitcnt vmcnt(18)
v_cmp_gt_u32 vcc, 2, v159
s_cbranch_vccnz SPIN_s1
RET_s1:
v_mfma_f32_16x16x32_bf16 v[112:115], a[32:35], a[84:87], v[112:115]
ds_read_b64_tr_b16 a[20:21], v15 offset:38016
v_mfma_f32_16x16x32_bf16 v[112:115], a[36:39], a[72:75], v[112:115]
ds_read_b64_tr_b16 a[22:23], v15 offset:40128
v_mfma_f32_16x16x32_bf16 v[116:119], a[36:39], a[76:79], v[116:119]
buffer_load_dwordx4 v[216:219], v252, s[76:79], s19 offen sc1
s_add_u32 s19, s19, 172032
v_mfma_f32_16x16x32_bf16 v[116:119], a[32:35], a[88:91], v[116:119]
ds_read_b64_tr_b16 a[24:25], v15 offset:42240
v_mfma_f32_16x16x32_bf16 v[120:123], a[32:35], a[92:95], v[120:123]
ds_read_b64_tr_b16 a[26:27], v15 offset:44352
v_mfma_f32_16x16x32_bf16 v[120:123], a[36:39], a[80:83], v[120:123]
s_waitcnt lgkmcnt(6)
v_mfma_f32_16x16x32_bf16 v[120:123], a[40:43], a[68:71], v[120:123]
ds_read_b64_tr_b16 a[28:29], v15 offset:46464
v_mfma_f32_16x16x32_bf16 v[120:123], a[44:47], a[56:59], v[120:123]
ds_read_b64_tr_b16 a[30:31], v15 offset:48576
v_mfma_f32_16x16x32_bf16 v[116:119], a[44:47], a[52:55], v[116:119]
buffer_load_dwordx4 v[220:223], v252, s[76:79], s19 offen sc1
s_add_u32 s19, s19, 172032
v_mfma_f32_16x16x32_bf16 v[116:119], a[40:43], a[64:67], v[116:119]
ds_read_b64_tr_b16 a[32:33], v8 offset:46464
v_mfma_f32_16x16x32_bf16 v[112:115], a[40:43], a[60:63], v[112:115]
ds_read_b64_tr_b16 a[34:35], v8 offset:48576
v_mfma_f32_16x16x32_bf16 v[112:115], a[44:47], a[48:51], v[112:115]
s_waitcnt lgkmcnt(6)
LS_107:
v_mfma_f32_16x16x32_bf16 v[76:79], a[16:19], a[96:99], v[76:79]
ds_read_b64_tr_b16 a[36:37], v8 offset:42240
v_mfma_f32_16x16x32_bf16 v[76:79], a[20:23], a[108:111], v[76:79]
ds_read_b64_tr_b16 a[38:39], v8 offset:44352
v_mfma_f32_16x16x32_bf16 v[80:83], a[20:23], a[112:115], v[80:83]
buffer_load_dwordx4 v[224:227], v252, s[76:79], s19 offen sc1
s_add_u32 s19, s19, 172032
v_mfma_f32_16x16x32_bf16 v[80:83], a[16:19], a[100:103], v[80:83]
ds_read_b64_tr_b16 a[40:41], v8 offset:38016
v_mfma_f32_16x16x32_bf16 v[84:87], a[16:19], a[104:107], v[84:87]
ds_read_b64_tr_b16 a[42:43], v8 offset:40128
v_mfma_f32_16x16x32_bf16 v[84:87], a[20:23], a[116:119], v[84:87]
s_waitcnt lgkmcnt(6)
v_mfma_f32_16x16x32_bf16 v[84:87], a[24:27], a[128:131], v[84:87]
ds_read_b64_tr_b16 a[44:45], v8 offset:33792
v_mfma_f32_16x16x32_bf16 v[84:87], a[28:31], a[140:143], v[84:87]
ds_read_b64_tr_b16 a[46:47], v8 offset:35904
v_mfma_f32_16x16x32_bf16 v[80:83], a[28:31], a[136:139], v[80:83]
buffer_load_dwordx4 v[228:231], v252, s[76:79], s19 offen sc1
s_add_u32 s19, s19, 172032
v_mfma_f32_16x16x32_bf16 v[80:83], a[24:27], a[124:127], v[80:83]
ds_read_b64_tr_b16 a[16:17], v15 offset:34304
v_mfma_f32_16x16x32_bf16 v[76:79], a[24:27], a[120:123], v[76:79]
ds_read_b64_tr_b16 a[18:19], v15 offset:36416
v_mfma_f32_16x16x32_bf16 v[76:79], a[28:31], a[132:135], v[76:79]
s_waitcnt lgkmcnt(6)
v_mfma_f32_16x16x32_bf16 v[88:91], a[32:35], a[132:135], v[88:91]
ds_read_b64_tr_b16 a[20:21], v15 offset:38528
v_mfma_f32_16x16x32_bf16 v[88:91], a[36:39], a[120:123], v[88:91]
ds_read_b64_tr_b16 a[22:23], v15 offset:40640
v_mfma_f32_16x16x32_bf16 v[92:95], a[36:39], a[124:127], v[92:95]
buffer_load_dwordx4 v[232:235], v252, s[76:79], s19 offen sc1
s_add_u32 s19, s19, 172032
v_mfma_f32_16x16x32_bf16 v[92:95], a[32:35], a[136:139], v[92:95]
ds_read_b64_tr_b16 a[24:25], v15 offset:42752
v_mfma_f32_16x16x32_bf16 v[96:99], a[32:35], a[140:143], v[96:99]
ds_read_b64_tr_b16 a[26:27], v15 offset:44864
v_mfma_f32_16x16x32_bf16 v[96:99], a[36:39], a[128:131], v[96:99]
s_waitcnt lgkmcnt(6)
v_mfma_f32_16x16x32_bf16 v[96:99], a[40:43], a[116:119], v[96:99]
ds_read_b64_tr_b16 a[28:29], v15 offset:46976
v_mfma_f32_16x16x32_bf16 v[96:99], a[44:47], a[104:107], v[96:99]
ds_read_b64_tr_b16 a[30:31], v15 offset:49088
v_mfma_f32_16x16x32_bf16 v[92:95], a[44:47], a[100:103], v[92:95]
s_waitcnt vmcnt(43)
s_barrier
v_mfma_f32_16x16x32_bf16 v[92:95], a[40:43], a[112:115], v[92:95]
ds_read_b64_tr_b16 a[32:33], v8 offset:46976
v_mfma_f32_16x16x32_bf16 v[88:91], a[40:43], a[108:111], v[88:91]
ds_read_b64_tr_b16 a[34:35], v8 offset:49088
v_cvt_pk_bf16_f32 v132, v84, v85
v_mfma_f32_16x16x32_bf16 v[88:91], a[44:47], a[96:99], v[88:91]
s_waitcnt lgkmcnt(6)
v_cvt_pk_bf16_f32 v133, v86, v87
v_mfma_f32_16x16x32_bf16 v[100:103], a[16:19], a[96:99], v[100:103]
ds_read_b64_tr_b16 a[36:37], v8 offset:42752
v_cvt_pk_bf16_f32 v134, v96, v97
v_mfma_f32_16x16x32_bf16 v[100:103], a[20:23], a[108:111], v[100:103]
ds_read_b64_tr_b16 a[38:39], v8 offset:44864
v_cvt_pk_bf16_f32 v135, v98, v99
v_mfma_f32_16x16x32_bf16 v[104:107], a[20:23], a[112:115], v[104:107]
buffer_load_dwordx4 v[236:239], v252, s[76:79], s19 offen sc1
s_add_u32 s19, s19, 172032
v_mfma_f32_16x16x32_bf16 v[104:107], a[16:19], a[100:103], v[104:107]
ds_read_b64_tr_b16 a[40:41], v8 offset:38528
v_cvt_pk_bf16_f32 v128, v80, v81
v_mfma_f32_16x16x32_bf16 v[108:111], a[16:19], a[104:107], v[108:111]
ds_read_b64_tr_b16 a[42:43], v8 offset:40640
v_cvt_pk_bf16_f32 v129, v82, v83
v_mfma_f32_16x16x32_bf16 v[108:111], a[20:23], a[116:119], v[108:111]
s_waitcnt lgkmcnt(6)
v_cvt_pk_bf16_f32 v130, v92, v93
v_mfma_f32_16x16x32_bf16 v[108:111], a[24:27], a[128:131], v[108:111]
ds_read_b64_tr_b16 a[44:45], v8 offset:34304
v_cvt_pk_bf16_f32 v131, v94, v95
v_mfma_f32_16x16x32_bf16 v[108:111], a[28:31], a[140:143], v[108:111]
ds_read_b64_tr_b16 a[46:47], v8 offset:36416
v_cvt_pk_bf16_f32 v124, v76, v77
v_mfma_f32_16x16x32_bf16 v[104:107], a[28:31], a[136:139], v[104:107]
buffer_load_dwordx4 v[240:243], v252, s[76:79], s19 offen sc1
s_add_u32 s19, s19, 172032
v_mfma_f32_16x16x32_bf16 v[104:107], a[24:27], a[124:127], v[104:107]
v_add_u32 v15, 50688, v15
ds_read_b64_tr_b16 a[16:17], v15 offset:0
v_mfma_f32_16x16x32_bf16 v[100:103], a[24:27], a[120:123], v[100:103]
ds_read_b64_tr_b16 a[18:19], v15 offset:2112
v_cvt_pk_bf16_f32 v125, v78, v79
v_mfma_f32_16x16x32_bf16 v[100:103], a[28:31], a[132:135], v[100:103]
s_waitcnt lgkmcnt(6)
buffer_load_dwordx4 v[244:247], v252, s[76:79], s19 offen sc1
v_mfma_f32_16x16x32_bf16 v[112:115], a[32:35], a[132:135], v[112:115]
ds_read_b64_tr_b16 a[20:21], v15 offset:4224
v_cvt_pk_bf16_f32 v126, v88, v89
v_mfma_f32_16x16x32_bf16 v[112:115], a[36:39], a[120:123], v[112:115]
ds_read_b64_tr_b16 a[22:23], v15 offset:6336
s_add_u32 m0, s17, 16896
s_add_u32 s50, s57, 229376
v_mfma_f32_16x16x32_bf16 v[116:119], a[36:39], a[124:127], v[116:119]
buffer_load_dwordx4 v4, s[32:35], s50 offen offset:0 lds
v_mfma_f32_16x16x32_bf16 v[116:119], a[32:35], a[136:139], v[116:119]
ds_read_b64_tr_b16 a[24:25], v15 offset:8448
v_cvt_pk_bf16_f32 v127, v90, v91
v_mfma_f32_16x16x32_bf16 v[120:123], a[32:35], a[140:143], v[120:123]
ds_read_b64_tr_b16 a[26:27], v15 offset:10560
v_mfma_f32_16x16x32_bf16 v[120:123], a[36:39], a[128:131], v[120:123]
s_waitcnt lgkmcnt(6)
buffer_load_dwordx4 v5, s[32:35], s50 offen offset:1056 lds
v_mfma_f32_16x16x32_bf16 v[120:123], a[40:43], a[116:119], v[120:123]
ds_read_b64_tr_b16 a[28:29], v15 offset:12672
v_mfma_f32_16x16x32_bf16 v[120:123], a[44:47], a[104:107], v[120:123]
ds_read_b64_tr_b16 a[30:31], v15 offset:14784
v_mfma_f32_16x16x32_bf16 v[116:119], a[44:47], a[100:103], v[116:119]
buffer_load_dwordx4 v6, s[32:35], s50 offen offset:2112 lds
v_mfma_f32_16x16x32_bf16 v[116:119], a[40:43], a[112:115], v[116:119]
v_add_u32 v8, 50688, v8
ds_read_b64_tr_b16 a[32:33], v8 offset:12672
v_mfma_f32_16x16x32_bf16 v[112:115], a[40:43], a[108:111], v[112:115]
ds_read_b64_tr_b16 a[34:35], v8 offset:14784
v_cvt_pk_bf16_f32 v144, v108, v109
v_mfma_f32_16x16x32_bf16 v[112:115], a[44:47], a[96:99], v[112:115]
s_waitcnt lgkmcnt(6)
buffer_load_dwordx4 v7, s[32:35], s50 offen offset:3168 lds
LS_108:
v_mfma_f32_16x16x32_bf16 v[16:19], a[16:19], a[144:147], 0
ds_read_b64_tr_b16 a[36:37], v8 offset:8448
v_cvt_pk_bf16_f32 v145, v110, v111
v_mfma_f32_16x16x32_bf16 v[16:19], a[20:23], a[156:159], v[16:19]
ds_read_b64_tr_b16 a[38:39], v8 offset:10560
v_cvt_pk_bf16_f32 v146, v120, v121
v_mfma_f32_16x16x32_bf16 v[20:23], a[20:23], a[160:163], 0
s_add_u32 m0, s17, 0
s_add_u32 s50, s57, 344064
v_mfma_f32_16x16x32_bf16 v[20:23], a[16:19], a[148:151], v[20:23]
ds_read_b64_tr_b16 a[40:41], v8 offset:4224
v_cvt_pk_bf16_f32 v147, v122, v123
v_mfma_f32_16x16x32_bf16 v[24:27], a[16:19], a[152:155], 0
ds_read_b64_tr_b16 a[42:43], v8 offset:6336
v_cvt_pk_bf16_f32 v140, v104, v105
v_mfma_f32_16x16x32_bf16 v[24:27], a[20:23], a[164:167], v[24:27]
s_waitcnt lgkmcnt(6)
v_cvt_pk_bf16_f32 v141, v106, v107
v_mfma_f32_16x16x32_bf16 v[24:27], a[24:27], a[176:179], v[24:27]
ds_read_b64_tr_b16 a[44:45], v8 offset:0
v_cvt_pk_bf16_f32 v142, v116, v117
v_mfma_f32_16x16x32_bf16 v[24:27], a[28:31], a[188:191], v[24:27]
ds_read_b64_tr_b16 a[46:47], v8 offset:2112
v_cvt_pk_bf16_f32 v143, v118, v119
v_mfma_f32_16x16x32_bf16 v[20:23], a[28:31], a[184:187], v[20:23]
buffer_load_dwordx4 v4, s[32:35], s50 offen offset:0 lds
v_mfma_f32_16x16x32_bf16 v[20:23], a[24:27], a[172:175], v[20:23]
ds_read_b64_tr_b16 a[16:17], v15 offset:512
v_cvt_pk_bf16_f32 v136, v100, v101
v_mfma_f32_16x16x32_bf16 v[16:19], a[24:27], a[168:171], v[16:19]
ds_read_b64_tr_b16 a[18:19], v15 offset:2624
v_cvt_pk_bf16_f32 v137, v102, v103
v_mfma_f32_16x16x32_bf16 v[16:19], a[28:31], a[180:183], v[16:19]
s_waitcnt lgkmcnt(6)
v_cvt_pk_bf16_f32 v138, v112, v113
v_mfma_f32_16x16x32_bf16 v[28:31], a[32:35], a[180:183], 0
ds_read_b64_tr_b16 a[20:21], v15 offset:4736
v_cvt_pk_bf16_f32 v139, v114, v115
v_mfma_f32_16x16x32_bf16 v[28:31], a[36:39], a[168:171], v[28:31]
ds_read_b64_tr_b16 a[22:23], v15 offset:6848
v_mfma_f32_16x16x32_bf16 v[32:35], a[36:39], a[172:175], 0
buffer_load_dwordx4 v5, s[32:35], s50 offen offset:1056 lds
v_mfma_f32_16x16x32_bf16 v[32:35], a[32:35], a[184:187], v[32:35]
ds_read_b64_tr_b16 a[24:25], v15 offset:8960
v_mfma_f32_16x16x32_bf16 v[36:39], a[32:35], a[188:191], 0
ds_read_b64_tr_b16 a[26:27], v15 offset:11072
v_mfma_f32_16x16x32_bf16 v[36:39], a[36:39], a[176:179], v[36:39]
s_waitcnt lgkmcnt(6)
v_mfma_f32_16x16x32_bf16 v[36:39], a[40:43], a[164:167], v[36:39]
ds_read_b64_tr_b16 a[28:29], v15 offset:13184
v_mfma_f32_16x16x32_bf16 v[36:39], a[44:47], a[152:155], v[36:39]
ds_read_b64_tr_b16 a[30:31], v15 offset:15296
v_mfma_f32_16x16x32_bf16 v[32:35], a[44:47], a[148:151], v[32:35]
s_waitcnt vmcnt(47)
s_barrier
v_mfma_f32_16x16x32_bf16 v[32:35], a[40:43], a[160:163], v[32:35]
ds_read_b64_tr_b16 a[32:33], v8 offset:13184
v_mfma_f32_16x16x32_bf16 v[28:31], a[40:43], a[156:159], v[28:31]
ds_read_b64_tr_b16 a[34:35], v8 offset:15296
v_mfma_f32_16x16x32_bf16 v[28:31], a[44:47], a[144:147], v[28:31]
s_waitcnt lgkmcnt(6)
buffer_load_dword v159, v158, s[80:83], 0 offen sc1
v_mfma_f32_16x16x32_bf16 v[40:43], a[16:19], a[144:147], 0
ds_read_b64_tr_b16 a[36:37], v8 offset:8960
v_mfma_f32_16x16x32_bf16 v[40:43], a[20:23], a[156:159], v[40:43]
ds_read_b64_tr_b16 a[38:39], v8 offset:11072
v_mfma_f32_16x16x32_bf16 v[44:47], a[20:23], a[160:163], 0
buffer_load_dwordx4 v6, s[32:35], s50 offen offset:2112 lds
v_mfma_f32_16x16x32_bf16 v[44:47], a[16:19], a[148:151], v[44:47]
ds_read_b64_tr_b16 a[40:41], v8 offset:4736
v_mfma_f32_16x16x32_bf16 v[48:51], a[16:19], a[152:155], 0
ds_read_b64_tr_b16 a[42:43], v8 offset:6848
v_mfma_f32_16x16x32_bf16 v[48:51], a[20:23], a[164:167], v[48:51]
s_waitcnt lgkmcnt(6)
v_mfma_f32_16x16x32_bf16 v[48:51], a[24:27], a[176:179], v[48:51]
ds_read_b64_tr_b16 a[44:45], v8 offset:512
v_mfma_f32_16x16x32_bf16 v[48:51], a[28:31], a[188:191], v[48:51]
ds_read_b64_tr_b16 a[46:47], v8 offset:2624
v_mfma_f32_16x16x32_bf16 v[44:47], a[28:31], a[184:187], v[44:47]
buffer_load_dwordx4 v7, s[32:35], s50 offen offset:3168 lds
v_mfma_f32_16x16x32_bf16 v[44:47], a[24:27], a[172:175], v[44:47]
ds_read_b64_tr_b16 a[16:17], v15 offset:16896
v_mfma_f32_16x16x32_bf16 v[40:43], a[24:27], a[168:171], v[40:43]
ds_read_b64_tr_b16 a[18:19], v15 offset:19008
v_mfma_f32_16x16x32_bf16 v[40:43], a[28:31], a[180:183], v[40:43]
s_waitcnt lgkmcnt(6)
v_mfma_f32_16x16x32_bf16 v[52:55], a[32:35], a[180:183], 0
ds_read_b64_tr_b16 a[20:21], v15 offset:21120
v_mfma_f32_16x16x32_bf16 v[52:55], a[36:39], a[168:171], v[52:55]
ds_read_b64_tr_b16 a[22:23], v15 offset:23232
v_mfma_f32_16x16x32_bf16 v[56:59], a[36:39], a[172:175], 0
s_mov_b32 s51, 18432
buffer_store_dwordx4 v[124:127], v252, s[40:43], s51 offen sc1
v_mfma_f32_16x16x32_bf16 v[56:59], a[32:35], a[184:187], v[56:59]
ds_read_b64_tr_b16 a[24:25], v15 offset:25344
v_mfma_f32_16x16x32_bf16 v[60:63], a[32:35], a[188:191], 0
ds_read_b64_tr_b16 a[26:27], v15 offset:27456
v_mfma_f32_16x16x32_bf16 v[60:63], a[36:39], a[176:179], v[60:63]
s_waitcnt lgkmcnt(6)
v_mfma_f32_16x16x32_bf16 v[60:63], a[40:43], a[164:167], v[60:63]
ds_read_b64_tr_b16 a[28:29], v15 offset:29568
v_mfma_f32_16x16x32_bf16 v[60:63], a[44:47], a[152:155], v[60:63]
ds_read_b64_tr_b16 a[30:31], v15 offset:31680
v_mfma_f32_16x16x32_bf16 v[56:59], a[44:47], a[148:151], v[56:59]
s_mov_b32 s51, 19456
buffer_store_dwordx4 v[128:131], v252, s[40:43], s51 offen sc1
v_mfma_f32_16x16x32_bf16 v[56:59], a[40:43], a[160:163], v[56:59]
ds_read_b64_tr_b16 a[32:33], v8 offset:29568
v_mfma_f32_16x16x32_bf16 v[52:55], a[40:43], a[156:159], v[52:55]
ds_read_b64_tr_b16 a[34:35], v8 offset:31680
v_mfma_f32_16x16x32_bf16 v[52:55], a[44:47], a[144:147], v[52:55]
s_waitcnt lgkmcnt(6)
LS_109:
v_mfma_f32_16x16x32_bf16 v[16:19], a[16:19], a[192:195], v[16:19]
ds_read_b64_tr_b16 a[36:37], v8 offset:25344
v_mfma_f32_16x16x32_bf16 v[16:19], a[20:23], a[204:207], v[16:19]
ds_read_b64_tr_b16 a[38:39], v8 offset:27456
s_mov_b32 s51, 20480
buffer_store_dwordx4 v[132:135], v252, s[40:43], s51 offen sc1
v_mfma_f32_16x16x32_bf16 v[20:23], a[20:23], a[208:211], v[20:23]
s_mov_b32 s51, 21504
buffer_store_dwordx4 v[136:139], v252, s[40:43], s51 offen sc1
v_mfma_f32_16x16x32_bf16 v[20:23], a[16:19], a[196:199], v[20:23]
ds_read_b64_tr_b16 a[40:41], v8 offset:21120
s_mov_b32 s51, 22528
buffer_store_dwordx4 v[140:143], v252, s[40:43], s51 offen sc1
v_mfma_f32_16x16x32_bf16 v[24:27], a[16:19], a[200:203], v[24:27]
ds_read_b64_tr_b16 a[42:43], v8 offset:23232
v_mfma_f32_16x16x32_bf16 v[24:27], a[20:23], a[212:215], v[24:27]
s_waitcnt lgkmcnt(6)
s_mov_b32 s51, 23552
buffer_store_dwordx4 v[144:147], v252, s[40:43], s51 offen sc1
v_mfma_f32_16x16x32_bf16 v[24:27], a[24:27], a[224:227], v[24:27]
ds_read_b64_tr_b16 a[44:45], v8 offset:16896
v_mfma_f32_16x16x32_bf16 v[24:27], a[28:31], a[236:239], v[24:27]
ds_read_b64_tr_b16 a[46:47], v8 offset:19008
v_mfma_f32_16x16x32_bf16 v[20:23], a[28:31], a[232:235], v[20:23]
s_add_u32 m0, s17, 33792
s_add_u32 s50, s58, 0
v_mfma_f32_16x16x32_bf16 v[20:23], a[24:27], a[220:223], v[20:23]
ds_read_b64_tr_b16 a[16:17], v15 offset:17408
v_mfma_f32_16x16x32_bf16 v[16:19], a[24:27], a[216:219], v[16:19]
ds_read_b64_tr_b16 a[18:19], v15 offset:19520
v_mfma_f32_16x16x32_bf16 v[16:19], a[28:31], a[228:231], v[16:19]
s_waitcnt lgkmcnt(6)
v_mfma_f32_16x16x32_bf16 v[28:31], a[32:35], a[228:231], v[28:31]
ds_read_b64_tr_b16 a[20:21], v15 offset:21632
v_mfma_f32_16x16x32_bf16 v[28:31], a[36:39], a[216:219], v[28:31]
ds_read_b64_tr_b16 a[22:23], v15 offset:23744
v_mfma_f32_16x16x32_bf16 v[32:35], a[36:39], a[220:223], v[32:35]
buffer_load_dwordx4 v4, s[32:35], s50 offen offset:0 lds
v_mfma_f32_16x16x32_bf16 v[32:35], a[32:35], a[232:235], v[32:35]
ds_read_b64_tr_b16 a[24:25], v15 offset:25856
v_mfma_f32_16x16x32_bf16 v[36:39], a[32:35], a[236:239], v[36:39]
ds_read_b64_tr_b16 a[26:27], v15 offset:27968
v_mfma_f32_16x16x32_bf16 v[36:39], a[36:39], a[224:227], v[36:39]
s_waitcnt lgkmcnt(6)
v_mfma_f32_16x16x32_bf16 v[36:39], a[40:43], a[212:215], v[36:39]
ds_read_b64_tr_b16 a[28:29], v15 offset:30080
v_mfma_f32_16x16x32_bf16 v[36:39], a[44:47], a[200:203], v[36:39]
ds_read_b64_tr_b16 a[30:31], v15 offset:32192
v_mfma_f32_16x16x32_bf16 v[32:35], a[44:47], a[196:199], v[32:35]
s_waitcnt vmcnt(45)
s_barrier
v_mfma_f32_16x16x32_bf16 v[32:35], a[40:43], a[208:211], v[32:35]
ds_read_b64_tr_b16 a[32:33], v8 offset:30080
v_mfma_f32_16x16x32_bf16 v[28:31], a[40:43], a[204:207], v[28:31]
ds_read_b64_tr_b16 a[34:35], v8 offset:32192
s_waitcnt vmcnt(16)
v_mfma_f32_16x16x32_bf16 v[172:175], v[150:153], v[218:221], 0
v_mfma_f32_16x16x32_bf16 v[172:175], v[150:153], v[226:229], v[172:175]
v_mfma_f32_16x16x32_bf16 v[172:175], v[150:153], v[234:237], v[172:175]
v_mfma_f32_16x16x32_bf16 v[172:175], v[150:153], v[242:245], v[172:175]
v_mfma_f32_16x16x32_bf16 v[168:171], v[150:153], v[222:225], 0
v_mfma_f32_16x16x32_bf16 v[168:171], v[150:153], v[230:233], v[168:171]
v_mfma_f32_16x16x32_bf16 v[168:171], v[150:153], v[238:241], v[168:171]
v_mfma_f32_16x16x32_bf16 v[168:171], v[152:155], v[216:219], v[168:171]
v_mfma_f32_16x16x32_bf16 v[168:171], v[148:151], v[244:247], v[168:171]
v_mfma_f32_16x16x32_bf16 v[28:31], a[44:47], a[192:195], v[28:31]
s_waitcnt lgkmcnt(6)
v_mfma_f32_16x16x32_bf16 v[40:43], a[16:19], a[192:195], v[40:43]
ds_read_b64_tr_b16 a[36:37], v8 offset:25856
v_mfma_f32_16x16x32_bf16 v[40:43], a[20:23], a[204:207], v[40:43]
ds_read_b64_tr_b16 a[38:39], v8 offset:27968
v_mfma_f32_16x16x32_bf16 v[44:47], a[20:23], a[208:211], v[44:47]
buffer_load_dwordx4 v5, s[32:35], s50 offen offset:1056 lds
v_mfma_f32_16x16x32_bf16 v[44:47], a[16:19], a[196:199], v[44:47]
ds_read_b64_tr_b16 a[40:41], v8 offset:21632
v_cvt_pk_bf16_f32 v180, v168, v169
v_mfma_f32_16x16x32_bf16 v[48:51], a[16:19], a[200:203], v[48:51]
ds_read_b64_tr_b16 a[42:43], v8 offset:23744
v_cvt_pk_bf16_f32 v181, v170, v171
v_mfma_f32_16x16x32_bf16 v[48:51], a[20:23], a[212:215], v[48:51]
s_waitcnt lgkmcnt(6)
v_cvt_pk_bf16_f32 v182, v172, v173
v_mfma_f32_16x16x32_bf16 v[48:51], a[24:27], a[224:227], v[48:51]
ds_read_b64_tr_b16 a[44:45], v8 offset:17408
v_cvt_pk_bf16_f32 v183, v174, v175
v_mfma_f32_16x16x32_bf16 v[48:51], a[28:31], a[236:239], v[48:51]
ds_read_b64_tr_b16 a[46:47], v8 offset:19520
v_mfma_f32_16x16x32_bf16 v[44:47], a[28:31], a[232:235], v[44:47]
buffer_load_dwordx4 v6, s[32:35], s50 offen offset:2112 lds
v_mfma_f32_16x16x32_bf16 v[44:47], a[24:27], a[220:223], v[44:47]
v_add_u32 v15, 50688, v15
ds_read_b64_tr_b16 a[16:17], v15 offset:33792
v_mfma_f32_16x16x32_bf16 v[40:43], a[24:27], a[216:219], v[40:43]
ds_read_b64_tr_b16 a[18:19], v15 offset:35904
v_permlane32_swap_b32 v180, v182
v_mfma_f32_16x16x32_bf16 v[40:43], a[28:31], a[228:231], v[40:43]
s_waitcnt lgkmcnt(6)
v_mfma_f32_16x16x32_bf16 v[52:55], a[32:35], a[228:231], v[52:55]
ds_read_b64_tr_b16 a[20:21], v15 offset:38016
v_permlane32_swap_b32 v181, v183
v_mfma_f32_16x16x32_bf16 v[52:55], a[36:39], a[216:219], v[52:55]
ds_read_b64_tr_b16 a[22:23], v15 offset:40128
v_mfma_f32_16x16x32_bf16 v[56:59], a[36:39], a[220:223], v[56:59]
buffer_load_dwordx4 v7, s[32:35], s50 offen offset:3168 lds
v_mfma_f32_16x16x32_bf16 v[56:59], a[32:35], a[232:235], v[56:59]
ds_read_b64_tr_b16 a[24:25], v15 offset:42240
v_permlane16_swap_b32 v180, v182
v_mfma_f32_16x16x32_bf16 v[60:63], a[32:35], a[236:239], v[60:63]
ds_read_b64_tr_b16 a[26:27], v15 offset:44352
v_mfma_f32_16x16x32_bf16 v[60:63], a[36:39], a[224:227], v[60:63]
s_waitcnt lgkmcnt(6)
v_permlane16_swap_b32 v181, v183
v_mfma_f32_16x16x32_bf16 v[60:63], a[40:43], a[212:215], v[60:63]
ds_read_b64_tr_b16 a[28:29], v15 offset:46464
buffer_store_dwordx4 v[180:183], v156, s[68:71], s7 offen
v_mfma_f32_16x16x32_bf16 v[60:63], a[44:47], a[200:203], v[60:63]
ds_read_b64_tr_b16 a[30:31], v15 offset:48576
v_mfma_f32_16x16x32_bf16 v[56:59], a[44:47], a[196:199], v[56:59]
v_mfma_f32_16x16x32_bf16 v[56:59], a[40:43], a[208:211], v[56:59]
v_add_u32 v8, 50688, v8
ds_read_b64_tr_b16 a[32:33], v8 offset:46464
v_mfma_f32_16x16x32_bf16 v[52:55], a[40:43], a[204:207], v[52:55]
ds_read_b64_tr_b16 a[34:35], v8 offset:48576
v_mfma_f32_16x16x32_bf16 v[52:55], a[44:47], a[192:195], v[52:55]
s_waitcnt lgkmcnt(6)
LS_110:
v_mfma_f32_16x16x32_bf16 v[16:19], a[16:19], a[48:51], v[16:19]
ds_read_b64_tr_b16 a[36:37], v8 offset:42240
v_mfma_f32_16x16x32_bf16 v[16:19], a[20:23], a[60:63], v[16:19]
ds_read_b64_tr_b16 a[38:39], v8 offset:44352
v_mfma_f32_16x16x32_bf16 v[20:23], a[20:23], a[64:67], v[20:23]
s_add_u32 m0, s17, 50688
s_add_u32 s50, s58, 114688
v_mfma_f32_16x16x32_bf16 v[20:23], a[16:19], a[52:55], v[20:23]
ds_read_b64_tr_b16 a[40:41], v8 offset:38016
v_mfma_f32_16x16x32_bf16 v[24:27], a[16:19], a[56:59], v[24:27]
ds_read_b64_tr_b16 a[42:43], v8 offset:40128
v_mfma_f32_16x16x32_bf16 v[24:27], a[20:23], a[68:71], v[24:27]
s_waitcnt lgkmcnt(6)
v_mfma_f32_16x16x32_bf16 v[24:27], a[24:27], a[80:83], v[24:27]
ds_read_b64_tr_b16 a[44:45], v8 offset:33792
v_mfma_f32_16x16x32_bf16 v[24:27], a[28:31], a[92:95], v[24:27]
ds_read_b64_tr_b16 a[46:47], v8 offset:35904
v_mfma_f32_16x16x32_bf16 v[20:23], a[28:31], a[88:91], v[20:23]
buffer_load_dwordx4 v4, s[32:35], s50 offen offset:0 lds
v_mfma_f32_16x16x32_bf16 v[20:23], a[24:27], a[76:79], v[20:23]
ds_read_b64_tr_b16 a[16:17], v15 offset:34304
v_mfma_f32_16x16x32_bf16 v[16:19], a[24:27], a[72:75], v[16:19]
ds_read_b64_tr_b16 a[18:19], v15 offset:36416
v_mfma_f32_16x16x32_bf16 v[16:19], a[28:31], a[84:87], v[16:19]
s_waitcnt lgkmcnt(6)
v_mfma_f32_16x16x32_bf16 v[28:31], a[32:35], a[84:87], v[28:31]
ds_read_b64_tr_b16 a[20:21], v15 offset:38528
v_mfma_f32_16x16x32_bf16 v[28:31], a[36:39], a[72:75], v[28:31]
ds_read_b64_tr_b16 a[22:23], v15 offset:40640
v_mfma_f32_16x16x32_bf16 v[32:35], a[36:39], a[76:79], v[32:35]
buffer_load_dwordx4 v5, s[32:35], s50 offen offset:1056 lds
v_mfma_f32_16x16x32_bf16 v[32:35], a[32:35], a[88:91], v[32:35]
ds_read_b64_tr_b16 a[24:25], v15 offset:42752
v_mfma_f32_16x16x32_bf16 v[36:39], a[32:35], a[92:95], v[36:39]
ds_read_b64_tr_b16 a[26:27], v15 offset:44864
v_mfma_f32_16x16x32_bf16 v[36:39], a[36:39], a[80:83], v[36:39]
s_waitcnt lgkmcnt(6)
v_mfma_f32_16x16x32_bf16 v[36:39], a[40:43], a[68:71], v[36:39]
ds_read_b64_tr_b16 a[28:29], v15 offset:46976
v_mfma_f32_16x16x32_bf16 v[36:39], a[44:47], a[56:59], v[36:39]
ds_read_b64_tr_b16 a[30:31], v15 offset:49088
v_mfma_f32_16x16x32_bf16 v[32:35], a[44:47], a[52:55], v[32:35]
s_waitcnt vmcnt(7)
v_mov_b32 v250, 4
buffer_store_dword v250, v157, s[80:83], 0 offen sc1
v_mfma_f32_16x16x32_bf16 v[32:35], a[40:43], a[64:67], v[32:35]
ds_read_b64_tr_b16 a[32:33], v8 offset:46976
v_mfma_f32_16x16x32_bf16 v[28:31], a[40:43], a[60:63], v[28:31]
ds_read_b64_tr_b16 a[34:35], v8 offset:49088
s_waitcnt vmcnt(47)
s_barrier
v_mfma_f32_16x16x32_bf16 v[28:31], a[44:47], a[48:51], v[28:31]
s_waitcnt lgkmcnt(6)
v_mfma_f32_16x16x32_bf16 v[40:43], a[16:19], a[48:51], v[40:43]
ds_read_b64_tr_b16 a[36:37], v8 offset:42752
v_mfma_f32_16x16x32_bf16 v[40:43], a[20:23], a[60:63], v[40:43]
ds_read_b64_tr_b16 a[38:39], v8 offset:44864
v_mfma_f32_16x16x32_bf16 v[44:47], a[20:23], a[64:67], v[44:47]
buffer_load_dwordx4 v6, s[32:35], s50 offen offset:2112 lds
v_mfma_f32_16x16x32_bf16 v[44:47], a[16:19], a[52:55], v[44:47]
ds_read_b64_tr_b16 a[40:41], v8 offset:38528
v_mfma_f32_16x16x32_bf16 v[48:51], a[16:19], a[56:59], v[48:51]
ds_read_b64_tr_b16 a[42:43], v8 offset:40640
v_mfma_f32_16x16x32_bf16 v[48:51], a[20:23], a[68:71], v[48:51]
s_waitcnt lgkmcnt(6)
v_mfma_f32_16x16x32_bf16 v[48:51], a[24:27], a[80:83], v[48:51]
ds_read_b64_tr_b16 a[44:45], v8 offset:34304
v_mfma_f32_16x16x32_bf16 v[48:51], a[28:31], a[92:95], v[48:51]
ds_read_b64_tr_b16 a[46:47], v8 offset:36416
v_mfma_f32_16x16x32_bf16 v[44:47], a[28:31], a[88:91], v[44:47]
buffer_load_dwordx4 v7, s[32:35], s50 offen offset:3168 lds
v_mfma_f32_16x16x32_bf16 v[44:47], a[24:27], a[76:79], v[44:47]
ds_read_b64_tr_b16 a[16:17], v15 offset:16896
v_mfma_f32_16x16x32_bf16 v[40:43], a[24:27], a[72:75], v[40:43]
ds_read_b64_tr_b16 a[18:19], v15 offset:19008
v_mfma_f32_16x16x32_bf16 v[40:43], a[28:31], a[84:87], v[40:43]
s_waitcnt lgkmcnt(6)
s_waitcnt vmcnt(18)
v_cmp_gt_u32 vcc, 3, v159
s_cbranch_vccnz SPIN_s2
RET_s2:
v_mfma_f32_16x16x32_bf16 v[52:55], a[32:35], a[84:87], v[52:55]
ds_read_b64_tr_b16 a[20:21], v15 offset:21120
v_mfma_f32_16x16x32_bf16 v[52:55], a[36:39], a[72:75], v[52:55]
ds_read_b64_tr_b16 a[22:23], v15 offset:23232
v_mfma_f32_16x16x32_bf16 v[56:59], a[36:39], a[76:79], v[56:59]
buffer_load_dwordx4 v[184:187], v252, s[76:79], s84 offen sc1
s_add_u32 s84, s84, 172032
v_mfma_f32_16x16x32_bf16 v[56:59], a[32:35], a[88:91], v[56:59]
ds_read_b64_tr_b16 a[24:25], v15 offset:25344
v_mfma_f32_16x16x32_bf16 v[60:63], a[32:35], a[92:95], v[60:63]
ds_read_b64_tr_b16 a[26:27], v15 offset:27456
v_mfma_f32_16x16x32_bf16 v[60:63], a[36:39], a[80:83], v[60:63]
s_waitcnt lgkmcnt(6)
v_mfma_f32_16x16x32_bf16 v[60:63], a[40:43], a[68:71], v[60:63]
ds_read_b64_tr_b16 a[28:29], v15 offset:29568
v_mfma_f32_16x16x32_bf16 v[60:63], a[44:47], a[56:59], v[60:63]
ds_read_b64_tr_b16 a[30:31], v15 offset:31680
v_mfma_f32_16x16x32_bf16 v[56:59], a[44:47], a[52:55], v[56:59]
buffer_load_dwordx4 v[188:191], v252, s[76:79], s84 offen sc1
s_add_u32 s84, s84, 172032
v_mfma_f32_16x16x32_bf16 v[56:59], a[40:43], a[64:67], v[56:59]
ds_read_b64_tr_b16 a[32:33], v8 offset:29568
v_mfma_f32_16x16x32_bf16 v[52:55], a[40:43], a[60:63], v[52:55]
ds_read_b64_tr_b16 a[34:35], v8 offset:31680
v_mfma_f32_16x16x32_bf16 v[52:55], a[44:47], a[48:51], v[52:55]
s_waitcnt lgkmcnt(6)
LS_111:
v_mfma_f32_16x16x32_bf16 v[16:19], a[16:19], a[96:99], v[16:19]
ds_read_b64_tr_b16 a[36:37], v8 offset:25344
v_mfma_f32_16x16x32_bf16 v[16:19], a[20:23], a[108:111], v[16:19]
ds_read_b64_tr_b16 a[38:39], v8 offset:27456
v_mfma_f32_16x16x32_bf16 v[20:23], a[20:23], a[112:115], v[20:23]
buffer_load_dwordx4 v[192:195], v252, s[76:79], s84 offen sc1
s_add_u32 s84, s84, 172032
v_mfma_f32_16x16x32_bf16 v[20:23], a[16:19], a[100:103], v[20:23]
ds_read_b64_tr_b16 a[40:41], v8 offset:21120
v_mfma_f32_16x16x32_bf16 v[24:27], a[16:19], a[104:107], v[24:27]
ds_read_b64_tr_b16 a[42:43], v8 offset:23232
v_mfma_f32_16x16x32_bf16 v[24:27], a[20:23], a[116:119], v[24:27]
s_waitcnt lgkmcnt(6)
v_mfma_f32_16x16x32_bf16 v[24:27], a[24:27], a[128:131], v[24:27]
ds_read_b64_tr_b16 a[44:45], v8 offset:16896
v_mfma_f32_16x16x32_bf16 v[24:27], a[28:31], a[140:143], v[24:27]
ds_read_b64_tr_b16 a[46:47], v8 offset:19008
v_mfma_f32_16x16x32_bf16 v[20:23], a[28:31], a[136:139], v[20:23]
buffer_load_dwordx4 v[196:199], v252, s[76:79], s84 offen sc1
s_add_u32 s84, s84, 172032
v_mfma_f32_16x16x32_bf16 v[20:23], a[24:27], a[124:127], v[20:23]
ds_read_b64_tr_b16 a[16:17], v15 offset:17408
v_mfma_f32_16x16x32_bf16 v[16:19], a[24:27], a[120:123], v[16:19]
ds_read_b64_tr_b16 a[18:19], v15 offset:19520
v_mfma_f32_16x16x32_bf16 v[16:19], a[28:31], a[132:135], v[16:19]
s_waitcnt lgkmcnt(6)
v_mfma_f32_16x16x32_bf16 v[28:31], a[32:35], a[132:135], v[28:31]
ds_read_b64_tr_b16 a[20:21], v15 offset:21632
v_mfma_f32_16x16x32_bf16 v[28:31], a[36:39], a[120:123], v[28:31]
ds_read_b64_tr_b16 a[22:23], v15 offset:23744
v_mfma_f32_16x16x32_bf16 v[32:35], a[36:39], a[124:127], v[32:35]
buffer_load_dwordx4 v[200:203], v252, s[76:79], s84 offen sc1
s_add_u32 s84, s84, 172032
v_mfma_f32_16x16x32_bf16 v[32:35], a[32:35], a[136:139], v[32:35]
ds_read_b64_tr_b16 a[24:25], v15 offset:25856
v_mfma_f32_16x16x32_bf16 v[36:39], a[32:35], a[140:143], v[36:39]
ds_read_b64_tr_b16 a[26:27], v15 offset:27968
v_mfma_f32_16x16x32_bf16 v[36:39], a[36:39], a[128:131], v[36:39]
s_waitcnt lgkmcnt(6)
v_mfma_f32_16x16x32_bf16 v[36:39], a[40:43], a[116:119], v[36:39]
ds_read_b64_tr_b16 a[28:29], v15 offset:30080
v_mfma_f32_16x16x32_bf16 v[36:39], a[44:47], a[104:107], v[36:39]
ds_read_b64_tr_b16 a[30:31], v15 offset:32192
v_mfma_f32_16x16x32_bf16 v[32:35], a[44:47], a[100:103], v[32:35]
s_waitcnt vmcnt(44)
s_barrier
v_mfma_f32_16x16x32_bf16 v[32:35], a[40:43], a[112:115], v[32:35]
ds_read_b64_tr_b16 a[32:33], v8 offset:30080
v_mfma_f32_16x16x32_bf16 v[28:31], a[40:43], a[108:111], v[28:31]
ds_read_b64_tr_b16 a[34:35], v8 offset:32192
v_cvt_pk_bf16_f32 v132, v24, v25
v_mfma_f32_16x16x32_bf16 v[28:31], a[44:47], a[96:99], v[28:31]
s_waitcnt lgkmcnt(6)
v_cvt_pk_bf16_f32 v133, v26, v27
v_mfma_f32_16x16x32_bf16 v[40:43], a[16:19], a[96:99], v[40:43]
ds_read_b64_tr_b16 a[36:37], v8 offset:25856
v_cvt_pk_bf16_f32 v134, v36, v37
v_mfma_f32_16x16x32_bf16 v[40:43], a[20:23], a[108:111], v[40:43]
ds_read_b64_tr_b16 a[38:39], v8 offset:27968
v_cvt_pk_bf16_f32 v135, v38, v39
v_mfma_f32_16x16x32_bf16 v[44:47], a[20:23], a[112:115], v[44:47]
buffer_load_dwordx4 v[204:207], v252, s[76:79], s84 offen sc1
s_add_u32 s84, s84, 172032
v_mfma_f32_16x16x32_bf16 v[44:47], a[16:19], a[100:103], v[44:47]
ds_read_b64_tr_b16 a[40:41], v8 offset:21632
v_cvt_pk_bf16_f32 v128, v20, v21
v_mfma_f32_16x16x32_bf16 v[48:51], a[16:19], a[104:107], v[48:51]
ds_read_b64_tr_b16 a[42:43], v8 offset:23744
v_cvt_pk_bf16_f32 v129, v22, v23
v_mfma_f32_16x16x32_bf16 v[48:51], a[20:23], a[116:119], v[48:51]
s_waitcnt lgkmcnt(6)
v_cvt_pk_bf16_f32 v130, v32, v33
v_mfma_f32_16x16x32_bf16 v[48:51], a[24:27], a[128:131], v[48:51]
ds_read_b64_tr_b16 a[44:45], v8 offset:17408
v_cvt_pk_bf16_f32 v131, v34, v35
v_mfma_f32_16x16x32_bf16 v[48:51], a[28:31], a[140:143], v[48:51]
ds_read_b64_tr_b16 a[46:47], v8 offset:19520
v_cvt_pk_bf16_f32 v124, v16, v17
v_mfma_f32_16x16x32_bf16 v[44:47], a[28:31], a[136:139], v[44:47]
buffer_load_dwordx4 v[208:211], v252, s[76:79], s84 offen sc1
s_add_u32 s84, s84, 172032
v_mfma_f32_16x16x32_bf16 v[44:47], a[24:27], a[124:127], v[44:47]
v_subrev_u32 v15, 50688, v15
ds_read_b64_tr_b16 a[16:17], v15 offset:33792
v_mfma_f32_16x16x32_bf16 v[40:43], a[24:27], a[120:123], v[40:43]
ds_read_b64_tr_b16 a[18:19], v15 offset:35904
v_cvt_pk_bf16_f32 v125, v18, v19
v_mfma_f32_16x16x32_bf16 v[40:43], a[28:31], a[132:135], v[40:43]
s_waitcnt lgkmcnt(6)
buffer_load_dwordx4 v[212:215], v252, s[76:79], s84 offen sc1
v_mfma_f32_16x16x32_bf16 v[52:55], a[32:35], a[132:135], v[52:55]
ds_read_b64_tr_b16 a[20:21], v15 offset:38016
v_cvt_pk_bf16_f32 v126, v28, v29
v_mfma_f32_16x16x32_bf16 v[52:55], a[36:39], a[120:123], v[52:55]
ds_read_b64_tr_b16 a[22:23], v15 offset:40128
s_add_u32 m0, s17, 67584
s_add_u32 s50, s58, 229376
v_mfma_f32_16x16x32_bf16 v[56:59], a[36:39], a[124:127], v[56:59]
buffer_load_dwordx4 v4, s[32:35], s50 offen offset:0 lds
v_mfma_f32_16x16x32_bf16 v[56:59], a[32:35], a[136:139], v[56:59]
ds_read_b64_tr_b16 a[24:25], v15 offset:42240
v_cvt_pk_bf16_f32 v127, v30, v31
v_mfma_f32_16x16x32_bf16 v[60:63], a[32:35], a[140:143], v[60:63]
ds_read_b64_tr_b16 a[26:27], v15 offset:44352
v_mfma_f32_16x16x32_bf16 v[60:63], a[36:39], a[128:131], v[60:63]
s_waitcnt lgkmcnt(6)
buffer_load_dwordx4 v5, s[32:35], s50 offen offset:1056 lds
v_mfma_f32_16x16x32_bf16 v[60:63], a[40:43], a[116:119], v[60:63]
ds_read_b64_tr_b16 a[28:29], v15 offset:46464
v_mfma_f32_16x16x32_bf16 v[60:63], a[44:47], a[104:107], v[60:63]
ds_read_b64_tr_b16 a[30:31], v15 offset:48576
v_mfma_f32_16x16x32_bf16 v[56:59], a[44:47], a[100:103], v[56:59]
buffer_load_dwordx4 v6, s[32:35], s50 offen offset:2112 lds
v_mfma_f32_16x16x32_bf16 v[56:59], a[40:43], a[112:115], v[56:59]
v_subrev_u32 v8, 50688, v8
ds_read_b64_tr_b16 a[32:33], v8 offset:46464
v_mfma_f32_16x16x32_bf16 v[52:55], a[40:43], a[108:111], v[52:55]
ds_read_b64_tr_b16 a[34:35], v8 offset:48576
v_cvt_pk_bf16_f32 v144, v48, v49
v_mfma_f32_16x16x32_bf16 v[52:55], a[44:47], a[96:99], v[52:55]
s_waitcnt lgkmcnt(6)
buffer_load_dwordx4 v7, s[32:35], s50 offen offset:3168 lds
LS_112:
v_mfma_f32_16x16x32_bf16 v[76:79], a[16:19], a[144:147], 0
ds_read_b64_tr_b16 a[36:37], v8 offset:42240
v_cvt_pk_bf16_f32 v145, v50, v51
v_mfma_f32_16x16x32_bf16 v[76:79], a[20:23], a[156:159], v[76:79]
ds_read_b64_tr_b16 a[38:39], v8 offset:44352
v_cvt_pk_bf16_f32 v146, v60, v61
v_mfma_f32_16x16x32_bf16 v[80:83], a[20:23], a[160:163], 0
s_add_u32 m0, s17, 135168
s_add_u32 s50, s58, 344064
v_mfma_f32_16x16x32_bf16 v[80:83], a[16:19], a[148:151], v[80:83]
ds_read_b64_tr_b16 a[40:41], v8 offset:38016
v_cvt_pk_bf16_f32 v147, v62, v63
v_mfma_f32_16x16x32_bf16 v[84:87], a[16:19], a[152:155], 0
ds_read_b64_tr_b16 a[42:43], v8 offset:40128
v_cvt_pk_bf16_f32 v140, v44, v45
v_mfma_f32_16x16x32_bf16 v[84:87], a[20:23], a[164:167], v[84:87]
s_waitcnt lgkmcnt(6)
v_cvt_pk_bf16_f32 v141, v46, v47
v_mfma_f32_16x16x32_bf16 v[84:87], a[24:27], a[176:179], v[84:87]
ds_read_b64_tr_b16 a[44:45], v8 offset:33792
v_cvt_pk_bf16_f32 v142, v56, v57
v_mfma_f32_16x16x32_bf16 v[84:87], a[28:31], a[188:191], v[84:87]
ds_read_b64_tr_b16 a[46:47], v8 offset:35904
v_cvt_pk_bf16_f32 v143, v58, v59
v_mfma_f32_16x16x32_bf16 v[80:83], a[28:31], a[184:187], v[80:83]
buffer_load_dwordx4 v4, s[32:35], s50 offen offset:0 lds
v_mfma_f32_16x16x32_bf16 v[80:83], a[24:27], a[172:175], v[80:83]
ds_read_b64_tr_b16 a[16:17], v15 offset:34304
v_cvt_pk_bf16_f32 v136, v40, v41
v_mfma_f32_16x16x32_bf16 v[76:79], a[24:27], a[168:171], v[76:79]
ds_read_b64_tr_b16 a[18:19], v15 offset:36416
v_cvt_pk_bf16_f32 v137, v42, v43
v_mfma_f32_16x16x32_bf16 v[76:79], a[28:31], a[180:183], v[76:79]
s_waitcnt lgkmcnt(6)
v_cvt_pk_bf16_f32 v138, v52, v53
v_mfma_f32_16x16x32_bf16 v[88:91], a[32:35], a[180:183], 0
ds_read_b64_tr_b16 a[20:21], v15 offset:38528
v_cvt_pk_bf16_f32 v139, v54, v55
v_mfma_f32_16x16x32_bf16 v[88:91], a[36:39], a[168:171], v[88:91]
ds_read_b64_tr_b16 a[22:23], v15 offset:40640
v_mfma_f32_16x16x32_bf16 v[92:95], a[36:39], a[172:175], 0
buffer_load_dwordx4 v5, s[32:35], s50 offen offset:1056 lds
v_mfma_f32_16x16x32_bf16 v[92:95], a[32:35], a[184:187], v[92:95]
ds_read_b64_tr_b16 a[24:25], v15 offset:42752
v_mfma_f32_16x16x32_bf16 v[96:99], a[32:35], a[188:191], 0
ds_read_b64_tr_b16 a[26:27], v15 offset:44864
v_mfma_f32_16x16x32_bf16 v[96:99], a[36:39], a[176:179], v[96:99]
s_waitcnt lgkmcnt(6)
v_mfma_f32_16x16x32_bf16 v[96:99], a[40:43], a[164:167], v[96:99]
ds_read_b64_tr_b16 a[28:29], v15 offset:46976
v_mfma_f32_16x16x32_bf16 v[96:99], a[44:47], a[152:155], v[96:99]
ds_read_b64_tr_b16 a[30:31], v15 offset:49088
v_mfma_f32_16x16x32_bf16 v[92:95], a[44:47], a[148:151], v[92:95]
s_waitcnt vmcnt(47)
s_barrier
v_mfma_f32_16x16x32_bf16 v[92:95], a[40:43], a[160:163], v[92:95]
ds_read_b64_tr_b16 a[32:33], v8 offset:46976
v_mfma_f32_16x16x32_bf16 v[88:91], a[40:43], a[156:159], v[88:91]
ds_read_b64_tr_b16 a[34:35], v8 offset:49088
v_mfma_f32_16x16x32_bf16 v[88:91], a[44:47], a[144:147], v[88:91]
s_waitcnt lgkmcnt(6)
buffer_load_dword v159, v158, s[80:83], 0 offen sc1
v_mfma_f32_16x16x32_bf16 v[100:103], a[16:19], a[144:147], 0
ds_read_b64_tr_b16 a[36:37], v8 offset:42752
v_mfma_f32_16x16x32_bf16 v[100:103], a[20:23], a[156:159], v[100:103]
ds_read_b64_tr_b16 a[38:39], v8 offset:44864
v_mfma_f32_16x16x32_bf16 v[104:107], a[20:23], a[160:163], 0
buffer_load_dwordx4 v6, s[32:35], s50 offen offset:2112 lds
v_mfma_f32_16x16x32_bf16 v[104:107], a[16:19], a[148:151], v[104:107]
ds_read_b64_tr_b16 a[40:41], v8 offset:38528
v_mfma_f32_16x16x32_bf16 v[108:111], a[16:19], a[152:155], 0
ds_read_b64_tr_b16 a[42:43], v8 offset:40640
v_mfma_f32_16x16x32_bf16 v[108:111], a[20:23], a[164:167], v[108:111]
s_waitcnt lgkmcnt(6)
v_mfma_f32_16x16x32_bf16 v[108:111], a[24:27], a[176:179], v[108:111]
ds_read_b64_tr_b16 a[44:45], v8 offset:34304
v_mfma_f32_16x16x32_bf16 v[108:111], a[28:31], a[188:191], v[108:111]
ds_read_b64_tr_b16 a[46:47], v8 offset:36416
v_mfma_f32_16x16x32_bf16 v[104:107], a[28:31], a[184:187], v[104:107]
buffer_load_dwordx4 v7, s[32:35], s50 offen offset:3168 lds
v_mfma_f32_16x16x32_bf16 v[104:107], a[24:27], a[172:175], v[104:107]
v_add_u32 v15, 50688, v15
ds_read_b64_tr_b16 a[16:17], v15 offset:0
v_mfma_f32_16x16x32_bf16 v[100:103], a[24:27], a[168:171], v[100:103]
ds_read_b64_tr_b16 a[18:19], v15 offset:2112
v_mfma_f32_16x16x32_bf16 v[100:103], a[28:31], a[180:183], v[100:103]
s_waitcnt lgkmcnt(6)
v_mfma_f32_16x16x32_bf16 v[112:115], a[32:35], a[180:183], 0
ds_read_b64_tr_b16 a[20:21], v15 offset:4224
v_mfma_f32_16x16x32_bf16 v[112:115], a[36:39], a[168:171], v[112:115]
ds_read_b64_tr_b16 a[22:23], v15 offset:6336
v_mfma_f32_16x16x32_bf16 v[116:119], a[36:39], a[172:175], 0
s_mov_b32 s51, 24576
buffer_store_dwordx4 v[124:127], v252, s[40:43], s51 offen sc1
v_mfma_f32_16x16x32_bf16 v[116:119], a[32:35], a[184:187], v[116:119]
ds_read_b64_tr_b16 a[24:25], v15 offset:8448
v_mfma_f32_16x16x32_bf16 v[120:123], a[32:35], a[188:191], 0
ds_read_b64_tr_b16 a[26:27], v15 offset:10560
v_mfma_f32_16x16x32_bf16 v[120:123], a[36:39], a[176:179], v[120:123]
s_waitcnt lgkmcnt(6)
v_mfma_f32_16x16x32_bf16 v[120:123], a[40:43], a[164:167], v[120:123]
ds_read_b64_tr_b16 a[28:29], v15 offset:12672
v_mfma_f32_16x16x32_bf16 v[120:123], a[44:47], a[152:155], v[120:123]
ds_read_b64_tr_b16 a[30:31], v15 offset:14784
v_mfma_f32_16x16x32_bf16 v[116:119], a[44:47], a[148:151], v[116:119]
s_mov_b32 s51, 25600
buffer_store_dwordx4 v[128:131], v252, s[40:43], s51 offen sc1
v_mfma_f32_16x16x32_bf16 v[116:119], a[40:43], a[160:163], v[116:119]
v_add_u32 v8, 50688, v8
ds_read_b64_tr_b16 a[32:33], v8 offset:12672
v_mfma_f32_16x16x32_bf16 v[112:115], a[40:43], a[156:159], v[112:115]
ds_read_b64_tr_b16 a[34:35], v8 offset:14784
v_mfma_f32_16x16x32_bf16 v[112:115], a[44:47], a[144:147], v[112:115]
s_waitcnt lgkmcnt(6)
LS_113:
v_mfma_f32_16x16x32_bf16 v[76:79], a[16:19], a[192:195], v[76:79]
ds_read_b64_tr_b16 a[36:37], v8 offset:8448
v_mfma_f32_16x16x32_bf16 v[76:79], a[20:23], a[204:207], v[76:79]
ds_read_b64_tr_b16 a[38:39], v8 offset:10560
s_mov_b32 s51, 26624
buffer_store_dwordx4 v[132:135], v252, s[40:43], s51 offen sc1
v_mfma_f32_16x16x32_bf16 v[80:83], a[20:23], a[208:211], v[80:83]
s_mov_b32 s51, 27648
buffer_store_dwordx4 v[136:139], v252, s[40:43], s51 offen sc1
v_mfma_f32_16x16x32_bf16 v[80:83], a[16:19], a[196:199], v[80:83]
ds_read_b64_tr_b16 a[40:41], v8 offset:4224
s_mov_b32 s51, 28672
buffer_store_dwordx4 v[140:143], v252, s[40:43], s51 offen sc1
v_mfma_f32_16x16x32_bf16 v[84:87], a[16:19], a[200:203], v[84:87]
ds_read_b64_tr_b16 a[42:43], v8 offset:6336
v_mfma_f32_16x16x32_bf16 v[84:87], a[20:23], a[212:215], v[84:87]
s_waitcnt lgkmcnt(6)
s_mov_b32 s51, 29696
buffer_store_dwordx4 v[144:147], v252, s[40:43], s51 offen sc1
v_mfma_f32_16x16x32_bf16 v[84:87], a[24:27], a[224:227], v[84:87]
ds_read_b64_tr_b16 a[44:45], v8 offset:0
v_mfma_f32_16x16x32_bf16 v[84:87], a[28:31], a[236:239], v[84:87]
ds_read_b64_tr_b16 a[46:47], v8 offset:2112
v_mfma_f32_16x16x32_bf16 v[80:83], a[28:31], a[232:235], v[80:83]
v_mfma_f32_16x16x32_bf16 v[80:83], a[24:27], a[220:223], v[80:83]
ds_read_b64_tr_b16 a[16:17], v15 offset:512
v_mfma_f32_16x16x32_bf16 v[76:79], a[24:27], a[216:219], v[76:79]
ds_read_b64_tr_b16 a[18:19], v15 offset:2624
v_mfma_f32_16x16x32_bf16 v[76:79], a[28:31], a[228:231], v[76:79]
s_waitcnt lgkmcnt(6)
v_mfma_f32_16x16x32_bf16 v[88:91], a[32:35], a[228:231], v[88:91]
ds_read_b64_tr_b16 a[20:21], v15 offset:4736
v_mfma_f32_16x16x32_bf16 v[88:91], a[36:39], a[216:219], v[88:91]
ds_read_b64_tr_b16 a[22:23], v15 offset:6848
v_mfma_f32_16x16x32_bf16 v[92:95], a[36:39], a[220:223], v[92:95]
v_mfma_f32_16x16x32_bf16 v[92:95], a[32:35], a[232:235], v[92:95]
ds_read_b64_tr_b16 a[24:25], v15 offset:8960
v_mfma_f32_16x16x32_bf16 v[96:99], a[32:35], a[236:239], v[96:99]
ds_read_b64_tr_b16 a[26:27], v15 offset:11072
v_mfma_f32_16x16x32_bf16 v[96:99], a[36:39], a[224:227], v[96:99]
s_waitcnt lgkmcnt(6)
v_mfma_f32_16x16x32_bf16 v[96:99], a[40:43], a[212:215], v[96:99]
ds_read_b64_tr_b16 a[28:29], v15 offset:13184
v_mfma_f32_16x16x32_bf16 v[96:99], a[44:47], a[200:203], v[96:99]
ds_read_b64_tr_b16 a[30:31], v15 offset:15296
v_mfma_f32_16x16x32_bf16 v[92:95], a[44:47], a[196:199], v[92:95]
s_waitcnt vmcnt(44)
s_barrier
v_mfma_f32_16x16x32_bf16 v[92:95], a[40:43], a[208:211], v[92:95]
ds_read_b64_tr_b16 a[32:33], v8 offset:13184
v_mfma_f32_16x16x32_bf16 v[88:91], a[40:43], a[204:207], v[88:91]
ds_read_b64_tr_b16 a[34:35], v8 offset:15296
s_waitcnt vmcnt(15)
v_mfma_f32_16x16x32_bf16 v[164:167], v[150:153], v[186:189], 0
v_mfma_f32_16x16x32_bf16 v[164:167], v[150:153], v[194:197], v[164:167]
v_mfma_f32_16x16x32_bf16 v[164:167], v[150:153], v[202:205], v[164:167]
v_mfma_f32_16x16x32_bf16 v[164:167], v[150:153], v[210:213], v[164:167]
v_mfma_f32_16x16x32_bf16 v[160:163], v[150:153], v[190:193], 0
v_mfma_f32_16x16x32_bf16 v[160:163], v[150:153], v[198:201], v[160:163]
v_mfma_f32_16x16x32_bf16 v[160:163], v[150:153], v[206:209], v[160:163]
v_mfma_f32_16x16x32_bf16 v[160:163], v[152:155], v[184:187], v[160:163]
v_mfma_f32_16x16x32_bf16 v[160:163], v[148:151], v[212:215], v[160:163]
v_mfma_f32_16x16x32_bf16 v[88:91], a[44:47], a[192:195], v[88:91]
s_waitcnt lgkmcnt(6)
v_mfma_f32_16x16x32_bf16 v[100:103], a[16:19], a[192:195], v[100:103]
ds_read_b64_tr_b16 a[36:37], v8 offset:8960
v_mfma_f32_16x16x32_bf16 v[100:103], a[20:23], a[204:207], v[100:103]
ds_read_b64_tr_b16 a[38:39], v8 offset:11072
v_mfma_f32_16x16x32_bf16 v[104:107], a[20:23], a[208:211], v[104:107]
s_nop 0
v_cvt_pk_bf16_f32 v176, v160, v161
v_mfma_f32_16x16x32_bf16 v[104:107], a[16:19], a[196:199], v[104:107]
ds_read_b64_tr_b16 a[40:41], v8 offset:4736
v_cvt_pk_bf16_f32 v177, v162, v163
v_mfma_f32_16x16x32_bf16 v[108:111], a[16:19], a[200:203], v[108:111]
ds_read_b64_tr_b16 a[42:43], v8 offset:6848
v_cvt_pk_bf16_f32 v178, v164, v165
v_mfma_f32_16x16x32_bf16 v[108:111], a[20:23], a[212:215], v[108:111]
s_waitcnt lgkmcnt(6)
v_cvt_pk_bf16_f32 v179, v166, v167
v_mfma_f32_16x16x32_bf16 v[108:111], a[24:27], a[224:227], v[108:111]
ds_read_b64_tr_b16 a[44:45], v8 offset:512
v_mfma_f32_16x16x32_bf16 v[108:111], a[28:31], a[236:239], v[108:111]
ds_read_b64_tr_b16 a[46:47], v8 offset:2624
v_permlane32_swap_b32 v176, v178
v_mfma_f32_16x16x32_bf16 v[104:107], a[28:31], a[232:235], v[104:107]
v_mfma_f32_16x16x32_bf16 v[104:107], a[24:27], a[220:223], v[104:107]
v_subrev_u32 v15, 101376, v15
ds_read_b64_tr_b16 a[16:17], v15 offset:16896
v_mfma_f32_16x16x32_bf16 v[100:103], a[24:27], a[216:219], v[100:103]
ds_read_b64_tr_b16 a[18:19], v15 offset:19008
v_permlane32_swap_b32 v177, v179
v_mfma_f32_16x16x32_bf16 v[100:103], a[28:31], a[228:231], v[100:103]
s_waitcnt lgkmcnt(6)
v_mfma_f32_16x16x32_bf16 v[112:115], a[32:35], a[228:231], v[112:115]
ds_read_b64_tr_b16 a[20:21], v15 offset:21120
v_permlane16_swap_b32 v176, v178
v_mfma_f32_16x16x32_bf16 v[112:115], a[36:39], a[216:219], v[112:115]
ds_read_b64_tr_b16 a[22:23], v15 offset:23232
v_mfma_f32_16x16x32_bf16 v[116:119], a[36:39], a[220:223], v[116:119]
v_permlane16_swap_b32 v177, v179
v_mfma_f32_16x16x32_bf16 v[116:119], a[32:35], a[232:235], v[116:119]
ds_read_b64_tr_b16 a[24:25], v15 offset:25344
buffer_store_dwordx4 v[176:179], v156, s[68:71], s8 offen
v_mfma_f32_16x16x32_bf16 v[120:123], a[32:35], a[236:239], v[120:123]
ds_read_b64_tr_b16 a[26:27], v15 offset:27456
v_mfma_f32_16x16x32_bf16 v[120:123], a[36:39], a[224:227], v[120:123]
s_waitcnt lgkmcnt(6)
v_mfma_f32_16x16x32_bf16 v[120:123], a[40:43], a[212:215], v[120:123]
ds_read_b64_tr_b16 a[28:29], v15 offset:29568
v_mfma_f32_16x16x32_bf16 v[120:123], a[44:47], a[200:203], v[120:123]
ds_read_b64_tr_b16 a[30:31], v15 offset:31680
v_mfma_f32_16x16x32_bf16 v[116:119], a[44:47], a[196:199], v[116:119]
v_mfma_f32_16x16x32_bf16 v[116:119], a[40:43], a[208:211], v[116:119]
v_subrev_u32 v8, 101376, v8
ds_read_b64_tr_b16 a[32:33], v8 offset:29568
v_mfma_f32_16x16x32_bf16 v[112:115], a[40:43], a[204:207], v[112:115]
ds_read_b64_tr_b16 a[34:35], v8 offset:31680
v_mfma_f32_16x16x32_bf16 v[112:115], a[44:47], a[192:195], v[112:115]
s_waitcnt lgkmcnt(6)
LS_114:
v_mfma_f32_16x16x32_bf16 v[76:79], a[16:19], a[48:51], v[76:79]
ds_read_b64_tr_b16 a[36:37], v8 offset:25344
v_mfma_f32_16x16x32_bf16 v[76:79], a[20:23], a[60:63], v[76:79]
ds_read_b64_tr_b16 a[38:39], v8 offset:27456
v_mfma_f32_16x16x32_bf16 v[80:83], a[20:23], a[64:67], v[80:83]
v_mfma_f32_16x16x32_bf16 v[80:83], a[16:19], a[52:55], v[80:83]
ds_read_b64_tr_b16 a[40:41], v8 offset:21120
v_mfma_f32_16x16x32_bf16 v[84:87], a[16:19], a[56:59], v[84:87]
ds_read_b64_tr_b16 a[42:43], v8 offset:23232
v_mfma_f32_16x16x32_bf16 v[84:87], a[20:23], a[68:71], v[84:87]
s_waitcnt lgkmcnt(6)
v_mfma_f32_16x16x32_bf16 v[84:87], a[24:27], a[80:83], v[84:87]
ds_read_b64_tr_b16 a[44:45], v8 offset:16896
v_mfma_f32_16x16x32_bf16 v[84:87], a[28:31], a[92:95], v[84:87]
ds_read_b64_tr_b16 a[46:47], v8 offset:19008
v_mfma_f32_16x16x32_bf16 v[80:83], a[28:31], a[88:91], v[80:83]
v_mfma_f32_16x16x32_bf16 v[80:83], a[24:27], a[76:79], v[80:83]
ds_read_b64_tr_b16 a[16:17], v15 offset:17408
v_mfma_f32_16x16x32_bf16 v[76:79], a[24:27], a[72:75], v[76:79]
ds_read_b64_tr_b16 a[18:19], v15 offset:19520
v_mfma_f32_16x16x32_bf16 v[76:79], a[28:31], a[84:87], v[76:79]
s_waitcnt lgkmcnt(6)
v_mfma_f32_16x16x32_bf16 v[88:91], a[32:35], a[84:87], v[88:91]
ds_read_b64_tr_b16 a[20:21], v15 offset:21632
v_mfma_f32_16x16x32_bf16 v[88:91], a[36:39], a[72:75], v[88:91]
ds_read_b64_tr_b16 a[22:23], v15 offset:23744
v_mfma_f32_16x16x32_bf16 v[92:95], a[36:39], a[76:79], v[92:95]
v_mfma_f32_16x16x32_bf16 v[92:95], a[32:35], a[88:91], v[92:95]
ds_read_b64_tr_b16 a[24:25], v15 offset:25856
v_mfma_f32_16x16x32_bf16 v[96:99], a[32:35], a[92:95], v[96:99]
ds_read_b64_tr_b16 a[26:27], v15 offset:27968
v_mfma_f32_16x16x32_bf16 v[96:99], a[36:39], a[80:83], v[96:99]
s_waitcnt lgkmcnt(6)
v_mfma_f32_16x16x32_bf16 v[96:99], a[40:43], a[68:71], v[96:99]
ds_read_b64_tr_b16 a[28:29], v15 offset:30080
v_mfma_f32_16x16x32_bf16 v[96:99], a[44:47], a[56:59], v[96:99]
ds_read_b64_tr_b16 a[30:31], v15 offset:32192
v_mfma_f32_16x16x32_bf16 v[92:95], a[44:47], a[52:55], v[92:95]
s_waitcnt vmcnt(1)
v_mov_b32 v250, 5
buffer_store_dword v250, v157, s[80:83], 0 offen sc1
v_mfma_f32_16x16x32_bf16 v[92:95], a[40:43], a[64:67], v[92:95]
ds_read_b64_tr_b16 a[32:33], v8 offset:30080
v_mfma_f32_16x16x32_bf16 v[88:91], a[40:43], a[60:63], v[88:91]
ds_read_b64_tr_b16 a[34:35], v8 offset:32192
s_waitcnt vmcnt(41)
s_barrier
v_mfma_f32_16x16x32_bf16 v[88:91], a[44:47], a[48:51], v[88:91]
s_waitcnt lgkmcnt(6)
v_mfma_f32_16x16x32_bf16 v[100:103], a[16:19], a[48:51], v[100:103]
ds_read_b64_tr_b16 a[36:37], v8 offset:25856
v_mfma_f32_16x16x32_bf16 v[100:103], a[20:23], a[60:63], v[100:103]
ds_read_b64_tr_b16 a[38:39], v8 offset:27968
v_mfma_f32_16x16x32_bf16 v[104:107], a[20:23], a[64:67], v[104:107]
v_mfma_f32_16x16x32_bf16 v[104:107], a[16:19], a[52:55], v[104:107]
ds_read_b64_tr_b16 a[40:41], v8 offset:21632
v_mfma_f32_16x16x32_bf16 v[108:111], a[16:19], a[56:59], v[108:111]
ds_read_b64_tr_b16 a[42:43], v8 offset:23744
v_mfma_f32_16x16x32_bf16 v[108:111], a[20:23], a[68:71], v[108:111]
s_waitcnt lgkmcnt(6)
v_mfma_f32_16x16x32_bf16 v[108:111], a[24:27], a[80:83], v[108:111]
ds_read_b64_tr_b16 a[44:45], v8 offset:17408
v_mfma_f32_16x16x32_bf16 v[108:111], a[28:31], a[92:95], v[108:111]
ds_read_b64_tr_b16 a[46:47], v8 offset:19520
v_mfma_f32_16x16x32_bf16 v[104:107], a[28:31], a[88:91], v[104:107]
v_mfma_f32_16x16x32_bf16 v[104:107], a[24:27], a[76:79], v[104:107]
ds_read_b64_tr_b16 a[16:17], v15 offset:0
v_mfma_f32_16x16x32_bf16 v[100:103], a[24:27], a[72:75], v[100:103]
ds_read_b64_tr_b16 a[18:19], v15 offset:2112
v_mfma_f32_16x16x32_bf16 v[100:103], a[28:31], a[84:87], v[100:103]
s_waitcnt lgkmcnt(6)
s_waitcnt vmcnt(10)
v_cmp_gt_u32 vcc, 4, v159
s_cbranch_vccnz SPIN_s3
RET_s3:
v_mfma_f32_16x16x32_bf16 v[112:115], a[32:35], a[84:87], v[112:115]
ds_read_b64_tr_b16 a[20:21], v15 offset:4224
v_mfma_f32_16x16x32_bf16 v[112:115], a[36:39], a[72:75], v[112:115]
ds_read_b64_tr_b16 a[22:23], v15 offset:6336
v_mfma_f32_16x16x32_bf16 v[116:119], a[36:39], a[76:79], v[116:119]
buffer_load_dwordx4 v[216:219], v252, s[76:79], s85 offen sc1
s_add_u32 s85, s85, 172032
v_mfma_f32_16x16x32_bf16 v[116:119], a[32:35], a[88:91], v[116:119]
ds_read_b64_tr_b16 a[24:25], v15 offset:8448
v_mfma_f32_16x16x32_bf16 v[120:123], a[32:35], a[92:95], v[120:123]
ds_read_b64_tr_b16 a[26:27], v15 offset:10560
v_mfma_f32_16x16x32_bf16 v[120:123], a[36:39], a[80:83], v[120:123]
s_waitcnt lgkmcnt(6)
v_mfma_f32_16x16x32_bf16 v[120:123], a[40:43], a[68:71], v[120:123]
ds_read_b64_tr_b16 a[28:29], v15 offset:12672
v_mfma_f32_16x16x32_bf16 v[120:123], a[44:47], a[56:59], v[120:123]
ds_read_b64_tr_b16 a[30:31], v15 offset:14784
v_mfma_f32_16x16x32_bf16 v[116:119], a[44:47], a[52:55], v[116:119]
buffer_load_dwordx4 v[220:223], v252, s[76:79], s85 offen sc1
s_add_u32 s85, s85, 172032
v_mfma_f32_16x16x32_bf16 v[116:119], a[40:43], a[64:67], v[116:119]
ds_read_b64_tr_b16 a[32:33], v8 offset:12672
v_mfma_f32_16x16x32_bf16 v[112:115], a[40:43], a[60:63], v[112:115]
ds_read_b64_tr_b16 a[34:35], v8 offset:14784
v_mfma_f32_16x16x32_bf16 v[112:115], a[44:47], a[48:51], v[112:115]
s_waitcnt lgkmcnt(6)
LS_115:
v_mfma_f32_16x16x32_bf16 v[76:79], a[16:19], a[96:99], v[76:79]
ds_read_b64_tr_b16 a[36:37], v8 offset:8448
v_mfma_f32_16x16x32_bf16 v[76:79], a[20:23], a[108:111], v[76:79]
ds_read_b64_tr_b16 a[38:39], v8 offset:10560
v_mfma_f32_16x16x32_bf16 v[80:83], a[20:23], a[112:115], v[80:83]
buffer_load_dwordx4 v[224:227], v252, s[76:79], s85 offen sc1
s_add_u32 s85, s85, 172032
v_mfma_f32_16x16x32_bf16 v[80:83], a[16:19], a[100:103], v[80:83]
ds_read_b64_tr_b16 a[40:41], v8 offset:4224
v_mfma_f32_16x16x32_bf16 v[84:87], a[16:19], a[104:107], v[84:87]
ds_read_b64_tr_b16 a[42:43], v8 offset:6336
v_mfma_f32_16x16x32_bf16 v[84:87], a[20:23], a[116:119], v[84:87]
s_waitcnt lgkmcnt(6)
v_mfma_f32_16x16x32_bf16 v[84:87], a[24:27], a[128:131], v[84:87]
ds_read_b64_tr_b16 a[44:45], v8 offset:0
v_mfma_f32_16x16x32_bf16 v[84:87], a[28:31], a[140:143], v[84:87]
ds_read_b64_tr_b16 a[46:47], v8 offset:2112
v_mfma_f32_16x16x32_bf16 v[80:83], a[28:31], a[136:139], v[80:83]
buffer_load_dwordx4 v[228:231], v252, s[76:79], s85 offen sc1
s_add_u32 s85, s85, 172032
v_mfma_f32_16x16x32_bf16 v[80:83], a[24:27], a[124:127], v[80:83]
ds_read_b64_tr_b16 a[16:17], v15 offset:512
v_mfma_f32_16x16x32_bf16 v[76:79], a[24:27], a[120:123], v[76:79]
ds_read_b64_tr_b16 a[18:19], v15 offset:2624
v_mfma_f32_16x16x32_bf16 v[76:79], a[28:31], a[132:135], v[76:79]
s_waitcnt lgkmcnt(6)
v_mfma_f32_16x16x32_bf16 v[88:91], a[32:35], a[132:135], v[88:91]
ds_read_b64_tr_b16 a[20:21], v15 offset:4736
v_mfma_f32_16x16x32_bf16 v[88:91], a[36:39], a[120:123], v[88:91]
ds_read_b64_tr_b16 a[22:23], v15 offset:6848
v_mfma_f32_16x16x32_bf16 v[92:95], a[36:39], a[124:127], v[92:95]
buffer_load_dwordx4 v[232:235], v252, s[76:79], s85 offen sc1
s_add_u32 s85, s85, 172032
v_mfma_f32_16x16x32_bf16 v[92:95], a[32:35], a[136:139], v[92:95]
ds_read_b64_tr_b16 a[24:25], v15 offset:8960
v_mfma_f32_16x16x32_bf16 v[96:99], a[32:35], a[140:143], v[96:99]
ds_read_b64_tr_b16 a[26:27], v15 offset:11072
v_mfma_f32_16x16x32_bf16 v[96:99], a[36:39], a[128:131], v[96:99]
s_waitcnt lgkmcnt(6)
v_mfma_f32_16x16x32_bf16 v[96:99], a[40:43], a[116:119], v[96:99]
ds_read_b64_tr_b16 a[28:29], v15 offset:13184
v_mfma_f32_16x16x32_bf16 v[96:99], a[44:47], a[104:107], v[96:99]
ds_read_b64_tr_b16 a[30:31], v15 offset:15296
v_mfma_f32_16x16x32_bf16 v[92:95], a[44:47], a[100:103], v[92:95]
s_waitcnt vmcnt(36)
s_barrier
v_mfma_f32_16x16x32_bf16 v[92:95], a[40:43], a[112:115], v[92:95]
ds_read_b64_tr_b16 a[32:33], v8 offset:13184
v_mfma_f32_16x16x32_bf16 v[88:91], a[40:43], a[108:111], v[88:91]
ds_read_b64_tr_b16 a[34:35], v8 offset:15296
v_cvt_pk_bf16_f32 v132, v84, v85
v_mfma_f32_16x16x32_bf16 v[88:91], a[44:47], a[96:99], v[88:91]
s_waitcnt lgkmcnt(6)
v_cvt_pk_bf16_f32 v133, v86, v87
v_mfma_f32_16x16x32_bf16 v[100:103], a[16:19], a[96:99], v[100:103]
ds_read_b64_tr_b16 a[36:37], v8 offset:8960
v_cvt_pk_bf16_f32 v134, v96, v97
v_mfma_f32_16x16x32_bf16 v[100:103], a[20:23], a[108:111], v[100:103]
ds_read_b64_tr_b16 a[38:39], v8 offset:11072
v_cvt_pk_bf16_f32 v135, v98, v99
v_mfma_f32_16x16x32_bf16 v[104:107], a[20:23], a[112:115], v[104:107]
buffer_load_dwordx4 v[236:239], v252, s[76:79], s85 offen sc1
s_add_u32 s85, s85, 172032
v_mfma_f32_16x16x32_bf16 v[104:107], a[16:19], a[100:103], v[104:107]
ds_read_b64_tr_b16 a[40:41], v8 offset:4736
v_cvt_pk_bf16_f32 v128, v80, v81
v_mfma_f32_16x16x32_bf16 v[108:111], a[16:19], a[104:107], v[108:111]
ds_read_b64_tr_b16 a[42:43], v8 offset:6848
v_cvt_pk_bf16_f32 v129, v82, v83
v_mfma_f32_16x16x32_bf16 v[108:111], a[20:23], a[116:119], v[108:111]
s_waitcnt lgkmcnt(6)
v_cvt_pk_bf16_f32 v130, v92, v93
v_mfma_f32_16x16x32_bf16 v[108:111], a[24:27], a[128:131], v[108:111]
ds_read_b64_tr_b16 a[44:45], v8 offset:512
v_cvt_pk_bf16_f32 v131, v94, v95
v_mfma_f32_16x16x32_bf16 v[108:111], a[28:31], a[140:143], v[108:111]
ds_read_b64_tr_b16 a[46:47], v8 offset:2624
v_cvt_pk_bf16_f32 v124, v76, v77
v_mfma_f32_16x16x32_bf16 v[104:107], a[28:31], a[136:139], v[104:107]
buffer_load_dwordx4 v[240:243], v252, s[76:79], s85 offen sc1
s_add_u32 s85, s85, 172032
v_mfma_f32_16x16x32_bf16 v[104:107], a[24:27], a[124:127], v[104:107]
ds_read_b64_tr_b16 a[16:17], v15 offset:33792
v_cvt_pk_bf16_f32 v125, v78, v79
v_mfma_f32_16x16x32_bf16 v[100:103], a[24:27], a[120:123], v[100:103]
ds_read_b64_tr_b16 a[18:19], v15 offset:35904
v_cvt_pk_bf16_f32 v126, v88, v89
v_mfma_f32_16x16x32_bf16 v[100:103], a[28:31], a[132:135], v[100:103]
s_waitcnt lgkmcnt(6)
buffer_load_dwordx4 v[244:247], v252, s[76:79], s85 offen sc1
v_mfma_f32_16x16x32_bf16 v[112:115], a[32:35], a[132:135], v[112:115]
ds_read_b64_tr_b16 a[20:21], v15 offset:38016
v_cvt_pk_bf16_f32 v127, v90, v91
v_mfma_f32_16x16x32_bf16 v[112:115], a[36:39], a[120:123], v[112:115]
ds_read_b64_tr_b16 a[22:23], v15 offset:40128
v_mfma_f32_16x16x32_bf16 v[116:119], a[36:39], a[124:127], v[116:119]
s_mov_b32 s51, 30720
buffer_store_dwordx4 v[124:127], v252, s[40:43], s51 offen sc1
v_mfma_f32_16x16x32_bf16 v[116:119], a[32:35], a[136:139], v[116:119]
ds_read_b64_tr_b16 a[24:25], v15 offset:42240
v_mfma_f32_16x16x32_bf16 v[120:123], a[32:35], a[140:143], v[120:123]
ds_read_b64_tr_b16 a[26:27], v15 offset:44352
v_mfma_f32_16x16x32_bf16 v[120:123], a[36:39], a[128:131], v[120:123]
s_waitcnt lgkmcnt(6)
v_mfma_f32_16x16x32_bf16 v[120:123], a[40:43], a[116:119], v[120:123]
ds_read_b64_tr_b16 a[28:29], v15 offset:46464
v_mfma_f32_16x16x32_bf16 v[120:123], a[44:47], a[104:107], v[120:123]
ds_read_b64_tr_b16 a[30:31], v15 offset:48576
v_mfma_f32_16x16x32_bf16 v[116:119], a[44:47], a[100:103], v[116:119]
s_mov_b32 s51, 31744
buffer_store_dwordx4 v[128:131], v252, s[40:43], s51 offen sc1
v_mfma_f32_16x16x32_bf16 v[116:119], a[40:43], a[112:115], v[116:119]
ds_read_b64_tr_b16 a[32:33], v8 offset:46464
v_mfma_f32_16x16x32_bf16 v[112:115], a[40:43], a[108:111], v[112:115]
ds_read_b64_tr_b16 a[34:35], v8 offset:48576
v_cvt_pk_bf16_f32 v144, v108, v109
v_mfma_f32_16x16x32_bf16 v[112:115], a[44:47], a[96:99], v[112:115]
s_waitcnt lgkmcnt(6)
v_cvt_pk_bf16_f32 v145, v110, v111
LS_116:
v_mfma_f32_16x16x32_bf16 v[16:19], a[16:19], a[144:147], 0
ds_read_b64_tr_b16 a[36:37], v8 offset:42240
v_cvt_pk_bf16_f32 v146, v120, v121
v_mfma_f32_16x16x32_bf16 v[16:19], a[20:23], a[156:159], v[16:19]
ds_read_b64_tr_b16 a[38:39], v8 offset:44352
v_cvt_pk_bf16_f32 v147, v122, v123
v_mfma_f32_16x16x32_bf16 v[20:23], a[20:23], a[160:163], 0
s_mov_b32 s51, 32768
buffer_store_dwordx4 v[132:135], v252, s[40:43], s51 offen sc1
v_mfma_f32_16x16x32_bf16 v[20:23], a[16:19], a[148:151], v[20:23]
ds_read_b64_tr_b16 a[40:41], v8 offset:38016
v_cvt_pk_bf16_f32 v140, v104, v105
v_mfma_f32_16x16x32_bf16 v[24:27], a[16:19], a[152:155], 0
ds_read_b64_tr_b16 a[42:43], v8 offset:40128
v_cvt_pk_bf16_f32 v141, v106, v107
v_mfma_f32_16x16x32_bf16 v[24:27], a[20:23], a[164:167], v[24:27]
s_waitcnt lgkmcnt(6)
v_cvt_pk_bf16_f32 v142, v116, v117
v_mfma_f32_16x16x32_bf16 v[24:27], a[24:27], a[176:179], v[24:27]
ds_read_b64_tr_b16 a[44:45], v8 offset:33792
v_cvt_pk_bf16_f32 v143, v118, v119
v_mfma_f32_16x16x32_bf16 v[24:27], a[28:31], a[188:191], v[24:27]
ds_read_b64_tr_b16 a[46:47], v8 offset:35904
v_cvt_pk_bf16_f32 v136, v100, v101
v_mfma_f32_16x16x32_bf16 v[20:23], a[28:31], a[184:187], v[20:23]
v_cvt_pk_bf16_f32 v137, v102, v103
v_cvt_pk_bf16_f32 v138, v112, v113
v_mfma_f32_16x16x32_bf16 v[20:23], a[24:27], a[172:175], v[20:23]
ds_read_b64_tr_b16 a[16:17], v15 offset:34304
v_cvt_pk_bf16_f32 v139, v114, v115
v_mfma_f32_16x16x32_bf16 v[16:19], a[24:27], a[168:171], v[16:19]
ds_read_b64_tr_b16 a[18:19], v15 offset:36416
v_mfma_f32_16x16x32_bf16 v[16:19], a[28:31], a[180:183], v[16:19]
s_waitcnt lgkmcnt(6)
v_mfma_f32_16x16x32_bf16 v[28:31], a[32:35], a[180:183], 0
ds_read_b64_tr_b16 a[20:21], v15 offset:38528
v_mfma_f32_16x16x32_bf16 v[28:31], a[36:39], a[168:171], v[28:31]
ds_read_b64_tr_b16 a[22:23], v15 offset:40640
v_mfma_f32_16x16x32_bf16 v[32:35], a[36:39], a[172:175], 0
s_mov_b32 s51, 33792
buffer_store_dwordx4 v[136:139], v252, s[40:43], s51 offen sc1
v_mfma_f32_16x16x32_bf16 v[32:35], a[32:35], a[184:187], v[32:35]
ds_read_b64_tr_b16 a[24:25], v15 offset:42752
v_mfma_f32_16x16x32_bf16 v[36:39], a[32:35], a[188:191], 0
ds_read_b64_tr_b16 a[26:27], v15 offset:44864
v_mfma_f32_16x16x32_bf16 v[36:39], a[36:39], a[176:179], v[36:39]
s_waitcnt lgkmcnt(6)
v_mfma_f32_16x16x32_bf16 v[36:39], a[40:43], a[164:167], v[36:39]
ds_read_b64_tr_b16 a[28:29], v15 offset:46976
v_mfma_f32_16x16x32_bf16 v[36:39], a[44:47], a[152:155], v[36:39]
ds_read_b64_tr_b16 a[30:31], v15 offset:49088
v_mfma_f32_16x16x32_bf16 v[32:35], a[44:47], a[148:151], v[32:35]
s_waitcnt vmcnt(37)
s_barrier
v_mfma_f32_16x16x32_bf16 v[32:35], a[40:43], a[160:163], v[32:35]
ds_read_b64_tr_b16 a[32:33], v8 offset:46976
v_mfma_f32_16x16x32_bf16 v[28:31], a[40:43], a[156:159], v[28:31]
ds_read_b64_tr_b16 a[34:35], v8 offset:49088
v_mfma_f32_16x16x32_bf16 v[28:31], a[44:47], a[144:147], v[28:31]
s_waitcnt lgkmcnt(6)
buffer_load_dword v159, v158, s[80:83], 0 offen sc1
v_mfma_f32_16x16x32_bf16 v[40:43], a[16:19], a[144:147], 0
ds_read_b64_tr_b16 a[36:37], v8 offset:42752
v_mfma_f32_16x16x32_bf16 v[40:43], a[20:23], a[156:159], v[40:43]
ds_read_b64_tr_b16 a[38:39], v8 offset:44864
v_mfma_f32_16x16x32_bf16 v[44:47], a[20:23], a[160:163], 0
s_mov_b32 s51, 34816
buffer_store_dwordx4 v[140:143], v252, s[40:43], s51 offen sc1
v_mfma_f32_16x16x32_bf16 v[44:47], a[16:19], a[148:151], v[44:47]
ds_read_b64_tr_b16 a[40:41], v8 offset:38528
v_mfma_f32_16x16x32_bf16 v[48:51], a[16:19], a[152:155], 0
ds_read_b64_tr_b16 a[42:43], v8 offset:40640
v_mfma_f32_16x16x32_bf16 v[48:51], a[20:23], a[164:167], v[48:51]
s_waitcnt lgkmcnt(6)
v_mfma_f32_16x16x32_bf16 v[48:51], a[24:27], a[176:179], v[48:51]
ds_read_b64_tr_b16 a[44:45], v8 offset:34304
v_mfma_f32_16x16x32_bf16 v[48:51], a[28:31], a[188:191], v[48:51]
ds_read_b64_tr_b16 a[46:47], v8 offset:36416
v_mfma_f32_16x16x32_bf16 v[44:47], a[28:31], a[184:187], v[44:47]
s_mov_b32 s51, 35840
buffer_store_dwordx4 v[144:147], v252, s[40:43], s51 offen sc1
v_mfma_f32_16x16x32_bf16 v[44:47], a[24:27], a[172:175], v[44:47]
v_add_u32 v15, 50688, v15
ds_read_b64_tr_b16 a[16:17], v15 offset:0
v_mfma_f32_16x16x32_bf16 v[40:43], a[24:27], a[168:171], v[40:43]
ds_read_b64_tr_b16 a[18:19], v15 offset:2112
v_mfma_f32_16x16x32_bf16 v[40:43], a[28:31], a[180:183], v[40:43]
s_waitcnt lgkmcnt(6)
v_mfma_f32_16x16x32_bf16 v[52:55], a[32:35], a[180:183], 0
ds_read_b64_tr_b16 a[20:21], v15 offset:4224
v_mfma_f32_16x16x32_bf16 v[52:55], a[36:39], a[168:171], v[52:55]
ds_read_b64_tr_b16 a[22:23], v15 offset:6336
v_mfma_f32_16x16x32_bf16 v[56:59], a[36:39], a[172:175], 0
v_mfma_f32_16x16x32_bf16 v[56:59], a[32:35], a[184:187], v[56:59]
ds_read_b64_tr_b16 a[24:25], v15 offset:8448
v_mfma_f32_16x16x32_bf16 v[60:63], a[32:35], a[188:191], 0
ds_read_b64_tr_b16 a[26:27], v15 offset:10560
v_mfma_f32_16x16x32_bf16 v[60:63], a[36:39], a[176:179], v[60:63]
s_waitcnt lgkmcnt(6)
v_mfma_f32_16x16x32_bf16 v[60:63], a[40:43], a[164:167], v[60:63]
ds_read_b64_tr_b16 a[28:29], v15 offset:12672
v_mfma_f32_16x16x32_bf16 v[60:63], a[44:47], a[152:155], v[60:63]
ds_read_b64_tr_b16 a[30:31], v15 offset:14784
v_mfma_f32_16x16x32_bf16 v[56:59], a[44:47], a[148:151], v[56:59]
v_mfma_f32_16x16x32_bf16 v[56:59], a[40:43], a[160:163], v[56:59]
v_add_u32 v8, 50688, v8
ds_read_b64_tr_b16 a[32:33], v8 offset:12672
v_mfma_f32_16x16x32_bf16 v[52:55], a[40:43], a[156:159], v[52:55]
ds_read_b64_tr_b16 a[34:35], v8 offset:14784
v_mfma_f32_16x16x32_bf16 v[52:55], a[44:47], a[144:147], v[52:55]
s_waitcnt lgkmcnt(6)
LS_117:
v_mfma_f32_16x16x32_bf16 v[16:19], a[16:19], a[192:195], v[16:19]
ds_read_b64_tr_b16 a[36:37], v8 offset:8448
v_mfma_f32_16x16x32_bf16 v[16:19], a[20:23], a[204:207], v[16:19]
ds_read_b64_tr_b16 a[38:39], v8 offset:10560
v_mfma_f32_16x16x32_bf16 v[20:23], a[20:23], a[208:211], v[20:23]
v_mfma_f32_16x16x32_bf16 v[20:23], a[16:19], a[196:199], v[20:23]
ds_read_b64_tr_b16 a[40:41], v8 offset:4224
v_mfma_f32_16x16x32_bf16 v[24:27], a[16:19], a[200:203], v[24:27]
ds_read_b64_tr_b16 a[42:43], v8 offset:6336
v_mfma_f32_16x16x32_bf16 v[24:27], a[20:23], a[212:215], v[24:27]
s_waitcnt lgkmcnt(6)
v_mfma_f32_16x16x32_bf16 v[24:27], a[24:27], a[224:227], v[24:27]
ds_read_b64_tr_b16 a[44:45], v8 offset:0
v_mfma_f32_16x16x32_bf16 v[24:27], a[28:31], a[236:239], v[24:27]
ds_read_b64_tr_b16 a[46:47], v8 offset:2112
v_mfma_f32_16x16x32_bf16 v[20:23], a[28:31], a[232:235], v[20:23]
v_mfma_f32_16x16x32_bf16 v[20:23], a[24:27], a[220:223], v[20:23]
ds_read_b64_tr_b16 a[16:17], v15 offset:512
v_mfma_f32_16x16x32_bf16 v[16:19], a[24:27], a[216:219], v[16:19]
ds_read_b64_tr_b16 a[18:19], v15 offset:2624
v_mfma_f32_16x16x32_bf16 v[16:19], a[28:31], a[228:231], v[16:19]
s_waitcnt lgkmcnt(6)
v_mfma_f32_16x16x32_bf16 v[28:31], a[32:35], a[228:231], v[28:31]
ds_read_b64_tr_b16 a[20:21], v15 offset:4736
v_mfma_f32_16x16x32_bf16 v[28:31], a[36:39], a[216:219], v[28:31]
ds_read_b64_tr_b16 a[22:23], v15 offset:6848
v_mfma_f32_16x16x32_bf16 v[32:35], a[36:39], a[220:223], v[32:35]
v_mfma_f32_16x16x32_bf16 v[32:35], a[32:35], a[232:235], v[32:35]
ds_read_b64_tr_b16 a[24:25], v15 offset:8960
v_mfma_f32_16x16x32_bf16 v[36:39], a[32:35], a[236:239], v[36:39]
ds_read_b64_tr_b16 a[26:27], v15 offset:11072
v_mfma_f32_16x16x32_bf16 v[36:39], a[36:39], a[224:227], v[36:39]
s_waitcnt lgkmcnt(6)
v_mfma_f32_16x16x32_bf16 v[36:39], a[40:43], a[212:215], v[36:39]
ds_read_b64_tr_b16 a[28:29], v15 offset:13184
v_mfma_f32_16x16x32_bf16 v[36:39], a[44:47], a[200:203], v[36:39]
ds_read_b64_tr_b16 a[30:31], v15 offset:15296
v_mfma_f32_16x16x32_bf16 v[32:35], a[44:47], a[196:199], v[32:35]
s_waitcnt vmcnt(28)
s_barrier
v_mfma_f32_16x16x32_bf16 v[32:35], a[40:43], a[208:211], v[32:35]
ds_read_b64_tr_b16 a[32:33], v8 offset:13184
v_mfma_f32_16x16x32_bf16 v[28:31], a[40:43], a[204:207], v[28:31]
ds_read_b64_tr_b16 a[34:35], v8 offset:15296
s_waitcnt vmcnt(7)
v_mfma_f32_16x16x32_bf16 v[172:175], v[150:153], v[218:221], 0
v_mfma_f32_16x16x32_bf16 v[172:175], v[150:153], v[226:229], v[172:175]
v_mfma_f32_16x16x32_bf16 v[172:175], v[150:153], v[234:237], v[172:175]
v_mfma_f32_16x16x32_bf16 v[172:175], v[150:153], v[242:245], v[172:175]
v_mfma_f32_16x16x32_bf16 v[168:171], v[150:153], v[222:225], 0
v_mfma_f32_16x16x32_bf16 v[168:171], v[150:153], v[230:233], v[168:171]
v_mfma_f32_16x16x32_bf16 v[168:171], v[150:153], v[238:241], v[168:171]
v_mfma_f32_16x16x32_bf16 v[168:171], v[152:155], v[216:219], v[168:171]
v_mfma_f32_16x16x32_bf16 v[168:171], v[148:151], v[244:247], v[168:171]
v_mfma_f32_16x16x32_bf16 v[28:31], a[44:47], a[192:195], v[28:31]
s_waitcnt lgkmcnt(6)
v_mfma_f32_16x16x32_bf16 v[40:43], a[16:19], a[192:195], v[40:43]
ds_read_b64_tr_b16 a[36:37], v8 offset:8960
v_mfma_f32_16x16x32_bf16 v[40:43], a[20:23], a[204:207], v[40:43]
ds_read_b64_tr_b16 a[38:39], v8 offset:11072
v_mfma_f32_16x16x32_bf16 v[44:47], a[20:23], a[208:211], v[44:47]
s_nop 0
v_cvt_pk_bf16_f32 v180, v168, v169
v_mfma_f32_16x16x32_bf16 v[44:47], a[16:19], a[196:199], v[44:47]
ds_read_b64_tr_b16 a[40:41], v8 offset:4736
v_cvt_pk_bf16_f32 v181, v170, v171
v_mfma_f32_16x16x32_bf16 v[48:51], a[16:19], a[200:203], v[48:51]
ds_read_b64_tr_b16 a[42:43], v8 offset:6848
v_cvt_pk_bf16_f32 v182, v172, v173
v_mfma_f32_16x16x32_bf16 v[48:51], a[20:23], a[212:215], v[48:51]
s_waitcnt lgkmcnt(6)
v_cvt_pk_bf16_f32 v183, v174, v175
v_mfma_f32_16x16x32_bf16 v[48:51], a[24:27], a[224:227], v[48:51]
ds_read_b64_tr_b16 a[44:45], v8 offset:512
v_mfma_f32_16x16x32_bf16 v[48:51], a[28:31], a[236:239], v[48:51]
ds_read_b64_tr_b16 a[46:47], v8 offset:2624
v_permlane32_swap_b32 v180, v182
v_mfma_f32_16x16x32_bf16 v[44:47], a[28:31], a[232:235], v[44:47]
v_mfma_f32_16x16x32_bf16 v[44:47], a[24:27], a[220:223], v[44:47]
ds_read_b64_tr_b16 a[16:17], v15 offset:16896
v_permlane32_swap_b32 v181, v183
v_mfma_f32_16x16x32_bf16 v[40:43], a[24:27], a[216:219], v[40:43]
ds_read_b64_tr_b16 a[18:19], v15 offset:19008
v_mfma_f32_16x16x32_bf16 v[40:43], a[28:31], a[228:231], v[40:43]
s_waitcnt lgkmcnt(6)
v_permlane16_swap_b32 v180, v182
v_mfma_f32_16x16x32_bf16 v[52:55], a[32:35], a[228:231], v[52:55]
ds_read_b64_tr_b16 a[20:21], v15 offset:21120
v_mfma_f32_16x16x32_bf16 v[52:55], a[36:39], a[216:219], v[52:55]
ds_read_b64_tr_b16 a[22:23], v15 offset:23232
v_permlane16_swap_b32 v181, v183
v_mfma_f32_16x16x32_bf16 v[56:59], a[36:39], a[220:223], v[56:59]
buffer_store_dwordx4 v[180:183], v156, s[68:71], s9 offen
v_mfma_f32_16x16x32_bf16 v[56:59], a[32:35], a[232:235], v[56:59]
ds_read_b64_tr_b16 a[24:25], v15 offset:25344
v_mfma_f32_16x16x32_bf16 v[60:63], a[32:35], a[236:239], v[60:63]
ds_read_b64_tr_b16 a[26:27], v15 offset:27456
v_mfma_f32_16x16x32_bf16 v[60:63], a[36:39], a[224:227], v[60:63]
s_waitcnt lgkmcnt(6)
v_mfma_f32_16x16x32_bf16 v[60:63], a[40:43], a[212:215], v[60:63]
ds_read_b64_tr_b16 a[28:29], v15 offset:29568
v_mfma_f32_16x16x32_bf16 v[60:63], a[44:47], a[200:203], v[60:63]
ds_read_b64_tr_b16 a[30:31], v15 offset:31680
v_mfma_f32_16x16x32_bf16 v[56:59], a[44:47], a[196:199], v[56:59]
v_mfma_f32_16x16x32_bf16 v[56:59], a[40:43], a[208:211], v[56:59]
ds_read_b64_tr_b16 a[32:33], v8 offset:29568
v_mfma_f32_16x16x32_bf16 v[52:55], a[40:43], a[204:207], v[52:55]
ds_read_b64_tr_b16 a[34:35], v8 offset:31680
v_mfma_f32_16x16x32_bf16 v[52:55], a[44:47], a[192:195], v[52:55]
s_waitcnt lgkmcnt(6)
LS_118:
v_mfma_f32_16x16x32_bf16 v[16:19], a[16:19], a[48:51], v[16:19]
ds_read_b64_tr_b16 a[36:37], v8 offset:25344
v_mfma_f32_16x16x32_bf16 v[16:19], a[20:23], a[60:63], v[16:19]
ds_read_b64_tr_b16 a[38:39], v8 offset:27456
v_mfma_f32_16x16x32_bf16 v[20:23], a[20:23], a[64:67], v[20:23]
v_mfma_f32_16x16x32_bf16 v[20:23], a[16:19], a[52:55], v[20:23]
ds_read_b64_tr_b16 a[40:41], v8 offset:21120
v_mfma_f32_16x16x32_bf16 v[24:27], a[16:19], a[56:59], v[24:27]
ds_read_b64_tr_b16 a[42:43], v8 offset:23232
v_mfma_f32_16x16x32_bf16 v[24:27], a[20:23], a[68:71], v[24:27]
s_waitcnt lgkmcnt(6)
v_mfma_f32_16x16x32_bf16 v[24:27], a[24:27], a[80:83], v[24:27]
ds_read_b64_tr_b16 a[44:45], v8 offset:16896
v_mfma_f32_16x16x32_bf16 v[24:27], a[28:31], a[92:95], v[24:27]
ds_read_b64_tr_b16 a[46:47], v8 offset:19008
v_mfma_f32_16x16x32_bf16 v[20:23], a[28:31], a[88:91], v[20:23]
v_mfma_f32_16x16x32_bf16 v[20:23], a[24:27], a[76:79], v[20:23]
ds_read_b64_tr_b16 a[16:17], v15 offset:17408
v_mfma_f32_16x16x32_bf16 v[16:19], a[24:27], a[72:75], v[16:19]
ds_read_b64_tr_b16 a[18:19], v15 offset:19520
v_mfma_f32_16x16x32_bf16 v[16:19], a[28:31], a[84:87], v[16:19]
s_waitcnt lgkmcnt(6)
v_mfma_f32_16x16x32_bf16 v[28:31], a[32:35], a[84:87], v[28:31]
ds_read_b64_tr_b16 a[20:21], v15 offset:21632
v_mfma_f32_16x16x32_bf16 v[28:31], a[36:39], a[72:75], v[28:31]
ds_read_b64_tr_b16 a[22:23], v15 offset:23744
v_mfma_f32_16x16x32_bf16 v[32:35], a[36:39], a[76:79], v[32:35]
v_mfma_f32_16x16x32_bf16 v[32:35], a[32:35], a[88:91], v[32:35]
ds_read_b64_tr_b16 a[24:25], v15 offset:25856
v_mfma_f32_16x16x32_bf16 v[36:39], a[32:35], a[92:95], v[36:39]
ds_read_b64_tr_b16 a[26:27], v15 offset:27968
v_mfma_f32_16x16x32_bf16 v[36:39], a[36:39], a[80:83], v[36:39]
s_waitcnt lgkmcnt(6)
v_mfma_f32_16x16x32_bf16 v[36:39], a[40:43], a[68:71], v[36:39]
ds_read_b64_tr_b16 a[28:29], v15 offset:30080
v_mfma_f32_16x16x32_bf16 v[36:39], a[44:47], a[56:59], v[36:39]
ds_read_b64_tr_b16 a[30:31], v15 offset:32192
v_mfma_f32_16x16x32_bf16 v[32:35], a[44:47], a[52:55], v[32:35]
s_waitcnt vmcnt(1)
v_mov_b32 v250, 6
buffer_store_dword v250, v157, s[80:83], 0 offen sc1
v_mfma_f32_16x16x32_bf16 v[32:35], a[40:43], a[64:67], v[32:35]
ds_read_b64_tr_b16 a[32:33], v8 offset:30080
v_mfma_f32_16x16x32_bf16 v[28:31], a[40:43], a[60:63], v[28:31]
ds_read_b64_tr_b16 a[34:35], v8 offset:32192
s_waitcnt vmcnt(25)
s_barrier
v_mfma_f32_16x16x32_bf16 v[28:31], a[44:47], a[48:51], v[28:31]
s_waitcnt lgkmcnt(6)
v_mfma_f32_16x16x32_bf16 v[40:43], a[16:19], a[48:51], v[40:43]
ds_read_b64_tr_b16 a[36:37], v8 offset:25856
v_mfma_f32_16x16x32_bf16 v[40:43], a[20:23], a[60:63], v[40:43]
ds_read_b64_tr_b16 a[38:39], v8 offset:27968
v_mfma_f32_16x16x32_bf16 v[44:47], a[20:23], a[64:67], v[44:47]
v_mfma_f32_16x16x32_bf16 v[44:47], a[16:19], a[52:55], v[44:47]
ds_read_b64_tr_b16 a[40:41], v8 offset:21632
v_mfma_f32_16x16x32_bf16 v[48:51], a[16:19], a[56:59], v[48:51]
ds_read_b64_tr_b16 a[42:43], v8 offset:23744
v_mfma_f32_16x16x32_bf16 v[48:51], a[20:23], a[68:71], v[48:51]
s_waitcnt lgkmcnt(6)
v_mfma_f32_16x16x32_bf16 v[48:51], a[24:27], a[80:83], v[48:51]
ds_read_b64_tr_b16 a[44:45], v8 offset:17408
v_mfma_f32_16x16x32_bf16 v[48:51], a[28:31], a[92:95], v[48:51]
ds_read_b64_tr_b16 a[46:47], v8 offset:19520
v_mfma_f32_16x16x32_bf16 v[44:47], a[28:31], a[88:91], v[44:47]
v_mfma_f32_16x16x32_bf16 v[44:47], a[24:27], a[76:79], v[44:47]
v_add_u32 v15, 50688, v15
ds_read_b64_tr_b16 a[16:17], v15 offset:33792
v_mfma_f32_16x16x32_bf16 v[40:43], a[24:27], a[72:75], v[40:43]
ds_read_b64_tr_b16 a[18:19], v15 offset:35904
v_mfma_f32_16x16x32_bf16 v[40:43], a[28:31], a[84:87], v[40:43]
s_waitcnt lgkmcnt(6)
s_waitcnt vmcnt(4)
v_cmp_gt_u32 vcc, 5, v159
s_cbranch_vccnz SPIN_s4
RET_s4:
v_mfma_f32_16x16x32_bf16 v[52:55], a[32:35], a[84:87], v[52:55]
ds_read_b64_tr_b16 a[20:21], v15 offset:38016
v_mfma_f32_16x16x32_bf16 v[52:55], a[36:39], a[72:75], v[52:55]
ds_read_b64_tr_b16 a[22:23], v15 offset:40128
v_mfma_f32_16x16x32_bf16 v[56:59], a[36:39], a[76:79], v[56:59]
buffer_load_dwordx4 v[184:187], v252, s[76:79], s96 offen sc1
s_add_u32 s96, s96, 172032
v_mfma_f32_16x16x32_bf16 v[56:59], a[32:35], a[88:91], v[56:59]
ds_read_b64_tr_b16 a[24:25], v15 offset:42240
v_mfma_f32_16x16x32_bf16 v[60:63], a[32:35], a[92:95], v[60:63]
ds_read_b64_tr_b16 a[26:27], v15 offset:44352
v_mfma_f32_16x16x32_bf16 v[60:63], a[36:39], a[80:83], v[60:63]
s_waitcnt lgkmcnt(6)
v_mfma_f32_16x16x32_bf16 v[60:63], a[40:43], a[68:71], v[60:63]
ds_read_b64_tr_b16 a[28:29], v15 offset:46464
v_mfma_f32_16x16x32_bf16 v[60:63], a[44:47], a[56:59], v[60:63]
ds_read_b64_tr_b16 a[30:31], v15 offset:48576
v_mfma_f32_16x16x32_bf16 v[56:59], a[44:47], a[52:55], v[56:59]
buffer_load_dwordx4 v[188:191], v252, s[76:79], s96 offen sc1
s_add_u32 s96, s96, 172032
v_mfma_f32_16x16x32_bf16 v[56:59], a[40:43], a[64:67], v[56:59]
v_add_u32 v8, 50688, v8
ds_read_b64_tr_b16 a[32:33], v8 offset:46464
v_mfma_f32_16x16x32_bf16 v[52:55], a[40:43], a[60:63], v[52:55]
ds_read_b64_tr_b16 a[34:35], v8 offset:48576
v_mfma_f32_16x16x32_bf16 v[52:55], a[44:47], a[48:51], v[52:55]
s_waitcnt lgkmcnt(6)
LS_119:
v_mfma_f32_16x16x32_bf16 v[16:19], a[16:19], a[96:99], v[16:19]
ds_read_b64_tr_b16 a[36:37], v8 offset:42240
v_mfma_f32_16x16x32_bf16 v[16:19], a[20:23], a[108:111], v[16:19]
ds_read_b64_tr_b16 a[38:39], v8 offset:44352
v_mfma_f32_16x16x32_bf16 v[20:23], a[20:23], a[112:115], v[20:23]
buffer_load_dwordx4 v[192:195], v252, s[76:79], s96 offen sc1
s_add_u32 s96, s96, 172032
v_mfma_f32_16x16x32_bf16 v[20:23], a[16:19], a[100:103], v[20:23]
ds_read_b64_tr_b16 a[40:41], v8 offset:38016
v_mfma_f32_16x16x32_bf16 v[24:27], a[16:19], a[104:107], v[24:27]
ds_read_b64_tr_b16 a[42:43], v8 offset:40128
v_mfma_f32_16x16x32_bf16 v[24:27], a[20:23], a[116:119], v[24:27]
s_waitcnt lgkmcnt(6)
v_mfma_f32_16x16x32_bf16 v[24:27], a[24:27], a[128:131], v[24:27]
ds_read_b64_tr_b16 a[44:45], v8 offset:33792
v_mfma_f32_16x16x32_bf16 v[24:27], a[28:31], a[140:143], v[24:27]
ds_read_b64_tr_b16 a[46:47], v8 offset:35904
v_mfma_f32_16x16x32_bf16 v[20:23], a[28:31], a[136:139], v[20:23]
buffer_load_dwordx4 v[196:199], v252, s[76:79], s96 offen sc1
s_add_u32 s96, s96, 172032
v_mfma_f32_16x16x32_bf16 v[20:23], a[24:27], a[124:127], v[20:23]
ds_read_b64_tr_b16 a[16:17], v15 offset:34304
v_mfma_f32_16x16x32_bf16 v[16:19], a[24:27], a[120:123], v[16:19]
ds_read_b64_tr_b16 a[18:19], v15 offset:36416
v_mfma_f32_16x16x32_bf16 v[16:19], a[28:31], a[132:135], v[16:19]
s_waitcnt lgkmcnt(6)
v_mfma_f32_16x16x32_bf16 v[28:31], a[32:35], a[132:135], v[28:31]
ds_read_b64_tr_b16 a[20:21], v15 offset:38528
v_mfma_f32_16x16x32_bf16 v[28:31], a[36:39], a[120:123], v[28:31]
ds_read_b64_tr_b16 a[22:23], v15 offset:40640
v_mfma_f32_16x16x32_bf16 v[32:35], a[36:39], a[124:127], v[32:35]
buffer_load_dwordx4 v[200:203], v252, s[76:79], s96 offen sc1
s_add_u32 s96, s96, 172032
v_mfma_f32_16x16x32_bf16 v[32:35], a[32:35], a[136:139], v[32:35]
ds_read_b64_tr_b16 a[24:25], v15 offset:42752
v_mfma_f32_16x16x32_bf16 v[36:39], a[32:35], a[140:143], v[36:39]
ds_read_b64_tr_b16 a[26:27], v15 offset:44864
v_mfma_f32_16x16x32_bf16 v[36:39], a[36:39], a[128:131], v[36:39]
s_waitcnt lgkmcnt(6)
v_mfma_f32_16x16x32_bf16 v[36:39], a[40:43], a[116:119], v[36:39]
ds_read_b64_tr_b16 a[28:29], v15 offset:46976
v_mfma_f32_16x16x32_bf16 v[36:39], a[44:47], a[104:107], v[36:39]
ds_read_b64_tr_b16 a[30:31], v15 offset:49088
v_mfma_f32_16x16x32_bf16 v[32:35], a[44:47], a[100:103], v[32:35]
buffer_load_dwordx4 v[204:207], v252, s[76:79], s96 offen sc1
s_add_u32 s96, s96, 172032
v_mfma_f32_16x16x32_bf16 v[32:35], a[40:43], a[112:115], v[32:35]
ds_read_b64_tr_b16 a[32:33], v8 offset:46976
v_mfma_f32_16x16x32_bf16 v[28:31], a[40:43], a[108:111], v[28:31]
ds_read_b64_tr_b16 a[34:35], v8 offset:49088
v_cvt_pk_bf16_f32 v132, v24, v25
v_mfma_f32_16x16x32_bf16 v[28:31], a[44:47], a[96:99], v[28:31]
s_waitcnt lgkmcnt(6)
v_cvt_pk_bf16_f32 v133, v26, v27
v_mfma_f32_16x16x32_bf16 v[40:43], a[16:19], a[96:99], v[40:43]
ds_read_b64_tr_b16 a[36:37], v8 offset:42752
v_cvt_pk_bf16_f32 v128, v20, v21
v_mfma_f32_16x16x32_bf16 v[40:43], a[20:23], a[108:111], v[40:43]
ds_read_b64_tr_b16 a[38:39], v8 offset:44864
v_cvt_pk_bf16_f32 v129, v22, v23
v_mfma_f32_16x16x32_bf16 v[44:47], a[20:23], a[112:115], v[44:47]
buffer_load_dwordx4 v[208:211], v252, s[76:79], s96 offen sc1
s_add_u32 s96, s96, 172032
v_mfma_f32_16x16x32_bf16 v[44:47], a[16:19], a[100:103], v[44:47]
ds_read_b64_tr_b16 a[40:41], v8 offset:38528
buffer_load_dword v159, v158, s[80:83], 0 offen sc1
v_mfma_f32_16x16x32_bf16 v[48:51], a[16:19], a[104:107], v[48:51]
ds_read_b64_tr_b16 a[42:43], v8 offset:40640
v_cvt_pk_bf16_f32 v124, v16, v17
v_mfma_f32_16x16x32_bf16 v[48:51], a[20:23], a[116:119], v[48:51]
s_waitcnt lgkmcnt(6)
buffer_load_dwordx4 v[212:215], v252, s[76:79], s96 offen sc1
v_mfma_f32_16x16x32_bf16 v[48:51], a[24:27], a[128:131], v[48:51]
ds_read_b64_tr_b16 a[44:45], v8 offset:34304
v_cvt_pk_bf16_f32 v125, v18, v19
v_mfma_f32_16x16x32_bf16 v[48:51], a[28:31], a[140:143], v[48:51]
ds_read_b64_tr_b16 a[46:47], v8 offset:36416
v_cvt_pk_bf16_f32 v126, v28, v29
v_mfma_f32_16x16x32_bf16 v[44:47], a[28:31], a[136:139], v[44:47]
v_cvt_pk_bf16_f32 v127, v30, v31
v_cvt_pk_bf16_f32 v130, v32, v33
v_mfma_f32_16x16x32_bf16 v[44:47], a[24:27], a[124:127], v[44:47]
v_cvt_pk_bf16_f32 v131, v34, v35
v_cvt_pk_bf16_f32 v134, v36, v37
v_mfma_f32_16x16x32_bf16 v[40:43], a[24:27], a[120:123], v[40:43]
s_mov_b32 s51, 36864
buffer_store_dwordx4 v[124:127], v252, s[40:43], s51 offen sc1
v_mfma_f32_16x16x32_bf16 v[40:43], a[28:31], a[132:135], v[40:43]
s_waitcnt lgkmcnt(4)
v_cvt_pk_bf16_f32 v135, v38, v39
v_mfma_f32_16x16x32_bf16 v[52:55], a[32:35], a[132:135], v[52:55]
s_mov_b32 s51, 37888
buffer_store_dwordx4 v[128:131], v252, s[40:43], s51 offen sc1
v_mfma_f32_16x16x32_bf16 v[52:55], a[36:39], a[120:123], v[52:55]
v_mfma_f32_16x16x32_bf16 v[56:59], a[36:39], a[124:127], v[56:59]
s_mov_b32 s51, 38912
buffer_store_dwordx4 v[132:135], v252, s[40:43], s51 offen sc1
v_mfma_f32_16x16x32_bf16 v[56:59], a[32:35], a[136:139], v[56:59]
v_mfma_f32_16x16x32_bf16 v[60:63], a[32:35], a[140:143], v[60:63]
v_mfma_f32_16x16x32_bf16 v[60:63], a[36:39], a[128:131], v[60:63]
s_waitcnt lgkmcnt(0)
v_mfma_f32_16x16x32_bf16 v[60:63], a[40:43], a[116:119], v[60:63]
v_mfma_f32_16x16x32_bf16 v[60:63], a[44:47], a[104:107], v[60:63]
v_mfma_f32_16x16x32_bf16 v[56:59], a[44:47], a[100:103], v[56:59]
v_mfma_f32_16x16x32_bf16 v[56:59], a[40:43], a[112:115], v[56:59]
v_mfma_f32_16x16x32_bf16 v[52:55], a[40:43], a[108:111], v[52:55]
v_mfma_f32_16x16x32_bf16 v[52:55], a[44:47], a[96:99], v[52:55]
v_cvt_pk_bf16_f32 v136, v40, v41
v_cvt_pk_bf16_f32 v137, v42, v43
s_nop 5
v_cvt_pk_bf16_f32 v138, v52, v53
v_cvt_pk_bf16_f32 v139, v54, v55
s_mov_b32 s51, 39936
buffer_store_dwordx4 v[136:139], v252, s[40:43], s51 offen sc1
v_cvt_pk_bf16_f32 v140, v44, v45
v_cvt_pk_bf16_f32 v141, v46, v47
v_cvt_pk_bf16_f32 v142, v56, v57
v_cvt_pk_bf16_f32 v143, v58, v59
s_mov_b32 s51, 40960
buffer_store_dwordx4 v[140:143], v252, s[40:43], s51 offen sc1
v_cvt_pk_bf16_f32 v144, v48, v49
v_cvt_pk_bf16_f32 v145, v50, v51
v_cvt_pk_bf16_f32 v146, v60, v61
v_cvt_pk_bf16_f32 v147, v62, v63
s_mov_b32 s51, 41984
buffer_store_dwordx4 v[144:147], v252, s[40:43], s51 offen sc1
s_waitcnt vmcnt(7)
v_cmp_gt_u32 vcc, 6, v159
s_cbranch_vccnz SPIN_t6
RET_t6:
buffer_load_dwordx4 a[80:83], v252, s[76:79], s97 offen sc1
s_add_u32 s97, s97, 172032
buffer_load_dwordx4 a[84:87], v252, s[76:79], s97 offen sc1
s_add_u32 s97, s97, 172032
buffer_load_dwordx4 a[88:91], v252, s[76:79], s97 offen sc1
s_add_u32 s97, s97, 172032
buffer_load_dwordx4 a[92:95], v252, s[76:79], s97 offen sc1
s_add_u32 s97, s97, 172032
buffer_load_dwordx4 a[96:99], v252, s[76:79], s97 offen sc1
s_add_u32 s97, s97, 172032
buffer_load_dwordx4 a[100:103], v252, s[76:79], s97 offen sc1
s_add_u32 s97, s97, 172032
buffer_load_dwordx4 a[104:107], v252, s[76:79], s97 offen sc1
s_add_u32 s97, s97, 172032
buffer_load_dwordx4 a[108:111], v252, s[76:79], s97 offen sc1
s_waitcnt vmcnt(14)
v_mfma_f32_16x16x32_bf16 v[164:167], v[150:153], v[186:189], 0
v_mfma_f32_16x16x32_bf16 v[164:167], v[150:153], v[194:197], v[164:167]
v_mfma_f32_16x16x32_bf16 v[164:167], v[150:153], v[202:205], v[164:167]
v_mfma_f32_16x16x32_bf16 v[164:167], v[150:153], v[210:213], v[164:167]
v_mfma_f32_16x16x32_bf16 v[160:163], v[150:153], v[190:193], 0
v_mfma_f32_16x16x32_bf16 v[160:163], v[150:153], v[198:201], v[160:163]
v_mfma_f32_16x16x32_bf16 v[160:163], v[150:153], v[206:209], v[160:163]
v_mfma_f32_16x16x32_bf16 v[160:163], v[152:155], v[184:187], v[160:163]
v_mfma_f32_16x16x32_bf16 v[160:163], v[148:151], v[212:215], v[160:163]
buffer_load_dwordx4 v[216:219], v252, s[76:79], s98 offen sc1
s_add_u32 s98, s98, 172032
buffer_load_dwordx4 v[220:223], v252, s[76:79], s98 offen sc1
s_add_u32 s98, s98, 172032
buffer_load_dwordx4 v[224:227], v252, s[76:79], s98 offen sc1
s_add_u32 s98, s98, 172032
buffer_load_dwordx4 v[228:231], v252, s[76:79], s98 offen sc1
s_add_u32 s98, s98, 172032
buffer_load_dwordx4 v[232:235], v252, s[76:79], s98 offen sc1
s_add_u32 s98, s98, 172032
buffer_load_dwordx4 v[236:239], v252, s[76:79], s98 offen sc1
s_add_u32 s98, s98, 172032
buffer_load_dwordx4 v[240:243], v252, s[76:79], s98 offen sc1
s_add_u32 s98, s98, 172032
buffer_load_dwordx4 v[244:247], v252, s[76:79], s98 offen sc1
v_cvt_pk_bf16_f32 v176, v160, v161
v_cvt_pk_bf16_f32 v177, v162, v163
v_cvt_pk_bf16_f32 v178, v164, v165
v_cvt_pk_bf16_f32 v179, v166, v167
s_nop 0
v_permlane32_swap_b32 v176, v178
v_permlane32_swap_b32 v177, v179
s_nop 0
v_permlane16_swap_b32 v176, v178
v_permlane16_swap_b32 v177, v179
buffer_store_dwordx4 v[176:179], v156, s[68:71], s10 offen
s_waitcnt vmcnt(17)
v_mov_b32 v250, 7
buffer_store_dword v250, v157, s[80:83], 0 offen sc1
s_waitcnt vmcnt(10)
v_mfma_f32_16x16x32_bf16 v[172:175], v[150:153], a[82:85], 0
v_mfma_f32_16x16x32_bf16 v[172:175], v[150:153], a[90:93], v[172:175]
v_mfma_f32_16x16x32_bf16 v[172:175], v[150:153], a[98:101], v[172:175]
v_mfma_f32_16x16x32_bf16 v[172:175], v[150:153], a[106:109], v[172:175]
v_mfma_f32_16x16x32_bf16 v[168:171], v[150:153], a[86:89], 0
v_mfma_f32_16x16x32_bf16 v[168:171], v[150:153], a[94:97], v[168:171]
v_mfma_f32_16x16x32_bf16 v[168:171], v[150:153], a[102:105], v[168:171]
v_mfma_f32_16x16x32_bf16 v[168:171], v[152:155], a[80:83], v[168:171]
v_mfma_f32_16x16x32_bf16 v[168:171], v[148:151], a[108:111], v[168:171]
s_nop 7
v_cvt_pk_bf16_f32 v180, v168, v169
v_cvt_pk_bf16_f32 v181, v170, v171
v_cvt_pk_bf16_f32 v182, v172, v173
v_cvt_pk_bf16_f32 v183, v174, v175
s_nop 0
v_permlane32_swap_b32 v180, v182
v_permlane32_swap_b32 v181, v183
s_nop 0
v_permlane16_swap_b32 v180, v182
v_permlane16_swap_b32 v181, v183
buffer_store_dwordx4 v[180:183], v156, s[68:71], s11 offen
s_waitcnt vmcnt(3)
v_max3_u32 v248, v216, v217, v218
v_max3_u32 v249, v219, v220, v221
v_max3_u32 v248, v248, v222, v223
v_max3_u32 v249, v249, v224, v225
v_max3_u32 v248, v248, v226, v227
v_max3_u32 v249, v249, v228, v229
v_max3_u32 v248, v248, v230, v231
v_max3_u32 v249, v249, v232, v233
v_max3_u32 v248, v248, v234, v235
v_max3_u32 v249, v249, v236, v237
v_max3_u32 v248, v248, v238, v239
v_max3_u32 v249, v249, v240, v241
v_max3_u32 v248, v248, v242, v243
v_max3_u32 v249, v249, v244, v245
v_max3_u32 v248, v248, v246, v247
v_max_u32 v248, v248, v249
v_cmp_eq_u32 vcc, -1, v248
s_cbranch_vccnz RETRY
RET_retry:
v_mfma_f32_16x16x32_bf16 v[164:167], v[150:153], v[218:221], 0
v_mfma_f32_16x16x32_bf16 v[164:167], v[150:153], v[226:229], v[164:167]
v_mfma_f32_16x16x32_bf16 v[164:167], v[150:153], v[234:237], v[164:167]
v_mfma_f32_16x16x32_bf16 v[164:167], v[150:153], v[242:245], v[164:167]
v_mfma_f32_16x16x32_bf16 v[160:163], v[150:153], v[222:225], 0
v_mfma_f32_16x16x32_bf16 v[160:163], v[150:153], v[230:233], v[160:163]
v_mfma_f32_16x16x32_bf16 v[160:163], v[150:153], v[238:241], v[160:163]
v_mfma_f32_16x16x32_bf16 v[160:163], v[152:155], v[216:219], v[160:163]
v_mfma_f32_16x16x32_bf16 v[160:163], v[148:151], v[244:247], v[160:163]
s_nop 7
v_cvt_pk_bf16_f32 v176, v160, v161
v_cvt_pk_bf16_f32 v177, v162, v163
v_cvt_pk_bf16_f32 v178, v164, v165
v_cvt_pk_bf16_f32 v179, v166, v167
s_nop 0
v_permlane32_swap_b32 v176, v178
v_permlane32_swap_b32 v177, v179
s_nop 0
v_permlane16_swap_b32 v176, v178
v_permlane16_swap_b32 v177, v179
buffer_store_dwordx4 v[176:179], v156, s[68:71], s12 offen
L_done:
s_endpgm
RARE_h0j0:
s_call_b64 s[60:61], RAREP_1
s_branch RET_h0j0
RARE_h0j1:
s_call_b64 s[60:61], RAREP_0
s_branch RET_h0j1
RARE_h0j2:
s_call_b64 s[60:61], RAREP_1
s_branch RET_h0j2
RARE_h0j3:
s_call_b64 s[60:61], RAREP_0
s_branch RET_h0j3
RARE_h0j4:
s_call_b64 s[60:61], RAREP_1
s_branch RET_h0j4
RARE_h0j5:
s_call_b64 s[60:61], RAREP_0
s_branch RET_h0j5
RARE_h0j6:
s_call_b64 s[60:61], RAREP_1
s_branch RET_h0j6
RARE_h0j7:
s_call_b64 s[60:61], RAREP_0
s_branch RET_h0j7
RARE_h0j8:
s_call_b64 s[60:61], RAREP_1
s_branch RET_h0j8
RARE_h0j9:
s_call_b64 s[60:61], RAREP_0
s_branch RET_h0j9
RARE_h0j10:
s_call_b64 s[60:61], RAREP_1
s_branch RET_h0j10
RARE_h0j11:
s_call_b64 s[60:61], RAREP_0
s_branch RET_h0j11
RARE_h0j12:
s_call_b64 s[60:61], RAREP_1
s_branch RET_h0j12
RARE_h0j13:
s_call_b64 s[60:61], RAREP_0
s_branch RET_h0j13
RARE_h0j14:
s_call_b64 s[60:61], RAREP_1
s_branch RET_h0j14
RARE_h1j0:
s_call_b64 s[60:61], RAREP_1
s_branch RET_h1j0
RARE_h1j1:
s_call_b64 s[60:61], RAREP_0
s_branch RET_h1j1
RARE_h1j2:
s_call_b64 s[60:61], RAREP_1
s_branch RET_h1j2
RARE_h1j3:
s_call_b64 s[60:61], RAREP_0
s_branch RET_h1j3
RARE_h1j4:
s_call_b64 s[60:61], RAREP_1
s_branch RET_h1j4
RARE_h1j5:
s_call_b64 s[60:61], RAREP_0
s_branch RET_h1j5
RARE_h1j6:
s_call_b64 s[60:61], RAREP_1
s_branch RET_h1j6
RARE_h1j7:
s_call_b64 s[60:61], RAREP_0
s_branch RET_h1j7
RARE_h1j8:
s_call_b64 s[60:61], RAREP_1
s_branch RET_h1j8
RARE_h1j9:
s_call_b64 s[60:61], RAREP_0
s_branch RET_h1j9
RARE_h1j10:
s_call_b64 s[60:61], RAREP_1
s_branch RET_h1j10
RARE_h1j11:
s_call_b64 s[60:61], RAREP_0
s_branch RET_h1j11
RARE_h1j12:
s_call_b64 s[60:61], RAREP_1
s_branch RET_h1j12
RARE_h1j13:
s_call_b64 s[60:61], RAREP_0
s_branch RET_h1j13
RARE_h1j14:
s_call_b64 s[60:61], RAREP_1
s_branch RET_h1j14
SPIN_clr:
s_mov_b32 s55, 0x200000
SPINL_clr:
s_sleep 1
buffer_load_dword v159, v251, s[72:75], 0 offen sc1
s_waitcnt vmcnt(0)
v_cmp_gt_u32 vcc, 8, v159
s_cbranch_vccz RET_clr
s_sub_u32 s55, s55, 1
s_cbranch_scc0 SPINL_clr
s_branch RET_clr
SPIN_s0:
s_mov_b32 s55, 0x200000
SPINL_s0:
s_sleep 1
buffer_load_dword v159, v158, s[80:83], 0 offen sc1
s_waitcnt vmcnt(0)
v_cmp_gt_u32 vcc, 1, v159
s_cbranch_vccz RET_s0
s_sub_u32 s55, s55, 1
s_cbranch_scc0 SPINL_s0
s_branch RET_s0
SPIN_s1:
s_mov_b32 s55, 0x200000
SPINL_s1:
s_sleep 1
buffer_load_dword v159, v158, s[80:83], 0 offen sc1
s_waitcnt vmcnt(0)
v_cmp_gt_u32 vcc, 2, v159
s_cbranch_vccz RET_s1
s_sub_u32 s55, s55, 1
s_cbranch_scc0 SPINL_s1
s_branch RET_s1
SPIN_s2:
s_mov_b32 s55, 0x200000
SPINL_s2:
s_sleep 1
buffer_load_dword v159, v158, s[80:83], 0 offen sc1
s_waitcnt vmcnt(0)
v_cmp_gt_u32 vcc, 3, v159
s_cbranch_vccz RET_s2
s_sub_u32 s55, s55, 1
s_cbranch_scc0 SPINL_s2
s_branch RET_s2
SPIN_s3:
s_mov_b32 s55, 0x200000
SPINL_s3:
s_sleep 1
buffer_load_dword v159, v158, s[80:83], 0 offen sc1
s_waitcnt vmcnt(0)
v_cmp_gt_u32 vcc, 4, v159
s_cbranch_vccz RET_s3
s_sub_u32 s55, s55, 1
s_cbranch_scc0 SPINL_s3
s_branch RET_s3
SPIN_s4:
s_mov_b32 s55, 0x200000
SPINL_s4:
s_sleep 1
buffer_load_dword v159, v158, s[80:83], 0 offen sc1
s_waitcnt vmcnt(0)
v_cmp_gt_u32 vcc, 5, v159
s_cbranch_vccz RET_s4
s_sub_u32 s55, s55, 1
s_cbranch_scc0 SPINL_s4
s_branch RET_s4
SPIN_t6:
s_mov_b32 s55, 0x200000
SPINL_t6:
s_sleep 1
buffer_load_dword v159, v158, s[80:83], 0 offen sc1
s_waitcnt vmcnt(0)
v_cmp_gt_u32 vcc, 6, v159
s_cbranch_vccz RET_t6
s_sub_u32 s55, s55, 1
s_cbranch_scc0 SPINL_t6
s_branch RET_t6
RETRY:
s_mov_b32 s55, 0x200000
RETRYL:
buffer_load_dword v159, v158, s[80:83], 0 offen sc1
s_sub_u32 s98, s98, 1204224
buffer_load_dwordx4 v[216:219], v252, s[76:79], s98 offen sc1
s_add_u32 s98, s98, 172032
buffer_load_dwordx4 v[220:223], v252, s[76:79], s98 offen sc1
s_add_u32 s98, s98, 172032
buffer_load_dwordx4 v[224:227], v252, s[76:79], s98 offen sc1
s_add_u32 s98, s98, 172032
buffer_load_dwordx4 v[228:231], v252, s[76:79], s98 offen sc1
s_add_u32 s98, s98, 172032
buffer_load_dwordx4 v[232:235], v252, s[76:79], s98 offen sc1
s_add_u32 s98, s98, 172032
buffer_load_dwordx4 v[236:239], v252, s[76:79], s98 offen sc1
s_add_u32 s98, s98, 172032
buffer_load_dwordx4 v[240:243], v252, s[76:79], s98 offen sc1
s_add_u32 s98, s98, 172032
buffer_load_dwordx4 v[244:247], v252, s[76:79], s98 offen sc1
s_waitcnt vmcnt(0)
v_max3_u32 v248, v216, v217, v218
v_max3_u32 v249, v219, v220, v221
v_max3_u32 v248, v248, v222, v223
v_max3_u32 v249, v249, v224, v225
v_max3_u32 v248, v248, v226, v227
v_max3_u32 v249, v249, v228, v229
v_max3_u32 v248, v248, v230, v231
v_max3_u32 v249, v249, v232, v233
v_max3_u32 v248, v248, v234, v235
v_max3_u32 v249, v249, v236, v237
v_max3_u32 v248, v248, v238, v239
v_max3_u32 v249, v249, v240, v241
v_max3_u32 v248, v248, v242, v243
v_max3_u32 v249, v249, v244, v245
v_max3_u32 v248, v248, v246, v247
v_max_u32 v248, v248, v249
v_cmp_eq_u32 vcc, -1, v248
s_cbranch_vccz RET_retry
v_cmp_gt_u32 vcc, 7, v159
s_cbranch_vccz RETRYF
s_sub_u32 s55, s55, 1
s_cbranch_scc0 RETRYL
RETRYF:
s_sub_u32 s98, s98, 1204224
buffer_load_dwordx4 v[216:219], v252, s[76:79], s98 offen sc1
s_add_u32 s98, s98, 172032
buffer_load_dwordx4 v[220:223], v252, s[76:79], s98 offen sc1
s_add_u32 s98, s98, 172032
buffer_load_dwordx4 v[224:227], v252, s[76:79], s98 offen sc1
s_add_u32 s98, s98, 172032
buffer_load_dwordx4 v[228:231], v252, s[76:79], s98 offen sc1
s_add_u32 s98, s98, 172032
buffer_load_dwordx4 v[232:235], v252, s[76:79], s98 offen sc1
s_add_u32 s98, s98, 172032
buffer_load_dwordx4 v[236:239], v252, s[76:79], s98 offen sc1
s_add_u32 s98, s98, 172032
buffer_load_dwordx4 v[240:243], v252, s[76:79], s98 offen sc1
s_add_u32 s98, s98, 172032
buffer_load_dwordx4 v[244:247], v252, s[76:79], s98 offen sc1
s_waitcnt vmcnt(0)
s_branch RET_retry
RAREP_0:
s_nop 15
v_accvgpr_write_b32 a240, v0
v_accvgpr_write_b32 a241, v1
v_accvgpr_write_b32 a242, v2
v_accvgpr_write_b32 a243, v3
v_accvgpr_write_b32 a244, v4
v_accvgpr_write_b32 a245, v5
v_accvgpr_write_b32 a246, v6
v_accvgpr_write_b32 a247, v7
v_max3_f32 v0, v40, v41, v42
v_max3_f32 v0, v0, v43, v52
v_max3_f32 v0, v0, v53, v54
v_max_f32 v0, v0, v55
v_mov_b32 v1, v0
s_nop 1
v_permlane32_swap_b32 v0, v1
v_max_f32 v0, v0, v1
v_mov_b32 v1, v0
s_nop 1
v_permlane16_swap_b32 v0, v1
v_max_f32 v0, v0, v1
v_ceil_f32 v0, v0
v_max_f32 v0, 0, v0
v_sub_f32 v40, v40, v0
v_sub_f32 v52, v52, v0
v_sub_f32 v16, v16, v0
v_sub_f32 v41, v41, v0
v_sub_f32 v53, v53, v0
v_sub_f32 v17, v17, v0
v_sub_f32 v42, v42, v0
v_sub_f32 v54, v54, v0
v_sub_f32 v18, v18, v0
v_sub_f32 v43, v43, v0
v_sub_f32 v55, v55, v0
v_sub_f32 v19, v19, v0
v_min_f32 v0, 0x43800000, v0
v_cvt_i32_f32 v2, v0
v_sub_u32 v2, 0, v2
v_ldexp_f32 v10, v10, v2
v_lshlrev_b32 v3, 16, v28
v_and_b32 v4, 0xffff0000, v28
v_ldexp_f32 v3, v3, v2
v_ldexp_f32 v4, v4, v2
v_cvt_pk_bf16_f32 v28, v3, v4
v_lshlrev_b32 v3, 16, v29
v_and_b32 v4, 0xffff0000, v29
v_ldexp_f32 v3, v3, v2
v_ldexp_f32 v4, v4, v2
v_cvt_pk_bf16_f32 v29, v3, v4
v_lshlrev_b32 v3, 16, v30
v_and_b32 v4, 0xffff0000, v30
v_ldexp_f32 v3, v3, v2
v_ldexp_f32 v4, v4, v2
v_cvt_pk_bf16_f32 v30, v3, v4
v_lshlrev_b32 v3, 16, v31
v_and_b32 v4, 0xffff0000, v31
v_ldexp_f32 v3, v3, v2
v_ldexp_f32 v4, v4, v2
v_cvt_pk_bf16_f32 v31, v3, v4
v_ldexp_f32 v76, v76, v2
v_ldexp_f32 v77, v77, v2
v_ldexp_f32 v78, v78, v2
v_ldexp_f32 v79, v79, v2
v_ldexp_f32 v88, v88, v2
v_ldexp_f32 v89, v89, v2
v_ldexp_f32 v90, v90, v2
v_ldexp_f32 v91, v91, v2
v_ldexp_f32 v100, v100, v2
v_ldexp_f32 v101, v101, v2
v_ldexp_f32 v102, v102, v2
v_ldexp_f32 v103, v103, v2
v_ldexp_f32 v112, v112, v2
v_ldexp_f32 v113, v113, v2
v_ldexp_f32 v114, v114, v2
v_ldexp_f32 v115, v115, v2
v_ldexp_f32 v124, v124, v2
v_ldexp_f32 v125, v125, v2
v_ldexp_f32 v126, v126, v2
v_ldexp_f32 v127, v127, v2
v_ldexp_f32 v136, v136, v2
v_ldexp_f32 v137, v137, v2
v_ldexp_f32 v138, v138, v2
v_ldexp_f32 v139, v139, v2
v_ldexp_f32 v148, v148, v2
v_ldexp_f32 v149, v149, v2
v_ldexp_f32 v150, v150, v2
v_ldexp_f32 v151, v151, v2
v_ldexp_f32 v160, v160, v2
v_ldexp_f32 v161, v161, v2
v_ldexp_f32 v162, v162, v2
v_ldexp_f32 v163, v163, v2
v_ldexp_f32 v172, v172, v2
v_ldexp_f32 v173, v173, v2
v_ldexp_f32 v174, v174, v2
v_ldexp_f32 v175, v175, v2
v_ldexp_f32 v184, v184, v2
v_ldexp_f32 v185, v185, v2
v_ldexp_f32 v186, v186, v2
v_ldexp_f32 v187, v187, v2
v_ldexp_f32 v196, v196, v2
v_ldexp_f32 v197, v197, v2
v_ldexp_f32 v198, v198, v2
v_ldexp_f32 v199, v199, v2
v_ldexp_f32 v208, v208, v2
v_ldexp_f32 v209, v209, v2
v_ldexp_f32 v210, v210, v2
v_ldexp_f32 v211, v211, v2
v_ldexp_f32 v220, v220, v2
v_ldexp_f32 v221, v221, v2
v_ldexp_f32 v222, v222, v2
v_ldexp_f32 v223, v223, v2
v_ldexp_f32 v232, v232, v2
v_ldexp_f32 v233, v233, v2
v_ldexp_f32 v234, v234, v2
v_ldexp_f32 v235, v235, v2
v_ldexp_f32 v244, v244, v2
v_ldexp_f32 v245, v245, v2
v_ldexp_f32 v246, v246, v2
v_ldexp_f32 v247, v247, v2
v_accvgpr_read_b32 v3, a4
v_ldexp_f32 v3, v3, v2
v_accvgpr_write_b32 a4, v3
v_accvgpr_read_b32 v3, a5
v_ldexp_f32 v3, v3, v2
v_accvgpr_write_b32 a5, v3
v_accvgpr_read_b32 v3, a6
v_ldexp_f32 v3, v3, v2
v_accvgpr_write_b32 a6, v3
v_accvgpr_read_b32 v3, a7
v_ldexp_f32 v3, v3, v2
v_accvgpr_write_b32 a7, v3
v_max3_f32 v0, v44, v45, v46
v_max3_f32 v0, v0, v47, v56
v_max3_f32 v0, v0, v57, v58
v_max_f32 v0, v0, v59
v_mov_b32 v1, v0
s_nop 1
v_permlane32_swap_b32 v0, v1
v_max_f32 v0, v0, v1
v_mov_b32 v1, v0
s_nop 1
v_permlane16_swap_b32 v0, v1
v_max_f32 v0, v0, v1
v_ceil_f32 v0, v0
v_max_f32 v0, 0, v0
v_sub_f32 v44, v44, v0
v_sub_f32 v56, v56, v0
v_sub_f32 v20, v20, v0
v_sub_f32 v45, v45, v0
v_sub_f32 v57, v57, v0
v_sub_f32 v21, v21, v0
v_sub_f32 v46, v46, v0
v_sub_f32 v58, v58, v0
v_sub_f32 v22, v22, v0
v_sub_f32 v47, v47, v0
v_sub_f32 v59, v59, v0
v_sub_f32 v23, v23, v0
v_min_f32 v0, 0x43800000, v0
v_cvt_i32_f32 v2, v0
v_sub_u32 v2, 0, v2
v_ldexp_f32 v11, v11, v2
v_lshlrev_b32 v3, 16, v32
v_and_b32 v4, 0xffff0000, v32
v_ldexp_f32 v3, v3, v2
v_ldexp_f32 v4, v4, v2
v_cvt_pk_bf16_f32 v32, v3, v4
v_lshlrev_b32 v3, 16, v33
v_and_b32 v4, 0xffff0000, v33
v_ldexp_f32 v3, v3, v2
v_ldexp_f32 v4, v4, v2
v_cvt_pk_bf16_f32 v33, v3, v4
v_lshlrev_b32 v3, 16, v34
v_and_b32 v4, 0xffff0000, v34
v_ldexp_f32 v3, v3, v2
v_ldexp_f32 v4, v4, v2
v_cvt_pk_bf16_f32 v34, v3, v4
v_lshlrev_b32 v3, 16, v35
v_and_b32 v4, 0xffff0000, v35
v_ldexp_f32 v3, v3, v2
v_ldexp_f32 v4, v4, v2
v_cvt_pk_bf16_f32 v35, v3, v4
v_ldexp_f32 v80, v80, v2
v_ldexp_f32 v81, v81, v2
v_ldexp_f32 v82, v82, v2
v_ldexp_f32 v83, v83, v2
v_ldexp_f32 v92, v92, v2
v_ldexp_f32 v93, v93, v2
v_ldexp_f32 v94, v94, v2
v_ldexp_f32 v95, v95, v2
v_ldexp_f32 v104, v104, v2
v_ldexp_f32 v105, v105, v2
v_ldexp_f32 v106, v106, v2
v_ldexp_f32 v107, v107, v2
v_ldexp_f32 v116, v116, v2
v_ldexp_f32 v117, v117, v2
v_ldexp_f32 v118, v118, v2
v_ldexp_f32 v119, v119, v2
v_ldexp_f32 v128, v128, v2
v_ldexp_f32 v129, v129, v2
v_ldexp_f32 v130, v130, v2
v_ldexp_f32 v131, v131, v2
v_ldexp_f32 v140, v140, v2
v_ldexp_f32 v141, v141, v2
v_ldexp_f32 v142, v142, v2
v_ldexp_f32 v143, v143, v2
v_ldexp_f32 v152, v152, v2
v_ldexp_f32 v153, v153, v2
v_ldexp_f32 v154, v154, v2
v_ldexp_f32 v155, v155, v2
v_ldexp_f32 v164, v164, v2
v_ldexp_f32 v165, v165, v2
v_ldexp_f32 v166, v166, v2
v_ldexp_f32 v167, v167, v2
v_ldexp_f32 v176, v176, v2
v_ldexp_f32 v177, v177, v2
v_ldexp_f32 v178, v178, v2
v_ldexp_f32 v179, v179, v2
v_ldexp_f32 v188, v188, v2
v_ldexp_f32 v189, v189, v2
v_ldexp_f32 v190, v190, v2
v_ldexp_f32 v191, v191, v2
v_ldexp_f32 v200, v200, v2
v_ldexp_f32 v201, v201, v2
v_ldexp_f32 v202, v202, v2
v_ldexp_f32 v203, v203, v2
v_ldexp_f32 v212, v212, v2
v_ldexp_f32 v213, v213, v2
v_ldexp_f32 v214, v214, v2
v_ldexp_f32 v215, v215, v2
v_ldexp_f32 v224, v224, v2
v_ldexp_f32 v225, v225, v2
v_ldexp_f32 v226, v226, v2
v_ldexp_f32 v227, v227, v2
v_ldexp_f32 v236, v236, v2
v_ldexp_f32 v237, v237, v2
v_ldexp_f32 v238, v238, v2
v_ldexp_f32 v239, v239, v2
v_ldexp_f32 v248, v248, v2
v_ldexp_f32 v249, v249, v2
v_ldexp_f32 v250, v250, v2
v_ldexp_f32 v251, v251, v2
v_accvgpr_read_b32 v3, a8
v_ldexp_f32 v3, v3, v2
v_accvgpr_write_b32 a8, v3
v_accvgpr_read_b32 v3, a9
v_ldexp_f32 v3, v3, v2
v_accvgpr_write_b32 a9, v3
v_accvgpr_read_b32 v3, a10
v_ldexp_f32 v3, v3, v2
v_accvgpr_write_b32 a10, v3
v_accvgpr_read_b32 v3, a11
v_ldexp_f32 v3, v3, v2
v_accvgpr_write_b32 a11, v3
v_max3_f32 v0, v48, v49, v50
v_max3_f32 v0, v0, v51, v60
v_max3_f32 v0, v0, v61, v62
v_max_f32 v0, v0, v63
v_mov_b32 v1, v0
s_nop 1
v_permlane32_swap_b32 v0, v1
v_max_f32 v0, v0, v1
v_mov_b32 v1, v0
s_nop 1
v_permlane16_swap_b32 v0, v1
v_max_f32 v0, v0, v1
v_ceil_f32 v0, v0
v_max_f32 v0, 0, v0
v_sub_f32 v48, v48, v0
v_sub_f32 v60, v60, v0
v_sub_f32 v24, v24, v0
v_sub_f32 v49, v49, v0
v_sub_f32 v61, v61, v0
v_sub_f32 v25, v25, v0
v_sub_f32 v50, v50, v0
v_sub_f32 v62, v62, v0
v_sub_f32 v26, v26, v0
v_sub_f32 v51, v51, v0
v_sub_f32 v63, v63, v0
v_sub_f32 v27, v27, v0
v_min_f32 v0, 0x43800000, v0
v_cvt_i32_f32 v2, v0
v_sub_u32 v2, 0, v2
v_ldexp_f32 v12, v12, v2
v_lshlrev_b32 v3, 16, v36
v_and_b32 v4, 0xffff0000, v36
v_ldexp_f32 v3, v3, v2
v_ldexp_f32 v4, v4, v2
v_cvt_pk_bf16_f32 v36, v3, v4
v_lshlrev_b32 v3, 16, v37
v_and_b32 v4, 0xffff0000, v37
v_ldexp_f32 v3, v3, v2
v_ldexp_f32 v4, v4, v2
v_cvt_pk_bf16_f32 v37, v3, v4
v_lshlrev_b32 v3, 16, v38
v_and_b32 v4, 0xffff0000, v38
v_ldexp_f32 v3, v3, v2
v_ldexp_f32 v4, v4, v2
v_cvt_pk_bf16_f32 v38, v3, v4
v_lshlrev_b32 v3, 16, v39
v_and_b32 v4, 0xffff0000, v39
v_ldexp_f32 v3, v3, v2
v_ldexp_f32 v4, v4, v2
v_cvt_pk_bf16_f32 v39, v3, v4
v_ldexp_f32 v84, v84, v2
v_ldexp_f32 v85, v85, v2
v_ldexp_f32 v86, v86, v2
v_ldexp_f32 v87, v87, v2
v_ldexp_f32 v96, v96, v2
v_ldexp_f32 v97, v97, v2
v_ldexp_f32 v98, v98, v2
v_ldexp_f32 v99, v99, v2
v_ldexp_f32 v108, v108, v2
v_ldexp_f32 v109, v109, v2
v_ldexp_f32 v110, v110, v2
v_ldexp_f32 v111, v111, v2
v_ldexp_f32 v120, v120, v2
v_ldexp_f32 v121, v121, v2
v_ldexp_f32 v122, v122, v2
v_ldexp_f32 v123, v123, v2
v_ldexp_f32 v132, v132, v2
v_ldexp_f32 v133, v133, v2
v_ldexp_f32 v134, v134, v2
v_ldexp_f32 v135, v135, v2
v_ldexp_f32 v144, v144, v2
v_ldexp_f32 v145, v145, v2
v_ldexp_f32 v146, v146, v2
v_ldexp_f32 v147, v147, v2
v_ldexp_f32 v156, v156, v2
v_ldexp_f32 v157, v157, v2
v_ldexp_f32 v158, v158, v2
v_ldexp_f32 v159, v159, v2
v_ldexp_f32 v168, v168, v2
v_ldexp_f32 v169, v169, v2
v_ldexp_f32 v170, v170, v2
v_ldexp_f32 v171, v171, v2
v_ldexp_f32 v180, v180, v2
v_ldexp_f32 v181, v181, v2
v_ldexp_f32 v182, v182, v2
v_ldexp_f32 v183, v183, v2
v_ldexp_f32 v192, v192, v2
v_ldexp_f32 v193, v193, v2
v_ldexp_f32 v194, v194, v2
v_ldexp_f32 v195, v195, v2
v_ldexp_f32 v204, v204, v2
v_ldexp_f32 v205, v205, v2
v_ldexp_f32 v206, v206, v2
v_ldexp_f32 v207, v207, v2
v_ldexp_f32 v216, v216, v2
v_ldexp_f32 v217, v217, v2
v_ldexp_f32 v218, v218, v2
v_ldexp_f32 v219, v219, v2
v_ldexp_f32 v228, v228, v2
v_ldexp_f32 v229, v229, v2
v_ldexp_f32 v230, v230, v2
v_ldexp_f32 v231, v231, v2
v_ldexp_f32 v240, v240, v2
v_ldexp_f32 v241, v241, v2
v_ldexp_f32 v242, v242, v2
v_ldexp_f32 v243, v243, v2
v_accvgpr_read_b32 v3, a0
v_ldexp_f32 v3, v3, v2
v_accvgpr_write_b32 a0, v3
v_accvgpr_read_b32 v3, a1
v_ldexp_f32 v3, v3, v2
v_accvgpr_write_b32 a1, v3
v_accvgpr_read_b32 v3, a2
v_ldexp_f32 v3, v3, v2
v_accvgpr_write_b32 a2, v3
v_accvgpr_read_b32 v3, a3
v_ldexp_f32 v3, v3, v2
v_accvgpr_write_b32 a3, v3
v_accvgpr_read_b32 v3, a12
v_ldexp_f32 v3, v3, v2
v_accvgpr_write_b32 a12, v3
v_accvgpr_read_b32 v3, a13
v_ldexp_f32 v3, v3, v2
v_accvgpr_write_b32 a13, v3
v_accvgpr_read_b32 v3, a14
v_ldexp_f32 v3, v3, v2
v_accvgpr_write_b32 a14, v3
v_accvgpr_read_b32 v3, a15
v_ldexp_f32 v3, v3, v2
v_accvgpr_write_b32 a15, v3
v_accvgpr_read_b32 v0, a240
v_accvgpr_read_b32 v1, a241
v_accvgpr_read_b32 v2, a242
v_accvgpr_read_b32 v3, a243
v_accvgpr_read_b32 v4, a244
v_accvgpr_read_b32 v5, a245
v_accvgpr_read_b32 v6, a246
v_accvgpr_read_b32 v7, a247
s_nop 1
s_setpc_b64 s[60:61]
RAREP_1:
s_nop 15
v_accvgpr_write_b32 a240, v0
v_accvgpr_write_b32 a241, v1
v_accvgpr_write_b32 a242, v2
v_accvgpr_write_b32 a243, v3
v_accvgpr_write_b32 a244, v4
v_accvgpr_write_b32 a245, v5
v_accvgpr_write_b32 a246, v6
v_accvgpr_write_b32 a247, v7
v_max3_f32 v0, v64, v65, v66
v_max3_f32 v0, v0, v67, v40
v_max3_f32 v0, v0, v41, v42
v_max_f32 v0, v0, v43
v_mov_b32 v1, v0
s_nop 1
v_permlane32_swap_b32 v0, v1
v_max_f32 v0, v0, v1
v_mov_b32 v1, v0
s_nop 1
v_permlane16_swap_b32 v0, v1
v_max_f32 v0, v0, v1
v_ceil_f32 v0, v0
v_max_f32 v0, 0, v0
v_sub_f32 v64, v64, v0
v_sub_f32 v40, v40, v0
v_sub_f32 v16, v16, v0
v_sub_f32 v65, v65, v0
v_sub_f32 v41, v41, v0
v_sub_f32 v17, v17, v0
v_sub_f32 v66, v66, v0
v_sub_f32 v42, v42, v0
v_sub_f32 v18, v18, v0
v_sub_f32 v67, v67, v0
v_sub_f32 v43, v43, v0
v_sub_f32 v19, v19, v0
v_min_f32 v0, 0x43800000, v0
v_cvt_i32_f32 v2, v0
v_sub_u32 v2, 0, v2
v_ldexp_f32 v10, v10, v2
v_lshlrev_b32 v3, 16, v28
v_and_b32 v4, 0xffff0000, v28
v_ldexp_f32 v3, v3, v2
v_ldexp_f32 v4, v4, v2
v_cvt_pk_bf16_f32 v28, v3, v4
v_lshlrev_b32 v3, 16, v29
v_and_b32 v4, 0xffff0000, v29
v_ldexp_f32 v3, v3, v2
v_ldexp_f32 v4, v4, v2
v_cvt_pk_bf16_f32 v29, v3, v4
v_lshlrev_b32 v3, 16, v30
v_and_b32 v4, 0xffff0000, v30
v_ldexp_f32 v3, v3, v2
v_ldexp_f32 v4, v4, v2
v_cvt_pk_bf16_f32 v30, v3, v4
v_lshlrev_b32 v3, 16, v31
v_and_b32 v4, 0xffff0000, v31
v_ldexp_f32 v3, v3, v2
v_ldexp_f32 v4, v4, v2
v_cvt_pk_bf16_f32 v31, v3, v4
v_ldexp_f32 v76, v76, v2
v_ldexp_f32 v77, v77, v2
v_ldexp_f32 v78, v78, v2
v_ldexp_f32 v79, v79, v2
v_ldexp_f32 v88, v88, v2
v_ldexp_f32 v89, v89, v2
v_ldexp_f32 v90, v90, v2
v_ldexp_f32 v91, v91, v2
v_ldexp_f32 v100, v100, v2
v_ldexp_f32 v101, v101, v2
v_ldexp_f32 v102, v102, v2
v_ldexp_f32 v103, v103, v2
v_ldexp_f32 v112, v112, v2
v_ldexp_f32 v113, v113, v2
v_ldexp_f32 v114, v114, v2
v_ldexp_f32 v115, v115, v2
v_ldexp_f32 v124, v124, v2
v_ldexp_f32 v125, v125, v2
v_ldexp_f32 v126, v126, v2
v_ldexp_f32 v127, v127, v2
v_ldexp_f32 v136, v136, v2
v_ldexp_f32 v137, v137, v2
v_ldexp_f32 v138, v138, v2
v_ldexp_f32 v139, v139, v2
v_ldexp_f32 v148, v148, v2
v_ldexp_f32 v149, v149, v2
v_ldexp_f32 v150, v150, v2
v_ldexp_f32 v151, v151, v2
v_ldexp_f32 v160, v160, v2
v_ldexp_f32 v161, v161, v2
v_ldexp_f32 v162, v162, v2
v_ldexp_f32 v163, v163, v2
v_ldexp_f32 v172, v172, v2
v_ldexp_f32 v173, v173, v2
v_ldexp_f32 v174, v174, v2
v_ldexp_f32 v175, v175, v2
v_ldexp_f32 v184, v184, v2
v_ldexp_f32 v185, v185, v2
v_ldexp_f32 v186, v186, v2
v_ldexp_f32 v187, v187, v2
v_ldexp_f32 v196, v196, v2
v_ldexp_f32 v197, v197, v2
v_ldexp_f32 v198, v198, v2
v_ldexp_f32 v199, v199, v2
v_ldexp_f32 v208, v208, v2
v_ldexp_f32 v209, v209, v2
v_ldexp_f32 v210, v210, v2
v_ldexp_f32 v211, v211, v2
v_ldexp_f32 v220, v220, v2
v_ldexp_f32 v221, v221, v2
v_ldexp_f32 v222, v222, v2
v_ldexp_f32 v223, v223, v2
v_ldexp_f32 v232, v232, v2
v_ldexp_f32 v233, v233, v2
v_ldexp_f32 v234, v234, v2
v_ldexp_f32 v235, v235, v2
v_ldexp_f32 v244, v244, v2
v_ldexp_f32 v245, v245, v2
v_ldexp_f32 v246, v246, v2
v_ldexp_f32 v247, v247, v2
v_accvgpr_read_b32 v3, a4
v_ldexp_f32 v3, v3, v2
v_accvgpr_write_b32 a4, v3
v_accvgpr_read_b32 v3, a5
v_ldexp_f32 v3, v3, v2
v_accvgpr_write_b32 a5, v3
v_accvgpr_read_b32 v3, a6
v_ldexp_f32 v3, v3, v2
v_accvgpr_write_b32 a6, v3
v_accvgpr_read_b32 v3, a7
v_ldexp_f32 v3, v3, v2
v_accvgpr_write_b32 a7, v3
v_max3_f32 v0, v68, v69, v70
v_max3_f32 v0, v0, v71, v44
v_max3_f32 v0, v0, v45, v46
v_max_f32 v0, v0, v47
v_mov_b32 v1, v0
s_nop 1
v_permlane32_swap_b32 v0, v1
v_max_f32 v0, v0, v1
v_mov_b32 v1, v0
s_nop 1
v_permlane16_swap_b32 v0, v1
v_max_f32 v0, v0, v1
v_ceil_f32 v0, v0
v_max_f32 v0, 0, v0
v_sub_f32 v68, v68, v0
v_sub_f32 v44, v44, v0
v_sub_f32 v20, v20, v0
v_sub_f32 v69, v69, v0
v_sub_f32 v45, v45, v0
v_sub_f32 v21, v21, v0
v_sub_f32 v70, v70, v0
v_sub_f32 v46, v46, v0
v_sub_f32 v22, v22, v0
v_sub_f32 v71, v71, v0
v_sub_f32 v47, v47, v0
v_sub_f32 v23, v23, v0
v_min_f32 v0, 0x43800000, v0
v_cvt_i32_f32 v2, v0
v_sub_u32 v2, 0, v2
v_ldexp_f32 v11, v11, v2
v_lshlrev_b32 v3, 16, v32
v_and_b32 v4, 0xffff0000, v32
v_ldexp_f32 v3, v3, v2
v_ldexp_f32 v4, v4, v2
v_cvt_pk_bf16_f32 v32, v3, v4
v_lshlrev_b32 v3, 16, v33
v_and_b32 v4, 0xffff0000, v33
v_ldexp_f32 v3, v3, v2
v_ldexp_f32 v4, v4, v2
v_cvt_pk_bf16_f32 v33, v3, v4
v_lshlrev_b32 v3, 16, v34
v_and_b32 v4, 0xffff0000, v34
v_ldexp_f32 v3, v3, v2
v_ldexp_f32 v4, v4, v2
v_cvt_pk_bf16_f32 v34, v3, v4
v_lshlrev_b32 v3, 16, v35
v_and_b32 v4, 0xffff0000, v35
v_ldexp_f32 v3, v3, v2
v_ldexp_f32 v4, v4, v2
v_cvt_pk_bf16_f32 v35, v3, v4
v_ldexp_f32 v80, v80, v2
v_ldexp_f32 v81, v81, v2
v_ldexp_f32 v82, v82, v2
v_ldexp_f32 v83, v83, v2
v_ldexp_f32 v92, v92, v2
v_ldexp_f32 v93, v93, v2
v_ldexp_f32 v94, v94, v2
v_ldexp_f32 v95, v95, v2
v_ldexp_f32 v104, v104, v2
v_ldexp_f32 v105, v105, v2
v_ldexp_f32 v106, v106, v2
v_ldexp_f32 v107, v107, v2
v_ldexp_f32 v116, v116, v2
v_ldexp_f32 v117, v117, v2
v_ldexp_f32 v118, v118, v2
v_ldexp_f32 v119, v119, v2
v_ldexp_f32 v128, v128, v2
v_ldexp_f32 v129, v129, v2
v_ldexp_f32 v130, v130, v2
v_ldexp_f32 v131, v131, v2
v_ldexp_f32 v140, v140, v2
v_ldexp_f32 v141, v141, v2
v_ldexp_f32 v142, v142, v2
v_ldexp_f32 v143, v143, v2
v_ldexp_f32 v152, v152, v2
v_ldexp_f32 v153, v153, v2
v_ldexp_f32 v154, v154, v2
v_ldexp_f32 v155, v155, v2
v_ldexp_f32 v164, v164, v2
v_ldexp_f32 v165, v165, v2
v_ldexp_f32 v166, v166, v2
v_ldexp_f32 v167, v167, v2
v_ldexp_f32 v176, v176, v2
v_ldexp_f32 v177, v177, v2
v_ldexp_f32 v178, v178, v2
v_ldexp_f32 v179, v179, v2
v_ldexp_f32 v188, v188, v2
v_ldexp_f32 v189, v189, v2
v_ldexp_f32 v190, v190, v2
v_ldexp_f32 v191, v191, v2
v_ldexp_f32 v200, v200, v2
v_ldexp_f32 v201, v201, v2
v_ldexp_f32 v202, v202, v2
v_ldexp_f32 v203, v203, v2
v_ldexp_f32 v212, v212, v2
v_ldexp_f32 v213, v213, v2
v_ldexp_f32 v214, v214, v2
v_ldexp_f32 v215, v215, v2
v_ldexp_f32 v224, v224, v2
v_ldexp_f32 v225, v225, v2
v_ldexp_f32 v226, v226, v2
v_ldexp_f32 v227, v227, v2
v_ldexp_f32 v236, v236, v2
v_ldexp_f32 v237, v237, v2
v_ldexp_f32 v238, v238, v2
v_ldexp_f32 v239, v239, v2
v_ldexp_f32 v248, v248, v2
v_ldexp_f32 v249, v249, v2
v_ldexp_f32 v250, v250, v2
v_ldexp_f32 v251, v251, v2
v_accvgpr_read_b32 v3, a8
v_ldexp_f32 v3, v3, v2
v_accvgpr_write_b32 a8, v3
v_accvgpr_read_b32 v3, a9
v_ldexp_f32 v3, v3, v2
v_accvgpr_write_b32 a9, v3
v_accvgpr_read_b32 v3, a10
v_ldexp_f32 v3, v3, v2
v_accvgpr_write_b32 a10, v3
v_accvgpr_read_b32 v3, a11
v_ldexp_f32 v3, v3, v2
v_accvgpr_write_b32 a11, v3
v_max3_f32 v0, v72, v73, v74
v_max3_f32 v0, v0, v75, v48
v_max3_f32 v0, v0, v49, v50
v_max_f32 v0, v0, v51
v_mov_b32 v1, v0
s_nop 1
v_permlane32_swap_b32 v0, v1
v_max_f32 v0, v0, v1
v_mov_b32 v1, v0
s_nop 1
v_permlane16_swap_b32 v0, v1
v_max_f32 v0, v0, v1
v_ceil_f32 v0, v0
v_max_f32 v0, 0, v0
v_sub_f32 v72, v72, v0
v_sub_f32 v48, v48, v0
v_sub_f32 v24, v24, v0
v_sub_f32 v73, v73, v0
v_sub_f32 v49, v49, v0
v_sub_f32 v25, v25, v0
v_sub_f32 v74, v74, v0
v_sub_f32 v50, v50, v0
v_sub_f32 v26, v26, v0
v_sub_f32 v75, v75, v0
v_sub_f32 v51, v51, v0
v_sub_f32 v27, v27, v0
v_min_f32 v0, 0x43800000, v0
v_cvt_i32_f32 v2, v0
v_sub_u32 v2, 0, v2
v_ldexp_f32 v12, v12, v2
v_lshlrev_b32 v3, 16, v36
v_and_b32 v4, 0xffff0000, v36
v_ldexp_f32 v3, v3, v2
v_ldexp_f32 v4, v4, v2
v_cvt_pk_bf16_f32 v36, v3, v4
v_lshlrev_b32 v3, 16, v37
v_and_b32 v4, 0xffff0000, v37
v_ldexp_f32 v3, v3, v2
v_ldexp_f32 v4, v4, v2
v_cvt_pk_bf16_f32 v37, v3, v4
v_lshlrev_b32 v3, 16, v38
v_and_b32 v4, 0xffff0000, v38
v_ldexp_f32 v3, v3, v2
v_ldexp_f32 v4, v4, v2
v_cvt_pk_bf16_f32 v38, v3, v4
v_lshlrev_b32 v3, 16, v39
v_and_b32 v4, 0xffff0000, v39
v_ldexp_f32 v3, v3, v2
v_ldexp_f32 v4, v4, v2
v_cvt_pk_bf16_f32 v39, v3, v4
v_ldexp_f32 v84, v84, v2
v_ldexp_f32 v85, v85, v2
v_ldexp_f32 v86, v86, v2
v_ldexp_f32 v87, v87, v2
v_ldexp_f32 v96, v96, v2
v_ldexp_f32 v97, v97, v2
v_ldexp_f32 v98, v98, v2
v_ldexp_f32 v99, v99, v2
v_ldexp_f32 v108, v108, v2
v_ldexp_f32 v109, v109, v2
v_ldexp_f32 v110, v110, v2
v_ldexp_f32 v111, v111, v2
v_ldexp_f32 v120, v120, v2
v_ldexp_f32 v121, v121, v2
v_ldexp_f32 v122, v122, v2
v_ldexp_f32 v123, v123, v2
v_ldexp_f32 v132, v132, v2
v_ldexp_f32 v133, v133, v2
v_ldexp_f32 v134, v134, v2
v_ldexp_f32 v135, v135, v2
v_ldexp_f32 v144, v144, v2
v_ldexp_f32 v145, v145, v2
v_ldexp_f32 v146, v146, v2
v_ldexp_f32 v147, v147, v2
v_ldexp_f32 v156, v156, v2
v_ldexp_f32 v157, v157, v2
v_ldexp_f32 v158, v158, v2
v_ldexp_f32 v159, v159, v2
v_ldexp_f32 v168, v168, v2
v_ldexp_f32 v169, v169, v2
v_ldexp_f32 v170, v170, v2
v_ldexp_f32 v171, v171, v2
v_ldexp_f32 v180, v180, v2
v_ldexp_f32 v181, v181, v2
v_ldexp_f32 v182, v182, v2
v_ldexp_f32 v183, v183, v2
v_ldexp_f32 v192, v192, v2
v_ldexp_f32 v193, v193, v2
v_ldexp_f32 v194, v194, v2
v_ldexp_f32 v195, v195, v2
v_ldexp_f32 v204, v204, v2
v_ldexp_f32 v205, v205, v2
v_ldexp_f32 v206, v206, v2
v_ldexp_f32 v207, v207, v2
v_ldexp_f32 v216, v216, v2
v_ldexp_f32 v217, v217, v2
v_ldexp_f32 v218, v218, v2
v_ldexp_f32 v219, v219, v2
v_ldexp_f32 v228, v228, v2
v_ldexp_f32 v229, v229, v2
v_ldexp_f32 v230, v230, v2
v_ldexp_f32 v231, v231, v2
v_ldexp_f32 v240, v240, v2
v_ldexp_f32 v241, v241, v2
v_ldexp_f32 v242, v242, v2
v_ldexp_f32 v243, v243, v2
v_accvgpr_read_b32 v3, a0
v_ldexp_f32 v3, v3, v2
v_accvgpr_write_b32 a0, v3
v_accvgpr_read_b32 v3, a1
v_ldexp_f32 v3, v3, v2
v_accvgpr_write_b32 a1, v3
v_accvgpr_read_b32 v3, a2
v_ldexp_f32 v3, v3, v2
v_accvgpr_write_b32 a2, v3
v_accvgpr_read_b32 v3, a3
v_ldexp_f32 v3, v3, v2
v_accvgpr_write_b32 a3, v3
v_accvgpr_read_b32 v3, a12
v_ldexp_f32 v3, v3, v2
v_accvgpr_write_b32 a12, v3
v_accvgpr_read_b32 v3, a13
v_ldexp_f32 v3, v3, v2
v_accvgpr_write_b32 a13, v3
v_accvgpr_read_b32 v3, a14
v_ldexp_f32 v3, v3, v2
v_accvgpr_write_b32 a14, v3
v_accvgpr_read_b32 v3, a15
v_ldexp_f32 v3, v3, v2
v_accvgpr_write_b32 a15, v3
v_accvgpr_read_b32 v0, a240
v_accvgpr_read_b32 v1, a241
v_accvgpr_read_b32 v2, a242
v_accvgpr_read_b32 v3, a243
v_accvgpr_read_b32 v4, a244
v_accvgpr_read_b32 v5, a245
v_accvgpr_read_b32 v6, a246
v_accvgpr_read_b32 v7, a247
s_nop 1
s_setpc_b64 s[60:61]
L_code_end:
.section .rodata,"a"
.p2align 6
.amdhsa_kernel standalone__mha_block_cached__near_ridge_kernel
  .amdhsa_next_free_vgpr 512
  .amdhsa_next_free_sgpr 102
  .amdhsa_accum_offset 256
  .amdhsa_group_segment_fixed_size 0
  .amdhsa_kernarg_size 64
  .amdhsa_user_sgpr_count 2
  .amdhsa_user_sgpr_kernarg_segment_ptr 1
  .amdhsa_system_sgpr_workgroup_id_x 1
  .amdhsa_float_denorm_mode_32 3
.end_amdhsa_kernel
```
